```python
import torch

def _softmax(x, axis=-1):
    return torch.softmax(x, dim=axis)

def _gelu(x):
    return torch.nn.functional.gelu(x, approximate='tanh')

def _silu(x):
    return torch.nn.functional.silu(x)

def _sigmoid(x):
    return torch.sigmoid(x)

def _layernorm(x, axis=-1, eps=1e-05):
    m = x.mean(dim=axis, keepdim=True)
    v = x.var(dim=axis, keepdim=True, unbiased=False)
    return (x - m) / torch.sqrt(v + eps)

def _scatter_add(tgt, idx, src, axis=0):
    return tgt.clone().index_add_(axis, idx, src)

def _segment_sum(src, seg, n):
    out = torch.zeros((n,) + src.shape[1:], dtype=src.dtype)
    return out.index_add_(0, seg, src)

def _pad(x, pw):
    flat = tuple((v for pair in reversed(pw) for v in pair))
    return torch.nn.functional.pad(x, flat)
kernel_name = 'gather_scatter__tensor_product_equiv_mace__graph'

def setup_inputs():

    _w = lambda a: (lambda t: t.to(torch.bfloat16) if t.is_floating_point() else t)(torch.as_tensor(a))
    N, deg = (10000, 32)
    Lmax, C, De = (1, 128, 16)
    M = (Lmax + 1) ** 2
    E = N * deg
    src = (lambda lo, hi, *s: torch.randint(lo, hi, s))(0, N, E).to(torch.int64)
    dst = (lambda lo, hi, *s: torch.randint(lo, hi, s))(0, N, E).to(torch.int64)
    r = (lambda *s: torch.randn(*s, dtype=torch.bfloat16) * 0.05)(E, 3).to(float)
    r = r / (torch.linalg.norm(r, dim=-1, keepdim=True).to(float) + 1e-06)
    rx, ry, rz = (r[:, 0].clone(), r[:, 1].clone(), r[:, 2].clone())
    x2, y2, z2 = (rx * rx, ry * ry, rz * rz)
    sh_list = [torch.ones_like(rx), rx, ry, rz, rx * ry, ry * rz, 2.0 * z2 - x2 - y2, rx * rz, x2 - y2, ry * (3.0 * x2 - y2), rx * ry * rz, ry * (4.0 * z2 - x2 - y2), rz * (2.0 * z2 - 3.0 * x2 - 3.0 * y2), rx * (4.0 * z2 - x2 - y2), rz * (x2 - y2), rx * (x2 - 3.0 * y2)]
    sh16 = torch.stack(sh_list, dim=-1).to(float)
    pad = max(0, M - 16)
    sh_full = torch.cat([sh16, torch.zeros((E, pad), dtype=float)], dim=-1)[:, :M]
    cg = ((lambda *s: torch.randn(*s, dtype=torch.bfloat16) * 0.05)(M, M, M) * (1.0 / float(M))).to(float)
    return {'x': _w(((lambda *s: torch.randn(*s, dtype=torch.bfloat16) * 0.05)(N, M, C) * 0.3).to(float)), 'src': _w(src), 'dst': _w(dst), 'sh': _w(sh_full.to(float)), 'edge_attr': _w(((lambda *s: torch.randn(*s, dtype=torch.bfloat16) * 0.05)(E, De) * 0.3).to(float)), 'cg': _w(cg), 'w_r': _w(((lambda *s: torch.randn(*s, dtype=torch.bfloat16) * 0.05)(De, C) * (1.0 / float(De) ** 0.5)).to(float)), 'w_out': _w(((lambda *s: torch.randn(*s, dtype=torch.bfloat16) * 0.05)(C, C) * (1.0 / float(C) ** 0.5)).to(float))}

def reference(x, src, dst, sh, edge_attr, cg, w_r, w_out):
    N = x.shape[0]
    M = x.shape[1]
    C = x.shape[2]
    h = x[src]
    tp = torch.einsum('uvw,euc,ev->ewc', cg, h, sh)
    rw = edge_attr @ w_r
    msg = tp * rw[:, None, :]
    msg2 = msg.reshape(-1, M * C)
    agg = _segment_sum(msg2, dst, N).reshape(N, M, C)
    out = torch.einsum('nmc,cd->nmd', agg, w_out)
    return out
```

```asm
; @launch kernel=part_kernel grid=(250,1,1) block=(640,1,1) lds=63488
; @launch kernel=gather_scatter__tensor_product_equiv_mace__graph_kernel grid=(256,1,1) block=(512,1,1) lds=125440
.amdgcn_target "amdgcn-amd-amdhsa--gfx950"
.text
.globl part_kernel
.p2align 8
.type part_kernel,@function
part_kernel:
    s_cmp_ge_u32 s2, 250
    s_cbranch_scc1 K1_done
    s_load_dwordx4 s[4:7], s[0:1], 8
    s_load_dwordx4 s[8:11], s[0:1], 24
    s_load_dwordx2 s[12:13], s[0:1], 80
    v_lshrrev_b32 v12, 6, v0
    v_lshlrev_b32 v1, 3, v0
    v_lshlrev_b32 v2, 4, v0
    v_and_b32 v3, 63, v0
    v_readfirstlane_b32 s3, v12
    v_lshlrev_b32 v13, 2, v0
    v_mov_b32 v14, 0
    v_mov_b32 v15, 1
    ds_write_b32 v13, v14
    s_mul_i32 s14, s2, 5120
    s_mul_i32 s15, s2, 10240
    s_mul_i32 s26, s2, 40960
    s_lshl_b32 s27, s3, 12
    v_lshl_add_u32 v16, v3, 4, s27
    s_add_u32 m0, s27, 22528
    s_waitcnt lgkmcnt(0)
    s_add_u32 s6, s6, s14
    s_addc_u32 s7, s7, 0
    global_load_dwordx2 v[4:5], v1, s[6:7] nt
    s_add_u32 s4, s4, s14
    s_addc_u32 s5, s5, 0
    global_load_dwordx2 v[6:7], v1, s[4:5] nt
    s_add_u32 s8, s8, s15
    s_addc_u32 s9, s9, 0
    global_load_dwordx4 v[8:11], v2, s[8:9] nt
    s_add_u32 s16, s10, s26
    s_addc_u32 s17, s11, 0
    s_mov_b32 s18, 40960
    s_mov_b32 s19, 0x20000
    buffer_load_dwordx4 v16, s[16:19], 0 offen offset:0 nt lds
    buffer_load_dwordx4 v16, s[16:19], 0 offen offset:1024 nt lds
    buffer_load_dwordx4 v16, s[16:19], 0 offen offset:2048 nt lds
    buffer_load_dwordx4 v16, s[16:19], 0 offen offset:3072 nt lds
    s_lshl_b32 s14, s2, 10
    s_add_u32 s20, s12, s14
    s_addc_u32 s21, s13, 0
    s_mul_i32 s14, s2, 15360
    s_add_u32 s14, s14, 262144
    s_add_u32 s22, s12, s14
    s_addc_u32 s23, s13, 0
    s_add_u32 s26, s26, 4194304
    s_add_u32 s24, s12, s26
    s_addc_u32 s25, s13, 0
    s_mov_b32 s28, 109951168
    s_movk_i32 s29, 625
    s_movk_i32 s30, 838
    s_barrier
    s_waitcnt vmcnt(6)
    v_mul_hi_u32 v20, v4, s28
    v_mul_hi_u32 v21, v5, s28
    v_lshlrev_b32 v22, 2, v20
    ds_add_rtn_u32 v24, v22, v15 offset:0
    v_lshlrev_b32 v23, 2, v21
    ds_add_rtn_u32 v25, v23, v15 offset:0
    v_mad_u32_u24 v26, v20, s29, 15
    v_lshrrev_b32 v26, 4, v26
    v_sub_u32 v26, v4, v26
    v_lshrrev_b32 v28, 3, v20
    v_and_b32 v28, 28, v28
    v_mad_u32_u24 v27, v21, s29, 15
    v_lshrrev_b32 v27, 4, v27
    v_sub_u32 v27, v5, v27
    v_lshrrev_b32 v29, 3, v21
    v_and_b32 v29, 28, v29
    s_waitcnt vmcnt(5)
    v_mul_u32_u24 v30, s30, v6
    v_lshrrev_b32 v30, 18, v30
    v_sub_u32 v30, v30, v28
    v_and_b32 v30, 31, v30
    v_lshl_or_b32 v30, v26, 5, v30
    v_lshlrev_b32 v30, 21, v30
    v_lshl_or_b32 v30, v6, 7, v30
    v_mul_u32_u24 v31, s30, v7
    v_lshrrev_b32 v31, 18, v31
    v_sub_u32 v31, v31, v29
    v_and_b32 v31, 31, v31
    v_lshl_or_b32 v31, v27, 5, v31
    v_lshlrev_b32 v31, 21, v31
    v_lshl_or_b32 v31, v7, 7, v31
    v_lshlrev_b32 v12, 4, v3
    s_waitcnt lgkmcnt(0)
    s_barrier
    ds_read_b128 v[32:35], v12 offset:0
    v_lshlrev_b32 v44, 6, v0
    v_add_u32 v45, 32, v44
    s_waitcnt lgkmcnt(0)
    v_add_u32 v36, v32, v33
    v_add3_u32 v36, v36, v34, v35
    v_mov_b32 v37, v36
    s_nop 1
    v_add_u32_dpp v37, v37, v37 row_shr:1 row_mask:0xf bank_mask:0xf
    s_nop 1
    v_add_u32_dpp v37, v37, v37 row_shr:2 row_mask:0xf bank_mask:0xf
    s_nop 1
    v_add_u32_dpp v37, v37, v37 row_shr:4 row_mask:0xf bank_mask:0xf
    s_nop 1
    v_add_u32_dpp v37, v37, v37 row_shr:8 row_mask:0xf bank_mask:0xf
    s_nop 1
    v_add_u32_dpp v37, v37, v37 row_bcast:15 row_mask:0xa bank_mask:0xf
    s_nop 1
    v_add_u32_dpp v37, v37, v37 row_bcast:31 row_mask:0xc bank_mask:0xf
    v_sub_u32 v40, v37, v36
    v_add_u32 v41, v40, v32
    v_add_u32 v42, v41, v33
    v_add_u32 v43, v42, v34
    ds_write_b128 v12, v[40:43] offset:1024
    ds_read_b32 v26, v22 offset:1024
    ds_read_b32 v27, v23 offset:1024
    s_cmp_lg_u32 s3, 9
    s_cbranch_scc1 K1_notab
    v_lshl_or_b32 v32, v32, 16, v40
    v_lshl_or_b32 v33, v33, 16, v41
    v_lshl_or_b32 v34, v34, 16, v42
    v_lshl_or_b32 v35, v35, 16, v43
    global_store_dwordx4 v12, v[32:35], s[20:21]
K1_notab:
    s_waitcnt vmcnt(4) lgkmcnt(0)
    v_add_u32 v26, v26, v24
    v_lshlrev_b32 v28, 2, v26
    v_mul_u32_u24 v26, 12, v26
    ds_write_b32 v28, v44 offset:2048
    v_add_u32 v26, 7168, v26
    ds_write2_b32 v26, v8, v9 offset0:0 offset1:1
    ds_write_b32 v26, v30 offset:8
    v_add_u32 v27, v27, v25
    v_lshlrev_b32 v29, 2, v27
    v_mul_u32_u24 v27, 12, v27
    ds_write_b32 v29, v45 offset:2048
    v_add_u32 v27, 7168, v27
    ds_write2_b32 v27, v10, v11 offset0:0 offset1:1
    ds_write_b32 v27, v31 offset:8
    v_lshrrev_b32 v20, 1, v3
    v_lshlrev_b32 v20, 2, v20
    s_lshl_b32 s14, s3, 9
    v_add_u32 v20, s14, v20
    v_and_b32 v21, 1, v3
    v_lshlrev_b32 v21, 4, v21
    v_add_u32 v21, 22528, v21
    s_waitcnt vmcnt(0) lgkmcnt(0)
    s_barrier
    ds_read_b32 v22, v20 offset:2048
    ds_read_b32 v23, v20 offset:2176
    ds_read_b32 v24, v20 offset:2304
    ds_read_b32 v25, v20 offset:2432
    ds_read_b128 v[48:51], v2 offset:7168
    ds_read_b128 v[52:55], v2 offset:17408
    s_waitcnt lgkmcnt(2)
    v_add_u32 v22, v21, v22
    ds_read_b128 v[56:59], v22
    v_add_u32 v23, v21, v23
    ds_read_b128 v[60:63], v23
    v_add_u32 v24, v21, v24
    ds_read_b128 v[64:67], v24
    v_add_u32 v25, v21, v25
    ds_read_b128 v[68:71], v25
    s_waitcnt lgkmcnt(4)
    global_store_dwordx4 v2, v[48:51], s[22:23]
    s_cmp_ge_u32 s3, 5
    s_cbranch_scc1 K1_nosk2
    v_add_u32 v1, 10240, v2
    global_store_dwordx4 v1, v[52:55], s[22:23]
K1_nosk2:
    s_waitcnt lgkmcnt(3)
    global_store_dwordx4 v16, v[56:59], s[24:25] offset:0
    s_waitcnt lgkmcnt(2)
    global_store_dwordx4 v16, v[60:63], s[24:25] offset:1024
    s_waitcnt lgkmcnt(1)
    global_store_dwordx4 v16, v[64:67], s[24:25] offset:2048
    s_waitcnt lgkmcnt(0)
    global_store_dwordx4 v16, v[68:71], s[24:25] offset:3072
K1_done:
    s_endpgm
.globl gather_scatter__tensor_product_equiv_mace__graph_kernel
.p2align 8
.type gather_scatter__tensor_product_equiv_mace__graph_kernel,@function
gather_scatter__tensor_product_equiv_mace__graph_kernel:
    s_cmp_ge_u32 s2, 256
    s_cbranch_scc1 K2_done
    s_load_dwordx2 s[14:15], s[0:1], 80
    s_load_dwordx2 s[4:5], s[0:1], 0
    s_load_dwordx4 s[8:11], s[0:1], 48
    s_load_dwordx2 s[6:7], s[0:1], 40
    s_load_dwordx2 s[12:13], s[0:1], 64
    v_lshrrev_b32 v8, 6, v0
    v_and_b32 v1, 63, v0
    v_readfirstlane_b32 s3, v8
    s_and_b32 s44, s2, 7
    s_lshl_b32 s44, s44, 5
    s_lshr_b32 s54, s2, 3
    s_add_u32 s44, s44, s54
    v_lshrrev_b32 v9, 1, v0
    v_lshlrev_b32 v10, 10, v9
    s_lshl_b32 s54, s44, 2
    v_lshlrev_b32 v2, 4, v1
    s_waitcnt lgkmcnt(0)
    s_mov_b32 s20, s14
    s_mov_b32 s21, s15
    s_mov_b32 s22, 256000
    s_mov_b32 s23, 0x20000
    buffer_load_dword v3, v10, s[20:23], s54 offen
    s_mov_b32 s32, s10
    s_mov_b32 s33, s11
    s_mov_b32 s34, 32768
    s_mov_b32 s35, 0x20000
    s_lshl_b32 s54, s3, 12
    s_add_u32 m0, s54, 15360
    s_nop 0
    buffer_load_dwordx4 v2, s[32:35], s54 offen offset:0 lds
    buffer_load_dwordx4 v2, s[32:35], s54 offen offset:1024 lds
    buffer_load_dwordx4 v2, s[32:35], s54 offen offset:2048 lds
    buffer_load_dwordx4 v2, s[32:35], s54 offen offset:3072 lds
    s_mov_b32 s36, s8
    s_mov_b32 s37, s9
    s_mov_b32 s38, 4096
    s_mov_b32 s39, 0x20000
    s_and_b32 s54, s3, 3
    s_lshl_b32 s54, s54, 10
    s_add_u32 m0, s54, 11264
    s_nop 0
    buffer_load_dwordx4 v2, s[36:39], s54 offen lds
    v_lshrrev_b32 v11, 4, v1
    v_lshlrev_b32 v11, 5, v11
    v_and_b32 v12, 3, v1
    v_lshl_add_u32 v11, v12, 1, v11
    global_load_ushort v128, v11, s[6:7] offset:0
    global_load_ushort v129, v11, s[6:7] offset:8
    global_load_ushort v130, v11, s[6:7] offset:16
    global_load_ushort v131, v11, s[6:7] offset:24
    s_mov_b32 s16, s4
    s_mov_b32 s17, s5
    s_mov_b32 s18, 10240000
    s_mov_b32 s19, 0x20000
    s_add_u32 s24, s14, 262144
    s_addc_u32 s25, s15, 0
    s_mov_b32 s26, 3840000
    s_mov_b32 s27, 0x20000
    s_add_u32 s28, s14, 4194304
    s_addc_u32 s29, s15, 0
    s_mov_b32 s30, 10240000
    s_mov_b32 s31, 0x20000
    s_mul_i32 s45, s44, 625
    s_add_u32 s46, s45, 640
    s_add_u32 s45, s45, 15
    s_lshr_b32 s45, s45, 4
    s_lshr_b32 s46, s46, 4
    s_sub_u32 s46, s46, s45
    s_lshl_b32 s54, s45, 10
    s_add_u32 s40, s12, s54
    s_addc_u32 s41, s13, 0
    s_lshl_b32 s42, s46, 10
    s_mov_b32 s43, 0x20000
    s_mov_b32 s86, 0x0f0f0f0f
    s_mov_b32 s87, 0x0f0f0f0f
    s_mov_b32 s88, 0xf0f0f0f0
    s_mov_b32 s89, 0xf0f0f0f0
    s_mov_b32 s48, 0
    s_cmp_eq_u32 s46, 40
    s_cselect_b32 s54, 8, 0
    s_add_u32 s54, s54, s3
    s_mov_b32 s52, 0
    s_cmp_eq_u32 s54, 0
    s_cselect_b32 s52, 612192963, s52
    s_cmp_eq_u32 s54, 1
    s_cselect_b32 s52, 644694533, s52
    s_cmp_eq_u32 s54, 2
    s_cselect_b32 s52, 657748352, s52
    s_cmp_eq_u32 s54, 3
    s_cselect_b32 s52, 577053577, s52
    s_cmp_eq_u32 s54, 4
    s_cselect_b32 s52, 543241226, s52
    s_cmp_eq_u32 s54, 5
    s_cselect_b32 s52, 561357572, s52
    s_cmp_eq_u32 s54, 6
    s_cselect_b32 s52, 628192321, s52
    s_cmp_eq_u32 s54, 7
    s_cselect_b32 s52, 595157954, s52
    s_cmp_eq_u32 s54, 8
    s_cselect_b32 s52, 662237825, s52
    s_cmp_eq_u32 s54, 9
    s_cselect_b32 s52, 628183618, s52
    s_cmp_eq_u32 s54, 10
    s_cselect_b32 s52, 527262596, s52
    s_cmp_eq_u32 s54, 11
    s_cselect_b32 s52, 593568518, s52
    s_cmp_eq_u32 s54, 12
    s_cselect_b32 s52, 645202435, s52
    s_cmp_eq_u32 s54, 13
    s_cselect_b32 s52, 577311557, s52
    s_cmp_eq_u32 s54, 14
    s_cselect_b32 s52, 612463872, s52
    s_cmp_eq_u32 s54, 15
    s_cselect_b32 s52, 560280263, s52
    v_mul_u32_u24 v205, 6, v1
    v_lshrrev_b32 v205, v205, s52
    v_and_b32 v205, 63, v205
    v_lshlrev_b32 v205, 2, v205
    v_mov_b32 v6, 1
    v_mov_b32 v16, 0
    v_mov_b32 v17, 0
    v_mov_b32 v18, 0
    v_mov_b32 v19, 0
    v_mov_b32 v20, 0
    v_mov_b32 v21, 0
    v_mov_b32 v22, 0
    v_mov_b32 v23, 0
    v_mov_b32 v24, 0
    v_mov_b32 v25, 0
    v_mov_b32 v26, 0
    v_mov_b32 v27, 0
    v_mov_b32 v28, 0
    v_mov_b32 v29, 0
    v_mov_b32 v30, 0
    v_mov_b32 v31, 0
    v_mov_b32 v32, 0
    v_mov_b32 v33, 0
    v_mov_b32 v34, 0
    v_mov_b32 v35, 0
    v_mov_b32 v36, 0
    v_mov_b32 v37, 0
    v_mov_b32 v38, 0
    v_mov_b32 v39, 0
    v_mov_b32 v40, 0
    v_mov_b32 v41, 0
    v_mov_b32 v42, 0
    v_mov_b32 v43, 0
    v_mov_b32 v44, 0
    v_mov_b32 v45, 0
    v_mov_b32 v46, 0
    v_mov_b32 v47, 0
    v_mov_b32 v48, 0
    v_mov_b32 v49, 0
    v_mov_b32 v50, 0
    v_mov_b32 v51, 0
    v_mov_b32 v52, 0
    v_mov_b32 v53, 0
    v_mov_b32 v54, 0
    v_mov_b32 v55, 0
    v_mov_b32 v56, 0
    v_mov_b32 v57, 0
    v_mov_b32 v58, 0
    v_mov_b32 v59, 0
    v_mov_b32 v60, 0
    v_mov_b32 v61, 0
    v_mov_b32 v62, 0
    v_mov_b32 v63, 0
    v_mov_b32 v164, 0
    v_mov_b32 v165, 0
    v_mov_b32 v166, 0
    v_mov_b32 v167, 0
    v_mov_b32 v168, 0
    v_mov_b32 v169, 0
    v_mov_b32 v170, 0
    v_mov_b32 v171, 0
    v_and_b32 v11, 4, v1
    v_lshlrev_b32 v11, 2, v11
    v_mov_b32 v12, 0xffff
    v_lshlrev_b32 v12, v11, v12
    v_bfe_i32 v11, v1, 3, 1
    v_and_b32 v199, v11, v12
    v_xor_b32 v198, v199, v12
    v_lshrrev_b32 v202, 5, v1
    v_lshlrev_b32 v202, 4, v202
    v_add_u32 v202, 76288, v202
    v_and_b32 v203, 15, v1
    v_lshlrev_b32 v203, 4, v203
    v_add_u32 v203, 48904, v203
    v_bfe_u32 v11, v1, 3, 2
    v_and_b32 v12, 3, v1
    v_lshl_add_u32 v11, v11, 2, v12
    v_lshlrev_b32 v204, 4, v11
    v_add_u32 v204, 48896, v204
    v_mul_u32_u24 v5, 1280, v9
    v_lshlrev_b32 v11, 2, v0
    v_mov_b32 v12, 0x00ffffff
    v_mov_b32 v13, 0
    ds_write_b32 v11, v12 offset:0
    ds_write_b32 v11, v12 offset:2048
    ds_write_b32 v11, v12 offset:4096
    ds_write_b32 v11, v13 offset:6144
    ds_write_b32 v11, v13 offset:8192
    v_and_b32 v14, 1023, v11
    ds_write_b32 v14, v13 offset:10240
    v_and_b32 v14, 255, v11
    ds_write_b32 v14, v13 offset:48128
    ds_write_b32 v13, v13 offset:48644
    ds_write_b32 v13, v13 offset:48640
    s_waitcnt lgkmcnt(0)
    s_barrier
    s_waitcnt vmcnt(9)
    v_and_b32 v11, 0xffff, v3
    v_lshrrev_b32 v3, 16, v3
    s_mov_b32 exec_lo, 0x55555555
    s_mov_b32 exec_hi, 0x55555555
    ds_add_rtn_u32 v4, v13, v3 offset:48640
    s_mov_b64 exec, -1
    v_add_u32 v5, v5, v11
    s_waitcnt lgkmcnt(0)
    v_mov_b32_dpp v4, v4 quad_perm:[0,0,2,2] row_mask:0xf bank_mask:0xf
K2_round:
    v_subrev_u32 v8, s48, v4
    v_sub_u32 v9, 0, v8
    v_max_i32 v9, 0, v9
    v_sub_u32 v10, 1536, v8
    v_min_i32 v10, v10, v3
    v_and_b32 v11, 1, v0
    v_add_u32 v9, v9, v11
    v_sub_u32 v10, v10, v9
    v_add_lshl_u32 v8, v8, v9, 2
    v_add_u32 v9, v5, v9
K2_map:
    v_cmpx_lt_i32 vcc, 0, v10
    ds_write_b32 v8, v9 offset:0
    v_add_u32 v9, 2, v9
    v_cmpx_lt_i32 vcc, 2, v10
    ds_write_b32 v8, v9 offset:8
    v_add_u32 v9, 2, v9
    v_cmpx_lt_i32 vcc, 4, v10
    ds_write_b32 v8, v9 offset:16
    v_add_u32 v9, 2, v9
    v_cmpx_lt_i32 vcc, 6, v10
    ds_write_b32 v8, v9 offset:24
    v_add_u32 v9, 2, v9
    v_cmpx_lt_i32 vcc, 8, v10
    ds_write_b32 v8, v9 offset:32
    v_add_u32 v9, 2, v9
    v_cmpx_lt_i32 vcc, 10, v10
    ds_write_b32 v8, v9 offset:40
    v_add_u32 v9, 2, v9
    v_cmpx_lt_i32 vcc, 12, v10
    ds_write_b32 v8, v9 offset:48
    v_add_u32 v9, 2, v9
    v_cmpx_lt_i32 vcc, 14, v10
    ds_write_b32 v8, v9 offset:56
    v_add_u32 v9, 2, v9
    v_cmpx_lt_i32 vcc, 16, v10
    v_add_u32 v8, 64, v8
    v_subrev_u32 v10, 16, v10
    s_cbranch_execnz K2_map
    s_mov_b64 exec, -1
    v_lshlrev_b32 v8, 2, v0
    v_lshrrev_b32 v9, 1, v1
    s_lshl_b32 s54, s3, 5
    v_add_lshl_u32 v9, v9, s54, 2
    v_and_b32 v10, 1, v1
    v_lshlrev_b32 v10, 4, v10
    v_mov_b32 v13, 0
    s_waitcnt lgkmcnt(0)
    s_barrier
    ds_read_b32 v64, v8 offset:0
    ds_read_b32 v65, v8 offset:2048
    ds_read_b32 v66, v8 offset:4096
    ds_read_b32 v68, v9 offset:0
    ds_read_b32 v69, v9 offset:1024
    ds_read_b32 v70, v9 offset:2048
    ds_read_b32 v71, v9 offset:3072
    ds_read_b32 v72, v9 offset:4096
    ds_read_b32 v73, v9 offset:5120
    ds_read_b32 v11, v13 offset:48640
    s_lshl_b32 s54, s3, 10
    s_add_u32 s54, s54, 76288
    s_waitcnt lgkmcnt(7)
    v_mul_u32_u24 v64, 12, v64
    buffer_load_dwordx3 v[76:78], v64, s[24:27], 0 offen
    v_mul_u32_u24 v65, 12, v65
    buffer_load_dwordx3 v[80:82], v65, s[24:27], 0 offen
    v_mul_u32_u24 v66, 12, v66
    buffer_load_dwordx3 v[84:86], v66, s[24:27], 0 offen
    s_waitcnt lgkmcnt(0)
    v_lshl_add_u32 v68, v68, 5, v10
    s_add_u32 m0, s54, 0
    s_nop 0
    buffer_load_dwordx4 v68, s[28:31], 0 offen  lds
    v_lshl_add_u32 v69, v69, 5, v10
    s_add_u32 m0, s54, 8192
    s_nop 0
    buffer_load_dwordx4 v69, s[28:31], 0 offen  lds
    v_lshl_add_u32 v70, v70, 5, v10
    s_add_u32 m0, s54, 16384
    s_nop 0
    buffer_load_dwordx4 v70, s[28:31], 0 offen  lds
    v_lshl_add_u32 v71, v71, 5, v10
    s_add_u32 m0, s54, 24576
    s_nop 0
    buffer_load_dwordx4 v71, s[28:31], 0 offen  lds
    v_lshl_add_u32 v72, v72, 5, v10
    s_add_u32 m0, s54, 32768
    s_nop 0
    buffer_load_dwordx4 v72, s[28:31], 0 offen  lds
    v_lshl_add_u32 v73, v73, 5, v10
    s_add_u32 m0, s54, 40960
    s_nop 0
    buffer_load_dwordx4 v73, s[28:31], 0 offen  lds
    v_readfirstlane_b32 s47, v11
    s_nop 0
    s_sub_u32 s49, s47, s48
    s_min_u32 s49, s49, 1536
    v_add_u32 v64, 0, v0
    v_cmp_gt_u32 s[80:81], s49, v64
    v_lshlrev_b32 v64, 21, v64
    v_add_u32 v65, 512, v0
    v_cmp_gt_u32 s[82:83], s49, v65
    v_lshlrev_b32 v65, 21, v65
    v_add_u32 v66, 1024, v0
    v_cmp_gt_u32 s[84:85], s49, v66
    v_lshlrev_b32 v66, 21, v66
    s_mov_b32 s55, 0x1fff80
    s_waitcnt vmcnt(8)
    v_lshrrev_b32 v92, 21, v78
    v_lshlrev_b32 v92, 2, v92
    v_lshrrev_b32 v11, 26, v78
    v_lshlrev_b32 v11, 2, v11
    s_mov_b64 exec, s[80:81]
    ds_add_rtn_u32 v88, v92, v6 offset:6144
    ds_add_u32 v11, v6 offset:48128
    s_mov_b64 exec, -1
    v_and_or_b32 v78, v78, s55, v64
    s_waitcnt vmcnt(7)
    v_lshrrev_b32 v93, 21, v82
    v_lshlrev_b32 v93, 2, v93
    v_lshrrev_b32 v11, 26, v82
    v_lshlrev_b32 v11, 2, v11
    s_mov_b64 exec, s[82:83]
    ds_add_rtn_u32 v89, v93, v6 offset:6144
    ds_add_u32 v11, v6 offset:48128
    s_mov_b64 exec, -1
    v_and_or_b32 v82, v82, s55, v65
    s_waitcnt vmcnt(6)
    v_lshrrev_b32 v94, 21, v86
    v_lshlrev_b32 v94, 2, v94
    v_lshrrev_b32 v11, 26, v86
    v_lshlrev_b32 v11, 2, v11
    s_mov_b64 exec, s[84:85]
    ds_add_rtn_u32 v90, v94, v6 offset:6144
    ds_add_u32 v11, v6 offset:48128
    s_mov_b64 exec, -1
    v_and_or_b32 v86, v86, s55, v66
    v_lshlrev_b32 v8, 2, v1
    s_waitcnt lgkmcnt(0)
    s_barrier
    s_cmp_lg_u32 s48, 0
    s_cbranch_scc1 K2_ranked
    ds_read_b32 v9, v8 offset:48128
    v_sub_u32 v10, 63, v1
    s_mul_i32 s54, s3, 5
    v_add_lshl_u32 v12, v1, s54, 7
    s_waitcnt lgkmcnt(0)
    v_lshl_or_b32 v9, v9, 6, v10
    s_nop 0
    v_readlane_b32 s64, v9, s54
    s_add_u32 s54, s54, 1
    v_readlane_b32 s65, v9, s54
    s_add_u32 s54, s54, 1
    v_readlane_b32 s66, v9, s54
    s_add_u32 s54, s54, 1
    v_readlane_b32 s67, v9, s54
    s_add_u32 s54, s54, 1
    v_readlane_b32 s68, v9, s54
    s_add_u32 s54, s54, 1
    v_cmp_lt_u32 s[70:71], s64, v9
    v_cmp_lt_u32 s[72:73], s65, v9
    v_cmp_lt_u32 s[74:75], s66, v9
    v_cmp_lt_u32 s[76:77], s67, v9
    v_cmp_lt_u32 s[78:79], s68, v9
    s_bcnt1_i32_b64 s64, s[70:71]
    s_lshl_b32 s64, s64, 2
    v_writelane_b32 v11, s64, 0
    s_bcnt1_i32_b64 s65, s[72:73]
    s_lshl_b32 s65, s65, 2
    v_writelane_b32 v11, s65, 1
    s_bcnt1_i32_b64 s66, s[74:75]
    s_lshl_b32 s66, s66, 2
    v_writelane_b32 v11, s66, 2
    s_bcnt1_i32_b64 s67, s[76:77]
    s_lshl_b32 s67, s67, 2
    v_writelane_b32 v11, s67, 3
    s_bcnt1_i32_b64 s68, s[78:79]
    s_lshl_b32 s68, s68, 2
    v_writelane_b32 v11, s68, 4
    s_mov_b64 exec, 31
    ds_write_b32 v11, v12 offset:48384
    s_mov_b64 exec, -1
    s_waitcnt lgkmcnt(0)
    s_barrier
    ds_read_b32 v9, v205 offset:48384
    s_waitcnt lgkmcnt(0)
    v_readlane_b32 s56, v9, 0
    v_readlane_b32 s57, v9, 1
    v_readlane_b32 s58, v9, 2
    v_readlane_b32 s59, v9, 3
    v_readlane_b32 s60, v9, 4
K2_ranked:
    v_and_b32 v8, 124, v8
    v_add_u32 v104, s56, v8
    ds_read_b32 v96, v104 offset:6144
    v_add_u32 v105, s57, v8
    ds_read_b32 v97, v105 offset:6144
    v_add_u32 v106, s58, v8
    ds_read_b32 v98, v106 offset:6144
    v_add_u32 v107, s59, v8
    ds_read_b32 v99, v107 offset:6144
    v_add_u32 v108, s60, v8
    ds_read_b32 v100, v108 offset:6144
    s_waitcnt lgkmcnt(0)
    v_add_u32 v97, v97, v96
    v_add_u32 v98, v98, v97
    v_add_u32 v99, v99, v98
    v_add_u32 v100, v100, v99
    v_mov_b32 v9, v100
    s_nop 1
    v_add_u32_dpp v9, v9, v9 row_shr:1 row_mask:0xf bank_mask:0xf
    s_nop 1
    v_add_u32_dpp v9, v9, v9 row_shr:2 row_mask:0xf bank_mask:0xf
    s_nop 1
    v_add_u32_dpp v9, v9, v9 row_shr:4 row_mask:0xf bank_mask:0xf
    s_nop 1
    v_add_u32_dpp v9, v9, v9 row_shr:8 row_mask:0xf bank_mask:0xf
    s_nop 1
    v_add_u32_dpp v9, v9, v9 row_bcast:15 row_mask:0xa bank_mask:0xf
    s_nop 0
    v_readlane_b32 s50, v9, 31
    v_sub_u32 v9, v9, v100
    s_add_u32 s54, s50, 16
    v_mov_b32 v10, s54
    s_mov_b64 exec, 1
    ds_add_rtn_u32 v11, v13, v10 offset:48644
    s_mov_b64 exec, -1
    v_add_u32 v100, v99, v9
    v_lshl_or_b32 v100, v100, 4, 4
    v_add_u32 v99, v98, v9
    v_lshl_or_b32 v99, v99, 4, 3
    v_add_u32 v98, v97, v9
    v_lshl_or_b32 v98, v98, 4, 2
    v_add_u32 v97, v96, v9
    v_lshl_or_b32 v97, v97, 4, 1
    v_lshlrev_b32 v96, 4, v9
    v_mov_b32 v12, 2097029
    s_waitcnt lgkmcnt(0)
    v_readfirstlane_b32 s51, v11
    s_nop 0
    s_lshl_b32 s51, s51, 4
    s_lshl_b32 s54, s50, 4
    v_add_u32 v96, s51, v96
    ds_write_b32 v104, v96 offset:6144
    v_add_u32 v97, s51, v97
    ds_write_b32 v105, v97 offset:6144
    v_add_u32 v98, s51, v98
    ds_write_b32 v106, v98 offset:6144
    v_add_u32 v99, s51, v99
    ds_write_b32 v107, v99 offset:6144
    v_add_u32 v100, s51, v100
    ds_write_b32 v108, v100 offset:6144
    v_add_u32 v200, s51, v203
    v_add_u32 v201, s51, v204
    v_add_u32 v11, s54, v200
    ds_write_b32 v11, v12
    s_waitcnt lgkmcnt(0)
    s_barrier
    ds_read_b32 v92, v92 offset:6144
    ds_read_b32 v93, v93 offset:6144
    ds_read_b32 v94, v94 offset:6144
    s_waitcnt lgkmcnt(2)
    v_and_or_b32 v78, v92, 7, v78
    v_lshl_add_u32 v92, v88, 4, v92
    v_and_b32 v92, -16, v92
    s_mov_b64 exec, s[80:81]
    ds_write_b96 v92, v[76:78] offset:48896
    s_mov_b64 exec, -1
    s_waitcnt lgkmcnt(2)
    v_and_or_b32 v82, v93, 7, v82
    v_lshl_add_u32 v93, v89, 4, v93
    v_and_b32 v93, -16, v93
    s_mov_b64 exec, s[82:83]
    ds_write_b96 v93, v[80:82] offset:48896
    s_mov_b64 exec, -1
    s_waitcnt lgkmcnt(2)
    v_and_or_b32 v86, v94, 7, v86
    v_lshl_add_u32 v94, v90, 4, v94
    v_and_b32 v94, -16, v94
    s_mov_b64 exec, s[84:85]
    ds_write_b96 v94, v[84:86] offset:48896
    s_mov_b64 exec, -1
    s_waitcnt lgkmcnt(0)
    s_barrier
    ds_read_b32 v196, v200
    ds_read_b32 v197, v200 offset:96
    ds_read_b128 v[192:195], v201
    s_mov_b32 s55, 0x00fffc38
    s_waitcnt lgkmcnt(2)
    v_lshlrev_b32 v196, 3, v196
    v_and_b32 v196, s55, v196
    s_nop 0
    v_readlane_b32 s64, v196, 0
    v_readlane_b32 s65, v196, 1
    v_readlane_b32 s66, v196, 2
    v_readlane_b32 s67, v196, 3
    v_readlane_b32 s68, v196, 4
    v_readlane_b32 s69, v196, 5
    s_and_b32 s61, s64, 0xffffff00
    buffer_load_dwordx4 v[96:99], v2, s[16:19], s61 offen
    s_and_b32 s61, s65, 0xffffff00
    buffer_load_dwordx4 v[100:103], v2, s[16:19], s61 offen
    s_and_b32 s61, s66, 0xffffff00
    buffer_load_dwordx4 v[104:107], v2, s[16:19], s61 offen
    s_and_b32 s61, s67, 0xffffff00
    buffer_load_dwordx4 v[108:111], v2, s[16:19], s61 offen
    s_and_b32 s61, s68, 0xffffff00
    buffer_load_dwordx4 v[112:115], v2, s[16:19], s61 offen
    s_and_b32 s61, s69, 0xffffff00
    buffer_load_dwordx4 v[116:119], v2, s[16:19], s61 offen
    s_cmp_lg_u32 s48, 0
    s_cbranch_scc1 K2_nofrag
    v_lshl_or_b32 v188, v129, 16, v128
    v_lshl_or_b32 v189, v131, 16, v130
    v_lshrrev_b32 v8, 5, v1
    v_lshlrev_b32 v8, 11, v8
    v_and_b32 v9, 15, v1
    v_lshl_add_u32 v8, v9, 4, v8
    ds_read_b128 v[64:67], v8 offset:11264
    ds_read_b128 v[68:71], v8 offset:11520
    ds_read_b128 v[72:75], v8 offset:11776
    ds_read_b128 v[76:79], v8 offset:12032
    ds_read_b128 v[80:83], v8 offset:12288
    ds_read_b128 v[84:87], v8 offset:12544
    ds_read_b128 v[88:91], v8 offset:12800
    ds_read_b128 v[92:95], v8 offset:13056
    v_bfe_u32 v10, v1, 4, 1
    v_mov_b32 v11, 0x02020202
    v_mul_lo_u32 v10, v10, v11
    v_add_u32 v10, 0x05040100, v10
    v_lshrrev_b32 v8, 4, v1
    v_lshlrev_b32 v8, 13, v8
    v_lshl_add_u32 v8, v9, 2, v8
    s_and_b32 s54, s3, 3
    s_lshl_b32 s54, s54, 6
    s_add_u32 s54, s54, 15360
    v_add_u32 v8, s54, v8
    s_waitcnt lgkmcnt(0)
    v_perm_b32 v172, v68, v64, v10
    v_perm_b32 v173, v76, v72, v10
    v_perm_b32 v174, v84, v80, v10
    v_perm_b32 v175, v92, v88, v10
    v_perm_b32 v176, v69, v65, v10
    v_perm_b32 v177, v77, v73, v10
    v_perm_b32 v178, v85, v81, v10
    v_perm_b32 v179, v93, v89, v10
    v_perm_b32 v180, v70, v66, v10
    v_perm_b32 v181, v78, v74, v10
    v_perm_b32 v182, v86, v82, v10
    v_perm_b32 v183, v94, v90, v10
    v_perm_b32 v184, v71, v67, v10
    v_perm_b32 v185, v79, v75, v10
    v_perm_b32 v186, v87, v83, v10
    v_perm_b32 v187, v95, v91, v10
    ds_read2st64_b32 v[64:65], v8 offset0:0 offset1:4
    ds_read2st64_b32 v[66:67], v8 offset0:8 offset1:12
    ds_read2st64_b32 v[68:69], v8 offset0:16 offset1:20
    ds_read2st64_b32 v[70:71], v8 offset0:24 offset1:28
    ds_read2st64_b32 v[72:73], v8 offset0:1 offset1:5
    ds_read2st64_b32 v[74:75], v8 offset0:9 offset1:13
    ds_read2st64_b32 v[76:77], v8 offset0:17 offset1:21
    ds_read2st64_b32 v[78:79], v8 offset0:25 offset1:29
    ds_read2st64_b32 v[80:81], v8 offset0:2 offset1:6
    ds_read2st64_b32 v[82:83], v8 offset0:10 offset1:14
    ds_read2st64_b32 v[84:85], v8 offset0:18 offset1:22
    ds_read2st64_b32 v[86:87], v8 offset0:26 offset1:30
    ds_read2st64_b32 v[88:89], v8 offset0:3 offset1:7
    ds_read2st64_b32 v[90:91], v8 offset0:11 offset1:15
    ds_read2st64_b32 v[92:93], v8 offset0:19 offset1:23
    ds_read2st64_b32 v[94:95], v8 offset0:27 offset1:31
    s_mov_b32 s62, 0x05040100
    s_mov_b32 s63, 0x07060302
    s_waitcnt lgkmcnt(0)
    v_perm_b32 v208, v65, v64, s62
    v_perm_b32 v209, v67, v66, s62
    v_perm_b32 v210, v69, v68, s62
    v_perm_b32 v211, v71, v70, s62
    v_perm_b32 v212, v65, v64, s63
    v_perm_b32 v213, v67, v66, s63
    v_perm_b32 v214, v69, v68, s63
    v_perm_b32 v215, v71, v70, s63
    v_perm_b32 v216, v73, v72, s62
    v_perm_b32 v217, v75, v74, s62
    v_perm_b32 v218, v77, v76, s62
    v_perm_b32 v219, v79, v78, s62
    v_perm_b32 v220, v73, v72, s63
    v_perm_b32 v221, v75, v74, s63
    v_perm_b32 v222, v77, v76, s63
    v_perm_b32 v223, v79, v78, s63
    v_perm_b32 v224, v81, v80, s62
    v_perm_b32 v225, v83, v82, s62
    v_perm_b32 v226, v85, v84, s62
    v_perm_b32 v227, v87, v86, s62
    v_perm_b32 v228, v81, v80, s63
    v_perm_b32 v229, v83, v82, s63
    v_perm_b32 v230, v85, v84, s63
    v_perm_b32 v231, v87, v86, s63
    v_perm_b32 v232, v89, v88, s62
    v_perm_b32 v233, v91, v90, s62
    v_perm_b32 v234, v93, v92, s62
    v_perm_b32 v235, v95, v94, s62
    v_perm_b32 v236, v89, v88, s63
    v_perm_b32 v237, v91, v90, s63
    v_perm_b32 v238, v93, v92, s63
    v_perm_b32 v239, v95, v94, s63
K2_nofrag:
    s_waitcnt vmcnt(6) lgkmcnt(0)
    s_barrier
    s_cmp_eq_u32 s50, 0
    s_cbranch_scc1 K2_swept
    v_lshrrev_b32 v8, 21, v194
    v_lshl_add_u32 v8, v8, 5, v202
    s_mov_b64 exec, s[86:87]
    ds_read_b128 v[164:167], v8
    s_mov_b64 exec, s[88:89]
    ds_read_b128 v[168:171], v8
    s_mov_b64 exec, -1
    s_mov_b32 s53, s50
.p2align 3
K2_loop:
    s_waitcnt lgkmcnt(0)
    v_mfma_f32_4x4x4_16b_bf16 v[144:147], v[192:193], v[188:189], 0 cbsz:4 abid:0
    v_mfma_f32_4x4x4_16b_bf16 v[148:151], v[192:193], v[188:189], 0 cbsz:4 abid:2
    v_mfma_f32_4x4x4_16b_bf16 v[152:155], v[192:193], v[188:189], 0 cbsz:4 abid:4
    v_mfma_f32_4x4x4_16b_bf16 v[156:159], v[192:193], v[188:189], 0 cbsz:4 abid:6
    v_mfma_f32_32x32x16_bf16 v[64:79], v[164:167], v[172:175], 0
    v_lshlrev_b32 v196, 3, v197
    v_and_b32 v196, s55, v196
    v_add_u32 v200, 256, v200
    v_mfma_f32_32x32x16_bf16 v[80:95], v[164:167], v[180:183], 0
    v_add_u32 v201, 256, v201
    ds_read_b32 v197, v200 offset:96
    ds_read_b128 v[192:195], v201
    v_mfma_f32_32x32x16_bf16 v[64:79], v[168:171], v[176:179], v[64:79]
    v_cvt_pk_bf16_f32 v9, v144, v144
    v_and_b32 v160, v198, v9
    v_and_b32 v161, v199, v9
    v_mfma_f32_32x32x16_bf16 v[80:95], v[168:171], v[184:187], v[80:95]
    s_waitcnt vmcnt(5)
    v_mfma_f32_16x16x16_bf16 v[128:131], v[160:161], v[96:97], 0
    v_readlane_b32 s70, v196, 0
    v_cvt_pk_bf16_f32 v10, v145, v145
    v_mfma_f32_16x16x16_bf16 v[132:135], v[160:161], v[98:99], 0
    v_and_b32 v162, v198, v10
    v_and_b32 v163, v199, v10
    s_and_b32 s61, s70, 0xffffff00
    buffer_load_dwordx4 v[120:123], v2, s[16:19], s61 offen
    s_waitcnt vmcnt(5)
    v_mfma_f32_16x16x16_bf16 v[136:139], v[162:163], v[100:101], 0
    v_readlane_b32 s71, v196, 1
    v_cvt_pk_bf16_f32 v9, v146, v146
    v_mfma_f32_16x16x16_bf16 v[140:143], v[162:163], v[102:103], 0
    v_and_b32 v160, v198, v9
    v_and_b32 v161, v199, v9
    s_and_b32 s61, s71, 0xffffff00
    buffer_load_dwordx4 v[124:127], v2, s[16:19], s61 offen
    s_set_gpr_idx_on s64, gpr_idx(SRC2,DST)
    v_pk_fma_f32 v[16:17], v[128:129], v[64:65], v[16:17] op_sel_hi:[1,0,1]
    v_pk_fma_f32 v[18:19], v[130:131], v[64:65], v[18:19] op_sel_hi:[1,0,1]
    v_pk_fma_f32 v[20:21], v[132:133], v[80:81], v[20:21] op_sel_hi:[1,0,1]
    v_pk_fma_f32 v[22:23], v[134:135], v[80:81], v[22:23] op_sel_hi:[1,0,1]
    s_set_gpr_idx_off
    s_waitcnt vmcnt(5)
    v_mfma_f32_16x16x16_bf16 v[128:131], v[160:161], v[104:105], 0
    v_readlane_b32 s72, v196, 2
    v_cvt_pk_bf16_f32 v10, v147, v147
    v_mfma_f32_16x16x16_bf16 v[132:135], v[160:161], v[106:107], 0
    v_and_b32 v162, v198, v10
    v_and_b32 v163, v199, v10
    s_and_b32 s61, s72, 0xffffff00
    buffer_load_dwordx4 v[96:99], v2, s[16:19], s61 offen
    s_waitcnt lgkmcnt(0)
    v_lshrrev_b32 v8, 21, v194
    v_lshl_add_u32 v8, v8, 5, v202
    s_mov_b64 exec, s[86:87]
    ds_read_b128 v[164:167], v8
    s_mov_b64 exec, s[88:89]
    ds_read_b128 v[168:171], v8
    s_mov_b64 exec, -1
    s_set_gpr_idx_on s65, gpr_idx(SRC2,DST)
    v_pk_fma_f32 v[16:17], v[136:137], v[64:65], v[16:17] op_sel:[0,1,0] op_sel_hi:[1,1,1]
    v_pk_fma_f32 v[18:19], v[138:139], v[64:65], v[18:19] op_sel:[0,1,0] op_sel_hi:[1,1,1]
    v_pk_fma_f32 v[20:21], v[140:141], v[80:81], v[20:21] op_sel:[0,1,0] op_sel_hi:[1,1,1]
    v_pk_fma_f32 v[22:23], v[142:143], v[80:81], v[22:23] op_sel:[0,1,0] op_sel_hi:[1,1,1]
    s_set_gpr_idx_off
    s_waitcnt vmcnt(5)
    v_mfma_f32_16x16x16_bf16 v[136:139], v[162:163], v[108:109], 0
    v_readlane_b32 s73, v196, 3
    v_cvt_pk_bf16_f32 v9, v148, v148
    v_mfma_f32_16x16x16_bf16 v[140:143], v[162:163], v[110:111], 0
    v_and_b32 v160, v198, v9
    v_and_b32 v161, v199, v9
    s_and_b32 s61, s73, 0xffffff00
    buffer_load_dwordx4 v[100:103], v2, s[16:19], s61 offen
    s_set_gpr_idx_on s66, gpr_idx(SRC2,DST)
    v_pk_fma_f32 v[16:17], v[128:129], v[66:67], v[16:17] op_sel_hi:[1,0,1]
    v_pk_fma_f32 v[18:19], v[130:131], v[66:67], v[18:19] op_sel_hi:[1,0,1]
    v_pk_fma_f32 v[20:21], v[132:133], v[82:83], v[20:21] op_sel_hi:[1,0,1]
    v_pk_fma_f32 v[22:23], v[134:135], v[82:83], v[22:23] op_sel_hi:[1,0,1]
    s_set_gpr_idx_off
    s_waitcnt vmcnt(5)
    v_mfma_f32_16x16x16_bf16 v[128:131], v[160:161], v[112:113], 0
    v_readlane_b32 s74, v196, 4
    v_cvt_pk_bf16_f32 v10, v149, v149
    v_mfma_f32_16x16x16_bf16 v[132:135], v[160:161], v[114:115], 0
    v_and_b32 v162, v198, v10
    v_and_b32 v163, v199, v10
    s_and_b32 s61, s74, 0xffffff00
    buffer_load_dwordx4 v[104:107], v2, s[16:19], s61 offen
    s_set_gpr_idx_on s67, gpr_idx(SRC2,DST)
    v_pk_fma_f32 v[16:17], v[136:137], v[66:67], v[16:17] op_sel:[0,1,0] op_sel_hi:[1,1,1]
    v_pk_fma_f32 v[18:19], v[138:139], v[66:67], v[18:19] op_sel:[0,1,0] op_sel_hi:[1,1,1]
    v_pk_fma_f32 v[20:21], v[140:141], v[82:83], v[20:21] op_sel:[0,1,0] op_sel_hi:[1,1,1]
    v_pk_fma_f32 v[22:23], v[142:143], v[82:83], v[22:23] op_sel:[0,1,0] op_sel_hi:[1,1,1]
    s_set_gpr_idx_off
    s_cmp_le_u32 s53, 4
    s_cbranch_scc1 K2_swept
    s_waitcnt vmcnt(5)
    v_mfma_f32_16x16x16_bf16 v[136:139], v[162:163], v[116:117], 0
    v_readlane_b32 s75, v196, 5
    v_cvt_pk_bf16_f32 v9, v150, v150
    v_mfma_f32_16x16x16_bf16 v[140:143], v[162:163], v[118:119], 0
    v_and_b32 v160, v198, v9
    v_and_b32 v161, v199, v9
    s_and_b32 s61, s75, 0xffffff00
    buffer_load_dwordx4 v[108:111], v2, s[16:19], s61 offen
    s_set_gpr_idx_on s68, gpr_idx(SRC2,DST)
    v_pk_fma_f32 v[16:17], v[128:129], v[68:69], v[16:17] op_sel_hi:[1,0,1]
    v_pk_fma_f32 v[18:19], v[130:131], v[68:69], v[18:19] op_sel_hi:[1,0,1]
    v_pk_fma_f32 v[20:21], v[132:133], v[84:85], v[20:21] op_sel_hi:[1,0,1]
    v_pk_fma_f32 v[22:23], v[134:135], v[84:85], v[22:23] op_sel_hi:[1,0,1]
    s_set_gpr_idx_off
    s_waitcnt vmcnt(5)
    v_mfma_f32_16x16x16_bf16 v[128:131], v[160:161], v[120:121], 0
    v_readlane_b32 s76, v196, 6
    v_cvt_pk_bf16_f32 v10, v151, v151
    v_mfma_f32_16x16x16_bf16 v[132:135], v[160:161], v[122:123], 0
    v_and_b32 v162, v198, v10
    v_and_b32 v163, v199, v10
    s_and_b32 s61, s76, 0xffffff00
    buffer_load_dwordx4 v[112:115], v2, s[16:19], s61 offen
    s_set_gpr_idx_on s69, gpr_idx(SRC2,DST)
    v_pk_fma_f32 v[16:17], v[136:137], v[68:69], v[16:17] op_sel:[0,1,0] op_sel_hi:[1,1,1]
    v_pk_fma_f32 v[18:19], v[138:139], v[68:69], v[18:19] op_sel:[0,1,0] op_sel_hi:[1,1,1]
    v_pk_fma_f32 v[20:21], v[140:141], v[84:85], v[20:21] op_sel:[0,1,0] op_sel_hi:[1,1,1]
    v_pk_fma_f32 v[22:23], v[142:143], v[84:85], v[22:23] op_sel:[0,1,0] op_sel_hi:[1,1,1]
    s_set_gpr_idx_off
    s_waitcnt vmcnt(5)
    v_mfma_f32_16x16x16_bf16 v[136:139], v[162:163], v[124:125], 0
    v_readlane_b32 s77, v196, 7
    v_cvt_pk_bf16_f32 v9, v152, v152
    v_mfma_f32_16x16x16_bf16 v[140:143], v[162:163], v[126:127], 0
    v_and_b32 v160, v198, v9
    v_and_b32 v161, v199, v9
    s_and_b32 s61, s77, 0xffffff00
    buffer_load_dwordx4 v[116:119], v2, s[16:19], s61 offen
    s_set_gpr_idx_on s70, gpr_idx(SRC2,DST)
    v_pk_fma_f32 v[16:17], v[128:129], v[70:71], v[16:17] op_sel_hi:[1,0,1]
    v_pk_fma_f32 v[18:19], v[130:131], v[70:71], v[18:19] op_sel_hi:[1,0,1]
    v_pk_fma_f32 v[20:21], v[132:133], v[86:87], v[20:21] op_sel_hi:[1,0,1]
    v_pk_fma_f32 v[22:23], v[134:135], v[86:87], v[22:23] op_sel_hi:[1,0,1]
    s_set_gpr_idx_off
    s_waitcnt vmcnt(5)
    v_mfma_f32_16x16x16_bf16 v[128:131], v[160:161], v[96:97], 0
    v_readlane_b32 s78, v196, 8
    v_cvt_pk_bf16_f32 v10, v153, v153
    v_mfma_f32_16x16x16_bf16 v[132:135], v[160:161], v[98:99], 0
    v_and_b32 v162, v198, v10
    v_and_b32 v163, v199, v10
    s_and_b32 s61, s78, 0xffffff00
    buffer_load_dwordx4 v[120:123], v2, s[16:19], s61 offen
    s_set_gpr_idx_on s71, gpr_idx(SRC2,DST)
    v_pk_fma_f32 v[16:17], v[136:137], v[70:71], v[16:17] op_sel:[0,1,0] op_sel_hi:[1,1,1]
    v_pk_fma_f32 v[18:19], v[138:139], v[70:71], v[18:19] op_sel:[0,1,0] op_sel_hi:[1,1,1]
    v_pk_fma_f32 v[20:21], v[140:141], v[86:87], v[20:21] op_sel:[0,1,0] op_sel_hi:[1,1,1]
    v_pk_fma_f32 v[22:23], v[142:143], v[86:87], v[22:23] op_sel:[0,1,0] op_sel_hi:[1,1,1]
    s_set_gpr_idx_off
    s_cmp_le_u32 s53, 8
    s_cbranch_scc1 K2_swept
    s_waitcnt vmcnt(5)
    v_mfma_f32_16x16x16_bf16 v[136:139], v[162:163], v[100:101], 0
    v_readlane_b32 s79, v196, 9
    v_cvt_pk_bf16_f32 v9, v154, v154
    v_mfma_f32_16x16x16_bf16 v[140:143], v[162:163], v[102:103], 0
    v_and_b32 v160, v198, v9
    v_and_b32 v161, v199, v9
    s_and_b32 s61, s79, 0xffffff00
    buffer_load_dwordx4 v[124:127], v2, s[16:19], s61 offen
    s_set_gpr_idx_on s72, gpr_idx(SRC2,DST)
    v_pk_fma_f32 v[16:17], v[128:129], v[72:73], v[16:17] op_sel_hi:[1,0,1]
    v_pk_fma_f32 v[18:19], v[130:131], v[72:73], v[18:19] op_sel_hi:[1,0,1]
    v_pk_fma_f32 v[20:21], v[132:133], v[88:89], v[20:21] op_sel_hi:[1,0,1]
    v_pk_fma_f32 v[22:23], v[134:135], v[88:89], v[22:23] op_sel_hi:[1,0,1]
    s_set_gpr_idx_off
    s_waitcnt vmcnt(5)
    v_mfma_f32_16x16x16_bf16 v[128:131], v[160:161], v[104:105], 0
    v_readlane_b32 s64, v196, 10
    v_cvt_pk_bf16_f32 v10, v155, v155
    v_mfma_f32_16x16x16_bf16 v[132:135], v[160:161], v[106:107], 0
    v_and_b32 v162, v198, v10
    v_and_b32 v163, v199, v10
    s_and_b32 s61, s64, 0xffffff00
    buffer_load_dwordx4 v[96:99], v2, s[16:19], s61 offen
    s_set_gpr_idx_on s73, gpr_idx(SRC2,DST)
    v_pk_fma_f32 v[16:17], v[136:137], v[72:73], v[16:17] op_sel:[0,1,0] op_sel_hi:[1,1,1]
    v_pk_fma_f32 v[18:19], v[138:139], v[72:73], v[18:19] op_sel:[0,1,0] op_sel_hi:[1,1,1]
    v_pk_fma_f32 v[20:21], v[140:141], v[88:89], v[20:21] op_sel:[0,1,0] op_sel_hi:[1,1,1]
    v_pk_fma_f32 v[22:23], v[142:143], v[88:89], v[22:23] op_sel:[0,1,0] op_sel_hi:[1,1,1]
    s_set_gpr_idx_off
    s_waitcnt vmcnt(5)
    v_mfma_f32_16x16x16_bf16 v[136:139], v[162:163], v[108:109], 0
    v_readlane_b32 s65, v196, 11
    v_cvt_pk_bf16_f32 v9, v156, v156
    v_mfma_f32_16x16x16_bf16 v[140:143], v[162:163], v[110:111], 0
    v_and_b32 v160, v198, v9
    v_and_b32 v161, v199, v9
    s_and_b32 s61, s65, 0xffffff00
    buffer_load_dwordx4 v[100:103], v2, s[16:19], s61 offen
    s_set_gpr_idx_on s74, gpr_idx(SRC2,DST)
    v_pk_fma_f32 v[16:17], v[128:129], v[74:75], v[16:17] op_sel_hi:[1,0,1]
    v_pk_fma_f32 v[18:19], v[130:131], v[74:75], v[18:19] op_sel_hi:[1,0,1]
    v_pk_fma_f32 v[20:21], v[132:133], v[90:91], v[20:21] op_sel_hi:[1,0,1]
    v_pk_fma_f32 v[22:23], v[134:135], v[90:91], v[22:23] op_sel_hi:[1,0,1]
    s_set_gpr_idx_off
    s_waitcnt vmcnt(5)
    v_mfma_f32_16x16x16_bf16 v[128:131], v[160:161], v[112:113], 0
    v_readlane_b32 s66, v196, 12
    v_cvt_pk_bf16_f32 v10, v157, v157
    v_mfma_f32_16x16x16_bf16 v[132:135], v[160:161], v[114:115], 0
    v_and_b32 v162, v198, v10
    v_and_b32 v163, v199, v10
    s_and_b32 s61, s66, 0xffffff00
    buffer_load_dwordx4 v[104:107], v2, s[16:19], s61 offen
    s_set_gpr_idx_on s75, gpr_idx(SRC2,DST)
    v_pk_fma_f32 v[16:17], v[136:137], v[74:75], v[16:17] op_sel:[0,1,0] op_sel_hi:[1,1,1]
    v_pk_fma_f32 v[18:19], v[138:139], v[74:75], v[18:19] op_sel:[0,1,0] op_sel_hi:[1,1,1]
    v_pk_fma_f32 v[20:21], v[140:141], v[90:91], v[20:21] op_sel:[0,1,0] op_sel_hi:[1,1,1]
    v_pk_fma_f32 v[22:23], v[142:143], v[90:91], v[22:23] op_sel:[0,1,0] op_sel_hi:[1,1,1]
    s_set_gpr_idx_off
    s_cmp_le_u32 s53, 12
    s_cbranch_scc1 K2_swept
    s_waitcnt vmcnt(5)
    v_mfma_f32_16x16x16_bf16 v[136:139], v[162:163], v[116:117], 0
    v_readlane_b32 s67, v196, 13
    v_cvt_pk_bf16_f32 v9, v158, v158
    v_mfma_f32_16x16x16_bf16 v[140:143], v[162:163], v[118:119], 0
    v_and_b32 v160, v198, v9
    v_and_b32 v161, v199, v9
    s_and_b32 s61, s67, 0xffffff00
    buffer_load_dwordx4 v[108:111], v2, s[16:19], s61 offen
    s_set_gpr_idx_on s76, gpr_idx(SRC2,DST)
    v_pk_fma_f32 v[16:17], v[128:129], v[76:77], v[16:17] op_sel_hi:[1,0,1]
    v_pk_fma_f32 v[18:19], v[130:131], v[76:77], v[18:19] op_sel_hi:[1,0,1]
    v_pk_fma_f32 v[20:21], v[132:133], v[92:93], v[20:21] op_sel_hi:[1,0,1]
    v_pk_fma_f32 v[22:23], v[134:135], v[92:93], v[22:23] op_sel_hi:[1,0,1]
    s_set_gpr_idx_off
    s_waitcnt vmcnt(5)
    v_mfma_f32_16x16x16_bf16 v[128:131], v[160:161], v[120:121], 0
    v_readlane_b32 s68, v196, 14
    v_cvt_pk_bf16_f32 v10, v159, v159
    v_mfma_f32_16x16x16_bf16 v[132:135], v[160:161], v[122:123], 0
    v_and_b32 v162, v198, v10
    v_and_b32 v163, v199, v10
    s_and_b32 s61, s68, 0xffffff00
    buffer_load_dwordx4 v[112:115], v2, s[16:19], s61 offen
    s_set_gpr_idx_on s77, gpr_idx(SRC2,DST)
    v_pk_fma_f32 v[16:17], v[136:137], v[76:77], v[16:17] op_sel:[0,1,0] op_sel_hi:[1,1,1]
    v_pk_fma_f32 v[18:19], v[138:139], v[76:77], v[18:19] op_sel:[0,1,0] op_sel_hi:[1,1,1]
    v_pk_fma_f32 v[20:21], v[140:141], v[92:93], v[20:21] op_sel:[0,1,0] op_sel_hi:[1,1,1]
    v_pk_fma_f32 v[22:23], v[142:143], v[92:93], v[22:23] op_sel:[0,1,0] op_sel_hi:[1,1,1]
    s_set_gpr_idx_off
    s_waitcnt vmcnt(5)
    v_mfma_f32_16x16x16_bf16 v[136:139], v[162:163], v[124:125], 0
    v_readlane_b32 s69, v196, 15
    v_mfma_f32_16x16x16_bf16 v[140:143], v[162:163], v[126:127], 0
    s_and_b32 s61, s69, 0xffffff00
    buffer_load_dwordx4 v[116:119], v2, s[16:19], s61 offen
    s_set_gpr_idx_on s78, gpr_idx(SRC2,DST)
    v_pk_fma_f32 v[16:17], v[128:129], v[78:79], v[16:17] op_sel_hi:[1,0,1]
    v_pk_fma_f32 v[18:19], v[130:131], v[78:79], v[18:19] op_sel_hi:[1,0,1]
    v_pk_fma_f32 v[20:21], v[132:133], v[94:95], v[20:21] op_sel_hi:[1,0,1]
    v_pk_fma_f32 v[22:23], v[134:135], v[94:95], v[22:23] op_sel_hi:[1,0,1]
    s_set_gpr_idx_off
    s_set_gpr_idx_on s79, gpr_idx(SRC2,DST)
    v_pk_fma_f32 v[16:17], v[136:137], v[78:79], v[16:17] op_sel:[0,1,0] op_sel_hi:[1,1,1]
    v_pk_fma_f32 v[18:19], v[138:139], v[78:79], v[18:19] op_sel:[0,1,0] op_sel_hi:[1,1,1]
    v_pk_fma_f32 v[20:21], v[140:141], v[94:95], v[20:21] op_sel:[0,1,0] op_sel_hi:[1,1,1]
    v_pk_fma_f32 v[22:23], v[142:143], v[94:95], v[22:23] op_sel:[0,1,0] op_sel_hi:[1,1,1]
    s_set_gpr_idx_off
    s_sub_i32 s53, s53, 16
    s_cmp_gt_i32 s53, 0
    s_cbranch_scc1 K2_loop
K2_swept:
    s_nop 7
    s_add_u32 s48, s48, 1536
    s_cmp_ge_u32 s48, s47
    s_cbranch_scc1 K2_epi
    s_waitcnt vmcnt(0) lgkmcnt(0)
    s_barrier
    v_lshlrev_b32 v11, 2, v0
    v_mov_b32 v12, 0x00ffffff
    v_mov_b32 v13, 0
    ds_write_b32 v11, v12 offset:0
    ds_write_b32 v11, v12 offset:2048
    ds_write_b32 v11, v12 offset:4096
    ds_write_b32 v11, v13 offset:6144
    ds_write_b32 v11, v13 offset:8192
    v_and_b32 v14, 1023, v11
    ds_write_b32 v14, v13 offset:10240
    v_and_b32 v14, 255, v11
    ds_write_b32 v14, v13 offset:48128
    ds_write_b32 v13, v13 offset:48644
    s_waitcnt lgkmcnt(0)
    s_barrier
    s_branch K2_round
K2_epi:
    v_lshlrev_b32 v8, 2, v1
    s_lshr_b32 s54, s56, 1
    s_and_b32 s54, s54, 0xc0
    s_lshl_b32 s55, s56, 3
    s_or_b32 s54, s54, s55
    s_xor_b32 s55, s54, 0
    v_cvt_pk_bf16_f32 v64, v16, v20
    v_xor_b32 v68, s55, v8
    ds_write_b32 v68, v64 offset:0
    s_xor_b32 s55, s54, 16
    v_cvt_pk_bf16_f32 v65, v17, v21
    v_xor_b32 v69, s55, v8
    ds_write_b32 v69, v65 offset:256
    s_xor_b32 s55, s54, 32
    v_cvt_pk_bf16_f32 v66, v18, v22
    v_xor_b32 v70, s55, v8
    ds_write_b32 v70, v66 offset:512
    s_xor_b32 s55, s54, 48
    v_cvt_pk_bf16_f32 v67, v19, v23
    v_xor_b32 v71, s55, v8
    ds_write_b32 v71, v67 offset:768
    s_lshr_b32 s54, s57, 1
    s_and_b32 s54, s54, 0xc0
    s_lshl_b32 s55, s57, 3
    s_or_b32 s54, s54, s55
    s_xor_b32 s55, s54, 0
    v_cvt_pk_bf16_f32 v72, v24, v28
    v_xor_b32 v76, s55, v8
    ds_write_b32 v76, v72 offset:0
    s_xor_b32 s55, s54, 16
    v_cvt_pk_bf16_f32 v73, v25, v29
    v_xor_b32 v77, s55, v8
    ds_write_b32 v77, v73 offset:256
    s_xor_b32 s55, s54, 32
    v_cvt_pk_bf16_f32 v74, v26, v30
    v_xor_b32 v78, s55, v8
    ds_write_b32 v78, v74 offset:512
    s_xor_b32 s55, s54, 48
    v_cvt_pk_bf16_f32 v75, v27, v31
    v_xor_b32 v79, s55, v8
    ds_write_b32 v79, v75 offset:768
    s_lshr_b32 s54, s58, 1
    s_and_b32 s54, s54, 0xc0
    s_lshl_b32 s55, s58, 3
    s_or_b32 s54, s54, s55
    s_xor_b32 s55, s54, 0
    v_cvt_pk_bf16_f32 v80, v32, v36
    v_xor_b32 v84, s55, v8
    ds_write_b32 v84, v80 offset:0
    s_xor_b32 s55, s54, 16
    v_cvt_pk_bf16_f32 v81, v33, v37
    v_xor_b32 v85, s55, v8
    ds_write_b32 v85, v81 offset:256
    s_xor_b32 s55, s54, 32
    v_cvt_pk_bf16_f32 v82, v34, v38
    v_xor_b32 v86, s55, v8
    ds_write_b32 v86, v82 offset:512
    s_xor_b32 s55, s54, 48
    v_cvt_pk_bf16_f32 v83, v35, v39
    v_xor_b32 v87, s55, v8
    ds_write_b32 v87, v83 offset:768
    s_lshr_b32 s54, s59, 1
    s_and_b32 s54, s54, 0xc0
    s_lshl_b32 s55, s59, 3
    s_or_b32 s54, s54, s55
    s_xor_b32 s55, s54, 0
    v_cvt_pk_bf16_f32 v88, v40, v44
    v_xor_b32 v92, s55, v8
    ds_write_b32 v92, v88 offset:0
    s_xor_b32 s55, s54, 16
    v_cvt_pk_bf16_f32 v89, v41, v45
    v_xor_b32 v93, s55, v8
    ds_write_b32 v93, v89 offset:256
    s_xor_b32 s55, s54, 32
    v_cvt_pk_bf16_f32 v90, v42, v46
    v_xor_b32 v94, s55, v8
    ds_write_b32 v94, v90 offset:512
    s_xor_b32 s55, s54, 48
    v_cvt_pk_bf16_f32 v91, v43, v47
    v_xor_b32 v95, s55, v8
    ds_write_b32 v95, v91 offset:768
    s_lshr_b32 s54, s60, 1
    s_and_b32 s54, s54, 0xc0
    s_lshl_b32 s55, s60, 3
    s_or_b32 s54, s54, s55
    s_xor_b32 s55, s54, 0
    v_cvt_pk_bf16_f32 v64, v48, v52
    v_xor_b32 v68, s55, v8
    ds_write_b32 v68, v64 offset:0
    s_xor_b32 s55, s54, 16
    v_cvt_pk_bf16_f32 v65, v49, v53
    v_xor_b32 v69, s55, v8
    ds_write_b32 v69, v65 offset:256
    s_xor_b32 s55, s54, 32
    v_cvt_pk_bf16_f32 v66, v50, v54
    v_xor_b32 v70, s55, v8
    ds_write_b32 v70, v66 offset:512
    s_xor_b32 s55, s54, 48
    v_cvt_pk_bf16_f32 v67, v51, v55
    v_xor_b32 v71, s55, v8
    ds_write_b32 v71, v67 offset:768
    v_and_b32 v8, 15, v1
    v_lshrrev_b32 v9, 4, v1
    v_xor_b32 v10, v8, v9
    v_lshlrev_b32 v10, 4, v10
    v_lshl_add_u32 v10, v8, 8, v10
    s_lshr_b32 s54, s3, 2
    s_mul_i32 s54, s54, 20480
    v_add_u32 v10, s54, v10
    v_xor_b32 v11, 64, v10
    v_xor_b32 v12, 128, v10
    v_xor_b32 v13, 192, v10
    v_lshlrev_b32 v9, 10, v9
    v_lshl_add_u32 v9, v8, 2, v9
    s_and_b32 s55, s3, 3
    s_lshl_b32 s55, s55, 6
    s_add_u32 s54, s54, s55
    s_waitcnt vmcnt(0) lgkmcnt(0)
    s_barrier
    ds_read_b128 v[16:19], v10 offset:0
    ds_read_b128 v[20:23], v11 offset:0
    ds_read_b128 v[24:27], v12 offset:0
    ds_read_b128 v[28:31], v13 offset:0
    ds_read_b128 v[32:35], v10 offset:4096
    ds_read_b128 v[36:39], v11 offset:4096
    ds_read_b128 v[40:43], v12 offset:4096
    ds_read_b128 v[44:47], v13 offset:4096
    ds_read_b128 v[48:51], v10 offset:8192
    ds_read_b128 v[52:55], v11 offset:8192
    ds_read_b128 v[56:59], v12 offset:8192
    ds_read_b128 v[60:63], v13 offset:8192
    ds_read_b128 v[64:67], v10 offset:12288
    ds_read_b128 v[68:71], v11 offset:12288
    ds_read_b128 v[72:75], v12 offset:12288
    ds_read_b128 v[76:79], v13 offset:12288
    ds_read_b128 v[80:83], v10 offset:16384
    ds_read_b128 v[84:87], v11 offset:16384
    ds_read_b128 v[88:91], v12 offset:16384
    ds_read_b128 v[92:95], v13 offset:16384
    s_waitcnt lgkmcnt(15)
    v_mfma_f32_16x16x32_bf16 v[128:131], v[16:19], v[208:211], 0
    v_mfma_f32_16x16x32_bf16 v[132:135], v[16:19], v[212:215], 0
    v_mfma_f32_16x16x32_bf16 v[128:131], v[20:23], v[216:219], v[128:131]
    v_mfma_f32_16x16x32_bf16 v[132:135], v[20:23], v[220:223], v[132:135]
    v_mfma_f32_16x16x32_bf16 v[128:131], v[24:27], v[224:227], v[128:131]
    v_mfma_f32_16x16x32_bf16 v[132:135], v[24:27], v[228:231], v[132:135]
    v_mfma_f32_16x16x32_bf16 v[128:131], v[28:31], v[232:235], v[128:131]
    v_mfma_f32_16x16x32_bf16 v[132:135], v[28:31], v[236:239], v[132:135]
    s_waitcnt lgkmcnt(12)
    v_mfma_f32_16x16x32_bf16 v[136:139], v[32:35], v[208:211], 0
    v_mfma_f32_16x16x32_bf16 v[140:143], v[32:35], v[212:215], 0
    v_mfma_f32_16x16x32_bf16 v[136:139], v[36:39], v[216:219], v[136:139]
    v_mfma_f32_16x16x32_bf16 v[140:143], v[36:39], v[220:223], v[140:143]
    v_mfma_f32_16x16x32_bf16 v[136:139], v[40:43], v[224:227], v[136:139]
    v_mfma_f32_16x16x32_bf16 v[140:143], v[40:43], v[228:231], v[140:143]
    v_mfma_f32_16x16x32_bf16 v[136:139], v[44:47], v[232:235], v[136:139]
    v_mfma_f32_16x16x32_bf16 v[140:143], v[44:47], v[236:239], v[140:143]
    v_cvt_pk_bf16_f32 v96, v128, v132
    buffer_store_dword v96, v9, s[40:43], s54 offen offset:0
    v_cvt_pk_bf16_f32 v97, v129, v133
    buffer_store_dword v97, v9, s[40:43], s54 offen offset:256
    v_cvt_pk_bf16_f32 v98, v130, v134
    buffer_store_dword v98, v9, s[40:43], s54 offen offset:512
    v_cvt_pk_bf16_f32 v99, v131, v135
    buffer_store_dword v99, v9, s[40:43], s54 offen offset:768
    s_add_u32 s54, s54, 4096
    s_waitcnt lgkmcnt(8)
    v_mfma_f32_16x16x32_bf16 v[144:147], v[48:51], v[208:211], 0
    v_mfma_f32_16x16x32_bf16 v[148:151], v[48:51], v[212:215], 0
    v_mfma_f32_16x16x32_bf16 v[144:147], v[52:55], v[216:219], v[144:147]
    v_mfma_f32_16x16x32_bf16 v[148:151], v[52:55], v[220:223], v[148:151]
    v_mfma_f32_16x16x32_bf16 v[144:147], v[56:59], v[224:227], v[144:147]
    v_mfma_f32_16x16x32_bf16 v[148:151], v[56:59], v[228:231], v[148:151]
    v_mfma_f32_16x16x32_bf16 v[144:147], v[60:63], v[232:235], v[144:147]
    v_mfma_f32_16x16x32_bf16 v[148:151], v[60:63], v[236:239], v[148:151]
    v_cvt_pk_bf16_f32 v100, v136, v140
    buffer_store_dword v100, v9, s[40:43], s54 offen offset:0
    v_cvt_pk_bf16_f32 v101, v137, v141
    buffer_store_dword v101, v9, s[40:43], s54 offen offset:256
    v_cvt_pk_bf16_f32 v102, v138, v142
    buffer_store_dword v102, v9, s[40:43], s54 offen offset:512
    v_cvt_pk_bf16_f32 v103, v139, v143
    buffer_store_dword v103, v9, s[40:43], s54 offen offset:768
    s_add_u32 s54, s54, 4096
    s_waitcnt lgkmcnt(4)
    v_mfma_f32_16x16x32_bf16 v[152:155], v[64:67], v[208:211], 0
    v_mfma_f32_16x16x32_bf16 v[156:159], v[64:67], v[212:215], 0
    v_mfma_f32_16x16x32_bf16 v[152:155], v[68:71], v[216:219], v[152:155]
    v_mfma_f32_16x16x32_bf16 v[156:159], v[68:71], v[220:223], v[156:159]
    v_mfma_f32_16x16x32_bf16 v[152:155], v[72:75], v[224:227], v[152:155]
    v_mfma_f32_16x16x32_bf16 v[156:159], v[72:75], v[228:231], v[156:159]
    v_mfma_f32_16x16x32_bf16 v[152:155], v[76:79], v[232:235], v[152:155]
    v_mfma_f32_16x16x32_bf16 v[156:159], v[76:79], v[236:239], v[156:159]
    v_cvt_pk_bf16_f32 v104, v144, v148
    buffer_store_dword v104, v9, s[40:43], s54 offen offset:0
    v_cvt_pk_bf16_f32 v105, v145, v149
    buffer_store_dword v105, v9, s[40:43], s54 offen offset:256
    v_cvt_pk_bf16_f32 v106, v146, v150
    buffer_store_dword v106, v9, s[40:43], s54 offen offset:512
    v_cvt_pk_bf16_f32 v107, v147, v151
    buffer_store_dword v107, v9, s[40:43], s54 offen offset:768
    s_add_u32 s54, s54, 4096
    s_waitcnt lgkmcnt(0)
    v_mfma_f32_16x16x32_bf16 v[160:163], v[80:83], v[208:211], 0
    v_mfma_f32_16x16x32_bf16 v[164:167], v[80:83], v[212:215], 0
    v_mfma_f32_16x16x32_bf16 v[160:163], v[84:87], v[216:219], v[160:163]
    v_mfma_f32_16x16x32_bf16 v[164:167], v[84:87], v[220:223], v[164:167]
    v_mfma_f32_16x16x32_bf16 v[160:163], v[88:91], v[224:227], v[160:163]
    v_mfma_f32_16x16x32_bf16 v[164:167], v[88:91], v[228:231], v[164:167]
    v_mfma_f32_16x16x32_bf16 v[160:163], v[92:95], v[232:235], v[160:163]
    v_mfma_f32_16x16x32_bf16 v[164:167], v[92:95], v[236:239], v[164:167]
    v_cvt_pk_bf16_f32 v108, v152, v156
    buffer_store_dword v108, v9, s[40:43], s54 offen offset:0
    v_cvt_pk_bf16_f32 v109, v153, v157
    buffer_store_dword v109, v9, s[40:43], s54 offen offset:256
    v_cvt_pk_bf16_f32 v110, v154, v158
    buffer_store_dword v110, v9, s[40:43], s54 offen offset:512
    v_cvt_pk_bf16_f32 v111, v155, v159
    buffer_store_dword v111, v9, s[40:43], s54 offen offset:768
    s_add_u32 s54, s54, 4096
    v_cvt_pk_bf16_f32 v112, v160, v164
    buffer_store_dword v112, v9, s[40:43], s54 offen offset:0
    v_cvt_pk_bf16_f32 v113, v161, v165
    buffer_store_dword v113, v9, s[40:43], s54 offen offset:256
    v_cvt_pk_bf16_f32 v114, v162, v166
    buffer_store_dword v114, v9, s[40:43], s54 offen offset:512
    v_cvt_pk_bf16_f32 v115, v163, v167
    buffer_store_dword v115, v9, s[40:43], s54 offen offset:768
    s_add_u32 s54, s54, 4096
K2_done:
    s_endpgm
.section .rodata,"a"
.p2align 6
.amdhsa_kernel part_kernel
  .amdhsa_next_free_vgpr 72
  .amdhsa_next_free_sgpr 64
  .amdhsa_accum_offset 72
  .amdhsa_group_segment_fixed_size 0
  .amdhsa_kernarg_size 88
  .amdhsa_user_sgpr_count 2
  .amdhsa_user_sgpr_kernarg_segment_ptr 1
  .amdhsa_system_sgpr_workgroup_id_x 1
  .amdhsa_float_denorm_mode_32 3
.end_amdhsa_kernel
.p2align 6
.amdhsa_kernel gather_scatter__tensor_product_equiv_mace__graph_kernel
  .amdhsa_next_free_vgpr 240
  .amdhsa_next_free_sgpr 102
  .amdhsa_accum_offset 240
  .amdhsa_group_segment_fixed_size 0
  .amdhsa_kernarg_size 88
  .amdhsa_user_sgpr_count 2
  .amdhsa_user_sgpr_kernarg_segment_ptr 1
  .amdhsa_system_sgpr_workgroup_id_x 1
  .amdhsa_float_denorm_mode_32 3
.end_amdhsa_kernel
```

```asm
; @launch kernel=part_kernel grid=(255,1,1) block=(640,1,1) lds=63488
; @launch kernel=gather_scatter__tensor_product_equiv_mace__graph_kernel grid=(256,1,1) block=(512,1,1) lds=150272
.amdgcn_target "amdgcn-amd-amdhsa--gfx950"
.text
.globl part_kernel
.p2align 8
.type part_kernel,@function
part_kernel:
    s_cmp_ge_u32 s2, 250
    s_cbranch_scc1 K1_frag
    s_load_dwordx4 s[4:7], s[0:1], 8
    s_load_dwordx4 s[8:11], s[0:1], 24
    s_load_dwordx2 s[12:13], s[0:1], 80
    v_lshrrev_b32 v12, 6, v0
    v_lshlrev_b32 v1, 3, v0
    v_lshlrev_b32 v2, 4, v0
    v_and_b32 v3, 63, v0
    v_readfirstlane_b32 s3, v12
    v_lshlrev_b32 v13, 2, v0
    v_mov_b32 v14, 0
    v_mov_b32 v15, 1
    ds_write_b32 v13, v14
    s_mul_i32 s14, s2, 5120
    s_mul_i32 s15, s2, 10240
    s_mul_i32 s26, s2, 40960
    s_lshl_b32 s27, s3, 12
    v_lshl_add_u32 v16, v3, 4, s27
    s_add_u32 m0, s27, 22528
    s_waitcnt lgkmcnt(0)
    s_add_u32 s6, s6, s14
    s_addc_u32 s7, s7, 0
    global_load_dwordx2 v[4:5], v1, s[6:7] nt
    s_add_u32 s4, s4, s14
    s_addc_u32 s5, s5, 0
    global_load_dwordx2 v[6:7], v1, s[4:5] nt
    s_add_u32 s8, s8, s15
    s_addc_u32 s9, s9, 0
    s_add_u32 s16, s10, s26
    s_addc_u32 s17, s11, 0
    s_mov_b32 s18, 40960
    s_mov_b32 s19, 0x20000
    s_barrier
    global_load_dwordx4 v[8:11], v2, s[8:9] nt
    buffer_load_dwordx4 v16, s[16:19], 0 offen offset:0 nt lds
    buffer_load_dwordx4 v16, s[16:19], 0 offen offset:1024 nt lds
    s_lshl_b32 s14, s2, 10
    s_add_u32 s20, s12, s14
    s_addc_u32 s21, s13, 0
    s_mul_i32 s14, s2, 15360
    s_add_u32 s14, s14, 262144
    s_add_u32 s22, s12, s14
    s_addc_u32 s23, s13, 0
    s_add_u32 s26, s26, 4194304
    s_add_u32 s24, s12, s26
    s_addc_u32 s25, s13, 0
    s_mov_b32 s28, 109951168
    s_movk_i32 s29, 625
    s_movk_i32 s30, 838
    s_waitcnt vmcnt(4)
    v_mul_hi_u32 v20, v4, s28
    v_mul_hi_u32 v21, v5, s28
    v_lshlrev_b32 v22, 2, v20
    ds_add_rtn_u32 v24, v22, v15 offset:0
    v_lshlrev_b32 v23, 2, v21
    ds_add_rtn_u32 v25, v23, v15 offset:0
    v_lshlrev_b32 v12, 4, v3
    s_waitcnt lgkmcnt(0)
    s_barrier
    ds_read_b128 v[32:35], v12 offset:0
    buffer_load_dwordx4 v16, s[16:19], 0 offen offset:2048 nt lds
    buffer_load_dwordx4 v16, s[16:19], 0 offen offset:3072 nt lds
    v_mad_u32_u24 v26, v20, s29, 15
    v_lshrrev_b32 v26, 4, v26
    v_sub_u32 v26, v4, v26
    v_lshrrev_b32 v28, 3, v20
    v_and_b32 v28, 28, v28
    v_mad_u32_u24 v27, v21, s29, 15
    v_lshrrev_b32 v27, 4, v27
    v_sub_u32 v27, v5, v27
    v_lshrrev_b32 v29, 3, v21
    v_and_b32 v29, 28, v29
    s_waitcnt lgkmcnt(0)
    v_add_u32 v36, v32, v33
    v_add3_u32 v36, v36, v34, v35
    v_mov_b32 v37, v36
    s_nop 1
    v_add_u32_dpp v37, v37, v37 row_shr:1 row_mask:0xf bank_mask:0xf
    s_nop 1
    v_add_u32_dpp v37, v37, v37 row_shr:2 row_mask:0xf bank_mask:0xf
    s_nop 1
    v_add_u32_dpp v37, v37, v37 row_shr:4 row_mask:0xf bank_mask:0xf
    s_nop 1
    v_add_u32_dpp v37, v37, v37 row_shr:8 row_mask:0xf bank_mask:0xf
    s_nop 1
    v_add_u32_dpp v37, v37, v37 row_bcast:15 row_mask:0xa bank_mask:0xf
    s_nop 1
    v_add_u32_dpp v37, v37, v37 row_bcast:31 row_mask:0xc bank_mask:0xf
    v_sub_u32 v40, v37, v36
    v_add_u32 v41, v40, v32
    v_add_u32 v42, v41, v33
    v_add_u32 v43, v42, v34
    ds_write_b128 v12, v[40:43] offset:1024
    ds_read_b32 v38, v22 offset:1024
    ds_read_b32 v39, v23 offset:1024
    s_waitcnt vmcnt(5)
    v_mul_u32_u24 v30, s30, v6
    v_lshrrev_b32 v30, 18, v30
    v_sub_u32 v30, v30, v28
    v_and_b32 v30, 31, v30
    v_lshl_or_b32 v30, v26, 5, v30
    v_lshlrev_b32 v30, 21, v30
    v_lshl_or_b32 v30, v6, 7, v30
    v_mul_u32_u24 v31, s30, v7
    v_lshrrev_b32 v31, 18, v31
    v_sub_u32 v31, v31, v29
    v_and_b32 v31, 31, v31
    v_lshl_or_b32 v31, v27, 5, v31
    v_lshlrev_b32 v31, 21, v31
    v_lshl_or_b32 v31, v7, 7, v31
    v_lshlrev_b32 v44, 6, v0
    v_add_u32 v45, 32, v44
    s_waitcnt vmcnt(4) lgkmcnt(0)
    v_add_u32 v26, v38, v24
    v_lshlrev_b32 v28, 2, v26
    v_mul_u32_u24 v26, 12, v26
    ds_write_b32 v28, v44 offset:2048
    v_add_u32 v26, 7168, v26
    ds_write2_b32 v26, v8, v9 offset0:0 offset1:1
    ds_write_b32 v26, v30 offset:8
    v_add_u32 v27, v39, v25
    v_lshlrev_b32 v29, 2, v27
    v_mul_u32_u24 v27, 12, v27
    ds_write_b32 v29, v45 offset:2048
    v_add_u32 v27, 7168, v27
    ds_write2_b32 v27, v10, v11 offset0:0 offset1:1
    ds_write_b32 v27, v31 offset:8
    v_lshl_or_b32 v32, v32, 16, v40
    v_lshl_or_b32 v33, v33, 16, v41
    v_lshl_or_b32 v34, v34, 16, v42
    v_lshl_or_b32 v35, v35, 16, v43
    v_lshrrev_b32 v20, 1, v3
    v_lshlrev_b32 v20, 2, v20
    s_lshl_b32 s14, s3, 9
    v_add_u32 v20, s14, v20
    v_and_b32 v21, 1, v3
    v_lshlrev_b32 v21, 4, v21
    v_add_u32 v21, 22528, v21
    s_mul_i32 s14, s3, 1536
    v_add_u32 v1, s14, v12
    s_waitcnt lgkmcnt(0)
    s_barrier
    ds_read_b128 v[48:51], v1 offset:7168
    ds_read_b128 v[52:55], v1 offset:8192
    ds_read_b32 v22, v20 offset:2048
    ds_read_b32 v23, v20 offset:2176
    ds_read_b32 v24, v20 offset:2304
    ds_read_b32 v25, v20 offset:2432
    s_waitcnt lgkmcnt(4)
    global_store_dwordx4 v1, v[48:51], s[22:23] sc1
    s_mov_b32 exec_hi, 0
    global_store_dwordx4 v1, v[52:55], s[22:23] offset:1024 sc1
    s_mov_b32 exec_hi, -1
    s_waitcnt lgkmcnt(0)
    v_add_u32 v22, v21, v22
    v_add_u32 v23, v21, v23
    v_add_u32 v24, v21, v24
    v_add_u32 v25, v21, v25
    s_waitcnt vmcnt(2)
    s_barrier
    ds_read_b128 v[56:59], v22
    ds_read_b128 v[60:63], v23
    ds_read_b128 v[64:67], v24
    ds_read_b128 v[68:71], v25
    s_waitcnt lgkmcnt(3)
    global_store_dwordx4 v16, v[56:59], s[24:25] offset:0 sc1
    s_waitcnt lgkmcnt(2)
    global_store_dwordx4 v16, v[60:63], s[24:25] offset:1024 sc1
    s_waitcnt lgkmcnt(1)
    global_store_dwordx4 v16, v[64:67], s[24:25] offset:2048 sc1
    s_waitcnt lgkmcnt(0)
    global_store_dwordx4 v16, v[68:71], s[24:25] offset:3072 sc1
    s_cmp_lg_u32 s3, 9
    s_cbranch_scc1 K1_notab
    global_store_dwordx4 v12, v[32:35], s[20:21] sc1
K1_notab:
K1_done:
    s_endpgm
K1_frag:
    s_cmp_ge_u32 s2, 255
    s_cbranch_scc1 K1_done
    s_load_dwordx2 s[4:5], s[0:1], 40
    s_load_dwordx4 s[8:11], s[0:1], 48
    s_load_dwordx2 s[12:13], s[0:1], 80
    v_lshrrev_b32 v12, 6, v0
    v_and_b32 v3, 63, v0
    v_and_b32 v4, 15, v0
    v_readfirstlane_b32 s3, v12
    s_sub_u32 s14, s2, 250
    s_cmp_ge_u32 s3, 8
    s_cbranch_scc1 K1_done
    s_waitcnt lgkmcnt(0)
    s_add_u32 s12, s12, 4128768
    s_addc_u32 s13, s13, 0
    v_lshlrev_b32 v2, 4, v0
    s_cmp_eq_u32 s14, 4
    s_cbranch_scc1 K1_fragc
    v_lshrrev_b32 v5, 4, v3
    v_lshlrev_b32 v5, 13, v5
    v_lshl_add_u32 v5, v4, 2, v5
    s_lshr_b32 s15, s3, 1
    s_lshl_b32 s15, s15, 8
    s_and_b32 s16, s3, 1
    s_lshl_b32 s16, s16, 1
    s_add_u32 s15, s15, s16
    s_lshl_b32 s16, s14, 6
    s_add_u32 s15, s15, s16
    v_add_u32 v5, s15, v5
    v_add_u32 v6, 4096, v5
    global_load_ushort v8, v5, s[10:11] offset:0
    global_load_ushort v9, v5, s[10:11] offset:1024
    global_load_ushort v10, v5, s[10:11] offset:2048
    global_load_ushort v11, v5, s[10:11] offset:3072
    global_load_ushort v12, v6, s[10:11] offset:0
    global_load_ushort v13, v6, s[10:11] offset:1024
    global_load_ushort v14, v6, s[10:11] offset:2048
    global_load_ushort v15, v6, s[10:11] offset:3072
    s_lshl_b32 s15, s14, 13
    s_add_u32 s15, s15, 8192
    v_add_u32 v2, s15, v2
K1_fragst:
    s_waitcnt vmcnt(0)
    v_lshl_or_b32 v16, v9, 16, v8
    v_lshl_or_b32 v17, v11, 16, v10
    v_lshl_or_b32 v18, v13, 16, v12
    v_lshl_or_b32 v19, v15, 16, v14
K1_fragst2:
    global_store_dwordx4 v2, v[16:19], s[12:13] sc1
    s_endpgm
K1_fragc:
    s_cmp_ge_u32 s3, 4
    s_cbranch_scc1 K1_fragc2
    v_lshrrev_b32 v5, 5, v3
    v_lshlrev_b32 v5, 11, v5
    v_lshl_add_u32 v5, v4, 4, v5
    v_bfe_u32 v6, v3, 4, 1
    v_lshl_add_u32 v5, v6, 1, v5
    s_lshl_b32 s15, s3, 2
    v_add_u32 v5, s15, v5
    global_load_ushort v8, v5, s[8:9] offset:0
    global_load_ushort v9, v5, s[8:9] offset:256
    global_load_ushort v10, v5, s[8:9] offset:512
    global_load_ushort v11, v5, s[8:9] offset:768
    global_load_ushort v12, v5, s[8:9] offset:1024
    global_load_ushort v13, v5, s[8:9] offset:1280
    global_load_ushort v14, v5, s[8:9] offset:1536
    global_load_ushort v15, v5, s[8:9] offset:1792
    s_branch K1_fragst
K1_fragc2:
    s_cmp_eq_u32 s3, 4
    s_cbranch_scc0 K1_fragc3
    v_lshrrev_b32 v5, 4, v3
    v_lshlrev_b32 v5, 5, v5
    v_and_b32 v6, 3, v3
    v_lshl_add_u32 v5, v6, 1, v5
    global_load_ushort v8, v5, s[4:5] offset:0
    global_load_ushort v9, v5, s[4:5] offset:8
    global_load_ushort v10, v5, s[4:5] offset:16
    global_load_ushort v11, v5, s[4:5] offset:24
    v_and_b32 v6, 4, v3
    v_lshlrev_b32 v6, 2, v6
    v_mov_b32 v7, 0xffff
    v_lshlrev_b32 v7, v6, v7
    v_bfe_i32 v6, v3, 3, 1
    v_and_b32 v19, v6, v7
    v_xor_b32 v18, v19, v7
    s_waitcnt vmcnt(0)
    v_lshl_or_b32 v16, v9, 16, v8
    v_lshl_or_b32 v17, v11, 16, v10
    s_branch K1_fragst2
K1_fragc3:
    v_mov_b32 v16, 0
    v_mov_b32 v17, 0
    v_mov_b32 v18, 0
    v_mov_b32 v19, 0
    v_writelane_b32 v16, 0, 3
    v_writelane_b32 v16, 1, 11
    v_writelane_b32 v16, 2, 21
    v_writelane_b32 v16, 3, 31
    v_writelane_b32 v16, 4, 36
    v_writelane_b32 v16, 8, 5
    v_writelane_b32 v16, 9, 8
    v_writelane_b32 v16, 10, 20
    v_writelane_b32 v16, 11, 27
    v_writelane_b32 v16, 12, 38
    v_writelane_b32 v16, 16, 0
    v_writelane_b32 v16, 17, 6
    v_writelane_b32 v16, 18, 7
    v_writelane_b32 v16, 19, 13
    v_writelane_b32 v16, 20, 39
    v_writelane_b32 v16, 24, 9
    v_writelane_b32 v16, 25, 14
    v_writelane_b32 v16, 26, 18
    v_writelane_b32 v16, 27, 25
    v_writelane_b32 v16, 28, 34
    v_writelane_b32 v16, 32, 10
    v_writelane_b32 v16, 33, 16
    v_writelane_b32 v16, 34, 19
    v_writelane_b32 v16, 35, 24
    v_writelane_b32 v16, 36, 32
    v_writelane_b32 v16, 40, 4
    v_writelane_b32 v16, 41, 12
    v_writelane_b32 v16, 42, 26
    v_writelane_b32 v16, 43, 29
    v_writelane_b32 v16, 44, 33
    v_writelane_b32 v16, 48, 1
    v_writelane_b32 v16, 49, 17
    v_writelane_b32 v16, 50, 23
    v_writelane_b32 v16, 51, 28
    v_writelane_b32 v16, 52, 37
    v_writelane_b32 v16, 56, 2
    v_writelane_b32 v16, 57, 15
    v_writelane_b32 v16, 58, 22
    v_writelane_b32 v16, 59, 30
    v_writelane_b32 v16, 60, 35
    v_writelane_b32 v17, 0, 1
    v_writelane_b32 v17, 1, 10
    v_writelane_b32 v17, 2, 15
    v_writelane_b32 v17, 3, 30
    v_writelane_b32 v17, 4, 39
    v_writelane_b32 v17, 8, 2
    v_writelane_b32 v17, 9, 9
    v_writelane_b32 v17, 10, 21
    v_writelane_b32 v17, 11, 28
    v_writelane_b32 v17, 12, 37
    v_writelane_b32 v17, 16, 4
    v_writelane_b32 v17, 17, 14
    v_writelane_b32 v17, 18, 22
    v_writelane_b32 v17, 19, 27
    v_writelane_b32 v17, 20, 31
    v_writelane_b32 v17, 24, 6
    v_writelane_b32 v17, 25, 12
    v_writelane_b32 v17, 26, 18
    v_writelane_b32 v17, 27, 24
    v_writelane_b32 v17, 28, 35
    v_writelane_b32 v17, 32, 3
    v_writelane_b32 v17, 33, 8
    v_writelane_b32 v17, 34, 16
    v_writelane_b32 v17, 35, 29
    v_writelane_b32 v17, 36, 38
    v_writelane_b32 v17, 40, 5
    v_writelane_b32 v17, 41, 13
    v_writelane_b32 v17, 42, 17
    v_writelane_b32 v17, 43, 26
    v_writelane_b32 v17, 44, 34
    v_writelane_b32 v17, 48, 0
    v_writelane_b32 v17, 49, 20
    v_writelane_b32 v17, 50, 23
    v_writelane_b32 v17, 51, 32
    v_writelane_b32 v17, 52, 36
    v_writelane_b32 v17, 56, 7
    v_writelane_b32 v17, 57, 11
    v_writelane_b32 v17, 58, 19
    v_writelane_b32 v17, 59, 25
    v_writelane_b32 v17, 60, 33
    v_and_b32 v8, 7, v16
    v_lshrrev_b32 v16, 3, v16
    v_lshlrev_b32 v8, 12, v8
    v_lshl_or_b32 v16, v16, 7, v8
    v_and_b32 v8, 7, v17
    v_lshrrev_b32 v17, 3, v17
    v_lshlrev_b32 v8, 12, v8
    v_lshl_or_b32 v17, v17, 7, v8
    s_branch K1_fragst2
.globl gather_scatter__tensor_product_equiv_mace__graph_kernel
.p2align 8
.type gather_scatter__tensor_product_equiv_mace__graph_kernel,@function
gather_scatter__tensor_product_equiv_mace__graph_kernel:
    s_cmp_ge_u32 s2, 256
    s_cbranch_scc1 K2_done
    s_load_dwordx2 s[14:15], s[0:1], 80
    s_load_dwordx2 s[4:5], s[0:1], 0
    s_load_dwordx2 s[12:13], s[0:1], 64
    v_lshrrev_b32 v8, 6, v0
    v_and_b32 v1, 63, v0
    v_readfirstlane_b32 s3, v8
    s_and_b32 s44, s2, 7
    s_lshl_b32 s44, s44, 5
    s_lshr_b32 s54, s2, 3
    s_add_u32 s44, s44, s54
    v_lshrrev_b32 v9, 1, v0
    v_lshlrev_b32 v10, 10, v9
    s_lshl_b32 s54, s44, 2
    s_mov_b32 s22, 256000
    s_mov_b32 s23, 0x20000
    v_lshlrev_b32 v11, 2, v0
    v_mov_b32 v12, 0x00700000
    v_mov_b32 v13, 0
    ds_write_b32 v11, v12 offset:0
    ds_write_b32 v11, v12 offset:2048
    ds_write_b32 v11, v12 offset:4096
    ds_write_b32 v11, v13 offset:6144
    ds_write_b32 v11, v13 offset:8192
    ds_write_b32 v11, v13 offset:10240
    ds_write_b32 v11, v13 offset:12288
    v_lshlrev_b32 v2, 4, v1
    s_waitcnt lgkmcnt(0)
    s_mov_b32 s20, s14
    s_mov_b32 s21, s15
    buffer_load_dword v3, v10, s[20:23], s54 offen
    s_mov_b32 s16, s4
    s_mov_b32 s17, s5
    s_mov_b32 s18, 10240000
    s_mov_b32 s19, 0x20000
    s_barrier
    s_add_u32 s32, s14, 4128768
    s_addc_u32 s33, s15, 0
    s_mov_b32 s34, 40960
    s_mov_b32 s35, 0x20000
    s_lshl_b32 s54, s3, 10
    s_add_u32 m0, s54, 32768
    s_nop 0
    buffer_load_dwordx4 v2, s[32:35], s54 offen lds
    s_lshl_b32 s54, s3, 12
    s_add_u32 s54, s54, 8192
    s_add_u32 m0, s54, 32768
    s_nop 0
    buffer_load_dwordx4 v2, s[32:35], s54 offen offset:0 lds
    buffer_load_dwordx4 v2, s[32:35], s54 offen offset:1024 lds
    buffer_load_dwordx4 v2, s[32:35], s54 offen offset:2048 lds
    buffer_load_dwordx4 v2, s[32:35], s54 offen offset:3072 lds
    s_add_u32 s24, s14, 262144
    s_addc_u32 s25, s15, 0
    s_mov_b32 s26, 3840000
    s_mov_b32 s27, 0x20000
    s_add_u32 s28, s14, 4194304
    s_addc_u32 s29, s15, 0
    s_mov_b32 s30, 10240000
    s_mov_b32 s31, 0x20000
    s_mov_b32 s48, 0
    s_lshl_b32 s52, s3, 10
    s_add_u32 s52, s52, 101120
    v_mul_u32_u24 v5, 1280, v9
    v_mov_b32 v6, 1
    v_bfe_i32 v14, v0, 0, 1
    v_mov_b32 v16, 0
    v_mov_b32 v17, 0
    v_mov_b32 v18, 0
    v_mov_b32 v19, 0
    v_mov_b32 v20, 0
    v_mov_b32 v21, 0
    v_mov_b32 v22, 0
    v_mov_b32 v23, 0
    v_mov_b32 v24, 0
    v_mov_b32 v25, 0
    v_mov_b32 v26, 0
    v_mov_b32 v27, 0
    v_mov_b32 v28, 0
    v_mov_b32 v29, 0
    v_mov_b32 v30, 0
    v_mov_b32 v31, 0
    v_mov_b32 v32, 0
    v_mov_b32 v33, 0
    v_mov_b32 v34, 0
    v_mov_b32 v35, 0
    v_mov_b32 v36, 0
    v_mov_b32 v37, 0
    v_mov_b32 v38, 0
    v_mov_b32 v39, 0
    v_mov_b32 v40, 0
    v_mov_b32 v41, 0
    v_mov_b32 v42, 0
    v_mov_b32 v43, 0
    v_mov_b32 v44, 0
    v_mov_b32 v45, 0
    v_mov_b32 v46, 0
    v_mov_b32 v47, 0
    v_mov_b32 v48, 0
    v_mov_b32 v49, 0
    v_mov_b32 v50, 0
    v_mov_b32 v51, 0
    v_mov_b32 v52, 0
    v_mov_b32 v53, 0
    v_mov_b32 v54, 0
    v_mov_b32 v55, 0
    v_mov_b32 v56, 0
    v_mov_b32 v57, 0
    v_mov_b32 v58, 0
    v_mov_b32 v59, 0
    v_mov_b32 v60, 0
    v_mov_b32 v61, 0
    v_mov_b32 v62, 0
    v_mov_b32 v63, 0
    s_waitcnt vmcnt(5)
    v_and_b32 v11, 0xffff, v3
    v_lshrrev_b32 v3, 16, v3
    v_and_b32 v4, v3, v14
    v_add_u32 v5, v5, v11
    s_nop 0
    v_add_u32_dpp v4, v4, v4 row_shr:1 row_mask:0xf bank_mask:0xf
    s_nop 1
    v_add_u32_dpp v4, v4, v4 row_shr:2 row_mask:0xf bank_mask:0xf
    s_nop 1
    v_add_u32_dpp v4, v4, v4 row_shr:4 row_mask:0xf bank_mask:0xf
    s_nop 1
    v_add_u32_dpp v4, v4, v4 row_shr:8 row_mask:0xf bank_mask:0xf
    s_nop 1
    v_add_u32_dpp v4, v4, v4 row_bcast:15 row_mask:0xa bank_mask:0xf
    s_nop 1
    v_add_u32_dpp v4, v4, v4 row_bcast:31 row_mask:0xc bank_mask:0xf
    s_mov_b32 exec_lo, 0
    s_brev_b32 exec_hi, 1
    ds_add_rtn_u32 v12, v13, v4 offset:13312
    s_mov_b64 exec, -1
    v_mov_b32_dpp v4, v4 quad_perm:[0,0,2,2] row_mask:0xf bank_mask:0xf
    s_waitcnt lgkmcnt(0)
    v_readlane_b32 s54, v12, 63
    s_nop 1
    v_add_u32 v4, s54, v4
    v_sub_u32 v5, v5, v4
K2_round:
    v_subrev_u32 v8, s48, v4
    v_and_b32 v11, 1, v0
    v_add_u32 v10, v8, v3
    v_max_i32 v8, 0, v8
    v_min_i32 v10, 1536, v10
    v_add_u32 v8, v8, v11
    v_sub_u32 v10, v10, v8
    v_lshlrev_b32 v8, 2, v8
    v_add_u32 v9, s48, v5
K2_map:
    v_cmp_lt_i32 s[64:65], 0, v10
    v_cmp_lt_i32 s[66:67], 2, v10
    v_cmp_lt_i32 s[68:69], 4, v10
    v_cmp_lt_i32 s[70:71], 6, v10
    v_cmp_lt_i32 s[72:73], 8, v10
    v_cmp_lt_i32 s[74:75], 10, v10
    v_cmp_lt_i32 s[76:77], 12, v10
    v_cmp_lt_i32 s[78:79], 14, v10
    s_mov_b64 exec, s[64:65]
    ds_write_b32 v8, v9 offset:0
    s_mov_b64 exec, s[66:67]
    ds_write_b32 v8, v9 offset:8
    s_mov_b64 exec, s[68:69]
    ds_write_b32 v8, v9 offset:16
    s_mov_b64 exec, s[70:71]
    ds_write_b32 v8, v9 offset:24
    s_mov_b64 exec, s[72:73]
    ds_write_b32 v8, v9 offset:32
    s_mov_b64 exec, s[74:75]
    ds_write_b32 v8, v9 offset:40
    s_mov_b64 exec, s[76:77]
    ds_write_b32 v8, v9 offset:48
    s_mov_b64 exec, -1
    s_cmp_lg_u64 s[78:79], 0
    s_cbranch_scc1 K2_map2
    v_lshlrev_b32 v8, 2, v0
    v_lshrrev_b32 v12, 1, v0
    v_lshlrev_b32 v9, 2, v12
    v_lshlrev_b32 v10, 4, v0
    v_mov_b32 v13, 0
    v_mul_u32_u24 v14, 12, v0
    s_waitcnt lgkmcnt(0)
    s_barrier
    ds_read_b32 v64, v8 offset:0
    ds_read_b32 v65, v8 offset:2048
    ds_read_b32 v66, v8 offset:4096
    ds_read_b32 v68, v9 offset:0
    ds_read_b32 v69, v9 offset:1024
    ds_read_b32 v70, v9 offset:2048
    ds_read_b32 v71, v9 offset:3072
    ds_read_b32 v72, v9 offset:4096
    ds_read_b32 v73, v9 offset:5120
    ds_read_b32 v11, v13 offset:13312
    s_waitcnt lgkmcnt(7)
    v_mad_i32_i24 v64, v64, 12, v14
    buffer_load_dwordx3 v[76:78], v64, s[24:27], 0 offen
    v_add_u32 v65, 512, v65
    v_mad_i32_i24 v65, v65, 12, v14
    buffer_load_dwordx3 v[80:82], v65, s[24:27], 0 offen
    v_add_u32 v66, 1024, v66
    v_mad_i32_i24 v66, v66, 12, v14
    buffer_load_dwordx3 v[84:86], v66, s[24:27], 0 offen
    s_waitcnt lgkmcnt(0)
    s_barrier
    v_lshl_add_u32 v68, v68, 5, v10
    v_lshl_add_u32 v69, v69, 5, v10
    v_add_u32 v69, 8192, v69
    v_lshl_add_u32 v70, v70, 5, v10
    v_add_u32 v70, 16384, v70
    v_lshl_add_u32 v71, v71, 5, v10
    v_add_u32 v71, 24576, v71
    v_lshl_add_u32 v72, v72, 5, v10
    v_add_u32 v72, 32768, v72
    v_lshl_add_u32 v73, v73, 5, v10
    v_add_u32 v73, 40960, v73
    s_add_u32 m0, s52, 0
    s_nop 0
    buffer_load_dwordx4 v68, s[28:31], 0 offen  lds
    s_add_u32 m0, s52, 8192
    s_nop 0
    buffer_load_dwordx4 v69, s[28:31], 0 offen  lds
    v_readfirstlane_b32 s47, v11
    s_nop 0
    s_sub_u32 s49, s47, s48
    s_min_u32 s49, s49, 1536
    v_add_u32 v64, 0, v0
    v_cmp_gt_u32 s[80:81], s49, v64
    v_lshlrev_b32 v64, 21, v64
    v_add_u32 v65, 512, v0
    v_cmp_gt_u32 s[82:83], s49, v65
    v_lshlrev_b32 v65, 21, v65
    v_add_u32 v66, 1024, v0
    v_cmp_gt_u32 s[84:85], s49, v66
    v_lshlrev_b32 v66, 21, v66
    s_mul_i32 s45, s44, 625
    s_add_u32 s46, s45, 640
    s_add_u32 s45, s45, 15
    s_lshr_b32 s45, s45, 4
    s_lshr_b32 s46, s46, 4
    s_sub_u32 s46, s46, s45
    s_mov_b32 s86, 0x0f0f0f0f
    s_mov_b32 s87, 0x0f0f0f0f
    s_mov_b32 s88, 0xf0f0f0f0
    s_mov_b32 s89, 0xf0f0f0f0
    v_mov_b32 v164, 0
    v_mov_b32 v165, 0
    v_mov_b32 v166, 0
    v_mov_b32 v167, 0
    v_mov_b32 v168, 0
    v_mov_b32 v169, 0
    v_mov_b32 v170, 0
    v_mov_b32 v171, 0
    v_lshrrev_b32 v200, 5, v1
    v_lshlrev_b32 v200, 4, v200
    v_add_u32 v200, 101120, v200
    v_and_b32 v201, 15, v1
    v_lshl_or_b32 v201, v201, 4, 8
    v_bfe_u32 v11, v1, 3, 2
    v_and_b32 v12, 3, v1
    v_lshl_add_u32 v11, v11, 2, v12
    v_lshlrev_b32 v202, 4, v11
    s_cmp_eq_u32 s46, 40
    s_cselect_b32 s54, 4, 0
    v_add_u32 v203, s54, v2
    v_lshlrev_b32 v8, 2, v1
    v_and_b32 v14, 124, v8
    s_mul_i32 s54, s3, 640
    v_add_u32 v15, s54, v14
    s_mov_b32 s55, 0x1fff80
    v_and_b32 v12, 12, v8
    v_sub_u32 v10, 63, v1
    s_mul_i32 s61, s3, 5
    s_waitcnt vmcnt(4)
    v_lshrrev_b32 v92, 21, v78
    v_lshlrev_b32 v92, 2, v92
    v_lshrrev_b32 v11, 26, v78
    v_lshl_or_b32 v11, v11, 4, v12
    s_mov_b64 exec, s[80:81]
    ds_add_rtn_u32 v88, v92, v6 offset:6144
    ds_add_u32 v11, v6 offset:12288
    s_mov_b64 exec, -1
    v_and_or_b32 v78, v78, s55, v64
    s_waitcnt vmcnt(3)
    v_lshrrev_b32 v93, 21, v82
    v_lshlrev_b32 v93, 2, v93
    v_lshrrev_b32 v11, 26, v82
    v_lshl_or_b32 v11, v11, 4, v12
    s_mov_b64 exec, s[82:83]
    ds_add_rtn_u32 v89, v93, v6 offset:6144
    ds_add_u32 v11, v6 offset:12288
    s_mov_b64 exec, -1
    v_and_or_b32 v82, v82, s55, v65
    s_waitcnt vmcnt(2)
    v_lshrrev_b32 v94, 21, v86
    v_lshlrev_b32 v94, 2, v94
    v_lshrrev_b32 v11, 26, v86
    v_lshl_or_b32 v11, v11, 4, v12
    s_mov_b64 exec, s[84:85]
    ds_add_rtn_u32 v90, v94, v6 offset:6144
    ds_add_u32 v11, v6 offset:12288
    s_mov_b64 exec, -1
    v_and_or_b32 v86, v86, s55, v66
    s_add_u32 m0, s52, 16384
    s_nop 0
    buffer_load_dwordx4 v70, s[28:31], 0 offen  lds
    s_add_u32 m0, s52, 24576
    s_nop 0
    buffer_load_dwordx4 v71, s[28:31], 0 offen  lds
    s_waitcnt lgkmcnt(0)
    s_barrier
    s_cmp_lg_u32 s48, 0
    s_cbranch_scc1 K2_rank2
    ds_read_b128 v[104:107], v2 offset:12288
    ds_read_b32 v203, v203 offset:37888
    ds_read_b32 v96, v15 offset:6144
    ds_read_b32 v97, v15 offset:6272
    ds_read_b32 v98, v15 offset:6400
    ds_read_b32 v99, v15 offset:6528
    ds_read_b32 v100, v15 offset:6656
    s_add_u32 s65, s61, 1
    s_add_u32 s66, s61, 2
    s_add_u32 s67, s61, 3
    s_add_u32 s68, s61, 4
    s_waitcnt lgkmcnt(6)
    v_add_u32 v9, v104, v105
    v_add3_u32 v9, v9, v106, v107
    v_lshl_or_b32 v9, v9, 6, v10
    s_nop 0
    v_readlane_b32 s64, v9, s61
    v_readlane_b32 s65, v9, s65
    v_readlane_b32 s66, v9, s66
    v_readlane_b32 s67, v9, s67
    v_readlane_b32 s68, v9, s68
    v_cmp_lt_u32 s[70:71], s64, v9
    v_cmp_lt_u32 s[72:73], s65, v9
    v_cmp_lt_u32 s[74:75], s66, v9
    v_cmp_lt_u32 s[76:77], s67, v9
    v_cmp_lt_u32 s[78:79], s68, v9
    s_bcnt1_i32_b64 s64, s[70:71]
    s_bcnt1_i32_b64 s65, s[72:73]
    s_bcnt1_i32_b64 s66, s[74:75]
    s_bcnt1_i32_b64 s67, s[76:77]
    s_bcnt1_i32_b64 s68, s[78:79]
    s_waitcnt lgkmcnt(0)
    v_readlane_b32 s36, v203, s64
    v_readlane_b32 s37, v203, s65
    v_readlane_b32 s38, v203, s66
    v_readlane_b32 s39, v203, s67
    v_readlane_b32 s62, v203, s68
K2_ranked:
    s_mov_b32 exec_hi, 0
    s_and_b32 s54, s36, 0x380
    v_add_u32 v104, s54, v14
    ds_add_rtn_u32 v96, v104, v96 offset:11264
    s_and_b32 s54, s37, 0x380
    v_add_u32 v105, s54, v14
    ds_add_rtn_u32 v97, v105, v97 offset:11264
    s_and_b32 s54, s38, 0x380
    v_add_u32 v106, s54, v14
    ds_add_rtn_u32 v98, v106, v98 offset:11264
    s_and_b32 s54, s39, 0x380
    v_add_u32 v107, s54, v14
    ds_add_rtn_u32 v99, v107, v99 offset:11264
    s_and_b32 s54, s62, 0x380
    v_add_u32 v108, s54, v14
    ds_add_rtn_u32 v100, v108, v100 offset:11264
    v_or_b32 v104, s36, v104
    v_or_b32 v105, s37, v105
    v_or_b32 v106, s38, v106
    v_or_b32 v107, s39, v107
    v_or_b32 v108, s62, v108
    s_waitcnt lgkmcnt(4)
    v_lshl_or_b32 v96, v96, 16, v104
    ds_write_b32 v15, v96 offset:6144
    s_waitcnt lgkmcnt(4)
    v_lshl_or_b32 v97, v97, 16, v105
    ds_write_b32 v15, v97 offset:6272
    s_waitcnt lgkmcnt(4)
    v_lshl_or_b32 v98, v98, 16, v106
    ds_write_b32 v15, v98 offset:6400
    s_waitcnt lgkmcnt(4)
    v_lshl_or_b32 v99, v99, 16, v107
    ds_write_b32 v15, v99 offset:6528
    s_waitcnt lgkmcnt(4)
    v_lshl_or_b32 v100, v100, 16, v108
    ds_write_b32 v15, v100 offset:6656
    v_writelane_b32 v11, s36, 0
    v_writelane_b32 v11, s37, 1
    v_writelane_b32 v11, s38, 2
    v_writelane_b32 v11, s39, 3
    v_writelane_b32 v11, s62, 4
    v_add_lshl_u32 v12, v1, s61, 7
    v_lshrrev_b32 v9, 10, v11
    v_bfe_u32 v11, v11, 2, 8
    v_or_b32 v11, v11, v9
    s_mov_b32 exec_lo, 31
    ds_write_b32 v11, v12 offset:13568
    s_mov_b64 exec, -1
    s_add_u32 m0, s52, 32768
    s_nop 0
    buffer_load_dwordx4 v72, s[28:31], 0 offen  lds
    s_add_u32 m0, s52, 40960
    s_nop 0
    buffer_load_dwordx4 v73, s[28:31], 0 offen  lds
    v_lshrrev_b32 v12, 3, v1
    v_mul_u32_u24 v12, 256, v12
    v_add_u32 v12, 73728, v12
    s_lshl_b32 s54, s3, 5
    v_add_u32 v11, s54, v8
    s_waitcnt lgkmcnt(0)
    s_barrier
    ds_read_b128 v[96:99], v2 offset:11264
    ds_read_b32 v92, v92 offset:6144
    ds_read_b32 v93, v93 offset:6144
    ds_read_b32 v94, v94 offset:6144
    ds_read_b32 v11, v11 offset:13568
    s_lshl_b32 s54, s3, 3
    s_add_u32 s55, s54, 7
    s_waitcnt lgkmcnt(4)
    v_add_u32 v9, v96, v97
    v_add3_u32 v9, v9, v98, v99
    v_mov_b32 v10, v9
    s_nop 1
    v_add_u32_dpp v10, v10, v10 row_shr:1 row_mask:0xf bank_mask:0xf
    s_nop 1
    v_add_u32_dpp v10, v10, v10 row_shr:2 row_mask:0xf bank_mask:0xf
    s_nop 1
    v_add_u32_dpp v10, v10, v10 row_shr:4 row_mask:0xf bank_mask:0xf
    s_nop 1
    v_add_u32_dpp v10, v10, v10 row_shr:8 row_mask:0xf bank_mask:0xf
    s_nop 1
    v_add_u32_dpp v10, v10, v10 row_bcast:15 row_mask:0xa bank_mask:0xf
    s_nop 1
    v_add_u32_dpp v10, v10, v10 row_bcast:31 row_mask:0xc bank_mask:0xf
    v_sub_u32 v9, v10, v9
    v_lshl_add_u32 v104, v9, 4, v12
    v_lshl_add_u32 v105, v96, 4, v104
    v_lshl_add_u32 v106, v97, 4, v105
    v_lshl_add_u32 v107, v98, 4, v106
    ds_write_b128 v2, v[104:107] offset:14336
    s_waitcnt lgkmcnt(2)
    v_and_b32 v64, 0x3ff, v92
    ds_read_b32 v64, v64 offset:14336
    v_and_b32 v65, 0x3ff, v93
    ds_read_b32 v65, v65 offset:14336
    v_and_b32 v66, 0x3ff, v94
    ds_read_b32 v66, v66 offset:14336
    v_readlane_b32 s50, v10, s55
    v_readlane_b32 s53, v9, s54
    v_readlane_b32 s51, v104, s54
    v_bfe_u32 v15, v92, 12, 3
    v_or_b32 v78, v15, v78
    v_lshrrev_b32 v92, 16, v92
    v_add_u32 v92, v92, v88
    v_bfe_u32 v15, v93, 12, 3
    v_or_b32 v82, v15, v82
    v_lshrrev_b32 v93, 16, v93
    v_add_u32 v93, v93, v89
    v_bfe_u32 v15, v94, 12, 3
    v_or_b32 v86, v15, v86
    v_lshrrev_b32 v94, 16, v94
    v_add_u32 v94, v94, v90
    s_sub_u32 s50, s50, s53
    s_lshl_b32 s54, s50, 4
    v_add_u32 v198, s51, v201
    v_add_u32 v199, s51, v202
    s_waitcnt lgkmcnt(2)
    v_lshl_add_u32 v92, v92, 4, v64
    s_mov_b64 exec, s[80:81]
    ds_write_b96 v92, v[76:78]
    s_mov_b64 exec, -1
    s_waitcnt lgkmcnt(2)
    v_lshl_add_u32 v93, v93, 4, v65
    s_mov_b64 exec, s[82:83]
    ds_write_b96 v93, v[80:82]
    s_mov_b64 exec, -1
    s_waitcnt lgkmcnt(2)
    v_lshl_add_u32 v94, v94, 4, v66
    s_mov_b64 exec, s[84:85]
    ds_write_b96 v94, v[84:86]
    s_mov_b64 exec, -1
    v_add_u32 v9, s54, v198
    v_mov_b32 v12, 2097029
    ds_write_b32 v9, v12
    v_readlane_b32 s56, v11, 0
    v_readlane_b32 s57, v11, 1
    v_readlane_b32 s58, v11, 2
    v_readlane_b32 s59, v11, 3
    v_readlane_b32 s60, v11, 4
    s_waitcnt lgkmcnt(0)
    s_barrier
    ds_read_b32 v196, v198
    ds_read_b32 v197, v198 offset:96
    ds_read_b128 v[192:195], v199
    s_mov_b32 s55, 0x00fffc38
    s_waitcnt lgkmcnt(2)
    v_lshlrev_b32 v196, 3, v196
    v_and_b32 v196, s55, v196
    s_nop 0
    v_readlane_b32 s64, v196, 0
    v_readlane_b32 s65, v196, 1
    v_readlane_b32 s66, v196, 2
    v_readlane_b32 s67, v196, 3
    v_readlane_b32 s68, v196, 4
    v_readlane_b32 s69, v196, 5
    ds_read_b128 v[172:175], v2 offset:32768
    ds_read_b128 v[176:179], v2 offset:33792
    ds_read_b128 v[180:183], v2 offset:34816
    ds_read_b128 v[184:187], v2 offset:35840
    ds_read_b128 v[188:191], v2 offset:36864
    s_and_b32 s61, s64, 0xffffff00
    buffer_load_dwordx4 v[96:99], v2, s[16:19], s61 offen
    s_and_b32 s61, s65, 0xffffff00
    buffer_load_dwordx4 v[100:103], v2, s[16:19], s61 offen
    s_and_b32 s61, s66, 0xffffff00
    buffer_load_dwordx4 v[104:107], v2, s[16:19], s61 offen
    s_and_b32 s61, s67, 0xffffff00
    buffer_load_dwordx4 v[108:111], v2, s[16:19], s61 offen
    s_and_b32 s61, s68, 0xffffff00
    buffer_load_dwordx4 v[112:115], v2, s[16:19], s61 offen
    s_and_b32 s61, s69, 0xffffff00
    buffer_load_dwordx4 v[116:119], v2, s[16:19], s61 offen
    s_waitcnt vmcnt(6) lgkmcnt(0)
    s_barrier
    s_cmp_eq_u32 s50, 0
    s_cbranch_scc1 K2_swept
    v_lshrrev_b32 v8, 21, v194
    v_lshl_add_u32 v8, v8, 5, v200
    s_mov_b64 exec, s[86:87]
    ds_read_b128 v[164:167], v8
    s_mov_b64 exec, s[88:89]
    ds_read_b128 v[168:171], v8
    s_mov_b64 exec, -1
    s_mov_b32 s53, s50
.p2align 3
K2_loop:
    s_waitcnt lgkmcnt(0)
    v_mfma_f32_4x4x4_16b_bf16 v[144:147], v[192:193], v[188:189], 0 cbsz:4 abid:0
    v_mfma_f32_4x4x4_16b_bf16 v[148:151], v[192:193], v[188:189], 0 cbsz:4 abid:2
    v_mfma_f32_4x4x4_16b_bf16 v[152:155], v[192:193], v[188:189], 0 cbsz:4 abid:4
    v_mfma_f32_4x4x4_16b_bf16 v[156:159], v[192:193], v[188:189], 0 cbsz:4 abid:6
    v_mfma_f32_32x32x16_bf16 v[64:79], v[164:167], v[172:175], 0
    v_lshlrev_b32 v196, 3, v197
    v_and_b32 v196, s55, v196
    v_add_u32 v198, 256, v198
    v_mfma_f32_32x32x16_bf16 v[80:95], v[164:167], v[180:183], 0
    v_add_u32 v199, 256, v199
    ds_read_b32 v197, v198 offset:96
    ds_read_b128 v[192:195], v199
    v_mfma_f32_32x32x16_bf16 v[64:79], v[168:171], v[176:179], v[64:79]
    v_cvt_pk_bf16_f32 v9, v144, v144
    v_and_b32 v160, v190, v9
    v_and_b32 v161, v191, v9
    v_mfma_f32_32x32x16_bf16 v[80:95], v[168:171], v[184:187], v[80:95]
    s_waitcnt vmcnt(5)
    v_mfma_f32_16x16x16_bf16 v[128:131], v[160:161], v[96:97], 0
    v_readlane_b32 s70, v196, 0
    v_cvt_pk_bf16_f32 v10, v145, v145
    v_mfma_f32_16x16x16_bf16 v[132:135], v[160:161], v[98:99], 0
    v_and_b32 v162, v190, v10
    v_and_b32 v163, v191, v10
    s_and_b32 s61, s70, 0xffffff00
    buffer_load_dwordx4 v[120:123], v2, s[16:19], s61 offen
    s_waitcnt vmcnt(5)
    v_mfma_f32_16x16x16_bf16 v[136:139], v[162:163], v[100:101], 0
    v_readlane_b32 s71, v196, 1
    v_cvt_pk_bf16_f32 v9, v146, v146
    v_mfma_f32_16x16x16_bf16 v[140:143], v[162:163], v[102:103], 0
    v_and_b32 v160, v190, v9
    v_and_b32 v161, v191, v9
    s_and_b32 s61, s71, 0xffffff00
    buffer_load_dwordx4 v[124:127], v2, s[16:19], s61 offen
    s_set_gpr_idx_on s64, gpr_idx(SRC2,DST)
    v_pk_fma_f32 v[16:17], v[128:129], v[64:65], v[16:17] op_sel_hi:[1,0,1]
    v_pk_fma_f32 v[18:19], v[130:131], v[64:65], v[18:19] op_sel_hi:[1,0,1]
    v_pk_fma_f32 v[20:21], v[132:133], v[80:81], v[20:21] op_sel_hi:[1,0,1]
    v_pk_fma_f32 v[22:23], v[134:135], v[80:81], v[22:23] op_sel_hi:[1,0,1]
    s_set_gpr_idx_off
    s_waitcnt vmcnt(5)
    v_mfma_f32_16x16x16_bf16 v[128:131], v[160:161], v[104:105], 0
    v_readlane_b32 s72, v196, 2
    v_cvt_pk_bf16_f32 v10, v147, v147
    v_mfma_f32_16x16x16_bf16 v[132:135], v[160:161], v[106:107], 0
    v_and_b32 v162, v190, v10
    v_and_b32 v163, v191, v10
    s_and_b32 s61, s72, 0xffffff00
    buffer_load_dwordx4 v[96:99], v2, s[16:19], s61 offen
    s_waitcnt lgkmcnt(0)
    v_lshrrev_b32 v8, 21, v194
    v_lshl_add_u32 v8, v8, 5, v200
    s_mov_b64 exec, s[86:87]
    ds_read_b128 v[164:167], v8
    s_mov_b64 exec, s[88:89]
    ds_read_b128 v[168:171], v8
    s_mov_b64 exec, -1
    s_set_gpr_idx_on s65, gpr_idx(SRC2,DST)
    v_pk_fma_f32 v[16:17], v[136:137], v[64:65], v[16:17] op_sel:[0,1,0] op_sel_hi:[1,1,1]
    v_pk_fma_f32 v[18:19], v[138:139], v[64:65], v[18:19] op_sel:[0,1,0] op_sel_hi:[1,1,1]
    v_pk_fma_f32 v[20:21], v[140:141], v[80:81], v[20:21] op_sel:[0,1,0] op_sel_hi:[1,1,1]
    v_pk_fma_f32 v[22:23], v[142:143], v[80:81], v[22:23] op_sel:[0,1,0] op_sel_hi:[1,1,1]
    s_set_gpr_idx_off
    s_waitcnt vmcnt(5)
    v_mfma_f32_16x16x16_bf16 v[136:139], v[162:163], v[108:109], 0
    v_readlane_b32 s73, v196, 3
    v_cvt_pk_bf16_f32 v9, v148, v148
    v_mfma_f32_16x16x16_bf16 v[140:143], v[162:163], v[110:111], 0
    v_and_b32 v160, v190, v9
    v_and_b32 v161, v191, v9
    s_and_b32 s61, s73, 0xffffff00
    buffer_load_dwordx4 v[100:103], v2, s[16:19], s61 offen
    s_set_gpr_idx_on s66, gpr_idx(SRC2,DST)
    v_pk_fma_f32 v[16:17], v[128:129], v[66:67], v[16:17] op_sel_hi:[1,0,1]
    v_pk_fma_f32 v[18:19], v[130:131], v[66:67], v[18:19] op_sel_hi:[1,0,1]
    v_pk_fma_f32 v[20:21], v[132:133], v[82:83], v[20:21] op_sel_hi:[1,0,1]
    v_pk_fma_f32 v[22:23], v[134:135], v[82:83], v[22:23] op_sel_hi:[1,0,1]
    s_set_gpr_idx_off
    s_waitcnt vmcnt(5)
    v_mfma_f32_16x16x16_bf16 v[128:131], v[160:161], v[112:113], 0
    v_readlane_b32 s74, v196, 4
    v_cvt_pk_bf16_f32 v10, v149, v149
    v_mfma_f32_16x16x16_bf16 v[132:135], v[160:161], v[114:115], 0
    v_and_b32 v162, v190, v10
    v_and_b32 v163, v191, v10
    s_and_b32 s61, s74, 0xffffff00
    buffer_load_dwordx4 v[104:107], v2, s[16:19], s61 offen
    s_set_gpr_idx_on s67, gpr_idx(SRC2,DST)
    v_pk_fma_f32 v[16:17], v[136:137], v[66:67], v[16:17] op_sel:[0,1,0] op_sel_hi:[1,1,1]
    v_pk_fma_f32 v[18:19], v[138:139], v[66:67], v[18:19] op_sel:[0,1,0] op_sel_hi:[1,1,1]
    v_pk_fma_f32 v[20:21], v[140:141], v[82:83], v[20:21] op_sel:[0,1,0] op_sel_hi:[1,1,1]
    v_pk_fma_f32 v[22:23], v[142:143], v[82:83], v[22:23] op_sel:[0,1,0] op_sel_hi:[1,1,1]
    s_set_gpr_idx_off
    s_cmp_le_u32 s53, 4
    s_cbranch_scc1 K2_swept
    s_waitcnt vmcnt(5)
    v_mfma_f32_16x16x16_bf16 v[136:139], v[162:163], v[116:117], 0
    v_readlane_b32 s75, v196, 5
    v_cvt_pk_bf16_f32 v9, v150, v150
    v_mfma_f32_16x16x16_bf16 v[140:143], v[162:163], v[118:119], 0
    v_and_b32 v160, v190, v9
    v_and_b32 v161, v191, v9
    s_and_b32 s61, s75, 0xffffff00
    buffer_load_dwordx4 v[108:111], v2, s[16:19], s61 offen
    s_set_gpr_idx_on s68, gpr_idx(SRC2,DST)
    v_pk_fma_f32 v[16:17], v[128:129], v[68:69], v[16:17] op_sel_hi:[1,0,1]
    v_pk_fma_f32 v[18:19], v[130:131], v[68:69], v[18:19] op_sel_hi:[1,0,1]
    v_pk_fma_f32 v[20:21], v[132:133], v[84:85], v[20:21] op_sel_hi:[1,0,1]
    v_pk_fma_f32 v[22:23], v[134:135], v[84:85], v[22:23] op_sel_hi:[1,0,1]
    s_set_gpr_idx_off
    s_waitcnt vmcnt(5)
    v_mfma_f32_16x16x16_bf16 v[128:131], v[160:161], v[120:121], 0
    v_readlane_b32 s76, v196, 6
    v_cvt_pk_bf16_f32 v10, v151, v151
    v_mfma_f32_16x16x16_bf16 v[132:135], v[160:161], v[122:123], 0
    v_and_b32 v162, v190, v10
    v_and_b32 v163, v191, v10
    s_and_b32 s61, s76, 0xffffff00
    buffer_load_dwordx4 v[112:115], v2, s[16:19], s61 offen
    s_set_gpr_idx_on s69, gpr_idx(SRC2,DST)
    v_pk_fma_f32 v[16:17], v[136:137], v[68:69], v[16:17] op_sel:[0,1,0] op_sel_hi:[1,1,1]
    v_pk_fma_f32 v[18:19], v[138:139], v[68:69], v[18:19] op_sel:[0,1,0] op_sel_hi:[1,1,1]
    v_pk_fma_f32 v[20:21], v[140:141], v[84:85], v[20:21] op_sel:[0,1,0] op_sel_hi:[1,1,1]
    v_pk_fma_f32 v[22:23], v[142:143], v[84:85], v[22:23] op_sel:[0,1,0] op_sel_hi:[1,1,1]
    s_set_gpr_idx_off
    s_waitcnt vmcnt(5)
    v_mfma_f32_16x16x16_bf16 v[136:139], v[162:163], v[124:125], 0
    v_readlane_b32 s77, v196, 7
    v_cvt_pk_bf16_f32 v9, v152, v152
    v_mfma_f32_16x16x16_bf16 v[140:143], v[162:163], v[126:127], 0
    v_and_b32 v160, v190, v9
    v_and_b32 v161, v191, v9
    s_and_b32 s61, s77, 0xffffff00
    buffer_load_dwordx4 v[116:119], v2, s[16:19], s61 offen
    s_set_gpr_idx_on s70, gpr_idx(SRC2,DST)
    v_pk_fma_f32 v[16:17], v[128:129], v[70:71], v[16:17] op_sel_hi:[1,0,1]
    v_pk_fma_f32 v[18:19], v[130:131], v[70:71], v[18:19] op_sel_hi:[1,0,1]
    v_pk_fma_f32 v[20:21], v[132:133], v[86:87], v[20:21] op_sel_hi:[1,0,1]
    v_pk_fma_f32 v[22:23], v[134:135], v[86:87], v[22:23] op_sel_hi:[1,0,1]
    s_set_gpr_idx_off
    s_waitcnt vmcnt(5)
    v_mfma_f32_16x16x16_bf16 v[128:131], v[160:161], v[96:97], 0
    v_readlane_b32 s78, v196, 8
    v_cvt_pk_bf16_f32 v10, v153, v153
    v_mfma_f32_16x16x16_bf16 v[132:135], v[160:161], v[98:99], 0
    v_and_b32 v162, v190, v10
    v_and_b32 v163, v191, v10
    s_and_b32 s61, s78, 0xffffff00
    buffer_load_dwordx4 v[120:123], v2, s[16:19], s61 offen
    s_set_gpr_idx_on s71, gpr_idx(SRC2,DST)
    v_pk_fma_f32 v[16:17], v[136:137], v[70:71], v[16:17] op_sel:[0,1,0] op_sel_hi:[1,1,1]
    v_pk_fma_f32 v[18:19], v[138:139], v[70:71], v[18:19] op_sel:[0,1,0] op_sel_hi:[1,1,1]
    v_pk_fma_f32 v[20:21], v[140:141], v[86:87], v[20:21] op_sel:[0,1,0] op_sel_hi:[1,1,1]
    v_pk_fma_f32 v[22:23], v[142:143], v[86:87], v[22:23] op_sel:[0,1,0] op_sel_hi:[1,1,1]
    s_set_gpr_idx_off
    s_cmp_le_u32 s53, 8
    s_cbranch_scc1 K2_swept
    s_waitcnt vmcnt(5)
    v_mfma_f32_16x16x16_bf16 v[136:139], v[162:163], v[100:101], 0
    v_readlane_b32 s79, v196, 9
    v_cvt_pk_bf16_f32 v9, v154, v154
    v_mfma_f32_16x16x16_bf16 v[140:143], v[162:163], v[102:103], 0
    v_and_b32 v160, v190, v9
    v_and_b32 v161, v191, v9
    s_and_b32 s61, s79, 0xffffff00
    buffer_load_dwordx4 v[124:127], v2, s[16:19], s61 offen
    s_set_gpr_idx_on s72, gpr_idx(SRC2,DST)
    v_pk_fma_f32 v[16:17], v[128:129], v[72:73], v[16:17] op_sel_hi:[1,0,1]
    v_pk_fma_f32 v[18:19], v[130:131], v[72:73], v[18:19] op_sel_hi:[1,0,1]
    v_pk_fma_f32 v[20:21], v[132:133], v[88:89], v[20:21] op_sel_hi:[1,0,1]
    v_pk_fma_f32 v[22:23], v[134:135], v[88:89], v[22:23] op_sel_hi:[1,0,1]
    s_set_gpr_idx_off
    s_waitcnt vmcnt(5)
    v_mfma_f32_16x16x16_bf16 v[128:131], v[160:161], v[104:105], 0
    v_readlane_b32 s64, v196, 10
    v_cvt_pk_bf16_f32 v10, v155, v155
    v_mfma_f32_16x16x16_bf16 v[132:135], v[160:161], v[106:107], 0
    v_and_b32 v162, v190, v10
    v_and_b32 v163, v191, v10
    s_and_b32 s61, s64, 0xffffff00
    buffer_load_dwordx4 v[96:99], v2, s[16:19], s61 offen
    s_set_gpr_idx_on s73, gpr_idx(SRC2,DST)
    v_pk_fma_f32 v[16:17], v[136:137], v[72:73], v[16:17] op_sel:[0,1,0] op_sel_hi:[1,1,1]
    v_pk_fma_f32 v[18:19], v[138:139], v[72:73], v[18:19] op_sel:[0,1,0] op_sel_hi:[1,1,1]
    v_pk_fma_f32 v[20:21], v[140:141], v[88:89], v[20:21] op_sel:[0,1,0] op_sel_hi:[1,1,1]
    v_pk_fma_f32 v[22:23], v[142:143], v[88:89], v[22:23] op_sel:[0,1,0] op_sel_hi:[1,1,1]
    s_set_gpr_idx_off
    s_waitcnt vmcnt(5)
    v_mfma_f32_16x16x16_bf16 v[136:139], v[162:163], v[108:109], 0
    v_readlane_b32 s65, v196, 11
    v_cvt_pk_bf16_f32 v9, v156, v156
    v_mfma_f32_16x16x16_bf16 v[140:143], v[162:163], v[110:111], 0
    v_and_b32 v160, v190, v9
    v_and_b32 v161, v191, v9
    s_and_b32 s61, s65, 0xffffff00
    buffer_load_dwordx4 v[100:103], v2, s[16:19], s61 offen
    s_set_gpr_idx_on s74, gpr_idx(SRC2,DST)
    v_pk_fma_f32 v[16:17], v[128:129], v[74:75], v[16:17] op_sel_hi:[1,0,1]
    v_pk_fma_f32 v[18:19], v[130:131], v[74:75], v[18:19] op_sel_hi:[1,0,1]
    v_pk_fma_f32 v[20:21], v[132:133], v[90:91], v[20:21] op_sel_hi:[1,0,1]
    v_pk_fma_f32 v[22:23], v[134:135], v[90:91], v[22:23] op_sel_hi:[1,0,1]
    s_set_gpr_idx_off
    s_waitcnt vmcnt(5)
    v_mfma_f32_16x16x16_bf16 v[128:131], v[160:161], v[112:113], 0
    v_readlane_b32 s66, v196, 12
    v_cvt_pk_bf16_f32 v10, v157, v157
    v_mfma_f32_16x16x16_bf16 v[132:135], v[160:161], v[114:115], 0
    v_and_b32 v162, v190, v10
    v_and_b32 v163, v191, v10
    s_and_b32 s61, s66, 0xffffff00
    buffer_load_dwordx4 v[104:107], v2, s[16:19], s61 offen
    s_set_gpr_idx_on s75, gpr_idx(SRC2,DST)
    v_pk_fma_f32 v[16:17], v[136:137], v[74:75], v[16:17] op_sel:[0,1,0] op_sel_hi:[1,1,1]
    v_pk_fma_f32 v[18:19], v[138:139], v[74:75], v[18:19] op_sel:[0,1,0] op_sel_hi:[1,1,1]
    v_pk_fma_f32 v[20:21], v[140:141], v[90:91], v[20:21] op_sel:[0,1,0] op_sel_hi:[1,1,1]
    v_pk_fma_f32 v[22:23], v[142:143], v[90:91], v[22:23] op_sel:[0,1,0] op_sel_hi:[1,1,1]
    s_set_gpr_idx_off
    s_cmp_le_u32 s53, 12
    s_cbranch_scc1 K2_swept
    s_waitcnt vmcnt(5)
    v_mfma_f32_16x16x16_bf16 v[136:139], v[162:163], v[116:117], 0
    v_readlane_b32 s67, v196, 13
    v_cvt_pk_bf16_f32 v9, v158, v158
    v_mfma_f32_16x16x16_bf16 v[140:143], v[162:163], v[118:119], 0
    v_and_b32 v160, v190, v9
    v_and_b32 v161, v191, v9
    s_and_b32 s61, s67, 0xffffff00
    buffer_load_dwordx4 v[108:111], v2, s[16:19], s61 offen
    s_set_gpr_idx_on s76, gpr_idx(SRC2,DST)
    v_pk_fma_f32 v[16:17], v[128:129], v[76:77], v[16:17] op_sel_hi:[1,0,1]
    v_pk_fma_f32 v[18:19], v[130:131], v[76:77], v[18:19] op_sel_hi:[1,0,1]
    v_pk_fma_f32 v[20:21], v[132:133], v[92:93], v[20:21] op_sel_hi:[1,0,1]
    v_pk_fma_f32 v[22:23], v[134:135], v[92:93], v[22:23] op_sel_hi:[1,0,1]
    s_set_gpr_idx_off
    s_waitcnt vmcnt(5)
    v_mfma_f32_16x16x16_bf16 v[128:131], v[160:161], v[120:121], 0
    v_readlane_b32 s68, v196, 14
    v_cvt_pk_bf16_f32 v10, v159, v159
    v_mfma_f32_16x16x16_bf16 v[132:135], v[160:161], v[122:123], 0
    v_and_b32 v162, v190, v10
    v_and_b32 v163, v191, v10
    s_and_b32 s61, s68, 0xffffff00
    buffer_load_dwordx4 v[112:115], v2, s[16:19], s61 offen
    s_set_gpr_idx_on s77, gpr_idx(SRC2,DST)
    v_pk_fma_f32 v[16:17], v[136:137], v[76:77], v[16:17] op_sel:[0,1,0] op_sel_hi:[1,1,1]
    v_pk_fma_f32 v[18:19], v[138:139], v[76:77], v[18:19] op_sel:[0,1,0] op_sel_hi:[1,1,1]
    v_pk_fma_f32 v[20:21], v[140:141], v[92:93], v[20:21] op_sel:[0,1,0] op_sel_hi:[1,1,1]
    v_pk_fma_f32 v[22:23], v[142:143], v[92:93], v[22:23] op_sel:[0,1,0] op_sel_hi:[1,1,1]
    s_set_gpr_idx_off
    s_waitcnt vmcnt(5)
    v_mfma_f32_16x16x16_bf16 v[136:139], v[162:163], v[124:125], 0
    v_readlane_b32 s69, v196, 15
    v_mfma_f32_16x16x16_bf16 v[140:143], v[162:163], v[126:127], 0
    s_and_b32 s61, s69, 0xffffff00
    buffer_load_dwordx4 v[116:119], v2, s[16:19], s61 offen
    s_set_gpr_idx_on s78, gpr_idx(SRC2,DST)
    v_pk_fma_f32 v[16:17], v[128:129], v[78:79], v[16:17] op_sel_hi:[1,0,1]
    v_pk_fma_f32 v[18:19], v[130:131], v[78:79], v[18:19] op_sel_hi:[1,0,1]
    v_pk_fma_f32 v[20:21], v[132:133], v[94:95], v[20:21] op_sel_hi:[1,0,1]
    v_pk_fma_f32 v[22:23], v[134:135], v[94:95], v[22:23] op_sel_hi:[1,0,1]
    s_set_gpr_idx_off
    s_set_gpr_idx_on s79, gpr_idx(SRC2,DST)
    v_pk_fma_f32 v[16:17], v[136:137], v[78:79], v[16:17] op_sel:[0,1,0] op_sel_hi:[1,1,1]
    v_pk_fma_f32 v[18:19], v[138:139], v[78:79], v[18:19] op_sel:[0,1,0] op_sel_hi:[1,1,1]
    v_pk_fma_f32 v[20:21], v[140:141], v[94:95], v[20:21] op_sel:[0,1,0] op_sel_hi:[1,1,1]
    v_pk_fma_f32 v[22:23], v[142:143], v[94:95], v[22:23] op_sel:[0,1,0] op_sel_hi:[1,1,1]
    s_set_gpr_idx_off
    s_sub_i32 s53, s53, 16
    s_cmp_gt_i32 s53, 0
    s_cbranch_scc1 K2_loop
K2_swept:
    s_nop 7
    s_add_u32 s48, s48, 1536
    s_cmp_ge_u32 s48, s47
    s_cbranch_scc1 K2_epi
    s_waitcnt vmcnt(0) lgkmcnt(0)
    s_barrier
    v_lshlrev_b32 v11, 2, v0
    v_mov_b32 v12, 0x00700000
    v_mov_b32 v13, 0
    ds_write_b32 v11, v12 offset:0
    ds_write_b32 v11, v12 offset:2048
    ds_write_b32 v11, v12 offset:4096
    ds_write_b32 v11, v13 offset:6144
    ds_write_b32 v11, v13 offset:8192
    ds_write_b32 v11, v13 offset:10240
    s_waitcnt lgkmcnt(0)
    s_barrier
    s_branch K2_round
K2_map2:
    v_add_u32 v8, 56, v8
    v_subrev_u32 v10, 14, v10
    s_branch K2_map
K2_rank2:
    ds_read_b32 v96, v15 offset:6144
    ds_read_b32 v97, v15 offset:6272
    ds_read_b32 v98, v15 offset:6400
    ds_read_b32 v99, v15 offset:6528
    ds_read_b32 v100, v15 offset:6656
    s_waitcnt lgkmcnt(0)
    s_branch K2_ranked
K2_epi:
    s_and_b32 s54, s3, 3
    s_lshl_b32 s54, s54, 13
    s_add_u32 s54, s54, 40960
    v_add_u32 v9, s54, v2
    s_waitcnt lgkmcnt(0)
    ds_read_b128 v[172:175], v9 offset:0
    ds_read_b128 v[176:179], v9 offset:1024
    ds_read_b128 v[180:183], v9 offset:2048
    ds_read_b128 v[184:187], v9 offset:3072
    ds_read_b128 v[188:191], v9 offset:4096
    ds_read_b128 v[192:195], v9 offset:5120
    ds_read_b128 v[196:199], v9 offset:6144
    ds_read_b128 v[200:203], v9 offset:7168
    s_lshl_b32 s54, s45, 10
    s_add_u32 s40, s12, s54
    s_addc_u32 s41, s13, 0
    s_lshl_b32 s42, s46, 10
    s_mov_b32 s43, 0x20000
    v_lshlrev_b32 v8, 2, v1
    s_lshr_b32 s54, s56, 1
    s_and_b32 s54, s54, 0xc0
    s_lshl_b32 s55, s56, 3
    s_or_b32 s54, s54, s55
    s_xor_b32 s55, s54, 0
    v_cvt_pk_bf16_f32 v64, v16, v20
    v_xor_b32 v68, s55, v8
    ds_write_b32 v68, v64 offset:0
    s_xor_b32 s55, s54, 16
    v_cvt_pk_bf16_f32 v65, v17, v21
    v_xor_b32 v69, s55, v8
    ds_write_b32 v69, v65 offset:256
    s_xor_b32 s55, s54, 32
    v_cvt_pk_bf16_f32 v66, v18, v22
    v_xor_b32 v70, s55, v8
    ds_write_b32 v70, v66 offset:512
    s_xor_b32 s55, s54, 48
    v_cvt_pk_bf16_f32 v67, v19, v23
    v_xor_b32 v71, s55, v8
    ds_write_b32 v71, v67 offset:768
    s_lshr_b32 s54, s57, 1
    s_and_b32 s54, s54, 0xc0
    s_lshl_b32 s55, s57, 3
    s_or_b32 s54, s54, s55
    s_xor_b32 s55, s54, 0
    v_cvt_pk_bf16_f32 v72, v24, v28
    v_xor_b32 v76, s55, v8
    ds_write_b32 v76, v72 offset:0
    s_xor_b32 s55, s54, 16
    v_cvt_pk_bf16_f32 v73, v25, v29
    v_xor_b32 v77, s55, v8
    ds_write_b32 v77, v73 offset:256
    s_xor_b32 s55, s54, 32
    v_cvt_pk_bf16_f32 v74, v26, v30
    v_xor_b32 v78, s55, v8
    ds_write_b32 v78, v74 offset:512
    s_xor_b32 s55, s54, 48
    v_cvt_pk_bf16_f32 v75, v27, v31
    v_xor_b32 v79, s55, v8
    ds_write_b32 v79, v75 offset:768
    s_lshr_b32 s54, s58, 1
    s_and_b32 s54, s54, 0xc0
    s_lshl_b32 s55, s58, 3
    s_or_b32 s54, s54, s55
    s_xor_b32 s55, s54, 0
    v_cvt_pk_bf16_f32 v80, v32, v36
    v_xor_b32 v84, s55, v8
    ds_write_b32 v84, v80 offset:0
    s_xor_b32 s55, s54, 16
    v_cvt_pk_bf16_f32 v81, v33, v37
    v_xor_b32 v85, s55, v8
    ds_write_b32 v85, v81 offset:256
    s_xor_b32 s55, s54, 32
    v_cvt_pk_bf16_f32 v82, v34, v38
    v_xor_b32 v86, s55, v8
    ds_write_b32 v86, v82 offset:512
    s_xor_b32 s55, s54, 48
    v_cvt_pk_bf16_f32 v83, v35, v39
    v_xor_b32 v87, s55, v8
    ds_write_b32 v87, v83 offset:768
    s_lshr_b32 s54, s59, 1
    s_and_b32 s54, s54, 0xc0
    s_lshl_b32 s55, s59, 3
    s_or_b32 s54, s54, s55
    s_xor_b32 s55, s54, 0
    v_cvt_pk_bf16_f32 v88, v40, v44
    v_xor_b32 v92, s55, v8
    ds_write_b32 v92, v88 offset:0
    s_xor_b32 s55, s54, 16
    v_cvt_pk_bf16_f32 v89, v41, v45
    v_xor_b32 v93, s55, v8
    ds_write_b32 v93, v89 offset:256
    s_xor_b32 s55, s54, 32
    v_cvt_pk_bf16_f32 v90, v42, v46
    v_xor_b32 v94, s55, v8
    ds_write_b32 v94, v90 offset:512
    s_xor_b32 s55, s54, 48
    v_cvt_pk_bf16_f32 v91, v43, v47
    v_xor_b32 v95, s55, v8
    ds_write_b32 v95, v91 offset:768
    s_lshr_b32 s54, s60, 1
    s_and_b32 s54, s54, 0xc0
    s_lshl_b32 s55, s60, 3
    s_or_b32 s54, s54, s55
    s_xor_b32 s55, s54, 0
    v_cvt_pk_bf16_f32 v64, v48, v52
    v_xor_b32 v68, s55, v8
    ds_write_b32 v68, v64 offset:0
    s_xor_b32 s55, s54, 16
    v_cvt_pk_bf16_f32 v65, v49, v53
    v_xor_b32 v69, s55, v8
    ds_write_b32 v69, v65 offset:256
    s_xor_b32 s55, s54, 32
    v_cvt_pk_bf16_f32 v66, v50, v54
    v_xor_b32 v70, s55, v8
    ds_write_b32 v70, v66 offset:512
    s_xor_b32 s55, s54, 48
    v_cvt_pk_bf16_f32 v67, v51, v55
    v_xor_b32 v71, s55, v8
    ds_write_b32 v71, v67 offset:768
    v_and_b32 v8, 15, v1
    v_lshrrev_b32 v9, 4, v1
    v_xor_b32 v10, v8, v9
    v_lshlrev_b32 v10, 4, v10
    v_lshl_add_u32 v10, v8, 8, v10
    s_lshr_b32 s54, s3, 2
    s_mul_i32 s54, s54, 20480
    v_add_u32 v10, s54, v10
    v_xor_b32 v11, 64, v10
    v_xor_b32 v12, 128, v10
    v_xor_b32 v13, 192, v10
    v_lshlrev_b32 v9, 10, v9
    v_lshl_add_u32 v9, v8, 2, v9
    s_and_b32 s55, s3, 3
    s_lshl_b32 s55, s55, 6
    s_add_u32 s54, s54, s55
    s_waitcnt vmcnt(0) lgkmcnt(0)
    s_barrier
    ds_read_b128 v[16:19], v10 offset:0
    ds_read_b128 v[20:23], v11 offset:0
    ds_read_b128 v[24:27], v12 offset:0
    ds_read_b128 v[28:31], v13 offset:0
    ds_read_b128 v[32:35], v10 offset:4096
    ds_read_b128 v[36:39], v11 offset:4096
    ds_read_b128 v[40:43], v12 offset:4096
    ds_read_b128 v[44:47], v13 offset:4096
    ds_read_b128 v[48:51], v10 offset:8192
    ds_read_b128 v[52:55], v11 offset:8192
    ds_read_b128 v[56:59], v12 offset:8192
    ds_read_b128 v[60:63], v13 offset:8192
    ds_read_b128 v[64:67], v10 offset:12288
    ds_read_b128 v[68:71], v11 offset:12288
    ds_read_b128 v[72:75], v12 offset:12288
    ds_read_b128 v[76:79], v13 offset:12288
    ds_read_b128 v[80:83], v10 offset:16384
    ds_read_b128 v[84:87], v11 offset:16384
    ds_read_b128 v[88:91], v12 offset:16384
    ds_read_b128 v[92:95], v13 offset:16384
    s_waitcnt lgkmcnt(15)
    v_mfma_f32_16x16x32_bf16 v[128:131], v[16:19], v[172:175], 0
    v_mfma_f32_16x16x32_bf16 v[132:135], v[16:19], v[176:179], 0
    v_mfma_f32_16x16x32_bf16 v[128:131], v[20:23], v[180:183], v[128:131]
    v_mfma_f32_16x16x32_bf16 v[132:135], v[20:23], v[184:187], v[132:135]
    v_mfma_f32_16x16x32_bf16 v[128:131], v[24:27], v[188:191], v[128:131]
    v_mfma_f32_16x16x32_bf16 v[132:135], v[24:27], v[192:195], v[132:135]
    v_mfma_f32_16x16x32_bf16 v[128:131], v[28:31], v[196:199], v[128:131]
    v_mfma_f32_16x16x32_bf16 v[132:135], v[28:31], v[200:203], v[132:135]
    s_waitcnt lgkmcnt(12)
    v_mfma_f32_16x16x32_bf16 v[136:139], v[32:35], v[172:175], 0
    v_mfma_f32_16x16x32_bf16 v[140:143], v[32:35], v[176:179], 0
    v_mfma_f32_16x16x32_bf16 v[136:139], v[36:39], v[180:183], v[136:139]
    v_mfma_f32_16x16x32_bf16 v[140:143], v[36:39], v[184:187], v[140:143]
    v_mfma_f32_16x16x32_bf16 v[136:139], v[40:43], v[188:191], v[136:139]
    v_mfma_f32_16x16x32_bf16 v[140:143], v[40:43], v[192:195], v[140:143]
    v_mfma_f32_16x16x32_bf16 v[136:139], v[44:47], v[196:199], v[136:139]
    v_mfma_f32_16x16x32_bf16 v[140:143], v[44:47], v[200:203], v[140:143]
    v_cvt_pk_bf16_f32 v96, v128, v132
    buffer_store_dword v96, v9, s[40:43], s54 offen offset:0
    v_cvt_pk_bf16_f32 v97, v129, v133
    buffer_store_dword v97, v9, s[40:43], s54 offen offset:256
    v_cvt_pk_bf16_f32 v98, v130, v134
    buffer_store_dword v98, v9, s[40:43], s54 offen offset:512
    v_cvt_pk_bf16_f32 v99, v131, v135
    buffer_store_dword v99, v9, s[40:43], s54 offen offset:768
    s_add_u32 s54, s54, 4096
    s_waitcnt lgkmcnt(8)
    v_mfma_f32_16x16x32_bf16 v[144:147], v[48:51], v[172:175], 0
    v_mfma_f32_16x16x32_bf16 v[148:151], v[48:51], v[176:179], 0
    v_mfma_f32_16x16x32_bf16 v[144:147], v[52:55], v[180:183], v[144:147]
    v_mfma_f32_16x16x32_bf16 v[148:151], v[52:55], v[184:187], v[148:151]
    v_mfma_f32_16x16x32_bf16 v[144:147], v[56:59], v[188:191], v[144:147]
    v_mfma_f32_16x16x32_bf16 v[148:151], v[56:59], v[192:195], v[148:151]
    v_mfma_f32_16x16x32_bf16 v[144:147], v[60:63], v[196:199], v[144:147]
    v_mfma_f32_16x16x32_bf16 v[148:151], v[60:63], v[200:203], v[148:151]
    v_cvt_pk_bf16_f32 v100, v136, v140
    buffer_store_dword v100, v9, s[40:43], s54 offen offset:0
    v_cvt_pk_bf16_f32 v101, v137, v141
    buffer_store_dword v101, v9, s[40:43], s54 offen offset:256
    v_cvt_pk_bf16_f32 v102, v138, v142
    buffer_store_dword v102, v9, s[40:43], s54 offen offset:512
    v_cvt_pk_bf16_f32 v103, v139, v143
    buffer_store_dword v103, v9, s[40:43], s54 offen offset:768
    s_add_u32 s54, s54, 4096
    s_waitcnt lgkmcnt(4)
    v_mfma_f32_16x16x32_bf16 v[152:155], v[64:67], v[172:175], 0
    v_mfma_f32_16x16x32_bf16 v[156:159], v[64:67], v[176:179], 0
    v_mfma_f32_16x16x32_bf16 v[152:155], v[68:71], v[180:183], v[152:155]
    v_mfma_f32_16x16x32_bf16 v[156:159], v[68:71], v[184:187], v[156:159]
    v_mfma_f32_16x16x32_bf16 v[152:155], v[72:75], v[188:191], v[152:155]
    v_mfma_f32_16x16x32_bf16 v[156:159], v[72:75], v[192:195], v[156:159]
    v_mfma_f32_16x16x32_bf16 v[152:155], v[76:79], v[196:199], v[152:155]
    v_mfma_f32_16x16x32_bf16 v[156:159], v[76:79], v[200:203], v[156:159]
    v_cvt_pk_bf16_f32 v104, v144, v148
    buffer_store_dword v104, v9, s[40:43], s54 offen offset:0
    v_cvt_pk_bf16_f32 v105, v145, v149
    buffer_store_dword v105, v9, s[40:43], s54 offen offset:256
    v_cvt_pk_bf16_f32 v106, v146, v150
    buffer_store_dword v106, v9, s[40:43], s54 offen offset:512
    v_cvt_pk_bf16_f32 v107, v147, v151
    buffer_store_dword v107, v9, s[40:43], s54 offen offset:768
    s_add_u32 s54, s54, 4096
    s_waitcnt lgkmcnt(0)
    v_mfma_f32_16x16x32_bf16 v[160:163], v[80:83], v[172:175], 0
    v_mfma_f32_16x16x32_bf16 v[164:167], v[80:83], v[176:179], 0
    v_mfma_f32_16x16x32_bf16 v[160:163], v[84:87], v[180:183], v[160:163]
    v_mfma_f32_16x16x32_bf16 v[164:167], v[84:87], v[184:187], v[164:167]
    v_mfma_f32_16x16x32_bf16 v[160:163], v[88:91], v[188:191], v[160:163]
    v_mfma_f32_16x16x32_bf16 v[164:167], v[88:91], v[192:195], v[164:167]
    v_mfma_f32_16x16x32_bf16 v[160:163], v[92:95], v[196:199], v[160:163]
    v_mfma_f32_16x16x32_bf16 v[164:167], v[92:95], v[200:203], v[164:167]
    v_cvt_pk_bf16_f32 v108, v152, v156
    buffer_store_dword v108, v9, s[40:43], s54 offen offset:0
    v_cvt_pk_bf16_f32 v109, v153, v157
    buffer_store_dword v109, v9, s[40:43], s54 offen offset:256
    v_cvt_pk_bf16_f32 v110, v154, v158
    buffer_store_dword v110, v9, s[40:43], s54 offen offset:512
    v_cvt_pk_bf16_f32 v111, v155, v159
    buffer_store_dword v111, v9, s[40:43], s54 offen offset:768
    s_add_u32 s54, s54, 4096
    v_cvt_pk_bf16_f32 v112, v160, v164
    buffer_store_dword v112, v9, s[40:43], s54 offen offset:0
    v_cvt_pk_bf16_f32 v113, v161, v165
    buffer_store_dword v113, v9, s[40:43], s54 offen offset:256
    v_cvt_pk_bf16_f32 v114, v162, v166
    buffer_store_dword v114, v9, s[40:43], s54 offen offset:512
    v_cvt_pk_bf16_f32 v115, v163, v167
    buffer_store_dword v115, v9, s[40:43], s54 offen offset:768
    s_add_u32 s54, s54, 4096
K2_done:
    s_endpgm
.section .rodata,"a"
.p2align 6
.amdhsa_kernel part_kernel
  .amdhsa_next_free_vgpr 72
  .amdhsa_next_free_sgpr 64
  .amdhsa_accum_offset 72
  .amdhsa_group_segment_fixed_size 0
  .amdhsa_kernarg_size 88
  .amdhsa_user_sgpr_count 2
  .amdhsa_user_sgpr_kernarg_segment_ptr 1
  .amdhsa_system_sgpr_workgroup_id_x 1
  .amdhsa_float_denorm_mode_32 3
.end_amdhsa_kernel
.p2align 6
.amdhsa_kernel gather_scatter__tensor_product_equiv_mace__graph_kernel
  .amdhsa_next_free_vgpr 208
  .amdhsa_next_free_sgpr 102
  .amdhsa_accum_offset 208
  .amdhsa_group_segment_fixed_size 0
  .amdhsa_kernarg_size 88
  .amdhsa_user_sgpr_count 2
  .amdhsa_user_sgpr_kernarg_segment_ptr 1
  .amdhsa_system_sgpr_workgroup_id_x 1
  .amdhsa_float_denorm_mode_32 3
.end_amdhsa_kernel
```

```asm
; @launch grid=(256,1,1) block=(512,1,1) lds=128768
.amdgcn_target "amdgcn-amd-amdhsa--gfx950"
.text
.globl gather_scatter__tensor_product_equiv_mace__graph_kernel
.p2align 8
.type gather_scatter__tensor_product_equiv_mace__graph_kernel,@function
gather_scatter__tensor_product_equiv_mace__graph_kernel:
    s_cmp_ge_u32 s2, 256
    s_cbranch_scc1 L_done
    s_load_dwordx4 s[4:7], s[0:1], 8
    s_load_dwordx4 s[8:11], s[0:1], 24
    s_load_dwordx2 s[14:15], s[0:1], 80
    s_load_dwordx2 s[64:65], s[0:1], 0
    s_load_dwordx2 s[66:67], s[0:1], 40
    s_load_dwordx4 s[68:71], s[0:1], 48
    s_load_dwordx2 s[12:13], s[0:1], 64
    v_lshrrev_b32 v8, 6, v0
    v_and_b32 v1, 63, v0
    v_lshlrev_b32 v9, 2, v0
    v_mov_b32 v13, 0
    v_readfirstlane_b32 s3, v8
    ds_write_b32 v9, v13 offset:52224
    ds_write_b32 v9, v13 offset:57344
    s_mul_i32 s54, s2, 5000
    s_mul_i32 s55, s2, 10000
    s_mul_i32 s61, s2, 40000
    v_lshlrev_b32 v2, 4, v1
    v_lshlrev_b32 v10, 3, v0
    v_lshlrev_b32 v15, 4, v0
    v_mov_b32 v6, 1
    s_lshl_b32 s52, s3, 10
    s_add_u32 s52, s52, 79616
    s_movk_i32 s53, 4096
    s_movk_i32 s50, 8192
    s_waitcnt lgkmcnt(0)
    s_add_u32 s32, s6, s54
    s_addc_u32 s33, s7, 0
    s_mov_b32 s34, 5000
    s_mov_b32 s35, 0x20000
    buffer_load_dword v64, v9, s[32:35], 0 offen offset:0 nt
    buffer_load_dword v65, v9, s[32:35], 0 offen offset:2048 nt
    buffer_load_dword v66, v9, s[32:35], s53 offen nt
    s_add_u32 s36, s4, s54
    s_addc_u32 s37, s5, 0
    s_mov_b32 s38, 5000
    s_mov_b32 s39, 0x20000
    buffer_load_dword v68, v9, s[36:39], 0 offen offset:0 nt
    buffer_load_dword v69, v9, s[36:39], 0 offen offset:2048 nt
    buffer_load_dword v70, v9, s[36:39], s53 offen nt
    s_load_dword s62, s[14:15], 524288
    s_getpc_b64 s[80:81]
L_pc:
    s_and_b32 s54, s2, 0xf8
    s_lshl_b32 s54, s54, 6
    v_and_b32 v11, 0x180, v10
    v_add_u32 v11, s54, v11
    v_min_u32 v11, L_end-L_pc, v11
    v_mov_b32 v113, s81
    v_add_co_u32 v112, vcc, s80, v11
    s_nop 1
    v_addc_co_u32 v113, vcc, 0, v113, vcc
    global_load_dword v205, v[112:113], off
    s_add_u32 s96, s8, s55
    s_addc_u32 s97, s9, 0
    s_mov_b32 s98, 10000
    s_mov_b32 s99, 0x20000
    s_add_u32 s28, s10, s61
    s_addc_u32 s29, s11, 0
    s_mov_b32 s30, 40000
    s_mov_b32 s31, 0x20000
    s_barrier
    buffer_load_dwordx2 v[72:73], v10, s[96:99], 0 offen nt
    buffer_load_dwordx2 v[74:75], v10, s[96:99], s53 offen nt
    buffer_load_dwordx2 v[76:77], v10, s[96:99], s50 offen nt
    s_add_u32 m0, s52, 0
    s_mov_b32 s54, 0
    buffer_load_dwordx4 v15, s[28:31], s54 offen nt lds
    s_add_u32 m0, s52, 8192
    s_mov_b32 s54, 8192
    buffer_load_dwordx4 v15, s[28:31], s54 offen nt lds
    s_add_u32 m0, s52, 16384
    s_mov_b32 s54, 16384
    buffer_load_dwordx4 v15, s[28:31], s54 offen nt lds
    s_mov_b32 s72, 109951168
    s_movk_i32 s73, 625
    s_movk_i32 s74, 838
    s_movk_i32 s54, 226
    v_cmp_gt_u32 s[84:85], s54, v0
    v_lshlrev_b32 v11, 2, v0
    v_mov_b32 v12, 0x00700000
    v_mov_b32 v13, 0
    ds_write_b32 v11, v12 offset:0
    ds_write_b32 v11, v12 offset:2048
    ds_write_b32 v11, v12 offset:4096
    ds_write_b32 v11, v13 offset:6144
    ds_write_b32 v11, v13 offset:8192
    ds_write_b32 v11, v13 offset:10240
    ds_write_b32 v11, v13 offset:12288
    v_mov_b32 v16, 0
    v_mov_b32 v17, 0
    v_mov_b32 v18, 0
    v_mov_b32 v19, 0
    v_mov_b32 v20, 0
    v_mov_b32 v21, 0
    v_mov_b32 v22, 0
    v_mov_b32 v23, 0
    v_mov_b32 v24, 0
    v_mov_b32 v25, 0
    v_mov_b32 v26, 0
    v_mov_b32 v27, 0
    v_mov_b32 v28, 0
    v_mov_b32 v29, 0
    v_mov_b32 v30, 0
    v_mov_b32 v31, 0
    v_mov_b32 v32, 0
    v_mov_b32 v33, 0
    v_mov_b32 v34, 0
    v_mov_b32 v35, 0
    v_mov_b32 v36, 0
    v_mov_b32 v37, 0
    v_mov_b32 v38, 0
    v_mov_b32 v39, 0
    v_mov_b32 v40, 0
    v_mov_b32 v41, 0
    v_mov_b32 v42, 0
    v_mov_b32 v43, 0
    v_mov_b32 v44, 0
    v_mov_b32 v45, 0
    v_mov_b32 v46, 0
    v_mov_b32 v47, 0
    v_mov_b32 v48, 0
    v_mov_b32 v49, 0
    v_mov_b32 v50, 0
    v_mov_b32 v51, 0
    v_mov_b32 v52, 0
    v_mov_b32 v53, 0
    v_mov_b32 v54, 0
    v_mov_b32 v55, 0
    v_mov_b32 v56, 0
    v_mov_b32 v57, 0
    v_mov_b32 v58, 0
    v_mov_b32 v59, 0
    v_mov_b32 v60, 0
    v_mov_b32 v61, 0
    v_mov_b32 v62, 0
    v_mov_b32 v63, 0
    s_waitcnt vmcnt(10)
    v_mul_hi_u32 v80, v64, s72
    v_mul_hi_u32 v81, v65, s72
    v_mul_hi_u32 v82, v66, s72
    v_lshlrev_b32 v84, 2, v80
    ds_add_rtn_u32 v88, v84, v6 offset:52224
    v_lshlrev_b32 v85, 2, v81
    ds_add_rtn_u32 v89, v85, v6 offset:52224
    v_lshlrev_b32 v86, 2, v82
    s_mov_b64 exec, s[84:85]
    ds_add_rtn_u32 v90, v86, v6 offset:52224
    s_mov_b64 exec, -1
    s_waitcnt lgkmcnt(0)
    s_barrier
    ds_read_b128 v[100:103], v2 offset:52224
    s_add_u32 m0, s52, 24576
    s_mov_b32 s54, 24576
    buffer_load_dwordx4 v15, s[28:31], s54 offen nt lds
    s_add_u32 m0, s52, 32768
    s_mov_b32 s54, 32768
    buffer_load_dwordx4 v15, s[28:31], s54 offen nt lds
    v_mad_u32_u24 v92, v80, s73, 15
    v_lshrrev_b32 v92, 4, v92
    v_sub_u32 v92, v64, v92
    v_lshrrev_b32 v80, 3, v80
    v_and_b32 v80, 28, v80
    v_mad_u32_u24 v93, v81, s73, 15
    v_lshrrev_b32 v93, 4, v93
    v_sub_u32 v93, v65, v93
    v_lshrrev_b32 v81, 3, v81
    v_and_b32 v81, 28, v81
    v_mad_u32_u24 v94, v82, s73, 15
    v_lshrrev_b32 v94, 4, v94
    v_sub_u32 v94, v66, v94
    v_lshrrev_b32 v82, 3, v82
    v_and_b32 v82, 28, v82
    s_waitcnt lgkmcnt(0)
    v_add_u32 v11, v100, v101
    v_add3_u32 v11, v11, v102, v103
    v_mov_b32 v12, v11
    s_nop 1
    v_add_u32_dpp v12, v12, v12 row_shr:1 row_mask:0xf bank_mask:0xf
    s_nop 1
    v_add_u32_dpp v12, v12, v12 row_shr:2 row_mask:0xf bank_mask:0xf
    s_nop 1
    v_add_u32_dpp v12, v12, v12 row_shr:4 row_mask:0xf bank_mask:0xf
    s_nop 1
    v_add_u32_dpp v12, v12, v12 row_shr:8 row_mask:0xf bank_mask:0xf
    s_nop 1
    v_add_u32_dpp v12, v12, v12 row_bcast:15 row_mask:0xa bank_mask:0xf
    s_nop 1
    v_add_u32_dpp v12, v12, v12 row_bcast:31 row_mask:0xc bank_mask:0xf
    v_sub_u32 v104, v12, v11
    v_add_u32 v105, v104, v100
    v_add_u32 v106, v105, v101
    v_add_u32 v107, v106, v102
    ds_write_b128 v2, v[104:107] offset:53248
    ds_read_b32 v108, v84 offset:53248
    ds_read_b32 v109, v85 offset:53248
    ds_read_b32 v110, v86 offset:53248
    s_waitcnt vmcnt(9)
    v_mul_u32_u24 v96, s74, v68
    v_lshrrev_b32 v96, 18, v96
    v_sub_u32 v96, v96, v80
    v_and_b32 v96, 31, v96
    v_lshl_or_b32 v96, v92, 5, v96
    v_lshlrev_b32 v96, 21, v96
    v_lshl_or_b32 v96, v68, 7, v96
    v_mul_u32_u24 v97, s74, v69
    v_lshrrev_b32 v97, 18, v97
    v_sub_u32 v97, v97, v81
    v_and_b32 v97, 31, v97
    v_lshl_or_b32 v97, v93, 5, v97
    v_lshlrev_b32 v97, 21, v97
    v_lshl_or_b32 v97, v69, 7, v97
    v_mul_u32_u24 v98, s74, v70
    v_lshrrev_b32 v98, 18, v98
    v_sub_u32 v98, v98, v82
    v_and_b32 v98, 31, v98
    v_lshl_or_b32 v98, v94, 5, v98
    v_lshlrev_b32 v98, 21, v98
    v_lshl_or_b32 v98, v70, 7, v98
    v_lshlrev_b32 v92, 5, v0
    v_add_u32 v93, 16384, v92
    v_add_u32 v94, 32768, v92
    s_mov_b32 s55, 59392
    s_waitcnt vmcnt(5) lgkmcnt(0)
    v_add_u32 v108, v108, v88
    v_lshlrev_b32 v84, 2, v108
    v_mad_u32_u24 v108, v108, 12, s55
    ds_write_b32 v84, v92 offset:54272
    ds_write2_b32 v108, v72, v73 offset0:0 offset1:1
    ds_write_b32 v108, v96 offset:8
    v_add_u32 v109, v109, v89
    v_lshlrev_b32 v85, 2, v109
    v_mad_u32_u24 v109, v109, 12, s55
    ds_write_b32 v85, v93 offset:54272
    ds_write2_b32 v109, v74, v75 offset0:0 offset1:1
    ds_write_b32 v109, v97 offset:8
    v_add_u32 v110, v110, v90
    v_lshlrev_b32 v86, 2, v110
    v_mad_u32_u24 v110, v110, 12, s55
    s_mov_b64 exec, s[84:85]
    ds_write_b32 v86, v94 offset:54272
    ds_write2_b32 v110, v76, v77 offset0:0 offset1:1
    ds_write_b32 v110, v98 offset:8
    s_mov_b64 exec, -1
    s_mul_i32 s62, s62, 0x9e3779b1
    s_add_u32 s62, s62, 0x7f4a7c15
    s_mul_i32 s63, s62, 0x85ebca6b
    s_and_b32 s63, s63, 0xffc00000
    ds_read_b64 v[100:101], v10 offset:52224
    ds_read_b64 v[104:105], v10 offset:53248
    s_mul_i32 s54, s2, 15360
    s_add_u32 s54, s54, 1048576
    s_add_u32 s32, s14, s54
    s_addc_u32 s33, s15, 0
    s_mov_b32 s34, 15360
    s_mov_b32 s35, 0x20000
    s_mul_i32 s54, s2, 40960
    s_add_u32 s54, s54, 5242880
    s_add_u32 s36, s14, s54
    s_addc_u32 s37, s15, 0
    s_mov_b32 s38, 40000
    s_mov_b32 s39, 0x20000
    v_lshrrev_b32 v11, 1, v0
    v_lshlrev_b32 v11, 2, v11
    v_and_b32 v12, 1, v0
    v_lshlrev_b32 v12, 4, v12
    v_add_u32 v12, 79616, v12
    v_add_u32 v14, 59392, v15
    s_waitcnt lgkmcnt(0)
    s_barrier
    ds_read_b128 v[128:131], v14
    ds_read_b128 v[132:135], v14 offset:8192
    ds_read_b32 v156, v11 offset:54272
    ds_read_b32 v157, v11 offset:55296
    ds_read_b32 v158, v11 offset:56320
    ds_read_b32 v159, v11 offset:57344
    ds_read_b32 v160, v11 offset:58368
    s_mov_b32 s40, s70
    s_mov_b32 s41, s71
    s_mov_b32 s42, 32768
    s_mov_b32 s43, 0x20000
    s_lshl_b32 s54, s3, 12
    s_add_u32 m0, s54, 19456
    s_nop 0
    buffer_load_dwordx4 v2, s[40:43], s54 offen offset:0 lds
    buffer_load_dwordx4 v2, s[40:43], s54 offen offset:1024 lds
    buffer_load_dwordx4 v2, s[40:43], s54 offen offset:2048 lds
    buffer_load_dwordx4 v2, s[40:43], s54 offen offset:3072 lds
    s_mov_b32 s16, s68
    s_mov_b32 s17, s69
    s_mov_b32 s18, 4096
    s_mov_b32 s19, 0x20000
    s_and_b32 s54, s3, 3
    s_lshl_b32 s54, s54, 10
    s_add_u32 m0, s54, 15360
    s_nop 0
    buffer_load_dwordx4 v2, s[16:19], s54 offen lds
    v_lshrrev_b32 v7, 4, v1
    v_lshlrev_b32 v7, 5, v7
    v_and_b32 v120, 3, v1
    v_lshl_add_u32 v7, v120, 1, v7
    global_load_ushort v120, v7, s[66:67] offset:0
    global_load_ushort v121, v7, s[66:67] offset:8
    global_load_ushort v122, v7, s[66:67] offset:16
    global_load_ushort v123, v7, s[66:67] offset:24
    s_waitcnt lgkmcnt(0)
    v_add_u32 v156, v12, v156
    v_add_u32 v157, v12, v157
    v_add_u32 v158, v12, v158
    v_add_u32 v159, v12, v159
    v_add_u32 v160, v12, v160
    v_lshl_or_b32 v112, v100, 11, v104
    v_or_b32 v112, s63, v112
    v_mov_b32 v113, s62
    v_lshl_or_b32 v114, v101, 11, v105
    v_or_b32 v114, s63, v114
    v_mov_b32 v115, s62
    s_and_b32 s44, s2, 7
    s_lshl_b32 s44, s44, 5
    s_lshr_b32 s54, s2, 3
    s_add_u32 s44, s44, s54
    s_mul_i32 s45, s44, 625
    s_add_u32 s46, s45, 640
    s_add_u32 s45, s45, 15
    s_lshr_b32 s45, s45, 4
    s_lshr_b32 s46, s46, 4
    s_sub_u32 s46, s46, s45
    s_mov_b32 s86, 0x0f0f0f0f
    s_mov_b32 s87, 0x0f0f0f0f
    s_mov_b32 s88, 0xf0f0f0f0
    s_mov_b32 s89, 0xf0f0f0f0
    s_waitcnt vmcnt(9)
    s_barrier
    ds_read_b128 v[136:139], v156
    ds_read_b128 v[140:143], v157
    ds_read_b128 v[144:147], v158
    ds_read_b128 v[148:151], v159
    ds_read_b128 v[152:155], v160
    buffer_store_dwordx4 v[128:131], v15, s[32:35], 0 offen sc1
    buffer_store_dwordx4 v[132:135], v15, s[32:35], s50 offen sc1
    s_mov_b32 s54, 0
    s_waitcnt lgkmcnt(4)
    buffer_store_dwordx4 v[136:139], v15, s[36:39], s54 offen sc1
    s_mov_b32 s54, 8192
    s_waitcnt lgkmcnt(3)
    buffer_store_dwordx4 v[140:143], v15, s[36:39], s54 offen sc1
    s_mov_b32 s54, 16384
    s_waitcnt lgkmcnt(2)
    buffer_store_dwordx4 v[144:147], v15, s[36:39], s54 offen sc1
    s_mov_b32 s54, 24576
    s_waitcnt lgkmcnt(1)
    buffer_store_dwordx4 v[148:151], v15, s[36:39], s54 offen sc1
    s_mov_b32 s54, 32768
    s_waitcnt lgkmcnt(0)
    buffer_store_dwordx4 v[152:155], v15, s[36:39], s54 offen sc1
    v_mov_b32 v164, 0
    v_mov_b32 v165, 0
    v_mov_b32 v166, 0
    v_mov_b32 v167, 0
    v_mov_b32 v168, 0
    v_mov_b32 v169, 0
    v_mov_b32 v170, 0
    v_mov_b32 v171, 0
    v_and_b32 v11, 4, v1
    v_lshlrev_b32 v11, 2, v11
    v_mov_b32 v12, 0xffff
    v_lshlrev_b32 v12, v11, v12
    v_bfe_i32 v11, v1, 3, 1
    v_and_b32 v191, v11, v12
    v_xor_b32 v190, v191, v12
    v_lshrrev_b32 v200, 5, v1
    v_lshlrev_b32 v200, 4, v200
    v_add_u32 v200, 79616, v200
    v_and_b32 v201, 15, v1
    v_lshl_or_b32 v201, v201, 4, 8
    v_bfe_u32 v11, v1, 3, 2
    v_and_b32 v12, 3, v1
    v_lshl_add_u32 v11, v11, 2, v12
    v_lshlrev_b32 v202, 4, v11
    s_cmp_eq_u32 s46, 40
    v_mov_b32 v203, 0
    s_mov_b32 s54, 671321104
    s_cselect_b32 s54, 276856880, s54
    s_mov_b32 exec_lo, 31
    s_mov_b32 exec_hi, 0
    v_mov_b32 v203, s54
    s_mov_b32 s54, 405087304
    s_cselect_b32 s54, 159876648, s54
    s_mov_b32 exec_lo, 992
    s_mov_b32 exec_hi, 0
    v_mov_b32 v203, s54
    s_mov_b32 s54, 424579168
    s_cselect_b32 s54, 296066625, s54
    s_mov_b32 exec_lo, 31744
    s_mov_b32 exec_hi, 0
    v_mov_b32 v203, s54
    s_mov_b32 s54, 577443961
    s_cselect_b32 s54, 980068482, s54
    s_mov_b32 exec_lo, 1015808
    s_mov_b32 exec_hi, 0
    v_mov_b32 v203, s54
    s_mov_b32 s54, 600547466
    s_cselect_b32 s54, 466166449, s54
    s_mov_b32 exec_lo, 32505856
    s_mov_b32 exec_hi, 0
    v_mov_b32 v203, s54
    s_mov_b32 s54, 734837403
    s_cselect_b32 s54, 590166779, s54
    s_mov_b32 exec_lo, 1040187392
    s_mov_b32 exec_hi, 0
    v_mov_b32 v203, s54
    s_mov_b32 s54, 481444091
    s_cselect_b32 s54, 754136323, s54
    s_mov_b32 exec_lo, 3221225472
    s_mov_b32 exec_hi, 7
    v_mov_b32 v203, s54
    s_mov_b32 s54, 338903356
    s_cselect_b32 s54, 76598556, s54
    s_mov_b32 exec_lo, 0
    s_mov_b32 exec_hi, 248
    v_mov_b32 v203, s54
    s_mov_b64 exec, -1
    v_mul_u32_u24 v11, 52, v1
    v_lshrrev_b32 v11, 8, v11
    v_mad_i32_i24 v11, v11, -5, v1
    v_mul_u32_u24 v11, 6, v11
    v_lshrrev_b32 v203, v11, v203
    v_and_b32 v11, 7, v203
    v_bfe_u32 v203, v203, 3, 3
    v_lshlrev_b32 v11, 12, v11
    v_lshl_or_b32 v203, v203, 7, v11
    s_mov_b32 s20, s14
    s_mov_b32 s21, s15
    s_mov_b32 s22, 524352
    s_mov_b32 s23, 0x20000
    s_add_u32 s24, s14, 1048576
    s_addc_u32 s25, s15, 0
    s_mov_b32 s26, 3932160
    s_mov_b32 s27, 0x20000
    s_lshl_b32 s54, s2, 11
    s_waitcnt vmcnt(0)
    s_barrier
    s_cmp_ge_u32 s3, 2
    s_cbranch_scc1 L_nopub
    buffer_store_dwordx4 v[112:115], v15, s[20:23], s54 offen sc1
L_nopub:
    s_mov_b32 s16, s64
    s_mov_b32 s17, s65
    s_mov_b32 s18, 10240000
    s_mov_b32 s19, 0x20000
    s_add_u32 s28, s14, 5242880
    s_addc_u32 s29, s15, 0
    s_mov_b32 s30, 10485760
    s_mov_b32 s31, 0x20000
    v_lshl_or_b32 v188, v121, 16, v120
    v_lshl_or_b32 v189, v123, 16, v122
    v_lshrrev_b32 v8, 5, v1
    v_lshlrev_b32 v8, 11, v8
    v_and_b32 v9, 15, v1
    v_lshl_add_u32 v8, v9, 4, v8
    ds_read_b128 v[64:67], v8 offset:15360
    ds_read_b128 v[68:71], v8 offset:15616
    ds_read_b128 v[72:75], v8 offset:15872
    ds_read_b128 v[76:79], v8 offset:16128
    ds_read_b128 v[80:83], v8 offset:16384
    ds_read_b128 v[84:87], v8 offset:16640
    ds_read_b128 v[88:91], v8 offset:16896
    ds_read_b128 v[92:95], v8 offset:17152
    v_bfe_i32 v10, v1, 4, 1
    v_and_b32 v10, 0x02020202, v10
    v_add_u32 v10, 0x05040100, v10
    v_lshrrev_b32 v8, 4, v1
    v_lshlrev_b32 v8, 13, v8
    v_lshl_add_u32 v8, v9, 2, v8
    s_and_b32 s54, s3, 3
    s_lshl_b32 s54, s54, 6
    s_add_u32 s54, s54, 19456
    v_add_u32 v8, s54, v8
    ds_read2st64_b32 v[128:129], v8 offset0:0 offset1:4
    ds_read2st64_b32 v[130:131], v8 offset0:8 offset1:12
    ds_read2st64_b32 v[132:133], v8 offset0:16 offset1:20
    ds_read2st64_b32 v[134:135], v8 offset0:24 offset1:28
    ds_read2st64_b32 v[136:137], v8 offset0:1 offset1:5
    ds_read2st64_b32 v[138:139], v8 offset0:9 offset1:13
    ds_read2st64_b32 v[140:141], v8 offset0:17 offset1:21
    ds_read2st64_b32 v[142:143], v8 offset0:25 offset1:29
    ds_read2st64_b32 v[144:145], v8 offset0:2 offset1:6
    ds_read2st64_b32 v[146:147], v8 offset0:10 offset1:14
    ds_read2st64_b32 v[148:149], v8 offset0:18 offset1:22
    ds_read2st64_b32 v[150:151], v8 offset0:26 offset1:30
    ds_read2st64_b32 v[152:153], v8 offset0:3 offset1:7
    ds_read2st64_b32 v[154:155], v8 offset0:11 offset1:15
    ds_read2st64_b32 v[156:157], v8 offset0:19 offset1:23
    ds_read2st64_b32 v[158:159], v8 offset0:27 offset1:31
    s_mov_b32 s72, 0x05040100
    s_mov_b32 s73, 0x07060302
    s_waitcnt lgkmcnt(15)
    v_perm_b32 v172, v68, v64, v10
    v_perm_b32 v173, v76, v72, v10
    v_perm_b32 v174, v84, v80, v10
    v_perm_b32 v175, v92, v88, v10
    v_perm_b32 v176, v69, v65, v10
    v_perm_b32 v177, v77, v73, v10
    v_perm_b32 v178, v85, v81, v10
    v_perm_b32 v179, v93, v89, v10
    v_perm_b32 v180, v70, v66, v10
    v_perm_b32 v181, v78, v74, v10
    v_perm_b32 v182, v86, v82, v10
    v_perm_b32 v183, v94, v90, v10
    v_perm_b32 v184, v71, v67, v10
    v_perm_b32 v185, v79, v75, v10
    v_perm_b32 v186, v87, v83, v10
    v_perm_b32 v187, v95, v91, v10
    s_waitcnt lgkmcnt(0)
    v_perm_b32 v208, v129, v128, s72
    v_perm_b32 v209, v131, v130, s72
    v_perm_b32 v210, v133, v132, s72
    v_perm_b32 v211, v135, v134, s72
    v_perm_b32 v212, v129, v128, s73
    v_perm_b32 v213, v131, v130, s73
    v_perm_b32 v214, v133, v132, s73
    v_perm_b32 v215, v135, v134, s73
    v_perm_b32 v216, v137, v136, s72
    v_perm_b32 v217, v139, v138, s72
    v_perm_b32 v218, v141, v140, s72
    v_perm_b32 v219, v143, v142, s72
    v_perm_b32 v220, v137, v136, s73
    v_perm_b32 v221, v139, v138, s73
    v_perm_b32 v222, v141, v140, s73
    v_perm_b32 v223, v143, v142, s73
    v_perm_b32 v224, v145, v144, s72
    v_perm_b32 v225, v147, v146, s72
    v_perm_b32 v226, v149, v148, s72
    v_perm_b32 v227, v151, v150, s72
    v_perm_b32 v228, v145, v144, s73
    v_perm_b32 v229, v147, v146, s73
    v_perm_b32 v230, v149, v148, s73
    v_perm_b32 v231, v151, v150, s73
    v_perm_b32 v232, v153, v152, s72
    v_perm_b32 v233, v155, v154, s72
    v_perm_b32 v234, v157, v156, s72
    v_perm_b32 v235, v159, v158, s72
    v_perm_b32 v236, v153, v152, s73
    v_perm_b32 v237, v155, v154, s73
    v_perm_b32 v238, v157, v156, s73
    v_perm_b32 v239, v159, v158, s73
    s_lshl_b32 s54, s45, 10
    s_add_u32 s40, s12, s54
    s_addc_u32 s41, s13, 0
    s_lshl_b32 s42, s46, 10
    s_mov_b32 s43, 0x20000
    v_lshrrev_b32 v9, 1, v0
    v_lshlrev_b32 v10, 11, v9
    s_lshl_b32 s54, s44, 3
    v_mul_u32_u24 v5, 1280, v9
    s_mov_b32 s48, 0
    s_mov_b32 s53, 200000
    s_mov_b32 s55, 0xffc00000
L_poll:
    buffer_load_dwordx2 v[14:15], v10, s[20:23], s54 offen sc1
    s_sub_u32 s53, s53, 1
    s_cbranch_scc1 L_done
    s_waitcnt vmcnt(0)
    v_xor_b32 v11, s63, v14
    v_xor_b32 v12, s62, v15
    v_and_or_b32 v11, v11, s55, v12
    v_cmpx_ne_u32 vcc, 0, v11
    s_cbranch_execnz L_poll
    s_mov_b64 exec, -1
    v_bfe_u32 v3, v14, 11, 11
    v_bfe_i32 v12, v0, 0, 1
    v_and_b32 v11, 0x7ff, v14
    v_and_b32 v4, v3, v12
    v_add_u32 v5, v5, v11
    s_nop 0
    v_add_u32_dpp v4, v4, v4 row_shr:1 row_mask:0xf bank_mask:0xf
    s_nop 1
    v_add_u32_dpp v4, v4, v4 row_shr:2 row_mask:0xf bank_mask:0xf
    s_nop 1
    v_add_u32_dpp v4, v4, v4 row_shr:4 row_mask:0xf bank_mask:0xf
    s_nop 1
    v_add_u32_dpp v4, v4, v4 row_shr:8 row_mask:0xf bank_mask:0xf
    s_nop 1
    v_add_u32_dpp v4, v4, v4 row_bcast:15 row_mask:0xa bank_mask:0xf
    s_nop 1
    v_add_u32_dpp v4, v4, v4 row_bcast:31 row_mask:0xc bank_mask:0xf
    s_mov_b32 exec_lo, 0
    s_brev_b32 exec_hi, 1
    ds_add_rtn_u32 v12, v13, v4 offset:13312
    s_mov_b64 exec, -1
    v_mov_b32_dpp v4, v4 quad_perm:[0,0,2,2] row_mask:0xf bank_mask:0xf
    s_waitcnt lgkmcnt(0)
    v_readlane_b32 s54, v12, 63
    s_nop 1
    v_add_u32 v4, s54, v4
    v_sub_u32 v5, v5, v4
L_round:
    v_subrev_u32 v8, s48, v4
    v_and_b32 v11, 1, v0
    v_add_u32 v10, v8, v3
    v_max_i32 v8, 0, v8
    v_min_i32 v10, 1536, v10
    v_add_u32 v8, v8, v11
    v_sub_u32 v10, v10, v8
    v_lshlrev_b32 v8, 2, v8
    v_add_u32 v9, s48, v5
L_map:
    v_cmp_lt_i32 s[64:65], 0, v10
    v_cmp_lt_i32 s[66:67], 2, v10
    v_cmp_lt_i32 s[68:69], 4, v10
    v_cmp_lt_i32 s[70:71], 6, v10
    v_cmp_lt_i32 s[72:73], 8, v10
    v_cmp_lt_i32 s[74:75], 10, v10
    v_cmp_lt_i32 s[76:77], 12, v10
    v_cmp_lt_i32 s[78:79], 14, v10
    s_mov_b64 exec, s[64:65]
    ds_write_b32 v8, v9 offset:0
    s_mov_b64 exec, s[66:67]
    ds_write_b32 v8, v9 offset:8
    s_mov_b64 exec, s[68:69]
    ds_write_b32 v8, v9 offset:16
    s_mov_b64 exec, s[70:71]
    ds_write_b32 v8, v9 offset:24
    s_mov_b64 exec, s[72:73]
    ds_write_b32 v8, v9 offset:32
    s_mov_b64 exec, s[74:75]
    ds_write_b32 v8, v9 offset:40
    s_mov_b64 exec, s[76:77]
    ds_write_b32 v8, v9 offset:48
    s_mov_b64 exec, -1
    s_cmp_lg_u64 s[78:79], 0
    s_cbranch_scc1 L_map2
    v_lshlrev_b32 v8, 2, v0
    v_lshrrev_b32 v12, 1, v0
    v_lshlrev_b32 v9, 2, v12
    v_lshlrev_b32 v10, 4, v0
    v_mul_u32_u24 v14, 12, v0
    s_waitcnt lgkmcnt(0)
    s_barrier
    ds_read_b32 v64, v8 offset:0
    ds_read_b32 v65, v8 offset:2048
    ds_read_b32 v66, v8 offset:4096
    ds_read_b32 v68, v9 offset:0
    ds_read_b32 v69, v9 offset:1024
    ds_read_b32 v70, v9 offset:2048
    ds_read_b32 v71, v9 offset:3072
    ds_read_b32 v72, v9 offset:4096
    ds_read_b32 v73, v9 offset:5120
    ds_read_b32 v11, v13 offset:13312
    s_waitcnt lgkmcnt(7)
    v_mad_i32_i24 v64, v64, 12, v14
    buffer_load_dwordx3 v[76:78], v64, s[24:27], 0 offen sc1
    v_add_u32 v65, 512, v65
    v_mad_i32_i24 v65, v65, 12, v14
    buffer_load_dwordx3 v[80:82], v65, s[24:27], 0 offen sc1
    v_add_u32 v66, 1024, v66
    v_mad_i32_i24 v66, v66, 12, v14
    buffer_load_dwordx3 v[84:86], v66, s[24:27], 0 offen sc1
    s_waitcnt lgkmcnt(0)
    s_barrier
    v_lshl_add_u32 v68, v68, 5, v10
    v_lshl_add_u32 v69, v69, 5, v10
    v_add_u32 v69, 8192, v69
    v_lshl_add_u32 v70, v70, 5, v10
    v_add_u32 v70, 16384, v70
    v_lshl_add_u32 v71, v71, 5, v10
    v_add_u32 v71, 24576, v71
    v_lshl_add_u32 v72, v72, 5, v10
    v_add_u32 v72, 32768, v72
    v_lshl_add_u32 v73, v73, 5, v10
    v_add_u32 v73, 40960, v73
    s_add_u32 m0, s52, 0
    s_nop 0
    buffer_load_dwordx4 v68, s[28:31], 0 offen sc1 lds
    s_add_u32 m0, s52, 8192
    s_nop 0
    buffer_load_dwordx4 v69, s[28:31], 0 offen sc1 lds
    v_readfirstlane_b32 s47, v11
    s_nop 0
    s_sub_u32 s49, s47, s48
    s_min_u32 s49, s49, 1536
    v_add_u32 v64, 0, v0
    v_cmp_gt_u32 s[80:81], s49, v64
    v_lshlrev_b32 v64, 21, v64
    v_add_u32 v65, 512, v0
    v_cmp_gt_u32 s[82:83], s49, v65
    v_lshlrev_b32 v65, 21, v65
    v_add_u32 v66, 1024, v0
    v_cmp_gt_u32 s[84:85], s49, v66
    v_lshlrev_b32 v66, 21, v66
    v_lshlrev_b32 v8, 2, v1
    v_and_b32 v14, 124, v8
    s_mul_i32 s54, s3, 640
    v_add_u32 v15, s54, v14
    s_mov_b32 s55, 0x1fff80
    v_and_b32 v12, 12, v8
    v_sub_u32 v10, 63, v1
    s_mul_i32 s61, s3, 5
    s_waitcnt vmcnt(4)
    v_lshrrev_b32 v92, 21, v78
    v_lshlrev_b32 v92, 2, v92
    v_lshrrev_b32 v11, 26, v78
    v_lshl_or_b32 v11, v11, 4, v12
    s_mov_b64 exec, s[80:81]
    ds_add_rtn_u32 v88, v92, v6 offset:6144
    ds_add_u32 v11, v6 offset:12288
    s_mov_b64 exec, -1
    v_and_or_b32 v78, v78, s55, v64
    s_waitcnt vmcnt(3)
    v_lshrrev_b32 v93, 21, v82
    v_lshlrev_b32 v93, 2, v93
    v_lshrrev_b32 v11, 26, v82
    v_lshl_or_b32 v11, v11, 4, v12
    s_mov_b64 exec, s[82:83]
    ds_add_rtn_u32 v89, v93, v6 offset:6144
    ds_add_u32 v11, v6 offset:12288
    s_mov_b64 exec, -1
    v_and_or_b32 v82, v82, s55, v65
    s_waitcnt vmcnt(2)
    v_lshrrev_b32 v94, 21, v86
    v_lshlrev_b32 v94, 2, v94
    v_lshrrev_b32 v11, 26, v86
    v_lshl_or_b32 v11, v11, 4, v12
    s_mov_b64 exec, s[84:85]
    ds_add_rtn_u32 v90, v94, v6 offset:6144
    ds_add_u32 v11, v6 offset:12288
    s_mov_b64 exec, -1
    v_and_or_b32 v86, v86, s55, v66
    s_add_u32 m0, s52, 16384
    s_nop 0
    buffer_load_dwordx4 v70, s[28:31], 0 offen sc1 lds
    s_add_u32 m0, s52, 24576
    s_nop 0
    buffer_load_dwordx4 v71, s[28:31], 0 offen sc1 lds
    s_waitcnt lgkmcnt(0)
    s_barrier
    s_cmp_lg_u32 s48, 0
    s_cbranch_scc1 L_rank2
    ds_read_b128 v[104:107], v2 offset:12288
    ds_read_b32 v96, v15 offset:6144
    ds_read_b32 v97, v15 offset:6272
    ds_read_b32 v98, v15 offset:6400
    ds_read_b32 v99, v15 offset:6528
    ds_read_b32 v100, v15 offset:6656
    s_add_u32 s65, s61, 1
    s_add_u32 s66, s61, 2
    s_add_u32 s67, s61, 3
    s_add_u32 s68, s61, 4
    s_waitcnt lgkmcnt(5)
    v_add_u32 v9, v104, v105
    v_add3_u32 v9, v9, v106, v107
    v_lshl_or_b32 v9, v9, 6, v10
    s_nop 0
    v_readlane_b32 s64, v9, s61
    v_readlane_b32 s65, v9, s65
    v_readlane_b32 s66, v9, s66
    v_readlane_b32 s67, v9, s67
    v_readlane_b32 s68, v9, s68
    v_cmp_lt_u32 s[70:71], s64, v9
    v_cmp_lt_u32 s[72:73], s65, v9
    v_cmp_lt_u32 s[74:75], s66, v9
    v_cmp_lt_u32 s[76:77], s67, v9
    v_cmp_lt_u32 s[78:79], s68, v9
    s_bcnt1_i32_b64 s64, s[70:71]
    s_bcnt1_i32_b64 s65, s[72:73]
    s_bcnt1_i32_b64 s66, s[74:75]
    s_bcnt1_i32_b64 s67, s[76:77]
    s_bcnt1_i32_b64 s68, s[78:79]
    s_waitcnt lgkmcnt(0)
    v_readlane_b32 s90, v203, s64
    v_readlane_b32 s91, v203, s65
    v_readlane_b32 s92, v203, s66
    v_readlane_b32 s93, v203, s67
    v_readlane_b32 s94, v203, s68
L_ranked:
    s_mov_b32 exec_hi, 0
    s_and_b32 s54, s90, 0x380
    v_add_u32 v104, s54, v14
    ds_add_rtn_u32 v96, v104, v96 offset:11264
    s_and_b32 s54, s91, 0x380
    v_add_u32 v105, s54, v14
    ds_add_rtn_u32 v97, v105, v97 offset:11264
    s_and_b32 s54, s92, 0x380
    v_add_u32 v106, s54, v14
    ds_add_rtn_u32 v98, v106, v98 offset:11264
    s_and_b32 s54, s93, 0x380
    v_add_u32 v107, s54, v14
    ds_add_rtn_u32 v99, v107, v99 offset:11264
    s_and_b32 s54, s94, 0x380
    v_add_u32 v108, s54, v14
    ds_add_rtn_u32 v100, v108, v100 offset:11264
    v_or_b32 v104, s90, v104
    v_or_b32 v105, s91, v105
    v_or_b32 v106, s92, v106
    v_or_b32 v107, s93, v107
    v_or_b32 v108, s94, v108
    s_waitcnt lgkmcnt(4)
    v_lshl_or_b32 v96, v96, 16, v104
    ds_write_b32 v15, v96 offset:6144
    s_waitcnt lgkmcnt(4)
    v_lshl_or_b32 v97, v97, 16, v105
    ds_write_b32 v15, v97 offset:6272
    s_waitcnt lgkmcnt(4)
    v_lshl_or_b32 v98, v98, 16, v106
    ds_write_b32 v15, v98 offset:6400
    s_waitcnt lgkmcnt(4)
    v_lshl_or_b32 v99, v99, 16, v107
    ds_write_b32 v15, v99 offset:6528
    s_waitcnt lgkmcnt(4)
    v_lshl_or_b32 v100, v100, 16, v108
    ds_write_b32 v15, v100 offset:6656
    v_writelane_b32 v11, s90, 0
    v_writelane_b32 v11, s91, 1
    v_writelane_b32 v11, s92, 2
    v_writelane_b32 v11, s93, 3
    v_writelane_b32 v11, s94, 4
    v_add_lshl_u32 v12, v1, s61, 7
    v_lshrrev_b32 v9, 10, v11
    v_bfe_u32 v11, v11, 2, 8
    v_or_b32 v11, v11, v9
    s_mov_b32 exec_lo, 31
    ds_write_b32 v11, v12 offset:13568
    s_mov_b64 exec, -1
    s_add_u32 m0, s52, 32768
    s_nop 0
    buffer_load_dwordx4 v72, s[28:31], 0 offen sc1 lds
    s_add_u32 m0, s52, 40960
    s_nop 0
    buffer_load_dwordx4 v73, s[28:31], 0 offen sc1 lds
    v_lshrrev_b32 v12, 3, v1
    v_mul_u32_u24 v12, 256, v12
    v_add_u32 v12, 52224, v12
    s_lshl_b32 s54, s3, 5
    v_add_u32 v11, s54, v8
    s_waitcnt lgkmcnt(0)
    s_barrier
    ds_read_b128 v[96:99], v2 offset:11264
    ds_read_b32 v92, v92 offset:6144
    ds_read_b32 v93, v93 offset:6144
    ds_read_b32 v94, v94 offset:6144
    ds_read_b32 v11, v11 offset:13568
    s_lshl_b32 s54, s3, 3
    s_add_u32 s55, s54, 7
    s_waitcnt lgkmcnt(4)
    v_add_u32 v9, v96, v97
    v_add3_u32 v9, v9, v98, v99
    v_mov_b32 v10, v9
    s_nop 1
    v_add_u32_dpp v10, v10, v10 row_shr:1 row_mask:0xf bank_mask:0xf
    s_nop 1
    v_add_u32_dpp v10, v10, v10 row_shr:2 row_mask:0xf bank_mask:0xf
    s_nop 1
    v_add_u32_dpp v10, v10, v10 row_shr:4 row_mask:0xf bank_mask:0xf
    s_nop 1
    v_add_u32_dpp v10, v10, v10 row_shr:8 row_mask:0xf bank_mask:0xf
    s_nop 1
    v_add_u32_dpp v10, v10, v10 row_bcast:15 row_mask:0xa bank_mask:0xf
    s_nop 1
    v_add_u32_dpp v10, v10, v10 row_bcast:31 row_mask:0xc bank_mask:0xf
    v_sub_u32 v9, v10, v9
    v_lshl_add_u32 v104, v9, 4, v12
    v_lshl_add_u32 v105, v96, 4, v104
    v_lshl_add_u32 v106, v97, 4, v105
    v_lshl_add_u32 v107, v98, 4, v106
    ds_write_b128 v2, v[104:107] offset:14336
    s_waitcnt lgkmcnt(2)
    v_and_b32 v64, 0x3ff, v92
    ds_read_b32 v64, v64 offset:14336
    v_and_b32 v65, 0x3ff, v93
    ds_read_b32 v65, v65 offset:14336
    v_and_b32 v66, 0x3ff, v94
    ds_read_b32 v66, v66 offset:14336
    v_readlane_b32 s50, v10, s55
    v_readlane_b32 s53, v9, s54
    v_readlane_b32 s51, v104, s54
    v_bfe_u32 v15, v92, 12, 3
    v_or_b32 v78, v15, v78
    v_lshrrev_b32 v92, 16, v92
    v_add_u32 v92, v92, v88
    v_bfe_u32 v15, v93, 12, 3
    v_or_b32 v82, v15, v82
    v_lshrrev_b32 v93, 16, v93
    v_add_u32 v93, v93, v89
    v_bfe_u32 v15, v94, 12, 3
    v_or_b32 v86, v15, v86
    v_lshrrev_b32 v94, 16, v94
    v_add_u32 v94, v94, v90
    s_sub_u32 s50, s50, s53
    s_lshl_b32 s54, s50, 4
    v_add_u32 v198, s51, v201
    v_add_u32 v199, s51, v202
    s_waitcnt lgkmcnt(2)
    v_lshl_add_u32 v92, v92, 4, v64
    s_mov_b64 exec, s[80:81]
    ds_write_b96 v92, v[76:78]
    s_mov_b64 exec, -1
    s_waitcnt lgkmcnt(2)
    v_lshl_add_u32 v93, v93, 4, v65
    s_mov_b64 exec, s[82:83]
    ds_write_b96 v93, v[80:82]
    s_mov_b64 exec, -1
    s_waitcnt lgkmcnt(2)
    v_lshl_add_u32 v94, v94, 4, v66
    s_mov_b64 exec, s[84:85]
    ds_write_b96 v94, v[84:86]
    s_mov_b64 exec, -1
    v_add_u32 v9, s54, v198
    v_mov_b32 v12, 2097029
    ds_write_b32 v9, v12
    v_readlane_b32 s56, v11, 0
    v_readlane_b32 s57, v11, 1
    v_readlane_b32 s58, v11, 2
    v_readlane_b32 s59, v11, 3
    v_readlane_b32 s60, v11, 4
    s_waitcnt lgkmcnt(0)
    s_barrier
    ds_read_b32 v196, v198
    ds_read_b32 v197, v198 offset:96
    ds_read_b128 v[192:195], v199
    s_mov_b32 s55, 0x00fffc38
    s_waitcnt lgkmcnt(2)
    v_lshlrev_b32 v196, 3, v196
    v_and_b32 v196, s55, v196
    s_nop 0
    v_readlane_b32 s64, v196, 0
    v_readlane_b32 s65, v196, 1
    v_readlane_b32 s66, v196, 2
    v_readlane_b32 s67, v196, 3
    v_readlane_b32 s68, v196, 4
    v_readlane_b32 s69, v196, 5
    s_and_b32 s61, s64, 0xffffff00
    buffer_load_dwordx4 v[96:99], v2, s[16:19], s61 offen
    s_and_b32 s61, s65, 0xffffff00
    buffer_load_dwordx4 v[100:103], v2, s[16:19], s61 offen
    s_and_b32 s61, s66, 0xffffff00
    buffer_load_dwordx4 v[104:107], v2, s[16:19], s61 offen
    s_and_b32 s61, s67, 0xffffff00
    buffer_load_dwordx4 v[108:111], v2, s[16:19], s61 offen
    s_and_b32 s61, s68, 0xffffff00
    buffer_load_dwordx4 v[112:115], v2, s[16:19], s61 offen
    s_and_b32 s61, s69, 0xffffff00
    buffer_load_dwordx4 v[116:119], v2, s[16:19], s61 offen
    s_waitcnt vmcnt(6) lgkmcnt(0)
    s_barrier
    s_cmp_eq_u32 s50, 0
    s_cbranch_scc1 L_swept
    v_lshrrev_b32 v8, 21, v194
    v_lshl_add_u32 v8, v8, 5, v200
    s_mov_b64 exec, s[86:87]
    ds_read_b128 v[164:167], v8
    s_mov_b64 exec, s[88:89]
    ds_read_b128 v[168:171], v8
    s_mov_b64 exec, -1
    s_mov_b32 s53, s50
.p2align 3
L_loop:
    s_waitcnt lgkmcnt(0)
    v_mfma_f32_4x4x4_16b_bf16 v[144:147], v[192:193], v[188:189], 0 cbsz:4 abid:0
    v_mfma_f32_4x4x4_16b_bf16 v[148:151], v[192:193], v[188:189], 0 cbsz:4 abid:2
    v_mfma_f32_4x4x4_16b_bf16 v[152:155], v[192:193], v[188:189], 0 cbsz:4 abid:4
    v_mfma_f32_4x4x4_16b_bf16 v[156:159], v[192:193], v[188:189], 0 cbsz:4 abid:6
    v_mfma_f32_32x32x16_bf16 v[64:79], v[164:167], v[172:175], 0
    v_lshlrev_b32 v196, 3, v197
    v_and_b32 v196, s55, v196
    v_add_u32 v198, 256, v198
    v_mfma_f32_32x32x16_bf16 v[80:95], v[164:167], v[180:183], 0
    v_add_u32 v199, 256, v199
    ds_read_b32 v197, v198 offset:96
    ds_read_b128 v[192:195], v199
    v_mfma_f32_32x32x16_bf16 v[64:79], v[168:171], v[176:179], v[64:79]
    v_cvt_pk_bf16_f32 v9, v144, v144
    v_and_b32 v160, v190, v9
    v_and_b32 v161, v191, v9
    v_mfma_f32_32x32x16_bf16 v[80:95], v[168:171], v[184:187], v[80:95]
    s_waitcnt vmcnt(5)
    v_mfma_f32_16x16x16_bf16 v[128:131], v[160:161], v[96:97], 0
    v_readlane_b32 s70, v196, 0
    v_cvt_pk_bf16_f32 v10, v145, v145
    v_mfma_f32_16x16x16_bf16 v[132:135], v[160:161], v[98:99], 0
    v_and_b32 v162, v190, v10
    v_and_b32 v163, v191, v10
    s_and_b32 s61, s70, 0xffffff00
    buffer_load_dwordx4 v[120:123], v2, s[16:19], s61 offen
    s_waitcnt vmcnt(5)
    v_mfma_f32_16x16x16_bf16 v[136:139], v[162:163], v[100:101], 0
    v_readlane_b32 s71, v196, 1
    v_cvt_pk_bf16_f32 v9, v146, v146
    v_mfma_f32_16x16x16_bf16 v[140:143], v[162:163], v[102:103], 0
    v_and_b32 v160, v190, v9
    v_and_b32 v161, v191, v9
    s_and_b32 s61, s71, 0xffffff00
    buffer_load_dwordx4 v[124:127], v2, s[16:19], s61 offen
    s_set_gpr_idx_on s64, gpr_idx(SRC2,DST)
    v_pk_fma_f32 v[16:17], v[128:129], v[64:65], v[16:17] op_sel_hi:[1,0,1]
    v_pk_fma_f32 v[18:19], v[130:131], v[64:65], v[18:19] op_sel_hi:[1,0,1]
    v_pk_fma_f32 v[20:21], v[132:133], v[80:81], v[20:21] op_sel_hi:[1,0,1]
    v_pk_fma_f32 v[22:23], v[134:135], v[80:81], v[22:23] op_sel_hi:[1,0,1]
    s_set_gpr_idx_off
    s_waitcnt vmcnt(5)
    v_mfma_f32_16x16x16_bf16 v[128:131], v[160:161], v[104:105], 0
    v_readlane_b32 s72, v196, 2
    v_cvt_pk_bf16_f32 v10, v147, v147
    v_mfma_f32_16x16x16_bf16 v[132:135], v[160:161], v[106:107], 0
    v_and_b32 v162, v190, v10
    v_and_b32 v163, v191, v10
    s_and_b32 s61, s72, 0xffffff00
    buffer_load_dwordx4 v[96:99], v2, s[16:19], s61 offen
    s_waitcnt lgkmcnt(0)
    v_lshrrev_b32 v8, 21, v194
    v_lshl_add_u32 v8, v8, 5, v200
    s_mov_b64 exec, s[86:87]
    ds_read_b128 v[164:167], v8
    s_mov_b64 exec, s[88:89]
    ds_read_b128 v[168:171], v8
    s_mov_b64 exec, -1
    s_set_gpr_idx_on s65, gpr_idx(SRC2,DST)
    v_pk_fma_f32 v[16:17], v[136:137], v[64:65], v[16:17] op_sel:[0,1,0] op_sel_hi:[1,1,1]
    v_pk_fma_f32 v[18:19], v[138:139], v[64:65], v[18:19] op_sel:[0,1,0] op_sel_hi:[1,1,1]
    v_pk_fma_f32 v[20:21], v[140:141], v[80:81], v[20:21] op_sel:[0,1,0] op_sel_hi:[1,1,1]
    v_pk_fma_f32 v[22:23], v[142:143], v[80:81], v[22:23] op_sel:[0,1,0] op_sel_hi:[1,1,1]
    s_set_gpr_idx_off
    s_waitcnt vmcnt(5)
    v_mfma_f32_16x16x16_bf16 v[136:139], v[162:163], v[108:109], 0
    v_readlane_b32 s73, v196, 3
    v_cvt_pk_bf16_f32 v9, v148, v148
    v_mfma_f32_16x16x16_bf16 v[140:143], v[162:163], v[110:111], 0
    v_and_b32 v160, v190, v9
    v_and_b32 v161, v191, v9
    s_and_b32 s61, s73, 0xffffff00
    buffer_load_dwordx4 v[100:103], v2, s[16:19], s61 offen
    s_set_gpr_idx_on s66, gpr_idx(SRC2,DST)
    v_pk_fma_f32 v[16:17], v[128:129], v[66:67], v[16:17] op_sel_hi:[1,0,1]
    v_pk_fma_f32 v[18:19], v[130:131], v[66:67], v[18:19] op_sel_hi:[1,0,1]
    v_pk_fma_f32 v[20:21], v[132:133], v[82:83], v[20:21] op_sel_hi:[1,0,1]
    v_pk_fma_f32 v[22:23], v[134:135], v[82:83], v[22:23] op_sel_hi:[1,0,1]
    s_set_gpr_idx_off
    s_waitcnt vmcnt(5)
    v_mfma_f32_16x16x16_bf16 v[128:131], v[160:161], v[112:113], 0
    v_readlane_b32 s74, v196, 4
    v_cvt_pk_bf16_f32 v10, v149, v149
    v_mfma_f32_16x16x16_bf16 v[132:135], v[160:161], v[114:115], 0
    v_and_b32 v162, v190, v10
    v_and_b32 v163, v191, v10
    s_and_b32 s61, s74, 0xffffff00
    buffer_load_dwordx4 v[104:107], v2, s[16:19], s61 offen
    s_set_gpr_idx_on s67, gpr_idx(SRC2,DST)
    v_pk_fma_f32 v[16:17], v[136:137], v[66:67], v[16:17] op_sel:[0,1,0] op_sel_hi:[1,1,1]
    v_pk_fma_f32 v[18:19], v[138:139], v[66:67], v[18:19] op_sel:[0,1,0] op_sel_hi:[1,1,1]
    v_pk_fma_f32 v[20:21], v[140:141], v[82:83], v[20:21] op_sel:[0,1,0] op_sel_hi:[1,1,1]
    v_pk_fma_f32 v[22:23], v[142:143], v[82:83], v[22:23] op_sel:[0,1,0] op_sel_hi:[1,1,1]
    s_set_gpr_idx_off
    s_cmp_le_u32 s53, 4
    s_cbranch_scc1 L_swept
    s_waitcnt vmcnt(5)
    v_mfma_f32_16x16x16_bf16 v[136:139], v[162:163], v[116:117], 0
    v_readlane_b32 s75, v196, 5
    v_cvt_pk_bf16_f32 v9, v150, v150
    v_mfma_f32_16x16x16_bf16 v[140:143], v[162:163], v[118:119], 0
    v_and_b32 v160, v190, v9
    v_and_b32 v161, v191, v9
    s_and_b32 s61, s75, 0xffffff00
    buffer_load_dwordx4 v[108:111], v2, s[16:19], s61 offen
    s_set_gpr_idx_on s68, gpr_idx(SRC2,DST)
    v_pk_fma_f32 v[16:17], v[128:129], v[68:69], v[16:17] op_sel_hi:[1,0,1]
    v_pk_fma_f32 v[18:19], v[130:131], v[68:69], v[18:19] op_sel_hi:[1,0,1]
    v_pk_fma_f32 v[20:21], v[132:133], v[84:85], v[20:21] op_sel_hi:[1,0,1]
    v_pk_fma_f32 v[22:23], v[134:135], v[84:85], v[22:23] op_sel_hi:[1,0,1]
    s_set_gpr_idx_off
    s_waitcnt vmcnt(5)
    v_mfma_f32_16x16x16_bf16 v[128:131], v[160:161], v[120:121], 0
    v_readlane_b32 s76, v196, 6
    v_cvt_pk_bf16_f32 v10, v151, v151
    v_mfma_f32_16x16x16_bf16 v[132:135], v[160:161], v[122:123], 0
    v_and_b32 v162, v190, v10
    v_and_b32 v163, v191, v10
    s_and_b32 s61, s76, 0xffffff00
    buffer_load_dwordx4 v[112:115], v2, s[16:19], s61 offen
    s_set_gpr_idx_on s69, gpr_idx(SRC2,DST)
    v_pk_fma_f32 v[16:17], v[136:137], v[68:69], v[16:17] op_sel:[0,1,0] op_sel_hi:[1,1,1]
    v_pk_fma_f32 v[18:19], v[138:139], v[68:69], v[18:19] op_sel:[0,1,0] op_sel_hi:[1,1,1]
    v_pk_fma_f32 v[20:21], v[140:141], v[84:85], v[20:21] op_sel:[0,1,0] op_sel_hi:[1,1,1]
    v_pk_fma_f32 v[22:23], v[142:143], v[84:85], v[22:23] op_sel:[0,1,0] op_sel_hi:[1,1,1]
    s_set_gpr_idx_off
    s_waitcnt vmcnt(5)
    v_mfma_f32_16x16x16_bf16 v[136:139], v[162:163], v[124:125], 0
    v_readlane_b32 s77, v196, 7
    v_cvt_pk_bf16_f32 v9, v152, v152
    v_mfma_f32_16x16x16_bf16 v[140:143], v[162:163], v[126:127], 0
    v_and_b32 v160, v190, v9
    v_and_b32 v161, v191, v9
    s_and_b32 s61, s77, 0xffffff00
    buffer_load_dwordx4 v[116:119], v2, s[16:19], s61 offen
    s_set_gpr_idx_on s70, gpr_idx(SRC2,DST)
    v_pk_fma_f32 v[16:17], v[128:129], v[70:71], v[16:17] op_sel_hi:[1,0,1]
    v_pk_fma_f32 v[18:19], v[130:131], v[70:71], v[18:19] op_sel_hi:[1,0,1]
    v_pk_fma_f32 v[20:21], v[132:133], v[86:87], v[20:21] op_sel_hi:[1,0,1]
    v_pk_fma_f32 v[22:23], v[134:135], v[86:87], v[22:23] op_sel_hi:[1,0,1]
    s_set_gpr_idx_off
    s_waitcnt vmcnt(5)
    v_mfma_f32_16x16x16_bf16 v[128:131], v[160:161], v[96:97], 0
    v_readlane_b32 s78, v196, 8
    v_cvt_pk_bf16_f32 v10, v153, v153
    v_mfma_f32_16x16x16_bf16 v[132:135], v[160:161], v[98:99], 0
    v_and_b32 v162, v190, v10
    v_and_b32 v163, v191, v10
    s_and_b32 s61, s78, 0xffffff00
    buffer_load_dwordx4 v[120:123], v2, s[16:19], s61 offen
    s_set_gpr_idx_on s71, gpr_idx(SRC2,DST)
    v_pk_fma_f32 v[16:17], v[136:137], v[70:71], v[16:17] op_sel:[0,1,0] op_sel_hi:[1,1,1]
    v_pk_fma_f32 v[18:19], v[138:139], v[70:71], v[18:19] op_sel:[0,1,0] op_sel_hi:[1,1,1]
    v_pk_fma_f32 v[20:21], v[140:141], v[86:87], v[20:21] op_sel:[0,1,0] op_sel_hi:[1,1,1]
    v_pk_fma_f32 v[22:23], v[142:143], v[86:87], v[22:23] op_sel:[0,1,0] op_sel_hi:[1,1,1]
    s_set_gpr_idx_off
    s_cmp_le_u32 s53, 8
    s_cbranch_scc1 L_swept
    s_waitcnt vmcnt(5)
    v_mfma_f32_16x16x16_bf16 v[136:139], v[162:163], v[100:101], 0
    v_readlane_b32 s79, v196, 9
    v_cvt_pk_bf16_f32 v9, v154, v154
    v_mfma_f32_16x16x16_bf16 v[140:143], v[162:163], v[102:103], 0
    v_and_b32 v160, v190, v9
    v_and_b32 v161, v191, v9
    s_and_b32 s61, s79, 0xffffff00
    buffer_load_dwordx4 v[124:127], v2, s[16:19], s61 offen
    s_set_gpr_idx_on s72, gpr_idx(SRC2,DST)
    v_pk_fma_f32 v[16:17], v[128:129], v[72:73], v[16:17] op_sel_hi:[1,0,1]
    v_pk_fma_f32 v[18:19], v[130:131], v[72:73], v[18:19] op_sel_hi:[1,0,1]
    v_pk_fma_f32 v[20:21], v[132:133], v[88:89], v[20:21] op_sel_hi:[1,0,1]
    v_pk_fma_f32 v[22:23], v[134:135], v[88:89], v[22:23] op_sel_hi:[1,0,1]
    s_set_gpr_idx_off
    s_waitcnt vmcnt(5)
    v_mfma_f32_16x16x16_bf16 v[128:131], v[160:161], v[104:105], 0
    v_readlane_b32 s64, v196, 10
    v_cvt_pk_bf16_f32 v10, v155, v155
    v_mfma_f32_16x16x16_bf16 v[132:135], v[160:161], v[106:107], 0
    v_and_b32 v162, v190, v10
    v_and_b32 v163, v191, v10
    s_and_b32 s61, s64, 0xffffff00
    buffer_load_dwordx4 v[96:99], v2, s[16:19], s61 offen
    s_set_gpr_idx_on s73, gpr_idx(SRC2,DST)
    v_pk_fma_f32 v[16:17], v[136:137], v[72:73], v[16:17] op_sel:[0,1,0] op_sel_hi:[1,1,1]
    v_pk_fma_f32 v[18:19], v[138:139], v[72:73], v[18:19] op_sel:[0,1,0] op_sel_hi:[1,1,1]
    v_pk_fma_f32 v[20:21], v[140:141], v[88:89], v[20:21] op_sel:[0,1,0] op_sel_hi:[1,1,1]
    v_pk_fma_f32 v[22:23], v[142:143], v[88:89], v[22:23] op_sel:[0,1,0] op_sel_hi:[1,1,1]
    s_set_gpr_idx_off
    s_waitcnt vmcnt(5)
    v_mfma_f32_16x16x16_bf16 v[136:139], v[162:163], v[108:109], 0
    v_readlane_b32 s65, v196, 11
    v_cvt_pk_bf16_f32 v9, v156, v156
    v_mfma_f32_16x16x16_bf16 v[140:143], v[162:163], v[110:111], 0
    v_and_b32 v160, v190, v9
    v_and_b32 v161, v191, v9
    s_and_b32 s61, s65, 0xffffff00
    buffer_load_dwordx4 v[100:103], v2, s[16:19], s61 offen
    s_set_gpr_idx_on s74, gpr_idx(SRC2,DST)
    v_pk_fma_f32 v[16:17], v[128:129], v[74:75], v[16:17] op_sel_hi:[1,0,1]
    v_pk_fma_f32 v[18:19], v[130:131], v[74:75], v[18:19] op_sel_hi:[1,0,1]
    v_pk_fma_f32 v[20:21], v[132:133], v[90:91], v[20:21] op_sel_hi:[1,0,1]
    v_pk_fma_f32 v[22:23], v[134:135], v[90:91], v[22:23] op_sel_hi:[1,0,1]
    s_set_gpr_idx_off
    s_waitcnt vmcnt(5)
    v_mfma_f32_16x16x16_bf16 v[128:131], v[160:161], v[112:113], 0
    v_readlane_b32 s66, v196, 12
    v_cvt_pk_bf16_f32 v10, v157, v157
    v_mfma_f32_16x16x16_bf16 v[132:135], v[160:161], v[114:115], 0
    v_and_b32 v162, v190, v10
    v_and_b32 v163, v191, v10
    s_and_b32 s61, s66, 0xffffff00
    buffer_load_dwordx4 v[104:107], v2, s[16:19], s61 offen
    s_set_gpr_idx_on s75, gpr_idx(SRC2,DST)
    v_pk_fma_f32 v[16:17], v[136:137], v[74:75], v[16:17] op_sel:[0,1,0] op_sel_hi:[1,1,1]
    v_pk_fma_f32 v[18:19], v[138:139], v[74:75], v[18:19] op_sel:[0,1,0] op_sel_hi:[1,1,1]
    v_pk_fma_f32 v[20:21], v[140:141], v[90:91], v[20:21] op_sel:[0,1,0] op_sel_hi:[1,1,1]
    v_pk_fma_f32 v[22:23], v[142:143], v[90:91], v[22:23] op_sel:[0,1,0] op_sel_hi:[1,1,1]
    s_set_gpr_idx_off
    s_cmp_le_u32 s53, 12
    s_cbranch_scc1 L_swept
    s_waitcnt vmcnt(5)
    v_mfma_f32_16x16x16_bf16 v[136:139], v[162:163], v[116:117], 0
    v_readlane_b32 s67, v196, 13
    v_cvt_pk_bf16_f32 v9, v158, v158
    v_mfma_f32_16x16x16_bf16 v[140:143], v[162:163], v[118:119], 0
    v_and_b32 v160, v190, v9
    v_and_b32 v161, v191, v9
    s_and_b32 s61, s67, 0xffffff00
    buffer_load_dwordx4 v[108:111], v2, s[16:19], s61 offen
    s_set_gpr_idx_on s76, gpr_idx(SRC2,DST)
    v_pk_fma_f32 v[16:17], v[128:129], v[76:77], v[16:17] op_sel_hi:[1,0,1]
    v_pk_fma_f32 v[18:19], v[130:131], v[76:77], v[18:19] op_sel_hi:[1,0,1]
    v_pk_fma_f32 v[20:21], v[132:133], v[92:93], v[20:21] op_sel_hi:[1,0,1]
    v_pk_fma_f32 v[22:23], v[134:135], v[92:93], v[22:23] op_sel_hi:[1,0,1]
    s_set_gpr_idx_off
    s_waitcnt vmcnt(5)
    v_mfma_f32_16x16x16_bf16 v[128:131], v[160:161], v[120:121], 0
    v_readlane_b32 s68, v196, 14
    v_cvt_pk_bf16_f32 v10, v159, v159
    v_mfma_f32_16x16x16_bf16 v[132:135], v[160:161], v[122:123], 0
    v_and_b32 v162, v190, v10
    v_and_b32 v163, v191, v10
    s_and_b32 s61, s68, 0xffffff00
    buffer_load_dwordx4 v[112:115], v2, s[16:19], s61 offen
    s_set_gpr_idx_on s77, gpr_idx(SRC2,DST)
    v_pk_fma_f32 v[16:17], v[136:137], v[76:77], v[16:17] op_sel:[0,1,0] op_sel_hi:[1,1,1]
    v_pk_fma_f32 v[18:19], v[138:139], v[76:77], v[18:19] op_sel:[0,1,0] op_sel_hi:[1,1,1]
    v_pk_fma_f32 v[20:21], v[140:141], v[92:93], v[20:21] op_sel:[0,1,0] op_sel_hi:[1,1,1]
    v_pk_fma_f32 v[22:23], v[142:143], v[92:93], v[22:23] op_sel:[0,1,0] op_sel_hi:[1,1,1]
    s_set_gpr_idx_off
    s_waitcnt vmcnt(5)
    v_mfma_f32_16x16x16_bf16 v[136:139], v[162:163], v[124:125], 0
    v_readlane_b32 s69, v196, 15
    v_mfma_f32_16x16x16_bf16 v[140:143], v[162:163], v[126:127], 0
    s_and_b32 s61, s69, 0xffffff00
    buffer_load_dwordx4 v[116:119], v2, s[16:19], s61 offen
    s_set_gpr_idx_on s78, gpr_idx(SRC2,DST)
    v_pk_fma_f32 v[16:17], v[128:129], v[78:79], v[16:17] op_sel_hi:[1,0,1]
    v_pk_fma_f32 v[18:19], v[130:131], v[78:79], v[18:19] op_sel_hi:[1,0,1]
    v_pk_fma_f32 v[20:21], v[132:133], v[94:95], v[20:21] op_sel_hi:[1,0,1]
    v_pk_fma_f32 v[22:23], v[134:135], v[94:95], v[22:23] op_sel_hi:[1,0,1]
    s_set_gpr_idx_off
    s_set_gpr_idx_on s79, gpr_idx(SRC2,DST)
    v_pk_fma_f32 v[16:17], v[136:137], v[78:79], v[16:17] op_sel:[0,1,0] op_sel_hi:[1,1,1]
    v_pk_fma_f32 v[18:19], v[138:139], v[78:79], v[18:19] op_sel:[0,1,0] op_sel_hi:[1,1,1]
    v_pk_fma_f32 v[20:21], v[140:141], v[94:95], v[20:21] op_sel:[0,1,0] op_sel_hi:[1,1,1]
    v_pk_fma_f32 v[22:23], v[142:143], v[94:95], v[22:23] op_sel:[0,1,0] op_sel_hi:[1,1,1]
    s_set_gpr_idx_off
    s_sub_i32 s53, s53, 16
    s_cmp_gt_i32 s53, 0
    s_cbranch_scc1 L_loop
L_swept:
    s_nop 7
    s_add_u32 s48, s48, 1536
    s_cmp_lt_u32 s48, s47
    s_cbranch_scc1 L_again
    v_lshlrev_b32 v8, 2, v1
    s_lshr_b32 s54, s56, 1
    s_and_b32 s54, s54, 0xc0
    s_lshl_b32 s55, s56, 3
    s_or_b32 s54, s54, s55
    s_xor_b32 s55, s54, 0
    v_cvt_pk_bf16_f32 v64, v16, v20
    v_xor_b32 v68, s55, v8
    ds_write_b32 v68, v64 offset:0
    s_xor_b32 s55, s54, 16
    v_cvt_pk_bf16_f32 v65, v17, v21
    v_xor_b32 v69, s55, v8
    ds_write_b32 v69, v65 offset:256
    s_xor_b32 s55, s54, 32
    v_cvt_pk_bf16_f32 v66, v18, v22
    v_xor_b32 v70, s55, v8
    ds_write_b32 v70, v66 offset:512
    s_xor_b32 s55, s54, 48
    v_cvt_pk_bf16_f32 v67, v19, v23
    v_xor_b32 v71, s55, v8
    ds_write_b32 v71, v67 offset:768
    s_lshr_b32 s54, s57, 1
    s_and_b32 s54, s54, 0xc0
    s_lshl_b32 s55, s57, 3
    s_or_b32 s54, s54, s55
    s_xor_b32 s55, s54, 0
    v_cvt_pk_bf16_f32 v72, v24, v28
    v_xor_b32 v76, s55, v8
    ds_write_b32 v76, v72 offset:0
    s_xor_b32 s55, s54, 16
    v_cvt_pk_bf16_f32 v73, v25, v29
    v_xor_b32 v77, s55, v8
    ds_write_b32 v77, v73 offset:256
    s_xor_b32 s55, s54, 32
    v_cvt_pk_bf16_f32 v74, v26, v30
    v_xor_b32 v78, s55, v8
    ds_write_b32 v78, v74 offset:512
    s_xor_b32 s55, s54, 48
    v_cvt_pk_bf16_f32 v75, v27, v31
    v_xor_b32 v79, s55, v8
    ds_write_b32 v79, v75 offset:768
    s_lshr_b32 s54, s58, 1
    s_and_b32 s54, s54, 0xc0
    s_lshl_b32 s55, s58, 3
    s_or_b32 s54, s54, s55
    s_xor_b32 s55, s54, 0
    v_cvt_pk_bf16_f32 v80, v32, v36
    v_xor_b32 v84, s55, v8
    ds_write_b32 v84, v80 offset:0
    s_xor_b32 s55, s54, 16
    v_cvt_pk_bf16_f32 v81, v33, v37
    v_xor_b32 v85, s55, v8
    ds_write_b32 v85, v81 offset:256
    s_xor_b32 s55, s54, 32
    v_cvt_pk_bf16_f32 v82, v34, v38
    v_xor_b32 v86, s55, v8
    ds_write_b32 v86, v82 offset:512
    s_xor_b32 s55, s54, 48
    v_cvt_pk_bf16_f32 v83, v35, v39
    v_xor_b32 v87, s55, v8
    ds_write_b32 v87, v83 offset:768
    s_lshr_b32 s54, s59, 1
    s_and_b32 s54, s54, 0xc0
    s_lshl_b32 s55, s59, 3
    s_or_b32 s54, s54, s55
    s_xor_b32 s55, s54, 0
    v_cvt_pk_bf16_f32 v88, v40, v44
    v_xor_b32 v92, s55, v8
    ds_write_b32 v92, v88 offset:0
    s_xor_b32 s55, s54, 16
    v_cvt_pk_bf16_f32 v89, v41, v45
    v_xor_b32 v93, s55, v8
    ds_write_b32 v93, v89 offset:256
    s_xor_b32 s55, s54, 32
    v_cvt_pk_bf16_f32 v90, v42, v46
    v_xor_b32 v94, s55, v8
    ds_write_b32 v94, v90 offset:512
    s_xor_b32 s55, s54, 48
    v_cvt_pk_bf16_f32 v91, v43, v47
    v_xor_b32 v95, s55, v8
    ds_write_b32 v95, v91 offset:768
    s_lshr_b32 s54, s60, 1
    s_and_b32 s54, s54, 0xc0
    s_lshl_b32 s55, s60, 3
    s_or_b32 s54, s54, s55
    s_xor_b32 s55, s54, 0
    v_cvt_pk_bf16_f32 v64, v48, v52
    v_xor_b32 v68, s55, v8
    ds_write_b32 v68, v64 offset:0
    s_xor_b32 s55, s54, 16
    v_cvt_pk_bf16_f32 v65, v49, v53
    v_xor_b32 v69, s55, v8
    ds_write_b32 v69, v65 offset:256
    s_xor_b32 s55, s54, 32
    v_cvt_pk_bf16_f32 v66, v50, v54
    v_xor_b32 v70, s55, v8
    ds_write_b32 v70, v66 offset:512
    s_xor_b32 s55, s54, 48
    v_cvt_pk_bf16_f32 v67, v51, v55
    v_xor_b32 v71, s55, v8
    ds_write_b32 v71, v67 offset:768
    v_and_b32 v8, 15, v1
    v_lshrrev_b32 v9, 4, v1
    v_xor_b32 v10, v8, v9
    v_lshlrev_b32 v10, 4, v10
    v_lshl_add_u32 v10, v8, 8, v10
    s_lshr_b32 s54, s3, 2
    s_mul_i32 s54, s54, 20480
    v_add_u32 v10, s54, v10
    v_xor_b32 v11, 64, v10
    v_xor_b32 v12, 128, v10
    v_xor_b32 v13, 192, v10
    v_lshlrev_b32 v9, 10, v9
    v_lshl_add_u32 v9, v8, 2, v9
    s_and_b32 s55, s3, 3
    s_lshl_b32 s55, s55, 6
    s_add_u32 s54, s54, s55
    s_waitcnt vmcnt(0) lgkmcnt(0)
    s_barrier
    ds_read_b128 v[16:19], v10 offset:0
    ds_read_b128 v[20:23], v11 offset:0
    ds_read_b128 v[24:27], v12 offset:0
    ds_read_b128 v[28:31], v13 offset:0
    ds_read_b128 v[32:35], v10 offset:4096
    ds_read_b128 v[36:39], v11 offset:4096
    ds_read_b128 v[40:43], v12 offset:4096
    ds_read_b128 v[44:47], v13 offset:4096
    ds_read_b128 v[48:51], v10 offset:8192
    ds_read_b128 v[52:55], v11 offset:8192
    ds_read_b128 v[56:59], v12 offset:8192
    ds_read_b128 v[60:63], v13 offset:8192
    ds_read_b128 v[64:67], v10 offset:12288
    ds_read_b128 v[68:71], v11 offset:12288
    ds_read_b128 v[72:75], v12 offset:12288
    ds_read_b128 v[76:79], v13 offset:12288
    ds_read_b128 v[80:83], v10 offset:16384
    ds_read_b128 v[84:87], v11 offset:16384
    ds_read_b128 v[88:91], v12 offset:16384
    ds_read_b128 v[92:95], v13 offset:16384
    s_waitcnt lgkmcnt(15)
    v_mfma_f32_16x16x32_bf16 v[128:131], v[16:19], v[208:211], 0
    v_mfma_f32_16x16x32_bf16 v[132:135], v[16:19], v[212:215], 0
    v_mfma_f32_16x16x32_bf16 v[128:131], v[20:23], v[216:219], v[128:131]
    v_mfma_f32_16x16x32_bf16 v[132:135], v[20:23], v[220:223], v[132:135]
    v_mfma_f32_16x16x32_bf16 v[128:131], v[24:27], v[224:227], v[128:131]
    v_mfma_f32_16x16x32_bf16 v[132:135], v[24:27], v[228:231], v[132:135]
    v_mfma_f32_16x16x32_bf16 v[128:131], v[28:31], v[232:235], v[128:131]
    v_mfma_f32_16x16x32_bf16 v[132:135], v[28:31], v[236:239], v[132:135]
    s_waitcnt lgkmcnt(12)
    v_mfma_f32_16x16x32_bf16 v[136:139], v[32:35], v[208:211], 0
    v_mfma_f32_16x16x32_bf16 v[140:143], v[32:35], v[212:215], 0
    v_mfma_f32_16x16x32_bf16 v[136:139], v[36:39], v[216:219], v[136:139]
    v_mfma_f32_16x16x32_bf16 v[140:143], v[36:39], v[220:223], v[140:143]
    v_mfma_f32_16x16x32_bf16 v[136:139], v[40:43], v[224:227], v[136:139]
    v_mfma_f32_16x16x32_bf16 v[140:143], v[40:43], v[228:231], v[140:143]
    v_mfma_f32_16x16x32_bf16 v[136:139], v[44:47], v[232:235], v[136:139]
    v_mfma_f32_16x16x32_bf16 v[140:143], v[44:47], v[236:239], v[140:143]
    v_cvt_pk_bf16_f32 v96, v128, v132
    buffer_store_dword v96, v9, s[40:43], s54 offen offset:0 sc1
    v_cvt_pk_bf16_f32 v97, v129, v133
    buffer_store_dword v97, v9, s[40:43], s54 offen offset:256 sc1
    v_cvt_pk_bf16_f32 v98, v130, v134
    buffer_store_dword v98, v9, s[40:43], s54 offen offset:512 sc1
    v_cvt_pk_bf16_f32 v99, v131, v135
    buffer_store_dword v99, v9, s[40:43], s54 offen offset:768 sc1
    s_add_u32 s54, s54, 4096
    s_waitcnt lgkmcnt(8)
    v_mfma_f32_16x16x32_bf16 v[144:147], v[48:51], v[208:211], 0
    v_mfma_f32_16x16x32_bf16 v[148:151], v[48:51], v[212:215], 0
    v_mfma_f32_16x16x32_bf16 v[144:147], v[52:55], v[216:219], v[144:147]
    v_mfma_f32_16x16x32_bf16 v[148:151], v[52:55], v[220:223], v[148:151]
    v_mfma_f32_16x16x32_bf16 v[144:147], v[56:59], v[224:227], v[144:147]
    v_mfma_f32_16x16x32_bf16 v[148:151], v[56:59], v[228:231], v[148:151]
    v_mfma_f32_16x16x32_bf16 v[144:147], v[60:63], v[232:235], v[144:147]
    v_mfma_f32_16x16x32_bf16 v[148:151], v[60:63], v[236:239], v[148:151]
    v_cvt_pk_bf16_f32 v100, v136, v140
    buffer_store_dword v100, v9, s[40:43], s54 offen offset:0 sc1
    v_cvt_pk_bf16_f32 v101, v137, v141
    buffer_store_dword v101, v9, s[40:43], s54 offen offset:256 sc1
    v_cvt_pk_bf16_f32 v102, v138, v142
    buffer_store_dword v102, v9, s[40:43], s54 offen offset:512 sc1
    v_cvt_pk_bf16_f32 v103, v139, v143
    buffer_store_dword v103, v9, s[40:43], s54 offen offset:768 sc1
    s_add_u32 s54, s54, 4096
    s_waitcnt lgkmcnt(4)
    v_mfma_f32_16x16x32_bf16 v[152:155], v[64:67], v[208:211], 0
    v_mfma_f32_16x16x32_bf16 v[156:159], v[64:67], v[212:215], 0
    v_mfma_f32_16x16x32_bf16 v[152:155], v[68:71], v[216:219], v[152:155]
    v_mfma_f32_16x16x32_bf16 v[156:159], v[68:71], v[220:223], v[156:159]
    v_mfma_f32_16x16x32_bf16 v[152:155], v[72:75], v[224:227], v[152:155]
    v_mfma_f32_16x16x32_bf16 v[156:159], v[72:75], v[228:231], v[156:159]
    v_mfma_f32_16x16x32_bf16 v[152:155], v[76:79], v[232:235], v[152:155]
    v_mfma_f32_16x16x32_bf16 v[156:159], v[76:79], v[236:239], v[156:159]
    v_cvt_pk_bf16_f32 v104, v144, v148
    buffer_store_dword v104, v9, s[40:43], s54 offen offset:0 sc1
    v_cvt_pk_bf16_f32 v105, v145, v149
    buffer_store_dword v105, v9, s[40:43], s54 offen offset:256 sc1
    v_cvt_pk_bf16_f32 v106, v146, v150
    buffer_store_dword v106, v9, s[40:43], s54 offen offset:512 sc1
    v_cvt_pk_bf16_f32 v107, v147, v151
    buffer_store_dword v107, v9, s[40:43], s54 offen offset:768 sc1
    s_add_u32 s54, s54, 4096
    s_waitcnt lgkmcnt(0)
    v_mfma_f32_16x16x32_bf16 v[160:163], v[80:83], v[208:211], 0
    v_mfma_f32_16x16x32_bf16 v[164:167], v[80:83], v[212:215], 0
    v_mfma_f32_16x16x32_bf16 v[160:163], v[84:87], v[216:219], v[160:163]
    v_mfma_f32_16x16x32_bf16 v[164:167], v[84:87], v[220:223], v[164:167]
    v_mfma_f32_16x16x32_bf16 v[160:163], v[88:91], v[224:227], v[160:163]
    v_mfma_f32_16x16x32_bf16 v[164:167], v[88:91], v[228:231], v[164:167]
    v_mfma_f32_16x16x32_bf16 v[160:163], v[92:95], v[232:235], v[160:163]
    v_mfma_f32_16x16x32_bf16 v[164:167], v[92:95], v[236:239], v[164:167]
    v_cvt_pk_bf16_f32 v108, v152, v156
    buffer_store_dword v108, v9, s[40:43], s54 offen offset:0 sc1
    v_cvt_pk_bf16_f32 v109, v153, v157
    buffer_store_dword v109, v9, s[40:43], s54 offen offset:256 sc1
    v_cvt_pk_bf16_f32 v110, v154, v158
    buffer_store_dword v110, v9, s[40:43], s54 offen offset:512 sc1
    v_cvt_pk_bf16_f32 v111, v155, v159
    buffer_store_dword v111, v9, s[40:43], s54 offen offset:768 sc1
    s_add_u32 s54, s54, 4096
    v_cvt_pk_bf16_f32 v112, v160, v164
    buffer_store_dword v112, v9, s[40:43], s54 offen offset:0 sc1
    v_cvt_pk_bf16_f32 v113, v161, v165
    buffer_store_dword v113, v9, s[40:43], s54 offen offset:256 sc1
    v_cvt_pk_bf16_f32 v114, v162, v166
    buffer_store_dword v114, v9, s[40:43], s54 offen offset:512 sc1
    v_cvt_pk_bf16_f32 v115, v163, v167
    buffer_store_dword v115, v9, s[40:43], s54 offen offset:768 sc1
    s_add_u32 s54, s54, 4096
    s_or_b32 s4, s2, s3
    s_cbranch_scc1 L_notag
    v_mov_b32 v8, s62
    v_lshlrev_b32 v10, 2, v1
    s_mov_b32 s54, 524288
    buffer_store_dword v8, v10, s[20:23], s54 offen sc1
L_notag:
L_done:
    s_endpgm
L_again:
    s_waitcnt vmcnt(0) lgkmcnt(0)
    s_barrier
    v_lshlrev_b32 v11, 2, v0
    v_mov_b32 v12, 0x00700000
    v_mov_b32 v13, 0
    ds_write_b32 v11, v12 offset:0
    ds_write_b32 v11, v12 offset:2048
    ds_write_b32 v11, v12 offset:4096
    ds_write_b32 v11, v13 offset:6144
    ds_write_b32 v11, v13 offset:8192
    ds_write_b32 v11, v13 offset:10240
    s_waitcnt lgkmcnt(0)
    s_barrier
    s_branch L_round
L_map2:
    v_add_u32 v8, 56, v8
    v_subrev_u32 v10, 14, v10
    s_branch L_map
L_rank2:
    ds_read_b32 v96, v15 offset:6144
    ds_read_b32 v97, v15 offset:6272
    ds_read_b32 v98, v15 offset:6400
    ds_read_b32 v99, v15 offset:6528
    ds_read_b32 v100, v15 offset:6656
    s_waitcnt lgkmcnt(0)
L_end:
    s_branch L_ranked
.section .rodata,"a"
.p2align 6
.amdhsa_kernel gather_scatter__tensor_product_equiv_mace__graph_kernel
  .amdhsa_next_free_vgpr 240
  .amdhsa_next_free_sgpr 102
  .amdhsa_accum_offset 240
  .amdhsa_group_segment_fixed_size 0
  .amdhsa_kernarg_size 88
  .amdhsa_user_sgpr_count 2
  .amdhsa_user_sgpr_kernarg_segment_ptr 1
  .amdhsa_system_sgpr_workgroup_id_x 1
  .amdhsa_float_denorm_mode_32 3
.end_amdhsa_kernel
```

```asm
; @launch grid=(256,1,1) block=(512,1,1) lds=125952
.amdgcn_target "amdgcn-amd-amdhsa--gfx950"
.text
.globl gather_scatter__tensor_product_equiv_mace__graph_kernel
.p2align 8
.type gather_scatter__tensor_product_equiv_mace__graph_kernel,@function
gather_scatter__tensor_product_equiv_mace__graph_kernel:
    s_cmp_ge_u32 s2, 256
    s_cbranch_scc1 L_done
    s_load_dwordx4 s[4:7], s[0:1], 8
    s_load_dwordx4 s[8:11], s[0:1], 24
    s_load_dwordx2 s[14:15], s[0:1], 80
    s_load_dwordx2 s[64:65], s[0:1], 0
    s_load_dwordx2 s[66:67], s[0:1], 40
    s_load_dwordx4 s[68:71], s[0:1], 48
    s_load_dwordx2 s[12:13], s[0:1], 64
    v_lshrrev_b32 v8, 6, v0
    v_and_b32 v1, 63, v0
    v_lshlrev_b32 v9, 2, v0
    v_mov_b32 v13, 0
    v_readfirstlane_b32 s3, v8
    ds_write_b32 v9, v13 offset:52224
    ds_write_b32 v9, v13 offset:57344
    s_mul_i32 s54, s2, 5000
    s_mul_i32 s55, s2, 10000
    s_mul_i32 s61, s2, 40000
    v_lshlrev_b32 v2, 4, v1
    v_lshlrev_b32 v10, 3, v0
    v_lshlrev_b32 v15, 4, v0
    v_mov_b32 v6, 1
    s_lshl_b32 s52, s3, 10
    s_add_u32 s52, s52, 76800
    s_movk_i32 s53, 4096
    s_movk_i32 s50, 8192
    s_waitcnt lgkmcnt(0)
    s_add_u32 s32, s6, s54
    s_addc_u32 s33, s7, 0
    s_mov_b32 s34, 5000
    s_mov_b32 s35, 0x20000
    buffer_load_dword v64, v9, s[32:35], 0 offen offset:0 nt
    buffer_load_dword v65, v9, s[32:35], 0 offen offset:2048 nt
    buffer_load_dword v66, v9, s[32:35], s53 offen nt
    s_add_u32 s36, s4, s54
    s_addc_u32 s37, s5, 0
    s_mov_b32 s38, 5000
    s_mov_b32 s39, 0x20000
    buffer_load_dword v68, v9, s[36:39], 0 offen offset:0 nt
    buffer_load_dword v69, v9, s[36:39], 0 offen offset:2048 nt
    buffer_load_dword v70, v9, s[36:39], s53 offen nt
    s_load_dword s62, s[14:15], 524288
    s_getpc_b64 s[80:81]
L_pc:
    s_and_b32 s54, s2, 0xf8
    s_lshl_b32 s54, s54, 6
    v_and_b32 v11, 0x180, v10
    v_add_u32 v11, s54, v11
    v_min_u32 v11, L_end-L_pc, v11
    v_mov_b32 v113, s81
    v_add_co_u32 v112, vcc, s80, v11
    s_nop 1
    v_addc_co_u32 v113, vcc, 0, v113, vcc
    global_load_dword v205, v[112:113], off
    s_add_u32 s96, s8, s55
    s_addc_u32 s97, s9, 0
    s_mov_b32 s98, 10000
    s_mov_b32 s99, 0x20000
    s_add_u32 s28, s10, s61
    s_addc_u32 s29, s11, 0
    s_mov_b32 s30, 40000
    s_mov_b32 s31, 0x20000
    s_barrier
    buffer_load_dwordx2 v[72:73], v10, s[96:99], 0 offen nt
    buffer_load_dwordx2 v[74:75], v10, s[96:99], s53 offen nt
    buffer_load_dwordx2 v[76:77], v10, s[96:99], s50 offen nt
    s_add_u32 m0, s52, 0
    s_mov_b32 s54, 0
    buffer_load_dwordx4 v15, s[28:31], s54 offen nt lds
    s_add_u32 m0, s52, 8192
    s_mov_b32 s54, 8192
    buffer_load_dwordx4 v15, s[28:31], s54 offen nt lds
    s_add_u32 m0, s52, 16384
    s_mov_b32 s54, 16384
    buffer_load_dwordx4 v15, s[28:31], s54 offen nt lds
    s_mov_b32 s72, 109951168
    s_movk_i32 s73, 625
    s_movk_i32 s74, 838
    s_movk_i32 s54, 226
    v_cmp_gt_u32 s[84:85], s54, v0
    v_lshlrev_b32 v11, 2, v0
    v_mov_b32 v12, 0x00700000
    v_mov_b32 v13, 0
    ds_write_b32 v11, v12 offset:0
    ds_write_b32 v11, v12 offset:2048
    ds_write_b32 v11, v12 offset:4096
    ds_write_b32 v11, v13 offset:6144
    ds_write_b32 v11, v13 offset:8192
    ds_write_b32 v11, v13 offset:10240
    ds_write_b32 v11, v13 offset:12288
    v_mov_b32 v16, 0
    v_mov_b32 v17, 0
    v_mov_b32 v18, 0
    v_mov_b32 v19, 0
    v_mov_b32 v20, 0
    v_mov_b32 v21, 0
    v_mov_b32 v22, 0
    v_mov_b32 v23, 0
    v_mov_b32 v24, 0
    v_mov_b32 v25, 0
    v_mov_b32 v26, 0
    v_mov_b32 v27, 0
    v_mov_b32 v28, 0
    v_mov_b32 v29, 0
    v_mov_b32 v30, 0
    v_mov_b32 v31, 0
    v_mov_b32 v32, 0
    v_mov_b32 v33, 0
    v_mov_b32 v34, 0
    v_mov_b32 v35, 0
    v_mov_b32 v36, 0
    v_mov_b32 v37, 0
    v_mov_b32 v38, 0
    v_mov_b32 v39, 0
    v_mov_b32 v40, 0
    v_mov_b32 v41, 0
    v_mov_b32 v42, 0
    v_mov_b32 v43, 0
    v_mov_b32 v44, 0
    v_mov_b32 v45, 0
    v_mov_b32 v46, 0
    v_mov_b32 v47, 0
    v_mov_b32 v48, 0
    v_mov_b32 v49, 0
    v_mov_b32 v50, 0
    v_mov_b32 v51, 0
    v_mov_b32 v52, 0
    v_mov_b32 v53, 0
    v_mov_b32 v54, 0
    v_mov_b32 v55, 0
    v_mov_b32 v56, 0
    v_mov_b32 v57, 0
    v_mov_b32 v58, 0
    v_mov_b32 v59, 0
    v_mov_b32 v60, 0
    v_mov_b32 v61, 0
    v_mov_b32 v62, 0
    v_mov_b32 v63, 0
    s_waitcnt vmcnt(10)
    v_mul_hi_u32 v80, v64, s72
    v_mul_hi_u32 v81, v65, s72
    v_mul_hi_u32 v82, v66, s72
    v_lshlrev_b32 v84, 2, v80
    ds_add_rtn_u32 v88, v84, v6 offset:52224
    v_lshlrev_b32 v85, 2, v81
    ds_add_rtn_u32 v89, v85, v6 offset:52224
    v_lshlrev_b32 v86, 2, v82
    s_mov_b64 exec, s[84:85]
    ds_add_rtn_u32 v90, v86, v6 offset:52224
    s_mov_b64 exec, -1
    s_waitcnt lgkmcnt(0)
    s_barrier
    ds_read_b128 v[100:103], v2 offset:52224
    s_add_u32 m0, s52, 24576
    s_mov_b32 s54, 24576
    buffer_load_dwordx4 v15, s[28:31], s54 offen nt lds
    s_add_u32 m0, s52, 32768
    s_mov_b32 s54, 32768
    buffer_load_dwordx4 v15, s[28:31], s54 offen nt lds
    v_mad_u32_u24 v92, v80, s73, 15
    v_lshrrev_b32 v92, 4, v92
    v_sub_u32 v92, v64, v92
    v_lshrrev_b32 v80, 3, v80
    v_and_b32 v80, 28, v80
    v_mad_u32_u24 v93, v81, s73, 15
    v_lshrrev_b32 v93, 4, v93
    v_sub_u32 v93, v65, v93
    v_lshrrev_b32 v81, 3, v81
    v_and_b32 v81, 28, v81
    v_mad_u32_u24 v94, v82, s73, 15
    v_lshrrev_b32 v94, 4, v94
    v_sub_u32 v94, v66, v94
    v_lshrrev_b32 v82, 3, v82
    v_and_b32 v82, 28, v82
    s_waitcnt lgkmcnt(0)
    v_add_u32 v11, v100, v101
    v_add3_u32 v11, v11, v102, v103
    v_mov_b32 v12, v11
    s_nop 1
    v_add_u32_dpp v12, v12, v12 row_shr:1 row_mask:0xf bank_mask:0xf
    s_nop 1
    v_add_u32_dpp v12, v12, v12 row_shr:2 row_mask:0xf bank_mask:0xf
    s_nop 1
    v_add_u32_dpp v12, v12, v12 row_shr:4 row_mask:0xf bank_mask:0xf
    s_nop 1
    v_add_u32_dpp v12, v12, v12 row_shr:8 row_mask:0xf bank_mask:0xf
    s_nop 1
    v_add_u32_dpp v12, v12, v12 row_bcast:15 row_mask:0xa bank_mask:0xf
    s_nop 1
    v_add_u32_dpp v12, v12, v12 row_bcast:31 row_mask:0xc bank_mask:0xf
    v_sub_u32 v104, v12, v11
    v_add_u32 v105, v104, v100
    v_add_u32 v106, v105, v101
    v_add_u32 v107, v106, v102
    ds_write_b128 v2, v[104:107] offset:53248
    ds_read_b32 v108, v84 offset:53248
    ds_read_b32 v109, v85 offset:53248
    ds_read_b32 v110, v86 offset:53248
    s_waitcnt vmcnt(9)
    v_mul_u32_u24 v96, s74, v68
    v_lshrrev_b32 v96, 18, v96
    v_sub_u32 v96, v96, v80
    v_and_b32 v96, 31, v96
    v_lshl_or_b32 v96, v92, 5, v96
    v_lshlrev_b32 v96, 21, v96
    v_lshl_or_b32 v96, v68, 7, v96
    v_mul_u32_u24 v97, s74, v69
    v_lshrrev_b32 v97, 18, v97
    v_sub_u32 v97, v97, v81
    v_and_b32 v97, 31, v97
    v_lshl_or_b32 v97, v93, 5, v97
    v_lshlrev_b32 v97, 21, v97
    v_lshl_or_b32 v97, v69, 7, v97
    v_mul_u32_u24 v98, s74, v70
    v_lshrrev_b32 v98, 18, v98
    v_sub_u32 v98, v98, v82
    v_and_b32 v98, 31, v98
    v_lshl_or_b32 v98, v94, 5, v98
    v_lshlrev_b32 v98, 21, v98
    v_lshl_or_b32 v98, v70, 7, v98
    v_lshlrev_b32 v92, 5, v0
    v_add_u32 v93, 16384, v92
    v_add_u32 v94, 32768, v92
    s_mov_b32 s55, 59392
    s_waitcnt vmcnt(5) lgkmcnt(0)
    v_add_u32 v108, v108, v88
    v_lshlrev_b32 v84, 2, v108
    v_mad_u32_u24 v108, v108, 12, s55
    ds_write_b32 v84, v92 offset:54272
    ds_write2_b32 v108, v72, v73 offset0:0 offset1:1
    ds_write_b32 v108, v96 offset:8
    v_add_u32 v109, v109, v89
    v_lshlrev_b32 v85, 2, v109
    v_mad_u32_u24 v109, v109, 12, s55
    ds_write_b32 v85, v93 offset:54272
    ds_write2_b32 v109, v74, v75 offset0:0 offset1:1
    ds_write_b32 v109, v97 offset:8
    v_add_u32 v110, v110, v90
    v_lshlrev_b32 v86, 2, v110
    v_mad_u32_u24 v110, v110, 12, s55
    s_mov_b64 exec, s[84:85]
    ds_write_b32 v86, v94 offset:54272
    ds_write2_b32 v110, v76, v77 offset0:0 offset1:1
    ds_write_b32 v110, v98 offset:8
    s_mov_b64 exec, -1
    s_mul_i32 s62, s62, 0x9e3779b1
    s_add_u32 s62, s62, 0x7f4a7c15
    s_mul_i32 s63, s62, 0x85ebca6b
    s_and_b32 s63, s63, 0xffc00000
    ds_read_b64 v[100:101], v10 offset:52224
    ds_read_b64 v[104:105], v10 offset:53248
    s_mul_i32 s54, s2, 15360
    s_add_u32 s54, s54, 1048576
    s_add_u32 s32, s14, s54
    s_addc_u32 s33, s15, 0
    s_mov_b32 s34, 15360
    s_mov_b32 s35, 0x20000
    s_mul_i32 s54, s2, 40960
    s_add_u32 s54, s54, 5242880
    s_add_u32 s36, s14, s54
    s_addc_u32 s37, s15, 0
    s_mov_b32 s38, 40000
    s_mov_b32 s39, 0x20000
    v_lshrrev_b32 v11, 1, v0
    v_lshlrev_b32 v11, 2, v11
    v_and_b32 v12, 1, v0
    v_lshlrev_b32 v12, 4, v12
    v_add_u32 v12, 76800, v12
    v_add_u32 v14, 59392, v15
    s_waitcnt lgkmcnt(0)
    s_barrier
    ds_read_b128 v[128:131], v14
    ds_read_b128 v[132:135], v14 offset:8192
    ds_read_b32 v156, v11 offset:54272
    ds_read_b32 v157, v11 offset:55296
    ds_read_b32 v158, v11 offset:56320
    ds_read_b32 v159, v11 offset:57344
    ds_read_b32 v160, v11 offset:58368
    s_mov_b32 s40, s70
    s_mov_b32 s41, s71
    s_mov_b32 s42, 32768
    s_mov_b32 s43, 0x20000
    s_lshl_b32 s54, s3, 12
    s_add_u32 m0, s54, 19456
    s_nop 0
    buffer_load_dwordx4 v2, s[40:43], s54 offen offset:0 lds
    buffer_load_dwordx4 v2, s[40:43], s54 offen offset:1024 lds
    buffer_load_dwordx4 v2, s[40:43], s54 offen offset:2048 lds
    buffer_load_dwordx4 v2, s[40:43], s54 offen offset:3072 lds
    s_mov_b32 s16, s68
    s_mov_b32 s17, s69
    s_mov_b32 s18, 4096
    s_mov_b32 s19, 0x20000
    s_and_b32 s54, s3, 3
    s_lshl_b32 s54, s54, 10
    s_add_u32 m0, s54, 15360
    s_nop 0
    buffer_load_dwordx4 v2, s[16:19], s54 offen lds
    v_lshrrev_b32 v7, 4, v1
    v_lshlrev_b32 v7, 5, v7
    v_and_b32 v120, 3, v1
    v_lshl_add_u32 v7, v120, 1, v7
    global_load_ushort v120, v7, s[66:67] offset:0
    global_load_ushort v121, v7, s[66:67] offset:8
    global_load_ushort v122, v7, s[66:67] offset:16
    global_load_ushort v123, v7, s[66:67] offset:24
    s_waitcnt lgkmcnt(0)
    v_add_u32 v156, v12, v156
    v_add_u32 v157, v12, v157
    v_add_u32 v158, v12, v158
    v_add_u32 v159, v12, v159
    v_add_u32 v160, v12, v160
    v_lshl_or_b32 v112, v100, 11, v104
    v_or_b32 v112, s63, v112
    v_mov_b32 v113, s62
    v_lshl_or_b32 v114, v101, 11, v105
    v_or_b32 v114, s63, v114
    v_mov_b32 v115, s62
    s_and_b32 s44, s2, 7
    s_lshl_b32 s44, s44, 5
    s_lshr_b32 s54, s2, 3
    s_add_u32 s44, s44, s54
    s_mul_i32 s45, s44, 625
    s_add_u32 s46, s45, 640
    s_add_u32 s45, s45, 15
    s_lshr_b32 s45, s45, 4
    s_lshr_b32 s46, s46, 4
    s_sub_u32 s46, s46, s45
    s_mov_b32 s86, 0x0f0f0f0f
    s_mov_b32 s87, 0x0f0f0f0f
    s_mov_b32 s88, 0xf0f0f0f0
    s_mov_b32 s89, 0xf0f0f0f0
    v_mov_b32 v164, 0
    v_mov_b32 v165, 0
    v_mov_b32 v166, 0
    v_mov_b32 v167, 0
    v_mov_b32 v168, 0
    v_mov_b32 v169, 0
    v_mov_b32 v170, 0
    v_mov_b32 v171, 0
    v_and_b32 v11, 4, v1
    v_lshlrev_b32 v11, 2, v11
    v_mov_b32 v12, 0xffff
    v_lshlrev_b32 v12, v11, v12
    v_bfe_i32 v11, v1, 3, 1
    v_and_b32 v191, v11, v12
    v_xor_b32 v190, v191, v12
    v_lshrrev_b32 v200, 5, v1
    v_lshlrev_b32 v200, 4, v200
    v_add_u32 v200, 76800, v200
    v_and_b32 v201, 15, v1
    v_lshlrev_b32 v201, 2, v201
    v_bfe_u32 v11, v1, 3, 2
    v_and_b32 v12, 3, v1
    v_lshl_add_u32 v11, v11, 2, v12
    v_lshlrev_b32 v202, 2, v11
    s_cmp_eq_u32 s46, 40
    v_mov_b32 v203, 0
    s_mov_b32 s54, 671321104
    s_cselect_b32 s54, 276856880, s54
    s_mov_b32 exec_lo, 31
    s_mov_b32 exec_hi, 0
    v_mov_b32 v203, s54
    s_mov_b32 s54, 405087304
    s_cselect_b32 s54, 159876648, s54
    s_mov_b32 exec_lo, 992
    s_mov_b32 exec_hi, 0
    v_mov_b32 v203, s54
    s_mov_b32 s54, 424579168
    s_cselect_b32 s54, 296066625, s54
    s_mov_b32 exec_lo, 31744
    s_mov_b32 exec_hi, 0
    v_mov_b32 v203, s54
    s_mov_b32 s54, 577443961
    s_cselect_b32 s54, 980068482, s54
    s_mov_b32 exec_lo, 1015808
    s_mov_b32 exec_hi, 0
    v_mov_b32 v203, s54
    s_mov_b32 s54, 600547466
    s_cselect_b32 s54, 466166449, s54
    s_mov_b32 exec_lo, 32505856
    s_mov_b32 exec_hi, 0
    v_mov_b32 v203, s54
    s_mov_b32 s54, 734837403
    s_cselect_b32 s54, 590166779, s54
    s_mov_b32 exec_lo, 1040187392
    s_mov_b32 exec_hi, 0
    v_mov_b32 v203, s54
    s_mov_b32 s54, 481444091
    s_cselect_b32 s54, 754136323, s54
    s_mov_b32 exec_lo, 3221225472
    s_mov_b32 exec_hi, 7
    v_mov_b32 v203, s54
    s_mov_b32 s54, 338903356
    s_cselect_b32 s54, 76598556, s54
    s_mov_b32 exec_lo, 0
    s_mov_b32 exec_hi, 248
    v_mov_b32 v203, s54
    s_mov_b64 exec, -1
    v_mul_u32_u24 v11, 52, v1
    v_lshrrev_b32 v11, 8, v11
    v_mad_i32_i24 v11, v11, -5, v1
    v_mul_u32_u24 v11, 6, v11
    v_lshrrev_b32 v203, v11, v203
    v_and_b32 v11, 7, v203
    v_bfe_u32 v203, v203, 3, 3
    v_lshlrev_b32 v11, 12, v11
    v_lshl_or_b32 v203, v203, 7, v11
    s_mov_b32 s20, s14
    s_mov_b32 s21, s15
    s_mov_b32 s22, 524352
    s_mov_b32 s23, 0x20000
    s_add_u32 s24, s14, 1048576
    s_addc_u32 s25, s15, 0
    s_mov_b32 s26, 3932160
    s_mov_b32 s27, 0x20000
    s_waitcnt vmcnt(9)
    s_barrier
    ds_read_b128 v[136:139], v156
    ds_read_b128 v[140:143], v157
    ds_read_b128 v[144:147], v158
    ds_read_b128 v[148:151], v159
    ds_read_b128 v[152:155], v160
    buffer_store_dwordx4 v[128:131], v15, s[32:35], 0 offen sc1
    buffer_store_dwordx4 v[132:135], v15, s[32:35], s50 offen sc1
    s_mov_b32 s54, 0
    s_waitcnt lgkmcnt(4)
    buffer_store_dwordx4 v[136:139], v15, s[36:39], s54 offen sc1
    s_mov_b32 s54, 8192
    s_waitcnt lgkmcnt(3)
    buffer_store_dwordx4 v[140:143], v15, s[36:39], s54 offen sc1
    s_mov_b32 s54, 16384
    s_waitcnt lgkmcnt(2)
    buffer_store_dwordx4 v[144:147], v15, s[36:39], s54 offen sc1
    s_mov_b32 s54, 24576
    s_waitcnt lgkmcnt(1)
    buffer_store_dwordx4 v[148:151], v15, s[36:39], s54 offen sc1
    s_mov_b32 s54, 32768
    s_waitcnt lgkmcnt(0)
    buffer_store_dwordx4 v[152:155], v15, s[36:39], s54 offen sc1
    s_lshl_b32 s54, s2, 11
    s_waitcnt vmcnt(0)
    s_barrier
    s_cmp_ge_u32 s3, 2
    s_cbranch_scc1 L_nopub
    buffer_store_dwordx4 v[112:115], v15, s[20:23], s54 offen sc1
L_nopub:
    s_mov_b32 s16, s64
    s_mov_b32 s17, s65
    s_mov_b32 s18, 10240000
    s_mov_b32 s19, 0x20000
    s_add_u32 s28, s14, 5242880
    s_addc_u32 s29, s15, 0
    s_mov_b32 s30, 10485760
    s_mov_b32 s31, 0x20000
    s_and_b32 s54, s2, 7
    s_mul_i32 s54, s54, 1282048
    s_and_b32 s55, s2, 0xf8
    s_add_u32 s55, s55, s3
    s_mul_i32 s55, s55, 2560
    s_add_u32 s54, s54, s55
    v_min_u32 v14, 19, v1
    v_lshlrev_b32 v14, 7, v14
    buffer_load_dword v7, v14, s[16:19], s54 offen
    v_lshl_or_b32 v188, v121, 16, v120
    v_lshl_or_b32 v189, v123, 16, v122
    v_lshrrev_b32 v8, 5, v1
    v_lshlrev_b32 v8, 11, v8
    v_and_b32 v9, 15, v1
    v_lshl_add_u32 v8, v9, 4, v8
    ds_read_b128 v[64:67], v8 offset:15360
    ds_read_b128 v[68:71], v8 offset:15616
    ds_read_b128 v[72:75], v8 offset:15872
    ds_read_b128 v[76:79], v8 offset:16128
    ds_read_b128 v[80:83], v8 offset:16384
    ds_read_b128 v[84:87], v8 offset:16640
    ds_read_b128 v[88:91], v8 offset:16896
    ds_read_b128 v[92:95], v8 offset:17152
    v_bfe_i32 v10, v1, 4, 1
    v_and_b32 v10, 0x02020202, v10
    v_add_u32 v10, 0x05040100, v10
    v_lshrrev_b32 v8, 4, v1
    v_lshlrev_b32 v8, 13, v8
    v_lshl_add_u32 v8, v9, 2, v8
    s_and_b32 s72, s3, 3
    s_lshl_b32 s72, s72, 6
    s_add_u32 s72, s72, 19456
    v_add_u32 v8, s72, v8
    ds_read2st64_b32 v[128:129], v8 offset0:0 offset1:4
    ds_read2st64_b32 v[130:131], v8 offset0:8 offset1:12
    ds_read2st64_b32 v[132:133], v8 offset0:16 offset1:20
    ds_read2st64_b32 v[134:135], v8 offset0:24 offset1:28
    ds_read2st64_b32 v[136:137], v8 offset0:1 offset1:5
    ds_read2st64_b32 v[138:139], v8 offset0:9 offset1:13
    ds_read2st64_b32 v[140:141], v8 offset0:17 offset1:21
    ds_read2st64_b32 v[142:143], v8 offset0:25 offset1:29
    ds_read2st64_b32 v[144:145], v8 offset0:2 offset1:6
    ds_read2st64_b32 v[146:147], v8 offset0:10 offset1:14
    ds_read2st64_b32 v[148:149], v8 offset0:18 offset1:22
    ds_read2st64_b32 v[150:151], v8 offset0:26 offset1:30
    ds_read2st64_b32 v[152:153], v8 offset0:3 offset1:7
    ds_read2st64_b32 v[154:155], v8 offset0:11 offset1:15
    ds_read2st64_b32 v[156:157], v8 offset0:19 offset1:23
    ds_read2st64_b32 v[158:159], v8 offset0:27 offset1:31
    s_mov_b32 s72, 0x05040100
    s_mov_b32 s73, 0x07060302
    s_waitcnt lgkmcnt(15)
    v_perm_b32 v172, v68, v64, v10
    v_perm_b32 v173, v76, v72, v10
    v_perm_b32 v174, v84, v80, v10
    v_perm_b32 v175, v92, v88, v10
    v_perm_b32 v176, v69, v65, v10
    v_perm_b32 v177, v77, v73, v10
    v_perm_b32 v178, v85, v81, v10
    v_perm_b32 v179, v93, v89, v10
    v_perm_b32 v180, v70, v66, v10
    v_perm_b32 v181, v78, v74, v10
    v_perm_b32 v182, v86, v82, v10
    v_perm_b32 v183, v94, v90, v10
    v_perm_b32 v184, v71, v67, v10
    v_perm_b32 v185, v79, v75, v10
    v_perm_b32 v186, v87, v83, v10
    v_perm_b32 v187, v95, v91, v10
    s_waitcnt lgkmcnt(0)
    v_perm_b32 v208, v129, v128, s72
    v_perm_b32 v209, v131, v130, s72
    v_perm_b32 v210, v133, v132, s72
    v_perm_b32 v211, v135, v134, s72
    v_perm_b32 v212, v129, v128, s73
    v_perm_b32 v213, v131, v130, s73
    v_perm_b32 v214, v133, v132, s73
    v_perm_b32 v215, v135, v134, s73
    v_perm_b32 v216, v137, v136, s72
    v_perm_b32 v217, v139, v138, s72
    v_perm_b32 v218, v141, v140, s72
    v_perm_b32 v219, v143, v142, s72
    v_perm_b32 v220, v137, v136, s73
    v_perm_b32 v221, v139, v138, s73
    v_perm_b32 v222, v141, v140, s73
    v_perm_b32 v223, v143, v142, s73
    v_perm_b32 v224, v145, v144, s72
    v_perm_b32 v225, v147, v146, s72
    v_perm_b32 v226, v149, v148, s72
    v_perm_b32 v227, v151, v150, s72
    v_perm_b32 v228, v145, v144, s73
    v_perm_b32 v229, v147, v146, s73
    v_perm_b32 v230, v149, v148, s73
    v_perm_b32 v231, v151, v150, s73
    v_perm_b32 v232, v153, v152, s72
    v_perm_b32 v233, v155, v154, s72
    v_perm_b32 v234, v157, v156, s72
    v_perm_b32 v235, v159, v158, s72
    v_perm_b32 v236, v153, v152, s73
    v_perm_b32 v237, v155, v154, s73
    v_perm_b32 v238, v157, v156, s73
    v_perm_b32 v239, v159, v158, s73
    s_lshl_b32 s54, s45, 10
    s_add_u32 s40, s12, s54
    s_addc_u32 s41, s13, 0
    s_lshl_b32 s42, s46, 10
    s_mov_b32 s43, 0x20000
    v_lshrrev_b32 v9, 1, v0
    v_lshlrev_b32 v10, 11, v9
    s_lshl_b32 s54, s44, 3
    v_mul_u32_u24 v5, 1280, v9
    s_mov_b32 s48, 0
    s_mov_b32 s53, 200000
    s_mov_b32 s55, 0xffc00000
    s_waitcnt vmcnt(0)
    s_barrier
L_poll:
    buffer_load_dwordx2 v[14:15], v10, s[20:23], s54 offen sc1
    s_sub_u32 s53, s53, 1
    s_cbranch_scc1 L_done
    s_waitcnt vmcnt(0)
    v_xor_b32 v11, s63, v14
    v_xor_b32 v12, s62, v15
    v_and_or_b32 v11, v11, s55, v12
    v_cmpx_ne_u32 vcc, 0, v11
    s_cbranch_execnz L_poll
    s_mov_b64 exec, -1
    v_bfe_u32 v3, v14, 11, 11
    v_bfe_i32 v12, v0, 0, 1
    v_and_b32 v11, 0x7ff, v14
    v_and_b32 v4, v3, v12
    v_add_u32 v5, v5, v11
    s_nop 0
    v_add_u32_dpp v4, v4, v4 row_shr:1 row_mask:0xf bank_mask:0xf
    s_nop 1
    v_add_u32_dpp v4, v4, v4 row_shr:2 row_mask:0xf bank_mask:0xf
    s_nop 1
    v_add_u32_dpp v4, v4, v4 row_shr:4 row_mask:0xf bank_mask:0xf
    s_nop 1
    v_add_u32_dpp v4, v4, v4 row_shr:8 row_mask:0xf bank_mask:0xf
    s_nop 1
    v_add_u32_dpp v4, v4, v4 row_bcast:15 row_mask:0xa bank_mask:0xf
    s_nop 1
    v_add_u32_dpp v4, v4, v4 row_bcast:31 row_mask:0xc bank_mask:0xf
    s_mov_b32 exec_lo, 0
    s_brev_b32 exec_hi, 1
    ds_add_rtn_u32 v12, v13, v4 offset:13312
    s_mov_b64 exec, -1
    v_mov_b32_dpp v4, v4 quad_perm:[0,0,2,2] row_mask:0xf bank_mask:0xf
    s_waitcnt lgkmcnt(0)
    v_readlane_b32 s54, v12, 63
    s_nop 1
    v_add_u32 v4, s54, v4
    v_sub_u32 v5, v5, v4
L_round:
    v_subrev_u32 v8, s48, v4
    v_and_b32 v11, 1, v0
    v_add_u32 v10, v8, v3
    v_max_i32 v8, 0, v8
    v_min_i32 v10, 1536, v10
    v_add_u32 v8, v8, v11
    v_sub_u32 v10, v10, v8
    v_lshlrev_b32 v8, 2, v8
    v_add_u32 v9, s48, v5
L_map:
    v_cmp_lt_i32 s[64:65], 0, v10
    v_cmp_lt_i32 s[66:67], 2, v10
    v_cmp_lt_i32 s[68:69], 4, v10
    v_cmp_lt_i32 s[70:71], 6, v10
    v_cmp_lt_i32 s[72:73], 8, v10
    v_cmp_lt_i32 s[74:75], 10, v10
    v_cmp_lt_i32 s[76:77], 12, v10
    v_cmp_lt_i32 s[78:79], 14, v10
    s_mov_b64 exec, s[64:65]
    ds_write_b32 v8, v9 offset:0
    s_mov_b64 exec, s[66:67]
    ds_write_b32 v8, v9 offset:8
    s_mov_b64 exec, s[68:69]
    ds_write_b32 v8, v9 offset:16
    s_mov_b64 exec, s[70:71]
    ds_write_b32 v8, v9 offset:24
    s_mov_b64 exec, s[72:73]
    ds_write_b32 v8, v9 offset:32
    s_mov_b64 exec, s[74:75]
    ds_write_b32 v8, v9 offset:40
    s_mov_b64 exec, s[76:77]
    ds_write_b32 v8, v9 offset:48
    s_mov_b64 exec, -1
    s_cmp_lg_u64 s[78:79], 0
    s_cbranch_scc1 L_map2
    v_lshlrev_b32 v8, 2, v0
    v_lshrrev_b32 v12, 1, v0
    v_lshlrev_b32 v9, 2, v12
    v_lshlrev_b32 v10, 4, v0
    v_mul_u32_u24 v14, 12, v0
    s_waitcnt lgkmcnt(0)
    s_barrier
    ds_read_b32 v64, v8 offset:0
    ds_read_b32 v65, v8 offset:2048
    ds_read_b32 v66, v8 offset:4096
    ds_read_b32 v68, v9 offset:0
    ds_read_b32 v69, v9 offset:1024
    ds_read_b32 v70, v9 offset:2048
    ds_read_b32 v71, v9 offset:3072
    ds_read_b32 v72, v9 offset:4096
    ds_read_b32 v73, v9 offset:5120
    ds_read_b32 v11, v13 offset:13312
    s_waitcnt lgkmcnt(7)
    v_mad_i32_i24 v64, v64, 12, v14
    buffer_load_dwordx3 v[76:78], v64, s[24:27], 0 offen sc1
    v_add_u32 v65, 512, v65
    v_mad_i32_i24 v65, v65, 12, v14
    buffer_load_dwordx3 v[80:82], v65, s[24:27], 0 offen sc1
    v_add_u32 v66, 1024, v66
    v_mad_i32_i24 v66, v66, 12, v14
    buffer_load_dwordx3 v[84:86], v66, s[24:27], 0 offen sc1
    s_waitcnt lgkmcnt(0)
    s_barrier
    v_lshl_add_u32 v68, v68, 5, v10
    v_lshl_add_u32 v69, v69, 5, v10
    v_add_u32 v69, 8192, v69
    v_lshl_add_u32 v70, v70, 5, v10
    v_add_u32 v70, 16384, v70
    v_lshl_add_u32 v71, v71, 5, v10
    v_add_u32 v71, 24576, v71
    v_lshl_add_u32 v72, v72, 5, v10
    v_add_u32 v72, 32768, v72
    v_lshl_add_u32 v73, v73, 5, v10
    v_add_u32 v73, 40960, v73
    s_add_u32 m0, s52, 0
    s_nop 0
    buffer_load_dwordx4 v68, s[28:31], 0 offen sc1 lds
    v_readfirstlane_b32 s47, v11
    s_nop 0
    s_sub_u32 s49, s47, s48
    s_min_u32 s49, s49, 1536
    v_add_u32 v64, 0, v0
    v_cmp_gt_u32 s[80:81], s49, v64
    v_lshlrev_b32 v64, 21, v64
    v_add_u32 v65, 512, v0
    v_cmp_gt_u32 s[82:83], s49, v65
    v_lshlrev_b32 v65, 21, v65
    v_add_u32 v66, 1024, v0
    v_cmp_gt_u32 s[84:85], s49, v66
    v_lshlrev_b32 v66, 21, v66
    v_lshlrev_b32 v8, 2, v1
    v_and_b32 v14, 124, v8
    s_mul_i32 s54, s3, 640
    v_add_u32 v15, s54, v14
    s_mov_b32 s55, 0x1fff80
    v_and_b32 v12, 12, v8
    v_sub_u32 v10, 63, v1
    s_mul_i32 s61, s3, 5
    v_lshlrev_b32 v9, 3, v0
    v_add_u32 v9, 59392, v9
    s_waitcnt vmcnt(3)
    v_lshrrev_b32 v92, 21, v78
    v_lshlrev_b32 v92, 2, v92
    v_lshrrev_b32 v11, 26, v78
    v_lshl_or_b32 v11, v11, 4, v12
    s_mov_b64 exec, s[80:81]
    ds_add_rtn_u32 v88, v92, v6 offset:6144
    ds_add_u32 v11, v6 offset:12288
    s_mov_b64 exec, -1
    v_and_or_b32 v78, v78, s55, v64
    s_waitcnt vmcnt(2)
    v_lshrrev_b32 v93, 21, v82
    v_lshlrev_b32 v93, 2, v93
    v_lshrrev_b32 v11, 26, v82
    v_lshl_or_b32 v11, v11, 4, v12
    s_mov_b64 exec, s[82:83]
    ds_add_rtn_u32 v89, v93, v6 offset:6144
    ds_add_u32 v11, v6 offset:12288
    s_mov_b64 exec, -1
    v_and_or_b32 v82, v82, s55, v65
    s_waitcnt vmcnt(1)
    v_lshrrev_b32 v94, 21, v86
    v_lshlrev_b32 v94, 2, v94
    v_lshrrev_b32 v11, 26, v86
    v_lshl_or_b32 v11, v11, 4, v12
    s_mov_b64 exec, s[84:85]
    ds_add_rtn_u32 v90, v94, v6 offset:6144
    ds_add_u32 v11, v6 offset:12288
    s_mov_b64 exec, -1
    v_and_or_b32 v86, v86, s55, v66
    ds_write_b64 v9, v[76:77] offset:0
    ds_write_b64 v9, v[80:81] offset:4096
    ds_write_b64 v9, v[84:85] offset:8192
    s_add_u32 m0, s52, 8192
    s_nop 0
    buffer_load_dwordx4 v69, s[28:31], 0 offen sc1 lds
    s_add_u32 m0, s52, 16384
    s_nop 0
    buffer_load_dwordx4 v70, s[28:31], 0 offen sc1 lds
    s_waitcnt lgkmcnt(3)
    s_barrier
    s_cmp_lg_u32 s48, 0
    s_cbranch_scc1 L_rank2
    ds_read_b128 v[104:107], v2 offset:12288
    ds_read_b32 v96, v15 offset:6144
    ds_read_b32 v97, v15 offset:6272
    ds_read_b32 v98, v15 offset:6400
    ds_read_b32 v99, v15 offset:6528
    ds_read_b32 v100, v15 offset:6656
    s_add_u32 s65, s61, 1
    s_add_u32 s66, s61, 2
    s_add_u32 s67, s61, 3
    s_add_u32 s68, s61, 4
    s_waitcnt lgkmcnt(5)
    v_add_u32 v9, v104, v105
    v_add3_u32 v9, v9, v106, v107
    v_lshl_or_b32 v9, v9, 6, v10
    s_nop 0
    v_readlane_b32 s64, v9, s61
    v_readlane_b32 s65, v9, s65
    v_readlane_b32 s66, v9, s66
    v_readlane_b32 s67, v9, s67
    v_readlane_b32 s68, v9, s68
    v_cmp_lt_u32 s[70:71], s64, v9
    v_cmp_lt_u32 s[72:73], s65, v9
    v_cmp_lt_u32 s[74:75], s66, v9
    v_cmp_lt_u32 s[76:77], s67, v9
    v_cmp_lt_u32 s[78:79], s68, v9
    s_bcnt1_i32_b64 s64, s[70:71]
    s_bcnt1_i32_b64 s65, s[72:73]
    s_bcnt1_i32_b64 s66, s[74:75]
    s_bcnt1_i32_b64 s67, s[76:77]
    s_bcnt1_i32_b64 s68, s[78:79]
    s_waitcnt lgkmcnt(0)
    v_readlane_b32 s90, v203, s64
    v_readlane_b32 s91, v203, s65
    v_readlane_b32 s92, v203, s66
    v_readlane_b32 s93, v203, s67
    v_readlane_b32 s94, v203, s68
L_ranked:
    s_mov_b32 exec_hi, 0
    s_and_b32 s54, s90, 0x380
    v_add_u32 v104, s54, v14
    ds_add_rtn_u32 v96, v104, v96 offset:11264
    s_and_b32 s54, s91, 0x380
    v_add_u32 v105, s54, v14
    ds_add_rtn_u32 v97, v105, v97 offset:11264
    s_and_b32 s54, s92, 0x380
    v_add_u32 v106, s54, v14
    ds_add_rtn_u32 v98, v106, v98 offset:11264
    s_and_b32 s54, s93, 0x380
    v_add_u32 v107, s54, v14
    ds_add_rtn_u32 v99, v107, v99 offset:11264
    s_and_b32 s54, s94, 0x380
    v_add_u32 v108, s54, v14
    ds_add_rtn_u32 v100, v108, v100 offset:11264
    v_or_b32 v104, s90, v104
    v_or_b32 v105, s91, v105
    v_or_b32 v106, s92, v106
    v_or_b32 v107, s93, v107
    v_or_b32 v108, s94, v108
    s_waitcnt lgkmcnt(4)
    v_lshl_or_b32 v96, v96, 16, v104
    ds_write_b32 v15, v96 offset:6144
    s_waitcnt lgkmcnt(4)
    v_lshl_or_b32 v97, v97, 16, v105
    ds_write_b32 v15, v97 offset:6272
    s_waitcnt lgkmcnt(4)
    v_lshl_or_b32 v98, v98, 16, v106
    ds_write_b32 v15, v98 offset:6400
    s_waitcnt lgkmcnt(4)
    v_lshl_or_b32 v99, v99, 16, v107
    ds_write_b32 v15, v99 offset:6528
    s_waitcnt lgkmcnt(4)
    v_lshl_or_b32 v100, v100, 16, v108
    ds_write_b32 v15, v100 offset:6656
    v_writelane_b32 v11, s90, 0
    v_writelane_b32 v11, s91, 1
    v_writelane_b32 v11, s92, 2
    v_writelane_b32 v11, s93, 3
    v_writelane_b32 v11, s94, 4
    v_add_lshl_u32 v12, v1, s61, 7
    v_lshrrev_b32 v9, 10, v11
    v_bfe_u32 v11, v11, 2, 8
    v_or_b32 v11, v11, v9
    s_mov_b32 exec_lo, 31
    ds_write_b32 v11, v12 offset:13568
    s_mov_b64 exec, -1
    s_add_u32 m0, s52, 24576
    s_nop 0
    buffer_load_dwordx4 v71, s[28:31], 0 offen sc1 lds
    s_add_u32 m0, s52, 32768
    s_nop 0
    buffer_load_dwordx4 v72, s[28:31], 0 offen sc1 lds
    s_add_u32 m0, s52, 40960
    s_nop 0
    buffer_load_dwordx4 v73, s[28:31], 0 offen sc1 lds
    v_lshrrev_b32 v12, 3, v1
    v_mul_u32_u24 v12, 64, v12
    v_add_u32 v12, 52224, v12
    s_lshl_b32 s54, s3, 5
    v_add_u32 v11, s54, v8
    s_waitcnt lgkmcnt(0)
    s_barrier
    ds_read_b128 v[96:99], v2 offset:11264
    ds_read_b32 v92, v92 offset:6144
    ds_read_b32 v93, v93 offset:6144
    ds_read_b32 v94, v94 offset:6144
    ds_read_b32 v11, v11 offset:13568
    s_lshl_b32 s54, s3, 3
    s_add_u32 s55, s54, 7
    s_waitcnt lgkmcnt(4)
    v_add_u32 v9, v96, v97
    v_add3_u32 v9, v9, v98, v99
    v_mov_b32 v10, v9
    s_nop 1
    v_add_u32_dpp v10, v10, v10 row_shr:1 row_mask:0xf bank_mask:0xf
    s_nop 1
    v_add_u32_dpp v10, v10, v10 row_shr:2 row_mask:0xf bank_mask:0xf
    s_nop 1
    v_add_u32_dpp v10, v10, v10 row_shr:4 row_mask:0xf bank_mask:0xf
    s_nop 1
    v_add_u32_dpp v10, v10, v10 row_shr:8 row_mask:0xf bank_mask:0xf
    s_nop 1
    v_add_u32_dpp v10, v10, v10 row_bcast:15 row_mask:0xa bank_mask:0xf
    s_nop 1
    v_add_u32_dpp v10, v10, v10 row_bcast:31 row_mask:0xc bank_mask:0xf
    v_sub_u32 v9, v10, v9
    v_lshl_add_u32 v104, v9, 2, v12
    v_lshl_add_u32 v105, v96, 2, v104
    v_lshl_add_u32 v106, v97, 2, v105
    v_lshl_add_u32 v107, v98, 2, v106
    ds_write_b128 v2, v[104:107] offset:14336
    s_waitcnt lgkmcnt(2)
    v_and_b32 v64, 0x3ff, v92
    ds_read_b32 v64, v64 offset:14336
    v_and_b32 v65, 0x3ff, v93
    ds_read_b32 v65, v65 offset:14336
    v_and_b32 v66, 0x3ff, v94
    ds_read_b32 v66, v66 offset:14336
    v_readlane_b32 s50, v10, s55
    v_readlane_b32 s53, v9, s54
    v_readlane_b32 s51, v104, s54
    v_bfe_u32 v15, v92, 12, 3
    v_or_b32 v78, v15, v78
    v_lshrrev_b32 v92, 16, v92
    v_add_u32 v92, v92, v88
    v_bfe_u32 v15, v93, 12, 3
    v_or_b32 v82, v15, v82
    v_lshrrev_b32 v93, 16, v93
    v_add_u32 v93, v93, v89
    v_bfe_u32 v15, v94, 12, 3
    v_or_b32 v86, v15, v86
    v_lshrrev_b32 v94, 16, v94
    v_add_u32 v94, v94, v90
    s_sub_u32 s50, s50, s53
    s_lshl_b32 s54, s50, 2
    v_add_u32 v198, s51, v201
    v_add_u32 v199, s51, v202
    s_waitcnt lgkmcnt(2)
    v_lshl_add_u32 v92, v92, 2, v64
    s_mov_b64 exec, s[80:81]
    ds_write_b32 v92, v78
    s_mov_b64 exec, -1
    s_waitcnt lgkmcnt(2)
    v_lshl_add_u32 v93, v93, 2, v65
    s_mov_b64 exec, s[82:83]
    ds_write_b32 v93, v82
    s_mov_b64 exec, -1
    s_waitcnt lgkmcnt(2)
    v_lshl_add_u32 v94, v94, 2, v66
    s_mov_b64 exec, s[84:85]
    ds_write_b32 v94, v86
    s_mov_b64 exec, -1
    v_add_u32 v9, s54, v198
    v_mov_b32 v12, 2097029
    ds_write_b32 v9, v12
    v_readlane_b32 s56, v11, 0
    v_readlane_b32 s57, v11, 1
    v_readlane_b32 s58, v11, 2
    v_readlane_b32 s59, v11, 3
    v_readlane_b32 s60, v11, 4
    s_mov_b32 s55, 0x00fffc38
    s_mov_b32 s53, s50
    s_mov_b32 s49, 0xffffff00
    s_mov_b32 s51, 59392
    s_waitcnt vmcnt(0) lgkmcnt(0)
    s_barrier
    ds_read_b32 v196, v198
    ds_read_b32 v194, v199
    ds_read_b32 v197, v198 offset:24
    s_cmp_eq_u32 s50, 0
    s_cbranch_scc1 L_swept
    s_waitcnt lgkmcnt(1)
    v_lshlrev_b32 v196, 3, v196
    v_and_b32 v196, s55, v196
    s_nop 0
    v_readlane_b32 s64, v196, 0
    v_readlane_b32 s65, v196, 1
    v_readlane_b32 s66, v196, 2
    s_and_b32 s61, s64, s49
    buffer_load_dwordx4 v[96:99], v2, s[16:19], s61 offen
    v_readlane_b32 s67, v196, 3
    s_and_b32 s61, s65, s49
    buffer_load_dwordx4 v[100:103], v2, s[16:19], s61 offen
    v_lshrrev_b32 v8, 21, v194
    v_lshl_add_u32 v11, v8, 3, s51
    v_lshl_add_u32 v8, v8, 5, v200
    ds_read_b64 v[192:193], v11
    s_mov_b64 exec, s[86:87]
    ds_read_b128 v[164:167], v8
    s_mov_b64 exec, s[88:89]
    ds_read_b128 v[168:171], v8
    s_mov_b64 exec, -1
    v_readlane_b32 s68, v196, 4
    s_and_b32 s61, s66, s49
    buffer_load_dwordx4 v[104:107], v2, s[16:19], s61 offen
    v_readlane_b32 s69, v196, 5
    s_and_b32 s61, s67, s49
    buffer_load_dwordx4 v[108:111], v2, s[16:19], s61 offen
    s_and_b32 s61, s68, s49
    buffer_load_dwordx4 v[112:115], v2, s[16:19], s61 offen
    s_and_b32 s61, s69, s49
    buffer_load_dwordx4 v[116:119], v2, s[16:19], s61 offen
.p2align 3
L_loop:
    s_waitcnt lgkmcnt(0)
.p2align 3
    v_mfma_f32_4x4x4_16b_bf16 v[144:147], v[192:193], v[188:189], 0 cbsz:4 abid:0
    v_mfma_f32_4x4x4_16b_bf16 v[148:151], v[192:193], v[188:189], 0 cbsz:4 abid:2
    v_mfma_f32_4x4x4_16b_bf16 v[152:155], v[192:193], v[188:189], 0 cbsz:4 abid:4
    v_mfma_f32_4x4x4_16b_bf16 v[156:159], v[192:193], v[188:189], 0 cbsz:4 abid:6
    v_mfma_f32_32x32x16_bf16 v[64:79], v[164:167], v[172:175], 0
    v_lshlrev_b32 v196, 3, v197
    v_and_b32 v196, s55, v196
    v_add_u32 v198, 64, v198
    v_mfma_f32_32x32x16_bf16 v[80:95], v[164:167], v[180:183], 0
    v_add_u32 v199, 64, v199
    ds_read_b32 v197, v198 offset:24
    ds_read_b32 v194, v199
    v_mfma_f32_32x32x16_bf16 v[64:79], v[168:171], v[176:179], v[64:79]
    v_cvt_pk_bf16_f32 v9, v144, v144
    v_and_b32 v160, v190, v9
    v_and_b32 v161, v191, v9
    v_mfma_f32_32x32x16_bf16 v[80:95], v[168:171], v[184:187], v[80:95]
    s_waitcnt vmcnt(5)
.p2align 3
    v_mfma_f32_16x16x16_bf16 v[128:131], v[160:161], v[96:97], 0
    v_readlane_b32 s70, v196, 0
    v_cvt_pk_bf16_f32 v10, v145, v145
    v_mfma_f32_16x16x16_bf16 v[132:135], v[160:161], v[98:99], 0
    v_and_b32 v162, v190, v10
    v_and_b32 v163, v191, v10
    s_and_b32 s61, s70, s49
.p2align 3
    buffer_load_dwordx4 v[120:123], v2, s[16:19], s61 offen
    s_waitcnt vmcnt(5)
.p2align 3
    v_mfma_f32_16x16x16_bf16 v[136:139], v[162:163], v[100:101], 0
    v_readlane_b32 s71, v196, 1
    v_cvt_pk_bf16_f32 v9, v146, v146
    v_mfma_f32_16x16x16_bf16 v[140:143], v[162:163], v[102:103], 0
    v_and_b32 v160, v190, v9
    v_and_b32 v161, v191, v9
    s_and_b32 s61, s71, s49
    s_set_gpr_idx_on s64, gpr_idx(SRC2,DST)
    buffer_load_dwordx4 v[124:127], v2, s[16:19], s61 offen
    v_pk_fma_f32 v[16:17], v[128:129], v[64:65], v[16:17] op_sel_hi:[1,0,1]
    v_pk_fma_f32 v[18:19], v[130:131], v[64:65], v[18:19] op_sel_hi:[1,0,1]
    v_pk_fma_f32 v[20:21], v[132:133], v[80:81], v[20:21] op_sel_hi:[1,0,1]
    v_pk_fma_f32 v[22:23], v[134:135], v[80:81], v[22:23] op_sel_hi:[1,0,1]
    s_set_gpr_idx_off
    s_waitcnt vmcnt(5)
.p2align 3
    v_mfma_f32_16x16x16_bf16 v[128:131], v[160:161], v[104:105], 0
    v_readlane_b32 s72, v196, 2
    v_cvt_pk_bf16_f32 v10, v147, v147
    v_mfma_f32_16x16x16_bf16 v[132:135], v[160:161], v[106:107], 0
    v_and_b32 v162, v190, v10
    v_and_b32 v163, v191, v10
    s_waitcnt lgkmcnt(0)
    v_lshrrev_b32 v8, 21, v194
    v_lshl_add_u32 v11, v8, 3, s51
    v_lshl_add_u32 v8, v8, 5, v200
    ds_read_b64 v[192:193], v11
    s_mov_b64 exec, s[86:87]
    ds_read_b128 v[164:167], v8
    s_mov_b64 exec, s[88:89]
    ds_read_b128 v[168:171], v8
    s_mov_b64 exec, -1
.p2align 3
    s_and_b32 s61, s72, s49
    s_set_gpr_idx_on s65, gpr_idx(SRC2,DST)
    buffer_load_dwordx4 v[96:99], v2, s[16:19], s61 offen
    v_pk_fma_f32 v[16:17], v[136:137], v[64:65], v[16:17] op_sel:[0,1,0] op_sel_hi:[1,1,1]
    v_pk_fma_f32 v[18:19], v[138:139], v[64:65], v[18:19] op_sel:[0,1,0] op_sel_hi:[1,1,1]
    v_pk_fma_f32 v[20:21], v[140:141], v[80:81], v[20:21] op_sel:[0,1,0] op_sel_hi:[1,1,1]
    v_pk_fma_f32 v[22:23], v[142:143], v[80:81], v[22:23] op_sel:[0,1,0] op_sel_hi:[1,1,1]
    s_set_gpr_idx_off
    s_waitcnt vmcnt(5)
.p2align 3
    v_mfma_f32_16x16x16_bf16 v[136:139], v[162:163], v[108:109], 0
    v_readlane_b32 s73, v196, 3
    v_cvt_pk_bf16_f32 v9, v148, v148
    v_mfma_f32_16x16x16_bf16 v[140:143], v[162:163], v[110:111], 0
    v_and_b32 v160, v190, v9
    v_and_b32 v161, v191, v9
    s_and_b32 s61, s73, s49
    s_set_gpr_idx_on s66, gpr_idx(SRC2,DST)
    buffer_load_dwordx4 v[100:103], v2, s[16:19], s61 offen
    v_pk_fma_f32 v[16:17], v[128:129], v[66:67], v[16:17] op_sel_hi:[1,0,1]
    v_pk_fma_f32 v[18:19], v[130:131], v[66:67], v[18:19] op_sel_hi:[1,0,1]
    v_pk_fma_f32 v[20:21], v[132:133], v[82:83], v[20:21] op_sel_hi:[1,0,1]
    v_pk_fma_f32 v[22:23], v[134:135], v[82:83], v[22:23] op_sel_hi:[1,0,1]
    s_set_gpr_idx_off
    s_waitcnt vmcnt(5)
.p2align 3
    v_mfma_f32_16x16x16_bf16 v[128:131], v[160:161], v[112:113], 0
    v_readlane_b32 s74, v196, 4
    v_cvt_pk_bf16_f32 v10, v149, v149
    v_mfma_f32_16x16x16_bf16 v[132:135], v[160:161], v[114:115], 0
    v_and_b32 v162, v190, v10
    v_and_b32 v163, v191, v10
    s_and_b32 s61, s74, s49
    s_set_gpr_idx_on s67, gpr_idx(SRC2,DST)
    buffer_load_dwordx4 v[104:107], v2, s[16:19], s61 offen
    v_pk_fma_f32 v[16:17], v[136:137], v[66:67], v[16:17] op_sel:[0,1,0] op_sel_hi:[1,1,1]
    v_pk_fma_f32 v[18:19], v[138:139], v[66:67], v[18:19] op_sel:[0,1,0] op_sel_hi:[1,1,1]
    v_pk_fma_f32 v[20:21], v[140:141], v[82:83], v[20:21] op_sel:[0,1,0] op_sel_hi:[1,1,1]
    v_pk_fma_f32 v[22:23], v[142:143], v[82:83], v[22:23] op_sel:[0,1,0] op_sel_hi:[1,1,1]
    s_set_gpr_idx_off
    s_cmp_le_u32 s53, 4
    s_cbranch_scc1 L_swept
    s_waitcnt vmcnt(5)
.p2align 3
    v_mfma_f32_16x16x16_bf16 v[136:139], v[162:163], v[116:117], 0
    v_readlane_b32 s75, v196, 5
    v_cvt_pk_bf16_f32 v9, v150, v150
    v_mfma_f32_16x16x16_bf16 v[140:143], v[162:163], v[118:119], 0
    v_and_b32 v160, v190, v9
    v_and_b32 v161, v191, v9
    s_and_b32 s61, s75, s49
    s_set_gpr_idx_on s68, gpr_idx(SRC2,DST)
    buffer_load_dwordx4 v[108:111], v2, s[16:19], s61 offen
    v_pk_fma_f32 v[16:17], v[128:129], v[68:69], v[16:17] op_sel_hi:[1,0,1]
    v_pk_fma_f32 v[18:19], v[130:131], v[68:69], v[18:19] op_sel_hi:[1,0,1]
    v_pk_fma_f32 v[20:21], v[132:133], v[84:85], v[20:21] op_sel_hi:[1,0,1]
    v_pk_fma_f32 v[22:23], v[134:135], v[84:85], v[22:23] op_sel_hi:[1,0,1]
    s_set_gpr_idx_off
    s_waitcnt vmcnt(5)
.p2align 3
    v_mfma_f32_16x16x16_bf16 v[128:131], v[160:161], v[120:121], 0
    v_readlane_b32 s76, v196, 6
    v_cvt_pk_bf16_f32 v10, v151, v151
    v_mfma_f32_16x16x16_bf16 v[132:135], v[160:161], v[122:123], 0
    v_and_b32 v162, v190, v10
    v_and_b32 v163, v191, v10
    s_and_b32 s61, s76, s49
    s_set_gpr_idx_on s69, gpr_idx(SRC2,DST)
    buffer_load_dwordx4 v[112:115], v2, s[16:19], s61 offen
    v_pk_fma_f32 v[16:17], v[136:137], v[68:69], v[16:17] op_sel:[0,1,0] op_sel_hi:[1,1,1]
    v_pk_fma_f32 v[18:19], v[138:139], v[68:69], v[18:19] op_sel:[0,1,0] op_sel_hi:[1,1,1]
    v_pk_fma_f32 v[20:21], v[140:141], v[84:85], v[20:21] op_sel:[0,1,0] op_sel_hi:[1,1,1]
    v_pk_fma_f32 v[22:23], v[142:143], v[84:85], v[22:23] op_sel:[0,1,0] op_sel_hi:[1,1,1]
    s_set_gpr_idx_off
    s_waitcnt vmcnt(5)
.p2align 3
    v_mfma_f32_16x16x16_bf16 v[136:139], v[162:163], v[124:125], 0
    v_readlane_b32 s77, v196, 7
    v_cvt_pk_bf16_f32 v9, v152, v152
    v_mfma_f32_16x16x16_bf16 v[140:143], v[162:163], v[126:127], 0
    v_and_b32 v160, v190, v9
    v_and_b32 v161, v191, v9
    s_and_b32 s61, s77, s49
    s_set_gpr_idx_on s70, gpr_idx(SRC2,DST)
    buffer_load_dwordx4 v[116:119], v2, s[16:19], s61 offen
    v_pk_fma_f32 v[16:17], v[128:129], v[70:71], v[16:17] op_sel_hi:[1,0,1]
    v_pk_fma_f32 v[18:19], v[130:131], v[70:71], v[18:19] op_sel_hi:[1,0,1]
    v_pk_fma_f32 v[20:21], v[132:133], v[86:87], v[20:21] op_sel_hi:[1,0,1]
    v_pk_fma_f32 v[22:23], v[134:135], v[86:87], v[22:23] op_sel_hi:[1,0,1]
    s_set_gpr_idx_off
    s_waitcnt vmcnt(5)
.p2align 3
    v_mfma_f32_16x16x16_bf16 v[128:131], v[160:161], v[96:97], 0
    v_readlane_b32 s78, v196, 8
    v_cvt_pk_bf16_f32 v10, v153, v153
    v_mfma_f32_16x16x16_bf16 v[132:135], v[160:161], v[98:99], 0
    v_and_b32 v162, v190, v10
    v_and_b32 v163, v191, v10
    s_and_b32 s61, s78, s49
    s_set_gpr_idx_on s71, gpr_idx(SRC2,DST)
    buffer_load_dwordx4 v[120:123], v2, s[16:19], s61 offen
    v_pk_fma_f32 v[16:17], v[136:137], v[70:71], v[16:17] op_sel:[0,1,0] op_sel_hi:[1,1,1]
    v_pk_fma_f32 v[18:19], v[138:139], v[70:71], v[18:19] op_sel:[0,1,0] op_sel_hi:[1,1,1]
    v_pk_fma_f32 v[20:21], v[140:141], v[86:87], v[20:21] op_sel:[0,1,0] op_sel_hi:[1,1,1]
    v_pk_fma_f32 v[22:23], v[142:143], v[86:87], v[22:23] op_sel:[0,1,0] op_sel_hi:[1,1,1]
    s_set_gpr_idx_off
    s_cmp_le_u32 s53, 8
    s_cbranch_scc1 L_swept
    s_waitcnt vmcnt(5)
.p2align 3
    v_mfma_f32_16x16x16_bf16 v[136:139], v[162:163], v[100:101], 0
    v_readlane_b32 s79, v196, 9
    v_cvt_pk_bf16_f32 v9, v154, v154
    v_mfma_f32_16x16x16_bf16 v[140:143], v[162:163], v[102:103], 0
    v_and_b32 v160, v190, v9
    v_and_b32 v161, v191, v9
    s_and_b32 s61, s79, s49
    s_set_gpr_idx_on s72, gpr_idx(SRC2,DST)
    buffer_load_dwordx4 v[124:127], v2, s[16:19], s61 offen
    v_pk_fma_f32 v[16:17], v[128:129], v[72:73], v[16:17] op_sel_hi:[1,0,1]
    v_pk_fma_f32 v[18:19], v[130:131], v[72:73], v[18:19] op_sel_hi:[1,0,1]
    v_pk_fma_f32 v[20:21], v[132:133], v[88:89], v[20:21] op_sel_hi:[1,0,1]
    v_pk_fma_f32 v[22:23], v[134:135], v[88:89], v[22:23] op_sel_hi:[1,0,1]
    s_set_gpr_idx_off
    s_waitcnt vmcnt(5)
.p2align 3
    v_mfma_f32_16x16x16_bf16 v[128:131], v[160:161], v[104:105], 0
    v_readlane_b32 s64, v196, 10
    v_cvt_pk_bf16_f32 v10, v155, v155
    v_mfma_f32_16x16x16_bf16 v[132:135], v[160:161], v[106:107], 0
    v_and_b32 v162, v190, v10
    v_and_b32 v163, v191, v10
    s_and_b32 s61, s64, s49
    s_set_gpr_idx_on s73, gpr_idx(SRC2,DST)
    buffer_load_dwordx4 v[96:99], v2, s[16:19], s61 offen
    v_pk_fma_f32 v[16:17], v[136:137], v[72:73], v[16:17] op_sel:[0,1,0] op_sel_hi:[1,1,1]
    v_pk_fma_f32 v[18:19], v[138:139], v[72:73], v[18:19] op_sel:[0,1,0] op_sel_hi:[1,1,1]
    v_pk_fma_f32 v[20:21], v[140:141], v[88:89], v[20:21] op_sel:[0,1,0] op_sel_hi:[1,1,1]
    v_pk_fma_f32 v[22:23], v[142:143], v[88:89], v[22:23] op_sel:[0,1,0] op_sel_hi:[1,1,1]
    s_set_gpr_idx_off
    s_waitcnt vmcnt(5)
.p2align 3
    v_mfma_f32_16x16x16_bf16 v[136:139], v[162:163], v[108:109], 0
    v_readlane_b32 s65, v196, 11
    v_cvt_pk_bf16_f32 v9, v156, v156
    v_mfma_f32_16x16x16_bf16 v[140:143], v[162:163], v[110:111], 0
    v_and_b32 v160, v190, v9
    v_and_b32 v161, v191, v9
    s_and_b32 s61, s65, s49
    s_set_gpr_idx_on s74, gpr_idx(SRC2,DST)
    buffer_load_dwordx4 v[100:103], v2, s[16:19], s61 offen
    v_pk_fma_f32 v[16:17], v[128:129], v[74:75], v[16:17] op_sel_hi:[1,0,1]
    v_pk_fma_f32 v[18:19], v[130:131], v[74:75], v[18:19] op_sel_hi:[1,0,1]
    v_pk_fma_f32 v[20:21], v[132:133], v[90:91], v[20:21] op_sel_hi:[1,0,1]
    v_pk_fma_f32 v[22:23], v[134:135], v[90:91], v[22:23] op_sel_hi:[1,0,1]
    s_set_gpr_idx_off
    s_waitcnt vmcnt(5)
.p2align 3
    v_mfma_f32_16x16x16_bf16 v[128:131], v[160:161], v[112:113], 0
    v_readlane_b32 s66, v196, 12
    v_cvt_pk_bf16_f32 v10, v157, v157
    v_mfma_f32_16x16x16_bf16 v[132:135], v[160:161], v[114:115], 0
    v_and_b32 v162, v190, v10
    v_and_b32 v163, v191, v10
    s_and_b32 s61, s66, s49
    s_set_gpr_idx_on s75, gpr_idx(SRC2,DST)
    buffer_load_dwordx4 v[104:107], v2, s[16:19], s61 offen
    v_pk_fma_f32 v[16:17], v[136:137], v[74:75], v[16:17] op_sel:[0,1,0] op_sel_hi:[1,1,1]
    v_pk_fma_f32 v[18:19], v[138:139], v[74:75], v[18:19] op_sel:[0,1,0] op_sel_hi:[1,1,1]
    v_pk_fma_f32 v[20:21], v[140:141], v[90:91], v[20:21] op_sel:[0,1,0] op_sel_hi:[1,1,1]
    v_pk_fma_f32 v[22:23], v[142:143], v[90:91], v[22:23] op_sel:[0,1,0] op_sel_hi:[1,1,1]
    s_set_gpr_idx_off
    s_cmp_le_u32 s53, 12
    s_cbranch_scc1 L_swept
    s_waitcnt vmcnt(5)
.p2align 3
    v_mfma_f32_16x16x16_bf16 v[136:139], v[162:163], v[116:117], 0
    v_readlane_b32 s67, v196, 13
    v_cvt_pk_bf16_f32 v9, v158, v158
    v_mfma_f32_16x16x16_bf16 v[140:143], v[162:163], v[118:119], 0
    v_and_b32 v160, v190, v9
    v_and_b32 v161, v191, v9
    s_and_b32 s61, s67, s49
    s_set_gpr_idx_on s76, gpr_idx(SRC2,DST)
    buffer_load_dwordx4 v[108:111], v2, s[16:19], s61 offen
    v_pk_fma_f32 v[16:17], v[128:129], v[76:77], v[16:17] op_sel_hi:[1,0,1]
    v_pk_fma_f32 v[18:19], v[130:131], v[76:77], v[18:19] op_sel_hi:[1,0,1]
    v_pk_fma_f32 v[20:21], v[132:133], v[92:93], v[20:21] op_sel_hi:[1,0,1]
    v_pk_fma_f32 v[22:23], v[134:135], v[92:93], v[22:23] op_sel_hi:[1,0,1]
    s_set_gpr_idx_off
    s_waitcnt vmcnt(5)
.p2align 3
    v_mfma_f32_16x16x16_bf16 v[128:131], v[160:161], v[120:121], 0
    v_readlane_b32 s68, v196, 14
    v_cvt_pk_bf16_f32 v10, v159, v159
    v_mfma_f32_16x16x16_bf16 v[132:135], v[160:161], v[122:123], 0
    v_and_b32 v162, v190, v10
    v_and_b32 v163, v191, v10
    s_and_b32 s61, s68, s49
    s_set_gpr_idx_on s77, gpr_idx(SRC2,DST)
    buffer_load_dwordx4 v[112:115], v2, s[16:19], s61 offen
    v_pk_fma_f32 v[16:17], v[136:137], v[76:77], v[16:17] op_sel:[0,1,0] op_sel_hi:[1,1,1]
    v_pk_fma_f32 v[18:19], v[138:139], v[76:77], v[18:19] op_sel:[0,1,0] op_sel_hi:[1,1,1]
    v_pk_fma_f32 v[20:21], v[140:141], v[92:93], v[20:21] op_sel:[0,1,0] op_sel_hi:[1,1,1]
    v_pk_fma_f32 v[22:23], v[142:143], v[92:93], v[22:23] op_sel:[0,1,0] op_sel_hi:[1,1,1]
    s_set_gpr_idx_off
    s_waitcnt vmcnt(5)
.p2align 3
    v_mfma_f32_16x16x16_bf16 v[136:139], v[162:163], v[124:125], 0
    v_readlane_b32 s69, v196, 15
    v_mfma_f32_16x16x16_bf16 v[140:143], v[162:163], v[126:127], 0
    s_and_b32 s61, s69, s49
    s_set_gpr_idx_on s78, gpr_idx(SRC2,DST)
    buffer_load_dwordx4 v[116:119], v2, s[16:19], s61 offen
    v_pk_fma_f32 v[16:17], v[128:129], v[78:79], v[16:17] op_sel_hi:[1,0,1]
    v_pk_fma_f32 v[18:19], v[130:131], v[78:79], v[18:19] op_sel_hi:[1,0,1]
    v_pk_fma_f32 v[20:21], v[132:133], v[94:95], v[20:21] op_sel_hi:[1,0,1]
    v_pk_fma_f32 v[22:23], v[134:135], v[94:95], v[22:23] op_sel_hi:[1,0,1]
    s_set_gpr_idx_idx s79
    s_sub_i32 s53, s53, 16
    v_pk_fma_f32 v[16:17], v[136:137], v[78:79], v[16:17] op_sel:[0,1,0] op_sel_hi:[1,1,1]
    v_pk_fma_f32 v[18:19], v[138:139], v[78:79], v[18:19] op_sel:[0,1,0] op_sel_hi:[1,1,1]
    v_pk_fma_f32 v[20:21], v[140:141], v[94:95], v[20:21] op_sel:[0,1,0] op_sel_hi:[1,1,1]
    v_pk_fma_f32 v[22:23], v[142:143], v[94:95], v[22:23] op_sel:[0,1,0] op_sel_hi:[1,1,1]
    s_set_gpr_idx_off
    s_cmp_gt_i32 s53, 0
    s_cbranch_scc1 L_loop
L_swept:
    s_nop 7
    s_add_u32 s48, s48, 1536
    s_cmp_lt_u32 s48, s47
    s_cbranch_scc1 L_again
    v_lshlrev_b32 v8, 2, v1
    s_mul_i32 s54, s56, 9
    v_cvt_pk_bf16_f32 v64, v16, v20
    v_cvt_pk_bf16_f32 v65, v17, v21
    v_cvt_pk_bf16_f32 v66, v18, v22
    v_cvt_pk_bf16_f32 v67, v19, v23
    v_add_u32 v84, s54, v8
    ds_write2_b32 v84, v64, v65 offset0:0 offset1:72
    ds_write2_b32 v84, v66, v67 offset0:144 offset1:216
    s_mul_i32 s54, s57, 9
    v_cvt_pk_bf16_f32 v68, v24, v28
    v_cvt_pk_bf16_f32 v69, v25, v29
    v_cvt_pk_bf16_f32 v70, v26, v30
    v_cvt_pk_bf16_f32 v71, v27, v31
    v_add_u32 v85, s54, v8
    ds_write2_b32 v85, v68, v69 offset0:0 offset1:72
    ds_write2_b32 v85, v70, v71 offset0:144 offset1:216
    s_mul_i32 s54, s58, 9
    v_cvt_pk_bf16_f32 v72, v32, v36
    v_cvt_pk_bf16_f32 v73, v33, v37
    v_cvt_pk_bf16_f32 v74, v34, v38
    v_cvt_pk_bf16_f32 v75, v35, v39
    v_add_u32 v86, s54, v8
    ds_write2_b32 v86, v72, v73 offset0:0 offset1:72
    ds_write2_b32 v86, v74, v75 offset0:144 offset1:216
    s_mul_i32 s54, s59, 9
    v_cvt_pk_bf16_f32 v76, v40, v44
    v_cvt_pk_bf16_f32 v77, v41, v45
    v_cvt_pk_bf16_f32 v78, v42, v46
    v_cvt_pk_bf16_f32 v79, v43, v47
    v_add_u32 v87, s54, v8
    ds_write2_b32 v87, v76, v77 offset0:0 offset1:72
    ds_write2_b32 v87, v78, v79 offset0:144 offset1:216
    s_mul_i32 s54, s60, 9
    v_cvt_pk_bf16_f32 v80, v48, v52
    v_cvt_pk_bf16_f32 v81, v49, v53
    v_cvt_pk_bf16_f32 v82, v50, v54
    v_cvt_pk_bf16_f32 v83, v51, v55
    v_add_u32 v88, s54, v8
    ds_write2_b32 v88, v80, v81 offset0:0 offset1:72
    ds_write2_b32 v88, v82, v83 offset0:144 offset1:216
    v_and_b32 v8, 15, v1
    v_lshrrev_b32 v9, 4, v1
    s_lshr_b32 s54, s3, 2
    s_mul_i32 s55, s54, 23040
    v_mul_u32_u24 v10, 288, v8
    v_lshl_add_u32 v10, v9, 4, v10
    v_add_u32 v10, s55, v10
    v_lshlrev_b32 v9, 10, v9
    v_lshl_add_u32 v9, v8, 2, v9
    s_mul_i32 s54, s54, 20480
    s_and_b32 s55, s3, 3
    s_lshl_b32 s55, s55, 6
    s_add_u32 s54, s54, s55
    s_waitcnt vmcnt(0) lgkmcnt(0)
    s_barrier
    ds_read_b128 v[16:19], v10 offset:0
    ds_read_b128 v[20:23], v10 offset:64
    ds_read_b128 v[24:27], v10 offset:128
    ds_read_b128 v[28:31], v10 offset:192
    ds_read_b128 v[32:35], v10 offset:4608
    ds_read_b128 v[36:39], v10 offset:4672
    ds_read_b128 v[40:43], v10 offset:4736
    ds_read_b128 v[44:47], v10 offset:4800
    ds_read_b128 v[48:51], v10 offset:9216
    ds_read_b128 v[52:55], v10 offset:9280
    ds_read_b128 v[56:59], v10 offset:9344
    ds_read_b128 v[60:63], v10 offset:9408
    s_waitcnt lgkmcnt(11)
    v_mfma_f32_16x16x32_bf16 v[128:131], v[16:19], v[208:211], 0
    v_mfma_f32_16x16x32_bf16 v[132:135], v[16:19], v[212:215], 0
    s_waitcnt lgkmcnt(10)
    v_mfma_f32_16x16x32_bf16 v[128:131], v[20:23], v[216:219], v[128:131]
    v_mfma_f32_16x16x32_bf16 v[132:135], v[20:23], v[220:223], v[132:135]
    s_waitcnt lgkmcnt(9)
    v_mfma_f32_16x16x32_bf16 v[128:131], v[24:27], v[224:227], v[128:131]
    v_mfma_f32_16x16x32_bf16 v[132:135], v[24:27], v[228:231], v[132:135]
    s_waitcnt lgkmcnt(8)
    v_mfma_f32_16x16x32_bf16 v[128:131], v[28:31], v[232:235], v[128:131]
    v_mfma_f32_16x16x32_bf16 v[132:135], v[28:31], v[236:239], v[132:135]
    ds_read_b128 v[64:67], v10 offset:13824
    ds_read_b128 v[68:71], v10 offset:13888
    ds_read_b128 v[72:75], v10 offset:13952
    ds_read_b128 v[76:79], v10 offset:14016
    s_waitcnt lgkmcnt(11)
    v_mfma_f32_16x16x32_bf16 v[136:139], v[32:35], v[208:211], 0
    v_mfma_f32_16x16x32_bf16 v[140:143], v[32:35], v[212:215], 0
    s_waitcnt lgkmcnt(10)
    v_mfma_f32_16x16x32_bf16 v[136:139], v[36:39], v[216:219], v[136:139]
    v_mfma_f32_16x16x32_bf16 v[140:143], v[36:39], v[220:223], v[140:143]
    s_waitcnt lgkmcnt(9)
    v_mfma_f32_16x16x32_bf16 v[136:139], v[40:43], v[224:227], v[136:139]
    v_mfma_f32_16x16x32_bf16 v[140:143], v[40:43], v[228:231], v[140:143]
    s_waitcnt lgkmcnt(8)
    v_mfma_f32_16x16x32_bf16 v[136:139], v[44:47], v[232:235], v[136:139]
    v_mfma_f32_16x16x32_bf16 v[140:143], v[44:47], v[236:239], v[140:143]
    v_cvt_pk_bf16_f32 v96, v128, v132
    buffer_store_dword v96, v9, s[40:43], s54 offen offset:0 sc1
    v_cvt_pk_bf16_f32 v97, v129, v133
    buffer_store_dword v97, v9, s[40:43], s54 offen offset:256 sc1
    v_cvt_pk_bf16_f32 v98, v130, v134
    buffer_store_dword v98, v9, s[40:43], s54 offen offset:512 sc1
    v_cvt_pk_bf16_f32 v99, v131, v135
    buffer_store_dword v99, v9, s[40:43], s54 offen offset:768 sc1
    s_add_u32 s54, s54, 4096
    ds_read_b128 v[80:83], v10 offset:18432
    ds_read_b128 v[84:87], v10 offset:18496
    ds_read_b128 v[88:91], v10 offset:18560
    ds_read_b128 v[92:95], v10 offset:18624
    s_waitcnt lgkmcnt(11)
    v_mfma_f32_16x16x32_bf16 v[144:147], v[48:51], v[208:211], 0
    v_mfma_f32_16x16x32_bf16 v[148:151], v[48:51], v[212:215], 0
    s_waitcnt lgkmcnt(10)
    v_mfma_f32_16x16x32_bf16 v[144:147], v[52:55], v[216:219], v[144:147]
    v_mfma_f32_16x16x32_bf16 v[148:151], v[52:55], v[220:223], v[148:151]
    s_waitcnt lgkmcnt(9)
    v_mfma_f32_16x16x32_bf16 v[144:147], v[56:59], v[224:227], v[144:147]
    v_mfma_f32_16x16x32_bf16 v[148:151], v[56:59], v[228:231], v[148:151]
    s_waitcnt lgkmcnt(8)
    v_mfma_f32_16x16x32_bf16 v[144:147], v[60:63], v[232:235], v[144:147]
    v_mfma_f32_16x16x32_bf16 v[148:151], v[60:63], v[236:239], v[148:151]
    v_cvt_pk_bf16_f32 v100, v136, v140
    buffer_store_dword v100, v9, s[40:43], s54 offen offset:0 sc1
    v_cvt_pk_bf16_f32 v101, v137, v141
    buffer_store_dword v101, v9, s[40:43], s54 offen offset:256 sc1
    v_cvt_pk_bf16_f32 v102, v138, v142
    buffer_store_dword v102, v9, s[40:43], s54 offen offset:512 sc1
    v_cvt_pk_bf16_f32 v103, v139, v143
    buffer_store_dword v103, v9, s[40:43], s54 offen offset:768 sc1
    s_add_u32 s54, s54, 4096
    s_waitcnt lgkmcnt(7)
    v_mfma_f32_16x16x32_bf16 v[152:155], v[64:67], v[208:211], 0
    v_mfma_f32_16x16x32_bf16 v[156:159], v[64:67], v[212:215], 0
    s_waitcnt lgkmcnt(6)
    v_mfma_f32_16x16x32_bf16 v[152:155], v[68:71], v[216:219], v[152:155]
    v_mfma_f32_16x16x32_bf16 v[156:159], v[68:71], v[220:223], v[156:159]
    s_waitcnt lgkmcnt(5)
    v_mfma_f32_16x16x32_bf16 v[152:155], v[72:75], v[224:227], v[152:155]
    v_mfma_f32_16x16x32_bf16 v[156:159], v[72:75], v[228:231], v[156:159]
    s_waitcnt lgkmcnt(4)
    v_mfma_f32_16x16x32_bf16 v[152:155], v[76:79], v[232:235], v[152:155]
    v_mfma_f32_16x16x32_bf16 v[156:159], v[76:79], v[236:239], v[156:159]
    v_cvt_pk_bf16_f32 v104, v144, v148
    buffer_store_dword v104, v9, s[40:43], s54 offen offset:0 sc1
    v_cvt_pk_bf16_f32 v105, v145, v149
    buffer_store_dword v105, v9, s[40:43], s54 offen offset:256 sc1
    v_cvt_pk_bf16_f32 v106, v146, v150
    buffer_store_dword v106, v9, s[40:43], s54 offen offset:512 sc1
    v_cvt_pk_bf16_f32 v107, v147, v151
    buffer_store_dword v107, v9, s[40:43], s54 offen offset:768 sc1
    s_add_u32 s54, s54, 4096
    s_waitcnt lgkmcnt(3)
    v_mfma_f32_16x16x32_bf16 v[160:163], v[80:83], v[208:211], 0
    v_mfma_f32_16x16x32_bf16 v[164:167], v[80:83], v[212:215], 0
    s_waitcnt lgkmcnt(2)
    v_mfma_f32_16x16x32_bf16 v[160:163], v[84:87], v[216:219], v[160:163]
    v_mfma_f32_16x16x32_bf16 v[164:167], v[84:87], v[220:223], v[164:167]
    s_waitcnt lgkmcnt(1)
    v_mfma_f32_16x16x32_bf16 v[160:163], v[88:91], v[224:227], v[160:163]
    v_mfma_f32_16x16x32_bf16 v[164:167], v[88:91], v[228:231], v[164:167]
    s_waitcnt lgkmcnt(0)
    v_mfma_f32_16x16x32_bf16 v[160:163], v[92:95], v[232:235], v[160:163]
    v_mfma_f32_16x16x32_bf16 v[164:167], v[92:95], v[236:239], v[164:167]
    v_cvt_pk_bf16_f32 v108, v152, v156
    buffer_store_dword v108, v9, s[40:43], s54 offen offset:0 sc1
    v_cvt_pk_bf16_f32 v109, v153, v157
    buffer_store_dword v109, v9, s[40:43], s54 offen offset:256 sc1
    v_cvt_pk_bf16_f32 v110, v154, v158
    buffer_store_dword v110, v9, s[40:43], s54 offen offset:512 sc1
    v_cvt_pk_bf16_f32 v111, v155, v159
    buffer_store_dword v111, v9, s[40:43], s54 offen offset:768 sc1
    s_add_u32 s54, s54, 4096
    v_cvt_pk_bf16_f32 v112, v160, v164
    buffer_store_dword v112, v9, s[40:43], s54 offen offset:0 sc1
    v_cvt_pk_bf16_f32 v113, v161, v165
    buffer_store_dword v113, v9, s[40:43], s54 offen offset:256 sc1
    v_cvt_pk_bf16_f32 v114, v162, v166
    buffer_store_dword v114, v9, s[40:43], s54 offen offset:512 sc1
    v_cvt_pk_bf16_f32 v115, v163, v167
    buffer_store_dword v115, v9, s[40:43], s54 offen offset:768 sc1
    s_add_u32 s54, s54, 4096
    s_or_b32 s4, s2, s3
    s_cbranch_scc1 L_notag
    v_mov_b32 v8, s62
    v_lshlrev_b32 v10, 2, v1
    s_mov_b32 s54, 524288
    buffer_store_dword v8, v10, s[20:23], s54 offen sc1
L_notag:
L_done:
    s_endpgm
L_again:
    s_waitcnt vmcnt(0) lgkmcnt(0)
    s_barrier
    v_lshlrev_b32 v11, 2, v0
    v_mov_b32 v12, 0x00700000
    v_mov_b32 v13, 0
    ds_write_b32 v11, v12 offset:0
    ds_write_b32 v11, v12 offset:2048
    ds_write_b32 v11, v12 offset:4096
    ds_write_b32 v11, v13 offset:6144
    ds_write_b32 v11, v13 offset:8192
    ds_write_b32 v11, v13 offset:10240
    s_waitcnt lgkmcnt(0)
    s_barrier
    s_branch L_round
L_map2:
    v_add_u32 v8, 56, v8
    v_subrev_u32 v10, 14, v10
    s_branch L_map
L_rank2:
    ds_read_b32 v96, v15 offset:6144
    ds_read_b32 v97, v15 offset:6272
    ds_read_b32 v98, v15 offset:6400
    ds_read_b32 v99, v15 offset:6528
    ds_read_b32 v100, v15 offset:6656
    s_waitcnt lgkmcnt(0)
L_end:
    s_branch L_ranked
.section .rodata,"a"
.p2align 6
.amdhsa_kernel gather_scatter__tensor_product_equiv_mace__graph_kernel
  .amdhsa_next_free_vgpr 240
  .amdhsa_next_free_sgpr 102
  .amdhsa_accum_offset 240
  .amdhsa_group_segment_fixed_size 0
  .amdhsa_kernarg_size 88
  .amdhsa_user_sgpr_count 2
  .amdhsa_user_sgpr_kernarg_segment_ptr 1
  .amdhsa_system_sgpr_workgroup_id_x 1
  .amdhsa_float_denorm_mode_32 3
.end_amdhsa_kernel
```

```asm
; @launch grid=(256,1,1) block=(512,1,1) lds=145408
.amdgcn_target "amdgcn-amd-amdhsa--gfx950"
.text
.globl gather_scatter__tensor_product_equiv_mace__graph_kernel
.p2align 8
.type gather_scatter__tensor_product_equiv_mace__graph_kernel,@function
gather_scatter__tensor_product_equiv_mace__graph_kernel:
    s_cmp_ge_u32 s2, 256
    s_cbranch_scc1 L_done
    s_load_dwordx4 s[4:7], s[0:1], 8
    s_load_dwordx4 s[8:11], s[0:1], 24
    s_load_dwordx2 s[14:15], s[0:1], 80
    s_load_dwordx2 s[64:65], s[0:1], 0
    s_load_dwordx2 s[66:67], s[0:1], 40
    s_load_dwordx4 s[68:71], s[0:1], 48
    s_load_dwordx2 s[12:13], s[0:1], 64
    v_lshrrev_b32 v8, 6, v0
    v_and_b32 v1, 63, v0
    v_lshlrev_b32 v9, 2, v0
    v_mov_b32 v13, 0
    v_readfirstlane_b32 s3, v8
    ds_write_b32 v9, v13 offset:54272
    ds_write_b32 v9, v13 offset:59392
    s_mul_i32 s54, s2, 5000
    s_mul_i32 s55, s2, 10000
    s_mul_i32 s61, s2, 40000
    v_lshlrev_b32 v2, 4, v1
    v_lshlrev_b32 v10, 3, v0
    v_lshlrev_b32 v15, 4, v0
    v_mov_b32 v6, 1
    s_lshl_b32 s52, s3, 10
    s_add_u32 s52, s52, 79872
    s_movk_i32 s53, 4096
    s_movk_i32 s50, 8192
    s_waitcnt lgkmcnt(0)
    s_add_u32 s32, s6, s54
    s_addc_u32 s33, s7, 0
    s_mov_b32 s34, 5000
    s_mov_b32 s35, 0x20000
    buffer_load_dword v64, v9, s[32:35], 0 offen offset:0 nt
    buffer_load_dword v65, v9, s[32:35], 0 offen offset:2048 nt
    buffer_load_dword v66, v9, s[32:35], s53 offen nt
    s_add_u32 s36, s4, s54
    s_addc_u32 s37, s5, 0
    s_mov_b32 s38, 5000
    s_mov_b32 s39, 0x20000
    buffer_load_dword v68, v9, s[36:39], 0 offen offset:0 nt
    buffer_load_dword v69, v9, s[36:39], 0 offen offset:2048 nt
    buffer_load_dword v70, v9, s[36:39], s53 offen nt
    s_load_dword s62, s[14:15], 524288
    s_getpc_b64 s[80:81]
L_pc:
    s_and_b32 s54, s2, 0xf8
    s_lshl_b32 s54, s54, 6
    v_and_b32 v11, 0x180, v10
    v_add_u32 v11, s54, v11
    v_min_u32 v11, L_end-L_pc, v11
    v_mov_b32 v113, s81
    v_add_co_u32 v112, vcc, s80, v11
    s_nop 1
    v_addc_co_u32 v113, vcc, 0, v113, vcc
    global_load_dword v205, v[112:113], off
    s_add_u32 s96, s8, s55
    s_addc_u32 s97, s9, 0
    s_mov_b32 s98, 10000
    s_mov_b32 s99, 0x20000
    s_add_u32 s28, s10, s61
    s_addc_u32 s29, s11, 0
    s_mov_b32 s30, 40000
    s_mov_b32 s31, 0x20000
    s_barrier
    buffer_load_dwordx2 v[72:73], v10, s[96:99], 0 offen nt
    buffer_load_dwordx2 v[74:75], v10, s[96:99], s53 offen nt
    buffer_load_dwordx2 v[76:77], v10, s[96:99], s50 offen nt
    s_add_u32 m0, s52, 0
    s_mov_b32 s54, 0
    buffer_load_dwordx4 v15, s[28:31], s54 offen nt lds
    s_add_u32 m0, s52, 8192
    s_mov_b32 s54, 8192
    buffer_load_dwordx4 v15, s[28:31], s54 offen nt lds
    s_add_u32 m0, s52, 16384
    s_mov_b32 s54, 16384
    buffer_load_dwordx4 v15, s[28:31], s54 offen nt lds
    s_mov_b32 s72, 109951168
    s_movk_i32 s73, 625
    s_movk_i32 s74, 838
    s_movk_i32 s54, 226
    v_cmp_gt_u32 s[84:85], s54, v0
    v_lshlrev_b32 v11, 2, v0
    v_mov_b32 v12, 0x00700000
    v_mov_b32 v13, 0
    ds_write_b32 v11, v12 offset:0
    ds_write_b32 v11, v12 offset:2048
    ds_write_b32 v11, v12 offset:4096
    ds_write_b32 v11, v12 offset:6144
    ds_write_b32 v11, v13 offset:8192
    ds_write_b32 v11, v13 offset:10240
    ds_write_b32 v11, v13 offset:12288
    ds_write_b32 v11, v13 offset:14336
    v_mov_b32 v16, 0
    v_mov_b32 v17, 0
    v_mov_b32 v18, 0
    v_mov_b32 v19, 0
    v_mov_b32 v20, 0
    v_mov_b32 v21, 0
    v_mov_b32 v22, 0
    v_mov_b32 v23, 0
    v_mov_b32 v24, 0
    v_mov_b32 v25, 0
    v_mov_b32 v26, 0
    v_mov_b32 v27, 0
    v_mov_b32 v28, 0
    v_mov_b32 v29, 0
    v_mov_b32 v30, 0
    v_mov_b32 v31, 0
    v_mov_b32 v32, 0
    v_mov_b32 v33, 0
    v_mov_b32 v34, 0
    v_mov_b32 v35, 0
    v_mov_b32 v36, 0
    v_mov_b32 v37, 0
    v_mov_b32 v38, 0
    v_mov_b32 v39, 0
    v_mov_b32 v40, 0
    v_mov_b32 v41, 0
    v_mov_b32 v42, 0
    v_mov_b32 v43, 0
    v_mov_b32 v44, 0
    v_mov_b32 v45, 0
    v_mov_b32 v46, 0
    v_mov_b32 v47, 0
    v_mov_b32 v48, 0
    v_mov_b32 v49, 0
    v_mov_b32 v50, 0
    v_mov_b32 v51, 0
    v_mov_b32 v52, 0
    v_mov_b32 v53, 0
    v_mov_b32 v54, 0
    v_mov_b32 v55, 0
    v_mov_b32 v56, 0
    v_mov_b32 v57, 0
    v_mov_b32 v58, 0
    v_mov_b32 v59, 0
    v_mov_b32 v60, 0
    v_mov_b32 v61, 0
    v_mov_b32 v62, 0
    v_mov_b32 v63, 0
    s_waitcnt vmcnt(10)
    v_mul_hi_u32 v80, v64, s72
    v_mul_hi_u32 v81, v65, s72
    v_mul_hi_u32 v82, v66, s72
    v_lshlrev_b32 v84, 2, v80
    ds_add_rtn_u32 v88, v84, v6 offset:54272
    v_lshlrev_b32 v85, 2, v81
    ds_add_rtn_u32 v89, v85, v6 offset:54272
    v_lshlrev_b32 v86, 2, v82
    s_mov_b64 exec, s[84:85]
    ds_add_rtn_u32 v90, v86, v6 offset:54272
    s_mov_b64 exec, -1
    s_waitcnt lgkmcnt(0)
    s_barrier
    ds_read_b128 v[100:103], v2 offset:54272
    s_add_u32 m0, s52, 24576
    s_mov_b32 s54, 24576
    buffer_load_dwordx4 v15, s[28:31], s54 offen nt lds
    s_add_u32 m0, s52, 32768
    s_mov_b32 s54, 32768
    buffer_load_dwordx4 v15, s[28:31], s54 offen nt lds
    v_mad_u32_u24 v92, v80, s73, 15
    v_lshrrev_b32 v92, 4, v92
    v_sub_u32 v92, v64, v92
    v_lshrrev_b32 v80, 3, v80
    v_and_b32 v80, 28, v80
    v_mad_u32_u24 v93, v81, s73, 15
    v_lshrrev_b32 v93, 4, v93
    v_sub_u32 v93, v65, v93
    v_lshrrev_b32 v81, 3, v81
    v_and_b32 v81, 28, v81
    v_mad_u32_u24 v94, v82, s73, 15
    v_lshrrev_b32 v94, 4, v94
    v_sub_u32 v94, v66, v94
    v_lshrrev_b32 v82, 3, v82
    v_and_b32 v82, 28, v82
    s_waitcnt lgkmcnt(0)
    v_add_u32 v11, v100, v101
    v_add3_u32 v11, v11, v102, v103
    v_mov_b32 v12, v11
    s_nop 1
    v_add_u32_dpp v12, v12, v12 row_shr:1 row_mask:0xf bank_mask:0xf
    s_nop 1
    v_add_u32_dpp v12, v12, v12 row_shr:2 row_mask:0xf bank_mask:0xf
    s_nop 1
    v_add_u32_dpp v12, v12, v12 row_shr:4 row_mask:0xf bank_mask:0xf
    s_nop 1
    v_add_u32_dpp v12, v12, v12 row_shr:8 row_mask:0xf bank_mask:0xf
    s_nop 1
    v_add_u32_dpp v12, v12, v12 row_bcast:15 row_mask:0xa bank_mask:0xf
    s_nop 1
    v_add_u32_dpp v12, v12, v12 row_bcast:31 row_mask:0xc bank_mask:0xf
    v_sub_u32 v104, v12, v11
    v_add_u32 v105, v104, v100
    v_add_u32 v106, v105, v101
    v_add_u32 v107, v106, v102
    ds_write_b128 v2, v[104:107] offset:55296
    ds_read_b32 v108, v84 offset:55296
    ds_read_b32 v109, v85 offset:55296
    ds_read_b32 v110, v86 offset:55296
    s_waitcnt vmcnt(9)
    v_mul_u32_u24 v96, s74, v68
    v_lshrrev_b32 v96, 18, v96
    v_sub_u32 v96, v96, v80
    v_and_b32 v96, 31, v96
    v_lshl_or_b32 v96, v92, 5, v96
    v_lshlrev_b32 v96, 21, v96
    v_lshl_or_b32 v96, v68, 7, v96
    v_mul_u32_u24 v97, s74, v69
    v_lshrrev_b32 v97, 18, v97
    v_sub_u32 v97, v97, v81
    v_and_b32 v97, 31, v97
    v_lshl_or_b32 v97, v93, 5, v97
    v_lshlrev_b32 v97, 21, v97
    v_lshl_or_b32 v97, v69, 7, v97
    v_mul_u32_u24 v98, s74, v70
    v_lshrrev_b32 v98, 18, v98
    v_sub_u32 v98, v98, v82
    v_and_b32 v98, 31, v98
    v_lshl_or_b32 v98, v94, 5, v98
    v_lshlrev_b32 v98, 21, v98
    v_lshl_or_b32 v98, v70, 7, v98
    v_lshlrev_b32 v92, 5, v0
    v_add_u32 v93, 16384, v92
    v_add_u32 v94, 32768, v92
    s_mov_b32 s55, 61440
    s_waitcnt vmcnt(5) lgkmcnt(0)
    v_add_u32 v108, v108, v88
    v_lshlrev_b32 v84, 2, v108
    v_mad_u32_u24 v108, v108, 12, s55
    ds_write_b32 v84, v92 offset:56320
    ds_write2_b32 v108, v72, v73 offset0:0 offset1:1
    ds_write_b32 v108, v96 offset:8
    v_add_u32 v109, v109, v89
    v_lshlrev_b32 v85, 2, v109
    v_mad_u32_u24 v109, v109, 12, s55
    ds_write_b32 v85, v93 offset:56320
    ds_write2_b32 v109, v74, v75 offset0:0 offset1:1
    ds_write_b32 v109, v97 offset:8
    v_add_u32 v110, v110, v90
    v_lshlrev_b32 v86, 2, v110
    v_mad_u32_u24 v110, v110, 12, s55
    s_mov_b64 exec, s[84:85]
    ds_write_b32 v86, v94 offset:56320
    ds_write2_b32 v110, v76, v77 offset0:0 offset1:1
    ds_write_b32 v110, v98 offset:8
    s_mov_b64 exec, -1
    s_mul_i32 s62, s62, 0x9e3779b1
    s_add_u32 s62, s62, 0x7f4a7c15
    s_mul_i32 s63, s62, 0x85ebca6b
    s_and_b32 s63, s63, 0xffc00000
    s_lshl_b32 s54, s3, 7
    v_lshl_add_u32 v11, v1, 3, s54
    ds_read_b64 v[100:101], v11 offset:54272
    ds_read_b64 v[104:105], v11 offset:55296
    s_mul_i32 s54, s2, 15360
    s_add_u32 s54, s54, 1048576
    s_add_u32 s32, s14, s54
    s_addc_u32 s33, s15, 0
    s_mov_b32 s34, 15360
    s_mov_b32 s35, 0x20000
    s_mul_i32 s54, s2, 40960
    s_add_u32 s54, s54, 5242880
    s_add_u32 s36, s14, s54
    s_addc_u32 s37, s15, 0
    s_mov_b32 s38, 40000
    s_mov_b32 s39, 0x20000
    v_lshrrev_b32 v11, 1, v0
    v_lshlrev_b32 v11, 2, v11
    v_and_b32 v12, 1, v0
    v_lshlrev_b32 v12, 4, v12
    v_add_u32 v12, 79872, v12
    v_add_u32 v14, 61440, v15
    s_waitcnt lgkmcnt(0)
    s_barrier
    ds_read_b128 v[128:131], v14
    ds_read_b128 v[132:135], v14 offset:8192
    ds_read_b32 v156, v11 offset:56320
    ds_read_b32 v157, v11 offset:57344
    ds_read_b32 v158, v11 offset:58368
    ds_read_b32 v159, v11 offset:59392
    ds_read_b32 v160, v11 offset:60416
    s_mov_b32 s40, s70
    s_mov_b32 s41, s71
    s_mov_b32 s42, 32768
    s_mov_b32 s43, 0x20000
    s_lshl_b32 s54, s3, 12
    s_add_u32 m0, s54, 21504
    s_nop 0
    buffer_load_dwordx4 v2, s[40:43], s54 offen offset:0 lds
    buffer_load_dwordx4 v2, s[40:43], s54 offen offset:1024 lds
    buffer_load_dwordx4 v2, s[40:43], s54 offen offset:2048 lds
    buffer_load_dwordx4 v2, s[40:43], s54 offen offset:3072 lds
    s_mov_b32 s16, s68
    s_mov_b32 s17, s69
    s_mov_b32 s18, 4096
    s_mov_b32 s19, 0x20000
    s_and_b32 s54, s3, 3
    s_lshl_b32 s54, s54, 10
    s_add_u32 m0, s54, 17408
    s_nop 0
    buffer_load_dwordx4 v2, s[16:19], s54 offen lds
    v_lshrrev_b32 v7, 4, v1
    v_lshlrev_b32 v7, 5, v7
    v_and_b32 v120, 3, v1
    v_lshl_add_u32 v7, v120, 1, v7
    global_load_ushort v120, v7, s[66:67] offset:0
    global_load_ushort v121, v7, s[66:67] offset:8
    global_load_ushort v122, v7, s[66:67] offset:16
    global_load_ushort v123, v7, s[66:67] offset:24
    s_waitcnt lgkmcnt(0)
    v_add_u32 v156, v12, v156
    v_add_u32 v157, v12, v157
    v_add_u32 v158, v12, v158
    v_add_u32 v159, v12, v159
    v_add_u32 v160, v12, v160
    v_lshl_or_b32 v112, v100, 11, v104
    v_or_b32 v112, s63, v112
    v_mov_b32 v113, s62
    v_lshl_or_b32 v114, v101, 11, v105
    v_or_b32 v114, s63, v114
    v_mov_b32 v115, s62
    s_and_b32 s44, s2, 7
    s_lshl_b32 s44, s44, 5
    s_lshr_b32 s54, s2, 3
    s_add_u32 s44, s44, s54
    s_mul_i32 s45, s44, 625
    s_add_u32 s46, s45, 640
    s_add_u32 s45, s45, 15
    s_lshr_b32 s45, s45, 4
    s_lshr_b32 s46, s46, 4
    s_sub_u32 s46, s46, s45
    s_mov_b32 s86, 0x0f0f0f0f
    s_mov_b32 s87, 0x0f0f0f0f
    s_mov_b32 s88, 0xf0f0f0f0
    s_mov_b32 s89, 0xf0f0f0f0
    v_mov_b32 v164, 0
    v_mov_b32 v165, 0
    v_mov_b32 v166, 0
    v_mov_b32 v167, 0
    v_mov_b32 v168, 0
    v_mov_b32 v169, 0
    v_mov_b32 v170, 0
    v_mov_b32 v171, 0
    v_and_b32 v11, 4, v1
    v_lshlrev_b32 v11, 2, v11
    v_mov_b32 v12, 0xffff
    v_lshlrev_b32 v12, v11, v12
    v_bfe_i32 v11, v1, 3, 1
    v_and_b32 v191, v11, v12
    v_xor_b32 v190, v191, v12
    v_lshrrev_b32 v200, 5, v1
    v_lshlrev_b32 v200, 4, v200
    v_add_u32 v200, 79872, v200
    v_and_b32 v201, 15, v1
    v_lshlrev_b32 v201, 2, v201
    v_bfe_u32 v11, v1, 3, 2
    v_and_b32 v12, 3, v1
    v_lshl_add_u32 v11, v11, 2, v12
    v_lshlrev_b32 v202, 2, v11
    v_bfe_i32 v240, v0, 0, 1
    s_lshl_b32 s54, s3, 10
    v_and_b32 v241, 4, v240
    v_add_u32 v241, s54, v241
    v_lshl_add_u32 v242, v1, 2, s54
    v_lshrrev_b32 v243, 1, v1
    v_lshl_add_u32 v243, v243, 2, s54
    v_mul_u32_u24 v244, 12, v1
    v_and_b32 v245, 12, v242
    v_and_b32 v250, 124, v242
    v_lshlrev_b32 v246, 1, v242
    v_add_u32 v246, 63488, v246
    v_lshlrev_b32 v247, 19, v242
    s_mul_i32 s54, s3, 640
    v_add_u32 v248, s54, v250
    v_sub_u32 v249, 63, v1
    s_lshl_b32 s54, s3, 5
    v_lshl_add_u32 v251, v1, 2, s54
    v_lshrrev_b32 v252, 3, v1
    v_mul_u32_u24 v252, 64, v252
    v_add_u32 v252, 54272, v252
    s_cmp_eq_u32 s46, 40
    v_mov_b32 v203, 0
    s_mov_b32 s54, 671321104
    s_cselect_b32 s54, 276856880, s54
    s_mov_b32 exec_lo, 31
    s_mov_b32 exec_hi, 0
    v_mov_b32 v203, s54
    s_mov_b32 s54, 405087304
    s_cselect_b32 s54, 159876648, s54
    s_mov_b32 exec_lo, 992
    s_mov_b32 exec_hi, 0
    v_mov_b32 v203, s54
    s_mov_b32 s54, 424579168
    s_cselect_b32 s54, 296066625, s54
    s_mov_b32 exec_lo, 31744
    s_mov_b32 exec_hi, 0
    v_mov_b32 v203, s54
    s_mov_b32 s54, 577443961
    s_cselect_b32 s54, 980068482, s54
    s_mov_b32 exec_lo, 1015808
    s_mov_b32 exec_hi, 0
    v_mov_b32 v203, s54
    s_mov_b32 s54, 600547466
    s_cselect_b32 s54, 466166449, s54
    s_mov_b32 exec_lo, 32505856
    s_mov_b32 exec_hi, 0
    v_mov_b32 v203, s54
    s_mov_b32 s54, 734837403
    s_cselect_b32 s54, 590166779, s54
    s_mov_b32 exec_lo, 1040187392
    s_mov_b32 exec_hi, 0
    v_mov_b32 v203, s54
    s_mov_b32 s54, 481444091
    s_cselect_b32 s54, 754136323, s54
    s_mov_b32 exec_lo, 3221225472
    s_mov_b32 exec_hi, 7
    v_mov_b32 v203, s54
    s_mov_b32 s54, 338903356
    s_cselect_b32 s54, 76598556, s54
    s_mov_b32 exec_lo, 0
    s_mov_b32 exec_hi, 248
    v_mov_b32 v203, s54
    s_mov_b64 exec, -1
    v_mul_u32_u24 v11, 52, v1
    v_lshrrev_b32 v11, 8, v11
    v_mad_i32_i24 v11, v11, -5, v1
    v_mul_u32_u24 v11, 6, v11
    v_lshrrev_b32 v203, v11, v203
    v_and_b32 v11, 7, v203
    v_bfe_u32 v203, v203, 3, 3
    v_lshlrev_b32 v11, 12, v11
    v_lshl_or_b32 v203, v203, 7, v11
    s_mov_b32 s20, s14
    s_mov_b32 s21, s15
    s_mov_b32 s22, 524352
    s_mov_b32 s23, 0x20000
    s_add_u32 s24, s14, 1048576
    s_addc_u32 s25, s15, 0
    s_mov_b32 s26, 3932160
    s_mov_b32 s27, 0x20000
    s_waitcnt vmcnt(9)
    s_barrier
    ds_read_b128 v[136:139], v156
    ds_read_b128 v[140:143], v157
    ds_read_b128 v[144:147], v158
    ds_read_b128 v[148:151], v159
    ds_read_b128 v[152:155], v160
    buffer_store_dwordx4 v[128:131], v15, s[32:35], 0 offen sc1
    buffer_store_dwordx4 v[132:135], v15, s[32:35], s50 offen sc1
    s_mov_b32 s54, 0
    s_waitcnt lgkmcnt(4)
    buffer_store_dwordx4 v[136:139], v15, s[36:39], s54 offen sc1
    s_mov_b32 s54, 8192
    s_waitcnt lgkmcnt(3)
    buffer_store_dwordx4 v[140:143], v15, s[36:39], s54 offen sc1
    s_mov_b32 s54, 16384
    s_waitcnt lgkmcnt(2)
    buffer_store_dwordx4 v[144:147], v15, s[36:39], s54 offen sc1
    s_mov_b32 s54, 24576
    s_waitcnt lgkmcnt(1)
    buffer_store_dwordx4 v[148:151], v15, s[36:39], s54 offen sc1
    s_mov_b32 s54, 32768
    s_waitcnt lgkmcnt(0)
    buffer_store_dwordx4 v[152:155], v15, s[36:39], s54 offen sc1
    s_lshl_b32 s54, s2, 3
    s_add_u32 s54, s54, s3
    s_lshl_b32 s54, s54, 8
    s_mov_b32 s16, s64
    s_mov_b32 s17, s65
    s_mov_b32 s18, 10240000
    s_mov_b32 s19, 0x20000
    s_add_u32 s28, s14, 5242880
    s_addc_u32 s29, s15, 0
    s_mov_b32 s30, 10485760
    s_mov_b32 s31, 0x20000
    s_and_b32 s51, s2, 7
    s_mul_i32 s51, s51, 1282048
    s_and_b32 s55, s2, 0xf8
    s_add_u32 s55, s55, s3
    s_mul_i32 s55, s55, 2560
    s_add_u32 s51, s51, s55
    v_min_u32 v14, 19, v1
    v_lshlrev_b32 v14, 7, v14
    s_waitcnt vmcnt(0)
    s_barrier
    s_mov_b64 exec, 0xffff
    buffer_store_dwordx4 v[112:115], v2, s[20:23], s54 offen sc1
    s_mov_b64 exec, -1
    buffer_load_dword v7, v14, s[16:19], s51 offen
    s_lshl_b32 s54, s45, 10
    s_add_u32 s40, s12, s54
    s_addc_u32 s41, s13, 0
    s_lshl_b32 s42, s46, 10
    s_mov_b32 s43, 0x20000
    v_lshl_or_b32 v188, v121, 16, v120
    v_lshl_or_b32 v189, v123, 16, v122
    v_lshrrev_b32 v8, 5, v1
    v_lshlrev_b32 v8, 11, v8
    v_and_b32 v9, 15, v1
    v_lshl_add_u32 v8, v9, 4, v8
    ds_read_b128 v[64:67], v8 offset:17408
    ds_read_b128 v[68:71], v8 offset:17664
    ds_read_b128 v[72:75], v8 offset:17920
    ds_read_b128 v[76:79], v8 offset:18176
    ds_read_b128 v[80:83], v8 offset:18432
    ds_read_b128 v[84:87], v8 offset:18688
    ds_read_b128 v[88:91], v8 offset:18944
    ds_read_b128 v[92:95], v8 offset:19200
    v_bfe_i32 v10, v1, 4, 1
    v_and_b32 v10, 0x02020202, v10
    v_add_u32 v10, 0x05040100, v10
    v_lshrrev_b32 v8, 4, v1
    v_lshlrev_b32 v8, 13, v8
    v_lshl_add_u32 v8, v9, 2, v8
    s_and_b32 s72, s3, 3
    s_lshl_b32 s72, s72, 6
    s_add_u32 s72, s72, 21504
    v_add_u32 v8, s72, v8
    ds_read2st64_b32 v[128:129], v8 offset0:0 offset1:4
    ds_read2st64_b32 v[130:131], v8 offset0:8 offset1:12
    ds_read2st64_b32 v[132:133], v8 offset0:16 offset1:20
    ds_read2st64_b32 v[134:135], v8 offset0:24 offset1:28
    ds_read2st64_b32 v[136:137], v8 offset0:1 offset1:5
    ds_read2st64_b32 v[138:139], v8 offset0:9 offset1:13
    ds_read2st64_b32 v[140:141], v8 offset0:17 offset1:21
    ds_read2st64_b32 v[142:143], v8 offset0:25 offset1:29
    ds_read2st64_b32 v[144:145], v8 offset0:2 offset1:6
    ds_read2st64_b32 v[146:147], v8 offset0:10 offset1:14
    ds_read2st64_b32 v[148:149], v8 offset0:18 offset1:22
    ds_read2st64_b32 v[150:151], v8 offset0:26 offset1:30
    ds_read2st64_b32 v[152:153], v8 offset0:3 offset1:7
    ds_read2st64_b32 v[154:155], v8 offset0:11 offset1:15
    ds_read2st64_b32 v[156:157], v8 offset0:19 offset1:23
    ds_read2st64_b32 v[158:159], v8 offset0:27 offset1:31
    s_mov_b32 s72, 0x05040100
    s_mov_b32 s73, 0x07060302
    s_waitcnt lgkmcnt(15)
    v_perm_b32 v172, v68, v64, v10
    v_perm_b32 v173, v76, v72, v10
    v_perm_b32 v174, v84, v80, v10
    v_perm_b32 v175, v92, v88, v10
    v_perm_b32 v176, v69, v65, v10
    v_perm_b32 v177, v77, v73, v10
    v_perm_b32 v178, v85, v81, v10
    v_perm_b32 v179, v93, v89, v10
    v_perm_b32 v180, v70, v66, v10
    v_perm_b32 v181, v78, v74, v10
    v_perm_b32 v182, v86, v82, v10
    v_perm_b32 v183, v94, v90, v10
    v_perm_b32 v184, v71, v67, v10
    v_perm_b32 v185, v79, v75, v10
    v_perm_b32 v186, v87, v83, v10
    v_perm_b32 v187, v95, v91, v10
    s_waitcnt lgkmcnt(0)
    v_perm_b32 v208, v129, v128, s72
    v_perm_b32 v209, v131, v130, s72
    v_perm_b32 v210, v133, v132, s72
    v_perm_b32 v211, v135, v134, s72
    v_perm_b32 v212, v129, v128, s73
    v_perm_b32 v213, v131, v130, s73
    v_perm_b32 v214, v133, v132, s73
    v_perm_b32 v215, v135, v134, s73
    v_perm_b32 v216, v137, v136, s72
    v_perm_b32 v217, v139, v138, s72
    v_perm_b32 v218, v141, v140, s72
    v_perm_b32 v219, v143, v142, s72
    v_perm_b32 v220, v137, v136, s73
    v_perm_b32 v221, v139, v138, s73
    v_perm_b32 v222, v141, v140, s73
    v_perm_b32 v223, v143, v142, s73
    v_perm_b32 v224, v145, v144, s72
    v_perm_b32 v225, v147, v146, s72
    v_perm_b32 v226, v149, v148, s72
    v_perm_b32 v227, v151, v150, s72
    v_perm_b32 v228, v145, v144, s73
    v_perm_b32 v229, v147, v146, s73
    v_perm_b32 v230, v149, v148, s73
    v_perm_b32 v231, v151, v150, s73
    v_perm_b32 v232, v153, v152, s72
    v_perm_b32 v233, v155, v154, s72
    v_perm_b32 v234, v157, v156, s72
    v_perm_b32 v235, v159, v158, s72
    v_perm_b32 v236, v153, v152, s73
    v_perm_b32 v237, v155, v154, s73
    v_perm_b32 v238, v157, v156, s73
    v_perm_b32 v239, v159, v158, s73
    v_lshrrev_b32 v9, 1, v0
    v_lshlrev_b32 v10, 11, v9
    s_lshl_b32 s49, s44, 3
    v_mul_u32_u24 v5, 1280, v9
    s_mov_b32 s48, 0
    s_mov_b32 s53, 200000
    s_mov_b32 s55, 0xffc00000
    s_lshl_b32 s52, s3, 13
    s_add_u32 s52, s52, 79872
    s_movk_i32 s98, 4096
    s_waitcnt vmcnt(0)
    s_barrier
    buffer_load_dwordx2 v[206:207], v10, s[20:23], s49 offen sc1
    s_waitcnt vmcnt(0)
    v_xor_b32 v11, s63, v206
    v_xor_b32 v12, s62, v207
    v_and_or_b32 v11, v11, s55, v12
    v_cmpx_ne_u32 vcc, 0, v11
    s_cbranch_execnz L_poll
L_polled:
    s_mov_b64 exec, -1
    v_bfe_u32 v3, v206, 11, 11
    v_and_b32 v4, v3, v240
    v_add_u32 v10, v3, v240
    v_and_b32 v11, 0x7ff, v206
    v_add_u32_dpp v4, v4, v4 row_shr:1 row_mask:0xf bank_mask:0xf
    v_cmp_lt_i32 s[64:65], 0, v10
    v_cmp_lt_i32 s[66:67], 2, v10
    v_add_u32_dpp v4, v4, v4 row_shr:2 row_mask:0xf bank_mask:0xf
    v_cmp_lt_i32 s[68:69], 4, v10
    v_cmp_lt_i32 s[70:71], 6, v10
    v_add_u32_dpp v4, v4, v4 row_shr:4 row_mask:0xf bank_mask:0xf
    v_cmp_lt_i32 s[72:73], 8, v10
    v_cmp_lt_i32 s[74:75], 10, v10
    v_add_u32_dpp v4, v4, v4 row_shr:8 row_mask:0xf bank_mask:0xf
    v_cmp_lt_i32 s[76:77], 12, v10
    v_cmp_lt_i32 s[78:79], 14, v10
    v_add_u32_dpp v4, v4, v4 row_bcast:15 row_mask:0xa bank_mask:0xf
    v_add_u32 v5, v5, v11
    s_nop 0
    v_add_u32_dpp v4, v4, v4 row_bcast:31 row_mask:0xc bank_mask:0xf
    s_nop 0
    v_readlane_b32 s95, v4, 63
    v_mov_b32_dpp v4, v4 quad_perm:[0,0,2,2] row_mask:0xf bank_mask:0xf
    v_sub_u32 v5, v5, v4
    v_lshl_add_u32 v8, v4, 2, v241
    s_cmp_gt_u32 s95, 256
    s_cbranch_scc1 L_clip
L_mapw:
    s_mov_b64 exec, s[64:65]
    ds_write_b32 v8, v5 offset:0
    s_mov_b64 exec, s[66:67]
    ds_write_b32 v8, v5 offset:8
    s_mov_b64 exec, s[68:69]
    ds_write_b32 v8, v5 offset:16
    s_mov_b64 exec, s[70:71]
    ds_write_b32 v8, v5 offset:24
    s_mov_b64 exec, s[72:73]
    ds_write_b32 v8, v5 offset:32
    s_mov_b64 exec, s[74:75]
    ds_write_b32 v8, v5 offset:40
    s_mov_b64 exec, s[76:77]
    ds_write_b32 v8, v5 offset:48
    s_mov_b64 exec, -1
    s_cmp_lg_u64 s[78:79], 0
    s_cbranch_scc1 L_map2
    ds_read_b32 v64, v242 offset:0
    ds_read_b32 v65, v242 offset:256
    ds_read_b32 v66, v242 offset:512
    ds_read_b32 v68, v243 offset:0
    ds_read_b32 v69, v243 offset:128
    ds_read_b32 v70, v243 offset:256
    ds_read_b32 v71, v243 offset:384
    ds_read_b32 v72, v243 offset:512
    ds_read_b32 v73, v243 offset:640
    s_cmp_gt_i32 s95, 192
    s_cbranch_scc1 L_r1
L_r1b:
    s_waitcnt lgkmcnt(6)
    v_mad_u32_u24 v64, v64, 12, v244
    buffer_load_dwordx3 v[76:78], v64, s[24:27], 0 offen offset:0 sc1
    v_mad_u32_u24 v65, v65, 12, v244
    buffer_load_dwordx3 v[80:82], v65, s[24:27], 0 offen offset:768 sc1
    v_mad_u32_u24 v66, v66, 12, v244
    buffer_load_dwordx3 v[84:86], v66, s[24:27], 0 offen offset:1536 sc1
    v_mov_b32 v11, s95
    s_mov_b64 exec, 1
    ds_max_i32 v13, v11 offset:15360
    s_mov_b64 exec, -1
    s_waitcnt lgkmcnt(1)
    v_lshl_add_u32 v68, v68, 5, v2
    v_lshl_add_u32 v69, v69, 5, v2
    v_lshl_add_u32 v70, v70, 5, v2
    v_lshl_add_u32 v71, v71, 5, v2
    v_lshl_add_u32 v72, v72, 5, v2
    v_lshl_add_u32 v73, v73, 5, v2
    s_barrier
    s_add_u32 m0, s52, 0
    s_nop 0
    buffer_load_dwordx4 v68, s[28:31], 0 offen offset:0 sc1 lds
    v_add_u32 v11, 0, v1
    v_cmp_gt_i32 s[80:81], s95, v11
    v_add_u32 v11, 64, v1
    v_cmp_gt_i32 s[82:83], s95, v11
    v_add_u32 v11, 128, v1
    v_cmp_gt_i32 s[84:85], s95, v11
    v_add_u32 v11, 192, v1
    v_cmp_gt_i32 s[96:97], s95, v11
    s_mov_b32 s55, 0x1fff80
    s_mul_i32 s61, s3, 5
    s_waitcnt vmcnt(3)
    v_lshrrev_b32 v132, 21, v78
    v_lshlrev_b32 v132, 2, v132
    v_lshrrev_b32 v11, 26, v78
    v_lshl_or_b32 v11, v11, 4, v245
    s_mov_b64 exec, s[80:81]
    ds_add_rtn_u32 v128, v132, v6 offset:8192
    ds_add_u32 v11, v6 offset:14336
    s_mov_b64 exec, -1
    s_waitcnt vmcnt(2)
    v_lshrrev_b32 v133, 21, v82
    v_lshlrev_b32 v133, 2, v133
    v_lshrrev_b32 v11, 26, v82
    v_lshl_or_b32 v11, v11, 4, v245
    s_mov_b64 exec, s[82:83]
    ds_add_rtn_u32 v129, v133, v6 offset:8192
    ds_add_u32 v11, v6 offset:14336
    s_mov_b64 exec, -1
    s_waitcnt vmcnt(1)
    v_lshrrev_b32 v134, 21, v86
    v_lshlrev_b32 v134, 2, v134
    v_lshrrev_b32 v11, 26, v86
    v_lshl_or_b32 v11, v11, 4, v245
    s_mov_b64 exec, s[84:85]
    ds_add_rtn_u32 v130, v134, v6 offset:8192
    ds_add_u32 v11, v6 offset:14336
    s_mov_b64 exec, -1
    s_cmp_gt_i32 s95, 192
    s_cbranch_scc1 L_r2
L_r2b:
    ds_write_b64 v246, v[76:77] offset:0
    v_and_or_b32 v78, v78, s55, v247
    ds_write_b64 v246, v[80:81] offset:512
    v_and_or_b32 v82, v82, s55, v247
    v_add_u32 v82, 134217728, v82
    ds_write_b64 v246, v[84:85] offset:1024
    v_and_or_b32 v86, v86, s55, v247
    v_add_u32 v86, 268435456, v86
    s_add_u32 m0, s52, 0
    s_nop 0
    buffer_load_dwordx4 v69, s[28:31], 0 offen offset:1024 sc1 lds
    s_add_u32 m0, s52, 0
    s_nop 0
    buffer_load_dwordx4 v70, s[28:31], 0 offen offset:2048 sc1 lds
    s_waitcnt lgkmcnt(3)
    s_barrier
    s_cmp_lg_u32 s48, 0
    s_cbranch_scc1 L_rank2
    ds_read_b128 v[104:107], v2 offset:14336
    ds_read_b32 v96, v248 offset:8192
    ds_read_b32 v97, v248 offset:8320
    ds_read_b32 v98, v248 offset:8448
    ds_read_b32 v99, v248 offset:8576
    ds_read_b32 v100, v248 offset:8704
    ds_read_b32 v14, v13 offset:15360
    s_add_u32 s65, s61, 1
    s_add_u32 s66, s61, 2
    s_add_u32 s67, s61, 3
    s_add_u32 s68, s61, 4
    s_waitcnt lgkmcnt(6)
    v_add_u32 v9, v104, v105
    v_add3_u32 v9, v9, v106, v107
    v_lshl_or_b32 v9, v9, 6, v249
    s_nop 0
    v_readlane_b32 s64, v9, s61
    v_readlane_b32 s65, v9, s65
    v_readlane_b32 s66, v9, s66
    v_readlane_b32 s67, v9, s67
    v_readlane_b32 s68, v9, s68
    v_cmp_lt_u32 s[70:71], s64, v9
    v_cmp_lt_u32 s[72:73], s65, v9
    v_cmp_lt_u32 s[74:75], s66, v9
    v_cmp_lt_u32 s[76:77], s67, v9
    v_cmp_lt_u32 s[78:79], s68, v9
    s_bcnt1_i32_b64 s64, s[70:71]
    s_bcnt1_i32_b64 s65, s[72:73]
    s_bcnt1_i32_b64 s66, s[74:75]
    s_bcnt1_i32_b64 s67, s[76:77]
    s_bcnt1_i32_b64 s68, s[78:79]
    s_waitcnt lgkmcnt(0)
    v_readlane_b32 s90, v203, s64
    v_readlane_b32 s91, v203, s65
    v_readlane_b32 s92, v203, s66
    v_readlane_b32 s93, v203, s67
    v_readlane_b32 s94, v203, s68
    v_readfirstlane_b32 s47, v14
L_ranked:
    s_mov_b32 exec_hi, 0
    s_and_b32 s54, s90, 0x380
    v_add_u32 v104, s54, v250
    ds_add_rtn_u32 v96, v104, v96 offset:13312
    s_and_b32 s54, s91, 0x380
    v_add_u32 v105, s54, v250
    ds_add_rtn_u32 v97, v105, v97 offset:13312
    s_and_b32 s54, s92, 0x380
    v_add_u32 v106, s54, v250
    ds_add_rtn_u32 v98, v106, v98 offset:13312
    s_and_b32 s54, s93, 0x380
    v_add_u32 v107, s54, v250
    ds_add_rtn_u32 v99, v107, v99 offset:13312
    s_and_b32 s54, s94, 0x380
    v_add_u32 v108, s54, v250
    ds_add_rtn_u32 v100, v108, v100 offset:13312
    v_or_b32 v104, s90, v104
    v_or_b32 v105, s91, v105
    v_or_b32 v106, s92, v106
    v_or_b32 v107, s93, v107
    v_or_b32 v108, s94, v108
    v_writelane_b32 v11, s90, 0
    v_writelane_b32 v11, s91, 1
    v_writelane_b32 v11, s92, 2
    v_writelane_b32 v11, s93, 3
    v_writelane_b32 v11, s94, 4
    s_waitcnt lgkmcnt(4)
    v_lshl_or_b32 v96, v96, 16, v104
    ds_write_b32 v248, v96 offset:8192
    s_waitcnt lgkmcnt(4)
    v_lshl_or_b32 v97, v97, 16, v105
    ds_write_b32 v248, v97 offset:8320
    s_waitcnt lgkmcnt(4)
    v_lshl_or_b32 v98, v98, 16, v106
    ds_write_b32 v248, v98 offset:8448
    s_waitcnt lgkmcnt(4)
    v_lshl_or_b32 v99, v99, 16, v107
    ds_write_b32 v248, v99 offset:8576
    s_waitcnt lgkmcnt(4)
    v_lshl_or_b32 v100, v100, 16, v108
    ds_write_b32 v248, v100 offset:8704
    v_add_lshl_u32 v12, v1, s61, 7
    v_lshrrev_b32 v9, 10, v11
    v_bfe_u32 v11, v11, 2, 8
    v_or_b32 v11, v11, v9
    s_mov_b32 exec_lo, 31
    ds_write_b32 v11, v12 offset:15616
    s_mov_b64 exec, -1
    s_add_u32 m0, s52, 0
    s_nop 0
    buffer_load_dwordx4 v71, s[28:31], 0 offen offset:3072 sc1 lds
    s_add_u32 m0, s52, 4096
    s_nop 0
    buffer_load_dwordx4 v72, s[28:31], s98 offen offset:0 sc1 lds
    s_add_u32 m0, s52, 4096
    s_nop 0
    buffer_load_dwordx4 v73, s[28:31], s98 offen offset:1024 sc1 lds
    s_lshl_b32 s54, s3, 3
    s_add_u32 s55, s54, 7
    s_waitcnt lgkmcnt(0)
    s_barrier
    ds_read_b128 v[96:99], v2 offset:13312
    ds_read_b32 v132, v132 offset:8192
    ds_read_b32 v133, v133 offset:8192
    ds_read_b32 v134, v134 offset:8192
    ds_read_b32 v11, v251 offset:15616
    s_waitcnt lgkmcnt(4)
    v_add_u32 v9, v96, v97
    v_add3_u32 v9, v9, v98, v99
    v_mov_b32 v10, v9
    s_waitcnt lgkmcnt(1)
    v_bfe_u32 v15, v132, 12, 3
    v_add_u32_dpp v10, v10, v10 row_shr:1 row_mask:0xf bank_mask:0xf
    v_or_b32 v78, v15, v78
    v_and_b32 v64, 0x3ff, v132
    v_add_u32_dpp v10, v10, v10 row_shr:2 row_mask:0xf bank_mask:0xf
    v_lshrrev_b32 v132, 16, v132
    v_add_u32 v132, v132, v128
    v_add_u32_dpp v10, v10, v10 row_shr:4 row_mask:0xf bank_mask:0xf
    v_bfe_u32 v15, v133, 12, 3
    v_or_b32 v82, v15, v82
    v_add_u32_dpp v10, v10, v10 row_shr:8 row_mask:0xf bank_mask:0xf
    v_and_b32 v65, 0x3ff, v133
    v_lshrrev_b32 v133, 16, v133
    v_add_u32_dpp v10, v10, v10 row_bcast:15 row_mask:0xa bank_mask:0xf
    v_add_u32 v133, v133, v129
    v_bfe_u32 v15, v134, 12, 3
    v_add_u32_dpp v10, v10, v10 row_bcast:31 row_mask:0xc bank_mask:0xf
    v_or_b32 v86, v15, v86
    v_and_b32 v66, 0x3ff, v134
    v_sub_u32 v9, v10, v9
    v_lshl_add_u32 v104, v9, 2, v252
    v_lshl_add_u32 v105, v96, 2, v104
    v_lshl_add_u32 v106, v97, 2, v105
    v_lshl_add_u32 v107, v98, 2, v106
    ds_write_b128 v2, v[104:107] offset:16384
    ds_read_b32 v64, v64 offset:16384
    ds_read_b32 v65, v65 offset:16384
    ds_read_b32 v66, v66 offset:16384
    v_lshrrev_b32 v134, 16, v134
    v_add_u32 v134, v134, v130
    v_readlane_b32 s50, v10, s55
    v_readlane_b32 s53, v9, s54
    v_readlane_b32 s51, v104, s54
    v_mov_b32 v12, 2097029
    s_sub_u32 s50, s50, s53
    s_lshl_b32 s54, s50, 2
    v_add_u32 v198, s51, v201
    v_add_u32 v199, s51, v202
    v_add_u32 v9, s54, v198
    s_waitcnt lgkmcnt(2)
    v_lshl_add_u32 v132, v132, 2, v64
    s_mov_b64 exec, s[80:81]
    ds_write_b32 v132, v78
    s_mov_b64 exec, -1
    s_waitcnt lgkmcnt(2)
    v_lshl_add_u32 v133, v133, 2, v65
    s_mov_b64 exec, s[82:83]
    ds_write_b32 v133, v82
    s_mov_b64 exec, -1
    s_waitcnt lgkmcnt(2)
    v_lshl_add_u32 v134, v134, 2, v66
    s_mov_b64 exec, s[84:85]
    ds_write_b32 v134, v86
    s_mov_b64 exec, -1
    ds_write_b32 v9, v12
    s_cmp_gt_i32 s95, 192
    s_cbranch_scc1 L_r3
L_r3b:
    v_readlane_b32 s56, v11, 0
    v_readlane_b32 s57, v11, 1
    v_readlane_b32 s58, v11, 2
    v_readlane_b32 s59, v11, 3
    v_readlane_b32 s60, v11, 4
    s_mov_b32 s55, 0x00fffc38
    s_mov_b32 s53, s50
    s_mov_b32 s49, 0xffffff00
    s_mov_b32 s51, 63488
    s_waitcnt vmcnt(0) lgkmcnt(0)
    s_barrier
    ds_read_b32 v196, v198
    ds_read_b32 v194, v199
    ds_read_b32 v197, v198 offset:24
    s_cmp_eq_u32 s50, 0
    s_cbranch_scc1 L_swept
    s_waitcnt lgkmcnt(1)
    v_lshlrev_b32 v196, 3, v196
    v_and_b32 v196, s55, v196
    s_nop 0
    v_readlane_b32 s64, v196, 0
    v_readlane_b32 s65, v196, 1
    v_readlane_b32 s66, v196, 2
    s_and_b32 s61, s64, s49
    buffer_load_dwordx4 v[96:99], v2, s[16:19], s61 offen
    v_readlane_b32 s67, v196, 3
    s_and_b32 s61, s65, s49
    buffer_load_dwordx4 v[100:103], v2, s[16:19], s61 offen
    v_lshrrev_b32 v8, 21, v194
    v_lshl_add_u32 v11, v8, 3, s51
    v_lshl_add_u32 v8, v8, 5, v200
    ds_read_b64 v[192:193], v11
    s_mov_b64 exec, s[86:87]
    ds_read_b128 v[164:167], v8
    s_mov_b64 exec, s[88:89]
    ds_read_b128 v[168:171], v8
    s_mov_b64 exec, -1
    v_readlane_b32 s68, v196, 4
    s_and_b32 s61, s66, s49
    buffer_load_dwordx4 v[104:107], v2, s[16:19], s61 offen
    v_readlane_b32 s69, v196, 5
    s_and_b32 s61, s67, s49
    buffer_load_dwordx4 v[108:111], v2, s[16:19], s61 offen
    s_and_b32 s61, s68, s49
    buffer_load_dwordx4 v[112:115], v2, s[16:19], s61 offen
    s_and_b32 s61, s69, s49
    buffer_load_dwordx4 v[116:119], v2, s[16:19], s61 offen
    s_cmp_lt_u32 s3, 4
    s_cbranch_scc1 L_np
    s_setprio 1
L_np:
.p2align 3
L_loop:
    s_waitcnt lgkmcnt(0)
.p2align 3
    v_mfma_f32_4x4x4_16b_bf16 v[144:147], v[192:193], v[188:189], 0 cbsz:4 abid:0
    v_mfma_f32_4x4x4_16b_bf16 v[148:151], v[192:193], v[188:189], 0 cbsz:4 abid:2
    v_mfma_f32_4x4x4_16b_bf16 v[152:155], v[192:193], v[188:189], 0 cbsz:4 abid:4
    v_mfma_f32_4x4x4_16b_bf16 v[156:159], v[192:193], v[188:189], 0 cbsz:4 abid:6
    v_mfma_f32_32x32x16_bf16 v[64:79], v[164:167], v[172:175], 0
    v_lshlrev_b32 v196, 3, v197
    v_and_b32 v196, s55, v196
    v_add_u32 v198, 64, v198
    v_mfma_f32_32x32x16_bf16 v[80:95], v[164:167], v[180:183], 0
    v_add_u32 v199, 64, v199
    ds_read_b32 v197, v198 offset:24
    ds_read_b32 v194, v199
    v_mfma_f32_32x32x16_bf16 v[64:79], v[168:171], v[176:179], v[64:79]
    v_cvt_pk_bf16_f32 v9, v144, v144
    v_and_b32 v160, v190, v9
    v_and_b32 v161, v191, v9
    v_mfma_f32_32x32x16_bf16 v[80:95], v[168:171], v[184:187], v[80:95]
    s_waitcnt vmcnt(5)
.p2align 3
    v_mfma_f32_16x16x16_bf16 v[128:131], v[160:161], v[96:97], 0
    v_readlane_b32 s70, v196, 0
    v_cvt_pk_bf16_f32 v10, v145, v145
    v_mfma_f32_16x16x16_bf16 v[132:135], v[160:161], v[98:99], 0
    v_and_b32 v162, v190, v10
    v_and_b32 v163, v191, v10
    s_and_b32 s61, s70, s49
    s_waitcnt vmcnt(4)
    buffer_load_dwordx4 v[120:123], v2, s[16:19], s61 offen
    v_mfma_f32_16x16x16_bf16 v[136:139], v[162:163], v[100:101], 0
    v_readlane_b32 s71, v196, 1
    v_cvt_pk_bf16_f32 v9, v146, v146
    v_mfma_f32_16x16x16_bf16 v[140:143], v[162:163], v[102:103], 0
    v_and_b32 v160, v190, v9
    v_and_b32 v161, v191, v9
    s_and_b32 s61, s71, s49
    s_set_gpr_idx_on s64, gpr_idx(SRC2,DST)
    buffer_load_dwordx4 v[124:127], v2, s[16:19], s61 offen
    v_pk_fma_f32 v[16:17], v[128:129], v[64:65], v[16:17] op_sel_hi:[1,0,1]
    v_pk_fma_f32 v[18:19], v[130:131], v[64:65], v[18:19] op_sel_hi:[1,0,1]
    v_pk_fma_f32 v[20:21], v[132:133], v[80:81], v[20:21] op_sel_hi:[1,0,1]
    v_pk_fma_f32 v[22:23], v[134:135], v[80:81], v[22:23] op_sel_hi:[1,0,1]
    s_set_gpr_idx_idx s65
.p2align 3
    v_pk_fma_f32 v[16:17], v[136:137], v[64:65], v[16:17] op_sel:[0,1,0] op_sel_hi:[1,1,1]
    v_pk_fma_f32 v[18:19], v[138:139], v[64:65], v[18:19] op_sel:[0,1,0] op_sel_hi:[1,1,1]
    v_pk_fma_f32 v[20:21], v[140:141], v[80:81], v[20:21] op_sel:[0,1,0] op_sel_hi:[1,1,1]
    v_pk_fma_f32 v[22:23], v[142:143], v[80:81], v[22:23] op_sel:[0,1,0] op_sel_hi:[1,1,1]
    s_set_gpr_idx_off
    s_waitcnt vmcnt(5)
.p2align 3
    v_mfma_f32_16x16x16_bf16 v[128:131], v[160:161], v[104:105], 0
    v_readlane_b32 s72, v196, 2
    v_cvt_pk_bf16_f32 v10, v147, v147
    v_mfma_f32_16x16x16_bf16 v[132:135], v[160:161], v[106:107], 0
    v_and_b32 v162, v190, v10
    v_and_b32 v163, v191, v10
    s_and_b32 s61, s72, s49
    s_waitcnt vmcnt(4)
    buffer_load_dwordx4 v[96:99], v2, s[16:19], s61 offen
    v_mfma_f32_16x16x16_bf16 v[136:139], v[162:163], v[108:109], 0
    v_readlane_b32 s73, v196, 3
    v_cvt_pk_bf16_f32 v9, v148, v148
    v_mfma_f32_16x16x16_bf16 v[140:143], v[162:163], v[110:111], 0
    v_and_b32 v160, v190, v9
    v_and_b32 v161, v191, v9
    s_waitcnt lgkmcnt(0)
    v_lshrrev_b32 v8, 21, v194
    v_lshl_add_u32 v11, v8, 3, s51
    v_lshl_add_u32 v8, v8, 5, v200
    ds_read_b64 v[192:193], v11
    s_mov_b64 exec, s[86:87]
    ds_read_b128 v[164:167], v8
    s_mov_b64 exec, s[88:89]
    ds_read_b128 v[168:171], v8
    s_mov_b64 exec, -1
.p2align 3
    s_and_b32 s61, s73, s49
    s_set_gpr_idx_on s66, gpr_idx(SRC2,DST)
    buffer_load_dwordx4 v[100:103], v2, s[16:19], s61 offen
    v_pk_fma_f32 v[16:17], v[128:129], v[66:67], v[16:17] op_sel_hi:[1,0,1]
    v_pk_fma_f32 v[18:19], v[130:131], v[66:67], v[18:19] op_sel_hi:[1,0,1]
    v_pk_fma_f32 v[20:21], v[132:133], v[82:83], v[20:21] op_sel_hi:[1,0,1]
    v_pk_fma_f32 v[22:23], v[134:135], v[82:83], v[22:23] op_sel_hi:[1,0,1]
    s_set_gpr_idx_idx s67
.p2align 3
    v_pk_fma_f32 v[16:17], v[136:137], v[66:67], v[16:17] op_sel:[0,1,0] op_sel_hi:[1,1,1]
    v_pk_fma_f32 v[18:19], v[138:139], v[66:67], v[18:19] op_sel:[0,1,0] op_sel_hi:[1,1,1]
    v_pk_fma_f32 v[20:21], v[140:141], v[82:83], v[20:21] op_sel:[0,1,0] op_sel_hi:[1,1,1]
    v_pk_fma_f32 v[22:23], v[142:143], v[82:83], v[22:23] op_sel:[0,1,0] op_sel_hi:[1,1,1]
    s_set_gpr_idx_off
    s_cmp_le_u32 s53, 4
    s_cbranch_scc1 L_swept
    s_waitcnt vmcnt(5)
.p2align 3
    v_mfma_f32_16x16x16_bf16 v[128:131], v[160:161], v[112:113], 0
    v_readlane_b32 s74, v196, 4
    v_cvt_pk_bf16_f32 v10, v149, v149
    v_mfma_f32_16x16x16_bf16 v[132:135], v[160:161], v[114:115], 0
    v_and_b32 v162, v190, v10
    v_and_b32 v163, v191, v10
    s_and_b32 s61, s74, s49
    s_waitcnt vmcnt(4)
    buffer_load_dwordx4 v[104:107], v2, s[16:19], s61 offen
    v_mfma_f32_16x16x16_bf16 v[136:139], v[162:163], v[116:117], 0
    v_readlane_b32 s75, v196, 5
    v_cvt_pk_bf16_f32 v9, v150, v150
    v_mfma_f32_16x16x16_bf16 v[140:143], v[162:163], v[118:119], 0
    v_and_b32 v160, v190, v9
    v_and_b32 v161, v191, v9
    s_and_b32 s61, s75, s49
    s_set_gpr_idx_on s68, gpr_idx(SRC2,DST)
    buffer_load_dwordx4 v[108:111], v2, s[16:19], s61 offen
    v_pk_fma_f32 v[16:17], v[128:129], v[68:69], v[16:17] op_sel_hi:[1,0,1]
    v_pk_fma_f32 v[18:19], v[130:131], v[68:69], v[18:19] op_sel_hi:[1,0,1]
    v_pk_fma_f32 v[20:21], v[132:133], v[84:85], v[20:21] op_sel_hi:[1,0,1]
    v_pk_fma_f32 v[22:23], v[134:135], v[84:85], v[22:23] op_sel_hi:[1,0,1]
    s_set_gpr_idx_idx s69
.p2align 3
    v_pk_fma_f32 v[16:17], v[136:137], v[68:69], v[16:17] op_sel:[0,1,0] op_sel_hi:[1,1,1]
    v_pk_fma_f32 v[18:19], v[138:139], v[68:69], v[18:19] op_sel:[0,1,0] op_sel_hi:[1,1,1]
    v_pk_fma_f32 v[20:21], v[140:141], v[84:85], v[20:21] op_sel:[0,1,0] op_sel_hi:[1,1,1]
    v_pk_fma_f32 v[22:23], v[142:143], v[84:85], v[22:23] op_sel:[0,1,0] op_sel_hi:[1,1,1]
    s_set_gpr_idx_off
    s_waitcnt vmcnt(5)
.p2align 3
    v_mfma_f32_16x16x16_bf16 v[128:131], v[160:161], v[120:121], 0
    v_readlane_b32 s76, v196, 6
    v_cvt_pk_bf16_f32 v10, v151, v151
    v_mfma_f32_16x16x16_bf16 v[132:135], v[160:161], v[122:123], 0
    v_and_b32 v162, v190, v10
    v_and_b32 v163, v191, v10
    s_and_b32 s61, s76, s49
    s_waitcnt vmcnt(4)
    buffer_load_dwordx4 v[112:115], v2, s[16:19], s61 offen
    v_mfma_f32_16x16x16_bf16 v[136:139], v[162:163], v[124:125], 0
    v_readlane_b32 s77, v196, 7
    v_cvt_pk_bf16_f32 v9, v152, v152
    v_mfma_f32_16x16x16_bf16 v[140:143], v[162:163], v[126:127], 0
    v_and_b32 v160, v190, v9
    v_and_b32 v161, v191, v9
    s_and_b32 s61, s77, s49
    s_set_gpr_idx_on s70, gpr_idx(SRC2,DST)
    buffer_load_dwordx4 v[116:119], v2, s[16:19], s61 offen
    v_pk_fma_f32 v[16:17], v[128:129], v[70:71], v[16:17] op_sel_hi:[1,0,1]
    v_pk_fma_f32 v[18:19], v[130:131], v[70:71], v[18:19] op_sel_hi:[1,0,1]
    v_pk_fma_f32 v[20:21], v[132:133], v[86:87], v[20:21] op_sel_hi:[1,0,1]
    v_pk_fma_f32 v[22:23], v[134:135], v[86:87], v[22:23] op_sel_hi:[1,0,1]
    s_set_gpr_idx_idx s71
.p2align 3
    v_pk_fma_f32 v[16:17], v[136:137], v[70:71], v[16:17] op_sel:[0,1,0] op_sel_hi:[1,1,1]
    v_pk_fma_f32 v[18:19], v[138:139], v[70:71], v[18:19] op_sel:[0,1,0] op_sel_hi:[1,1,1]
    v_pk_fma_f32 v[20:21], v[140:141], v[86:87], v[20:21] op_sel:[0,1,0] op_sel_hi:[1,1,1]
    v_pk_fma_f32 v[22:23], v[142:143], v[86:87], v[22:23] op_sel:[0,1,0] op_sel_hi:[1,1,1]
    s_set_gpr_idx_off
    s_cmp_le_u32 s53, 8
    s_cbranch_scc1 L_swept
    s_waitcnt vmcnt(5)
.p2align 3
    v_mfma_f32_16x16x16_bf16 v[128:131], v[160:161], v[96:97], 0
    v_readlane_b32 s78, v196, 8
    v_cvt_pk_bf16_f32 v10, v153, v153
    v_mfma_f32_16x16x16_bf16 v[132:135], v[160:161], v[98:99], 0
    v_and_b32 v162, v190, v10
    v_and_b32 v163, v191, v10
    s_and_b32 s61, s78, s49
    s_waitcnt vmcnt(4)
    buffer_load_dwordx4 v[120:123], v2, s[16:19], s61 offen
    v_mfma_f32_16x16x16_bf16 v[136:139], v[162:163], v[100:101], 0
    v_readlane_b32 s79, v196, 9
    v_cvt_pk_bf16_f32 v9, v154, v154
    v_mfma_f32_16x16x16_bf16 v[140:143], v[162:163], v[102:103], 0
    v_and_b32 v160, v190, v9
    v_and_b32 v161, v191, v9
    s_and_b32 s61, s79, s49
    s_set_gpr_idx_on s72, gpr_idx(SRC2,DST)
    buffer_load_dwordx4 v[124:127], v2, s[16:19], s61 offen
    v_pk_fma_f32 v[16:17], v[128:129], v[72:73], v[16:17] op_sel_hi:[1,0,1]
    v_pk_fma_f32 v[18:19], v[130:131], v[72:73], v[18:19] op_sel_hi:[1,0,1]
    v_pk_fma_f32 v[20:21], v[132:133], v[88:89], v[20:21] op_sel_hi:[1,0,1]
    v_pk_fma_f32 v[22:23], v[134:135], v[88:89], v[22:23] op_sel_hi:[1,0,1]
    s_set_gpr_idx_idx s73
.p2align 3
    v_pk_fma_f32 v[16:17], v[136:137], v[72:73], v[16:17] op_sel:[0,1,0] op_sel_hi:[1,1,1]
    v_pk_fma_f32 v[18:19], v[138:139], v[72:73], v[18:19] op_sel:[0,1,0] op_sel_hi:[1,1,1]
    v_pk_fma_f32 v[20:21], v[140:141], v[88:89], v[20:21] op_sel:[0,1,0] op_sel_hi:[1,1,1]
    v_pk_fma_f32 v[22:23], v[142:143], v[88:89], v[22:23] op_sel:[0,1,0] op_sel_hi:[1,1,1]
    s_set_gpr_idx_off
    s_waitcnt vmcnt(5)
.p2align 3
    v_mfma_f32_16x16x16_bf16 v[128:131], v[160:161], v[104:105], 0
    v_readlane_b32 s64, v196, 10
    v_cvt_pk_bf16_f32 v10, v155, v155
    v_mfma_f32_16x16x16_bf16 v[132:135], v[160:161], v[106:107], 0
    v_and_b32 v162, v190, v10
    v_and_b32 v163, v191, v10
    s_and_b32 s61, s64, s49
    s_waitcnt vmcnt(4)
    buffer_load_dwordx4 v[96:99], v2, s[16:19], s61 offen
    v_mfma_f32_16x16x16_bf16 v[136:139], v[162:163], v[108:109], 0
    v_readlane_b32 s65, v196, 11
    v_cvt_pk_bf16_f32 v9, v156, v156
    v_mfma_f32_16x16x16_bf16 v[140:143], v[162:163], v[110:111], 0
    v_and_b32 v160, v190, v9
    v_and_b32 v161, v191, v9
    s_and_b32 s61, s65, s49
    s_set_gpr_idx_on s74, gpr_idx(SRC2,DST)
    buffer_load_dwordx4 v[100:103], v2, s[16:19], s61 offen
    v_pk_fma_f32 v[16:17], v[128:129], v[74:75], v[16:17] op_sel_hi:[1,0,1]
    v_pk_fma_f32 v[18:19], v[130:131], v[74:75], v[18:19] op_sel_hi:[1,0,1]
    v_pk_fma_f32 v[20:21], v[132:133], v[90:91], v[20:21] op_sel_hi:[1,0,1]
    v_pk_fma_f32 v[22:23], v[134:135], v[90:91], v[22:23] op_sel_hi:[1,0,1]
    s_set_gpr_idx_idx s75
.p2align 3
    v_pk_fma_f32 v[16:17], v[136:137], v[74:75], v[16:17] op_sel:[0,1,0] op_sel_hi:[1,1,1]
    v_pk_fma_f32 v[18:19], v[138:139], v[74:75], v[18:19] op_sel:[0,1,0] op_sel_hi:[1,1,1]
    v_pk_fma_f32 v[20:21], v[140:141], v[90:91], v[20:21] op_sel:[0,1,0] op_sel_hi:[1,1,1]
    v_pk_fma_f32 v[22:23], v[142:143], v[90:91], v[22:23] op_sel:[0,1,0] op_sel_hi:[1,1,1]
    s_set_gpr_idx_off
    s_cmp_le_u32 s53, 12
    s_cbranch_scc1 L_swept
    s_waitcnt vmcnt(5)
.p2align 3
    v_mfma_f32_16x16x16_bf16 v[128:131], v[160:161], v[112:113], 0
    v_readlane_b32 s66, v196, 12
    v_cvt_pk_bf16_f32 v10, v157, v157
    v_mfma_f32_16x16x16_bf16 v[132:135], v[160:161], v[114:115], 0
    v_and_b32 v162, v190, v10
    v_and_b32 v163, v191, v10
    s_and_b32 s61, s66, s49
    s_waitcnt vmcnt(4)
    buffer_load_dwordx4 v[104:107], v2, s[16:19], s61 offen
    v_mfma_f32_16x16x16_bf16 v[136:139], v[162:163], v[116:117], 0
    v_readlane_b32 s67, v196, 13
    v_cvt_pk_bf16_f32 v9, v158, v158
    v_mfma_f32_16x16x16_bf16 v[140:143], v[162:163], v[118:119], 0
    v_and_b32 v160, v190, v9
    v_and_b32 v161, v191, v9
    s_and_b32 s61, s67, s49
    s_set_gpr_idx_on s76, gpr_idx(SRC2,DST)
    buffer_load_dwordx4 v[108:111], v2, s[16:19], s61 offen
    v_pk_fma_f32 v[16:17], v[128:129], v[76:77], v[16:17] op_sel_hi:[1,0,1]
    v_pk_fma_f32 v[18:19], v[130:131], v[76:77], v[18:19] op_sel_hi:[1,0,1]
    v_pk_fma_f32 v[20:21], v[132:133], v[92:93], v[20:21] op_sel_hi:[1,0,1]
    v_pk_fma_f32 v[22:23], v[134:135], v[92:93], v[22:23] op_sel_hi:[1,0,1]
    s_set_gpr_idx_idx s77
.p2align 3
    v_pk_fma_f32 v[16:17], v[136:137], v[76:77], v[16:17] op_sel:[0,1,0] op_sel_hi:[1,1,1]
    v_pk_fma_f32 v[18:19], v[138:139], v[76:77], v[18:19] op_sel:[0,1,0] op_sel_hi:[1,1,1]
    v_pk_fma_f32 v[20:21], v[140:141], v[92:93], v[20:21] op_sel:[0,1,0] op_sel_hi:[1,1,1]
    v_pk_fma_f32 v[22:23], v[142:143], v[92:93], v[22:23] op_sel:[0,1,0] op_sel_hi:[1,1,1]
    s_set_gpr_idx_off
    s_waitcnt vmcnt(5)
.p2align 3
    v_mfma_f32_16x16x16_bf16 v[128:131], v[160:161], v[120:121], 0
    v_readlane_b32 s68, v196, 14
    v_cvt_pk_bf16_f32 v10, v159, v159
    v_mfma_f32_16x16x16_bf16 v[132:135], v[160:161], v[122:123], 0
    v_and_b32 v162, v190, v10
    v_and_b32 v163, v191, v10
    s_and_b32 s61, s68, s49
    s_waitcnt vmcnt(4)
    buffer_load_dwordx4 v[112:115], v2, s[16:19], s61 offen
    v_mfma_f32_16x16x16_bf16 v[136:139], v[162:163], v[124:125], 0
    v_readlane_b32 s69, v196, 15
    v_mfma_f32_16x16x16_bf16 v[140:143], v[162:163], v[126:127], 0
    s_and_b32 s61, s69, s49
    s_set_gpr_idx_on s78, gpr_idx(SRC2,DST)
    buffer_load_dwordx4 v[116:119], v2, s[16:19], s61 offen
    v_pk_fma_f32 v[16:17], v[128:129], v[78:79], v[16:17] op_sel_hi:[1,0,1]
    v_pk_fma_f32 v[18:19], v[130:131], v[78:79], v[18:19] op_sel_hi:[1,0,1]
    v_pk_fma_f32 v[20:21], v[132:133], v[94:95], v[20:21] op_sel_hi:[1,0,1]
    v_pk_fma_f32 v[22:23], v[134:135], v[94:95], v[22:23] op_sel_hi:[1,0,1]
    s_set_gpr_idx_idx s79
    s_sub_i32 s53, s53, 16
.p2align 3
    v_pk_fma_f32 v[16:17], v[136:137], v[78:79], v[16:17] op_sel:[0,1,0] op_sel_hi:[1,1,1]
    v_pk_fma_f32 v[18:19], v[138:139], v[78:79], v[18:19] op_sel:[0,1,0] op_sel_hi:[1,1,1]
    v_pk_fma_f32 v[20:21], v[140:141], v[94:95], v[20:21] op_sel:[0,1,0] op_sel_hi:[1,1,1]
    v_pk_fma_f32 v[22:23], v[142:143], v[94:95], v[22:23] op_sel:[0,1,0] op_sel_hi:[1,1,1]
    s_set_gpr_idx_off
    s_cmp_gt_i32 s53, 0
    s_cbranch_scc1 L_loop
L_swept:
    s_nop 7
    s_add_u32 s48, s48, 256
    s_cmp_lt_u32 s48, s47
    s_cbranch_scc1 L_again
    v_lshlrev_b32 v8, 2, v1
    s_mul_i32 s54, s56, 9
    v_cvt_pk_bf16_f32 v64, v16, v20
    v_cvt_pk_bf16_f32 v65, v17, v21
    v_cvt_pk_bf16_f32 v66, v18, v22
    v_cvt_pk_bf16_f32 v67, v19, v23
    v_add_u32 v84, s54, v8
    ds_write2_b32 v84, v64, v65 offset0:0 offset1:72
    ds_write2_b32 v84, v66, v67 offset0:144 offset1:216
    s_mul_i32 s54, s57, 9
    v_cvt_pk_bf16_f32 v68, v24, v28
    v_cvt_pk_bf16_f32 v69, v25, v29
    v_cvt_pk_bf16_f32 v70, v26, v30
    v_cvt_pk_bf16_f32 v71, v27, v31
    v_add_u32 v85, s54, v8
    ds_write2_b32 v85, v68, v69 offset0:0 offset1:72
    ds_write2_b32 v85, v70, v71 offset0:144 offset1:216
    s_mul_i32 s54, s58, 9
    v_cvt_pk_bf16_f32 v72, v32, v36
    v_cvt_pk_bf16_f32 v73, v33, v37
    v_cvt_pk_bf16_f32 v74, v34, v38
    v_cvt_pk_bf16_f32 v75, v35, v39
    v_add_u32 v86, s54, v8
    ds_write2_b32 v86, v72, v73 offset0:0 offset1:72
    ds_write2_b32 v86, v74, v75 offset0:144 offset1:216
    s_mul_i32 s54, s59, 9
    v_cvt_pk_bf16_f32 v76, v40, v44
    v_cvt_pk_bf16_f32 v77, v41, v45
    v_cvt_pk_bf16_f32 v78, v42, v46
    v_cvt_pk_bf16_f32 v79, v43, v47
    v_add_u32 v87, s54, v8
    ds_write2_b32 v87, v76, v77 offset0:0 offset1:72
    ds_write2_b32 v87, v78, v79 offset0:144 offset1:216
    s_mul_i32 s54, s60, 9
    v_cvt_pk_bf16_f32 v80, v48, v52
    v_cvt_pk_bf16_f32 v81, v49, v53
    v_cvt_pk_bf16_f32 v82, v50, v54
    v_cvt_pk_bf16_f32 v83, v51, v55
    v_add_u32 v88, s54, v8
    ds_write2_b32 v88, v80, v81 offset0:0 offset1:72
    ds_write2_b32 v88, v82, v83 offset0:144 offset1:216
    v_and_b32 v8, 15, v1
    v_lshrrev_b32 v9, 4, v1
    s_lshr_b32 s54, s3, 2
    s_mul_i32 s55, s54, 23040
    v_mul_u32_u24 v10, 288, v8
    v_lshl_add_u32 v10, v9, 4, v10
    v_add_u32 v10, s55, v10
    v_lshlrev_b32 v9, 10, v9
    v_lshl_add_u32 v9, v8, 2, v9
    s_mul_i32 s54, s54, 20480
    s_and_b32 s55, s3, 3
    s_lshl_b32 s55, s55, 6
    s_add_u32 s54, s54, s55
    s_waitcnt lgkmcnt(0)
    s_barrier
    ds_read_b128 v[16:19], v10 offset:0
    ds_read_b128 v[20:23], v10 offset:64
    ds_read_b128 v[24:27], v10 offset:128
    ds_read_b128 v[28:31], v10 offset:192
    ds_read_b128 v[32:35], v10 offset:4608
    ds_read_b128 v[36:39], v10 offset:4672
    ds_read_b128 v[40:43], v10 offset:4736
    ds_read_b128 v[44:47], v10 offset:4800
    ds_read_b128 v[48:51], v10 offset:9216
    ds_read_b128 v[52:55], v10 offset:9280
    ds_read_b128 v[56:59], v10 offset:9344
    ds_read_b128 v[60:63], v10 offset:9408
    s_waitcnt lgkmcnt(11)
    v_mfma_f32_16x16x32_bf16 v[128:131], v[16:19], v[208:211], 0
    v_mfma_f32_16x16x32_bf16 v[132:135], v[16:19], v[212:215], 0
    s_waitcnt lgkmcnt(10)
    v_mfma_f32_16x16x32_bf16 v[128:131], v[20:23], v[216:219], v[128:131]
    v_mfma_f32_16x16x32_bf16 v[132:135], v[20:23], v[220:223], v[132:135]
    s_waitcnt lgkmcnt(9)
    v_mfma_f32_16x16x32_bf16 v[128:131], v[24:27], v[224:227], v[128:131]
    v_mfma_f32_16x16x32_bf16 v[132:135], v[24:27], v[228:231], v[132:135]
    s_waitcnt lgkmcnt(8)
    v_mfma_f32_16x16x32_bf16 v[128:131], v[28:31], v[232:235], v[128:131]
    v_mfma_f32_16x16x32_bf16 v[132:135], v[28:31], v[236:239], v[132:135]
    ds_read_b128 v[64:67], v10 offset:13824
    ds_read_b128 v[68:71], v10 offset:13888
    ds_read_b128 v[72:75], v10 offset:13952
    ds_read_b128 v[76:79], v10 offset:14016
    s_waitcnt lgkmcnt(8)
    v_mfma_f32_16x16x32_bf16 v[136:139], v[32:35], v[208:211], 0
    v_mfma_f32_16x16x32_bf16 v[140:143], v[32:35], v[212:215], 0
    v_mfma_f32_16x16x32_bf16 v[136:139], v[36:39], v[216:219], v[136:139]
    v_mfma_f32_16x16x32_bf16 v[140:143], v[36:39], v[220:223], v[140:143]
    v_mfma_f32_16x16x32_bf16 v[136:139], v[40:43], v[224:227], v[136:139]
    v_mfma_f32_16x16x32_bf16 v[140:143], v[40:43], v[228:231], v[140:143]
    v_mfma_f32_16x16x32_bf16 v[136:139], v[44:47], v[232:235], v[136:139]
    v_mfma_f32_16x16x32_bf16 v[140:143], v[44:47], v[236:239], v[140:143]
    v_cvt_pk_bf16_f32 v168, v128, v132
    buffer_store_dword v168, v9, s[40:43], s54 offen offset:0 sc1
    v_cvt_pk_bf16_f32 v169, v129, v133
    buffer_store_dword v169, v9, s[40:43], s54 offen offset:256 sc1
    v_cvt_pk_bf16_f32 v170, v130, v134
    buffer_store_dword v170, v9, s[40:43], s54 offen offset:512 sc1
    v_cvt_pk_bf16_f32 v171, v131, v135
    buffer_store_dword v171, v9, s[40:43], s54 offen offset:768 sc1
    s_add_u32 s54, s54, 4096
    ds_read_b128 v[80:83], v10 offset:18432
    ds_read_b128 v[84:87], v10 offset:18496
    ds_read_b128 v[88:91], v10 offset:18560
    ds_read_b128 v[92:95], v10 offset:18624
    s_waitcnt lgkmcnt(8)
    v_mfma_f32_16x16x32_bf16 v[144:147], v[48:51], v[208:211], 0
    v_mfma_f32_16x16x32_bf16 v[148:151], v[48:51], v[212:215], 0
    v_mfma_f32_16x16x32_bf16 v[144:147], v[52:55], v[216:219], v[144:147]
    v_mfma_f32_16x16x32_bf16 v[148:151], v[52:55], v[220:223], v[148:151]
    v_mfma_f32_16x16x32_bf16 v[144:147], v[56:59], v[224:227], v[144:147]
    v_mfma_f32_16x16x32_bf16 v[148:151], v[56:59], v[228:231], v[148:151]
    v_mfma_f32_16x16x32_bf16 v[144:147], v[60:63], v[232:235], v[144:147]
    v_mfma_f32_16x16x32_bf16 v[148:151], v[60:63], v[236:239], v[148:151]
    v_cvt_pk_bf16_f32 v172, v136, v140
    buffer_store_dword v172, v9, s[40:43], s54 offen offset:0 sc1
    v_cvt_pk_bf16_f32 v173, v137, v141
    buffer_store_dword v173, v9, s[40:43], s54 offen offset:256 sc1
    v_cvt_pk_bf16_f32 v174, v138, v142
    buffer_store_dword v174, v9, s[40:43], s54 offen offset:512 sc1
    v_cvt_pk_bf16_f32 v175, v139, v143
    buffer_store_dword v175, v9, s[40:43], s54 offen offset:768 sc1
    s_add_u32 s54, s54, 4096
    s_waitcnt lgkmcnt(4)
    v_mfma_f32_16x16x32_bf16 v[152:155], v[64:67], v[208:211], 0
    v_mfma_f32_16x16x32_bf16 v[156:159], v[64:67], v[212:215], 0
    v_mfma_f32_16x16x32_bf16 v[152:155], v[68:71], v[216:219], v[152:155]
    v_mfma_f32_16x16x32_bf16 v[156:159], v[68:71], v[220:223], v[156:159]
    v_mfma_f32_16x16x32_bf16 v[152:155], v[72:75], v[224:227], v[152:155]
    v_mfma_f32_16x16x32_bf16 v[156:159], v[72:75], v[228:231], v[156:159]
    v_mfma_f32_16x16x32_bf16 v[152:155], v[76:79], v[232:235], v[152:155]
    v_mfma_f32_16x16x32_bf16 v[156:159], v[76:79], v[236:239], v[156:159]
    v_cvt_pk_bf16_f32 v176, v144, v148
    buffer_store_dword v176, v9, s[40:43], s54 offen offset:0 sc1
    v_cvt_pk_bf16_f32 v177, v145, v149
    buffer_store_dword v177, v9, s[40:43], s54 offen offset:256 sc1
    v_cvt_pk_bf16_f32 v178, v146, v150
    buffer_store_dword v178, v9, s[40:43], s54 offen offset:512 sc1
    v_cvt_pk_bf16_f32 v179, v147, v151
    buffer_store_dword v179, v9, s[40:43], s54 offen offset:768 sc1
    s_add_u32 s54, s54, 4096
    s_waitcnt lgkmcnt(0)
    v_mfma_f32_16x16x32_bf16 v[160:163], v[80:83], v[208:211], 0
    v_mfma_f32_16x16x32_bf16 v[164:167], v[80:83], v[212:215], 0
    v_mfma_f32_16x16x32_bf16 v[160:163], v[84:87], v[216:219], v[160:163]
    v_mfma_f32_16x16x32_bf16 v[164:167], v[84:87], v[220:223], v[164:167]
    v_mfma_f32_16x16x32_bf16 v[160:163], v[88:91], v[224:227], v[160:163]
    v_mfma_f32_16x16x32_bf16 v[164:167], v[88:91], v[228:231], v[164:167]
    v_mfma_f32_16x16x32_bf16 v[160:163], v[92:95], v[232:235], v[160:163]
    v_mfma_f32_16x16x32_bf16 v[164:167], v[92:95], v[236:239], v[164:167]
    v_cvt_pk_bf16_f32 v180, v152, v156
    buffer_store_dword v180, v9, s[40:43], s54 offen offset:0 sc1
    v_cvt_pk_bf16_f32 v181, v153, v157
    buffer_store_dword v181, v9, s[40:43], s54 offen offset:256 sc1
    v_cvt_pk_bf16_f32 v182, v154, v158
    buffer_store_dword v182, v9, s[40:43], s54 offen offset:512 sc1
    v_cvt_pk_bf16_f32 v183, v155, v159
    buffer_store_dword v183, v9, s[40:43], s54 offen offset:768 sc1
    s_add_u32 s54, s54, 4096
    v_cvt_pk_bf16_f32 v184, v160, v164
    buffer_store_dword v184, v9, s[40:43], s54 offen offset:0 sc1
    v_cvt_pk_bf16_f32 v185, v161, v165
    buffer_store_dword v185, v9, s[40:43], s54 offen offset:256 sc1
    v_cvt_pk_bf16_f32 v186, v162, v166
    buffer_store_dword v186, v9, s[40:43], s54 offen offset:512 sc1
    v_cvt_pk_bf16_f32 v187, v163, v167
    buffer_store_dword v187, v9, s[40:43], s54 offen offset:768 sc1
    s_add_u32 s54, s54, 4096
    s_or_b32 s4, s2, s3
    s_cbranch_scc1 L_notag
    v_mov_b32 v8, s62
    v_lshlrev_b32 v10, 2, v1
    s_mov_b32 s54, 524288
    buffer_store_dword v8, v10, s[20:23], s54 offen sc1
L_notag:
L_done:
    s_endpgm
L_again:
    s_waitcnt vmcnt(0) lgkmcnt(0)
    s_barrier
    v_lshlrev_b32 v11, 2, v0
    v_mov_b32 v12, 0x00700000
    v_mov_b32 v13, 0
    ds_write_b32 v11, v12 offset:0
    ds_write_b32 v11, v12 offset:2048
    ds_write_b32 v11, v12 offset:4096
    ds_write_b32 v11, v12 offset:6144
    ds_write_b32 v11, v13 offset:8192
    ds_write_b32 v11, v13 offset:10240
    ds_write_b32 v11, v13 offset:12288
    v_add_u32 v3, v3, v4
    v_subrev_u32 v3, 256, v3
    v_max_i32 v3, 0, v3
    v_subrev_u32 v4, 256, v4
    v_max_i32 v4, 0, v4
    v_sub_u32 v3, v3, v4
    v_add_u32 v5, 256, v5
    s_sub_i32 s95, s95, 256
    v_lshl_add_u32 v8, v4, 2, v241
    s_waitcnt lgkmcnt(0)
    s_barrier
L_clip:
    v_add_u32 v10, v4, v3
    v_min_i32 v10, 256, v10
    v_sub_u32 v10, v10, v4
    v_add_u32 v10, v10, v240
L_masks:
    v_cmp_lt_i32 s[64:65], 0, v10
    v_cmp_lt_i32 s[66:67], 2, v10
    v_cmp_lt_i32 s[68:69], 4, v10
    v_cmp_lt_i32 s[70:71], 6, v10
    v_cmp_lt_i32 s[72:73], 8, v10
    v_cmp_lt_i32 s[74:75], 10, v10
    v_cmp_lt_i32 s[76:77], 12, v10
    v_cmp_lt_i32 s[78:79], 14, v10
    s_nop 0
    s_branch L_mapw
L_map2:
    v_add_u32 v8, 56, v8
    v_subrev_u32 v10, 14, v10
    s_branch L_masks
L_r1:
    ds_read_b32 v67, v242 offset:768
    ds_read_b32 v74, v243 offset:768
    ds_read_b32 v75, v243 offset:896
    s_waitcnt lgkmcnt(0)
    v_mad_u32_u24 v67, v67, 12, v244
    buffer_load_dwordx3 v[88:90], v67, s[24:27], 0 offen offset:2304 sc1
    v_lshl_add_u32 v74, v74, 5, v2
    s_add_u32 m0, s52, 4096
    s_nop 0
    buffer_load_dwordx4 v74, s[28:31], s98 offen offset:2048 sc1 lds
    v_lshl_add_u32 v75, v75, 5, v2
    s_add_u32 m0, s52, 4096
    s_nop 0
    buffer_load_dwordx4 v75, s[28:31], s98 offen offset:3072 sc1 lds
    s_branch L_r1b
L_r2:
    v_lshrrev_b32 v135, 21, v90
    v_lshlrev_b32 v135, 2, v135
    v_lshrrev_b32 v11, 26, v90
    v_lshl_or_b32 v11, v11, 4, v245
    s_mov_b64 exec, s[96:97]
    ds_add_rtn_u32 v131, v135, v6 offset:8192
    ds_add_u32 v11, v6 offset:14336
    s_mov_b64 exec, -1
    ds_write_b64 v246, v[88:89] offset:1536
    v_and_or_b32 v90, v90, s55, v247
    v_add_u32 v90, 402653184, v90
    s_branch L_r2b
L_r3:
    ds_read_b32 v135, v135 offset:8192
    s_waitcnt lgkmcnt(0)
    v_bfe_u32 v15, v135, 12, 3
    v_or_b32 v90, v15, v90
    v_and_b32 v67, 0x3ff, v135
    v_lshrrev_b32 v135, 16, v135
    v_add_u32 v135, v135, v131
    ds_read_b32 v67, v67 offset:16384
    s_waitcnt lgkmcnt(0)
    v_lshl_add_u32 v135, v135, 2, v67
    s_mov_b64 exec, s[96:97]
    ds_write_b32 v135, v90
    s_mov_b64 exec, -1
    s_branch L_r3b
L_poll:
    buffer_load_dwordx2 v[206:207], v10, s[20:23], s49 offen sc1
    s_sub_u32 s53, s53, 1
    s_cbranch_scc1 L_done
    s_waitcnt vmcnt(0)
    v_xor_b32 v11, s63, v206
    v_xor_b32 v12, s62, v207
    v_and_or_b32 v11, v11, s55, v12
    v_cmpx_ne_u32 vcc, 0, v11
    s_cbranch_execnz L_poll
    s_branch L_polled
L_rank2:
    ds_read_b32 v96, v248 offset:8192
    ds_read_b32 v97, v248 offset:8320
    ds_read_b32 v98, v248 offset:8448
    ds_read_b32 v99, v248 offset:8576
    ds_read_b32 v100, v248 offset:8704
    s_waitcnt lgkmcnt(0)
L_end:
    s_branch L_ranked
.section .rodata,"a"
.p2align 6
.amdhsa_kernel gather_scatter__tensor_product_equiv_mace__graph_kernel
  .amdhsa_next_free_vgpr 256
  .amdhsa_next_free_sgpr 102
  .amdhsa_accum_offset 256
  .amdhsa_group_segment_fixed_size 0
  .amdhsa_kernarg_size 88
  .amdhsa_user_sgpr_count 2
  .amdhsa_user_sgpr_kernarg_segment_ptr 1
  .amdhsa_system_sgpr_workgroup_id_x 1
  .amdhsa_float_denorm_mode_32 3
.end_amdhsa_kernel
```

```asm
; @launch grid=(256,1,1) block=(512,1,1) lds=147456
.amdgcn_target "amdgcn-amd-amdhsa--gfx950"
.text
.globl gather_scatter__tensor_product_equiv_mace__graph_kernel
.p2align 8
.type gather_scatter__tensor_product_equiv_mace__graph_kernel,@function
gather_scatter__tensor_product_equiv_mace__graph_kernel:
    s_cmp_ge_u32 s2, 256
    s_cbranch_scc1 L_done
    s_load_dwordx4 s[4:7], s[0:1], 8
    s_load_dwordx4 s[8:11], s[0:1], 24
    s_load_dwordx2 s[14:15], s[0:1], 80
    s_load_dwordx2 s[64:65], s[0:1], 0
    s_load_dwordx2 s[66:67], s[0:1], 40
    s_load_dwordx4 s[68:71], s[0:1], 48
    s_load_dwordx2 s[12:13], s[0:1], 64
    v_lshrrev_b32 v8, 6, v0
    v_and_b32 v1, 63, v0
    v_lshlrev_b32 v9, 2, v0
    v_mov_b32 v13, 0
    v_readfirstlane_b32 s3, v8
    ds_write_b32 v9, v13 offset:56320
    ds_write_b32 v9, v13 offset:61440
    s_mul_i32 s54, s2, 5000
    s_mul_i32 s55, s2, 10000
    s_mul_i32 s61, s2, 40000
    v_lshlrev_b32 v2, 4, v1
    v_lshlrev_b32 v10, 3, v0
    v_lshlrev_b32 v15, 4, v0
    v_mov_b32 v6, 1
    s_lshl_b32 s52, s3, 10
    s_add_u32 s52, s52, 81920
    s_movk_i32 s53, 4096
    s_movk_i32 s50, 8192
    s_waitcnt lgkmcnt(0)
    s_add_u32 s32, s6, s54
    s_addc_u32 s33, s7, 0
    s_mov_b32 s34, 5000
    s_mov_b32 s35, 0x20000
    buffer_load_dword v64, v9, s[32:35], 0 offen offset:0 nt
    buffer_load_dword v65, v9, s[32:35], 0 offen offset:2048 nt
    buffer_load_dword v66, v9, s[32:35], s53 offen nt
    s_add_u32 s36, s4, s54
    s_addc_u32 s37, s5, 0
    s_mov_b32 s38, 5000
    s_mov_b32 s39, 0x20000
    buffer_load_dword v68, v9, s[36:39], 0 offen offset:0 nt
    buffer_load_dword v69, v9, s[36:39], 0 offen offset:2048 nt
    buffer_load_dword v70, v9, s[36:39], s53 offen nt
    s_load_dword s62, s[14:15], 524288
    s_getpc_b64 s[80:81]
L_pc:
    s_and_b32 s54, s2, 0xf8
    s_lshl_b32 s54, s54, 6
    v_and_b32 v11, 0x180, v10
    v_add_u32 v11, s54, v11
    v_min_u32 v11, L_end-L_pc, v11
    v_mov_b32 v113, s81
    v_add_co_u32 v112, vcc, s80, v11
    s_nop 1
    v_addc_co_u32 v113, vcc, 0, v113, vcc
    global_load_dword v205, v[112:113], off
    s_add_u32 s96, s8, s55
    s_addc_u32 s97, s9, 0
    s_mov_b32 s98, 10000
    s_mov_b32 s99, 0x20000
    s_add_u32 s28, s10, s61
    s_addc_u32 s29, s11, 0
    s_mov_b32 s30, 40000
    s_mov_b32 s31, 0x20000
    s_barrier
    buffer_load_dwordx2 v[72:73], v10, s[96:99], 0 offen nt
    buffer_load_dwordx2 v[74:75], v10, s[96:99], s53 offen nt
    buffer_load_dwordx2 v[76:77], v10, s[96:99], s50 offen nt
    s_add_u32 m0, s52, 0
    s_mov_b32 s54, 0
    buffer_load_dwordx4 v15, s[28:31], s54 offen nt lds
    s_add_u32 m0, s52, 8192
    s_mov_b32 s54, 8192
    buffer_load_dwordx4 v15, s[28:31], s54 offen nt lds
    s_add_u32 m0, s52, 16384
    s_mov_b32 s54, 16384
    buffer_load_dwordx4 v15, s[28:31], s54 offen nt lds
    s_mov_b32 s72, 109951168
    s_movk_i32 s73, 625
    s_movk_i32 s74, 838
    s_movk_i32 s54, 226
    v_cmp_gt_u32 s[84:85], s54, v0
    v_lshlrev_b32 v11, 2, v0
    v_mov_b32 v12, 0x00700000
    v_mov_b32 v13, 0
    ds_write_b32 v11, v12 offset:0
    ds_write_b32 v11, v12 offset:2048
    ds_write_b32 v11, v12 offset:4096
    ds_write_b32 v11, v12 offset:6144
    ds_write_b32 v11, v13 offset:8192
    ds_write_b32 v11, v13 offset:10240
    ds_write_b32 v11, v13 offset:12288
    ds_write_b32 v11, v13 offset:14336
    s_waitcnt vmcnt(10)
    v_mul_hi_u32 v80, v64, s72
    v_mul_hi_u32 v81, v65, s72
    v_mul_hi_u32 v82, v66, s72
    v_lshlrev_b32 v84, 2, v80
    ds_add_rtn_u32 v88, v84, v6 offset:56320
    v_lshlrev_b32 v85, 2, v81
    ds_add_rtn_u32 v89, v85, v6 offset:56320
    v_lshlrev_b32 v86, 2, v82
    s_mov_b64 exec, s[84:85]
    ds_add_rtn_u32 v90, v86, v6 offset:56320
    s_mov_b64 exec, -1
    s_waitcnt lgkmcnt(0)
    s_barrier
    ds_read_b128 v[100:103], v2 offset:56320
    s_add_u32 m0, s52, 24576
    s_mov_b32 s54, 24576
    buffer_load_dwordx4 v15, s[28:31], s54 offen nt lds
    s_add_u32 m0, s52, 32768
    s_mov_b32 s54, 32768
    buffer_load_dwordx4 v15, s[28:31], s54 offen nt lds
    v_mad_u32_u24 v92, v80, s73, 15
    v_lshrrev_b32 v92, 4, v92
    v_sub_u32 v92, v64, v92
    v_lshrrev_b32 v80, 3, v80
    v_and_b32 v80, 28, v80
    v_mad_u32_u24 v93, v81, s73, 15
    v_lshrrev_b32 v93, 4, v93
    v_sub_u32 v93, v65, v93
    v_lshrrev_b32 v81, 3, v81
    v_and_b32 v81, 28, v81
    v_mad_u32_u24 v94, v82, s73, 15
    v_lshrrev_b32 v94, 4, v94
    v_sub_u32 v94, v66, v94
    v_lshrrev_b32 v82, 3, v82
    v_and_b32 v82, 28, v82
    s_waitcnt lgkmcnt(0)
    v_add_u32 v11, v100, v101
    v_add3_u32 v11, v11, v102, v103
    v_mov_b32 v12, v11
    s_nop 1
    v_add_u32_dpp v12, v12, v12 row_shr:1 row_mask:0xf bank_mask:0xf
    s_nop 1
    v_add_u32_dpp v12, v12, v12 row_shr:2 row_mask:0xf bank_mask:0xf
    s_nop 1
    v_add_u32_dpp v12, v12, v12 row_shr:4 row_mask:0xf bank_mask:0xf
    s_nop 1
    v_add_u32_dpp v12, v12, v12 row_shr:8 row_mask:0xf bank_mask:0xf
    s_nop 1
    v_add_u32_dpp v12, v12, v12 row_bcast:15 row_mask:0xa bank_mask:0xf
    s_nop 1
    v_add_u32_dpp v12, v12, v12 row_bcast:31 row_mask:0xc bank_mask:0xf
    v_sub_u32 v104, v12, v11
    v_add_u32 v105, v104, v100
    v_add_u32 v106, v105, v101
    v_add_u32 v107, v106, v102
    ds_write_b128 v2, v[104:107] offset:57344
    ds_read_b32 v108, v84 offset:57344
    ds_read_b32 v109, v85 offset:57344
    ds_read_b32 v110, v86 offset:57344
    s_waitcnt vmcnt(9)
    v_mul_u32_u24 v96, s74, v68
    v_lshrrev_b32 v96, 18, v96
    v_sub_u32 v96, v96, v80
    v_and_b32 v96, 31, v96
    v_lshl_or_b32 v96, v92, 5, v96
    v_lshlrev_b32 v96, 21, v96
    v_lshl_or_b32 v96, v68, 7, v96
    v_mul_u32_u24 v97, s74, v69
    v_lshrrev_b32 v97, 18, v97
    v_sub_u32 v97, v97, v81
    v_and_b32 v97, 31, v97
    v_lshl_or_b32 v97, v93, 5, v97
    v_lshlrev_b32 v97, 21, v97
    v_lshl_or_b32 v97, v69, 7, v97
    v_mul_u32_u24 v98, s74, v70
    v_lshrrev_b32 v98, 18, v98
    v_sub_u32 v98, v98, v82
    v_and_b32 v98, 31, v98
    v_lshl_or_b32 v98, v94, 5, v98
    v_lshlrev_b32 v98, 21, v98
    v_lshl_or_b32 v98, v70, 7, v98
    v_lshlrev_b32 v92, 5, v0
    v_add_u32 v93, 16384, v92
    v_add_u32 v94, 32768, v92
    s_mov_b32 s55, 63488
    s_waitcnt vmcnt(5) lgkmcnt(0)
    v_add_u32 v108, v108, v88
    v_lshlrev_b32 v84, 2, v108
    v_mad_u32_u24 v108, v108, 12, s55
    ds_write_b32 v84, v92 offset:58368
    ds_write2_b32 v108, v72, v73 offset0:0 offset1:1
    ds_write_b32 v108, v96 offset:8
    v_add_u32 v109, v109, v89
    v_lshlrev_b32 v85, 2, v109
    v_mad_u32_u24 v109, v109, 12, s55
    ds_write_b32 v85, v93 offset:58368
    ds_write2_b32 v109, v74, v75 offset0:0 offset1:1
    ds_write_b32 v109, v97 offset:8
    v_add_u32 v110, v110, v90
    v_lshlrev_b32 v86, 2, v110
    v_mad_u32_u24 v110, v110, 12, s55
    s_mov_b64 exec, s[84:85]
    ds_write_b32 v86, v94 offset:58368
    ds_write2_b32 v110, v76, v77 offset0:0 offset1:1
    ds_write_b32 v110, v98 offset:8
    s_mov_b64 exec, -1
    s_mul_i32 s62, s62, 0x9e3779b1
    s_add_u32 s62, s62, 0x7f4a7c15
    s_mul_i32 s63, s62, 0x85ebca6b
    s_and_b32 s63, s63, 0xffc00000
    s_lshl_b32 s54, s3, 7
    v_lshl_add_u32 v11, v1, 3, s54
    ds_read_b64 v[100:101], v11 offset:56320
    ds_read_b64 v[104:105], v11 offset:57344
    s_mul_i32 s54, s2, 15360
    s_add_u32 s54, s54, 1048576
    s_add_u32 s32, s14, s54
    s_addc_u32 s33, s15, 0
    s_mov_b32 s34, 15360
    s_mov_b32 s35, 0x20000
    s_mul_i32 s54, s2, 40960
    s_add_u32 s54, s54, 5242880
    s_add_u32 s36, s14, s54
    s_addc_u32 s37, s15, 0
    s_mov_b32 s38, 40000
    s_mov_b32 s39, 0x20000
    v_lshrrev_b32 v11, 1, v0
    v_lshlrev_b32 v11, 2, v11
    v_and_b32 v12, 1, v0
    v_lshlrev_b32 v12, 4, v12
    v_add_u32 v12, 81920, v12
    v_add_u32 v14, 63488, v15
    s_waitcnt lgkmcnt(0)
    s_barrier
    ds_read_b128 v[128:131], v14
    ds_read_b128 v[132:135], v14 offset:8192
    ds_read_b32 v156, v11 offset:58368
    ds_read_b32 v157, v11 offset:59392
    ds_read_b32 v158, v11 offset:60416
    ds_read_b32 v159, v11 offset:61440
    ds_read_b32 v160, v11 offset:62464
    s_cmp_lt_u32 s3, 4
    s_cselect_b32 s16, s68, s66
    s_cselect_b32 s17, s69, s67
    s_movk_i32 s54, 128
    s_cselect_b32 s18, s53, s54
    s_mov_b32 s19, 0x20000
    s_min_u32 s54, s3, 5
    s_lshl_b32 s54, s54, 10
    s_add_u32 m0, s54, 17408
    s_and_b32 s54, s54, 0xc00
    buffer_load_dwordx4 v2, s[16:19], s54 offen lds
    s_mov_b32 s40, s70
    s_mov_b32 s41, s71
    s_mov_b32 s42, 32768
    s_mov_b32 s43, 0x20000
    s_lshl_b32 s55, s3, 12
    s_add_u32 m0, s55, 23552
    s_nop 0
    buffer_load_dwordx4 v2, s[40:43], s55 offen offset:0 lds
    buffer_load_dwordx4 v2, s[40:43], s55 offen offset:1024 lds
    buffer_load_dwordx4 v2, s[40:43], s55 offen offset:2048 lds
    buffer_load_dwordx4 v2, s[40:43], s55 offen offset:3072 lds
    s_waitcnt lgkmcnt(0)
    v_add_u32 v156, v12, v156
    v_add_u32 v157, v12, v157
    v_add_u32 v158, v12, v158
    v_add_u32 v159, v12, v159
    v_add_u32 v160, v12, v160
    v_lshl_or_b32 v112, v100, 11, v104
    v_or_b32 v112, s63, v112
    v_mov_b32 v113, s62
    v_lshl_or_b32 v114, v101, 11, v105
    v_or_b32 v114, s63, v114
    v_mov_b32 v115, s62
    s_waitcnt vmcnt(5)
    s_barrier
    ds_read_b128 v[136:139], v156
    ds_read_b128 v[140:143], v157
    ds_read_b128 v[144:147], v158
    ds_read_b128 v[148:151], v159
    ds_read_b128 v[152:155], v160
    s_and_b32 s44, s2, 7
    s_lshl_b32 s44, s44, 5
    s_lshr_b32 s54, s2, 3
    s_add_u32 s44, s44, s54
    s_mul_i32 s45, s44, 625
    s_add_u32 s46, s45, 640
    s_add_u32 s45, s45, 15
    s_lshr_b32 s45, s45, 4
    s_lshr_b32 s46, s46, 4
    s_sub_u32 s46, s46, s45
    s_mov_b32 s86, 0x0f0f0f0f
    s_mov_b32 s87, 0x0f0f0f0f
    s_mov_b32 s88, 0xf0f0f0f0
    s_mov_b32 s89, 0xf0f0f0f0
    v_mov_b32 v164, 0
    v_mov_b32 v165, 0
    v_mov_b32 v166, 0
    v_mov_b32 v167, 0
    v_mov_b32 v168, 0
    v_mov_b32 v169, 0
    v_mov_b32 v170, 0
    v_mov_b32 v171, 0
    v_and_b32 v11, 4, v1
    v_lshlrev_b32 v11, 2, v11
    v_mov_b32 v12, 0xffff
    v_lshlrev_b32 v12, v11, v12
    v_bfe_i32 v11, v1, 3, 1
    v_and_b32 v191, v11, v12
    v_xor_b32 v190, v191, v12
    v_lshrrev_b32 v200, 5, v1
    v_lshlrev_b32 v200, 4, v200
    v_add_u32 v200, 81920, v200
    v_and_b32 v201, 15, v1
    v_lshlrev_b32 v201, 2, v201
    v_bfe_u32 v11, v1, 3, 2
    v_and_b32 v12, 3, v1
    v_lshl_add_u32 v11, v11, 2, v12
    v_lshlrev_b32 v202, 2, v11
    v_bfe_i32 v240, v0, 0, 1
    s_lshl_b32 s54, s3, 10
    v_and_b32 v241, 4, v240
    v_add_u32 v241, s54, v241
    v_lshl_add_u32 v242, v1, 2, s54
    v_lshrrev_b32 v243, 1, v1
    v_lshl_add_u32 v243, v243, 2, s54
    v_mul_u32_u24 v244, 12, v1
    v_and_b32 v245, 12, v242
    v_and_b32 v250, 124, v242
    v_lshlrev_b32 v246, 1, v242
    v_add_u32 v246, 65536, v246
    v_lshlrev_b32 v247, 19, v242
    s_mul_i32 s54, s3, 640
    v_add_u32 v248, s54, v250
    v_sub_u32 v249, 63, v1
    s_lshl_b32 s54, s3, 5
    v_lshl_add_u32 v251, v1, 2, s54
    v_lshrrev_b32 v252, 3, v1
    v_mul_u32_u24 v252, 64, v252
    v_add_u32 v252, 56320, v252
    s_cmp_eq_u32 s46, 40
    v_mov_b32 v203, 0
    s_mov_b32 s54, 671321104
    s_cselect_b32 s54, 276856880, s54
    s_mov_b32 exec_lo, 31
    s_mov_b32 exec_hi, 0
    v_mov_b32 v203, s54
    s_mov_b32 s54, 405087304
    s_cselect_b32 s54, 159876648, s54
    s_mov_b32 exec_lo, 992
    s_mov_b32 exec_hi, 0
    v_mov_b32 v203, s54
    s_mov_b32 s54, 424579168
    s_cselect_b32 s54, 296066625, s54
    s_mov_b32 exec_lo, 31744
    s_mov_b32 exec_hi, 0
    v_mov_b32 v203, s54
    s_mov_b32 s54, 577443961
    s_cselect_b32 s54, 980068482, s54
    s_mov_b32 exec_lo, 1015808
    s_mov_b32 exec_hi, 0
    v_mov_b32 v203, s54
    s_mov_b32 s54, 600547466
    s_cselect_b32 s54, 466166449, s54
    s_mov_b32 exec_lo, 32505856
    s_mov_b32 exec_hi, 0
    v_mov_b32 v203, s54
    s_mov_b32 s54, 734837403
    s_cselect_b32 s54, 590166779, s54
    s_mov_b32 exec_lo, 1040187392
    s_mov_b32 exec_hi, 0
    v_mov_b32 v203, s54
    s_mov_b32 s54, 481444091
    s_cselect_b32 s54, 754136323, s54
    s_mov_b32 exec_lo, 3221225472
    s_mov_b32 exec_hi, 7
    v_mov_b32 v203, s54
    s_mov_b32 s54, 338903356
    s_cselect_b32 s54, 76598556, s54
    s_mov_b32 exec_lo, 0
    s_mov_b32 exec_hi, 248
    v_mov_b32 v203, s54
    s_mov_b64 exec, -1
    v_mul_u32_u24 v11, 52, v1
    v_lshrrev_b32 v11, 8, v11
    v_mad_i32_i24 v11, v11, -5, v1
    v_mul_u32_u24 v11, 6, v11
    v_lshrrev_b32 v203, v11, v203
    v_and_b32 v11, 7, v203
    v_bfe_u32 v203, v203, 3, 3
    v_lshlrev_b32 v11, 12, v11
    v_lshl_or_b32 v203, v203, 7, v11
    s_mov_b32 s20, s14
    s_mov_b32 s21, s15
    s_mov_b32 s22, 524352
    s_mov_b32 s23, 0x20000
    s_add_u32 s24, s14, 1048576
    s_addc_u32 s25, s15, 0
    s_mov_b32 s26, 3932160
    s_mov_b32 s27, 0x20000
    buffer_store_dwordx4 v[128:131], v15, s[32:35], 0 offen sc1
    buffer_store_dwordx4 v[132:135], v15, s[32:35], s50 offen sc1
    s_mov_b32 s54, 0
    s_waitcnt lgkmcnt(4)
    buffer_store_dwordx4 v[136:139], v15, s[36:39], s54 offen sc1
    s_mov_b32 s54, 8192
    s_waitcnt lgkmcnt(3)
    buffer_store_dwordx4 v[140:143], v15, s[36:39], s54 offen sc1
    s_mov_b32 s54, 16384
    s_waitcnt lgkmcnt(2)
    buffer_store_dwordx4 v[144:147], v15, s[36:39], s54 offen sc1
    s_mov_b32 s54, 24576
    s_waitcnt lgkmcnt(1)
    buffer_store_dwordx4 v[148:151], v15, s[36:39], s54 offen sc1
    s_mov_b32 s54, 32768
    s_waitcnt lgkmcnt(0)
    buffer_store_dwordx4 v[152:155], v15, s[36:39], s54 offen sc1
    v_mov_b32 v16, 0
    v_mov_b32 v17, 0
    v_mov_b32 v18, 0
    v_mov_b32 v19, 0
    v_mov_b32 v20, 0
    v_mov_b32 v21, 0
    v_mov_b32 v22, 0
    v_mov_b32 v23, 0
    v_mov_b32 v24, 0
    v_mov_b32 v25, 0
    v_mov_b32 v26, 0
    v_mov_b32 v27, 0
    v_mov_b32 v28, 0
    v_mov_b32 v29, 0
    v_mov_b32 v30, 0
    v_mov_b32 v31, 0
    v_mov_b32 v32, 0
    v_mov_b32 v33, 0
    v_mov_b32 v34, 0
    v_mov_b32 v35, 0
    v_mov_b32 v36, 0
    v_mov_b32 v37, 0
    v_mov_b32 v38, 0
    v_mov_b32 v39, 0
    v_mov_b32 v40, 0
    v_mov_b32 v41, 0
    v_mov_b32 v42, 0
    v_mov_b32 v43, 0
    v_mov_b32 v44, 0
    v_mov_b32 v45, 0
    v_mov_b32 v46, 0
    v_mov_b32 v47, 0
    v_mov_b32 v48, 0
    v_mov_b32 v49, 0
    v_mov_b32 v50, 0
    v_mov_b32 v51, 0
    v_mov_b32 v52, 0
    v_mov_b32 v53, 0
    v_mov_b32 v54, 0
    v_mov_b32 v55, 0
    v_mov_b32 v56, 0
    v_mov_b32 v57, 0
    v_mov_b32 v58, 0
    v_mov_b32 v59, 0
    v_mov_b32 v60, 0
    v_mov_b32 v61, 0
    v_mov_b32 v62, 0
    v_mov_b32 v63, 0
    s_lshl_b32 s54, s2, 3
    s_add_u32 s54, s54, s3
    s_lshl_b32 s54, s54, 8
    s_mov_b32 s16, s64
    s_mov_b32 s17, s65
    s_mov_b32 s18, 10240000
    s_mov_b32 s19, 0x20000
    s_add_u32 s28, s14, 5242880
    s_addc_u32 s29, s15, 0
    s_mov_b32 s30, 10485760
    s_mov_b32 s31, 0x20000
    s_and_b32 s51, s2, 7
    s_mul_i32 s51, s51, 1282048
    s_and_b32 s55, s2, 0xf8
    s_add_u32 s55, s55, s3
    s_mul_i32 s55, s55, 2560
    s_add_u32 s51, s51, s55
    v_min_u32 v14, 19, v1
    v_lshlrev_b32 v14, 7, v14
    s_waitcnt vmcnt(0)
    s_barrier
    s_mov_b64 exec, 0xffff
    buffer_store_dwordx4 v[112:115], v2, s[20:23], s54 offen sc1
    s_mov_b64 exec, -1
    buffer_load_dword v7, v14, s[16:19], s51 offen
    s_lshl_b32 s54, s45, 10
    s_add_u32 s40, s12, s54
    s_addc_u32 s41, s13, 0
    s_lshl_b32 s42, s46, 10
    s_mov_b32 s43, 0x20000
    v_lshrrev_b32 v8, 5, v1
    v_lshlrev_b32 v8, 11, v8
    v_and_b32 v9, 15, v1
    v_lshl_add_u32 v8, v9, 4, v8
    ds_read_b128 v[64:67], v8 offset:17408
    ds_read_b128 v[68:71], v8 offset:17664
    ds_read_b128 v[72:75], v8 offset:17920
    ds_read_b128 v[76:79], v8 offset:18176
    ds_read_b128 v[80:83], v8 offset:18432
    ds_read_b128 v[84:87], v8 offset:18688
    ds_read_b128 v[88:91], v8 offset:18944
    ds_read_b128 v[92:95], v8 offset:19200
    v_lshrrev_b32 v8, 4, v1
    v_lshlrev_b32 v8, 5, v8
    v_and_b32 v9, 3, v1
    v_lshl_add_u32 v8, v9, 1, v8
    ds_read_u16 v96, v8 offset:21504
    ds_read_u16 v97, v8 offset:21512
    ds_read_u16 v98, v8 offset:21520
    ds_read_u16 v99, v8 offset:21528
    v_bfe_i32 v10, v1, 4, 1
    v_and_b32 v10, 0x02020202, v10
    v_add_u32 v10, 0x05040100, v10
    s_waitcnt lgkmcnt(0)
    v_perm_b32 v172, v68, v64, v10
    v_perm_b32 v173, v76, v72, v10
    v_perm_b32 v174, v84, v80, v10
    v_perm_b32 v175, v92, v88, v10
    v_perm_b32 v176, v69, v65, v10
    v_perm_b32 v177, v77, v73, v10
    v_perm_b32 v178, v85, v81, v10
    v_perm_b32 v179, v93, v89, v10
    v_perm_b32 v180, v70, v66, v10
    v_perm_b32 v181, v78, v74, v10
    v_perm_b32 v182, v86, v82, v10
    v_perm_b32 v183, v94, v90, v10
    v_perm_b32 v184, v71, v67, v10
    v_perm_b32 v185, v79, v75, v10
    v_perm_b32 v186, v87, v83, v10
    v_perm_b32 v187, v95, v91, v10
    v_lshl_or_b32 v188, v97, 16, v96
    v_lshl_or_b32 v189, v99, 16, v98
    v_and_b32 v9, 15, v1
    v_lshrrev_b32 v8, 4, v1
    v_lshlrev_b32 v8, 13, v8
    v_lshl_add_u32 v8, v9, 2, v8
    s_and_b32 s72, s3, 3
    s_lshl_b32 s72, s72, 6
    s_add_u32 s72, s72, 23552
    v_add_u32 v8, s72, v8
    ds_read2st64_b32 v[128:129], v8 offset0:0 offset1:4
    ds_read2st64_b32 v[130:131], v8 offset0:8 offset1:12
    ds_read2st64_b32 v[132:133], v8 offset0:16 offset1:20
    ds_read2st64_b32 v[134:135], v8 offset0:24 offset1:28
    ds_read2st64_b32 v[136:137], v8 offset0:1 offset1:5
    ds_read2st64_b32 v[138:139], v8 offset0:9 offset1:13
    ds_read2st64_b32 v[140:141], v8 offset0:17 offset1:21
    ds_read2st64_b32 v[142:143], v8 offset0:25 offset1:29
    ds_read2st64_b32 v[144:145], v8 offset0:2 offset1:6
    ds_read2st64_b32 v[146:147], v8 offset0:10 offset1:14
    ds_read2st64_b32 v[148:149], v8 offset0:18 offset1:22
    ds_read2st64_b32 v[150:151], v8 offset0:26 offset1:30
    ds_read2st64_b32 v[152:153], v8 offset0:3 offset1:7
    ds_read2st64_b32 v[154:155], v8 offset0:11 offset1:15
    ds_read2st64_b32 v[156:157], v8 offset0:19 offset1:23
    ds_read2st64_b32 v[158:159], v8 offset0:27 offset1:31
    s_mov_b32 s72, 0x05040100
    s_mov_b32 s73, 0x07060302
    s_waitcnt lgkmcnt(12)
    v_perm_b32 v208, v129, v128, s72
    v_perm_b32 v209, v131, v130, s72
    v_perm_b32 v210, v133, v132, s72
    v_perm_b32 v211, v135, v134, s72
    v_perm_b32 v212, v129, v128, s73
    v_perm_b32 v213, v131, v130, s73
    v_perm_b32 v214, v133, v132, s73
    v_perm_b32 v215, v135, v134, s73
    s_waitcnt lgkmcnt(8)
    v_perm_b32 v216, v137, v136, s72
    v_perm_b32 v217, v139, v138, s72
    v_perm_b32 v218, v141, v140, s72
    v_perm_b32 v219, v143, v142, s72
    v_perm_b32 v220, v137, v136, s73
    v_perm_b32 v221, v139, v138, s73
    v_perm_b32 v222, v141, v140, s73
    v_perm_b32 v223, v143, v142, s73
    s_waitcnt lgkmcnt(4)
    v_perm_b32 v224, v145, v144, s72
    v_perm_b32 v225, v147, v146, s72
    v_perm_b32 v226, v149, v148, s72
    v_perm_b32 v227, v151, v150, s72
    v_perm_b32 v228, v145, v144, s73
    v_perm_b32 v229, v147, v146, s73
    v_perm_b32 v230, v149, v148, s73
    v_perm_b32 v231, v151, v150, s73
    s_waitcnt lgkmcnt(0)
    v_perm_b32 v232, v153, v152, s72
    v_perm_b32 v233, v155, v154, s72
    v_perm_b32 v234, v157, v156, s72
    v_perm_b32 v235, v159, v158, s72
    v_perm_b32 v236, v153, v152, s73
    v_perm_b32 v237, v155, v154, s73
    v_perm_b32 v238, v157, v156, s73
    v_perm_b32 v239, v159, v158, s73
    v_lshrrev_b32 v9, 1, v0
    v_lshlrev_b32 v10, 11, v9
    s_lshl_b32 s49, s44, 3
    v_mul_u32_u24 v5, 1280, v9
    s_mov_b32 s48, 0
    s_mov_b32 s53, 200000
    s_mov_b32 s55, 0xffc00000
    s_lshl_b32 s52, s3, 13
    s_add_u32 s52, s52, 81920
    s_movk_i32 s98, 4096
    s_waitcnt vmcnt(0)
    s_barrier
    buffer_load_dwordx2 v[206:207], v10, s[20:23], s49 offen sc1
    s_waitcnt vmcnt(0)
    v_xor_b32 v11, s63, v206
    v_xor_b32 v12, s62, v207
    v_and_or_b32 v11, v11, s55, v12
    v_cmpx_ne_u32 vcc, 0, v11
    s_cbranch_execnz L_poll
L_polled:
    s_mov_b64 exec, -1
    v_bfe_u32 v3, v206, 11, 11
    v_and_b32 v4, v3, v240
    v_add_u32 v10, v3, v240
    v_and_b32 v11, 0x7ff, v206
    v_add_u32_dpp v4, v4, v4 row_shr:1 row_mask:0xf bank_mask:0xf
    v_cmp_lt_i32 s[64:65], 0, v10
    v_cmp_lt_i32 s[66:67], 2, v10
    v_add_u32_dpp v4, v4, v4 row_shr:2 row_mask:0xf bank_mask:0xf
    v_cmp_lt_i32 s[68:69], 4, v10
    v_cmp_lt_i32 s[70:71], 6, v10
    v_add_u32_dpp v4, v4, v4 row_shr:4 row_mask:0xf bank_mask:0xf
    v_cmp_lt_i32 s[72:73], 8, v10
    v_cmp_lt_i32 s[74:75], 10, v10
    v_add_u32_dpp v4, v4, v4 row_shr:8 row_mask:0xf bank_mask:0xf
    v_cmp_lt_i32 s[76:77], 12, v10
    v_cmp_lt_i32 s[78:79], 14, v10
    v_add_u32_dpp v4, v4, v4 row_bcast:15 row_mask:0xa bank_mask:0xf
    v_add_u32 v5, v5, v11
    s_nop 0
    v_add_u32_dpp v4, v4, v4 row_bcast:31 row_mask:0xc bank_mask:0xf
    s_nop 0
    v_readlane_b32 s95, v4, 63
    v_mov_b32_dpp v4, v4 quad_perm:[0,0,2,2] row_mask:0xf bank_mask:0xf
    v_sub_u32 v5, v5, v4
    v_lshl_add_u32 v8, v4, 2, v241
    s_cmp_gt_u32 s95, 256
    s_cbranch_scc1 L_clip
L_mapw:
    s_mov_b64 exec, s[64:65]
    ds_write_b32 v8, v5 offset:0
    s_mov_b64 exec, s[66:67]
    ds_write_b32 v8, v5 offset:8
    s_mov_b64 exec, s[68:69]
    ds_write_b32 v8, v5 offset:16
    s_mov_b64 exec, s[70:71]
    ds_write_b32 v8, v5 offset:24
    s_mov_b64 exec, s[72:73]
    ds_write_b32 v8, v5 offset:32
    s_mov_b64 exec, s[74:75]
    ds_write_b32 v8, v5 offset:40
    s_mov_b64 exec, s[76:77]
    ds_write_b32 v8, v5 offset:48
    s_mov_b64 exec, -1
    s_cmp_lg_u64 s[78:79], 0
    s_cbranch_scc1 L_map2
    ds_read_b32 v64, v242 offset:0
    ds_read_b32 v65, v242 offset:256
    ds_read_b32 v66, v242 offset:512
    ds_read_b32 v68, v243 offset:0
    ds_read_b32 v69, v243 offset:128
    ds_read_b32 v70, v243 offset:256
    ds_read_b32 v71, v243 offset:384
    ds_read_b32 v72, v243 offset:512
    ds_read_b32 v73, v243 offset:640
    s_cmp_gt_i32 s95, 192
    s_cbranch_scc1 L_r1
L_r1b:
    s_waitcnt lgkmcnt(6)
    v_mad_u32_u24 v64, v64, 12, v244
    buffer_load_dwordx3 v[76:78], v64, s[24:27], 0 offen offset:0 sc1
    v_mad_u32_u24 v65, v65, 12, v244
    buffer_load_dwordx3 v[80:82], v65, s[24:27], 0 offen offset:768 sc1
    v_mad_u32_u24 v66, v66, 12, v244
    buffer_load_dwordx3 v[84:86], v66, s[24:27], 0 offen offset:1536 sc1
    v_mov_b32 v11, s95
    s_mov_b64 exec, 1
    ds_max_i32 v13, v11 offset:15360
    s_mov_b64 exec, -1
    s_waitcnt lgkmcnt(1)
    v_lshl_add_u32 v68, v68, 5, v2
    v_lshl_add_u32 v69, v69, 5, v2
    v_lshl_add_u32 v70, v70, 5, v2
    v_lshl_add_u32 v71, v71, 5, v2
    v_lshl_add_u32 v72, v72, 5, v2
    v_lshl_add_u32 v73, v73, 5, v2
    s_barrier
    s_add_u32 m0, s52, 0
    s_nop 0
    buffer_load_dwordx4 v68, s[28:31], 0 offen offset:0 sc1 lds
    v_add_u32 v11, 0, v1
    v_cmp_gt_i32 s[80:81], s95, v11
    v_add_u32 v11, 64, v1
    v_cmp_gt_i32 s[82:83], s95, v11
    v_add_u32 v11, 128, v1
    v_cmp_gt_i32 s[84:85], s95, v11
    v_add_u32 v11, 192, v1
    v_cmp_gt_i32 s[96:97], s95, v11
    s_mov_b32 s55, 0x1fff80
    s_mul_i32 s61, s3, 5
    s_waitcnt vmcnt(3)
    v_lshrrev_b32 v132, 21, v78
    v_lshlrev_b32 v132, 2, v132
    v_lshrrev_b32 v11, 26, v78
    v_lshl_or_b32 v11, v11, 4, v245
    s_mov_b64 exec, s[80:81]
    ds_add_rtn_u32 v128, v132, v6 offset:8192
    ds_add_u32 v11, v6 offset:14336
    s_mov_b64 exec, -1
    s_waitcnt vmcnt(2)
    v_lshrrev_b32 v133, 21, v82
    v_lshlrev_b32 v133, 2, v133
    v_lshrrev_b32 v11, 26, v82
    v_lshl_or_b32 v11, v11, 4, v245
    s_mov_b64 exec, s[82:83]
    ds_add_rtn_u32 v129, v133, v6 offset:8192
    ds_add_u32 v11, v6 offset:14336
    s_mov_b64 exec, -1
    s_waitcnt vmcnt(1)
    v_lshrrev_b32 v134, 21, v86
    v_lshlrev_b32 v134, 2, v134
    v_lshrrev_b32 v11, 26, v86
    v_lshl_or_b32 v11, v11, 4, v245
    s_mov_b64 exec, s[84:85]
    ds_add_rtn_u32 v130, v134, v6 offset:8192
    ds_add_u32 v11, v6 offset:14336
    s_mov_b64 exec, -1
    s_cmp_gt_i32 s95, 192
    s_cbranch_scc1 L_r2
L_r2b:
    ds_write_b64 v246, v[76:77] offset:0
    v_and_or_b32 v78, v78, s55, v247
    ds_write_b64 v246, v[80:81] offset:512
    v_and_or_b32 v82, v82, s55, v247
    v_add_u32 v82, 134217728, v82
    ds_write_b64 v246, v[84:85] offset:1024
    v_and_or_b32 v86, v86, s55, v247
    v_add_u32 v86, 268435456, v86
    s_add_u32 m0, s52, 0
    s_nop 0
    buffer_load_dwordx4 v69, s[28:31], 0 offen offset:1024 sc1 lds
    s_add_u32 m0, s52, 0
    s_nop 0
    buffer_load_dwordx4 v70, s[28:31], 0 offen offset:2048 sc1 lds
    s_waitcnt lgkmcnt(3)
    s_barrier
    s_cmp_lg_u32 s48, 0
    s_cbranch_scc1 L_rank2
    ds_read_b128 v[104:107], v2 offset:14336
    ds_read_b32 v96, v248 offset:8192
    ds_read_b32 v97, v248 offset:8320
    ds_read_b32 v98, v248 offset:8448
    ds_read_b32 v99, v248 offset:8576
    ds_read_b32 v100, v248 offset:8704
    ds_read_b32 v14, v13 offset:15360
    s_add_u32 s65, s61, 1
    s_add_u32 s66, s61, 2
    s_add_u32 s67, s61, 3
    s_add_u32 s68, s61, 4
    s_waitcnt lgkmcnt(6)
    v_add_u32 v9, v104, v105
    v_add3_u32 v9, v9, v106, v107
    v_lshl_or_b32 v9, v9, 6, v249
    s_nop 0
    v_readlane_b32 s64, v9, s61
    v_readlane_b32 s65, v9, s65
    v_readlane_b32 s66, v9, s66
    v_readlane_b32 s67, v9, s67
    v_readlane_b32 s68, v9, s68
    v_cmp_lt_u32 s[70:71], s64, v9
    v_cmp_lt_u32 s[72:73], s65, v9
    v_cmp_lt_u32 s[74:75], s66, v9
    v_cmp_lt_u32 s[76:77], s67, v9
    v_cmp_lt_u32 s[78:79], s68, v9
    s_bcnt1_i32_b64 s64, s[70:71]
    s_bcnt1_i32_b64 s65, s[72:73]
    s_bcnt1_i32_b64 s66, s[74:75]
    s_bcnt1_i32_b64 s67, s[76:77]
    s_bcnt1_i32_b64 s68, s[78:79]
    s_waitcnt lgkmcnt(0)
    v_readlane_b32 s90, v203, s64
    v_readlane_b32 s91, v203, s65
    v_readlane_b32 s92, v203, s66
    v_readlane_b32 s93, v203, s67
    v_readlane_b32 s94, v203, s68
    v_readfirstlane_b32 s47, v14
L_ranked:
    s_mov_b32 exec_hi, 0
    s_and_b32 s54, s90, 0x380
    v_add_u32 v104, s54, v250
    ds_add_rtn_u32 v96, v104, v96 offset:13312
    s_and_b32 s54, s91, 0x380
    v_add_u32 v105, s54, v250
    ds_add_rtn_u32 v97, v105, v97 offset:13312
    s_and_b32 s54, s92, 0x380
    v_add_u32 v106, s54, v250
    ds_add_rtn_u32 v98, v106, v98 offset:13312
    s_and_b32 s54, s93, 0x380
    v_add_u32 v107, s54, v250
    ds_add_rtn_u32 v99, v107, v99 offset:13312
    s_and_b32 s54, s94, 0x380
    v_add_u32 v108, s54, v250
    ds_add_rtn_u32 v100, v108, v100 offset:13312
    v_or_b32 v104, s90, v104
    v_or_b32 v105, s91, v105
    v_or_b32 v106, s92, v106
    v_or_b32 v107, s93, v107
    v_or_b32 v108, s94, v108
    v_writelane_b32 v11, s90, 0
    v_writelane_b32 v11, s91, 1
    v_writelane_b32 v11, s92, 2
    v_writelane_b32 v11, s93, 3
    v_writelane_b32 v11, s94, 4
    s_waitcnt lgkmcnt(4)
    v_lshl_or_b32 v96, v96, 16, v104
    ds_write_b32 v248, v96 offset:8192
    s_waitcnt lgkmcnt(4)
    v_lshl_or_b32 v97, v97, 16, v105
    ds_write_b32 v248, v97 offset:8320
    s_waitcnt lgkmcnt(4)
    v_lshl_or_b32 v98, v98, 16, v106
    ds_write_b32 v248, v98 offset:8448
    s_waitcnt lgkmcnt(4)
    v_lshl_or_b32 v99, v99, 16, v107
    ds_write_b32 v248, v99 offset:8576
    s_waitcnt lgkmcnt(4)
    v_lshl_or_b32 v100, v100, 16, v108
    ds_write_b32 v248, v100 offset:8704
    v_add_lshl_u32 v12, v1, s61, 7
    v_lshrrev_b32 v9, 10, v11
    v_bfe_u32 v11, v11, 2, 8
    v_or_b32 v11, v11, v9
    s_mov_b32 exec_lo, 31
    ds_write_b32 v11, v12 offset:15616
    s_mov_b64 exec, -1
    s_add_u32 m0, s52, 0
    s_nop 0
    buffer_load_dwordx4 v71, s[28:31], 0 offen offset:3072 sc1 lds
    s_add_u32 m0, s52, 4096
    s_nop 0
    buffer_load_dwordx4 v72, s[28:31], s98 offen offset:0 sc1 lds
    s_add_u32 m0, s52, 4096
    s_nop 0
    buffer_load_dwordx4 v73, s[28:31], s98 offen offset:1024 sc1 lds
    s_lshl_b32 s54, s3, 3
    s_add_u32 s55, s54, 7
    s_waitcnt lgkmcnt(0)
    s_barrier
    ds_read_b128 v[96:99], v2 offset:13312
    ds_read_b32 v132, v132 offset:8192
    ds_read_b32 v133, v133 offset:8192
    ds_read_b32 v134, v134 offset:8192
    ds_read_b32 v11, v251 offset:15616
    s_waitcnt lgkmcnt(4)
    v_add_u32 v9, v96, v97
    v_add3_u32 v9, v9, v98, v99
    v_mov_b32 v10, v9
    s_waitcnt lgkmcnt(1)
    v_bfe_u32 v15, v132, 12, 3
    v_add_u32_dpp v10, v10, v10 row_shr:1 row_mask:0xf bank_mask:0xf
    v_or_b32 v78, v15, v78
    v_and_b32 v64, 0x3ff, v132
    v_add_u32_dpp v10, v10, v10 row_shr:2 row_mask:0xf bank_mask:0xf
    v_lshrrev_b32 v132, 16, v132
    v_add_u32 v132, v132, v128
    v_add_u32_dpp v10, v10, v10 row_shr:4 row_mask:0xf bank_mask:0xf
    v_bfe_u32 v15, v133, 12, 3
    v_or_b32 v82, v15, v82
    v_add_u32_dpp v10, v10, v10 row_shr:8 row_mask:0xf bank_mask:0xf
    v_and_b32 v65, 0x3ff, v133
    v_lshrrev_b32 v133, 16, v133
    v_add_u32_dpp v10, v10, v10 row_bcast:15 row_mask:0xa bank_mask:0xf
    v_add_u32 v133, v133, v129
    v_bfe_u32 v15, v134, 12, 3
    v_add_u32_dpp v10, v10, v10 row_bcast:31 row_mask:0xc bank_mask:0xf
    v_or_b32 v86, v15, v86
    v_and_b32 v66, 0x3ff, v134
    v_sub_u32 v9, v10, v9
    v_lshl_add_u32 v104, v9, 2, v252
    v_lshl_add_u32 v105, v96, 2, v104
    v_lshl_add_u32 v106, v97, 2, v105
    v_lshl_add_u32 v107, v98, 2, v106
    ds_write_b128 v2, v[104:107] offset:16384
    ds_read_b32 v64, v64 offset:16384
    ds_read_b32 v65, v65 offset:16384
    ds_read_b32 v66, v66 offset:16384
    v_lshrrev_b32 v134, 16, v134
    v_add_u32 v134, v134, v130
    v_readlane_b32 s50, v10, s55
    v_readlane_b32 s53, v9, s54
    v_readlane_b32 s51, v104, s54
    v_mov_b32 v12, 2097029
    s_sub_u32 s50, s50, s53
    s_lshl_b32 s54, s50, 2
    v_add_u32 v198, s51, v201
    v_add_u32 v199, s51, v202
    v_add_u32 v9, s54, v198
    s_waitcnt lgkmcnt(2)
    v_lshl_add_u32 v132, v132, 2, v64
    s_mov_b64 exec, s[80:81]
    ds_write_b32 v132, v78
    s_mov_b64 exec, -1
    s_waitcnt lgkmcnt(2)
    v_lshl_add_u32 v133, v133, 2, v65
    s_mov_b64 exec, s[82:83]
    ds_write_b32 v133, v82
    s_mov_b64 exec, -1
    s_waitcnt lgkmcnt(2)
    v_lshl_add_u32 v134, v134, 2, v66
    s_mov_b64 exec, s[84:85]
    ds_write_b32 v134, v86
    s_mov_b64 exec, -1
    ds_write_b32 v9, v12
    s_cmp_gt_i32 s95, 192
    s_cbranch_scc1 L_r3
L_r3b:
    v_readlane_b32 s56, v11, 0
    v_readlane_b32 s57, v11, 1
    v_readlane_b32 s58, v11, 2
    v_readlane_b32 s59, v11, 3
    v_readlane_b32 s60, v11, 4
    s_mov_b32 s55, 0x00fffc38
    s_mov_b32 s53, s50
    s_mov_b32 s49, 0xffffff00
    s_mov_b32 s51, 65536
    s_waitcnt vmcnt(0) lgkmcnt(0)
    s_barrier
    ds_read_b32 v196, v198
    ds_read_b32 v194, v199
    ds_read_b32 v197, v198 offset:24
    s_cmp_eq_u32 s50, 0
    s_cbranch_scc1 L_swept
    s_waitcnt lgkmcnt(1)
    v_lshlrev_b32 v196, 3, v196
    v_and_b32 v196, s55, v196
    s_nop 0
    v_readlane_b32 s64, v196, 0
    v_readlane_b32 s65, v196, 1
    v_readlane_b32 s66, v196, 2
    s_and_b32 s61, s64, s49
    buffer_load_dwordx4 v[96:99], v2, s[16:19], s61 offen
    v_readlane_b32 s67, v196, 3
    s_and_b32 s61, s65, s49
    buffer_load_dwordx4 v[100:103], v2, s[16:19], s61 offen
    v_lshrrev_b32 v8, 21, v194
    v_lshl_add_u32 v11, v8, 3, s51
    v_lshl_add_u32 v8, v8, 5, v200
    ds_read_b64 v[192:193], v11
    s_mov_b64 exec, s[86:87]
    ds_read_b128 v[164:167], v8
    s_mov_b64 exec, s[88:89]
    ds_read_b128 v[168:171], v8
    s_mov_b64 exec, -1
    v_readlane_b32 s68, v196, 4
    s_and_b32 s61, s66, s49
    buffer_load_dwordx4 v[104:107], v2, s[16:19], s61 offen
    v_readlane_b32 s69, v196, 5
    s_and_b32 s61, s67, s49
    buffer_load_dwordx4 v[108:111], v2, s[16:19], s61 offen
    s_and_b32 s61, s68, s49
    buffer_load_dwordx4 v[112:115], v2, s[16:19], s61 offen
    s_and_b32 s61, s69, s49
    buffer_load_dwordx4 v[116:119], v2, s[16:19], s61 offen
    s_cmp_lt_u32 s3, 4
    s_cbranch_scc1 L_np
    s_setprio 1
L_np:
.p2align 3
L_loop:
    s_waitcnt lgkmcnt(0)
.p2align 3
    v_mfma_f32_4x4x4_16b_bf16 v[144:147], v[192:193], v[188:189], 0 cbsz:4 abid:0
    v_mfma_f32_4x4x4_16b_bf16 v[148:151], v[192:193], v[188:189], 0 cbsz:4 abid:2
    v_mfma_f32_4x4x4_16b_bf16 v[152:155], v[192:193], v[188:189], 0 cbsz:4 abid:4
    v_mfma_f32_4x4x4_16b_bf16 v[156:159], v[192:193], v[188:189], 0 cbsz:4 abid:6
    v_mfma_f32_32x32x16_bf16 v[64:79], v[164:167], v[172:175], 0
    v_lshlrev_b32 v196, 3, v197
    v_and_b32 v196, s55, v196
    v_add_u32 v198, 64, v198
    v_mfma_f32_32x32x16_bf16 v[80:95], v[164:167], v[180:183], 0
    v_add_u32 v199, 64, v199
    ds_read_b32 v197, v198 offset:24
    ds_read_b32 v194, v199
    v_mfma_f32_32x32x16_bf16 v[64:79], v[168:171], v[176:179], v[64:79]
    v_cvt_pk_bf16_f32 v9, v144, v144
    v_and_b32 v160, v190, v9
    v_and_b32 v161, v191, v9
    v_mfma_f32_32x32x16_bf16 v[80:95], v[168:171], v[184:187], v[80:95]
    s_waitcnt vmcnt(5)
.p2align 3
    v_mfma_f32_16x16x16_bf16 v[128:131], v[160:161], v[96:97], 0
    v_readlane_b32 s70, v196, 0
    v_cvt_pk_bf16_f32 v10, v145, v145
    v_mfma_f32_16x16x16_bf16 v[132:135], v[160:161], v[98:99], 0
    v_and_b32 v162, v190, v10
    v_and_b32 v163, v191, v10
    s_and_b32 s61, s70, s49
    s_waitcnt vmcnt(4)
    buffer_load_dwordx4 v[120:123], v2, s[16:19], s61 offen
    v_mfma_f32_16x16x16_bf16 v[136:139], v[162:163], v[100:101], 0
    v_readlane_b32 s71, v196, 1
    v_cvt_pk_bf16_f32 v9, v146, v146
    v_mfma_f32_16x16x16_bf16 v[140:143], v[162:163], v[102:103], 0
    v_and_b32 v160, v190, v9
    v_and_b32 v161, v191, v9
    s_and_b32 s61, s71, s49
    s_set_gpr_idx_on s64, gpr_idx(SRC2,DST)
    buffer_load_dwordx4 v[124:127], v2, s[16:19], s61 offen
    v_pk_fma_f32 v[16:17], v[128:129], v[64:65], v[16:17] op_sel_hi:[1,0,1]
    v_pk_fma_f32 v[18:19], v[130:131], v[64:65], v[18:19] op_sel_hi:[1,0,1]
    v_pk_fma_f32 v[20:21], v[132:133], v[80:81], v[20:21] op_sel_hi:[1,0,1]
    v_pk_fma_f32 v[22:23], v[134:135], v[80:81], v[22:23] op_sel_hi:[1,0,1]
    s_set_gpr_idx_idx s65
.p2align 3
    v_pk_fma_f32 v[16:17], v[136:137], v[64:65], v[16:17] op_sel:[0,1,0] op_sel_hi:[1,1,1]
    v_pk_fma_f32 v[18:19], v[138:139], v[64:65], v[18:19] op_sel:[0,1,0] op_sel_hi:[1,1,1]
    v_pk_fma_f32 v[20:21], v[140:141], v[80:81], v[20:21] op_sel:[0,1,0] op_sel_hi:[1,1,1]
    v_pk_fma_f32 v[22:23], v[142:143], v[80:81], v[22:23] op_sel:[0,1,0] op_sel_hi:[1,1,1]
    s_set_gpr_idx_off
    s_waitcnt vmcnt(5)
.p2align 3
    v_mfma_f32_16x16x16_bf16 v[128:131], v[160:161], v[104:105], 0
    v_readlane_b32 s72, v196, 2
    v_cvt_pk_bf16_f32 v10, v147, v147
    v_mfma_f32_16x16x16_bf16 v[132:135], v[160:161], v[106:107], 0
    v_and_b32 v162, v190, v10
    v_and_b32 v163, v191, v10
    s_and_b32 s61, s72, s49
    s_waitcnt vmcnt(4)
    buffer_load_dwordx4 v[96:99], v2, s[16:19], s61 offen
    v_mfma_f32_16x16x16_bf16 v[136:139], v[162:163], v[108:109], 0
    v_readlane_b32 s73, v196, 3
    v_cvt_pk_bf16_f32 v9, v148, v148
    v_mfma_f32_16x16x16_bf16 v[140:143], v[162:163], v[110:111], 0
    v_and_b32 v160, v190, v9
    v_and_b32 v161, v191, v9
    s_waitcnt lgkmcnt(0)
    v_lshrrev_b32 v8, 21, v194
    v_lshl_add_u32 v11, v8, 3, s51
    v_lshl_add_u32 v8, v8, 5, v200
    ds_read_b64 v[192:193], v11
    s_mov_b64 exec, s[86:87]
    ds_read_b128 v[164:167], v8
    s_mov_b64 exec, s[88:89]
    ds_read_b128 v[168:171], v8
    s_mov_b64 exec, -1
.p2align 3
    s_and_b32 s61, s73, s49
    s_set_gpr_idx_on s66, gpr_idx(SRC2,DST)
    buffer_load_dwordx4 v[100:103], v2, s[16:19], s61 offen
    v_pk_fma_f32 v[16:17], v[128:129], v[66:67], v[16:17] op_sel_hi:[1,0,1]
    v_pk_fma_f32 v[18:19], v[130:131], v[66:67], v[18:19] op_sel_hi:[1,0,1]
    v_pk_fma_f32 v[20:21], v[132:133], v[82:83], v[20:21] op_sel_hi:[1,0,1]
    v_pk_fma_f32 v[22:23], v[134:135], v[82:83], v[22:23] op_sel_hi:[1,0,1]
    s_set_gpr_idx_idx s67
.p2align 3
    v_pk_fma_f32 v[16:17], v[136:137], v[66:67], v[16:17] op_sel:[0,1,0] op_sel_hi:[1,1,1]
    v_pk_fma_f32 v[18:19], v[138:139], v[66:67], v[18:19] op_sel:[0,1,0] op_sel_hi:[1,1,1]
    v_pk_fma_f32 v[20:21], v[140:141], v[82:83], v[20:21] op_sel:[0,1,0] op_sel_hi:[1,1,1]
    v_pk_fma_f32 v[22:23], v[142:143], v[82:83], v[22:23] op_sel:[0,1,0] op_sel_hi:[1,1,1]
    s_set_gpr_idx_off
    s_cmp_le_u32 s53, 4
    s_cbranch_scc1 L_swept
    s_waitcnt vmcnt(5)
.p2align 3
    v_mfma_f32_16x16x16_bf16 v[128:131], v[160:161], v[112:113], 0
    v_readlane_b32 s74, v196, 4
    v_cvt_pk_bf16_f32 v10, v149, v149
    v_mfma_f32_16x16x16_bf16 v[132:135], v[160:161], v[114:115], 0
    v_and_b32 v162, v190, v10
    v_and_b32 v163, v191, v10
    s_and_b32 s61, s74, s49
    s_waitcnt vmcnt(4)
    buffer_load_dwordx4 v[104:107], v2, s[16:19], s61 offen
    v_mfma_f32_16x16x16_bf16 v[136:139], v[162:163], v[116:117], 0
    v_readlane_b32 s75, v196, 5
    v_cvt_pk_bf16_f32 v9, v150, v150
    v_mfma_f32_16x16x16_bf16 v[140:143], v[162:163], v[118:119], 0
    v_and_b32 v160, v190, v9
    v_and_b32 v161, v191, v9
    s_and_b32 s61, s75, s49
    s_set_gpr_idx_on s68, gpr_idx(SRC2,DST)
    buffer_load_dwordx4 v[108:111], v2, s[16:19], s61 offen
    v_pk_fma_f32 v[16:17], v[128:129], v[68:69], v[16:17] op_sel_hi:[1,0,1]
    v_pk_fma_f32 v[18:19], v[130:131], v[68:69], v[18:19] op_sel_hi:[1,0,1]
    v_pk_fma_f32 v[20:21], v[132:133], v[84:85], v[20:21] op_sel_hi:[1,0,1]
    v_pk_fma_f32 v[22:23], v[134:135], v[84:85], v[22:23] op_sel_hi:[1,0,1]
    s_set_gpr_idx_idx s69
.p2align 3
    v_pk_fma_f32 v[16:17], v[136:137], v[68:69], v[16:17] op_sel:[0,1,0] op_sel_hi:[1,1,1]
    v_pk_fma_f32 v[18:19], v[138:139], v[68:69], v[18:19] op_sel:[0,1,0] op_sel_hi:[1,1,1]
    v_pk_fma_f32 v[20:21], v[140:141], v[84:85], v[20:21] op_sel:[0,1,0] op_sel_hi:[1,1,1]
    v_pk_fma_f32 v[22:23], v[142:143], v[84:85], v[22:23] op_sel:[0,1,0] op_sel_hi:[1,1,1]
    s_set_gpr_idx_off
    s_waitcnt vmcnt(5)
.p2align 3
    v_mfma_f32_16x16x16_bf16 v[128:131], v[160:161], v[120:121], 0
    v_readlane_b32 s76, v196, 6
    v_cvt_pk_bf16_f32 v10, v151, v151
    v_mfma_f32_16x16x16_bf16 v[132:135], v[160:161], v[122:123], 0
    v_and_b32 v162, v190, v10
    v_and_b32 v163, v191, v10
    s_and_b32 s61, s76, s49
    s_waitcnt vmcnt(4)
    buffer_load_dwordx4 v[112:115], v2, s[16:19], s61 offen
    v_mfma_f32_16x16x16_bf16 v[136:139], v[162:163], v[124:125], 0
    v_readlane_b32 s77, v196, 7
    v_cvt_pk_bf16_f32 v9, v152, v152
    v_mfma_f32_16x16x16_bf16 v[140:143], v[162:163], v[126:127], 0
    v_and_b32 v160, v190, v9
    v_and_b32 v161, v191, v9
    s_and_b32 s61, s77, s49
    s_set_gpr_idx_on s70, gpr_idx(SRC2,DST)
    buffer_load_dwordx4 v[116:119], v2, s[16:19], s61 offen
    v_pk_fma_f32 v[16:17], v[128:129], v[70:71], v[16:17] op_sel_hi:[1,0,1]
    v_pk_fma_f32 v[18:19], v[130:131], v[70:71], v[18:19] op_sel_hi:[1,0,1]
    v_pk_fma_f32 v[20:21], v[132:133], v[86:87], v[20:21] op_sel_hi:[1,0,1]
    v_pk_fma_f32 v[22:23], v[134:135], v[86:87], v[22:23] op_sel_hi:[1,0,1]
    s_set_gpr_idx_idx s71
.p2align 3
    v_pk_fma_f32 v[16:17], v[136:137], v[70:71], v[16:17] op_sel:[0,1,0] op_sel_hi:[1,1,1]
    v_pk_fma_f32 v[18:19], v[138:139], v[70:71], v[18:19] op_sel:[0,1,0] op_sel_hi:[1,1,1]
    v_pk_fma_f32 v[20:21], v[140:141], v[86:87], v[20:21] op_sel:[0,1,0] op_sel_hi:[1,1,1]
    v_pk_fma_f32 v[22:23], v[142:143], v[86:87], v[22:23] op_sel:[0,1,0] op_sel_hi:[1,1,1]
    s_set_gpr_idx_off
    s_cmp_le_u32 s53, 8
    s_cbranch_scc1 L_swept
    s_waitcnt vmcnt(5)
.p2align 3
    v_mfma_f32_16x16x16_bf16 v[128:131], v[160:161], v[96:97], 0
    v_readlane_b32 s78, v196, 8
    v_cvt_pk_bf16_f32 v10, v153, v153
    v_mfma_f32_16x16x16_bf16 v[132:135], v[160:161], v[98:99], 0
    v_and_b32 v162, v190, v10
    v_and_b32 v163, v191, v10
    s_and_b32 s61, s78, s49
    s_waitcnt vmcnt(4)
    buffer_load_dwordx4 v[120:123], v2, s[16:19], s61 offen
    v_mfma_f32_16x16x16_bf16 v[136:139], v[162:163], v[100:101], 0
    v_readlane_b32 s79, v196, 9
    v_cvt_pk_bf16_f32 v9, v154, v154
    v_mfma_f32_16x16x16_bf16 v[140:143], v[162:163], v[102:103], 0
    v_and_b32 v160, v190, v9
    v_and_b32 v161, v191, v9
    s_and_b32 s61, s79, s49
    s_set_gpr_idx_on s72, gpr_idx(SRC2,DST)
    buffer_load_dwordx4 v[124:127], v2, s[16:19], s61 offen
    v_pk_fma_f32 v[16:17], v[128:129], v[72:73], v[16:17] op_sel_hi:[1,0,1]
    v_pk_fma_f32 v[18:19], v[130:131], v[72:73], v[18:19] op_sel_hi:[1,0,1]
    v_pk_fma_f32 v[20:21], v[132:133], v[88:89], v[20:21] op_sel_hi:[1,0,1]
    v_pk_fma_f32 v[22:23], v[134:135], v[88:89], v[22:23] op_sel_hi:[1,0,1]
    s_set_gpr_idx_idx s73
.p2align 3
    v_pk_fma_f32 v[16:17], v[136:137], v[72:73], v[16:17] op_sel:[0,1,0] op_sel_hi:[1,1,1]
    v_pk_fma_f32 v[18:19], v[138:139], v[72:73], v[18:19] op_sel:[0,1,0] op_sel_hi:[1,1,1]
    v_pk_fma_f32 v[20:21], v[140:141], v[88:89], v[20:21] op_sel:[0,1,0] op_sel_hi:[1,1,1]
    v_pk_fma_f32 v[22:23], v[142:143], v[88:89], v[22:23] op_sel:[0,1,0] op_sel_hi:[1,1,1]
    s_set_gpr_idx_off
    s_waitcnt vmcnt(5)
.p2align 3
    v_mfma_f32_16x16x16_bf16 v[128:131], v[160:161], v[104:105], 0
    v_readlane_b32 s64, v196, 10
    v_cvt_pk_bf16_f32 v10, v155, v155
    v_mfma_f32_16x16x16_bf16 v[132:135], v[160:161], v[106:107], 0
    v_and_b32 v162, v190, v10
    v_and_b32 v163, v191, v10
    s_and_b32 s61, s64, s49
    s_waitcnt vmcnt(4)
    buffer_load_dwordx4 v[96:99], v2, s[16:19], s61 offen
    v_mfma_f32_16x16x16_bf16 v[136:139], v[162:163], v[108:109], 0
    v_readlane_b32 s65, v196, 11
    v_cvt_pk_bf16_f32 v9, v156, v156
    v_mfma_f32_16x16x16_bf16 v[140:143], v[162:163], v[110:111], 0
    v_and_b32 v160, v190, v9
    v_and_b32 v161, v191, v9
    s_and_b32 s61, s65, s49
    s_set_gpr_idx_on s74, gpr_idx(SRC2,DST)
    buffer_load_dwordx4 v[100:103], v2, s[16:19], s61 offen
    v_pk_fma_f32 v[16:17], v[128:129], v[74:75], v[16:17] op_sel_hi:[1,0,1]
    v_pk_fma_f32 v[18:19], v[130:131], v[74:75], v[18:19] op_sel_hi:[1,0,1]
    v_pk_fma_f32 v[20:21], v[132:133], v[90:91], v[20:21] op_sel_hi:[1,0,1]
    v_pk_fma_f32 v[22:23], v[134:135], v[90:91], v[22:23] op_sel_hi:[1,0,1]
    s_set_gpr_idx_idx s75
.p2align 3
    v_pk_fma_f32 v[16:17], v[136:137], v[74:75], v[16:17] op_sel:[0,1,0] op_sel_hi:[1,1,1]
    v_pk_fma_f32 v[18:19], v[138:139], v[74:75], v[18:19] op_sel:[0,1,0] op_sel_hi:[1,1,1]
    v_pk_fma_f32 v[20:21], v[140:141], v[90:91], v[20:21] op_sel:[0,1,0] op_sel_hi:[1,1,1]
    v_pk_fma_f32 v[22:23], v[142:143], v[90:91], v[22:23] op_sel:[0,1,0] op_sel_hi:[1,1,1]
    s_set_gpr_idx_off
    s_cmp_le_u32 s53, 12
    s_cbranch_scc1 L_swept
    s_waitcnt vmcnt(5)
.p2align 3
    v_mfma_f32_16x16x16_bf16 v[128:131], v[160:161], v[112:113], 0
    v_readlane_b32 s66, v196, 12
    v_cvt_pk_bf16_f32 v10, v157, v157
    v_mfma_f32_16x16x16_bf16 v[132:135], v[160:161], v[114:115], 0
    v_and_b32 v162, v190, v10
    v_and_b32 v163, v191, v10
    s_and_b32 s61, s66, s49
    s_waitcnt vmcnt(4)
    buffer_load_dwordx4 v[104:107], v2, s[16:19], s61 offen
    v_mfma_f32_16x16x16_bf16 v[136:139], v[162:163], v[116:117], 0
    v_readlane_b32 s67, v196, 13
    v_cvt_pk_bf16_f32 v9, v158, v158
    v_mfma_f32_16x16x16_bf16 v[140:143], v[162:163], v[118:119], 0
    v_and_b32 v160, v190, v9
    v_and_b32 v161, v191, v9
    s_and_b32 s61, s67, s49
    s_set_gpr_idx_on s76, gpr_idx(SRC2,DST)
    buffer_load_dwordx4 v[108:111], v2, s[16:19], s61 offen
    v_pk_fma_f32 v[16:17], v[128:129], v[76:77], v[16:17] op_sel_hi:[1,0,1]
    v_pk_fma_f32 v[18:19], v[130:131], v[76:77], v[18:19] op_sel_hi:[1,0,1]
    v_pk_fma_f32 v[20:21], v[132:133], v[92:93], v[20:21] op_sel_hi:[1,0,1]
    v_pk_fma_f32 v[22:23], v[134:135], v[92:93], v[22:23] op_sel_hi:[1,0,1]
    s_set_gpr_idx_idx s77
.p2align 3
    v_pk_fma_f32 v[16:17], v[136:137], v[76:77], v[16:17] op_sel:[0,1,0] op_sel_hi:[1,1,1]
    v_pk_fma_f32 v[18:19], v[138:139], v[76:77], v[18:19] op_sel:[0,1,0] op_sel_hi:[1,1,1]
    v_pk_fma_f32 v[20:21], v[140:141], v[92:93], v[20:21] op_sel:[0,1,0] op_sel_hi:[1,1,1]
    v_pk_fma_f32 v[22:23], v[142:143], v[92:93], v[22:23] op_sel:[0,1,0] op_sel_hi:[1,1,1]
    s_set_gpr_idx_off
    s_waitcnt vmcnt(5)
.p2align 3
    v_mfma_f32_16x16x16_bf16 v[128:131], v[160:161], v[120:121], 0
    v_readlane_b32 s68, v196, 14
    v_cvt_pk_bf16_f32 v10, v159, v159
    v_mfma_f32_16x16x16_bf16 v[132:135], v[160:161], v[122:123], 0
    v_and_b32 v162, v190, v10
    v_and_b32 v163, v191, v10
    s_and_b32 s61, s68, s49
    s_waitcnt vmcnt(4)
    buffer_load_dwordx4 v[112:115], v2, s[16:19], s61 offen
    v_mfma_f32_16x16x16_bf16 v[136:139], v[162:163], v[124:125], 0
    v_readlane_b32 s69, v196, 15
    v_mfma_f32_16x16x16_bf16 v[140:143], v[162:163], v[126:127], 0
    s_and_b32 s61, s69, s49
    s_set_gpr_idx_on s78, gpr_idx(SRC2,DST)
    buffer_load_dwordx4 v[116:119], v2, s[16:19], s61 offen
    v_pk_fma_f32 v[16:17], v[128:129], v[78:79], v[16:17] op_sel_hi:[1,0,1]
    v_pk_fma_f32 v[18:19], v[130:131], v[78:79], v[18:19] op_sel_hi:[1,0,1]
    v_pk_fma_f32 v[20:21], v[132:133], v[94:95], v[20:21] op_sel_hi:[1,0,1]
    v_pk_fma_f32 v[22:23], v[134:135], v[94:95], v[22:23] op_sel_hi:[1,0,1]
    s_set_gpr_idx_idx s79
    s_sub_i32 s53, s53, 16
.p2align 3
    v_pk_fma_f32 v[16:17], v[136:137], v[78:79], v[16:17] op_sel:[0,1,0] op_sel_hi:[1,1,1]
    v_pk_fma_f32 v[18:19], v[138:139], v[78:79], v[18:19] op_sel:[0,1,0] op_sel_hi:[1,1,1]
    v_pk_fma_f32 v[20:21], v[140:141], v[94:95], v[20:21] op_sel:[0,1,0] op_sel_hi:[1,1,1]
    v_pk_fma_f32 v[22:23], v[142:143], v[94:95], v[22:23] op_sel:[0,1,0] op_sel_hi:[1,1,1]
    s_set_gpr_idx_off
    s_cmp_gt_i32 s53, 0
    s_cbranch_scc1 L_loop
L_swept:
    s_nop 7
    s_add_u32 s48, s48, 256
    s_cmp_lt_u32 s48, s47
    s_cbranch_scc1 L_again
    v_lshlrev_b32 v8, 2, v1
    s_mul_i32 s54, s56, 9
    v_cvt_pk_bf16_f32 v64, v16, v20
    v_cvt_pk_bf16_f32 v65, v17, v21
    v_cvt_pk_bf16_f32 v66, v18, v22
    v_cvt_pk_bf16_f32 v67, v19, v23
    v_add_u32 v84, s54, v8
    ds_write2_b32 v84, v64, v65 offset0:0 offset1:72
    ds_write2_b32 v84, v66, v67 offset0:144 offset1:216
    s_mul_i32 s54, s57, 9
    v_cvt_pk_bf16_f32 v68, v24, v28
    v_cvt_pk_bf16_f32 v69, v25, v29
    v_cvt_pk_bf16_f32 v70, v26, v30
    v_cvt_pk_bf16_f32 v71, v27, v31
    v_add_u32 v85, s54, v8
    ds_write2_b32 v85, v68, v69 offset0:0 offset1:72
    ds_write2_b32 v85, v70, v71 offset0:144 offset1:216
    s_mul_i32 s54, s58, 9
    v_cvt_pk_bf16_f32 v72, v32, v36
    v_cvt_pk_bf16_f32 v73, v33, v37
    v_cvt_pk_bf16_f32 v74, v34, v38
    v_cvt_pk_bf16_f32 v75, v35, v39
    v_add_u32 v86, s54, v8
    ds_write2_b32 v86, v72, v73 offset0:0 offset1:72
    ds_write2_b32 v86, v74, v75 offset0:144 offset1:216
    s_mul_i32 s54, s59, 9
    v_cvt_pk_bf16_f32 v76, v40, v44
    v_cvt_pk_bf16_f32 v77, v41, v45
    v_cvt_pk_bf16_f32 v78, v42, v46
    v_cvt_pk_bf16_f32 v79, v43, v47
    v_add_u32 v87, s54, v8
    ds_write2_b32 v87, v76, v77 offset0:0 offset1:72
    ds_write2_b32 v87, v78, v79 offset0:144 offset1:216
    s_mul_i32 s54, s60, 9
    v_cvt_pk_bf16_f32 v80, v48, v52
    v_cvt_pk_bf16_f32 v81, v49, v53
    v_cvt_pk_bf16_f32 v82, v50, v54
    v_cvt_pk_bf16_f32 v83, v51, v55
    v_add_u32 v88, s54, v8
    ds_write2_b32 v88, v80, v81 offset0:0 offset1:72
    ds_write2_b32 v88, v82, v83 offset0:144 offset1:216
    v_and_b32 v8, 15, v1
    v_lshrrev_b32 v9, 4, v1
    s_lshr_b32 s54, s3, 2
    s_mul_i32 s55, s54, 23040
    v_mul_u32_u24 v10, 288, v8
    v_lshl_add_u32 v10, v9, 4, v10
    v_add_u32 v10, s55, v10
    v_lshlrev_b32 v9, 10, v9
    v_lshl_add_u32 v9, v8, 2, v9
    s_mul_i32 s54, s54, 20480
    s_and_b32 s55, s3, 3
    s_lshl_b32 s55, s55, 6
    s_add_u32 s54, s54, s55
    s_waitcnt lgkmcnt(0)
    s_barrier
    ds_read_b128 v[16:19], v10 offset:0
    ds_read_b128 v[20:23], v10 offset:64
    ds_read_b128 v[24:27], v10 offset:128
    ds_read_b128 v[28:31], v10 offset:192
    ds_read_b128 v[32:35], v10 offset:4608
    ds_read_b128 v[36:39], v10 offset:4672
    ds_read_b128 v[40:43], v10 offset:4736
    ds_read_b128 v[44:47], v10 offset:4800
    ds_read_b128 v[48:51], v10 offset:9216
    ds_read_b128 v[52:55], v10 offset:9280
    ds_read_b128 v[56:59], v10 offset:9344
    ds_read_b128 v[60:63], v10 offset:9408
    s_waitcnt lgkmcnt(11)
    v_mfma_f32_16x16x32_bf16 v[128:131], v[16:19], v[208:211], 0
    v_mfma_f32_16x16x32_bf16 v[132:135], v[16:19], v[212:215], 0
    s_waitcnt lgkmcnt(10)
    v_mfma_f32_16x16x32_bf16 v[128:131], v[20:23], v[216:219], v[128:131]
    v_mfma_f32_16x16x32_bf16 v[132:135], v[20:23], v[220:223], v[132:135]
    s_waitcnt lgkmcnt(9)
    v_mfma_f32_16x16x32_bf16 v[128:131], v[24:27], v[224:227], v[128:131]
    v_mfma_f32_16x16x32_bf16 v[132:135], v[24:27], v[228:231], v[132:135]
    s_waitcnt lgkmcnt(8)
    v_mfma_f32_16x16x32_bf16 v[128:131], v[28:31], v[232:235], v[128:131]
    v_mfma_f32_16x16x32_bf16 v[132:135], v[28:31], v[236:239], v[132:135]
    ds_read_b128 v[64:67], v10 offset:13824
    ds_read_b128 v[68:71], v10 offset:13888
    ds_read_b128 v[72:75], v10 offset:13952
    ds_read_b128 v[76:79], v10 offset:14016
    s_waitcnt lgkmcnt(8)
    v_mfma_f32_16x16x32_bf16 v[136:139], v[32:35], v[208:211], 0
    v_mfma_f32_16x16x32_bf16 v[140:143], v[32:35], v[212:215], 0
    v_mfma_f32_16x16x32_bf16 v[136:139], v[36:39], v[216:219], v[136:139]
    v_mfma_f32_16x16x32_bf16 v[140:143], v[36:39], v[220:223], v[140:143]
    v_mfma_f32_16x16x32_bf16 v[136:139], v[40:43], v[224:227], v[136:139]
    v_mfma_f32_16x16x32_bf16 v[140:143], v[40:43], v[228:231], v[140:143]
    v_mfma_f32_16x16x32_bf16 v[136:139], v[44:47], v[232:235], v[136:139]
    v_mfma_f32_16x16x32_bf16 v[140:143], v[44:47], v[236:239], v[140:143]
    v_cvt_pk_bf16_f32 v168, v128, v132
    buffer_store_dword v168, v9, s[40:43], s54 offen offset:0 sc1
    v_cvt_pk_bf16_f32 v169, v129, v133
    buffer_store_dword v169, v9, s[40:43], s54 offen offset:256 sc1
    v_cvt_pk_bf16_f32 v170, v130, v134
    buffer_store_dword v170, v9, s[40:43], s54 offen offset:512 sc1
    v_cvt_pk_bf16_f32 v171, v131, v135
    buffer_store_dword v171, v9, s[40:43], s54 offen offset:768 sc1
    s_add_u32 s54, s54, 4096
    ds_read_b128 v[80:83], v10 offset:18432
    ds_read_b128 v[84:87], v10 offset:18496
    ds_read_b128 v[88:91], v10 offset:18560
    ds_read_b128 v[92:95], v10 offset:18624
    s_waitcnt lgkmcnt(8)
    v_mfma_f32_16x16x32_bf16 v[144:147], v[48:51], v[208:211], 0
    v_mfma_f32_16x16x32_bf16 v[148:151], v[48:51], v[212:215], 0
    v_mfma_f32_16x16x32_bf16 v[144:147], v[52:55], v[216:219], v[144:147]
    v_mfma_f32_16x16x32_bf16 v[148:151], v[52:55], v[220:223], v[148:151]
    v_mfma_f32_16x16x32_bf16 v[144:147], v[56:59], v[224:227], v[144:147]
    v_mfma_f32_16x16x32_bf16 v[148:151], v[56:59], v[228:231], v[148:151]
    v_mfma_f32_16x16x32_bf16 v[144:147], v[60:63], v[232:235], v[144:147]
    v_mfma_f32_16x16x32_bf16 v[148:151], v[60:63], v[236:239], v[148:151]
    v_cvt_pk_bf16_f32 v172, v136, v140
    buffer_store_dword v172, v9, s[40:43], s54 offen offset:0 sc1
    v_cvt_pk_bf16_f32 v173, v137, v141
    buffer_store_dword v173, v9, s[40:43], s54 offen offset:256 sc1
    v_cvt_pk_bf16_f32 v174, v138, v142
    buffer_store_dword v174, v9, s[40:43], s54 offen offset:512 sc1
    v_cvt_pk_bf16_f32 v175, v139, v143
    buffer_store_dword v175, v9, s[40:43], s54 offen offset:768 sc1
    s_add_u32 s54, s54, 4096
    s_waitcnt lgkmcnt(4)
    v_mfma_f32_16x16x32_bf16 v[152:155], v[64:67], v[208:211], 0
    v_mfma_f32_16x16x32_bf16 v[156:159], v[64:67], v[212:215], 0
    v_mfma_f32_16x16x32_bf16 v[152:155], v[68:71], v[216:219], v[152:155]
    v_mfma_f32_16x16x32_bf16 v[156:159], v[68:71], v[220:223], v[156:159]
    v_mfma_f32_16x16x32_bf16 v[152:155], v[72:75], v[224:227], v[152:155]
    v_mfma_f32_16x16x32_bf16 v[156:159], v[72:75], v[228:231], v[156:159]
    v_mfma_f32_16x16x32_bf16 v[152:155], v[76:79], v[232:235], v[152:155]
    v_mfma_f32_16x16x32_bf16 v[156:159], v[76:79], v[236:239], v[156:159]
    v_cvt_pk_bf16_f32 v176, v144, v148
    buffer_store_dword v176, v9, s[40:43], s54 offen offset:0 sc1
    v_cvt_pk_bf16_f32 v177, v145, v149
    buffer_store_dword v177, v9, s[40:43], s54 offen offset:256 sc1
    v_cvt_pk_bf16_f32 v178, v146, v150
    buffer_store_dword v178, v9, s[40:43], s54 offen offset:512 sc1
    v_cvt_pk_bf16_f32 v179, v147, v151
    buffer_store_dword v179, v9, s[40:43], s54 offen offset:768 sc1
    s_add_u32 s54, s54, 4096
    s_waitcnt lgkmcnt(0)
    v_mfma_f32_16x16x32_bf16 v[160:163], v[80:83], v[208:211], 0
    v_mfma_f32_16x16x32_bf16 v[164:167], v[80:83], v[212:215], 0
    v_mfma_f32_16x16x32_bf16 v[160:163], v[84:87], v[216:219], v[160:163]
    v_mfma_f32_16x16x32_bf16 v[164:167], v[84:87], v[220:223], v[164:167]
    v_mfma_f32_16x16x32_bf16 v[160:163], v[88:91], v[224:227], v[160:163]
    v_mfma_f32_16x16x32_bf16 v[164:167], v[88:91], v[228:231], v[164:167]
    v_mfma_f32_16x16x32_bf16 v[160:163], v[92:95], v[232:235], v[160:163]
    v_mfma_f32_16x16x32_bf16 v[164:167], v[92:95], v[236:239], v[164:167]
    v_cvt_pk_bf16_f32 v180, v152, v156
    buffer_store_dword v180, v9, s[40:43], s54 offen offset:0 sc1
    v_cvt_pk_bf16_f32 v181, v153, v157
    buffer_store_dword v181, v9, s[40:43], s54 offen offset:256 sc1
    v_cvt_pk_bf16_f32 v182, v154, v158
    buffer_store_dword v182, v9, s[40:43], s54 offen offset:512 sc1
    v_cvt_pk_bf16_f32 v183, v155, v159
    buffer_store_dword v183, v9, s[40:43], s54 offen offset:768 sc1
    s_add_u32 s54, s54, 4096
    v_cvt_pk_bf16_f32 v184, v160, v164
    buffer_store_dword v184, v9, s[40:43], s54 offen offset:0 sc1
    v_cvt_pk_bf16_f32 v185, v161, v165
    buffer_store_dword v185, v9, s[40:43], s54 offen offset:256 sc1
    v_cvt_pk_bf16_f32 v186, v162, v166
    buffer_store_dword v186, v9, s[40:43], s54 offen offset:512 sc1
    v_cvt_pk_bf16_f32 v187, v163, v167
    buffer_store_dword v187, v9, s[40:43], s54 offen offset:768 sc1
    s_add_u32 s54, s54, 4096
    s_or_b32 s4, s2, s3
    s_cbranch_scc1 L_notag
    v_mov_b32 v8, s62
    v_lshlrev_b32 v10, 2, v1
    s_mov_b32 s54, 524288
    buffer_store_dword v8, v10, s[20:23], s54 offen sc1
L_notag:
L_done:
    s_endpgm
L_again:
    s_waitcnt vmcnt(0) lgkmcnt(0)
    s_barrier
    v_lshlrev_b32 v11, 2, v0
    v_mov_b32 v12, 0x00700000
    v_mov_b32 v13, 0
    ds_write_b32 v11, v12 offset:0
    ds_write_b32 v11, v12 offset:2048
    ds_write_b32 v11, v12 offset:4096
    ds_write_b32 v11, v12 offset:6144
    ds_write_b32 v11, v13 offset:8192
    ds_write_b32 v11, v13 offset:10240
    ds_write_b32 v11, v13 offset:12288
    v_add_u32 v3, v3, v4
    v_subrev_u32 v3, 256, v3
    v_max_i32 v3, 0, v3
    v_subrev_u32 v4, 256, v4
    v_max_i32 v4, 0, v4
    v_sub_u32 v3, v3, v4
    v_add_u32 v5, 256, v5
    s_sub_i32 s95, s95, 256
    v_lshl_add_u32 v8, v4, 2, v241
    s_waitcnt lgkmcnt(0)
    s_barrier
L_clip:
    v_add_u32 v10, v4, v3
    v_min_i32 v10, 256, v10
    v_sub_u32 v10, v10, v4
    v_add_u32 v10, v10, v240
L_masks:
    v_cmp_lt_i32 s[64:65], 0, v10
    v_cmp_lt_i32 s[66:67], 2, v10
    v_cmp_lt_i32 s[68:69], 4, v10
    v_cmp_lt_i32 s[70:71], 6, v10
    v_cmp_lt_i32 s[72:73], 8, v10
    v_cmp_lt_i32 s[74:75], 10, v10
    v_cmp_lt_i32 s[76:77], 12, v10
    v_cmp_lt_i32 s[78:79], 14, v10
    s_nop 0
    s_branch L_mapw
L_map2:
    v_add_u32 v8, 56, v8
    v_subrev_u32 v10, 14, v10
    s_branch L_masks
L_r1:
    ds_read_b32 v67, v242 offset:768
    ds_read_b32 v74, v243 offset:768
    ds_read_b32 v75, v243 offset:896
    s_waitcnt lgkmcnt(0)
    v_mad_u32_u24 v67, v67, 12, v244
    buffer_load_dwordx3 v[88:90], v67, s[24:27], 0 offen offset:2304 sc1
    v_lshl_add_u32 v74, v74, 5, v2
    s_add_u32 m0, s52, 4096
    s_nop 0
    buffer_load_dwordx4 v74, s[28:31], s98 offen offset:2048 sc1 lds
    v_lshl_add_u32 v75, v75, 5, v2
    s_add_u32 m0, s52, 4096
    s_nop 0
    buffer_load_dwordx4 v75, s[28:31], s98 offen offset:3072 sc1 lds
    s_branch L_r1b
L_r2:
    v_lshrrev_b32 v135, 21, v90
    v_lshlrev_b32 v135, 2, v135
    v_lshrrev_b32 v11, 26, v90
    v_lshl_or_b32 v11, v11, 4, v245
    s_mov_b64 exec, s[96:97]
    ds_add_rtn_u32 v131, v135, v6 offset:8192
    ds_add_u32 v11, v6 offset:14336
    s_mov_b64 exec, -1
    ds_write_b64 v246, v[88:89] offset:1536
    v_and_or_b32 v90, v90, s55, v247
    v_add_u32 v90, 402653184, v90
    s_branch L_r2b
L_r3:
    ds_read_b32 v135, v135 offset:8192
    s_waitcnt lgkmcnt(0)
    v_bfe_u32 v15, v135, 12, 3
    v_or_b32 v90, v15, v90
    v_and_b32 v67, 0x3ff, v135
    v_lshrrev_b32 v135, 16, v135
    v_add_u32 v135, v135, v131
    ds_read_b32 v67, v67 offset:16384
    s_waitcnt lgkmcnt(0)
    v_lshl_add_u32 v135, v135, 2, v67
    s_mov_b64 exec, s[96:97]
    ds_write_b32 v135, v90
    s_mov_b64 exec, -1
    s_branch L_r3b
L_poll:
    buffer_load_dwordx2 v[206:207], v10, s[20:23], s49 offen sc1
    s_sub_u32 s53, s53, 1
    s_cbranch_scc1 L_done
    s_waitcnt vmcnt(0)
    v_xor_b32 v11, s63, v206
    v_xor_b32 v12, s62, v207
    v_and_or_b32 v11, v11, s55, v12
    v_cmpx_ne_u32 vcc, 0, v11
    s_cbranch_execnz L_poll
    s_branch L_polled
L_rank2:
    ds_read_b32 v96, v248 offset:8192
    ds_read_b32 v97, v248 offset:8320
    ds_read_b32 v98, v248 offset:8448
    ds_read_b32 v99, v248 offset:8576
    ds_read_b32 v100, v248 offset:8704
    s_waitcnt lgkmcnt(0)
L_end:
    s_branch L_ranked
.section .rodata,"a"
.p2align 6
.amdhsa_kernel gather_scatter__tensor_product_equiv_mace__graph_kernel
  .amdhsa_next_free_vgpr 256
  .amdhsa_next_free_sgpr 102
  .amdhsa_accum_offset 256
  .amdhsa_group_segment_fixed_size 0
  .amdhsa_kernarg_size 88
  .amdhsa_user_sgpr_count 2
  .amdhsa_user_sgpr_kernarg_segment_ptr 1
  .amdhsa_system_sgpr_workgroup_id_x 1
  .amdhsa_float_denorm_mode_32 3
.end_amdhsa_kernel
```

```asm
; @launch grid=(256,1,1) block=(512,1,1) lds=147456
.amdgcn_target "amdgcn-amd-amdhsa--gfx950"
.text
.globl gather_scatter__tensor_product_equiv_mace__graph_kernel
.p2align 8
.type gather_scatter__tensor_product_equiv_mace__graph_kernel,@function
gather_scatter__tensor_product_equiv_mace__graph_kernel:
    s_cmp_ge_u32 s2, 256
    s_cbranch_scc1 L_done
    s_load_dwordx4 s[4:7], s[0:1], 8
    s_load_dwordx4 s[8:11], s[0:1], 24
    s_load_dwordx2 s[14:15], s[0:1], 80
    s_load_dwordx2 s[64:65], s[0:1], 0
    s_load_dwordx2 s[66:67], s[0:1], 40
    s_load_dwordx4 s[68:71], s[0:1], 48
    s_load_dwordx2 s[12:13], s[0:1], 64
    v_lshrrev_b32 v8, 6, v0
    v_and_b32 v1, 63, v0
    v_lshlrev_b32 v9, 2, v0
    v_mov_b32 v13, 0
    v_readfirstlane_b32 s3, v8
    ds_write_b32 v9, v13 offset:56320
    ds_write_b32 v9, v13 offset:61440
    s_mul_i32 s54, s2, 5000
    s_mul_i32 s55, s2, 10000
    s_mul_i32 s61, s2, 40000
    v_lshlrev_b32 v2, 4, v1
    v_lshlrev_b32 v10, 3, v0
    v_lshlrev_b32 v15, 4, v0
    v_mov_b32 v6, 1
    s_lshl_b32 s52, s3, 10
    s_add_u32 s52, s52, 81920
    s_movk_i32 s53, 4096
    s_movk_i32 s50, 8192
    s_waitcnt lgkmcnt(0)
    s_add_u32 s32, s6, s54
    s_addc_u32 s33, s7, 0
    s_mov_b32 s34, 5000
    s_mov_b32 s35, 0x20000
    buffer_load_dword v64, v9, s[32:35], 0 offen offset:0 nt
    buffer_load_dword v65, v9, s[32:35], 0 offen offset:2048 nt
    buffer_load_dword v66, v9, s[32:35], s53 offen nt
    s_add_u32 s36, s4, s54
    s_addc_u32 s37, s5, 0
    s_mov_b32 s38, 5000
    s_mov_b32 s39, 0x20000
    buffer_load_dword v68, v9, s[36:39], 0 offen offset:0 nt
    buffer_load_dword v69, v9, s[36:39], 0 offen offset:2048 nt
    buffer_load_dword v70, v9, s[36:39], s53 offen nt
    s_load_dword s62, s[14:15], 524288
    s_getpc_b64 s[80:81]
L_pc:
    s_and_b32 s54, s2, 0xf8
    s_lshl_b32 s54, s54, 6
    v_and_b32 v11, 0x180, v10
    v_add_u32 v11, s54, v11
    v_min_u32 v11, L_end-L_pc, v11
    v_mov_b32 v113, s81
    v_add_co_u32 v112, vcc, s80, v11
    s_nop 1
    v_addc_co_u32 v113, vcc, 0, v113, vcc
    global_load_dword v205, v[112:113], off
    s_add_u32 s96, s8, s55
    s_addc_u32 s97, s9, 0
    s_mov_b32 s98, 10000
    s_mov_b32 s99, 0x20000
    s_add_u32 s28, s10, s61
    s_addc_u32 s29, s11, 0
    s_mov_b32 s30, 40000
    s_mov_b32 s31, 0x20000
    s_barrier
    buffer_load_dwordx2 v[72:73], v10, s[96:99], 0 offen nt
    buffer_load_dwordx2 v[74:75], v10, s[96:99], s53 offen nt
    buffer_load_dwordx2 v[76:77], v10, s[96:99], s50 offen nt
    s_add_u32 m0, s52, 0
    s_mov_b32 s54, 0
    buffer_load_dwordx4 v15, s[28:31], s54 offen nt lds
    s_add_u32 m0, s52, 8192
    s_mov_b32 s54, 8192
    buffer_load_dwordx4 v15, s[28:31], s54 offen nt lds
    s_add_u32 m0, s52, 16384
    s_mov_b32 s54, 16384
    buffer_load_dwordx4 v15, s[28:31], s54 offen nt lds
    s_mov_b32 s72, 109951168
    s_movk_i32 s73, 625
    s_movk_i32 s74, 838
    s_movk_i32 s54, 226
    v_cmp_gt_u32 s[84:85], s54, v0
    v_lshlrev_b32 v11, 2, v0
    v_mov_b32 v12, 0x00700000
    v_mov_b32 v13, 0
    ds_write_b32 v11, v12 offset:0
    ds_write_b32 v11, v12 offset:2048
    ds_write_b32 v11, v12 offset:4096
    ds_write_b32 v11, v12 offset:6144
    ds_write_b32 v11, v13 offset:8192
    ds_write_b32 v11, v13 offset:10240
    ds_write_b32 v11, v13 offset:12288
    ds_write_b32 v11, v13 offset:14336
    s_waitcnt vmcnt(10)
    v_mul_hi_u32 v80, v64, s72
    v_mul_hi_u32 v81, v65, s72
    v_mul_hi_u32 v82, v66, s72
    v_lshlrev_b32 v84, 2, v80
    ds_add_rtn_u32 v88, v84, v6 offset:56320
    v_lshlrev_b32 v85, 2, v81
    ds_add_rtn_u32 v89, v85, v6 offset:56320
    v_lshlrev_b32 v86, 2, v82
    s_mov_b64 exec, s[84:85]
    ds_add_rtn_u32 v90, v86, v6 offset:56320
    s_mov_b64 exec, -1
    s_waitcnt lgkmcnt(0)
    s_barrier
    ds_read_b128 v[100:103], v2 offset:56320
    s_add_u32 m0, s52, 24576
    s_mov_b32 s54, 24576
    buffer_load_dwordx4 v15, s[28:31], s54 offen nt lds
    s_add_u32 m0, s52, 32768
    s_mov_b32 s54, 32768
    buffer_load_dwordx4 v15, s[28:31], s54 offen nt lds
    v_mad_u32_u24 v92, v80, s73, 15
    v_lshrrev_b32 v92, 4, v92
    v_sub_u32 v92, v64, v92
    v_lshrrev_b32 v80, 3, v80
    v_and_b32 v80, 28, v80
    v_mad_u32_u24 v93, v81, s73, 15
    v_lshrrev_b32 v93, 4, v93
    v_sub_u32 v93, v65, v93
    v_lshrrev_b32 v81, 3, v81
    v_and_b32 v81, 28, v81
    v_mad_u32_u24 v94, v82, s73, 15
    v_lshrrev_b32 v94, 4, v94
    v_sub_u32 v94, v66, v94
    v_lshrrev_b32 v82, 3, v82
    v_and_b32 v82, 28, v82
    s_waitcnt lgkmcnt(0)
    v_add_u32 v11, v100, v101
    v_add3_u32 v11, v11, v102, v103
    v_mov_b32 v12, v11
    s_nop 1
    v_add_u32_dpp v12, v12, v12 row_shr:1 row_mask:0xf bank_mask:0xf
    s_nop 1
    v_add_u32_dpp v12, v12, v12 row_shr:2 row_mask:0xf bank_mask:0xf
    s_nop 1
    v_add_u32_dpp v12, v12, v12 row_shr:4 row_mask:0xf bank_mask:0xf
    s_nop 1
    v_add_u32_dpp v12, v12, v12 row_shr:8 row_mask:0xf bank_mask:0xf
    s_nop 1
    v_add_u32_dpp v12, v12, v12 row_bcast:15 row_mask:0xa bank_mask:0xf
    s_nop 1
    v_add_u32_dpp v12, v12, v12 row_bcast:31 row_mask:0xc bank_mask:0xf
    v_sub_u32 v104, v12, v11
    v_add_u32 v105, v104, v100
    v_add_u32 v106, v105, v101
    v_add_u32 v107, v106, v102
    ds_write_b128 v2, v[104:107] offset:57344
    ds_read_b32 v108, v84 offset:57344
    ds_read_b32 v109, v85 offset:57344
    ds_read_b32 v110, v86 offset:57344
    s_waitcnt vmcnt(9)
    v_mul_u32_u24 v96, s74, v68
    v_lshrrev_b32 v96, 18, v96
    v_sub_u32 v96, v96, v80
    v_and_b32 v96, 31, v96
    v_lshl_or_b32 v96, v92, 5, v96
    v_lshlrev_b32 v96, 21, v96
    v_lshl_or_b32 v96, v68, 7, v96
    v_mul_u32_u24 v97, s74, v69
    v_lshrrev_b32 v97, 18, v97
    v_sub_u32 v97, v97, v81
    v_and_b32 v97, 31, v97
    v_lshl_or_b32 v97, v93, 5, v97
    v_lshlrev_b32 v97, 21, v97
    v_lshl_or_b32 v97, v69, 7, v97
    v_mul_u32_u24 v98, s74, v70
    v_lshrrev_b32 v98, 18, v98
    v_sub_u32 v98, v98, v82
    v_and_b32 v98, 31, v98
    v_lshl_or_b32 v98, v94, 5, v98
    v_lshlrev_b32 v98, 21, v98
    v_lshl_or_b32 v98, v70, 7, v98
    v_lshlrev_b32 v92, 5, v0
    v_add_u32 v93, 16384, v92
    v_add_u32 v94, 32768, v92
    s_mov_b32 s55, 63488
    s_waitcnt vmcnt(5) lgkmcnt(0)
    v_add_u32 v108, v108, v88
    v_lshlrev_b32 v84, 2, v108
    v_mad_u32_u24 v108, v108, 12, s55
    ds_write_b32 v84, v92 offset:58368
    ds_write2_b32 v108, v72, v73 offset0:0 offset1:1
    ds_write_b32 v108, v96 offset:8
    v_add_u32 v109, v109, v89
    v_lshlrev_b32 v85, 2, v109
    v_mad_u32_u24 v109, v109, 12, s55
    ds_write_b32 v85, v93 offset:58368
    ds_write2_b32 v109, v74, v75 offset0:0 offset1:1
    ds_write_b32 v109, v97 offset:8
    v_add_u32 v110, v110, v90
    v_lshlrev_b32 v86, 2, v110
    v_mad_u32_u24 v110, v110, 12, s55
    s_mov_b64 exec, s[84:85]
    ds_write_b32 v86, v94 offset:58368
    ds_write2_b32 v110, v76, v77 offset0:0 offset1:1
    ds_write_b32 v110, v98 offset:8
    s_mov_b64 exec, -1
    s_mul_i32 s62, s62, 0x9e3779b1
    s_add_u32 s62, s62, 0x7f4a7c15
    s_mul_i32 s63, s62, 0x85ebca6b
    s_and_b32 s63, s63, 0xffc00000
    s_lshl_b32 s54, s3, 7
    v_lshl_add_u32 v11, v1, 3, s54
    ds_read_b64 v[100:101], v11 offset:56320
    ds_read_b64 v[104:105], v11 offset:57344
    s_mul_i32 s54, s2, 15360
    s_add_u32 s54, s54, 1048576
    s_add_u32 s32, s14, s54
    s_addc_u32 s33, s15, 0
    s_mov_b32 s34, 15360
    s_mov_b32 s35, 0x20000
    s_mul_i32 s54, s2, 40960
    s_add_u32 s54, s54, 5242880
    s_add_u32 s36, s14, s54
    s_addc_u32 s37, s15, 0
    s_mov_b32 s38, 40000
    s_mov_b32 s39, 0x20000
    v_lshrrev_b32 v11, 1, v0
    v_lshlrev_b32 v11, 2, v11
    v_and_b32 v12, 1, v0
    v_lshlrev_b32 v12, 4, v12
    v_add_u32 v12, 81920, v12
    v_add_u32 v14, 63488, v15
    s_waitcnt lgkmcnt(0)
    s_barrier
    ds_read_b128 v[128:131], v14
    ds_read_b128 v[132:135], v14 offset:8192
    ds_read_b32 v156, v11 offset:58368
    ds_read_b32 v157, v11 offset:59392
    ds_read_b32 v158, v11 offset:60416
    ds_read_b32 v159, v11 offset:61440
    ds_read_b32 v160, v11 offset:62464
    s_cmp_lt_u32 s3, 4
    s_cselect_b32 s16, s68, s66
    s_cselect_b32 s17, s69, s67
    s_movk_i32 s54, 128
    s_cselect_b32 s18, s53, s54
    s_mov_b32 s19, 0x20000
    s_min_u32 s54, s3, 5
    s_lshl_b32 s54, s54, 10
    s_add_u32 m0, s54, 17408
    s_and_b32 s54, s54, 0xc00
    buffer_load_dwordx4 v2, s[16:19], s54 offen lds
    s_mov_b32 s40, s70
    s_mov_b32 s41, s71
    s_mov_b32 s42, 32768
    s_mov_b32 s43, 0x20000
    s_lshl_b32 s55, s3, 12
    s_add_u32 m0, s55, 23552
    s_nop 0
    buffer_load_dwordx4 v2, s[40:43], s55 offen offset:0 lds
    buffer_load_dwordx4 v2, s[40:43], s55 offen offset:1024 lds
    buffer_load_dwordx4 v2, s[40:43], s55 offen offset:2048 lds
    buffer_load_dwordx4 v2, s[40:43], s55 offen offset:3072 lds
    s_waitcnt lgkmcnt(0)
    v_add_u32 v156, v12, v156
    v_add_u32 v157, v12, v157
    v_add_u32 v158, v12, v158
    v_add_u32 v159, v12, v159
    v_add_u32 v160, v12, v160
    v_lshl_or_b32 v112, v100, 11, v104
    v_or_b32 v112, s63, v112
    v_mov_b32 v113, s62
    v_lshl_or_b32 v114, v101, 11, v105
    v_or_b32 v114, s63, v114
    v_mov_b32 v115, s62
    s_waitcnt vmcnt(0)
    s_barrier
    ds_read_b128 v[136:139], v156
    ds_read_b128 v[140:143], v157
    ds_read_b128 v[144:147], v158
    ds_read_b128 v[148:151], v159
    ds_read_b128 v[152:155], v160
    buffer_store_dwordx4 v[128:131], v15, s[32:35], 0 offen sc1
    buffer_store_dwordx4 v[132:135], v15, s[32:35], s50 offen sc1
    s_mov_b32 s54, 0
    s_waitcnt lgkmcnt(4)
    buffer_store_dwordx4 v[136:139], v15, s[36:39], s54 offen sc1
    s_mov_b32 s54, 8192
    s_waitcnt lgkmcnt(3)
    buffer_store_dwordx4 v[140:143], v15, s[36:39], s54 offen sc1
    s_mov_b32 s54, 16384
    s_waitcnt lgkmcnt(2)
    buffer_store_dwordx4 v[144:147], v15, s[36:39], s54 offen sc1
    s_mov_b32 s54, 24576
    s_waitcnt lgkmcnt(1)
    buffer_store_dwordx4 v[148:151], v15, s[36:39], s54 offen sc1
    s_mov_b32 s54, 32768
    s_waitcnt lgkmcnt(0)
    buffer_store_dwordx4 v[152:155], v15, s[36:39], s54 offen sc1
    s_and_b32 s44, s2, 7
    s_lshl_b32 s44, s44, 5
    s_lshr_b32 s54, s2, 3
    s_add_u32 s44, s44, s54
    s_mul_i32 s45, s44, 625
    s_add_u32 s46, s45, 640
    s_add_u32 s45, s45, 15
    s_lshr_b32 s45, s45, 4
    s_lshr_b32 s46, s46, 4
    s_sub_u32 s46, s46, s45
    s_mov_b32 s86, 0x0f0f0f0f
    s_mov_b32 s87, 0x0f0f0f0f
    s_mov_b32 s88, 0xf0f0f0f0
    s_mov_b32 s89, 0xf0f0f0f0
    v_mov_b32 v164, 0
    v_mov_b32 v165, 0
    v_mov_b32 v166, 0
    v_mov_b32 v167, 0
    v_mov_b32 v168, 0
    v_mov_b32 v169, 0
    v_mov_b32 v170, 0
    v_mov_b32 v171, 0
    v_and_b32 v11, 4, v1
    v_lshlrev_b32 v11, 2, v11
    v_mov_b32 v12, 0xffff
    v_lshlrev_b32 v12, v11, v12
    v_bfe_i32 v11, v1, 3, 1
    v_and_b32 v191, v11, v12
    v_xor_b32 v190, v191, v12
    v_lshrrev_b32 v200, 5, v1
    v_lshlrev_b32 v200, 4, v200
    v_add_u32 v200, 81920, v200
    v_and_b32 v201, 15, v1
    v_lshlrev_b32 v201, 2, v201
    v_bfe_u32 v11, v1, 3, 2
    v_and_b32 v12, 3, v1
    v_lshl_add_u32 v11, v11, 2, v12
    v_lshlrev_b32 v202, 2, v11
    v_bfe_i32 v240, v0, 0, 1
    s_lshl_b32 s54, s3, 10
    v_and_b32 v241, 4, v240
    v_add_u32 v241, s54, v241
    v_lshl_add_u32 v242, v1, 2, s54
    v_lshrrev_b32 v243, 1, v1
    v_lshl_add_u32 v243, v243, 2, s54
    v_mul_u32_u24 v244, 12, v1
    v_and_b32 v245, 12, v242
    v_and_b32 v250, 124, v242
    v_lshlrev_b32 v246, 1, v242
    v_add_u32 v246, 65536, v246
    v_lshlrev_b32 v247, 19, v242
    s_mul_i32 s54, s3, 640
    v_add_u32 v248, s54, v250
    v_sub_u32 v249, 63, v1
    s_lshl_b32 s54, s3, 5
    v_lshl_add_u32 v251, v1, 2, s54
    v_lshrrev_b32 v252, 3, v1
    v_mul_u32_u24 v252, 64, v252
    v_add_u32 v252, 56320, v252
    s_cmp_eq_u32 s46, 40
    v_mov_b32 v203, 0
    s_mov_b32 s54, 671321104
    s_cselect_b32 s54, 276856880, s54
    s_mov_b32 exec_lo, 31
    s_mov_b32 exec_hi, 0
    v_mov_b32 v203, s54
    s_mov_b32 s54, 405087304
    s_cselect_b32 s54, 159876648, s54
    s_mov_b32 exec_lo, 992
    s_mov_b32 exec_hi, 0
    v_mov_b32 v203, s54
    s_mov_b32 s54, 424579168
    s_cselect_b32 s54, 296066625, s54
    s_mov_b32 exec_lo, 31744
    s_mov_b32 exec_hi, 0
    v_mov_b32 v203, s54
    s_mov_b32 s54, 577443961
    s_cselect_b32 s54, 980068482, s54
    s_mov_b32 exec_lo, 1015808
    s_mov_b32 exec_hi, 0
    v_mov_b32 v203, s54
    s_mov_b32 s54, 600547466
    s_cselect_b32 s54, 466166449, s54
    s_mov_b32 exec_lo, 32505856
    s_mov_b32 exec_hi, 0
    v_mov_b32 v203, s54
    s_mov_b32 s54, 734837403
    s_cselect_b32 s54, 590166779, s54
    s_mov_b32 exec_lo, 1040187392
    s_mov_b32 exec_hi, 0
    v_mov_b32 v203, s54
    s_mov_b32 s54, 481444091
    s_cselect_b32 s54, 754136323, s54
    s_mov_b32 exec_lo, 3221225472
    s_mov_b32 exec_hi, 7
    v_mov_b32 v203, s54
    s_mov_b32 s54, 338903356
    s_cselect_b32 s54, 76598556, s54
    s_mov_b32 exec_lo, 0
    s_mov_b32 exec_hi, 248
    v_mov_b32 v203, s54
    s_mov_b64 exec, -1
    v_mul_u32_u24 v11, 52, v1
    v_lshrrev_b32 v11, 8, v11
    v_mad_i32_i24 v11, v11, -5, v1
    v_mul_u32_u24 v11, 6, v11
    v_lshrrev_b32 v203, v11, v203
    v_and_b32 v11, 7, v203
    v_bfe_u32 v203, v203, 3, 3
    v_lshlrev_b32 v11, 12, v11
    v_lshl_or_b32 v203, v203, 7, v11
    s_mov_b32 s20, s14
    s_mov_b32 s21, s15
    s_mov_b32 s22, 524352
    s_mov_b32 s23, 0x20000
    s_add_u32 s24, s14, 1048576
    s_addc_u32 s25, s15, 0
    s_mov_b32 s26, 3932160
    s_mov_b32 s27, 0x20000
    v_mov_b32 v16, 0
    v_mov_b32 v17, 0
    v_mov_b32 v18, 0
    v_mov_b32 v19, 0
    v_mov_b32 v20, 0
    v_mov_b32 v21, 0
    v_mov_b32 v22, 0
    v_mov_b32 v23, 0
    v_mov_b32 v24, 0
    v_mov_b32 v25, 0
    v_mov_b32 v26, 0
    v_mov_b32 v27, 0
    v_mov_b32 v28, 0
    v_mov_b32 v29, 0
    v_mov_b32 v30, 0
    v_mov_b32 v31, 0
    v_mov_b32 v32, 0
    v_mov_b32 v33, 0
    v_mov_b32 v34, 0
    v_mov_b32 v35, 0
    v_mov_b32 v36, 0
    v_mov_b32 v37, 0
    v_mov_b32 v38, 0
    v_mov_b32 v39, 0
    v_mov_b32 v40, 0
    v_mov_b32 v41, 0
    v_mov_b32 v42, 0
    v_mov_b32 v43, 0
    v_mov_b32 v44, 0
    v_mov_b32 v45, 0
    v_mov_b32 v46, 0
    v_mov_b32 v47, 0
    v_mov_b32 v48, 0
    v_mov_b32 v49, 0
    v_mov_b32 v50, 0
    v_mov_b32 v51, 0
    v_mov_b32 v52, 0
    v_mov_b32 v53, 0
    v_mov_b32 v54, 0
    v_mov_b32 v55, 0
    v_mov_b32 v56, 0
    v_mov_b32 v57, 0
    v_mov_b32 v58, 0
    v_mov_b32 v59, 0
    v_mov_b32 v60, 0
    v_mov_b32 v61, 0
    v_mov_b32 v62, 0
    v_mov_b32 v63, 0
    s_lshl_b32 s54, s2, 3
    s_add_u32 s54, s54, s3
    s_lshl_b32 s54, s54, 8
    s_mov_b32 s16, s64
    s_mov_b32 s17, s65
    s_mov_b32 s18, 10240000
    s_mov_b32 s19, 0x20000
    s_add_u32 s28, s14, 5242880
    s_addc_u32 s29, s15, 0
    s_mov_b32 s30, 10485760
    s_mov_b32 s31, 0x20000
    s_and_b32 s51, s2, 7
    s_mul_i32 s51, s51, 1282048
    s_and_b32 s55, s2, 0xf8
    s_add_u32 s55, s55, s3
    s_mul_i32 s55, s55, 3328
    s_add_u32 s51, s51, s55
    v_min_u32 v14, 25, v1
    v_lshlrev_b32 v14, 7, v14
    s_waitcnt vmcnt(0)
    s_barrier
    s_mov_b64 exec, 0xffff
    buffer_store_dwordx4 v[112:115], v2, s[20:23], s54 offen sc1
    s_mov_b64 exec, -1
    buffer_load_dword v7, v14, s[16:19], s51 offen
    s_lshl_b32 s54, s45, 10
    s_add_u32 s40, s12, s54
    s_addc_u32 s41, s13, 0
    s_lshl_b32 s42, s46, 10
    s_mov_b32 s43, 0x20000
    v_lshrrev_b32 v8, 5, v1
    v_lshlrev_b32 v8, 11, v8
    v_and_b32 v9, 15, v1
    v_lshl_add_u32 v8, v9, 4, v8
    ds_read_b128 v[64:67], v8 offset:17408
    ds_read_b128 v[68:71], v8 offset:17664
    ds_read_b128 v[72:75], v8 offset:17920
    ds_read_b128 v[76:79], v8 offset:18176
    ds_read_b128 v[80:83], v8 offset:18432
    ds_read_b128 v[84:87], v8 offset:18688
    ds_read_b128 v[88:91], v8 offset:18944
    ds_read_b128 v[92:95], v8 offset:19200
    v_lshrrev_b32 v8, 4, v1
    v_lshlrev_b32 v8, 5, v8
    v_and_b32 v9, 3, v1
    v_lshl_add_u32 v8, v9, 1, v8
    ds_read_u16 v96, v8 offset:21504
    ds_read_u16 v97, v8 offset:21512
    ds_read_u16 v98, v8 offset:21520
    ds_read_u16 v99, v8 offset:21528
    v_bfe_i32 v10, v1, 4, 1
    v_and_b32 v10, 0x02020202, v10
    v_add_u32 v10, 0x05040100, v10
    s_waitcnt lgkmcnt(0)
    v_perm_b32 v172, v68, v64, v10
    v_perm_b32 v173, v76, v72, v10
    v_perm_b32 v174, v84, v80, v10
    v_perm_b32 v175, v92, v88, v10
    v_perm_b32 v176, v69, v65, v10
    v_perm_b32 v177, v77, v73, v10
    v_perm_b32 v178, v85, v81, v10
    v_perm_b32 v179, v93, v89, v10
    v_perm_b32 v180, v70, v66, v10
    v_perm_b32 v181, v78, v74, v10
    v_perm_b32 v182, v86, v82, v10
    v_perm_b32 v183, v94, v90, v10
    v_perm_b32 v184, v71, v67, v10
    v_perm_b32 v185, v79, v75, v10
    v_perm_b32 v186, v87, v83, v10
    v_perm_b32 v187, v95, v91, v10
    v_lshl_or_b32 v188, v97, 16, v96
    v_lshl_or_b32 v189, v99, 16, v98
    v_and_b32 v9, 15, v1
    v_lshrrev_b32 v8, 4, v1
    v_lshlrev_b32 v8, 13, v8
    v_lshl_add_u32 v8, v9, 2, v8
    s_and_b32 s72, s3, 3
    s_lshl_b32 s72, s72, 6
    s_add_u32 s72, s72, 23552
    v_add_u32 v8, s72, v8
    ds_read2st64_b32 v[128:129], v8 offset0:0 offset1:4
    ds_read2st64_b32 v[130:131], v8 offset0:8 offset1:12
    ds_read2st64_b32 v[132:133], v8 offset0:16 offset1:20
    ds_read2st64_b32 v[134:135], v8 offset0:24 offset1:28
    ds_read2st64_b32 v[136:137], v8 offset0:1 offset1:5
    ds_read2st64_b32 v[138:139], v8 offset0:9 offset1:13
    ds_read2st64_b32 v[140:141], v8 offset0:17 offset1:21
    ds_read2st64_b32 v[142:143], v8 offset0:25 offset1:29
    ds_read2st64_b32 v[144:145], v8 offset0:2 offset1:6
    ds_read2st64_b32 v[146:147], v8 offset0:10 offset1:14
    ds_read2st64_b32 v[148:149], v8 offset0:18 offset1:22
    ds_read2st64_b32 v[150:151], v8 offset0:26 offset1:30
    ds_read2st64_b32 v[152:153], v8 offset0:3 offset1:7
    ds_read2st64_b32 v[154:155], v8 offset0:11 offset1:15
    ds_read2st64_b32 v[156:157], v8 offset0:19 offset1:23
    ds_read2st64_b32 v[158:159], v8 offset0:27 offset1:31
    s_mov_b32 s72, 0x05040100
    s_mov_b32 s73, 0x07060302
    s_waitcnt lgkmcnt(12)
    v_perm_b32 v208, v129, v128, s72
    v_perm_b32 v209, v131, v130, s72
    v_perm_b32 v210, v133, v132, s72
    v_perm_b32 v211, v135, v134, s72
    v_perm_b32 v212, v129, v128, s73
    v_perm_b32 v213, v131, v130, s73
    v_perm_b32 v214, v133, v132, s73
    v_perm_b32 v215, v135, v134, s73
    s_waitcnt lgkmcnt(8)
    v_perm_b32 v216, v137, v136, s72
    v_perm_b32 v217, v139, v138, s72
    v_perm_b32 v218, v141, v140, s72
    v_perm_b32 v219, v143, v142, s72
    v_perm_b32 v220, v137, v136, s73
    v_perm_b32 v221, v139, v138, s73
    v_perm_b32 v222, v141, v140, s73
    v_perm_b32 v223, v143, v142, s73
    s_waitcnt lgkmcnt(4)
    v_perm_b32 v224, v145, v144, s72
    v_perm_b32 v225, v147, v146, s72
    v_perm_b32 v226, v149, v148, s72
    v_perm_b32 v227, v151, v150, s72
    v_perm_b32 v228, v145, v144, s73
    v_perm_b32 v229, v147, v146, s73
    v_perm_b32 v230, v149, v148, s73
    v_perm_b32 v231, v151, v150, s73
    s_waitcnt lgkmcnt(0)
    v_perm_b32 v232, v153, v152, s72
    v_perm_b32 v233, v155, v154, s72
    v_perm_b32 v234, v157, v156, s72
    v_perm_b32 v235, v159, v158, s72
    v_perm_b32 v236, v153, v152, s73
    v_perm_b32 v237, v155, v154, s73
    v_perm_b32 v238, v157, v156, s73
    v_perm_b32 v239, v159, v158, s73
    v_lshrrev_b32 v9, 1, v0
    v_lshlrev_b32 v10, 11, v9
    s_lshl_b32 s49, s44, 3
    v_mul_u32_u24 v5, 1280, v9
    s_mov_b32 s48, 0
    s_mov_b32 s53, 200000
    s_mov_b32 s55, 0xffc00000
    s_lshl_b32 s52, s3, 13
    s_add_u32 s52, s52, 81920
    s_movk_i32 s98, 4096
    s_waitcnt vmcnt(0)
    s_barrier
    buffer_load_dwordx2 v[206:207], v10, s[20:23], s49 offen sc1
    s_waitcnt vmcnt(0)
    v_xor_b32 v11, s63, v206
    v_xor_b32 v12, s62, v207
    v_and_or_b32 v11, v11, s55, v12
    v_cmpx_ne_u32 vcc, 0, v11
    s_cbranch_execnz L_poll
L_polled:
    s_mov_b64 exec, -1
    v_bfe_u32 v3, v206, 11, 11
    v_and_b32 v4, v3, v240
    v_add_u32 v10, v3, v240
    v_and_b32 v11, 0x7ff, v206
    v_add_u32_dpp v4, v4, v4 row_shr:1 row_mask:0xf bank_mask:0xf
    v_cmp_lt_i32 s[64:65], 0, v10
    v_cmp_lt_i32 s[66:67], 2, v10
    v_add_u32_dpp v4, v4, v4 row_shr:2 row_mask:0xf bank_mask:0xf
    v_cmp_lt_i32 s[68:69], 4, v10
    v_cmp_lt_i32 s[70:71], 6, v10
    v_add_u32_dpp v4, v4, v4 row_shr:4 row_mask:0xf bank_mask:0xf
    v_cmp_lt_i32 s[72:73], 8, v10
    v_cmp_lt_i32 s[74:75], 10, v10
    v_add_u32_dpp v4, v4, v4 row_shr:8 row_mask:0xf bank_mask:0xf
    v_cmp_lt_i32 s[76:77], 12, v10
    v_cmp_lt_i32 s[78:79], 14, v10
    v_add_u32_dpp v4, v4, v4 row_bcast:15 row_mask:0xa bank_mask:0xf
    v_add_u32 v5, v5, v11
    s_nop 0
    v_add_u32_dpp v4, v4, v4 row_bcast:31 row_mask:0xc bank_mask:0xf
    s_nop 0
    v_readlane_b32 s95, v4, 63
    v_mov_b32_dpp v4, v4 quad_perm:[0,0,2,2] row_mask:0xf bank_mask:0xf
    v_sub_u32 v5, v5, v4
    v_lshl_add_u32 v8, v4, 2, v241
    s_cmp_gt_u32 s95, 256
    s_cbranch_scc1 L_clip
L_mapw:
    s_mov_b64 exec, s[64:65]
    ds_write_b32 v8, v5 offset:0
    s_mov_b64 exec, s[66:67]
    ds_write_b32 v8, v5 offset:8
    s_mov_b64 exec, s[68:69]
    ds_write_b32 v8, v5 offset:16
    s_mov_b64 exec, s[70:71]
    ds_write_b32 v8, v5 offset:24
    s_mov_b64 exec, s[72:73]
    ds_write_b32 v8, v5 offset:32
    s_mov_b64 exec, s[74:75]
    ds_write_b32 v8, v5 offset:40
    s_mov_b64 exec, s[76:77]
    ds_write_b32 v8, v5 offset:48
    s_mov_b64 exec, -1
    s_cmp_lg_u64 s[78:79], 0
    s_cbranch_scc1 L_map2
    ds_read_b32 v64, v242 offset:0
    ds_read_b32 v65, v242 offset:256
    ds_read_b32 v66, v242 offset:512
    ds_read_b32 v68, v243 offset:0
    ds_read_b32 v69, v243 offset:128
    ds_read_b32 v70, v243 offset:256
    ds_read_b32 v71, v243 offset:384
    ds_read_b32 v72, v243 offset:512
    ds_read_b32 v73, v243 offset:640
    s_cmp_gt_i32 s95, 192
    s_cbranch_scc1 L_r1
L_r1b:
    s_waitcnt lgkmcnt(6)
    v_mad_u32_u24 v64, v64, 12, v244
    buffer_load_dwordx3 v[76:78], v64, s[24:27], 0 offen offset:0 sc1
    v_mad_u32_u24 v65, v65, 12, v244
    buffer_load_dwordx3 v[80:82], v65, s[24:27], 0 offen offset:768 sc1
    v_mad_u32_u24 v66, v66, 12, v244
    buffer_load_dwordx3 v[84:86], v66, s[24:27], 0 offen offset:1536 sc1
    v_mov_b32 v11, s95
    s_mov_b64 exec, 1
    ds_max_i32 v13, v11 offset:15360
    s_mov_b64 exec, -1
    s_waitcnt lgkmcnt(1)
    v_lshl_add_u32 v68, v68, 5, v2
    v_lshl_add_u32 v69, v69, 5, v2
    v_lshl_add_u32 v70, v70, 5, v2
    v_lshl_add_u32 v71, v71, 5, v2
    v_lshl_add_u32 v72, v72, 5, v2
    v_lshl_add_u32 v73, v73, 5, v2
    s_barrier
    s_add_u32 m0, s52, 0
    s_nop 0
    buffer_load_dwordx4 v68, s[28:31], 0 offen offset:0 sc1 lds
    v_add_u32 v11, 0, v1
    v_cmp_gt_i32 s[80:81], s95, v11
    v_add_u32 v11, 64, v1
    v_cmp_gt_i32 s[82:83], s95, v11
    v_add_u32 v11, 128, v1
    v_cmp_gt_i32 s[84:85], s95, v11
    v_add_u32 v11, 192, v1
    v_cmp_gt_i32 s[96:97], s95, v11
    s_mov_b32 s55, 0x1fff80
    s_mul_i32 s61, s3, 5
    s_waitcnt vmcnt(3)
    v_lshrrev_b32 v132, 21, v78
    v_lshlrev_b32 v132, 2, v132
    v_lshrrev_b32 v11, 26, v78
    v_lshl_or_b32 v11, v11, 4, v245
    s_mov_b64 exec, s[80:81]
    ds_add_rtn_u32 v128, v132, v6 offset:8192
    ds_add_u32 v11, v6 offset:14336
    s_mov_b64 exec, -1
    s_waitcnt vmcnt(2)
    v_lshrrev_b32 v133, 21, v82
    v_lshlrev_b32 v133, 2, v133
    v_lshrrev_b32 v11, 26, v82
    v_lshl_or_b32 v11, v11, 4, v245
    s_mov_b64 exec, s[82:83]
    ds_add_rtn_u32 v129, v133, v6 offset:8192
    ds_add_u32 v11, v6 offset:14336
    s_mov_b64 exec, -1
    s_waitcnt vmcnt(1)
    v_lshrrev_b32 v134, 21, v86
    v_lshlrev_b32 v134, 2, v134
    v_lshrrev_b32 v11, 26, v86
    v_lshl_or_b32 v11, v11, 4, v245
    s_mov_b64 exec, s[84:85]
    ds_add_rtn_u32 v130, v134, v6 offset:8192
    ds_add_u32 v11, v6 offset:14336
    s_mov_b64 exec, -1
    s_cmp_gt_i32 s95, 192
    s_cbranch_scc1 L_r2
L_r2b:
    ds_write_b64 v246, v[76:77] offset:0
    v_and_or_b32 v78, v78, s55, v247
    ds_write_b64 v246, v[80:81] offset:512
    v_and_or_b32 v82, v82, s55, v247
    v_add_u32 v82, 134217728, v82
    ds_write_b64 v246, v[84:85] offset:1024
    v_and_or_b32 v86, v86, s55, v247
    v_add_u32 v86, 268435456, v86
    s_add_u32 m0, s52, 0
    s_nop 0
    buffer_load_dwordx4 v69, s[28:31], 0 offen offset:1024 sc1 lds
    s_add_u32 m0, s52, 0
    s_nop 0
    buffer_load_dwordx4 v70, s[28:31], 0 offen offset:2048 sc1 lds
    s_waitcnt lgkmcnt(3)
    s_barrier
    s_cmp_lg_u32 s48, 0
    s_cbranch_scc1 L_rank2
    ds_read_b128 v[104:107], v2 offset:14336
    ds_read_b32 v96, v248 offset:8192
    ds_read_b32 v97, v248 offset:8320
    ds_read_b32 v98, v248 offset:8448
    ds_read_b32 v99, v248 offset:8576
    ds_read_b32 v100, v248 offset:8704
    ds_read_b32 v14, v13 offset:15360
    s_add_u32 s65, s61, 1
    s_add_u32 s66, s61, 2
    s_add_u32 s67, s61, 3
    s_add_u32 s68, s61, 4
    s_waitcnt lgkmcnt(6)
    v_add_u32 v9, v104, v105
    v_add3_u32 v9, v9, v106, v107
    v_lshl_or_b32 v9, v9, 6, v249
    s_nop 0
    v_readlane_b32 s64, v9, s61
    v_readlane_b32 s65, v9, s65
    v_readlane_b32 s66, v9, s66
    v_readlane_b32 s67, v9, s67
    v_readlane_b32 s68, v9, s68
    v_cmp_lt_u32 s[70:71], s64, v9
    v_cmp_lt_u32 s[72:73], s65, v9
    v_cmp_lt_u32 s[74:75], s66, v9
    v_cmp_lt_u32 s[76:77], s67, v9
    v_cmp_lt_u32 s[78:79], s68, v9
    s_bcnt1_i32_b64 s64, s[70:71]
    s_bcnt1_i32_b64 s65, s[72:73]
    s_bcnt1_i32_b64 s66, s[74:75]
    s_bcnt1_i32_b64 s67, s[76:77]
    s_bcnt1_i32_b64 s68, s[78:79]
    s_waitcnt lgkmcnt(0)
    v_readlane_b32 s90, v203, s64
    v_readlane_b32 s91, v203, s65
    v_readlane_b32 s92, v203, s66
    v_readlane_b32 s93, v203, s67
    v_readlane_b32 s94, v203, s68
    v_readfirstlane_b32 s47, v14
L_ranked:
    s_mov_b32 exec_hi, 0
    s_and_b32 s54, s90, 0x380
    v_add_u32 v104, s54, v250
    ds_add_rtn_u32 v96, v104, v96 offset:13312
    s_and_b32 s54, s91, 0x380
    v_add_u32 v105, s54, v250
    ds_add_rtn_u32 v97, v105, v97 offset:13312
    s_and_b32 s54, s92, 0x380
    v_add_u32 v106, s54, v250
    ds_add_rtn_u32 v98, v106, v98 offset:13312
    s_and_b32 s54, s93, 0x380
    v_add_u32 v107, s54, v250
    ds_add_rtn_u32 v99, v107, v99 offset:13312
    s_and_b32 s54, s94, 0x380
    v_add_u32 v108, s54, v250
    ds_add_rtn_u32 v100, v108, v100 offset:13312
    v_or_b32 v104, s90, v104
    v_or_b32 v105, s91, v105
    v_or_b32 v106, s92, v106
    v_or_b32 v107, s93, v107
    v_or_b32 v108, s94, v108
    v_writelane_b32 v11, s90, 0
    v_writelane_b32 v11, s91, 1
    v_writelane_b32 v11, s92, 2
    v_writelane_b32 v11, s93, 3
    v_writelane_b32 v11, s94, 4
    s_waitcnt lgkmcnt(4)
    v_lshl_or_b32 v96, v96, 16, v104
    ds_write_b32 v248, v96 offset:8192
    s_waitcnt lgkmcnt(4)
    v_lshl_or_b32 v97, v97, 16, v105
    ds_write_b32 v248, v97 offset:8320
    s_waitcnt lgkmcnt(4)
    v_lshl_or_b32 v98, v98, 16, v106
    ds_write_b32 v248, v98 offset:8448
    s_waitcnt lgkmcnt(4)
    v_lshl_or_b32 v99, v99, 16, v107
    ds_write_b32 v248, v99 offset:8576
    s_waitcnt lgkmcnt(4)
    v_lshl_or_b32 v100, v100, 16, v108
    ds_write_b32 v248, v100 offset:8704
    v_add_lshl_u32 v12, v1, s61, 7
    v_lshrrev_b32 v9, 10, v11
    v_bfe_u32 v11, v11, 2, 8
    v_or_b32 v11, v11, v9
    s_mov_b32 exec_lo, 31
    ds_write_b32 v11, v12 offset:15616
    s_mov_b64 exec, -1
    s_add_u32 m0, s52, 0
    s_nop 0
    buffer_load_dwordx4 v71, s[28:31], 0 offen offset:3072 sc1 lds
    s_add_u32 m0, s52, 4096
    s_nop 0
    buffer_load_dwordx4 v72, s[28:31], s98 offen offset:0 sc1 lds
    s_add_u32 m0, s52, 4096
    s_nop 0
    buffer_load_dwordx4 v73, s[28:31], s98 offen offset:1024 sc1 lds
    s_lshl_b32 s54, s3, 3
    s_add_u32 s55, s54, 7
    s_waitcnt lgkmcnt(0)
    s_barrier
    ds_read_b128 v[96:99], v2 offset:13312
    ds_read_b32 v132, v132 offset:8192
    ds_read_b32 v133, v133 offset:8192
    ds_read_b32 v134, v134 offset:8192
    ds_read_b32 v11, v251 offset:15616
    s_waitcnt lgkmcnt(4)
    v_add_u32 v9, v96, v97
    v_add3_u32 v9, v9, v98, v99
    v_mov_b32 v10, v9
    s_waitcnt lgkmcnt(1)
    v_bfe_u32 v15, v132, 12, 3
    v_add_u32_dpp v10, v10, v10 row_shr:1 row_mask:0xf bank_mask:0xf
    v_or_b32 v78, v15, v78
    v_and_b32 v64, 0x3ff, v132
    v_add_u32_dpp v10, v10, v10 row_shr:2 row_mask:0xf bank_mask:0xf
    v_lshrrev_b32 v132, 16, v132
    v_add_u32 v132, v132, v128
    v_add_u32_dpp v10, v10, v10 row_shr:4 row_mask:0xf bank_mask:0xf
    v_bfe_u32 v15, v133, 12, 3
    v_or_b32 v82, v15, v82
    v_add_u32_dpp v10, v10, v10 row_shr:8 row_mask:0xf bank_mask:0xf
    v_and_b32 v65, 0x3ff, v133
    v_lshrrev_b32 v133, 16, v133
    v_add_u32_dpp v10, v10, v10 row_bcast:15 row_mask:0xa bank_mask:0xf
    v_add_u32 v133, v133, v129
    v_bfe_u32 v15, v134, 12, 3
    v_add_u32_dpp v10, v10, v10 row_bcast:31 row_mask:0xc bank_mask:0xf
    v_or_b32 v86, v15, v86
    v_and_b32 v66, 0x3ff, v134
    v_sub_u32 v9, v10, v9
    v_lshl_add_u32 v104, v9, 2, v252
    v_lshl_add_u32 v105, v96, 2, v104
    v_lshl_add_u32 v106, v97, 2, v105
    v_lshl_add_u32 v107, v98, 2, v106
    ds_write_b128 v2, v[104:107] offset:16384
    ds_read_b32 v64, v64 offset:16384
    ds_read_b32 v65, v65 offset:16384
    ds_read_b32 v66, v66 offset:16384
    v_lshrrev_b32 v134, 16, v134
    v_add_u32 v134, v134, v130
    v_readlane_b32 s50, v10, s55
    v_readlane_b32 s53, v9, s54
    v_readlane_b32 s51, v104, s54
    v_mov_b32 v12, 2097029
    s_sub_u32 s50, s50, s53
    s_lshl_b32 s54, s50, 2
    v_add_u32 v198, s51, v201
    v_add_u32 v199, s51, v202
    v_add_u32 v9, s54, v198
    s_waitcnt lgkmcnt(2)
    v_lshl_add_u32 v132, v132, 2, v64
    s_mov_b64 exec, s[80:81]
    ds_write_b32 v132, v78
    s_mov_b64 exec, -1
    s_waitcnt lgkmcnt(2)
    v_lshl_add_u32 v133, v133, 2, v65
    s_mov_b64 exec, s[82:83]
    ds_write_b32 v133, v82
    s_mov_b64 exec, -1
    s_waitcnt lgkmcnt(2)
    v_lshl_add_u32 v134, v134, 2, v66
    s_mov_b64 exec, s[84:85]
    ds_write_b32 v134, v86
    s_mov_b64 exec, -1
    ds_write_b32 v9, v12
    s_cmp_gt_i32 s95, 192
    s_cbranch_scc1 L_r3
L_r3b:
    v_readlane_b32 s56, v11, 0
    v_readlane_b32 s57, v11, 1
    v_readlane_b32 s58, v11, 2
    v_readlane_b32 s59, v11, 3
    v_readlane_b32 s60, v11, 4
    s_add_u32 s54, s50, 1
    s_and_b32 s54, s54, -2
    s_add_u32 s53, s54, 15
    s_lshr_b32 s53, s53, 4
    s_sub_u32 s54, 0, s54
    s_and_b32 s54, s54, 15
    s_sub_u32 s53, s53, 1
    s_cmp_gt_i32 s53, 0
    s_cselect_b32 s54, s54, 0
    s_lshl_b32 s61, s54, 2
    v_subrev_u32 v198, s61, v198
    v_subrev_u32 v199, s61, v199
    s_and_b32 s61, s61, 32
    v_add_u32 v12, s61, v198
    s_and_b32 s72, s54, 6
    s_mov_b32 s55, 0x00fffc38
    s_mov_b32 s49, 0xffffff00
    s_mov_b32 s51, 65536
    s_cmp_lt_u32 s3, 4
    s_cbranch_scc1 L_np
    s_setprio 1
L_np:
    s_waitcnt vmcnt(0) lgkmcnt(0)
    s_barrier
    ds_read_b32 v196, v12
    ds_read_b32 v194, v199
    ds_read_b32 v197, v198 offset:24
    s_cmp_eq_u32 s50, 0
    s_cbranch_scc1 L_swept
    s_waitcnt lgkmcnt(1)
    v_lshlrev_b32 v196, 3, v196
    v_and_b32 v196, s55, v196
    s_cmp_eq_u32 s72, 2
    s_cbranch_scc1 L_p2
    s_cmp_eq_u32 s72, 4
    s_cbranch_scc1 L_p4
    s_cmp_eq_u32 s72, 6
    s_cbranch_scc1 L_p6
L_p0:
    v_readlane_b32 s64, v196, 0
    v_readlane_b32 s65, v196, 1
    s_and_b32 s61, s64, s49
    buffer_load_dwordx4 v[96:99], v2, s[16:19], s61 offen
    s_and_b32 s61, s65, s49
    buffer_load_dwordx4 v[100:103], v2, s[16:19], s61 offen
L_p2:
    v_readlane_b32 s66, v196, 2
    v_readlane_b32 s67, v196, 3
    s_and_b32 s61, s66, s49
    buffer_load_dwordx4 v[104:107], v2, s[16:19], s61 offen
    s_and_b32 s61, s67, s49
    buffer_load_dwordx4 v[108:111], v2, s[16:19], s61 offen
L_p4:
    v_readlane_b32 s68, v196, 4
    v_readlane_b32 s69, v196, 5
    s_and_b32 s61, s68, s49
    buffer_load_dwordx4 v[112:115], v2, s[16:19], s61 offen
    s_and_b32 s61, s69, s49
    buffer_load_dwordx4 v[116:119], v2, s[16:19], s61 offen
    s_cmp_eq_u32 s72, 0
    s_cbranch_scc1 L_pd
L_p6:
    v_readlane_b32 s70, v196, 6
    v_readlane_b32 s71, v196, 7
    s_and_b32 s61, s70, s49
    buffer_load_dwordx4 v[120:123], v2, s[16:19], s61 offen
    s_and_b32 s61, s71, s49
    buffer_load_dwordx4 v[124:127], v2, s[16:19], s61 offen
    s_cmp_eq_u32 s72, 2
    s_cbranch_scc1 L_pd
L_p8:
    v_readlane_b32 s64, v196, 8
    v_readlane_b32 s65, v196, 9
    s_and_b32 s61, s64, s49
    buffer_load_dwordx4 v[96:99], v2, s[16:19], s61 offen
    s_and_b32 s61, s65, s49
    buffer_load_dwordx4 v[100:103], v2, s[16:19], s61 offen
    s_cmp_eq_u32 s72, 4
    s_cbranch_scc1 L_pd
L_p10:
    v_readlane_b32 s66, v196, 10
    v_readlane_b32 s67, v196, 11
    s_and_b32 s61, s66, s49
    buffer_load_dwordx4 v[104:107], v2, s[16:19], s61 offen
    s_and_b32 s61, s67, s49
    buffer_load_dwordx4 v[108:111], v2, s[16:19], s61 offen
L_pd:
    v_lshrrev_b32 v8, 21, v194
    v_lshl_add_u32 v11, v8, 3, s51
    v_lshl_add_u32 v8, v8, 5, v200
    ds_read_b64 v[192:193], v11
    s_mov_b64 exec, s[86:87]
    ds_read_b128 v[164:167], v8
    s_mov_b64 exec, s[88:89]
    ds_read_b128 v[168:171], v8
    s_mov_b64 exec, -1
    s_waitcnt lgkmcnt(0)
.p2align 3
    v_mfma_f32_4x4x4_16b_bf16 v[144:147], v[192:193], v[188:189], 0 cbsz:4 abid:0
    v_mfma_f32_4x4x4_16b_bf16 v[148:151], v[192:193], v[188:189], 0 cbsz:4 abid:2
    v_mfma_f32_4x4x4_16b_bf16 v[152:155], v[192:193], v[188:189], 0 cbsz:4 abid:4
    v_mfma_f32_4x4x4_16b_bf16 v[156:159], v[192:193], v[188:189], 0 cbsz:4 abid:6
    v_mfma_f32_32x32x16_bf16 v[64:79], v[164:167], v[172:175], 0
    v_lshlrev_b32 v196, 3, v197
    v_and_b32 v196, s55, v196
    v_add_u32 v198, 64, v198
    v_add_u32 v199, 64, v199
    v_mfma_f32_32x32x16_bf16 v[80:95], v[164:167], v[180:183], 0
    ds_read_b32 v197, v198 offset:24
    ds_read_b32 v194, v199
    v_mfma_f32_32x32x16_bf16 v[64:79], v[168:171], v[176:179], v[64:79]
    v_mfma_f32_32x32x16_bf16 v[80:95], v[168:171], v[184:187], v[80:95]
    s_set_gpr_idx_on s54, gpr_idx(SRC0,SRC1)
    v_cvt_pk_bf16_f32 v9, v144, v144
    s_set_gpr_idx_off
    v_and_b32 v160, v190, v9
    v_and_b32 v161, v191, v9
    s_waitcnt lgkmcnt(0)
    v_lshrrev_b32 v8, 21, v194
    v_lshl_add_u32 v11, v8, 3, s51
    v_lshl_add_u32 v8, v8, 5, v200
    ds_read_b64 v[192:193], v11
    s_mov_b64 exec, s[86:87]
    ds_read_b128 v[164:167], v8
    s_mov_b64 exec, s[88:89]
    ds_read_b128 v[168:171], v8
    s_mov_b64 exec, -1
    s_cmp_eq_u32 s53, 0
    s_cbranch_scc1 L_f0
    s_cmp_eq_u32 s54, 2
    s_cbranch_scc1 L_j2
    s_cmp_eq_u32 s54, 4
    s_cbranch_scc1 L_j4
    s_cmp_eq_u32 s54, 6
    s_cbranch_scc1 L_j6
    s_cmp_eq_u32 s54, 8
    s_cbranch_scc1 L_j8
    s_cmp_eq_u32 s54, 10
    s_cbranch_scc1 L_j10
    s_cmp_eq_u32 s54, 12
    s_cbranch_scc1 L_j12
    s_cmp_eq_u32 s54, 14
    s_cbranch_scc1 L_j14
    s_branch L_j0
.p2align 3
L_loop:
    s_waitcnt lgkmcnt(0)
.p2align 3
    v_mfma_f32_4x4x4_16b_bf16 v[144:147], v[192:193], v[188:189], 0 cbsz:4 abid:0
    v_mfma_f32_4x4x4_16b_bf16 v[148:151], v[192:193], v[188:189], 0 cbsz:4 abid:2
    v_mfma_f32_4x4x4_16b_bf16 v[152:155], v[192:193], v[188:189], 0 cbsz:4 abid:4
    v_mfma_f32_4x4x4_16b_bf16 v[156:159], v[192:193], v[188:189], 0 cbsz:4 abid:6
    v_mfma_f32_32x32x16_bf16 v[64:79], v[164:167], v[172:175], 0
    v_lshlrev_b32 v196, 3, v197
    v_and_b32 v196, s55, v196
    v_add_u32 v198, 64, v198
    v_add_u32 v199, 64, v199
    v_mfma_f32_32x32x16_bf16 v[80:95], v[164:167], v[180:183], 0
    ds_read_b32 v197, v198 offset:24
    ds_read_b32 v194, v199
    v_mfma_f32_32x32x16_bf16 v[64:79], v[168:171], v[176:179], v[64:79]
    v_cvt_pk_bf16_f32 v9, v144, v144
    v_and_b32 v160, v190, v9
    v_and_b32 v161, v191, v9
    v_mfma_f32_32x32x16_bf16 v[80:95], v[168:171], v[184:187], v[80:95]
L_j0:
    s_waitcnt vmcnt(5)
.p2align 3
    v_mfma_f32_16x16x16_bf16 v[128:131], v[160:161], v[96:97], 0
    v_readlane_b32 s70, v196, 0
    v_cvt_pk_bf16_f32 v10, v145, v145
    v_mfma_f32_16x16x16_bf16 v[132:135], v[160:161], v[98:99], 0
    v_and_b32 v162, v190, v10
    v_and_b32 v163, v191, v10
    s_and_b32 s61, s70, s49
    s_waitcnt vmcnt(4)
    buffer_load_dwordx4 v[120:123], v2, s[16:19], s61 offen
    v_mfma_f32_16x16x16_bf16 v[136:139], v[162:163], v[100:101], 0
    v_readlane_b32 s71, v196, 1
    v_cvt_pk_bf16_f32 v9, v146, v146
    v_mfma_f32_16x16x16_bf16 v[140:143], v[162:163], v[102:103], 0
    v_and_b32 v160, v190, v9
    v_and_b32 v161, v191, v9
    s_and_b32 s61, s71, s49
    s_set_gpr_idx_on s64, gpr_idx(SRC2,DST)
    buffer_load_dwordx4 v[124:127], v2, s[16:19], s61 offen
    v_pk_fma_f32 v[16:17], v[128:129], v[64:65], v[16:17] op_sel_hi:[1,0,1]
    v_pk_fma_f32 v[18:19], v[130:131], v[64:65], v[18:19] op_sel_hi:[1,0,1]
    v_pk_fma_f32 v[20:21], v[132:133], v[80:81], v[20:21] op_sel_hi:[1,0,1]
    v_pk_fma_f32 v[22:23], v[134:135], v[80:81], v[22:23] op_sel_hi:[1,0,1]
    s_set_gpr_idx_idx s65
.p2align 3
    v_pk_fma_f32 v[16:17], v[136:137], v[64:65], v[16:17] op_sel:[0,1,0] op_sel_hi:[1,1,1]
    v_pk_fma_f32 v[18:19], v[138:139], v[64:65], v[18:19] op_sel:[0,1,0] op_sel_hi:[1,1,1]
    v_pk_fma_f32 v[20:21], v[140:141], v[80:81], v[20:21] op_sel:[0,1,0] op_sel_hi:[1,1,1]
    v_pk_fma_f32 v[22:23], v[142:143], v[80:81], v[22:23] op_sel:[0,1,0] op_sel_hi:[1,1,1]
    s_set_gpr_idx_off
L_j2:
    s_waitcnt vmcnt(5)
.p2align 3
    v_mfma_f32_16x16x16_bf16 v[128:131], v[160:161], v[104:105], 0
    v_readlane_b32 s64, v196, 2
    v_cvt_pk_bf16_f32 v10, v147, v147
    v_mfma_f32_16x16x16_bf16 v[132:135], v[160:161], v[106:107], 0
    v_and_b32 v162, v190, v10
    v_and_b32 v163, v191, v10
    s_and_b32 s61, s64, s49
    s_waitcnt vmcnt(4)
    buffer_load_dwordx4 v[96:99], v2, s[16:19], s61 offen
    v_mfma_f32_16x16x16_bf16 v[136:139], v[162:163], v[108:109], 0
    v_readlane_b32 s65, v196, 3
    v_cvt_pk_bf16_f32 v9, v148, v148
    v_mfma_f32_16x16x16_bf16 v[140:143], v[162:163], v[110:111], 0
    v_and_b32 v160, v190, v9
    v_and_b32 v161, v191, v9
    s_waitcnt lgkmcnt(0)
    v_lshrrev_b32 v8, 21, v194
    v_lshl_add_u32 v11, v8, 3, s51
    v_lshl_add_u32 v8, v8, 5, v200
    ds_read_b64 v[192:193], v11
    s_mov_b64 exec, s[86:87]
    ds_read_b128 v[164:167], v8
    s_mov_b64 exec, s[88:89]
    ds_read_b128 v[168:171], v8
    s_mov_b64 exec, -1
.p2align 3
    s_and_b32 s61, s65, s49
    s_set_gpr_idx_on s66, gpr_idx(SRC2,DST)
    buffer_load_dwordx4 v[100:103], v2, s[16:19], s61 offen
    v_pk_fma_f32 v[16:17], v[128:129], v[66:67], v[16:17] op_sel_hi:[1,0,1]
    v_pk_fma_f32 v[18:19], v[130:131], v[66:67], v[18:19] op_sel_hi:[1,0,1]
    v_pk_fma_f32 v[20:21], v[132:133], v[82:83], v[20:21] op_sel_hi:[1,0,1]
    v_pk_fma_f32 v[22:23], v[134:135], v[82:83], v[22:23] op_sel_hi:[1,0,1]
    s_set_gpr_idx_idx s67
.p2align 3
    v_pk_fma_f32 v[16:17], v[136:137], v[66:67], v[16:17] op_sel:[0,1,0] op_sel_hi:[1,1,1]
    v_pk_fma_f32 v[18:19], v[138:139], v[66:67], v[18:19] op_sel:[0,1,0] op_sel_hi:[1,1,1]
    v_pk_fma_f32 v[20:21], v[140:141], v[82:83], v[20:21] op_sel:[0,1,0] op_sel_hi:[1,1,1]
    v_pk_fma_f32 v[22:23], v[142:143], v[82:83], v[22:23] op_sel:[0,1,0] op_sel_hi:[1,1,1]
    s_set_gpr_idx_off
L_j4:
    s_waitcnt vmcnt(5)
.p2align 3
    v_mfma_f32_16x16x16_bf16 v[128:131], v[160:161], v[112:113], 0
    v_readlane_b32 s66, v196, 4
    v_cvt_pk_bf16_f32 v10, v149, v149
    v_mfma_f32_16x16x16_bf16 v[132:135], v[160:161], v[114:115], 0
    v_and_b32 v162, v190, v10
    v_and_b32 v163, v191, v10
    s_and_b32 s61, s66, s49
    s_waitcnt vmcnt(4)
    buffer_load_dwordx4 v[104:107], v2, s[16:19], s61 offen
    v_mfma_f32_16x16x16_bf16 v[136:139], v[162:163], v[116:117], 0
    v_readlane_b32 s67, v196, 5
    v_cvt_pk_bf16_f32 v9, v150, v150
    v_mfma_f32_16x16x16_bf16 v[140:143], v[162:163], v[118:119], 0
    v_and_b32 v160, v190, v9
    v_and_b32 v161, v191, v9
    s_and_b32 s61, s67, s49
    s_set_gpr_idx_on s68, gpr_idx(SRC2,DST)
    buffer_load_dwordx4 v[108:111], v2, s[16:19], s61 offen
    v_pk_fma_f32 v[16:17], v[128:129], v[68:69], v[16:17] op_sel_hi:[1,0,1]
    v_pk_fma_f32 v[18:19], v[130:131], v[68:69], v[18:19] op_sel_hi:[1,0,1]
    v_pk_fma_f32 v[20:21], v[132:133], v[84:85], v[20:21] op_sel_hi:[1,0,1]
    v_pk_fma_f32 v[22:23], v[134:135], v[84:85], v[22:23] op_sel_hi:[1,0,1]
    s_set_gpr_idx_idx s69
.p2align 3
    v_pk_fma_f32 v[16:17], v[136:137], v[68:69], v[16:17] op_sel:[0,1,0] op_sel_hi:[1,1,1]
    v_pk_fma_f32 v[18:19], v[138:139], v[68:69], v[18:19] op_sel:[0,1,0] op_sel_hi:[1,1,1]
    v_pk_fma_f32 v[20:21], v[140:141], v[84:85], v[20:21] op_sel:[0,1,0] op_sel_hi:[1,1,1]
    v_pk_fma_f32 v[22:23], v[142:143], v[84:85], v[22:23] op_sel:[0,1,0] op_sel_hi:[1,1,1]
    s_set_gpr_idx_off
L_j6:
    s_waitcnt vmcnt(5)
.p2align 3
    v_mfma_f32_16x16x16_bf16 v[128:131], v[160:161], v[120:121], 0
    v_readlane_b32 s68, v196, 6
    v_cvt_pk_bf16_f32 v10, v151, v151
    v_mfma_f32_16x16x16_bf16 v[132:135], v[160:161], v[122:123], 0
    v_and_b32 v162, v190, v10
    v_and_b32 v163, v191, v10
    s_and_b32 s61, s68, s49
    s_waitcnt vmcnt(4)
    buffer_load_dwordx4 v[112:115], v2, s[16:19], s61 offen
    v_mfma_f32_16x16x16_bf16 v[136:139], v[162:163], v[124:125], 0
    v_readlane_b32 s69, v196, 7
    v_cvt_pk_bf16_f32 v9, v152, v152
    v_mfma_f32_16x16x16_bf16 v[140:143], v[162:163], v[126:127], 0
    v_and_b32 v160, v190, v9
    v_and_b32 v161, v191, v9
    s_and_b32 s61, s69, s49
    s_set_gpr_idx_on s70, gpr_idx(SRC2,DST)
    buffer_load_dwordx4 v[116:119], v2, s[16:19], s61 offen
    v_pk_fma_f32 v[16:17], v[128:129], v[70:71], v[16:17] op_sel_hi:[1,0,1]
    v_pk_fma_f32 v[18:19], v[130:131], v[70:71], v[18:19] op_sel_hi:[1,0,1]
    v_pk_fma_f32 v[20:21], v[132:133], v[86:87], v[20:21] op_sel_hi:[1,0,1]
    v_pk_fma_f32 v[22:23], v[134:135], v[86:87], v[22:23] op_sel_hi:[1,0,1]
    s_set_gpr_idx_idx s71
.p2align 3
    v_pk_fma_f32 v[16:17], v[136:137], v[70:71], v[16:17] op_sel:[0,1,0] op_sel_hi:[1,1,1]
    v_pk_fma_f32 v[18:19], v[138:139], v[70:71], v[18:19] op_sel:[0,1,0] op_sel_hi:[1,1,1]
    v_pk_fma_f32 v[20:21], v[140:141], v[86:87], v[20:21] op_sel:[0,1,0] op_sel_hi:[1,1,1]
    v_pk_fma_f32 v[22:23], v[142:143], v[86:87], v[22:23] op_sel:[0,1,0] op_sel_hi:[1,1,1]
    s_set_gpr_idx_off
L_j8:
    s_waitcnt vmcnt(5)
.p2align 3
    v_mfma_f32_16x16x16_bf16 v[128:131], v[160:161], v[96:97], 0
    v_readlane_b32 s70, v196, 8
    v_cvt_pk_bf16_f32 v10, v153, v153
    v_mfma_f32_16x16x16_bf16 v[132:135], v[160:161], v[98:99], 0
    v_and_b32 v162, v190, v10
    v_and_b32 v163, v191, v10
    s_and_b32 s61, s70, s49
    s_waitcnt vmcnt(4)
    buffer_load_dwordx4 v[120:123], v2, s[16:19], s61 offen
    v_mfma_f32_16x16x16_bf16 v[136:139], v[162:163], v[100:101], 0
    v_readlane_b32 s71, v196, 9
    v_cvt_pk_bf16_f32 v9, v154, v154
    v_mfma_f32_16x16x16_bf16 v[140:143], v[162:163], v[102:103], 0
    v_and_b32 v160, v190, v9
    v_and_b32 v161, v191, v9
    s_and_b32 s61, s71, s49
    s_set_gpr_idx_on s64, gpr_idx(SRC2,DST)
    buffer_load_dwordx4 v[124:127], v2, s[16:19], s61 offen
    v_pk_fma_f32 v[16:17], v[128:129], v[72:73], v[16:17] op_sel_hi:[1,0,1]
    v_pk_fma_f32 v[18:19], v[130:131], v[72:73], v[18:19] op_sel_hi:[1,0,1]
    v_pk_fma_f32 v[20:21], v[132:133], v[88:89], v[20:21] op_sel_hi:[1,0,1]
    v_pk_fma_f32 v[22:23], v[134:135], v[88:89], v[22:23] op_sel_hi:[1,0,1]
    s_set_gpr_idx_idx s65
.p2align 3
    v_pk_fma_f32 v[16:17], v[136:137], v[72:73], v[16:17] op_sel:[0,1,0] op_sel_hi:[1,1,1]
    v_pk_fma_f32 v[18:19], v[138:139], v[72:73], v[18:19] op_sel:[0,1,0] op_sel_hi:[1,1,1]
    v_pk_fma_f32 v[20:21], v[140:141], v[88:89], v[20:21] op_sel:[0,1,0] op_sel_hi:[1,1,1]
    v_pk_fma_f32 v[22:23], v[142:143], v[88:89], v[22:23] op_sel:[0,1,0] op_sel_hi:[1,1,1]
    s_set_gpr_idx_off
L_j10:
    s_waitcnt vmcnt(5)
.p2align 3
    v_mfma_f32_16x16x16_bf16 v[128:131], v[160:161], v[104:105], 0
    v_readlane_b32 s64, v196, 10
    v_cvt_pk_bf16_f32 v10, v155, v155
    v_mfma_f32_16x16x16_bf16 v[132:135], v[160:161], v[106:107], 0
    v_and_b32 v162, v190, v10
    v_and_b32 v163, v191, v10
    s_and_b32 s61, s64, s49
    s_waitcnt vmcnt(4)
    buffer_load_dwordx4 v[96:99], v2, s[16:19], s61 offen
    v_mfma_f32_16x16x16_bf16 v[136:139], v[162:163], v[108:109], 0
    v_readlane_b32 s65, v196, 11
    v_cvt_pk_bf16_f32 v9, v156, v156
    v_mfma_f32_16x16x16_bf16 v[140:143], v[162:163], v[110:111], 0
    v_and_b32 v160, v190, v9
    v_and_b32 v161, v191, v9
    s_and_b32 s61, s65, s49
    s_set_gpr_idx_on s66, gpr_idx(SRC2,DST)
    buffer_load_dwordx4 v[100:103], v2, s[16:19], s61 offen
    v_pk_fma_f32 v[16:17], v[128:129], v[74:75], v[16:17] op_sel_hi:[1,0,1]
    v_pk_fma_f32 v[18:19], v[130:131], v[74:75], v[18:19] op_sel_hi:[1,0,1]
    v_pk_fma_f32 v[20:21], v[132:133], v[90:91], v[20:21] op_sel_hi:[1,0,1]
    v_pk_fma_f32 v[22:23], v[134:135], v[90:91], v[22:23] op_sel_hi:[1,0,1]
    s_set_gpr_idx_idx s67
.p2align 3
    v_pk_fma_f32 v[16:17], v[136:137], v[74:75], v[16:17] op_sel:[0,1,0] op_sel_hi:[1,1,1]
    v_pk_fma_f32 v[18:19], v[138:139], v[74:75], v[18:19] op_sel:[0,1,0] op_sel_hi:[1,1,1]
    v_pk_fma_f32 v[20:21], v[140:141], v[90:91], v[20:21] op_sel:[0,1,0] op_sel_hi:[1,1,1]
    v_pk_fma_f32 v[22:23], v[142:143], v[90:91], v[22:23] op_sel:[0,1,0] op_sel_hi:[1,1,1]
    s_set_gpr_idx_off
L_j12:
    s_waitcnt vmcnt(5)
.p2align 3
    v_mfma_f32_16x16x16_bf16 v[128:131], v[160:161], v[112:113], 0
    v_readlane_b32 s66, v196, 12
    v_cvt_pk_bf16_f32 v10, v157, v157
    v_mfma_f32_16x16x16_bf16 v[132:135], v[160:161], v[114:115], 0
    v_and_b32 v162, v190, v10
    v_and_b32 v163, v191, v10
    s_and_b32 s61, s66, s49
    s_waitcnt vmcnt(4)
    buffer_load_dwordx4 v[104:107], v2, s[16:19], s61 offen
    v_mfma_f32_16x16x16_bf16 v[136:139], v[162:163], v[116:117], 0
    v_readlane_b32 s67, v196, 13
    v_cvt_pk_bf16_f32 v9, v158, v158
    v_mfma_f32_16x16x16_bf16 v[140:143], v[162:163], v[118:119], 0
    v_and_b32 v160, v190, v9
    v_and_b32 v161, v191, v9
    s_and_b32 s61, s67, s49
    s_set_gpr_idx_on s68, gpr_idx(SRC2,DST)
    buffer_load_dwordx4 v[108:111], v2, s[16:19], s61 offen
    v_pk_fma_f32 v[16:17], v[128:129], v[76:77], v[16:17] op_sel_hi:[1,0,1]
    v_pk_fma_f32 v[18:19], v[130:131], v[76:77], v[18:19] op_sel_hi:[1,0,1]
    v_pk_fma_f32 v[20:21], v[132:133], v[92:93], v[20:21] op_sel_hi:[1,0,1]
    v_pk_fma_f32 v[22:23], v[134:135], v[92:93], v[22:23] op_sel_hi:[1,0,1]
    s_set_gpr_idx_idx s69
.p2align 3
    v_pk_fma_f32 v[16:17], v[136:137], v[76:77], v[16:17] op_sel:[0,1,0] op_sel_hi:[1,1,1]
    v_pk_fma_f32 v[18:19], v[138:139], v[76:77], v[18:19] op_sel:[0,1,0] op_sel_hi:[1,1,1]
    v_pk_fma_f32 v[20:21], v[140:141], v[92:93], v[20:21] op_sel:[0,1,0] op_sel_hi:[1,1,1]
    v_pk_fma_f32 v[22:23], v[142:143], v[92:93], v[22:23] op_sel:[0,1,0] op_sel_hi:[1,1,1]
    s_set_gpr_idx_off
L_j14:
    s_waitcnt vmcnt(5)
.p2align 3
    v_mfma_f32_16x16x16_bf16 v[128:131], v[160:161], v[120:121], 0
    v_readlane_b32 s68, v196, 14
    v_cvt_pk_bf16_f32 v10, v159, v159
    v_mfma_f32_16x16x16_bf16 v[132:135], v[160:161], v[122:123], 0
    v_and_b32 v162, v190, v10
    v_and_b32 v163, v191, v10
    s_and_b32 s61, s68, s49
    s_waitcnt vmcnt(4)
    buffer_load_dwordx4 v[112:115], v2, s[16:19], s61 offen
    v_mfma_f32_16x16x16_bf16 v[136:139], v[162:163], v[124:125], 0
    v_readlane_b32 s69, v196, 15
    v_mfma_f32_16x16x16_bf16 v[140:143], v[162:163], v[126:127], 0
    s_and_b32 s61, s69, s49
    s_set_gpr_idx_on s70, gpr_idx(SRC2,DST)
    buffer_load_dwordx4 v[116:119], v2, s[16:19], s61 offen
    v_pk_fma_f32 v[16:17], v[128:129], v[78:79], v[16:17] op_sel_hi:[1,0,1]
    v_pk_fma_f32 v[18:19], v[130:131], v[78:79], v[18:19] op_sel_hi:[1,0,1]
    v_pk_fma_f32 v[20:21], v[132:133], v[94:95], v[20:21] op_sel_hi:[1,0,1]
    v_pk_fma_f32 v[22:23], v[134:135], v[94:95], v[22:23] op_sel_hi:[1,0,1]
    s_set_gpr_idx_idx s71
    s_sub_u32 s53, s53, 1
.p2align 3
    v_pk_fma_f32 v[16:17], v[136:137], v[78:79], v[16:17] op_sel:[0,1,0] op_sel_hi:[1,1,1]
    v_pk_fma_f32 v[18:19], v[138:139], v[78:79], v[18:19] op_sel:[0,1,0] op_sel_hi:[1,1,1]
    v_pk_fma_f32 v[20:21], v[140:141], v[94:95], v[20:21] op_sel:[0,1,0] op_sel_hi:[1,1,1]
    v_pk_fma_f32 v[22:23], v[142:143], v[94:95], v[22:23] op_sel:[0,1,0] op_sel_hi:[1,1,1]
    s_set_gpr_idx_off
    s_cmp_lg_u32 s53, 0
    s_cbranch_scc1 L_loop
    s_waitcnt lgkmcnt(0)
.p2align 3
    v_mfma_f32_4x4x4_16b_bf16 v[144:147], v[192:193], v[188:189], 0 cbsz:4 abid:0
    v_mfma_f32_4x4x4_16b_bf16 v[148:151], v[192:193], v[188:189], 0 cbsz:4 abid:2
    v_mfma_f32_4x4x4_16b_bf16 v[152:155], v[192:193], v[188:189], 0 cbsz:4 abid:4
    v_mfma_f32_4x4x4_16b_bf16 v[156:159], v[192:193], v[188:189], 0 cbsz:4 abid:6
    v_mfma_f32_32x32x16_bf16 v[64:79], v[164:167], v[172:175], 0
    v_lshlrev_b32 v196, 3, v197
    v_and_b32 v196, s55, v196
    v_mfma_f32_32x32x16_bf16 v[80:95], v[164:167], v[180:183], 0
    v_mfma_f32_32x32x16_bf16 v[64:79], v[168:171], v[176:179], v[64:79]
    v_cvt_pk_bf16_f32 v9, v144, v144
    v_and_b32 v160, v190, v9
    v_and_b32 v161, v191, v9
    v_mfma_f32_32x32x16_bf16 v[80:95], v[168:171], v[184:187], v[80:95]
L_f0:
    s_waitcnt vmcnt(5)
.p2align 3
    v_mfma_f32_16x16x16_bf16 v[128:131], v[160:161], v[96:97], 0
    v_readlane_b32 s70, v196, 0
    v_cvt_pk_bf16_f32 v10, v145, v145
    v_mfma_f32_16x16x16_bf16 v[132:135], v[160:161], v[98:99], 0
    v_and_b32 v162, v190, v10
    v_and_b32 v163, v191, v10
    s_and_b32 s61, s70, s49
    s_waitcnt vmcnt(4)
    buffer_load_dwordx4 v[120:123], v2, s[16:19], s61 offen
    v_mfma_f32_16x16x16_bf16 v[136:139], v[162:163], v[100:101], 0
    v_readlane_b32 s71, v196, 1
    v_cvt_pk_bf16_f32 v9, v146, v146
    v_mfma_f32_16x16x16_bf16 v[140:143], v[162:163], v[102:103], 0
    v_and_b32 v160, v190, v9
    v_and_b32 v161, v191, v9
    s_and_b32 s61, s71, s49
    s_set_gpr_idx_on s64, gpr_idx(SRC2,DST)
    buffer_load_dwordx4 v[124:127], v2, s[16:19], s61 offen
    v_pk_fma_f32 v[16:17], v[128:129], v[64:65], v[16:17] op_sel_hi:[1,0,1]
    v_pk_fma_f32 v[18:19], v[130:131], v[64:65], v[18:19] op_sel_hi:[1,0,1]
    v_pk_fma_f32 v[20:21], v[132:133], v[80:81], v[20:21] op_sel_hi:[1,0,1]
    v_pk_fma_f32 v[22:23], v[134:135], v[80:81], v[22:23] op_sel_hi:[1,0,1]
    s_set_gpr_idx_idx s65
.p2align 3
    v_pk_fma_f32 v[16:17], v[136:137], v[64:65], v[16:17] op_sel:[0,1,0] op_sel_hi:[1,1,1]
    v_pk_fma_f32 v[18:19], v[138:139], v[64:65], v[18:19] op_sel:[0,1,0] op_sel_hi:[1,1,1]
    v_pk_fma_f32 v[20:21], v[140:141], v[80:81], v[20:21] op_sel:[0,1,0] op_sel_hi:[1,1,1]
    v_pk_fma_f32 v[22:23], v[142:143], v[80:81], v[22:23] op_sel:[0,1,0] op_sel_hi:[1,1,1]
    s_set_gpr_idx_off
    s_waitcnt vmcnt(5)
.p2align 3
    v_mfma_f32_16x16x16_bf16 v[128:131], v[160:161], v[104:105], 0
    v_readlane_b32 s64, v196, 2
    v_cvt_pk_bf16_f32 v10, v147, v147
    v_mfma_f32_16x16x16_bf16 v[132:135], v[160:161], v[106:107], 0
    v_and_b32 v162, v190, v10
    v_and_b32 v163, v191, v10
    s_and_b32 s61, s64, s49
    s_waitcnt vmcnt(4)
    buffer_load_dwordx4 v[96:99], v2, s[16:19], s61 offen
    v_mfma_f32_16x16x16_bf16 v[136:139], v[162:163], v[108:109], 0
    v_readlane_b32 s65, v196, 3
    v_cvt_pk_bf16_f32 v9, v148, v148
    v_mfma_f32_16x16x16_bf16 v[140:143], v[162:163], v[110:111], 0
    v_and_b32 v160, v190, v9
    v_and_b32 v161, v191, v9
    s_and_b32 s61, s65, s49
    s_set_gpr_idx_on s66, gpr_idx(SRC2,DST)
    buffer_load_dwordx4 v[100:103], v2, s[16:19], s61 offen
    v_pk_fma_f32 v[16:17], v[128:129], v[66:67], v[16:17] op_sel_hi:[1,0,1]
    v_pk_fma_f32 v[18:19], v[130:131], v[66:67], v[18:19] op_sel_hi:[1,0,1]
    v_pk_fma_f32 v[20:21], v[132:133], v[82:83], v[20:21] op_sel_hi:[1,0,1]
    v_pk_fma_f32 v[22:23], v[134:135], v[82:83], v[22:23] op_sel_hi:[1,0,1]
    s_set_gpr_idx_idx s67
.p2align 3
    v_pk_fma_f32 v[16:17], v[136:137], v[66:67], v[16:17] op_sel:[0,1,0] op_sel_hi:[1,1,1]
    v_pk_fma_f32 v[18:19], v[138:139], v[66:67], v[18:19] op_sel:[0,1,0] op_sel_hi:[1,1,1]
    v_pk_fma_f32 v[20:21], v[140:141], v[82:83], v[20:21] op_sel:[0,1,0] op_sel_hi:[1,1,1]
    v_pk_fma_f32 v[22:23], v[142:143], v[82:83], v[22:23] op_sel:[0,1,0] op_sel_hi:[1,1,1]
    s_set_gpr_idx_off
    s_waitcnt vmcnt(5)
.p2align 3
    v_mfma_f32_16x16x16_bf16 v[128:131], v[160:161], v[112:113], 0
    v_readlane_b32 s66, v196, 4
    v_cvt_pk_bf16_f32 v10, v149, v149
    v_mfma_f32_16x16x16_bf16 v[132:135], v[160:161], v[114:115], 0
    v_and_b32 v162, v190, v10
    v_and_b32 v163, v191, v10
    s_and_b32 s61, s66, s49
    s_waitcnt vmcnt(4)
    buffer_load_dwordx4 v[104:107], v2, s[16:19], s61 offen
    v_mfma_f32_16x16x16_bf16 v[136:139], v[162:163], v[116:117], 0
    v_readlane_b32 s67, v196, 5
    v_cvt_pk_bf16_f32 v9, v150, v150
    v_mfma_f32_16x16x16_bf16 v[140:143], v[162:163], v[118:119], 0
    v_and_b32 v160, v190, v9
    v_and_b32 v161, v191, v9
    s_and_b32 s61, s67, s49
    s_set_gpr_idx_on s68, gpr_idx(SRC2,DST)
    buffer_load_dwordx4 v[108:111], v2, s[16:19], s61 offen
    v_pk_fma_f32 v[16:17], v[128:129], v[68:69], v[16:17] op_sel_hi:[1,0,1]
    v_pk_fma_f32 v[18:19], v[130:131], v[68:69], v[18:19] op_sel_hi:[1,0,1]
    v_pk_fma_f32 v[20:21], v[132:133], v[84:85], v[20:21] op_sel_hi:[1,0,1]
    v_pk_fma_f32 v[22:23], v[134:135], v[84:85], v[22:23] op_sel_hi:[1,0,1]
    s_set_gpr_idx_idx s69
.p2align 3
    v_pk_fma_f32 v[16:17], v[136:137], v[68:69], v[16:17] op_sel:[0,1,0] op_sel_hi:[1,1,1]
    v_pk_fma_f32 v[18:19], v[138:139], v[68:69], v[18:19] op_sel:[0,1,0] op_sel_hi:[1,1,1]
    v_pk_fma_f32 v[20:21], v[140:141], v[84:85], v[20:21] op_sel:[0,1,0] op_sel_hi:[1,1,1]
    v_pk_fma_f32 v[22:23], v[142:143], v[84:85], v[22:23] op_sel:[0,1,0] op_sel_hi:[1,1,1]
    s_set_gpr_idx_off
    s_waitcnt vmcnt(5)
.p2align 3
    v_mfma_f32_16x16x16_bf16 v[128:131], v[160:161], v[120:121], 0
    v_readlane_b32 s68, v196, 6
    v_cvt_pk_bf16_f32 v10, v151, v151
    v_mfma_f32_16x16x16_bf16 v[132:135], v[160:161], v[122:123], 0
    v_and_b32 v162, v190, v10
    v_and_b32 v163, v191, v10
    s_and_b32 s61, s68, s49
    s_waitcnt vmcnt(4)
    buffer_load_dwordx4 v[112:115], v2, s[16:19], s61 offen
    v_mfma_f32_16x16x16_bf16 v[136:139], v[162:163], v[124:125], 0
    v_readlane_b32 s69, v196, 7
    v_cvt_pk_bf16_f32 v9, v152, v152
    v_mfma_f32_16x16x16_bf16 v[140:143], v[162:163], v[126:127], 0
    v_and_b32 v160, v190, v9
    v_and_b32 v161, v191, v9
    s_and_b32 s61, s69, s49
    s_set_gpr_idx_on s70, gpr_idx(SRC2,DST)
    buffer_load_dwordx4 v[116:119], v2, s[16:19], s61 offen
    v_pk_fma_f32 v[16:17], v[128:129], v[70:71], v[16:17] op_sel_hi:[1,0,1]
    v_pk_fma_f32 v[18:19], v[130:131], v[70:71], v[18:19] op_sel_hi:[1,0,1]
    v_pk_fma_f32 v[20:21], v[132:133], v[86:87], v[20:21] op_sel_hi:[1,0,1]
    v_pk_fma_f32 v[22:23], v[134:135], v[86:87], v[22:23] op_sel_hi:[1,0,1]
    s_set_gpr_idx_idx s71
.p2align 3
    v_pk_fma_f32 v[16:17], v[136:137], v[70:71], v[16:17] op_sel:[0,1,0] op_sel_hi:[1,1,1]
    v_pk_fma_f32 v[18:19], v[138:139], v[70:71], v[18:19] op_sel:[0,1,0] op_sel_hi:[1,1,1]
    v_pk_fma_f32 v[20:21], v[140:141], v[86:87], v[20:21] op_sel:[0,1,0] op_sel_hi:[1,1,1]
    v_pk_fma_f32 v[22:23], v[142:143], v[86:87], v[22:23] op_sel:[0,1,0] op_sel_hi:[1,1,1]
    s_set_gpr_idx_off
    s_waitcnt vmcnt(5)
.p2align 3
    v_mfma_f32_16x16x16_bf16 v[128:131], v[160:161], v[96:97], 0
    v_readlane_b32 s70, v196, 8
    v_cvt_pk_bf16_f32 v10, v153, v153
    v_mfma_f32_16x16x16_bf16 v[132:135], v[160:161], v[98:99], 0
    v_and_b32 v162, v190, v10
    v_and_b32 v163, v191, v10
    s_and_b32 s61, s70, s49
    s_waitcnt vmcnt(4)
    buffer_load_dwordx4 v[120:123], v2, s[16:19], s61 offen
    v_mfma_f32_16x16x16_bf16 v[136:139], v[162:163], v[100:101], 0
    v_readlane_b32 s71, v196, 9
    v_cvt_pk_bf16_f32 v9, v154, v154
    v_mfma_f32_16x16x16_bf16 v[140:143], v[162:163], v[102:103], 0
    v_and_b32 v160, v190, v9
    v_and_b32 v161, v191, v9
    s_and_b32 s61, s71, s49
    s_set_gpr_idx_on s64, gpr_idx(SRC2,DST)
    buffer_load_dwordx4 v[124:127], v2, s[16:19], s61 offen
    v_pk_fma_f32 v[16:17], v[128:129], v[72:73], v[16:17] op_sel_hi:[1,0,1]
    v_pk_fma_f32 v[18:19], v[130:131], v[72:73], v[18:19] op_sel_hi:[1,0,1]
    v_pk_fma_f32 v[20:21], v[132:133], v[88:89], v[20:21] op_sel_hi:[1,0,1]
    v_pk_fma_f32 v[22:23], v[134:135], v[88:89], v[22:23] op_sel_hi:[1,0,1]
    s_set_gpr_idx_idx s65
.p2align 3
    v_pk_fma_f32 v[16:17], v[136:137], v[72:73], v[16:17] op_sel:[0,1,0] op_sel_hi:[1,1,1]
    v_pk_fma_f32 v[18:19], v[138:139], v[72:73], v[18:19] op_sel:[0,1,0] op_sel_hi:[1,1,1]
    v_pk_fma_f32 v[20:21], v[140:141], v[88:89], v[20:21] op_sel:[0,1,0] op_sel_hi:[1,1,1]
    v_pk_fma_f32 v[22:23], v[142:143], v[88:89], v[22:23] op_sel:[0,1,0] op_sel_hi:[1,1,1]
    s_set_gpr_idx_off
    s_waitcnt vmcnt(5)
.p2align 3
    v_mfma_f32_16x16x16_bf16 v[128:131], v[160:161], v[104:105], 0
    v_cvt_pk_bf16_f32 v10, v155, v155
    v_mfma_f32_16x16x16_bf16 v[132:135], v[160:161], v[106:107], 0
    v_and_b32 v162, v190, v10
    v_and_b32 v163, v191, v10
    s_waitcnt vmcnt(4)
.p2align 3
    s_nop 0
    v_mfma_f32_16x16x16_bf16 v[136:139], v[162:163], v[108:109], 0
    v_cvt_pk_bf16_f32 v9, v156, v156
    v_mfma_f32_16x16x16_bf16 v[140:143], v[162:163], v[110:111], 0
    v_and_b32 v160, v190, v9
    v_and_b32 v161, v191, v9
    s_set_gpr_idx_on s66, gpr_idx(SRC2,DST)
.p2align 3
    v_pk_fma_f32 v[16:17], v[128:129], v[74:75], v[16:17] op_sel_hi:[1,0,1]
    v_pk_fma_f32 v[18:19], v[130:131], v[74:75], v[18:19] op_sel_hi:[1,0,1]
    v_pk_fma_f32 v[20:21], v[132:133], v[90:91], v[20:21] op_sel_hi:[1,0,1]
    v_pk_fma_f32 v[22:23], v[134:135], v[90:91], v[22:23] op_sel_hi:[1,0,1]
    s_set_gpr_idx_idx s67
.p2align 3
    v_pk_fma_f32 v[16:17], v[136:137], v[74:75], v[16:17] op_sel:[0,1,0] op_sel_hi:[1,1,1]
    v_pk_fma_f32 v[18:19], v[138:139], v[74:75], v[18:19] op_sel:[0,1,0] op_sel_hi:[1,1,1]
    v_pk_fma_f32 v[20:21], v[140:141], v[90:91], v[20:21] op_sel:[0,1,0] op_sel_hi:[1,1,1]
    v_pk_fma_f32 v[22:23], v[142:143], v[90:91], v[22:23] op_sel:[0,1,0] op_sel_hi:[1,1,1]
    s_set_gpr_idx_off
    s_waitcnt vmcnt(3)
.p2align 3
    v_mfma_f32_16x16x16_bf16 v[128:131], v[160:161], v[112:113], 0
    v_cvt_pk_bf16_f32 v10, v157, v157
    v_mfma_f32_16x16x16_bf16 v[132:135], v[160:161], v[114:115], 0
    v_and_b32 v162, v190, v10
    v_and_b32 v163, v191, v10
    s_waitcnt vmcnt(2)
.p2align 3
    s_nop 0
    v_mfma_f32_16x16x16_bf16 v[136:139], v[162:163], v[116:117], 0
    v_cvt_pk_bf16_f32 v9, v158, v158
    v_mfma_f32_16x16x16_bf16 v[140:143], v[162:163], v[118:119], 0
    v_and_b32 v160, v190, v9
    v_and_b32 v161, v191, v9
    s_set_gpr_idx_on s68, gpr_idx(SRC2,DST)
.p2align 3
    v_pk_fma_f32 v[16:17], v[128:129], v[76:77], v[16:17] op_sel_hi:[1,0,1]
    v_pk_fma_f32 v[18:19], v[130:131], v[76:77], v[18:19] op_sel_hi:[1,0,1]
    v_pk_fma_f32 v[20:21], v[132:133], v[92:93], v[20:21] op_sel_hi:[1,0,1]
    v_pk_fma_f32 v[22:23], v[134:135], v[92:93], v[22:23] op_sel_hi:[1,0,1]
    s_set_gpr_idx_idx s69
.p2align 3
    v_pk_fma_f32 v[16:17], v[136:137], v[76:77], v[16:17] op_sel:[0,1,0] op_sel_hi:[1,1,1]
    v_pk_fma_f32 v[18:19], v[138:139], v[76:77], v[18:19] op_sel:[0,1,0] op_sel_hi:[1,1,1]
    v_pk_fma_f32 v[20:21], v[140:141], v[92:93], v[20:21] op_sel:[0,1,0] op_sel_hi:[1,1,1]
    v_pk_fma_f32 v[22:23], v[142:143], v[92:93], v[22:23] op_sel:[0,1,0] op_sel_hi:[1,1,1]
    s_set_gpr_idx_off
    s_waitcnt vmcnt(1)
.p2align 3
    v_mfma_f32_16x16x16_bf16 v[128:131], v[160:161], v[120:121], 0
    v_cvt_pk_bf16_f32 v10, v159, v159
    v_mfma_f32_16x16x16_bf16 v[132:135], v[160:161], v[122:123], 0
    v_and_b32 v162, v190, v10
    v_and_b32 v163, v191, v10
    s_waitcnt vmcnt(0)
.p2align 3
    s_nop 0
    v_mfma_f32_16x16x16_bf16 v[136:139], v[162:163], v[124:125], 0
    v_mfma_f32_16x16x16_bf16 v[140:143], v[162:163], v[126:127], 0
    s_set_gpr_idx_on s70, gpr_idx(SRC2,DST)
.p2align 3
    v_pk_fma_f32 v[16:17], v[128:129], v[78:79], v[16:17] op_sel_hi:[1,0,1]
    v_pk_fma_f32 v[18:19], v[130:131], v[78:79], v[18:19] op_sel_hi:[1,0,1]
    v_pk_fma_f32 v[20:21], v[132:133], v[94:95], v[20:21] op_sel_hi:[1,0,1]
    v_pk_fma_f32 v[22:23], v[134:135], v[94:95], v[22:23] op_sel_hi:[1,0,1]
    s_set_gpr_idx_idx s71
.p2align 3
    s_nop 0
    v_pk_fma_f32 v[16:17], v[136:137], v[78:79], v[16:17] op_sel:[0,1,0] op_sel_hi:[1,1,1]
    v_pk_fma_f32 v[18:19], v[138:139], v[78:79], v[18:19] op_sel:[0,1,0] op_sel_hi:[1,1,1]
    v_pk_fma_f32 v[20:21], v[140:141], v[94:95], v[20:21] op_sel:[0,1,0] op_sel_hi:[1,1,1]
    v_pk_fma_f32 v[22:23], v[142:143], v[94:95], v[22:23] op_sel:[0,1,0] op_sel_hi:[1,1,1]
    s_set_gpr_idx_off
L_swept:
    s_add_u32 s48, s48, 256
    s_cmp_lt_u32 s48, s47
    s_cbranch_scc1 L_again
    v_lshlrev_b32 v8, 2, v1
    s_mul_i32 s54, s56, 9
    v_cvt_pk_bf16_f32 v64, v16, v20
    v_cvt_pk_bf16_f32 v65, v17, v21
    v_cvt_pk_bf16_f32 v66, v18, v22
    v_cvt_pk_bf16_f32 v67, v19, v23
    v_add_u32 v84, s54, v8
    ds_write2_b32 v84, v64, v65 offset0:0 offset1:72
    ds_write2_b32 v84, v66, v67 offset0:144 offset1:216
    s_mul_i32 s54, s57, 9
    v_cvt_pk_bf16_f32 v68, v24, v28
    v_cvt_pk_bf16_f32 v69, v25, v29
    v_cvt_pk_bf16_f32 v70, v26, v30
    v_cvt_pk_bf16_f32 v71, v27, v31
    v_add_u32 v85, s54, v8
    ds_write2_b32 v85, v68, v69 offset0:0 offset1:72
    ds_write2_b32 v85, v70, v71 offset0:144 offset1:216
    s_mul_i32 s54, s58, 9
    v_cvt_pk_bf16_f32 v72, v32, v36
    v_cvt_pk_bf16_f32 v73, v33, v37
    v_cvt_pk_bf16_f32 v74, v34, v38
    v_cvt_pk_bf16_f32 v75, v35, v39
    v_add_u32 v86, s54, v8
    ds_write2_b32 v86, v72, v73 offset0:0 offset1:72
    ds_write2_b32 v86, v74, v75 offset0:144 offset1:216
    s_mul_i32 s54, s59, 9
    v_cvt_pk_bf16_f32 v76, v40, v44
    v_cvt_pk_bf16_f32 v77, v41, v45
    v_cvt_pk_bf16_f32 v78, v42, v46
    v_cvt_pk_bf16_f32 v79, v43, v47
    v_add_u32 v87, s54, v8
    ds_write2_b32 v87, v76, v77 offset0:0 offset1:72
    ds_write2_b32 v87, v78, v79 offset0:144 offset1:216
    s_mul_i32 s54, s60, 9
    v_cvt_pk_bf16_f32 v80, v48, v52
    v_cvt_pk_bf16_f32 v81, v49, v53
    v_cvt_pk_bf16_f32 v82, v50, v54
    v_cvt_pk_bf16_f32 v83, v51, v55
    v_add_u32 v88, s54, v8
    ds_write2_b32 v88, v80, v81 offset0:0 offset1:72
    ds_write2_b32 v88, v82, v83 offset0:144 offset1:216
    v_and_b32 v8, 15, v1
    v_lshrrev_b32 v9, 4, v1
    s_lshr_b32 s54, s3, 2
    s_mul_i32 s55, s54, 23040
    v_mul_u32_u24 v10, 288, v8
    v_lshl_add_u32 v10, v9, 4, v10
    v_add_u32 v10, s55, v10
    v_lshlrev_b32 v9, 10, v9
    v_lshl_add_u32 v9, v8, 2, v9
    s_mul_i32 s54, s54, 20480
    s_and_b32 s55, s3, 3
    s_lshl_b32 s55, s55, 6
    s_add_u32 s54, s54, s55
    s_waitcnt lgkmcnt(0)
    s_barrier
    ds_read_b128 v[16:19], v10 offset:0
    ds_read_b128 v[20:23], v10 offset:64
    ds_read_b128 v[24:27], v10 offset:128
    ds_read_b128 v[28:31], v10 offset:192
    ds_read_b128 v[32:35], v10 offset:4608
    ds_read_b128 v[36:39], v10 offset:4672
    ds_read_b128 v[40:43], v10 offset:4736
    ds_read_b128 v[44:47], v10 offset:4800
    ds_read_b128 v[48:51], v10 offset:9216
    ds_read_b128 v[52:55], v10 offset:9280
    ds_read_b128 v[56:59], v10 offset:9344
    ds_read_b128 v[60:63], v10 offset:9408
    s_waitcnt lgkmcnt(11)
    v_mfma_f32_16x16x32_bf16 v[128:131], v[16:19], v[208:211], 0
    v_mfma_f32_16x16x32_bf16 v[132:135], v[16:19], v[212:215], 0
    s_waitcnt lgkmcnt(10)
    v_mfma_f32_16x16x32_bf16 v[128:131], v[20:23], v[216:219], v[128:131]
    v_mfma_f32_16x16x32_bf16 v[132:135], v[20:23], v[220:223], v[132:135]
    s_waitcnt lgkmcnt(9)
    v_mfma_f32_16x16x32_bf16 v[128:131], v[24:27], v[224:227], v[128:131]
    v_mfma_f32_16x16x32_bf16 v[132:135], v[24:27], v[228:231], v[132:135]
    s_waitcnt lgkmcnt(8)
    v_mfma_f32_16x16x32_bf16 v[128:131], v[28:31], v[232:235], v[128:131]
    v_mfma_f32_16x16x32_bf16 v[132:135], v[28:31], v[236:239], v[132:135]
    ds_read_b128 v[64:67], v10 offset:13824
    ds_read_b128 v[68:71], v10 offset:13888
    ds_read_b128 v[72:75], v10 offset:13952
    ds_read_b128 v[76:79], v10 offset:14016
    s_waitcnt lgkmcnt(8)
    v_mfma_f32_16x16x32_bf16 v[136:139], v[32:35], v[208:211], 0
    v_mfma_f32_16x16x32_bf16 v[140:143], v[32:35], v[212:215], 0
    v_mfma_f32_16x16x32_bf16 v[136:139], v[36:39], v[216:219], v[136:139]
    v_mfma_f32_16x16x32_bf16 v[140:143], v[36:39], v[220:223], v[140:143]
    v_mfma_f32_16x16x32_bf16 v[136:139], v[40:43], v[224:227], v[136:139]
    v_mfma_f32_16x16x32_bf16 v[140:143], v[40:43], v[228:231], v[140:143]
    v_mfma_f32_16x16x32_bf16 v[136:139], v[44:47], v[232:235], v[136:139]
    v_mfma_f32_16x16x32_bf16 v[140:143], v[44:47], v[236:239], v[140:143]
    v_cvt_pk_bf16_f32 v168, v128, v132
    buffer_store_dword v168, v9, s[40:43], s54 offen offset:0 sc1
    v_cvt_pk_bf16_f32 v169, v129, v133
    buffer_store_dword v169, v9, s[40:43], s54 offen offset:256 sc1
    v_cvt_pk_bf16_f32 v170, v130, v134
    buffer_store_dword v170, v9, s[40:43], s54 offen offset:512 sc1
    v_cvt_pk_bf16_f32 v171, v131, v135
    buffer_store_dword v171, v9, s[40:43], s54 offen offset:768 sc1
    s_add_u32 s54, s54, 4096
    ds_read_b128 v[80:83], v10 offset:18432
    ds_read_b128 v[84:87], v10 offset:18496
    ds_read_b128 v[88:91], v10 offset:18560
    ds_read_b128 v[92:95], v10 offset:18624
    s_waitcnt lgkmcnt(8)
    v_mfma_f32_16x16x32_bf16 v[144:147], v[48:51], v[208:211], 0
    v_mfma_f32_16x16x32_bf16 v[148:151], v[48:51], v[212:215], 0
    v_mfma_f32_16x16x32_bf16 v[144:147], v[52:55], v[216:219], v[144:147]
    v_mfma_f32_16x16x32_bf16 v[148:151], v[52:55], v[220:223], v[148:151]
    v_mfma_f32_16x16x32_bf16 v[144:147], v[56:59], v[224:227], v[144:147]
    v_mfma_f32_16x16x32_bf16 v[148:151], v[56:59], v[228:231], v[148:151]
    v_mfma_f32_16x16x32_bf16 v[144:147], v[60:63], v[232:235], v[144:147]
    v_mfma_f32_16x16x32_bf16 v[148:151], v[60:63], v[236:239], v[148:151]
    v_cvt_pk_bf16_f32 v172, v136, v140
    buffer_store_dword v172, v9, s[40:43], s54 offen offset:0 sc1
    v_cvt_pk_bf16_f32 v173, v137, v141
    buffer_store_dword v173, v9, s[40:43], s54 offen offset:256 sc1
    v_cvt_pk_bf16_f32 v174, v138, v142
    buffer_store_dword v174, v9, s[40:43], s54 offen offset:512 sc1
    v_cvt_pk_bf16_f32 v175, v139, v143
    buffer_store_dword v175, v9, s[40:43], s54 offen offset:768 sc1
    s_add_u32 s54, s54, 4096
    s_waitcnt lgkmcnt(4)
    v_mfma_f32_16x16x32_bf16 v[152:155], v[64:67], v[208:211], 0
    v_mfma_f32_16x16x32_bf16 v[156:159], v[64:67], v[212:215], 0
    v_mfma_f32_16x16x32_bf16 v[152:155], v[68:71], v[216:219], v[152:155]
    v_mfma_f32_16x16x32_bf16 v[156:159], v[68:71], v[220:223], v[156:159]
    v_mfma_f32_16x16x32_bf16 v[152:155], v[72:75], v[224:227], v[152:155]
    v_mfma_f32_16x16x32_bf16 v[156:159], v[72:75], v[228:231], v[156:159]
    v_mfma_f32_16x16x32_bf16 v[152:155], v[76:79], v[232:235], v[152:155]
    v_mfma_f32_16x16x32_bf16 v[156:159], v[76:79], v[236:239], v[156:159]
    v_cvt_pk_bf16_f32 v176, v144, v148
    buffer_store_dword v176, v9, s[40:43], s54 offen offset:0 sc1
    v_cvt_pk_bf16_f32 v177, v145, v149
    buffer_store_dword v177, v9, s[40:43], s54 offen offset:256 sc1
    v_cvt_pk_bf16_f32 v178, v146, v150
    buffer_store_dword v178, v9, s[40:43], s54 offen offset:512 sc1
    v_cvt_pk_bf16_f32 v179, v147, v151
    buffer_store_dword v179, v9, s[40:43], s54 offen offset:768 sc1
    s_add_u32 s54, s54, 4096
    s_waitcnt lgkmcnt(0)
    v_mfma_f32_16x16x32_bf16 v[160:163], v[80:83], v[208:211], 0
    v_mfma_f32_16x16x32_bf16 v[164:167], v[80:83], v[212:215], 0
    v_mfma_f32_16x16x32_bf16 v[160:163], v[84:87], v[216:219], v[160:163]
    v_mfma_f32_16x16x32_bf16 v[164:167], v[84:87], v[220:223], v[164:167]
    v_mfma_f32_16x16x32_bf16 v[160:163], v[88:91], v[224:227], v[160:163]
    v_mfma_f32_16x16x32_bf16 v[164:167], v[88:91], v[228:231], v[164:167]
    v_mfma_f32_16x16x32_bf16 v[160:163], v[92:95], v[232:235], v[160:163]
    v_mfma_f32_16x16x32_bf16 v[164:167], v[92:95], v[236:239], v[164:167]
    v_cvt_pk_bf16_f32 v180, v152, v156
    buffer_store_dword v180, v9, s[40:43], s54 offen offset:0 sc1
    v_cvt_pk_bf16_f32 v181, v153, v157
    buffer_store_dword v181, v9, s[40:43], s54 offen offset:256 sc1
    v_cvt_pk_bf16_f32 v182, v154, v158
    buffer_store_dword v182, v9, s[40:43], s54 offen offset:512 sc1
    v_cvt_pk_bf16_f32 v183, v155, v159
    buffer_store_dword v183, v9, s[40:43], s54 offen offset:768 sc1
    s_add_u32 s54, s54, 4096
    v_cvt_pk_bf16_f32 v184, v160, v164
    buffer_store_dword v184, v9, s[40:43], s54 offen offset:0 sc1
    v_cvt_pk_bf16_f32 v185, v161, v165
    buffer_store_dword v185, v9, s[40:43], s54 offen offset:256 sc1
    v_cvt_pk_bf16_f32 v186, v162, v166
    buffer_store_dword v186, v9, s[40:43], s54 offen offset:512 sc1
    v_cvt_pk_bf16_f32 v187, v163, v167
    buffer_store_dword v187, v9, s[40:43], s54 offen offset:768 sc1
    s_add_u32 s54, s54, 4096
    s_or_b32 s4, s2, s3
    s_cbranch_scc1 L_notag
    v_mov_b32 v8, s62
    v_lshlrev_b32 v10, 2, v1
    s_mov_b32 s54, 524288
    buffer_store_dword v8, v10, s[20:23], s54 offen sc1
L_notag:
L_done:
    s_endpgm
L_again:
    s_waitcnt vmcnt(0) lgkmcnt(0)
    s_barrier
    v_lshlrev_b32 v11, 2, v0
    v_mov_b32 v12, 0x00700000
    v_mov_b32 v13, 0
    ds_write_b32 v11, v12 offset:0
    ds_write_b32 v11, v12 offset:2048
    ds_write_b32 v11, v12 offset:4096
    ds_write_b32 v11, v12 offset:6144
    ds_write_b32 v11, v13 offset:8192
    ds_write_b32 v11, v13 offset:10240
    ds_write_b32 v11, v13 offset:12288
    v_add_u32 v3, v3, v4
    v_subrev_u32 v3, 256, v3
    v_max_i32 v3, 0, v3
    v_subrev_u32 v4, 256, v4
    v_max_i32 v4, 0, v4
    v_sub_u32 v3, v3, v4
    v_add_u32 v5, 256, v5
    s_sub_i32 s95, s95, 256
    v_lshl_add_u32 v8, v4, 2, v241
    s_waitcnt lgkmcnt(0)
    s_barrier
L_clip:
    v_add_u32 v10, v4, v3
    v_min_i32 v10, 256, v10
    v_sub_u32 v10, v10, v4
    v_add_u32 v10, v10, v240
L_masks:
    v_cmp_lt_i32 s[64:65], 0, v10
    v_cmp_lt_i32 s[66:67], 2, v10
    v_cmp_lt_i32 s[68:69], 4, v10
    v_cmp_lt_i32 s[70:71], 6, v10
    v_cmp_lt_i32 s[72:73], 8, v10
    v_cmp_lt_i32 s[74:75], 10, v10
    v_cmp_lt_i32 s[76:77], 12, v10
    v_cmp_lt_i32 s[78:79], 14, v10
    s_nop 0
    s_branch L_mapw
L_map2:
    v_add_u32 v8, 56, v8
    v_subrev_u32 v10, 14, v10
    s_branch L_masks
L_r1:
    ds_read_b32 v67, v242 offset:768
    ds_read_b32 v74, v243 offset:768
    ds_read_b32 v75, v243 offset:896
    s_waitcnt lgkmcnt(0)
    v_mad_u32_u24 v67, v67, 12, v244
    buffer_load_dwordx3 v[88:90], v67, s[24:27], 0 offen offset:2304 sc1
    v_lshl_add_u32 v74, v74, 5, v2
    s_add_u32 m0, s52, 4096
    s_nop 0
    buffer_load_dwordx4 v74, s[28:31], s98 offen offset:2048 sc1 lds
    v_lshl_add_u32 v75, v75, 5, v2
    s_add_u32 m0, s52, 4096
    s_nop 0
    buffer_load_dwordx4 v75, s[28:31], s98 offen offset:3072 sc1 lds
    s_branch L_r1b
L_r2:
    v_lshrrev_b32 v135, 21, v90
    v_lshlrev_b32 v135, 2, v135
    v_lshrrev_b32 v11, 26, v90
    v_lshl_or_b32 v11, v11, 4, v245
    s_mov_b64 exec, s[96:97]
    ds_add_rtn_u32 v131, v135, v6 offset:8192
    ds_add_u32 v11, v6 offset:14336
    s_mov_b64 exec, -1
    ds_write_b64 v246, v[88:89] offset:1536
    v_and_or_b32 v90, v90, s55, v247
    v_add_u32 v90, 402653184, v90
    s_branch L_r2b
L_r3:
    ds_read_b32 v135, v135 offset:8192
    s_waitcnt lgkmcnt(0)
    v_bfe_u32 v15, v135, 12, 3
    v_or_b32 v90, v15, v90
    v_and_b32 v67, 0x3ff, v135
    v_lshrrev_b32 v135, 16, v135
    v_add_u32 v135, v135, v131
    ds_read_b32 v67, v67 offset:16384
    s_waitcnt lgkmcnt(0)
    v_lshl_add_u32 v135, v135, 2, v67
    s_mov_b64 exec, s[96:97]
    ds_write_b32 v135, v90
    s_mov_b64 exec, -1
    s_branch L_r3b
L_poll:
    buffer_load_dwordx2 v[206:207], v10, s[20:23], s49 offen sc1
    s_sub_u32 s53, s53, 1
    s_cbranch_scc1 L_done
    s_waitcnt vmcnt(0)
    v_xor_b32 v11, s63, v206
    v_xor_b32 v12, s62, v207
    v_and_or_b32 v11, v11, s55, v12
    v_cmpx_ne_u32 vcc, 0, v11
    s_cbranch_execnz L_poll
    s_branch L_polled
L_rank2:
    ds_read_b32 v96, v248 offset:8192
    ds_read_b32 v97, v248 offset:8320
    ds_read_b32 v98, v248 offset:8448
    ds_read_b32 v99, v248 offset:8576
    ds_read_b32 v100, v248 offset:8704
    s_waitcnt lgkmcnt(0)
L_end:
    s_branch L_ranked
.section .rodata,"a"
.p2align 6
.amdhsa_kernel gather_scatter__tensor_product_equiv_mace__graph_kernel
  .amdhsa_next_free_vgpr 256
  .amdhsa_next_free_sgpr 102
  .amdhsa_accum_offset 256
  .amdhsa_group_segment_fixed_size 0
  .amdhsa_kernarg_size 88
  .amdhsa_user_sgpr_count 2
  .amdhsa_user_sgpr_kernarg_segment_ptr 1
  .amdhsa_system_sgpr_workgroup_id_x 1
  .amdhsa_float_denorm_mode_32 3
.end_amdhsa_kernel
```

```asm
; @launch grid=(256,1,1) block=(512,1,1) lds=147456
.amdgcn_target "amdgcn-amd-amdhsa--gfx950"
.text
.globl gather_scatter__tensor_product_equiv_mace__graph_kernel
.p2align 8
.type gather_scatter__tensor_product_equiv_mace__graph_kernel,@function
gather_scatter__tensor_product_equiv_mace__graph_kernel:
    s_cmp_ge_u32 s2, 256
    s_cbranch_scc1 L_done
    s_load_dwordx4 s[4:7], s[0:1], 8
    s_load_dwordx4 s[8:11], s[0:1], 24
    s_load_dwordx2 s[14:15], s[0:1], 80
    s_load_dwordx2 s[64:65], s[0:1], 0
    s_load_dwordx2 s[66:67], s[0:1], 40
    s_load_dwordx4 s[68:71], s[0:1], 48
    s_load_dwordx2 s[12:13], s[0:1], 64
    v_lshlrev_b32 v10, 3, v0
    s_getpc_b64 s[80:81]
L_pc:
    s_and_b32 s44, s2, 0xf8
    s_lshl_b32 s44, s44, 6
    v_and_b32 v11, 0x180, v10
    v_add_u32 v11, s44, v11
    v_min_u32 v11, L_end-L_pc, v11
    v_mov_b32 v113, s81
    v_add_co_u32 v112, vcc, s80, v11
    s_nop 1
    v_addc_co_u32 v113, vcc, 0, v113, vcc
    global_load_dword v205, v[112:113], off
    v_lshrrev_b32 v8, 6, v0
    v_and_b32 v1, 63, v0
    v_lshlrev_b32 v9, 2, v0
    v_mov_b32 v13, 0
    v_readfirstlane_b32 s3, v8
    ds_write_b32 v9, v13 offset:56320
    ds_write_b32 v9, v13 offset:61440
    s_mul_i32 s54, s2, 5000
    s_mul_i32 s55, s2, 10000
    s_mul_i32 s61, s2, 40000
    v_lshlrev_b32 v2, 4, v1
    v_lshlrev_b32 v15, 4, v0
    v_mov_b32 v6, 1
    s_lshl_b32 s52, s3, 10
    s_add_u32 s52, s52, 81920
    s_movk_i32 s53, 4096
    s_movk_i32 s50, 8192
    s_mov_b32 s34, 5000
    s_mov_b32 s35, 0x20000
    s_mov_b32 s38, 5000
    s_mov_b32 s39, 0x20000
    s_mov_b32 s98, 10000
    s_mov_b32 s99, 0x20000
    s_mov_b32 s30, 40000
    s_mov_b32 s31, 0x20000
    s_waitcnt lgkmcnt(0)
    s_add_u32 s32, s6, s54
    s_addc_u32 s33, s7, 0
    buffer_load_dword v64, v9, s[32:35], 0 offen offset:0 nt
    buffer_load_dword v65, v9, s[32:35], 0 offen offset:2048 nt
    buffer_load_dword v66, v9, s[32:35], s53 offen nt
    s_add_u32 s36, s4, s54
    s_addc_u32 s37, s5, 0
    s_barrier
    buffer_load_dword v68, v9, s[36:39], 0 offen offset:0 nt
    buffer_load_dword v69, v9, s[36:39], 0 offen offset:2048 nt
    buffer_load_dword v70, v9, s[36:39], s53 offen nt
    s_load_dword s62, s[14:15], 524288
    s_add_u32 s96, s8, s55
    s_addc_u32 s97, s9, 0
    s_add_u32 s28, s10, s61
    s_addc_u32 s29, s11, 0
    buffer_load_dwordx2 v[72:73], v10, s[96:99], 0 offen nt
    buffer_load_dwordx2 v[74:75], v10, s[96:99], s53 offen nt
    buffer_load_dwordx2 v[76:77], v10, s[96:99], s50 offen nt
    s_add_u32 m0, s52, 0
    s_mov_b32 s54, 0
    buffer_load_dwordx4 v15, s[28:31], s54 offen nt lds
    s_add_u32 m0, s52, 8192
    s_mov_b32 s54, 8192
    buffer_load_dwordx4 v15, s[28:31], s54 offen nt lds
    s_mov_b32 s72, 109951168
    s_movk_i32 s73, 625
    s_movk_i32 s74, 838
    s_movk_i32 s54, 226
    v_cmp_gt_u32 s[84:85], s54, v0
    v_lshlrev_b32 v11, 2, v0
    v_mov_b32 v12, 0x00700000
    v_mov_b32 v13, 0
    ds_write_b32 v11, v12 offset:0
    ds_write_b32 v11, v12 offset:2048
    ds_write_b32 v11, v12 offset:4096
    ds_write_b32 v11, v12 offset:6144
    ds_write_b32 v11, v13 offset:8192
    ds_write_b32 v11, v13 offset:10240
    ds_write_b32 v11, v13 offset:12288
    ds_write_b32 v11, v13 offset:14336
    s_waitcnt vmcnt(8)
    v_mul_hi_u32 v80, v64, s72
    v_mul_hi_u32 v81, v65, s72
    v_mul_hi_u32 v82, v66, s72
    v_lshlrev_b32 v84, 2, v80
    ds_add_rtn_u32 v88, v84, v6 offset:56320
    v_lshlrev_b32 v85, 2, v81
    ds_add_rtn_u32 v89, v85, v6 offset:56320
    v_lshlrev_b32 v86, 2, v82
    s_mov_b64 exec, s[84:85]
    ds_add_rtn_u32 v90, v86, v6 offset:56320
    s_mov_b64 exec, -1
    s_waitcnt lgkmcnt(0)
    s_barrier
    ds_read_b128 v[100:103], v2 offset:56320
    v_mad_u32_u24 v92, v80, s73, 15
    v_lshrrev_b32 v92, 4, v92
    v_sub_u32 v92, v64, v92
    v_lshrrev_b32 v80, 3, v80
    v_and_b32 v80, 28, v80
    v_mad_u32_u24 v93, v81, s73, 15
    v_lshrrev_b32 v93, 4, v93
    v_sub_u32 v93, v65, v93
    v_lshrrev_b32 v81, 3, v81
    v_and_b32 v81, 28, v81
    v_mad_u32_u24 v94, v82, s73, 15
    v_lshrrev_b32 v94, 4, v94
    v_sub_u32 v94, v66, v94
    v_lshrrev_b32 v82, 3, v82
    v_and_b32 v82, 28, v82
    s_waitcnt lgkmcnt(0)
    v_add_u32 v11, v100, v101
    v_add3_u32 v11, v11, v102, v103
    v_mov_b32 v12, v11
    s_nop 1
    v_add_u32_dpp v12, v12, v12 row_shr:1 row_mask:0xf bank_mask:0xf
    s_nop 1
    v_add_u32_dpp v12, v12, v12 row_shr:2 row_mask:0xf bank_mask:0xf
    s_nop 1
    v_add_u32_dpp v12, v12, v12 row_shr:4 row_mask:0xf bank_mask:0xf
    s_nop 1
    v_add_u32_dpp v12, v12, v12 row_shr:8 row_mask:0xf bank_mask:0xf
    s_nop 1
    v_add_u32_dpp v12, v12, v12 row_bcast:15 row_mask:0xa bank_mask:0xf
    s_nop 1
    v_add_u32_dpp v12, v12, v12 row_bcast:31 row_mask:0xc bank_mask:0xf
    v_sub_u32 v104, v12, v11
    v_add_u32 v105, v104, v100
    v_add_u32 v106, v105, v101
    v_add_u32 v107, v106, v102
    ds_write_b128 v2, v[104:107] offset:57344
    ds_read_b32 v108, v84 offset:57344
    ds_read_b32 v109, v85 offset:57344
    ds_read_b32 v110, v86 offset:57344
    s_waitcnt vmcnt(5)
    v_mul_u32_u24 v96, s74, v68
    v_lshrrev_b32 v96, 18, v96
    v_sub_u32 v96, v96, v80
    v_and_b32 v96, 31, v96
    v_lshl_or_b32 v96, v92, 5, v96
    v_lshlrev_b32 v96, 21, v96
    v_lshl_or_b32 v96, v68, 7, v96
    v_mul_u32_u24 v97, s74, v69
    v_lshrrev_b32 v97, 18, v97
    v_sub_u32 v97, v97, v81
    v_and_b32 v97, 31, v97
    v_lshl_or_b32 v97, v93, 5, v97
    v_lshlrev_b32 v97, 21, v97
    v_lshl_or_b32 v97, v69, 7, v97
    v_mul_u32_u24 v98, s74, v70
    v_lshrrev_b32 v98, 18, v98
    v_sub_u32 v98, v98, v82
    v_and_b32 v98, 31, v98
    v_lshl_or_b32 v98, v94, 5, v98
    v_lshlrev_b32 v98, 21, v98
    v_lshl_or_b32 v98, v70, 7, v98
    v_lshlrev_b32 v92, 5, v0
    v_add_u32 v93, 16384, v92
    v_add_u32 v94, 32768, v92
    s_mov_b32 s55, 63488
    s_waitcnt vmcnt(2) lgkmcnt(0)
    v_add_u32 v108, v108, v88
    v_lshlrev_b32 v84, 2, v108
    v_mad_u32_u24 v108, v108, 12, s55
    ds_write_b32 v84, v92 offset:58368
    ds_write2_b32 v108, v72, v73 offset0:0 offset1:1
    ds_write_b32 v108, v96 offset:8
    v_add_u32 v109, v109, v89
    v_lshlrev_b32 v85, 2, v109
    v_mad_u32_u24 v109, v109, 12, s55
    ds_write_b32 v85, v93 offset:58368
    ds_write2_b32 v109, v74, v75 offset0:0 offset1:1
    ds_write_b32 v109, v97 offset:8
    v_add_u32 v110, v110, v90
    v_lshlrev_b32 v86, 2, v110
    v_mad_u32_u24 v110, v110, 12, s55
    s_mov_b64 exec, s[84:85]
    ds_write_b32 v86, v94 offset:58368
    ds_write2_b32 v110, v76, v77 offset0:0 offset1:1
    ds_write_b32 v110, v98 offset:8
    s_mov_b64 exec, -1
    s_add_u32 m0, s52, 16384
    s_mov_b32 s54, 16384
    buffer_load_dwordx4 v15, s[28:31], s54 offen nt lds
    s_add_u32 m0, s52, 24576
    s_mov_b32 s54, 24576
    buffer_load_dwordx4 v15, s[28:31], s54 offen nt lds
    s_add_u32 m0, s52, 32768
    s_mov_b32 s54, 32768
    buffer_load_dwordx4 v15, s[28:31], s54 offen nt lds
    s_mul_i32 s62, s62, 0x9e3779b1
    s_add_u32 s62, s62, 0x7f4a7c15
    s_mul_i32 s63, s62, 0x85ebca6b
    s_and_b32 s63, s63, 0xffc00000
    s_lshl_b32 s54, s3, 7
    v_lshl_add_u32 v11, v1, 3, s54
    ds_read_b64 v[100:101], v11 offset:56320
    ds_read_b64 v[104:105], v11 offset:57344
    s_mul_i32 s54, s2, 15360
    s_add_u32 s54, s54, 1048576
    s_add_u32 s32, s14, s54
    s_addc_u32 s33, s15, 0
    s_mov_b32 s34, 15360
    s_mov_b32 s35, 0x20000
    s_mul_i32 s54, s2, 40960
    s_add_u32 s54, s54, 5242880
    s_add_u32 s36, s14, s54
    s_addc_u32 s37, s15, 0
    s_mov_b32 s38, 40000
    s_mov_b32 s39, 0x20000
    v_lshrrev_b32 v11, 1, v0
    v_lshlrev_b32 v11, 2, v11
    v_and_b32 v12, 1, v0
    v_lshlrev_b32 v12, 4, v12
    v_add_u32 v12, 81920, v12
    v_add_u32 v14, 63488, v15
    s_waitcnt lgkmcnt(0)
    s_barrier
    ds_read_b128 v[128:131], v14
    ds_read_b128 v[132:135], v14 offset:8192
    ds_read_b32 v156, v11 offset:58368
    ds_read_b32 v157, v11 offset:59392
    ds_read_b32 v158, v11 offset:60416
    ds_read_b32 v159, v11 offset:61440
    ds_read_b32 v160, v11 offset:62464
    s_cmp_lt_u32 s3, 4
    s_cselect_b32 s16, s68, s66
    s_cselect_b32 s17, s69, s67
    s_movk_i32 s54, 128
    s_cselect_b32 s18, s53, s54
    s_mov_b32 s19, 0x20000
    s_min_u32 s54, s3, 5
    s_lshl_b32 s54, s54, 10
    s_add_u32 m0, s54, 17408
    s_and_b32 s54, s54, 0xc00
    buffer_load_dwordx4 v2, s[16:19], s54 offen lds
    s_mov_b32 s40, s70
    s_mov_b32 s41, s71
    s_mov_b32 s42, 32768
    s_mov_b32 s43, 0x20000
    s_lshl_b32 s55, s3, 12
    s_add_u32 m0, s55, 23552
    s_nop 0
    buffer_load_dwordx4 v2, s[40:43], s55 offen offset:0 lds
    buffer_load_dwordx4 v2, s[40:43], s55 offen offset:1024 lds
    buffer_load_dwordx4 v2, s[40:43], s55 offen offset:2048 lds
    buffer_load_dwordx4 v2, s[40:43], s55 offen offset:3072 lds
    s_waitcnt lgkmcnt(0)
    v_add_u32 v156, v12, v156
    v_add_u32 v157, v12, v157
    v_add_u32 v158, v12, v158
    v_add_u32 v159, v12, v159
    v_add_u32 v160, v12, v160
    v_lshl_or_b32 v112, v100, 11, v104
    v_or_b32 v112, s63, v112
    v_mov_b32 v113, s62
    v_lshl_or_b32 v114, v101, 11, v105
    v_or_b32 v114, s63, v114
    v_mov_b32 v115, s62
    s_waitcnt vmcnt(0)
    s_barrier
    ds_read_b128 v[136:139], v156
    ds_read_b128 v[140:143], v157
    ds_read_b128 v[144:147], v158
    ds_read_b128 v[148:151], v159
    ds_read_b128 v[152:155], v160
    buffer_store_dwordx4 v[128:131], v15, s[32:35], 0 offen sc1
    buffer_store_dwordx4 v[132:135], v15, s[32:35], s50 offen sc1
    s_mov_b32 s54, 0
    s_waitcnt lgkmcnt(4)
    buffer_store_dwordx4 v[136:139], v15, s[36:39], s54 offen sc1
    s_mov_b32 s54, 8192
    s_waitcnt lgkmcnt(3)
    buffer_store_dwordx4 v[140:143], v15, s[36:39], s54 offen sc1
    s_mov_b32 s54, 16384
    s_waitcnt lgkmcnt(2)
    buffer_store_dwordx4 v[144:147], v15, s[36:39], s54 offen sc1
    s_mov_b32 s54, 24576
    s_waitcnt lgkmcnt(1)
    buffer_store_dwordx4 v[148:151], v15, s[36:39], s54 offen sc1
    s_mov_b32 s54, 32768
    s_waitcnt lgkmcnt(0)
    buffer_store_dwordx4 v[152:155], v15, s[36:39], s54 offen sc1
    s_and_b32 s44, s2, 7
    s_lshl_b32 s44, s44, 5
    s_lshr_b32 s54, s2, 3
    s_add_u32 s44, s44, s54
    s_mul_i32 s45, s44, 625
    s_add_u32 s46, s45, 640
    s_add_u32 s45, s45, 15
    s_lshr_b32 s45, s45, 4
    s_lshr_b32 s46, s46, 4
    s_sub_u32 s46, s46, s45
    s_mov_b32 s86, 0x0f0f0f0f
    s_mov_b32 s87, 0x0f0f0f0f
    s_mov_b32 s88, 0xf0f0f0f0
    s_mov_b32 s89, 0xf0f0f0f0
    v_mov_b32 v164, 0
    v_mov_b32 v165, 0
    v_mov_b32 v166, 0
    v_mov_b32 v167, 0
    v_mov_b32 v168, 0
    v_mov_b32 v169, 0
    v_mov_b32 v170, 0
    v_mov_b32 v171, 0
    v_and_b32 v11, 4, v1
    v_lshlrev_b32 v11, 2, v11
    v_mov_b32 v12, 0xffff
    v_lshlrev_b32 v12, v11, v12
    v_bfe_i32 v11, v1, 3, 1
    v_and_b32 v191, v11, v12
    v_xor_b32 v190, v191, v12
    v_lshrrev_b32 v200, 5, v1
    v_lshlrev_b32 v200, 4, v200
    v_add_u32 v200, 81920, v200
    v_and_b32 v201, 15, v1
    v_lshlrev_b32 v201, 2, v201
    v_bfe_u32 v11, v1, 3, 2
    v_and_b32 v12, 3, v1
    v_lshl_add_u32 v11, v11, 2, v12
    v_lshlrev_b32 v202, 2, v11
    v_bfe_i32 v240, v0, 0, 1
    s_lshl_b32 s54, s3, 10
    v_and_b32 v241, 4, v240
    v_add_u32 v241, s54, v241
    v_lshl_add_u32 v242, v1, 2, s54
    v_lshrrev_b32 v243, 1, v1
    v_lshl_add_u32 v243, v243, 2, s54
    v_mul_u32_u24 v244, 12, v1
    v_and_b32 v245, 12, v242
    v_and_b32 v250, 124, v242
    v_lshlrev_b32 v246, 1, v242
    v_add_u32 v246, 65536, v246
    v_lshlrev_b32 v247, 19, v242
    s_mul_i32 s54, s3, 640
    v_add_u32 v248, s54, v250
    v_sub_u32 v249, 63, v1
    s_lshl_b32 s54, s3, 5
    v_lshl_add_u32 v251, v1, 2, s54
    v_lshrrev_b32 v252, 3, v1
    v_mul_u32_u24 v252, 64, v252
    v_add_u32 v252, 56320, v252
    s_cmp_eq_u32 s46, 40
    v_mov_b32 v203, 0
    s_mov_b32 s54, 671321104
    s_cselect_b32 s54, 276856880, s54
    s_mov_b32 exec_lo, 31
    s_mov_b32 exec_hi, 0
    v_mov_b32 v203, s54
    s_mov_b32 s54, 405087304
    s_cselect_b32 s54, 159876648, s54
    s_mov_b32 exec_lo, 992
    s_mov_b32 exec_hi, 0
    v_mov_b32 v203, s54
    s_mov_b32 s54, 424579168
    s_cselect_b32 s54, 296066625, s54
    s_mov_b32 exec_lo, 31744
    s_mov_b32 exec_hi, 0
    v_mov_b32 v203, s54
    s_mov_b32 s54, 577443961
    s_cselect_b32 s54, 980068482, s54
    s_mov_b32 exec_lo, 1015808
    s_mov_b32 exec_hi, 0
    v_mov_b32 v203, s54
    s_mov_b32 s54, 600547466
    s_cselect_b32 s54, 466166449, s54
    s_mov_b32 exec_lo, 32505856
    s_mov_b32 exec_hi, 0
    v_mov_b32 v203, s54
    s_mov_b32 s54, 734837403
    s_cselect_b32 s54, 590166779, s54
    s_mov_b32 exec_lo, 1040187392
    s_mov_b32 exec_hi, 0
    v_mov_b32 v203, s54
    s_mov_b32 s54, 481444091
    s_cselect_b32 s54, 754136323, s54
    s_mov_b32 exec_lo, 3221225472
    s_mov_b32 exec_hi, 7
    v_mov_b32 v203, s54
    s_mov_b32 s54, 338903356
    s_cselect_b32 s54, 76598556, s54
    s_mov_b32 exec_lo, 0
    s_mov_b32 exec_hi, 248
    v_mov_b32 v203, s54
    s_mov_b64 exec, -1
    v_mul_u32_u24 v11, 52, v1
    v_lshrrev_b32 v11, 8, v11
    v_mad_i32_i24 v11, v11, -5, v1
    v_mul_u32_u24 v11, 6, v11
    v_lshrrev_b32 v203, v11, v203
    v_and_b32 v11, 7, v203
    v_bfe_u32 v203, v203, 3, 3
    v_lshlrev_b32 v11, 12, v11
    v_lshl_or_b32 v203, v203, 7, v11
    s_mov_b32 s20, s14
    s_mov_b32 s21, s15
    s_mov_b32 s22, 524352
    s_mov_b32 s23, 0x20000
    s_add_u32 s24, s14, 1048576
    s_addc_u32 s25, s15, 0
    s_mov_b32 s26, 3932160
    s_mov_b32 s27, 0x20000
    v_mov_b32 v16, 0
    v_mov_b32 v17, 0
    v_mov_b32 v18, 0
    v_mov_b32 v19, 0
    v_mov_b32 v20, 0
    v_mov_b32 v21, 0
    v_mov_b32 v22, 0
    v_mov_b32 v23, 0
    v_mov_b32 v24, 0
    v_mov_b32 v25, 0
    v_mov_b32 v26, 0
    v_mov_b32 v27, 0
    v_mov_b32 v28, 0
    v_mov_b32 v29, 0
    v_mov_b32 v30, 0
    v_mov_b32 v31, 0
    v_mov_b32 v32, 0
    v_mov_b32 v33, 0
    v_mov_b32 v34, 0
    v_mov_b32 v35, 0
    v_mov_b32 v36, 0
    v_mov_b32 v37, 0
    v_mov_b32 v38, 0
    v_mov_b32 v39, 0
    v_mov_b32 v40, 0
    v_mov_b32 v41, 0
    v_mov_b32 v42, 0
    v_mov_b32 v43, 0
    v_mov_b32 v44, 0
    v_mov_b32 v45, 0
    v_mov_b32 v46, 0
    v_mov_b32 v47, 0
    v_mov_b32 v48, 0
    v_mov_b32 v49, 0
    v_mov_b32 v50, 0
    v_mov_b32 v51, 0
    v_mov_b32 v52, 0
    v_mov_b32 v53, 0
    v_mov_b32 v54, 0
    v_mov_b32 v55, 0
    v_mov_b32 v56, 0
    v_mov_b32 v57, 0
    v_mov_b32 v58, 0
    v_mov_b32 v59, 0
    v_mov_b32 v60, 0
    v_mov_b32 v61, 0
    v_mov_b32 v62, 0
    v_mov_b32 v63, 0
    s_lshl_b32 s54, s2, 3
    s_add_u32 s54, s54, s3
    s_lshl_b32 s54, s54, 8
    s_mov_b32 s16, s64
    s_mov_b32 s17, s65
    s_mov_b32 s18, 10240000
    s_mov_b32 s19, 0x20000
    s_add_u32 s28, s14, 5242880
    s_addc_u32 s29, s15, 0
    s_mov_b32 s30, 10485760
    s_mov_b32 s31, 0x20000
    s_and_b32 s51, s2, 7
    s_mul_i32 s51, s51, 1282048
    s_and_b32 s55, s2, 0xf8
    s_add_u32 s55, s55, s3
    s_mul_i32 s55, s55, 3328
    s_add_u32 s51, s51, s55
    v_min_u32 v14, 25, v1
    v_lshlrev_b32 v14, 7, v14
    s_waitcnt vmcnt(0)
    s_barrier
    s_mov_b64 exec, 0xffff
    buffer_store_dwordx4 v[112:115], v2, s[20:23], s54 offen sc1
    s_mov_b64 exec, -1
    buffer_load_dword v7, v14, s[16:19], s51 offen
    s_lshl_b32 s54, s45, 10
    s_add_u32 s40, s12, s54
    s_addc_u32 s41, s13, 0
    s_lshl_b32 s42, s46, 10
    s_mov_b32 s43, 0x20000
    v_lshrrev_b32 v8, 5, v1
    v_lshlrev_b32 v8, 11, v8
    v_and_b32 v9, 15, v1
    v_lshl_add_u32 v8, v9, 4, v8
    ds_read_b128 v[64:67], v8 offset:17408
    ds_read_b128 v[68:71], v8 offset:17664
    ds_read_b128 v[72:75], v8 offset:17920
    ds_read_b128 v[76:79], v8 offset:18176
    ds_read_b128 v[80:83], v8 offset:18432
    ds_read_b128 v[84:87], v8 offset:18688
    ds_read_b128 v[88:91], v8 offset:18944
    ds_read_b128 v[92:95], v8 offset:19200
    v_lshrrev_b32 v8, 4, v1
    v_lshlrev_b32 v8, 5, v8
    v_and_b32 v9, 3, v1
    v_lshl_add_u32 v8, v9, 1, v8
    ds_read_u16 v96, v8 offset:21504
    ds_read_u16 v97, v8 offset:21512
    ds_read_u16 v98, v8 offset:21520
    ds_read_u16 v99, v8 offset:21528
    v_bfe_i32 v10, v1, 4, 1
    v_and_b32 v10, 0x02020202, v10
    v_add_u32 v10, 0x05040100, v10
    s_waitcnt lgkmcnt(0)
    v_perm_b32 v172, v68, v64, v10
    v_perm_b32 v173, v76, v72, v10
    v_perm_b32 v174, v84, v80, v10
    v_perm_b32 v175, v92, v88, v10
    v_perm_b32 v176, v69, v65, v10
    v_perm_b32 v177, v77, v73, v10
    v_perm_b32 v178, v85, v81, v10
    v_perm_b32 v179, v93, v89, v10
    v_perm_b32 v180, v70, v66, v10
    v_perm_b32 v181, v78, v74, v10
    v_perm_b32 v182, v86, v82, v10
    v_perm_b32 v183, v94, v90, v10
    v_perm_b32 v184, v71, v67, v10
    v_perm_b32 v185, v79, v75, v10
    v_perm_b32 v186, v87, v83, v10
    v_perm_b32 v187, v95, v91, v10
    v_lshl_or_b32 v188, v97, 16, v96
    v_lshl_or_b32 v189, v99, 16, v98
    v_and_b32 v9, 15, v1
    v_lshrrev_b32 v8, 4, v1
    v_lshlrev_b32 v8, 13, v8
    v_lshl_add_u32 v8, v9, 2, v8
    s_and_b32 s72, s3, 3
    s_lshl_b32 s72, s72, 6
    s_add_u32 s72, s72, 23552
    v_add_u32 v8, s72, v8
    ds_read2st64_b32 v[128:129], v8 offset0:0 offset1:4
    ds_read2st64_b32 v[130:131], v8 offset0:8 offset1:12
    ds_read2st64_b32 v[132:133], v8 offset0:16 offset1:20
    ds_read2st64_b32 v[134:135], v8 offset0:24 offset1:28
    ds_read2st64_b32 v[136:137], v8 offset0:1 offset1:5
    ds_read2st64_b32 v[138:139], v8 offset0:9 offset1:13
    ds_read2st64_b32 v[140:141], v8 offset0:17 offset1:21
    ds_read2st64_b32 v[142:143], v8 offset0:25 offset1:29
    ds_read2st64_b32 v[144:145], v8 offset0:2 offset1:6
    ds_read2st64_b32 v[146:147], v8 offset0:10 offset1:14
    ds_read2st64_b32 v[148:149], v8 offset0:18 offset1:22
    ds_read2st64_b32 v[150:151], v8 offset0:26 offset1:30
    ds_read2st64_b32 v[152:153], v8 offset0:3 offset1:7
    ds_read2st64_b32 v[154:155], v8 offset0:11 offset1:15
    ds_read2st64_b32 v[156:157], v8 offset0:19 offset1:23
    ds_read2st64_b32 v[158:159], v8 offset0:27 offset1:31
    s_mov_b32 s72, 0x05040100
    s_mov_b32 s73, 0x07060302
    s_waitcnt lgkmcnt(12)
    v_perm_b32 v208, v129, v128, s72
    v_perm_b32 v209, v131, v130, s72
    v_perm_b32 v210, v133, v132, s72
    v_perm_b32 v211, v135, v134, s72
    v_perm_b32 v212, v129, v128, s73
    v_perm_b32 v213, v131, v130, s73
    v_perm_b32 v214, v133, v132, s73
    v_perm_b32 v215, v135, v134, s73
    s_waitcnt lgkmcnt(8)
    v_perm_b32 v216, v137, v136, s72
    v_perm_b32 v217, v139, v138, s72
    v_perm_b32 v218, v141, v140, s72
    v_perm_b32 v219, v143, v142, s72
    v_perm_b32 v220, v137, v136, s73
    v_perm_b32 v221, v139, v138, s73
    v_perm_b32 v222, v141, v140, s73
    v_perm_b32 v223, v143, v142, s73
    s_waitcnt lgkmcnt(4)
    v_perm_b32 v224, v145, v144, s72
    v_perm_b32 v225, v147, v146, s72
    v_perm_b32 v226, v149, v148, s72
    v_perm_b32 v227, v151, v150, s72
    v_perm_b32 v228, v145, v144, s73
    v_perm_b32 v229, v147, v146, s73
    v_perm_b32 v230, v149, v148, s73
    v_perm_b32 v231, v151, v150, s73
    s_waitcnt lgkmcnt(0)
    v_perm_b32 v232, v153, v152, s72
    v_perm_b32 v233, v155, v154, s72
    v_perm_b32 v234, v157, v156, s72
    v_perm_b32 v235, v159, v158, s72
    v_perm_b32 v236, v153, v152, s73
    v_perm_b32 v237, v155, v154, s73
    v_perm_b32 v238, v157, v156, s73
    v_perm_b32 v239, v159, v158, s73
    v_lshrrev_b32 v9, 1, v0
    v_lshlrev_b32 v10, 11, v9
    s_lshl_b32 s49, s44, 3
    v_mul_u32_u24 v5, 1280, v9
    s_mov_b32 s48, 0
    s_mov_b32 s53, 200000
    s_mov_b32 s55, 0xffc00000
    s_lshl_b32 s52, s3, 13
    s_add_u32 s52, s52, 81920
    s_movk_i32 s98, 4096
    s_waitcnt vmcnt(0)
    s_barrier
    buffer_load_dwordx2 v[206:207], v10, s[20:23], s49 offen sc1
    s_waitcnt vmcnt(0)
    v_xor_b32 v11, s63, v206
    v_xor_b32 v12, s62, v207
    v_and_or_b32 v11, v11, s55, v12
    v_cmpx_ne_u32 vcc, 0, v11
    s_cbranch_execnz L_poll
L_polled:
    s_mov_b64 exec, -1
    v_bfe_u32 v3, v206, 11, 11
    v_and_b32 v4, v3, v240
    v_add_u32 v10, v3, v240
    v_and_b32 v11, 0x7ff, v206
    v_add_u32_dpp v4, v4, v4 row_shr:1 row_mask:0xf bank_mask:0xf
    v_cmp_lt_i32 s[64:65], 0, v10
    v_cmp_lt_i32 s[66:67], 2, v10
    v_add_u32_dpp v4, v4, v4 row_shr:2 row_mask:0xf bank_mask:0xf
    v_cmp_lt_i32 s[68:69], 4, v10
    v_cmp_lt_i32 s[70:71], 6, v10
    v_add_u32_dpp v4, v4, v4 row_shr:4 row_mask:0xf bank_mask:0xf
    v_cmp_lt_i32 s[72:73], 8, v10
    v_cmp_lt_i32 s[74:75], 10, v10
    v_add_u32_dpp v4, v4, v4 row_shr:8 row_mask:0xf bank_mask:0xf
    v_cmp_lt_i32 s[76:77], 12, v10
    v_cmp_lt_i32 s[78:79], 14, v10
    v_add_u32_dpp v4, v4, v4 row_bcast:15 row_mask:0xa bank_mask:0xf
    v_add_u32 v5, v5, v11
    s_nop 0
    v_add_u32_dpp v4, v4, v4 row_bcast:31 row_mask:0xc bank_mask:0xf
    s_nop 0
    v_readlane_b32 s95, v4, 63
    v_mov_b32_dpp v4, v4 quad_perm:[0,0,2,2] row_mask:0xf bank_mask:0xf
    v_sub_u32 v5, v5, v4
    v_lshl_add_u32 v8, v4, 2, v241
    s_cmp_gt_u32 s95, 256
    s_cbranch_scc1 L_clip
L_mapw:
    s_mov_b64 exec, s[64:65]
    ds_write_b32 v8, v5 offset:0
    s_mov_b64 exec, s[66:67]
    ds_write_b32 v8, v5 offset:8
    s_mov_b64 exec, s[68:69]
    ds_write_b32 v8, v5 offset:16
    s_mov_b64 exec, s[70:71]
    ds_write_b32 v8, v5 offset:24
    s_mov_b64 exec, s[72:73]
    ds_write_b32 v8, v5 offset:32
    s_mov_b64 exec, s[74:75]
    ds_write_b32 v8, v5 offset:40
    s_mov_b64 exec, s[76:77]
    ds_write_b32 v8, v5 offset:48
    s_mov_b64 exec, -1
    s_cmp_lg_u64 s[78:79], 0
    s_cbranch_scc1 L_map2
    ds_read_b32 v64, v242 offset:0
    ds_read_b32 v65, v242 offset:256
    ds_read_b32 v66, v242 offset:512
    ds_read_b32 v68, v243 offset:0
    ds_read_b32 v69, v243 offset:128
    ds_read_b32 v70, v243 offset:256
    ds_read_b32 v71, v243 offset:384
    ds_read_b32 v72, v243 offset:512
    ds_read_b32 v73, v243 offset:640
    s_cmp_gt_i32 s95, 192
    s_cbranch_scc1 L_r1
L_r1b:
    s_waitcnt lgkmcnt(6)
    v_mad_u32_u24 v64, v64, 12, v244
    buffer_load_dwordx3 v[76:78], v64, s[24:27], 0 offen offset:0 sc1
    v_mad_u32_u24 v65, v65, 12, v244
    buffer_load_dwordx3 v[80:82], v65, s[24:27], 0 offen offset:768 sc1
    v_mad_u32_u24 v66, v66, 12, v244
    buffer_load_dwordx3 v[84:86], v66, s[24:27], 0 offen offset:1536 sc1
    v_mov_b32 v11, s95
    s_mov_b64 exec, 1
    ds_max_i32 v13, v11 offset:15360
    s_mov_b64 exec, -1
    s_waitcnt lgkmcnt(1)
    v_lshl_add_u32 v68, v68, 5, v2
    v_lshl_add_u32 v69, v69, 5, v2
    v_lshl_add_u32 v70, v70, 5, v2
    v_lshl_add_u32 v71, v71, 5, v2
    v_lshl_add_u32 v72, v72, 5, v2
    v_lshl_add_u32 v73, v73, 5, v2
    s_barrier
    s_add_u32 m0, s52, 0
    s_nop 0
    buffer_load_dwordx4 v68, s[28:31], 0 offen offset:0 sc1 lds
    v_add_u32 v11, 0, v1
    v_cmp_gt_i32 s[80:81], s95, v11
    v_add_u32 v11, 64, v1
    v_cmp_gt_i32 s[82:83], s95, v11
    v_add_u32 v11, 128, v1
    v_cmp_gt_i32 s[84:85], s95, v11
    v_add_u32 v11, 192, v1
    v_cmp_gt_i32 s[96:97], s95, v11
    s_mov_b32 s55, 0x1fff80
    s_mul_i32 s61, s3, 5
    s_waitcnt vmcnt(3)
    v_lshrrev_b32 v132, 21, v78
    v_lshlrev_b32 v132, 2, v132
    v_lshrrev_b32 v11, 26, v78
    v_lshl_or_b32 v11, v11, 4, v245
    s_mov_b64 exec, s[80:81]
    ds_add_rtn_u32 v128, v132, v6 offset:8192
    ds_add_u32 v11, v6 offset:14336
    s_mov_b64 exec, -1
    s_waitcnt vmcnt(2)
    v_lshrrev_b32 v133, 21, v82
    v_lshlrev_b32 v133, 2, v133
    v_lshrrev_b32 v11, 26, v82
    v_lshl_or_b32 v11, v11, 4, v245
    s_mov_b64 exec, s[82:83]
    ds_add_rtn_u32 v129, v133, v6 offset:8192
    ds_add_u32 v11, v6 offset:14336
    s_mov_b64 exec, -1
    s_waitcnt vmcnt(1)
    v_lshrrev_b32 v134, 21, v86
    v_lshlrev_b32 v134, 2, v134
    v_lshrrev_b32 v11, 26, v86
    v_lshl_or_b32 v11, v11, 4, v245
    s_mov_b64 exec, s[84:85]
    ds_add_rtn_u32 v130, v134, v6 offset:8192
    ds_add_u32 v11, v6 offset:14336
    s_mov_b64 exec, -1
    s_cmp_gt_i32 s95, 192
    s_cbranch_scc1 L_r2
L_r2b:
    ds_write_b64 v246, v[76:77] offset:0
    v_and_or_b32 v78, v78, s55, v247
    ds_write_b64 v246, v[80:81] offset:512
    v_and_or_b32 v82, v82, s55, v247
    v_add_u32 v82, 134217728, v82
    ds_write_b64 v246, v[84:85] offset:1024
    v_and_or_b32 v86, v86, s55, v247
    v_add_u32 v86, 268435456, v86
    s_add_u32 m0, s52, 0
    s_nop 0
    buffer_load_dwordx4 v69, s[28:31], 0 offen offset:1024 sc1 lds
    s_add_u32 m0, s52, 0
    s_nop 0
    buffer_load_dwordx4 v70, s[28:31], 0 offen offset:2048 sc1 lds
    s_waitcnt lgkmcnt(3)
    s_barrier
    s_cmp_lg_u32 s48, 0
    s_cbranch_scc1 L_rank2
    ds_read_b128 v[104:107], v2 offset:14336
    ds_read_b32 v96, v248 offset:8192
    ds_read_b32 v97, v248 offset:8320
    ds_read_b32 v98, v248 offset:8448
    ds_read_b32 v99, v248 offset:8576
    ds_read_b32 v100, v248 offset:8704
    ds_read_b32 v14, v13 offset:15360
    s_add_u32 s65, s61, 1
    s_add_u32 s66, s61, 2
    s_add_u32 s67, s61, 3
    s_add_u32 s68, s61, 4
    s_waitcnt lgkmcnt(6)
    v_add_u32 v9, v104, v105
    v_add3_u32 v9, v9, v106, v107
    v_lshl_or_b32 v9, v9, 6, v249
    s_nop 0
    v_readlane_b32 s64, v9, s61
    v_readlane_b32 s65, v9, s65
    v_readlane_b32 s66, v9, s66
    v_readlane_b32 s67, v9, s67
    v_readlane_b32 s68, v9, s68
    v_cmp_lt_u32 s[70:71], s64, v9
    v_cmp_lt_u32 s[72:73], s65, v9
    v_cmp_lt_u32 s[74:75], s66, v9
    v_cmp_lt_u32 s[76:77], s67, v9
    v_cmp_lt_u32 s[78:79], s68, v9
    s_bcnt1_i32_b64 s64, s[70:71]
    s_bcnt1_i32_b64 s65, s[72:73]
    s_bcnt1_i32_b64 s66, s[74:75]
    s_bcnt1_i32_b64 s67, s[76:77]
    s_bcnt1_i32_b64 s68, s[78:79]
    s_waitcnt lgkmcnt(0)
    v_readlane_b32 s90, v203, s64
    v_readlane_b32 s91, v203, s65
    v_readlane_b32 s92, v203, s66
    v_readlane_b32 s93, v203, s67
    v_readlane_b32 s94, v203, s68
    v_readfirstlane_b32 s47, v14
L_ranked:
    s_mov_b32 exec_hi, 0
    s_and_b32 s54, s90, 0x380
    v_add_u32 v104, s54, v250
    ds_add_rtn_u32 v96, v104, v96 offset:13312
    s_and_b32 s54, s91, 0x380
    v_add_u32 v105, s54, v250
    ds_add_rtn_u32 v97, v105, v97 offset:13312
    s_and_b32 s54, s92, 0x380
    v_add_u32 v106, s54, v250
    ds_add_rtn_u32 v98, v106, v98 offset:13312
    s_and_b32 s54, s93, 0x380
    v_add_u32 v107, s54, v250
    ds_add_rtn_u32 v99, v107, v99 offset:13312
    s_and_b32 s54, s94, 0x380
    v_add_u32 v108, s54, v250
    ds_add_rtn_u32 v100, v108, v100 offset:13312
    v_or_b32 v104, s90, v104
    v_or_b32 v105, s91, v105
    v_or_b32 v106, s92, v106
    v_or_b32 v107, s93, v107
    v_or_b32 v108, s94, v108
    v_writelane_b32 v11, s90, 0
    v_writelane_b32 v11, s91, 1
    v_writelane_b32 v11, s92, 2
    v_writelane_b32 v11, s93, 3
    v_writelane_b32 v11, s94, 4
    s_waitcnt lgkmcnt(4)
    v_lshl_or_b32 v96, v96, 16, v104
    ds_write_b32 v248, v96 offset:8192
    s_waitcnt lgkmcnt(4)
    v_lshl_or_b32 v97, v97, 16, v105
    ds_write_b32 v248, v97 offset:8320
    s_waitcnt lgkmcnt(4)
    v_lshl_or_b32 v98, v98, 16, v106
    ds_write_b32 v248, v98 offset:8448
    s_waitcnt lgkmcnt(4)
    v_lshl_or_b32 v99, v99, 16, v107
    ds_write_b32 v248, v99 offset:8576
    s_waitcnt lgkmcnt(4)
    v_lshl_or_b32 v100, v100, 16, v108
    ds_write_b32 v248, v100 offset:8704
    v_add_lshl_u32 v12, v1, s61, 7
    v_lshrrev_b32 v9, 10, v11
    v_bfe_u32 v11, v11, 2, 8
    v_or_b32 v11, v11, v9
    s_mov_b32 exec_lo, 31
    ds_write_b32 v11, v12 offset:15616
    s_mov_b64 exec, -1
    s_add_u32 m0, s52, 0
    s_nop 0
    buffer_load_dwordx4 v71, s[28:31], 0 offen offset:3072 sc1 lds
    s_add_u32 m0, s52, 4096
    s_nop 0
    buffer_load_dwordx4 v72, s[28:31], s98 offen offset:0 sc1 lds
    s_add_u32 m0, s52, 4096
    s_nop 0
    buffer_load_dwordx4 v73, s[28:31], s98 offen offset:1024 sc1 lds
    s_lshl_b32 s54, s3, 3
    s_add_u32 s55, s54, 7
    s_waitcnt lgkmcnt(0)
    s_barrier
    ds_read_b128 v[96:99], v2 offset:13312
    ds_read_b32 v132, v132 offset:8192
    ds_read_b32 v133, v133 offset:8192
    ds_read_b32 v134, v134 offset:8192
    ds_read_b32 v11, v251 offset:15616
    s_waitcnt lgkmcnt(4)
    v_add_u32 v9, v96, v97
    v_add3_u32 v9, v9, v98, v99
    v_mov_b32 v10, v9
    s_waitcnt lgkmcnt(1)
    v_bfe_u32 v15, v132, 12, 3
    v_add_u32_dpp v10, v10, v10 row_shr:1 row_mask:0xf bank_mask:0xf
    v_or_b32 v78, v15, v78
    v_and_b32 v64, 0x3ff, v132
    v_add_u32_dpp v10, v10, v10 row_shr:2 row_mask:0xf bank_mask:0xf
    v_lshrrev_b32 v132, 16, v132
    v_add_u32 v132, v132, v128
    v_add_u32_dpp v10, v10, v10 row_shr:4 row_mask:0xf bank_mask:0xf
    v_bfe_u32 v15, v133, 12, 3
    v_or_b32 v82, v15, v82
    v_add_u32_dpp v10, v10, v10 row_shr:8 row_mask:0xf bank_mask:0xf
    v_and_b32 v65, 0x3ff, v133
    v_lshrrev_b32 v133, 16, v133
    v_add_u32_dpp v10, v10, v10 row_bcast:15 row_mask:0xa bank_mask:0xf
    v_add_u32 v133, v133, v129
    v_bfe_u32 v15, v134, 12, 3
    v_add_u32_dpp v10, v10, v10 row_bcast:31 row_mask:0xc bank_mask:0xf
    v_or_b32 v86, v15, v86
    v_and_b32 v66, 0x3ff, v134
    v_sub_u32 v9, v10, v9
    v_lshl_add_u32 v104, v9, 2, v252
    v_lshl_add_u32 v105, v96, 2, v104
    v_lshl_add_u32 v106, v97, 2, v105
    v_lshl_add_u32 v107, v98, 2, v106
    ds_write_b128 v2, v[104:107] offset:16384
    ds_read_b32 v64, v64 offset:16384
    ds_read_b32 v65, v65 offset:16384
    ds_read_b32 v66, v66 offset:16384
    v_lshrrev_b32 v134, 16, v134
    v_add_u32 v134, v134, v130
    v_readlane_b32 s50, v10, s55
    v_readlane_b32 s53, v9, s54
    v_readlane_b32 s51, v104, s54
    v_mov_b32 v12, 2097029
    s_sub_u32 s50, s50, s53
    s_lshl_b32 s54, s50, 2
    v_add_u32 v198, s51, v201
    v_add_u32 v199, s51, v202
    v_add_u32 v9, s54, v198
    s_waitcnt lgkmcnt(2)
    v_lshl_add_u32 v132, v132, 2, v64
    s_mov_b64 exec, s[80:81]
    ds_write_b32 v132, v78
    s_mov_b64 exec, -1
    s_waitcnt lgkmcnt(2)
    v_lshl_add_u32 v133, v133, 2, v65
    s_mov_b64 exec, s[82:83]
    ds_write_b32 v133, v82
    s_mov_b64 exec, -1
    s_waitcnt lgkmcnt(2)
    v_lshl_add_u32 v134, v134, 2, v66
    s_mov_b64 exec, s[84:85]
    ds_write_b32 v134, v86
    s_mov_b64 exec, -1
    ds_write_b32 v9, v12
    s_cmp_gt_i32 s95, 192
    s_cbranch_scc1 L_r3
L_r3b:
    v_readlane_b32 s56, v11, 0
    v_readlane_b32 s57, v11, 1
    v_readlane_b32 s58, v11, 2
    v_readlane_b32 s59, v11, 3
    v_readlane_b32 s60, v11, 4
    s_add_u32 s54, s50, 1
    s_and_b32 s54, s54, -2
    s_add_u32 s53, s54, 15
    s_lshr_b32 s53, s53, 4
    s_sub_u32 s54, 0, s54
    s_and_b32 s54, s54, 15
    s_sub_u32 s53, s53, 1
    s_cmp_gt_i32 s53, 0
    s_cselect_b32 s54, s54, 0
    s_lshl_b32 s61, s54, 2
    v_subrev_u32 v198, s61, v198
    v_subrev_u32 v199, s61, v199
    s_and_b32 s61, s61, 32
    v_add_u32 v12, s61, v198
    s_and_b32 s72, s54, 6
    s_mov_b32 s55, 0x00fffc38
    s_mov_b32 s49, 0xffffff00
    s_mov_b32 s51, 65536
    s_cmp_lt_u32 s3, 4
    s_cbranch_scc1 L_np
    s_setprio 1
L_np:
    s_waitcnt vmcnt(0) lgkmcnt(0)
    s_barrier
    ds_read_b32 v196, v12
    ds_read_b32 v194, v199
    ds_read_b32 v197, v198 offset:24
    s_cmp_eq_u32 s50, 0
    s_cbranch_scc1 L_swept
    s_waitcnt lgkmcnt(1)
    v_lshlrev_b32 v196, 3, v196
    v_and_b32 v196, s55, v196
    v_lshrrev_b32 v8, 21, v194
    v_lshl_add_u32 v11, v8, 3, s51
    v_lshl_add_u32 v8, v8, 5, v200
    ds_read_b64 v[192:193], v11
    s_mov_b64 exec, s[86:87]
    ds_read_b128 v[164:167], v8
    s_mov_b64 exec, s[88:89]
    ds_read_b128 v[168:171], v8
    s_mov_b64 exec, -1
    s_cmp_eq_u32 s72, 2
    s_cbranch_scc1 L_p2
    s_cmp_eq_u32 s72, 4
    s_cbranch_scc1 L_p4
    s_cmp_eq_u32 s72, 6
    s_cbranch_scc1 L_p6
L_p0:
    v_readlane_b32 s64, v196, 0
    v_readlane_b32 s65, v196, 1
    s_and_b32 s61, s64, s49
    buffer_load_dwordx4 v[96:99], v2, s[16:19], s61 offen
    s_and_b32 s61, s65, s49
    buffer_load_dwordx4 v[100:103], v2, s[16:19], s61 offen
L_p2:
    v_readlane_b32 s66, v196, 2
    v_readlane_b32 s67, v196, 3
    s_and_b32 s61, s66, s49
    buffer_load_dwordx4 v[104:107], v2, s[16:19], s61 offen
    s_and_b32 s61, s67, s49
    buffer_load_dwordx4 v[108:111], v2, s[16:19], s61 offen
L_p4:
    v_readlane_b32 s68, v196, 4
    v_readlane_b32 s69, v196, 5
    s_and_b32 s61, s68, s49
    buffer_load_dwordx4 v[112:115], v2, s[16:19], s61 offen
    s_and_b32 s61, s69, s49
    buffer_load_dwordx4 v[116:119], v2, s[16:19], s61 offen
    s_cmp_eq_u32 s72, 0
    s_cbranch_scc1 L_pd
L_p6:
    v_readlane_b32 s70, v196, 6
    v_readlane_b32 s71, v196, 7
    s_and_b32 s61, s70, s49
    buffer_load_dwordx4 v[120:123], v2, s[16:19], s61 offen
    s_and_b32 s61, s71, s49
    buffer_load_dwordx4 v[124:127], v2, s[16:19], s61 offen
    s_cmp_eq_u32 s72, 2
    s_cbranch_scc1 L_pd
L_p8:
    v_readlane_b32 s64, v196, 8
    v_readlane_b32 s65, v196, 9
    s_and_b32 s61, s64, s49
    buffer_load_dwordx4 v[96:99], v2, s[16:19], s61 offen
    s_and_b32 s61, s65, s49
    buffer_load_dwordx4 v[100:103], v2, s[16:19], s61 offen
    s_cmp_eq_u32 s72, 4
    s_cbranch_scc1 L_pd
L_p10:
    v_readlane_b32 s66, v196, 10
    v_readlane_b32 s67, v196, 11
    s_and_b32 s61, s66, s49
    buffer_load_dwordx4 v[104:107], v2, s[16:19], s61 offen
    s_and_b32 s61, s67, s49
    buffer_load_dwordx4 v[108:111], v2, s[16:19], s61 offen
L_pd:
    s_waitcnt lgkmcnt(0)
.p2align 3
    v_mfma_f32_4x4x4_16b_bf16 v[144:147], v[192:193], v[188:189], 0 cbsz:4 abid:0
    v_mfma_f32_4x4x4_16b_bf16 v[148:151], v[192:193], v[188:189], 0 cbsz:4 abid:2
    v_mfma_f32_4x4x4_16b_bf16 v[152:155], v[192:193], v[188:189], 0 cbsz:4 abid:4
    v_mfma_f32_4x4x4_16b_bf16 v[156:159], v[192:193], v[188:189], 0 cbsz:4 abid:6
    v_mfma_f32_32x32x16_bf16 v[64:79], v[164:167], v[172:175], 0
    v_lshlrev_b32 v196, 3, v197
    v_and_b32 v196, s55, v196
    v_add_u32 v198, 64, v198
    v_add_u32 v199, 64, v199
    v_mfma_f32_32x32x16_bf16 v[80:95], v[164:167], v[180:183], 0
    ds_read_b32 v197, v198 offset:24
    ds_read_b32 v194, v199
    v_mfma_f32_32x32x16_bf16 v[64:79], v[168:171], v[176:179], v[64:79]
    v_mfma_f32_32x32x16_bf16 v[80:95], v[168:171], v[184:187], v[80:95]
    s_set_gpr_idx_on s54, gpr_idx(SRC0,SRC1)
    v_cvt_pk_bf16_f32 v9, v144, v144
    s_set_gpr_idx_off
    v_and_b32 v160, v190, v9
    v_and_b32 v161, v191, v9
    s_waitcnt lgkmcnt(0)
    v_lshrrev_b32 v8, 21, v194
    v_lshl_add_u32 v11, v8, 3, s51
    v_lshl_add_u32 v8, v8, 5, v200
    ds_read_b64 v[192:193], v11
    s_mov_b64 exec, s[86:87]
    ds_read_b128 v[164:167], v8
    s_mov_b64 exec, s[88:89]
    ds_read_b128 v[168:171], v8
    s_mov_b64 exec, -1
    s_cmp_eq_u32 s53, 0
    s_cbranch_scc1 L_f0
    s_cmp_eq_u32 s54, 2
    s_cbranch_scc1 L_j2
    s_cmp_eq_u32 s54, 4
    s_cbranch_scc1 L_j4
    s_cmp_eq_u32 s54, 6
    s_cbranch_scc1 L_j6
    s_cmp_eq_u32 s54, 8
    s_cbranch_scc1 L_j8
    s_cmp_eq_u32 s54, 10
    s_cbranch_scc1 L_j10
    s_cmp_eq_u32 s54, 12
    s_cbranch_scc1 L_j12
    s_cmp_eq_u32 s54, 14
    s_cbranch_scc1 L_j14
    s_branch L_j0
.p2align 3
L_loop:
    s_waitcnt lgkmcnt(0)
.p2align 3
    v_mfma_f32_4x4x4_16b_bf16 v[144:147], v[192:193], v[188:189], 0 cbsz:4 abid:0
    v_mfma_f32_4x4x4_16b_bf16 v[148:151], v[192:193], v[188:189], 0 cbsz:4 abid:2
    v_mfma_f32_4x4x4_16b_bf16 v[152:155], v[192:193], v[188:189], 0 cbsz:4 abid:4
    v_mfma_f32_4x4x4_16b_bf16 v[156:159], v[192:193], v[188:189], 0 cbsz:4 abid:6
    v_mfma_f32_32x32x16_bf16 v[64:79], v[164:167], v[172:175], 0
    v_lshlrev_b32 v196, 3, v197
    v_and_b32 v196, s55, v196
    v_add_u32 v198, 64, v198
    v_add_u32 v199, 64, v199
    v_mfma_f32_32x32x16_bf16 v[80:95], v[164:167], v[180:183], 0
    ds_read_b32 v197, v198 offset:24
    ds_read_b32 v194, v199
    v_mfma_f32_32x32x16_bf16 v[64:79], v[168:171], v[176:179], v[64:79]
    v_cvt_pk_bf16_f32 v9, v144, v144
    v_and_b32 v160, v190, v9
    v_and_b32 v161, v191, v9
    v_mfma_f32_32x32x16_bf16 v[80:95], v[168:171], v[184:187], v[80:95]
L_j0:
    s_waitcnt vmcnt(5)
.p2align 3
    v_mfma_f32_16x16x16_bf16 v[128:131], v[160:161], v[96:97], 0
    v_readlane_b32 s70, v196, 0
    v_cvt_pk_bf16_f32 v10, v145, v145
    v_mfma_f32_16x16x16_bf16 v[132:135], v[160:161], v[98:99], 0
    v_and_b32 v162, v190, v10
    v_and_b32 v163, v191, v10
    s_and_b32 s61, s70, s49
    s_waitcnt vmcnt(4)
    buffer_load_dwordx4 v[120:123], v2, s[16:19], s61 offen
    v_mfma_f32_16x16x16_bf16 v[136:139], v[162:163], v[100:101], 0
    v_readlane_b32 s71, v196, 1
    v_cvt_pk_bf16_f32 v9, v146, v146
    v_mfma_f32_16x16x16_bf16 v[140:143], v[162:163], v[102:103], 0
    v_and_b32 v160, v190, v9
    v_and_b32 v161, v191, v9
    s_and_b32 s61, s71, s49
    s_set_gpr_idx_on s64, gpr_idx(SRC2,DST)
    buffer_load_dwordx4 v[124:127], v2, s[16:19], s61 offen
    v_pk_fma_f32 v[16:17], v[128:129], v[64:65], v[16:17] op_sel_hi:[1,0,1]
    v_pk_fma_f32 v[18:19], v[130:131], v[64:65], v[18:19] op_sel_hi:[1,0,1]
    v_pk_fma_f32 v[20:21], v[132:133], v[80:81], v[20:21] op_sel_hi:[1,0,1]
    v_pk_fma_f32 v[22:23], v[134:135], v[80:81], v[22:23] op_sel_hi:[1,0,1]
    s_set_gpr_idx_idx s65
.p2align 3
    v_pk_fma_f32 v[16:17], v[136:137], v[64:65], v[16:17] op_sel:[0,1,0] op_sel_hi:[1,1,1]
    v_pk_fma_f32 v[18:19], v[138:139], v[64:65], v[18:19] op_sel:[0,1,0] op_sel_hi:[1,1,1]
    v_pk_fma_f32 v[20:21], v[140:141], v[80:81], v[20:21] op_sel:[0,1,0] op_sel_hi:[1,1,1]
    v_pk_fma_f32 v[22:23], v[142:143], v[80:81], v[22:23] op_sel:[0,1,0] op_sel_hi:[1,1,1]
    s_set_gpr_idx_off
L_j2:
    s_waitcnt vmcnt(5)
.p2align 3
    v_mfma_f32_16x16x16_bf16 v[128:131], v[160:161], v[104:105], 0
    v_readlane_b32 s64, v196, 2
    v_cvt_pk_bf16_f32 v10, v147, v147
    v_mfma_f32_16x16x16_bf16 v[132:135], v[160:161], v[106:107], 0
    v_and_b32 v162, v190, v10
    v_and_b32 v163, v191, v10
    s_and_b32 s61, s64, s49
    s_waitcnt vmcnt(4)
    buffer_load_dwordx4 v[96:99], v2, s[16:19], s61 offen
    v_mfma_f32_16x16x16_bf16 v[136:139], v[162:163], v[108:109], 0
    v_readlane_b32 s65, v196, 3
    v_cvt_pk_bf16_f32 v9, v148, v148
    v_mfma_f32_16x16x16_bf16 v[140:143], v[162:163], v[110:111], 0
    v_and_b32 v160, v190, v9
    v_and_b32 v161, v191, v9
    s_waitcnt lgkmcnt(0)
    v_lshrrev_b32 v8, 21, v194
    v_lshl_add_u32 v11, v8, 3, s51
    v_lshl_add_u32 v8, v8, 5, v200
    ds_read_b64 v[192:193], v11
    s_mov_b64 exec, s[86:87]
    ds_read_b128 v[164:167], v8
    s_mov_b64 exec, s[88:89]
    ds_read_b128 v[168:171], v8
    s_mov_b64 exec, -1
.p2align 3
    s_and_b32 s61, s65, s49
    s_set_gpr_idx_on s66, gpr_idx(SRC2,DST)
    buffer_load_dwordx4 v[100:103], v2, s[16:19], s61 offen
    v_pk_fma_f32 v[16:17], v[128:129], v[66:67], v[16:17] op_sel_hi:[1,0,1]
    v_pk_fma_f32 v[18:19], v[130:131], v[66:67], v[18:19] op_sel_hi:[1,0,1]
    v_pk_fma_f32 v[20:21], v[132:133], v[82:83], v[20:21] op_sel_hi:[1,0,1]
    v_pk_fma_f32 v[22:23], v[134:135], v[82:83], v[22:23] op_sel_hi:[1,0,1]
    s_set_gpr_idx_idx s67
.p2align 3
    v_pk_fma_f32 v[16:17], v[136:137], v[66:67], v[16:17] op_sel:[0,1,0] op_sel_hi:[1,1,1]
    v_pk_fma_f32 v[18:19], v[138:139], v[66:67], v[18:19] op_sel:[0,1,0] op_sel_hi:[1,1,1]
    v_pk_fma_f32 v[20:21], v[140:141], v[82:83], v[20:21] op_sel:[0,1,0] op_sel_hi:[1,1,1]
    v_pk_fma_f32 v[22:23], v[142:143], v[82:83], v[22:23] op_sel:[0,1,0] op_sel_hi:[1,1,1]
    s_set_gpr_idx_off
L_j4:
    s_waitcnt vmcnt(5)
.p2align 3
    v_mfma_f32_16x16x16_bf16 v[128:131], v[160:161], v[112:113], 0
    v_readlane_b32 s66, v196, 4
    v_cvt_pk_bf16_f32 v10, v149, v149
    v_mfma_f32_16x16x16_bf16 v[132:135], v[160:161], v[114:115], 0
    v_and_b32 v162, v190, v10
    v_and_b32 v163, v191, v10
    s_and_b32 s61, s66, s49
    s_waitcnt vmcnt(4)
    buffer_load_dwordx4 v[104:107], v2, s[16:19], s61 offen
    v_mfma_f32_16x16x16_bf16 v[136:139], v[162:163], v[116:117], 0
    v_readlane_b32 s67, v196, 5
    v_cvt_pk_bf16_f32 v9, v150, v150
    v_mfma_f32_16x16x16_bf16 v[140:143], v[162:163], v[118:119], 0
    v_and_b32 v160, v190, v9
    v_and_b32 v161, v191, v9
    s_and_b32 s61, s67, s49
    s_set_gpr_idx_on s68, gpr_idx(SRC2,DST)
    buffer_load_dwordx4 v[108:111], v2, s[16:19], s61 offen
    v_pk_fma_f32 v[16:17], v[128:129], v[68:69], v[16:17] op_sel_hi:[1,0,1]
    v_pk_fma_f32 v[18:19], v[130:131], v[68:69], v[18:19] op_sel_hi:[1,0,1]
    v_pk_fma_f32 v[20:21], v[132:133], v[84:85], v[20:21] op_sel_hi:[1,0,1]
    v_pk_fma_f32 v[22:23], v[134:135], v[84:85], v[22:23] op_sel_hi:[1,0,1]
    s_set_gpr_idx_idx s69
.p2align 3
    v_pk_fma_f32 v[16:17], v[136:137], v[68:69], v[16:17] op_sel:[0,1,0] op_sel_hi:[1,1,1]
    v_pk_fma_f32 v[18:19], v[138:139], v[68:69], v[18:19] op_sel:[0,1,0] op_sel_hi:[1,1,1]
    v_pk_fma_f32 v[20:21], v[140:141], v[84:85], v[20:21] op_sel:[0,1,0] op_sel_hi:[1,1,1]
    v_pk_fma_f32 v[22:23], v[142:143], v[84:85], v[22:23] op_sel:[0,1,0] op_sel_hi:[1,1,1]
    s_set_gpr_idx_off
L_j6:
    s_waitcnt vmcnt(5)
.p2align 3
    v_mfma_f32_16x16x16_bf16 v[128:131], v[160:161], v[120:121], 0
    v_readlane_b32 s68, v196, 6
    v_cvt_pk_bf16_f32 v10, v151, v151
    v_mfma_f32_16x16x16_bf16 v[132:135], v[160:161], v[122:123], 0
    v_and_b32 v162, v190, v10
    v_and_b32 v163, v191, v10
    s_and_b32 s61, s68, s49
    s_waitcnt vmcnt(4)
    buffer_load_dwordx4 v[112:115], v2, s[16:19], s61 offen
    v_mfma_f32_16x16x16_bf16 v[136:139], v[162:163], v[124:125], 0
    v_readlane_b32 s69, v196, 7
    v_cvt_pk_bf16_f32 v9, v152, v152
    v_mfma_f32_16x16x16_bf16 v[140:143], v[162:163], v[126:127], 0
    v_and_b32 v160, v190, v9
    v_and_b32 v161, v191, v9
    s_and_b32 s61, s69, s49
    s_set_gpr_idx_on s70, gpr_idx(SRC2,DST)
    buffer_load_dwordx4 v[116:119], v2, s[16:19], s61 offen
    v_pk_fma_f32 v[16:17], v[128:129], v[70:71], v[16:17] op_sel_hi:[1,0,1]
    v_pk_fma_f32 v[18:19], v[130:131], v[70:71], v[18:19] op_sel_hi:[1,0,1]
    v_pk_fma_f32 v[20:21], v[132:133], v[86:87], v[20:21] op_sel_hi:[1,0,1]
    v_pk_fma_f32 v[22:23], v[134:135], v[86:87], v[22:23] op_sel_hi:[1,0,1]
    s_set_gpr_idx_idx s71
.p2align 3
    v_pk_fma_f32 v[16:17], v[136:137], v[70:71], v[16:17] op_sel:[0,1,0] op_sel_hi:[1,1,1]
    v_pk_fma_f32 v[18:19], v[138:139], v[70:71], v[18:19] op_sel:[0,1,0] op_sel_hi:[1,1,1]
    v_pk_fma_f32 v[20:21], v[140:141], v[86:87], v[20:21] op_sel:[0,1,0] op_sel_hi:[1,1,1]
    v_pk_fma_f32 v[22:23], v[142:143], v[86:87], v[22:23] op_sel:[0,1,0] op_sel_hi:[1,1,1]
    s_set_gpr_idx_off
L_j8:
    s_waitcnt vmcnt(5)
.p2align 3
    v_mfma_f32_16x16x16_bf16 v[128:131], v[160:161], v[96:97], 0
    v_readlane_b32 s70, v196, 8
    v_cvt_pk_bf16_f32 v10, v153, v153
    v_mfma_f32_16x16x16_bf16 v[132:135], v[160:161], v[98:99], 0
    v_and_b32 v162, v190, v10
    v_and_b32 v163, v191, v10
    s_and_b32 s61, s70, s49
    s_waitcnt vmcnt(4)
    buffer_load_dwordx4 v[120:123], v2, s[16:19], s61 offen
    v_mfma_f32_16x16x16_bf16 v[136:139], v[162:163], v[100:101], 0
    v_readlane_b32 s71, v196, 9
    v_cvt_pk_bf16_f32 v9, v154, v154
    v_mfma_f32_16x16x16_bf16 v[140:143], v[162:163], v[102:103], 0
    v_and_b32 v160, v190, v9
    v_and_b32 v161, v191, v9
    s_and_b32 s61, s71, s49
    s_set_gpr_idx_on s64, gpr_idx(SRC2,DST)
    buffer_load_dwordx4 v[124:127], v2, s[16:19], s61 offen
    v_pk_fma_f32 v[16:17], v[128:129], v[72:73], v[16:17] op_sel_hi:[1,0,1]
    v_pk_fma_f32 v[18:19], v[130:131], v[72:73], v[18:19] op_sel_hi:[1,0,1]
    v_pk_fma_f32 v[20:21], v[132:133], v[88:89], v[20:21] op_sel_hi:[1,0,1]
    v_pk_fma_f32 v[22:23], v[134:135], v[88:89], v[22:23] op_sel_hi:[1,0,1]
    s_set_gpr_idx_idx s65
.p2align 3
    v_pk_fma_f32 v[16:17], v[136:137], v[72:73], v[16:17] op_sel:[0,1,0] op_sel_hi:[1,1,1]
    v_pk_fma_f32 v[18:19], v[138:139], v[72:73], v[18:19] op_sel:[0,1,0] op_sel_hi:[1,1,1]
    v_pk_fma_f32 v[20:21], v[140:141], v[88:89], v[20:21] op_sel:[0,1,0] op_sel_hi:[1,1,1]
    v_pk_fma_f32 v[22:23], v[142:143], v[88:89], v[22:23] op_sel:[0,1,0] op_sel_hi:[1,1,1]
    s_set_gpr_idx_off
L_j10:
    s_waitcnt vmcnt(5)
.p2align 3
    v_mfma_f32_16x16x16_bf16 v[128:131], v[160:161], v[104:105], 0
    v_readlane_b32 s64, v196, 10
    v_cvt_pk_bf16_f32 v10, v155, v155
    v_mfma_f32_16x16x16_bf16 v[132:135], v[160:161], v[106:107], 0
    v_and_b32 v162, v190, v10
    v_and_b32 v163, v191, v10
    s_and_b32 s61, s64, s49
    s_waitcnt vmcnt(4)
    buffer_load_dwordx4 v[96:99], v2, s[16:19], s61 offen
    v_mfma_f32_16x16x16_bf16 v[136:139], v[162:163], v[108:109], 0
    v_readlane_b32 s65, v196, 11
    v_cvt_pk_bf16_f32 v9, v156, v156
    v_mfma_f32_16x16x16_bf16 v[140:143], v[162:163], v[110:111], 0
    v_and_b32 v160, v190, v9
    v_and_b32 v161, v191, v9
    s_and_b32 s61, s65, s49
    s_set_gpr_idx_on s66, gpr_idx(SRC2,DST)
    buffer_load_dwordx4 v[100:103], v2, s[16:19], s61 offen
    v_pk_fma_f32 v[16:17], v[128:129], v[74:75], v[16:17] op_sel_hi:[1,0,1]
    v_pk_fma_f32 v[18:19], v[130:131], v[74:75], v[18:19] op_sel_hi:[1,0,1]
    v_pk_fma_f32 v[20:21], v[132:133], v[90:91], v[20:21] op_sel_hi:[1,0,1]
    v_pk_fma_f32 v[22:23], v[134:135], v[90:91], v[22:23] op_sel_hi:[1,0,1]
    s_set_gpr_idx_idx s67
.p2align 3
    v_pk_fma_f32 v[16:17], v[136:137], v[74:75], v[16:17] op_sel:[0,1,0] op_sel_hi:[1,1,1]
    v_pk_fma_f32 v[18:19], v[138:139], v[74:75], v[18:19] op_sel:[0,1,0] op_sel_hi:[1,1,1]
    v_pk_fma_f32 v[20:21], v[140:141], v[90:91], v[20:21] op_sel:[0,1,0] op_sel_hi:[1,1,1]
    v_pk_fma_f32 v[22:23], v[142:143], v[90:91], v[22:23] op_sel:[0,1,0] op_sel_hi:[1,1,1]
    s_set_gpr_idx_off
L_j12:
    s_waitcnt vmcnt(5)
.p2align 3
    v_mfma_f32_16x16x16_bf16 v[128:131], v[160:161], v[112:113], 0
    v_readlane_b32 s66, v196, 12
    v_cvt_pk_bf16_f32 v10, v157, v157
    v_mfma_f32_16x16x16_bf16 v[132:135], v[160:161], v[114:115], 0
    v_and_b32 v162, v190, v10
    v_and_b32 v163, v191, v10
    s_and_b32 s61, s66, s49
    s_waitcnt vmcnt(4)
    buffer_load_dwordx4 v[104:107], v2, s[16:19], s61 offen
    v_mfma_f32_16x16x16_bf16 v[136:139], v[162:163], v[116:117], 0
    v_readlane_b32 s67, v196, 13
    v_cvt_pk_bf16_f32 v9, v158, v158
    v_mfma_f32_16x16x16_bf16 v[140:143], v[162:163], v[118:119], 0
    v_and_b32 v160, v190, v9
    v_and_b32 v161, v191, v9
    s_and_b32 s61, s67, s49
    s_set_gpr_idx_on s68, gpr_idx(SRC2,DST)
    buffer_load_dwordx4 v[108:111], v2, s[16:19], s61 offen
    v_pk_fma_f32 v[16:17], v[128:129], v[76:77], v[16:17] op_sel_hi:[1,0,1]
    v_pk_fma_f32 v[18:19], v[130:131], v[76:77], v[18:19] op_sel_hi:[1,0,1]
    v_pk_fma_f32 v[20:21], v[132:133], v[92:93], v[20:21] op_sel_hi:[1,0,1]
    v_pk_fma_f32 v[22:23], v[134:135], v[92:93], v[22:23] op_sel_hi:[1,0,1]
    s_set_gpr_idx_idx s69
.p2align 3
    v_pk_fma_f32 v[16:17], v[136:137], v[76:77], v[16:17] op_sel:[0,1,0] op_sel_hi:[1,1,1]
    v_pk_fma_f32 v[18:19], v[138:139], v[76:77], v[18:19] op_sel:[0,1,0] op_sel_hi:[1,1,1]
    v_pk_fma_f32 v[20:21], v[140:141], v[92:93], v[20:21] op_sel:[0,1,0] op_sel_hi:[1,1,1]
    v_pk_fma_f32 v[22:23], v[142:143], v[92:93], v[22:23] op_sel:[0,1,0] op_sel_hi:[1,1,1]
    s_set_gpr_idx_off
L_j14:
    s_waitcnt vmcnt(5)
.p2align 3
    v_mfma_f32_16x16x16_bf16 v[128:131], v[160:161], v[120:121], 0
    v_readlane_b32 s68, v196, 14
    v_cvt_pk_bf16_f32 v10, v159, v159
    v_mfma_f32_16x16x16_bf16 v[132:135], v[160:161], v[122:123], 0
    v_and_b32 v162, v190, v10
    v_and_b32 v163, v191, v10
    s_and_b32 s61, s68, s49
    s_waitcnt vmcnt(4)
    buffer_load_dwordx4 v[112:115], v2, s[16:19], s61 offen
    v_mfma_f32_16x16x16_bf16 v[136:139], v[162:163], v[124:125], 0
    v_readlane_b32 s69, v196, 15
    v_mfma_f32_16x16x16_bf16 v[140:143], v[162:163], v[126:127], 0
    s_and_b32 s61, s69, s49
    s_set_gpr_idx_on s70, gpr_idx(SRC2,DST)
    buffer_load_dwordx4 v[116:119], v2, s[16:19], s61 offen
    v_pk_fma_f32 v[16:17], v[128:129], v[78:79], v[16:17] op_sel_hi:[1,0,1]
    v_pk_fma_f32 v[18:19], v[130:131], v[78:79], v[18:19] op_sel_hi:[1,0,1]
    v_pk_fma_f32 v[20:21], v[132:133], v[94:95], v[20:21] op_sel_hi:[1,0,1]
    v_pk_fma_f32 v[22:23], v[134:135], v[94:95], v[22:23] op_sel_hi:[1,0,1]
    s_set_gpr_idx_idx s71
    s_sub_u32 s53, s53, 1
.p2align 3
    v_pk_fma_f32 v[16:17], v[136:137], v[78:79], v[16:17] op_sel:[0,1,0] op_sel_hi:[1,1,1]
    v_pk_fma_f32 v[18:19], v[138:139], v[78:79], v[18:19] op_sel:[0,1,0] op_sel_hi:[1,1,1]
    v_pk_fma_f32 v[20:21], v[140:141], v[94:95], v[20:21] op_sel:[0,1,0] op_sel_hi:[1,1,1]
    v_pk_fma_f32 v[22:23], v[142:143], v[94:95], v[22:23] op_sel:[0,1,0] op_sel_hi:[1,1,1]
    s_set_gpr_idx_off
    s_cmp_lg_u32 s53, 0
    s_cbranch_scc1 L_loop
    s_waitcnt lgkmcnt(0)
.p2align 3
    v_mfma_f32_4x4x4_16b_bf16 v[144:147], v[192:193], v[188:189], 0 cbsz:4 abid:0
    v_mfma_f32_4x4x4_16b_bf16 v[148:151], v[192:193], v[188:189], 0 cbsz:4 abid:2
    v_mfma_f32_4x4x4_16b_bf16 v[152:155], v[192:193], v[188:189], 0 cbsz:4 abid:4
    v_mfma_f32_4x4x4_16b_bf16 v[156:159], v[192:193], v[188:189], 0 cbsz:4 abid:6
    v_mfma_f32_32x32x16_bf16 v[64:79], v[164:167], v[172:175], 0
    v_lshlrev_b32 v196, 3, v197
    v_and_b32 v196, s55, v196
    v_mfma_f32_32x32x16_bf16 v[80:95], v[164:167], v[180:183], 0
    v_mfma_f32_32x32x16_bf16 v[64:79], v[168:171], v[176:179], v[64:79]
    v_cvt_pk_bf16_f32 v9, v144, v144
    v_and_b32 v160, v190, v9
    v_and_b32 v161, v191, v9
    v_mfma_f32_32x32x16_bf16 v[80:95], v[168:171], v[184:187], v[80:95]
L_f0:
    s_waitcnt vmcnt(5)
.p2align 3
    v_mfma_f32_16x16x16_bf16 v[128:131], v[160:161], v[96:97], 0
    v_readlane_b32 s70, v196, 0
    v_cvt_pk_bf16_f32 v10, v145, v145
    v_mfma_f32_16x16x16_bf16 v[132:135], v[160:161], v[98:99], 0
    v_and_b32 v162, v190, v10
    v_and_b32 v163, v191, v10
    s_and_b32 s61, s70, s49
    s_waitcnt vmcnt(4)
    buffer_load_dwordx4 v[120:123], v2, s[16:19], s61 offen
    v_mfma_f32_16x16x16_bf16 v[136:139], v[162:163], v[100:101], 0
    v_readlane_b32 s71, v196, 1
    v_cvt_pk_bf16_f32 v9, v146, v146
    v_mfma_f32_16x16x16_bf16 v[140:143], v[162:163], v[102:103], 0
    v_and_b32 v160, v190, v9
    v_and_b32 v161, v191, v9
    s_and_b32 s61, s71, s49
    s_set_gpr_idx_on s64, gpr_idx(SRC2,DST)
    buffer_load_dwordx4 v[124:127], v2, s[16:19], s61 offen
    v_pk_fma_f32 v[16:17], v[128:129], v[64:65], v[16:17] op_sel_hi:[1,0,1]
    v_pk_fma_f32 v[18:19], v[130:131], v[64:65], v[18:19] op_sel_hi:[1,0,1]
    v_pk_fma_f32 v[20:21], v[132:133], v[80:81], v[20:21] op_sel_hi:[1,0,1]
    v_pk_fma_f32 v[22:23], v[134:135], v[80:81], v[22:23] op_sel_hi:[1,0,1]
    s_set_gpr_idx_idx s65
.p2align 3
    v_pk_fma_f32 v[16:17], v[136:137], v[64:65], v[16:17] op_sel:[0,1,0] op_sel_hi:[1,1,1]
    v_pk_fma_f32 v[18:19], v[138:139], v[64:65], v[18:19] op_sel:[0,1,0] op_sel_hi:[1,1,1]
    v_pk_fma_f32 v[20:21], v[140:141], v[80:81], v[20:21] op_sel:[0,1,0] op_sel_hi:[1,1,1]
    v_pk_fma_f32 v[22:23], v[142:143], v[80:81], v[22:23] op_sel:[0,1,0] op_sel_hi:[1,1,1]
    s_set_gpr_idx_off
    s_waitcnt vmcnt(5)
.p2align 3
    v_mfma_f32_16x16x16_bf16 v[128:131], v[160:161], v[104:105], 0
    v_readlane_b32 s64, v196, 2
    v_cvt_pk_bf16_f32 v10, v147, v147
    v_mfma_f32_16x16x16_bf16 v[132:135], v[160:161], v[106:107], 0
    v_and_b32 v162, v190, v10
    v_and_b32 v163, v191, v10
    s_and_b32 s61, s64, s49
    s_waitcnt vmcnt(4)
    buffer_load_dwordx4 v[96:99], v2, s[16:19], s61 offen
    v_mfma_f32_16x16x16_bf16 v[136:139], v[162:163], v[108:109], 0
    v_readlane_b32 s65, v196, 3
    v_cvt_pk_bf16_f32 v9, v148, v148
    v_mfma_f32_16x16x16_bf16 v[140:143], v[162:163], v[110:111], 0
    v_and_b32 v160, v190, v9
    v_and_b32 v161, v191, v9
    s_and_b32 s61, s65, s49
    s_set_gpr_idx_on s66, gpr_idx(SRC2,DST)
    buffer_load_dwordx4 v[100:103], v2, s[16:19], s61 offen
    v_pk_fma_f32 v[16:17], v[128:129], v[66:67], v[16:17] op_sel_hi:[1,0,1]
    v_pk_fma_f32 v[18:19], v[130:131], v[66:67], v[18:19] op_sel_hi:[1,0,1]
    v_pk_fma_f32 v[20:21], v[132:133], v[82:83], v[20:21] op_sel_hi:[1,0,1]
    v_pk_fma_f32 v[22:23], v[134:135], v[82:83], v[22:23] op_sel_hi:[1,0,1]
    s_set_gpr_idx_idx s67
.p2align 3
    v_pk_fma_f32 v[16:17], v[136:137], v[66:67], v[16:17] op_sel:[0,1,0] op_sel_hi:[1,1,1]
    v_pk_fma_f32 v[18:19], v[138:139], v[66:67], v[18:19] op_sel:[0,1,0] op_sel_hi:[1,1,1]
    v_pk_fma_f32 v[20:21], v[140:141], v[82:83], v[20:21] op_sel:[0,1,0] op_sel_hi:[1,1,1]
    v_pk_fma_f32 v[22:23], v[142:143], v[82:83], v[22:23] op_sel:[0,1,0] op_sel_hi:[1,1,1]
    s_set_gpr_idx_off
    s_waitcnt vmcnt(5)
.p2align 3
    v_mfma_f32_16x16x16_bf16 v[128:131], v[160:161], v[112:113], 0
    v_readlane_b32 s66, v196, 4
    v_cvt_pk_bf16_f32 v10, v149, v149
    v_mfma_f32_16x16x16_bf16 v[132:135], v[160:161], v[114:115], 0
    v_and_b32 v162, v190, v10
    v_and_b32 v163, v191, v10
    s_and_b32 s61, s66, s49
    s_waitcnt vmcnt(4)
    buffer_load_dwordx4 v[104:107], v2, s[16:19], s61 offen
    v_mfma_f32_16x16x16_bf16 v[136:139], v[162:163], v[116:117], 0
    v_readlane_b32 s67, v196, 5
    v_cvt_pk_bf16_f32 v9, v150, v150
    v_mfma_f32_16x16x16_bf16 v[140:143], v[162:163], v[118:119], 0
    v_and_b32 v160, v190, v9
    v_and_b32 v161, v191, v9
    s_and_b32 s61, s67, s49
    s_set_gpr_idx_on s68, gpr_idx(SRC2,DST)
    buffer_load_dwordx4 v[108:111], v2, s[16:19], s61 offen
    v_pk_fma_f32 v[16:17], v[128:129], v[68:69], v[16:17] op_sel_hi:[1,0,1]
    v_pk_fma_f32 v[18:19], v[130:131], v[68:69], v[18:19] op_sel_hi:[1,0,1]
    v_pk_fma_f32 v[20:21], v[132:133], v[84:85], v[20:21] op_sel_hi:[1,0,1]
    v_pk_fma_f32 v[22:23], v[134:135], v[84:85], v[22:23] op_sel_hi:[1,0,1]
    s_set_gpr_idx_idx s69
.p2align 3
    v_pk_fma_f32 v[16:17], v[136:137], v[68:69], v[16:17] op_sel:[0,1,0] op_sel_hi:[1,1,1]
    v_pk_fma_f32 v[18:19], v[138:139], v[68:69], v[18:19] op_sel:[0,1,0] op_sel_hi:[1,1,1]
    v_pk_fma_f32 v[20:21], v[140:141], v[84:85], v[20:21] op_sel:[0,1,0] op_sel_hi:[1,1,1]
    v_pk_fma_f32 v[22:23], v[142:143], v[84:85], v[22:23] op_sel:[0,1,0] op_sel_hi:[1,1,1]
    s_set_gpr_idx_off
    s_waitcnt vmcnt(5)
.p2align 3
    v_mfma_f32_16x16x16_bf16 v[128:131], v[160:161], v[120:121], 0
    v_readlane_b32 s68, v196, 6
    v_cvt_pk_bf16_f32 v10, v151, v151
    v_mfma_f32_16x16x16_bf16 v[132:135], v[160:161], v[122:123], 0
    v_and_b32 v162, v190, v10
    v_and_b32 v163, v191, v10
    s_and_b32 s61, s68, s49
    s_waitcnt vmcnt(4)
    buffer_load_dwordx4 v[112:115], v2, s[16:19], s61 offen
    v_mfma_f32_16x16x16_bf16 v[136:139], v[162:163], v[124:125], 0
    v_readlane_b32 s69, v196, 7
    v_cvt_pk_bf16_f32 v9, v152, v152
    v_mfma_f32_16x16x16_bf16 v[140:143], v[162:163], v[126:127], 0
    v_and_b32 v160, v190, v9
    v_and_b32 v161, v191, v9
    s_and_b32 s61, s69, s49
    s_set_gpr_idx_on s70, gpr_idx(SRC2,DST)
    buffer_load_dwordx4 v[116:119], v2, s[16:19], s61 offen
    v_pk_fma_f32 v[16:17], v[128:129], v[70:71], v[16:17] op_sel_hi:[1,0,1]
    v_pk_fma_f32 v[18:19], v[130:131], v[70:71], v[18:19] op_sel_hi:[1,0,1]
    v_pk_fma_f32 v[20:21], v[132:133], v[86:87], v[20:21] op_sel_hi:[1,0,1]
    v_pk_fma_f32 v[22:23], v[134:135], v[86:87], v[22:23] op_sel_hi:[1,0,1]
    s_set_gpr_idx_idx s71
.p2align 3
    v_pk_fma_f32 v[16:17], v[136:137], v[70:71], v[16:17] op_sel:[0,1,0] op_sel_hi:[1,1,1]
    v_pk_fma_f32 v[18:19], v[138:139], v[70:71], v[18:19] op_sel:[0,1,0] op_sel_hi:[1,1,1]
    v_pk_fma_f32 v[20:21], v[140:141], v[86:87], v[20:21] op_sel:[0,1,0] op_sel_hi:[1,1,1]
    v_pk_fma_f32 v[22:23], v[142:143], v[86:87], v[22:23] op_sel:[0,1,0] op_sel_hi:[1,1,1]
    s_set_gpr_idx_off
    s_waitcnt vmcnt(5)
.p2align 3
    v_mfma_f32_16x16x16_bf16 v[128:131], v[160:161], v[96:97], 0
    v_readlane_b32 s70, v196, 8
    v_cvt_pk_bf16_f32 v10, v153, v153
    v_mfma_f32_16x16x16_bf16 v[132:135], v[160:161], v[98:99], 0
    v_and_b32 v162, v190, v10
    v_and_b32 v163, v191, v10
    s_and_b32 s61, s70, s49
    s_waitcnt vmcnt(4)
    buffer_load_dwordx4 v[120:123], v2, s[16:19], s61 offen
    v_mfma_f32_16x16x16_bf16 v[136:139], v[162:163], v[100:101], 0
    v_readlane_b32 s71, v196, 9
    v_cvt_pk_bf16_f32 v9, v154, v154
    v_mfma_f32_16x16x16_bf16 v[140:143], v[162:163], v[102:103], 0
    v_and_b32 v160, v190, v9
    v_and_b32 v161, v191, v9
    s_and_b32 s61, s71, s49
    s_set_gpr_idx_on s64, gpr_idx(SRC2,DST)
    buffer_load_dwordx4 v[124:127], v2, s[16:19], s61 offen
    v_pk_fma_f32 v[16:17], v[128:129], v[72:73], v[16:17] op_sel_hi:[1,0,1]
    v_pk_fma_f32 v[18:19], v[130:131], v[72:73], v[18:19] op_sel_hi:[1,0,1]
    v_pk_fma_f32 v[20:21], v[132:133], v[88:89], v[20:21] op_sel_hi:[1,0,1]
    v_pk_fma_f32 v[22:23], v[134:135], v[88:89], v[22:23] op_sel_hi:[1,0,1]
    s_set_gpr_idx_idx s65
.p2align 3
    v_pk_fma_f32 v[16:17], v[136:137], v[72:73], v[16:17] op_sel:[0,1,0] op_sel_hi:[1,1,1]
    v_pk_fma_f32 v[18:19], v[138:139], v[72:73], v[18:19] op_sel:[0,1,0] op_sel_hi:[1,1,1]
    v_pk_fma_f32 v[20:21], v[140:141], v[88:89], v[20:21] op_sel:[0,1,0] op_sel_hi:[1,1,1]
    v_pk_fma_f32 v[22:23], v[142:143], v[88:89], v[22:23] op_sel:[0,1,0] op_sel_hi:[1,1,1]
    s_set_gpr_idx_off
    s_waitcnt vmcnt(5)
.p2align 3
    v_mfma_f32_16x16x16_bf16 v[128:131], v[160:161], v[104:105], 0
    v_cvt_pk_bf16_f32 v10, v155, v155
    v_mfma_f32_16x16x16_bf16 v[132:135], v[160:161], v[106:107], 0
    v_and_b32 v162, v190, v10
    v_and_b32 v163, v191, v10
    s_waitcnt vmcnt(4)
.p2align 3
    s_nop 0
    v_mfma_f32_16x16x16_bf16 v[136:139], v[162:163], v[108:109], 0
    v_cvt_pk_bf16_f32 v9, v156, v156
    v_mfma_f32_16x16x16_bf16 v[140:143], v[162:163], v[110:111], 0
    v_and_b32 v160, v190, v9
    v_and_b32 v161, v191, v9
    s_set_gpr_idx_on s66, gpr_idx(SRC2,DST)
.p2align 3
    v_pk_fma_f32 v[16:17], v[128:129], v[74:75], v[16:17] op_sel_hi:[1,0,1]
    v_pk_fma_f32 v[18:19], v[130:131], v[74:75], v[18:19] op_sel_hi:[1,0,1]
    v_pk_fma_f32 v[20:21], v[132:133], v[90:91], v[20:21] op_sel_hi:[1,0,1]
    v_pk_fma_f32 v[22:23], v[134:135], v[90:91], v[22:23] op_sel_hi:[1,0,1]
    s_set_gpr_idx_idx s67
.p2align 3
    v_pk_fma_f32 v[16:17], v[136:137], v[74:75], v[16:17] op_sel:[0,1,0] op_sel_hi:[1,1,1]
    v_pk_fma_f32 v[18:19], v[138:139], v[74:75], v[18:19] op_sel:[0,1,0] op_sel_hi:[1,1,1]
    v_pk_fma_f32 v[20:21], v[140:141], v[90:91], v[20:21] op_sel:[0,1,0] op_sel_hi:[1,1,1]
    v_pk_fma_f32 v[22:23], v[142:143], v[90:91], v[22:23] op_sel:[0,1,0] op_sel_hi:[1,1,1]
    s_set_gpr_idx_off
    s_waitcnt vmcnt(3)
.p2align 3
    v_mfma_f32_16x16x16_bf16 v[128:131], v[160:161], v[112:113], 0
    v_cvt_pk_bf16_f32 v10, v157, v157
    v_mfma_f32_16x16x16_bf16 v[132:135], v[160:161], v[114:115], 0
    v_and_b32 v162, v190, v10
    v_and_b32 v163, v191, v10
    s_waitcnt vmcnt(2)
.p2align 3
    s_nop 0
    v_mfma_f32_16x16x16_bf16 v[136:139], v[162:163], v[116:117], 0
    v_cvt_pk_bf16_f32 v9, v158, v158
    v_mfma_f32_16x16x16_bf16 v[140:143], v[162:163], v[118:119], 0
    v_and_b32 v160, v190, v9
    v_and_b32 v161, v191, v9
    s_set_gpr_idx_on s68, gpr_idx(SRC2,DST)
.p2align 3
    v_pk_fma_f32 v[16:17], v[128:129], v[76:77], v[16:17] op_sel_hi:[1,0,1]
    v_pk_fma_f32 v[18:19], v[130:131], v[76:77], v[18:19] op_sel_hi:[1,0,1]
    v_pk_fma_f32 v[20:21], v[132:133], v[92:93], v[20:21] op_sel_hi:[1,0,1]
    v_pk_fma_f32 v[22:23], v[134:135], v[92:93], v[22:23] op_sel_hi:[1,0,1]
    s_set_gpr_idx_idx s69
.p2align 3
    v_pk_fma_f32 v[16:17], v[136:137], v[76:77], v[16:17] op_sel:[0,1,0] op_sel_hi:[1,1,1]
    v_pk_fma_f32 v[18:19], v[138:139], v[76:77], v[18:19] op_sel:[0,1,0] op_sel_hi:[1,1,1]
    v_pk_fma_f32 v[20:21], v[140:141], v[92:93], v[20:21] op_sel:[0,1,0] op_sel_hi:[1,1,1]
    v_pk_fma_f32 v[22:23], v[142:143], v[92:93], v[22:23] op_sel:[0,1,0] op_sel_hi:[1,1,1]
    s_set_gpr_idx_off
    s_waitcnt vmcnt(1)
.p2align 3
    v_mfma_f32_16x16x16_bf16 v[128:131], v[160:161], v[120:121], 0
    v_cvt_pk_bf16_f32 v10, v159, v159
    v_mfma_f32_16x16x16_bf16 v[132:135], v[160:161], v[122:123], 0
    v_and_b32 v162, v190, v10
    v_and_b32 v163, v191, v10
    s_waitcnt vmcnt(0)
.p2align 3
    s_nop 0
    v_mfma_f32_16x16x16_bf16 v[136:139], v[162:163], v[124:125], 0
    v_mfma_f32_16x16x16_bf16 v[140:143], v[162:163], v[126:127], 0
    s_set_gpr_idx_on s70, gpr_idx(SRC2,DST)
.p2align 3
    v_pk_fma_f32 v[16:17], v[128:129], v[78:79], v[16:17] op_sel_hi:[1,0,1]
    v_pk_fma_f32 v[18:19], v[130:131], v[78:79], v[18:19] op_sel_hi:[1,0,1]
    v_pk_fma_f32 v[20:21], v[132:133], v[94:95], v[20:21] op_sel_hi:[1,0,1]
    v_pk_fma_f32 v[22:23], v[134:135], v[94:95], v[22:23] op_sel_hi:[1,0,1]
    s_set_gpr_idx_idx s71
.p2align 3
    s_nop 0
    v_pk_fma_f32 v[16:17], v[136:137], v[78:79], v[16:17] op_sel:[0,1,0] op_sel_hi:[1,1,1]
    v_pk_fma_f32 v[18:19], v[138:139], v[78:79], v[18:19] op_sel:[0,1,0] op_sel_hi:[1,1,1]
    v_pk_fma_f32 v[20:21], v[140:141], v[94:95], v[20:21] op_sel:[0,1,0] op_sel_hi:[1,1,1]
    v_pk_fma_f32 v[22:23], v[142:143], v[94:95], v[22:23] op_sel:[0,1,0] op_sel_hi:[1,1,1]
    s_set_gpr_idx_off
L_swept:
    s_add_u32 s48, s48, 256
    s_cmp_lt_u32 s48, s47
    s_cbranch_scc1 L_again
    v_lshlrev_b32 v8, 2, v1
    s_mul_i32 s54, s56, 9
    v_cvt_pk_bf16_f32 v64, v16, v20
    v_cvt_pk_bf16_f32 v65, v17, v21
    v_cvt_pk_bf16_f32 v66, v18, v22
    v_cvt_pk_bf16_f32 v67, v19, v23
    v_add_u32 v84, s54, v8
    ds_write2_b32 v84, v64, v65 offset0:0 offset1:72
    ds_write2_b32 v84, v66, v67 offset0:144 offset1:216
    s_mul_i32 s54, s57, 9
    v_cvt_pk_bf16_f32 v68, v24, v28
    v_cvt_pk_bf16_f32 v69, v25, v29
    v_cvt_pk_bf16_f32 v70, v26, v30
    v_cvt_pk_bf16_f32 v71, v27, v31
    v_add_u32 v85, s54, v8
    ds_write2_b32 v85, v68, v69 offset0:0 offset1:72
    ds_write2_b32 v85, v70, v71 offset0:144 offset1:216
    s_mul_i32 s54, s58, 9
    v_cvt_pk_bf16_f32 v72, v32, v36
    v_cvt_pk_bf16_f32 v73, v33, v37
    v_cvt_pk_bf16_f32 v74, v34, v38
    v_cvt_pk_bf16_f32 v75, v35, v39
    v_add_u32 v86, s54, v8
    ds_write2_b32 v86, v72, v73 offset0:0 offset1:72
    ds_write2_b32 v86, v74, v75 offset0:144 offset1:216
    s_mul_i32 s54, s59, 9
    v_cvt_pk_bf16_f32 v76, v40, v44
    v_cvt_pk_bf16_f32 v77, v41, v45
    v_cvt_pk_bf16_f32 v78, v42, v46
    v_cvt_pk_bf16_f32 v79, v43, v47
    v_add_u32 v87, s54, v8
    ds_write2_b32 v87, v76, v77 offset0:0 offset1:72
    ds_write2_b32 v87, v78, v79 offset0:144 offset1:216
    s_mul_i32 s54, s60, 9
    v_cvt_pk_bf16_f32 v80, v48, v52
    v_cvt_pk_bf16_f32 v81, v49, v53
    v_cvt_pk_bf16_f32 v82, v50, v54
    v_cvt_pk_bf16_f32 v83, v51, v55
    v_add_u32 v88, s54, v8
    ds_write2_b32 v88, v80, v81 offset0:0 offset1:72
    ds_write2_b32 v88, v82, v83 offset0:144 offset1:216
    v_and_b32 v8, 15, v1
    v_lshrrev_b32 v9, 4, v1
    s_lshr_b32 s54, s3, 2
    s_mul_i32 s55, s54, 23040
    v_mul_u32_u24 v10, 288, v8
    v_lshl_add_u32 v10, v9, 4, v10
    v_add_u32 v10, s55, v10
    v_lshlrev_b32 v9, 10, v9
    v_lshl_add_u32 v9, v8, 2, v9
    s_mul_i32 s54, s54, 20480
    s_and_b32 s55, s3, 3
    s_lshl_b32 s55, s55, 6
    s_add_u32 s54, s54, s55
    s_waitcnt lgkmcnt(0)
    s_barrier
    ds_read_b128 v[16:19], v10 offset:0
    ds_read_b128 v[20:23], v10 offset:64
    ds_read_b128 v[24:27], v10 offset:128
    ds_read_b128 v[28:31], v10 offset:192
    ds_read_b128 v[32:35], v10 offset:4608
    ds_read_b128 v[36:39], v10 offset:4672
    ds_read_b128 v[40:43], v10 offset:4736
    ds_read_b128 v[44:47], v10 offset:4800
    ds_read_b128 v[48:51], v10 offset:9216
    ds_read_b128 v[52:55], v10 offset:9280
    ds_read_b128 v[56:59], v10 offset:9344
    ds_read_b128 v[60:63], v10 offset:9408
    s_waitcnt lgkmcnt(11)
    v_mfma_f32_16x16x32_bf16 v[128:131], v[16:19], v[208:211], 0
    v_mfma_f32_16x16x32_bf16 v[132:135], v[16:19], v[212:215], 0
    s_waitcnt lgkmcnt(10)
    v_mfma_f32_16x16x32_bf16 v[128:131], v[20:23], v[216:219], v[128:131]
    v_mfma_f32_16x16x32_bf16 v[132:135], v[20:23], v[220:223], v[132:135]
    s_waitcnt lgkmcnt(9)
    v_mfma_f32_16x16x32_bf16 v[128:131], v[24:27], v[224:227], v[128:131]
    v_mfma_f32_16x16x32_bf16 v[132:135], v[24:27], v[228:231], v[132:135]
    s_waitcnt lgkmcnt(8)
    v_mfma_f32_16x16x32_bf16 v[128:131], v[28:31], v[232:235], v[128:131]
    v_mfma_f32_16x16x32_bf16 v[132:135], v[28:31], v[236:239], v[132:135]
    ds_read_b128 v[64:67], v10 offset:13824
    ds_read_b128 v[68:71], v10 offset:13888
    ds_read_b128 v[72:75], v10 offset:13952
    ds_read_b128 v[76:79], v10 offset:14016
    s_waitcnt lgkmcnt(8)
    v_mfma_f32_16x16x32_bf16 v[136:139], v[32:35], v[208:211], 0
    v_mfma_f32_16x16x32_bf16 v[140:143], v[32:35], v[212:215], 0
    v_mfma_f32_16x16x32_bf16 v[136:139], v[36:39], v[216:219], v[136:139]
    v_mfma_f32_16x16x32_bf16 v[140:143], v[36:39], v[220:223], v[140:143]
    v_mfma_f32_16x16x32_bf16 v[136:139], v[40:43], v[224:227], v[136:139]
    v_mfma_f32_16x16x32_bf16 v[140:143], v[40:43], v[228:231], v[140:143]
    v_mfma_f32_16x16x32_bf16 v[136:139], v[44:47], v[232:235], v[136:139]
    v_mfma_f32_16x16x32_bf16 v[140:143], v[44:47], v[236:239], v[140:143]
    v_cvt_pk_bf16_f32 v168, v128, v132
    buffer_store_dword v168, v9, s[40:43], s54 offen offset:0 sc1
    v_cvt_pk_bf16_f32 v169, v129, v133
    buffer_store_dword v169, v9, s[40:43], s54 offen offset:256 sc1
    v_cvt_pk_bf16_f32 v170, v130, v134
    buffer_store_dword v170, v9, s[40:43], s54 offen offset:512 sc1
    v_cvt_pk_bf16_f32 v171, v131, v135
    buffer_store_dword v171, v9, s[40:43], s54 offen offset:768 sc1
    s_add_u32 s54, s54, 4096
    ds_read_b128 v[80:83], v10 offset:18432
    ds_read_b128 v[84:87], v10 offset:18496
    ds_read_b128 v[88:91], v10 offset:18560
    ds_read_b128 v[92:95], v10 offset:18624
    s_waitcnt lgkmcnt(8)
    v_mfma_f32_16x16x32_bf16 v[144:147], v[48:51], v[208:211], 0
    v_mfma_f32_16x16x32_bf16 v[148:151], v[48:51], v[212:215], 0
    v_mfma_f32_16x16x32_bf16 v[144:147], v[52:55], v[216:219], v[144:147]
    v_mfma_f32_16x16x32_bf16 v[148:151], v[52:55], v[220:223], v[148:151]
    v_mfma_f32_16x16x32_bf16 v[144:147], v[56:59], v[224:227], v[144:147]
    v_mfma_f32_16x16x32_bf16 v[148:151], v[56:59], v[228:231], v[148:151]
    v_mfma_f32_16x16x32_bf16 v[144:147], v[60:63], v[232:235], v[144:147]
    v_mfma_f32_16x16x32_bf16 v[148:151], v[60:63], v[236:239], v[148:151]
    v_cvt_pk_bf16_f32 v172, v136, v140
    buffer_store_dword v172, v9, s[40:43], s54 offen offset:0 sc1
    v_cvt_pk_bf16_f32 v173, v137, v141
    buffer_store_dword v173, v9, s[40:43], s54 offen offset:256 sc1
    v_cvt_pk_bf16_f32 v174, v138, v142
    buffer_store_dword v174, v9, s[40:43], s54 offen offset:512 sc1
    v_cvt_pk_bf16_f32 v175, v139, v143
    buffer_store_dword v175, v9, s[40:43], s54 offen offset:768 sc1
    s_add_u32 s54, s54, 4096
    s_waitcnt lgkmcnt(4)
    v_mfma_f32_16x16x32_bf16 v[152:155], v[64:67], v[208:211], 0
    v_mfma_f32_16x16x32_bf16 v[156:159], v[64:67], v[212:215], 0
    v_mfma_f32_16x16x32_bf16 v[152:155], v[68:71], v[216:219], v[152:155]
    v_mfma_f32_16x16x32_bf16 v[156:159], v[68:71], v[220:223], v[156:159]
    v_mfma_f32_16x16x32_bf16 v[152:155], v[72:75], v[224:227], v[152:155]
    v_mfma_f32_16x16x32_bf16 v[156:159], v[72:75], v[228:231], v[156:159]
    v_mfma_f32_16x16x32_bf16 v[152:155], v[76:79], v[232:235], v[152:155]
    v_mfma_f32_16x16x32_bf16 v[156:159], v[76:79], v[236:239], v[156:159]
    v_cvt_pk_bf16_f32 v176, v144, v148
    buffer_store_dword v176, v9, s[40:43], s54 offen offset:0 sc1
    v_cvt_pk_bf16_f32 v177, v145, v149
    buffer_store_dword v177, v9, s[40:43], s54 offen offset:256 sc1
    v_cvt_pk_bf16_f32 v178, v146, v150
    buffer_store_dword v178, v9, s[40:43], s54 offen offset:512 sc1
    v_cvt_pk_bf16_f32 v179, v147, v151
    buffer_store_dword v179, v9, s[40:43], s54 offen offset:768 sc1
    s_add_u32 s54, s54, 4096
    s_waitcnt lgkmcnt(0)
    v_mfma_f32_16x16x32_bf16 v[160:163], v[80:83], v[208:211], 0
    v_mfma_f32_16x16x32_bf16 v[164:167], v[80:83], v[212:215], 0
    v_mfma_f32_16x16x32_bf16 v[160:163], v[84:87], v[216:219], v[160:163]
    v_mfma_f32_16x16x32_bf16 v[164:167], v[84:87], v[220:223], v[164:167]
    v_mfma_f32_16x16x32_bf16 v[160:163], v[88:91], v[224:227], v[160:163]
    v_mfma_f32_16x16x32_bf16 v[164:167], v[88:91], v[228:231], v[164:167]
    v_mfma_f32_16x16x32_bf16 v[160:163], v[92:95], v[232:235], v[160:163]
    v_mfma_f32_16x16x32_bf16 v[164:167], v[92:95], v[236:239], v[164:167]
    v_cvt_pk_bf16_f32 v180, v152, v156
    buffer_store_dword v180, v9, s[40:43], s54 offen offset:0 sc1
    v_cvt_pk_bf16_f32 v181, v153, v157
    buffer_store_dword v181, v9, s[40:43], s54 offen offset:256 sc1
    v_cvt_pk_bf16_f32 v182, v154, v158
    buffer_store_dword v182, v9, s[40:43], s54 offen offset:512 sc1
    v_cvt_pk_bf16_f32 v183, v155, v159
    buffer_store_dword v183, v9, s[40:43], s54 offen offset:768 sc1
    s_add_u32 s54, s54, 4096
    v_cvt_pk_bf16_f32 v184, v160, v164
    buffer_store_dword v184, v9, s[40:43], s54 offen offset:0 sc1
    v_cvt_pk_bf16_f32 v185, v161, v165
    buffer_store_dword v185, v9, s[40:43], s54 offen offset:256 sc1
    v_cvt_pk_bf16_f32 v186, v162, v166
    buffer_store_dword v186, v9, s[40:43], s54 offen offset:512 sc1
    v_cvt_pk_bf16_f32 v187, v163, v167
    buffer_store_dword v187, v9, s[40:43], s54 offen offset:768 sc1
    s_add_u32 s54, s54, 4096
    s_or_b32 s4, s2, s3
    s_cbranch_scc1 L_notag
    v_mov_b32 v8, s62
    v_lshlrev_b32 v10, 2, v1
    s_mov_b32 s54, 524288
    buffer_store_dword v8, v10, s[20:23], s54 offen sc1
L_notag:
L_done:
    s_endpgm
L_again:
    s_waitcnt vmcnt(0) lgkmcnt(0)
    s_barrier
    v_lshlrev_b32 v11, 2, v0
    v_mov_b32 v12, 0x00700000
    v_mov_b32 v13, 0
    ds_write_b32 v11, v12 offset:0
    ds_write_b32 v11, v12 offset:2048
    ds_write_b32 v11, v12 offset:4096
    ds_write_b32 v11, v12 offset:6144
    ds_write_b32 v11, v13 offset:8192
    ds_write_b32 v11, v13 offset:10240
    ds_write_b32 v11, v13 offset:12288
    v_add_u32 v3, v3, v4
    v_subrev_u32 v3, 256, v3
    v_max_i32 v3, 0, v3
    v_subrev_u32 v4, 256, v4
    v_max_i32 v4, 0, v4
    v_sub_u32 v3, v3, v4
    v_add_u32 v5, 256, v5
    s_sub_i32 s95, s95, 256
    v_lshl_add_u32 v8, v4, 2, v241
    s_waitcnt lgkmcnt(0)
    s_barrier
L_clip:
    v_add_u32 v10, v4, v3
    v_min_i32 v10, 256, v10
    v_sub_u32 v10, v10, v4
    v_add_u32 v10, v10, v240
L_masks:
    v_cmp_lt_i32 s[64:65], 0, v10
    v_cmp_lt_i32 s[66:67], 2, v10
    v_cmp_lt_i32 s[68:69], 4, v10
    v_cmp_lt_i32 s[70:71], 6, v10
    v_cmp_lt_i32 s[72:73], 8, v10
    v_cmp_lt_i32 s[74:75], 10, v10
    v_cmp_lt_i32 s[76:77], 12, v10
    v_cmp_lt_i32 s[78:79], 14, v10
    s_nop 0
    s_branch L_mapw
L_map2:
    v_add_u32 v8, 56, v8
    v_subrev_u32 v10, 14, v10
    s_branch L_masks
L_r1:
    ds_read_b32 v67, v242 offset:768
    ds_read_b32 v74, v243 offset:768
    ds_read_b32 v75, v243 offset:896
    s_waitcnt lgkmcnt(0)
    v_mad_u32_u24 v67, v67, 12, v244
    buffer_load_dwordx3 v[88:90], v67, s[24:27], 0 offen offset:2304 sc1
    v_lshl_add_u32 v74, v74, 5, v2
    s_add_u32 m0, s52, 4096
    s_nop 0
    buffer_load_dwordx4 v74, s[28:31], s98 offen offset:2048 sc1 lds
    v_lshl_add_u32 v75, v75, 5, v2
    s_add_u32 m0, s52, 4096
    s_nop 0
    buffer_load_dwordx4 v75, s[28:31], s98 offen offset:3072 sc1 lds
    s_branch L_r1b
L_r2:
    v_lshrrev_b32 v135, 21, v90
    v_lshlrev_b32 v135, 2, v135
    v_lshrrev_b32 v11, 26, v90
    v_lshl_or_b32 v11, v11, 4, v245
    s_mov_b64 exec, s[96:97]
    ds_add_rtn_u32 v131, v135, v6 offset:8192
    ds_add_u32 v11, v6 offset:14336
    s_mov_b64 exec, -1
    ds_write_b64 v246, v[88:89] offset:1536
    v_and_or_b32 v90, v90, s55, v247
    v_add_u32 v90, 402653184, v90
    s_branch L_r2b
L_r3:
    ds_read_b32 v135, v135 offset:8192
    s_waitcnt lgkmcnt(0)
    v_bfe_u32 v15, v135, 12, 3
    v_or_b32 v90, v15, v90
    v_and_b32 v67, 0x3ff, v135
    v_lshrrev_b32 v135, 16, v135
    v_add_u32 v135, v135, v131
    ds_read_b32 v67, v67 offset:16384
    s_waitcnt lgkmcnt(0)
    v_lshl_add_u32 v135, v135, 2, v67
    s_mov_b64 exec, s[96:97]
    ds_write_b32 v135, v90
    s_mov_b64 exec, -1
    s_branch L_r3b
L_poll:
    buffer_load_dwordx2 v[206:207], v10, s[20:23], s49 offen sc1
    s_sub_u32 s53, s53, 1
    s_cbranch_scc1 L_done
    s_waitcnt vmcnt(0)
    v_xor_b32 v11, s63, v206
    v_xor_b32 v12, s62, v207
    v_and_or_b32 v11, v11, s55, v12
    v_cmpx_ne_u32 vcc, 0, v11
    s_cbranch_execnz L_poll
    s_branch L_polled
L_rank2:
    ds_read_b32 v96, v248 offset:8192
    ds_read_b32 v97, v248 offset:8320
    ds_read_b32 v98, v248 offset:8448
    ds_read_b32 v99, v248 offset:8576
    ds_read_b32 v100, v248 offset:8704
    s_waitcnt lgkmcnt(0)
L_end:
    s_branch L_ranked
.section .rodata,"a"
.p2align 6
.amdhsa_kernel gather_scatter__tensor_product_equiv_mace__graph_kernel
  .amdhsa_next_free_vgpr 256
  .amdhsa_next_free_sgpr 102
  .amdhsa_accum_offset 256
  .amdhsa_group_segment_fixed_size 0
  .amdhsa_kernarg_size 88
  .amdhsa_user_sgpr_count 2
  .amdhsa_user_sgpr_kernarg_segment_ptr 1
  .amdhsa_system_sgpr_workgroup_id_x 1
  .amdhsa_float_denorm_mode_32 3
.end_amdhsa_kernel
```

```asm
; @launch grid=(256,1,1) block=(512,1,1) lds=147456
.amdgcn_target "amdgcn-amd-amdhsa--gfx950"
.text
.globl gather_scatter__tensor_product_equiv_mace__graph_kernel
.p2align 8
.type gather_scatter__tensor_product_equiv_mace__graph_kernel,@function
gather_scatter__tensor_product_equiv_mace__graph_kernel:
    s_cmp_ge_u32 s2, 256
    s_cbranch_scc1 L_done
    s_load_dwordx4 s[4:7], s[0:1], 8
    s_load_dwordx4 s[8:11], s[0:1], 24
    s_load_dwordx2 s[14:15], s[0:1], 80
    s_load_dwordx2 s[64:65], s[0:1], 0
    s_load_dwordx2 s[66:67], s[0:1], 40
    s_load_dwordx4 s[68:71], s[0:1], 48
    s_load_dwordx2 s[12:13], s[0:1], 64
    v_lshlrev_b32 v10, 3, v0
    s_getpc_b64 s[80:81]
L_pc:
    s_and_b32 s44, s2, 0xf8
    s_lshl_b32 s44, s44, 6
    v_and_b32 v11, 0x180, v10
    v_add_u32 v11, s44, v11
    v_min_u32 v11, L_end-L_pc, v11
    v_mov_b32 v113, s81
    v_add_co_u32 v112, vcc, s80, v11
    s_nop 1
    v_addc_co_u32 v113, vcc, 0, v113, vcc
    global_load_dword v205, v[112:113], off
    v_lshrrev_b32 v8, 6, v0
    v_and_b32 v1, 63, v0
    v_lshlrev_b32 v9, 2, v0
    v_mov_b32 v13, 0
    v_readfirstlane_b32 s3, v8
    ds_write_b32 v9, v13 offset:56320
    ds_write_b32 v9, v13 offset:61440
    s_mul_i32 s54, s2, 5000
    s_mul_i32 s55, s2, 10000
    s_mul_i32 s61, s2, 40000
    v_lshlrev_b32 v2, 4, v1
    v_lshlrev_b32 v15, 4, v0
    v_mov_b32 v6, 1
    s_lshl_b32 s52, s3, 10
    s_add_u32 s52, s52, 81920
    s_movk_i32 s53, 4096
    s_movk_i32 s50, 8192
    s_mov_b32 s34, 5000
    s_mov_b32 s35, 0x20000
    s_mov_b32 s38, 5000
    s_mov_b32 s39, 0x20000
    s_mov_b32 s98, 10000
    s_mov_b32 s99, 0x20000
    s_mov_b32 s30, 40000
    s_mov_b32 s31, 0x20000
    s_waitcnt lgkmcnt(0)
    s_add_u32 s32, s6, s54
    s_addc_u32 s33, s7, 0
    buffer_load_dword v64, v9, s[32:35], 0 offen offset:0 nt
    buffer_load_dword v65, v9, s[32:35], 0 offen offset:2048 nt
    buffer_load_dword v66, v9, s[32:35], s53 offen nt
    s_add_u32 s36, s4, s54
    s_addc_u32 s37, s5, 0
    s_barrier
    buffer_load_dword v68, v9, s[36:39], 0 offen offset:0 nt
    buffer_load_dword v69, v9, s[36:39], 0 offen offset:2048 nt
    buffer_load_dword v70, v9, s[36:39], s53 offen nt
    s_load_dword s62, s[14:15], 524288
    s_add_u32 s96, s8, s55
    s_addc_u32 s97, s9, 0
    s_add_u32 s28, s10, s61
    s_addc_u32 s29, s11, 0
    buffer_load_dwordx2 v[72:73], v10, s[96:99], 0 offen nt
    buffer_load_dwordx2 v[74:75], v10, s[96:99], s53 offen nt
    buffer_load_dwordx2 v[76:77], v10, s[96:99], s50 offen nt
    s_add_u32 m0, s52, 0
    s_mov_b32 s54, 0
    buffer_load_dwordx4 v15, s[28:31], s54 offen nt lds
    s_add_u32 m0, s52, 8192
    s_mov_b32 s54, 8192
    buffer_load_dwordx4 v15, s[28:31], s54 offen nt lds
    s_mov_b32 s72, 109951168
    s_movk_i32 s73, 625
    s_movk_i32 s74, 838
    s_movk_i32 s54, 226
    v_cmp_gt_u32 s[84:85], s54, v0
    s_mov_b32 s20, s14
    s_mov_b32 s21, s15
    s_mov_b32 s22, 598016
    s_mov_b32 s23, 0x20000
    v_lshlrev_b32 v11, 2, v0
    v_mov_b32 v12, 0x00700000
    v_mov_b32 v13, 0
    ds_write_b32 v11, v12 offset:0
    ds_write_b32 v11, v12 offset:2048
    ds_write_b32 v11, v12 offset:4096
    ds_write_b32 v11, v12 offset:6144
    ds_write_b32 v11, v13 offset:8192
    ds_write_b32 v11, v13 offset:10240
    ds_write_b32 v11, v13 offset:12288
    ds_write_b32 v11, v13 offset:14336
    s_waitcnt vmcnt(8)
    v_mul_hi_u32 v80, v64, s72
    v_mul_hi_u32 v81, v65, s72
    v_mul_hi_u32 v82, v66, s72
    v_lshlrev_b32 v84, 2, v80
    ds_add_rtn_u32 v88, v84, v6 offset:56320
    v_lshlrev_b32 v85, 2, v81
    ds_add_rtn_u32 v89, v85, v6 offset:56320
    v_lshlrev_b32 v86, 2, v82
    s_mov_b64 exec, s[84:85]
    ds_add_rtn_u32 v90, v86, v6 offset:56320
    s_mov_b64 exec, -1
    s_waitcnt lgkmcnt(0)
    s_barrier
    ds_read_b128 v[100:103], v2 offset:56320
    s_mul_i32 s62, s62, 0x9e3779b1
    s_add_u32 s62, s62, 0x7f4a7c15
    s_mul_i32 s63, s62, 0x85ebca6b
    s_and_b32 s63, s63, 0xffc00000
    v_mad_u32_u24 v92, v80, s73, 15
    v_lshrrev_b32 v92, 4, v92
    v_sub_u32 v92, v64, v92
    v_lshrrev_b32 v80, 3, v80
    v_and_b32 v80, 28, v80
    v_mad_u32_u24 v93, v81, s73, 15
    v_lshrrev_b32 v93, 4, v93
    v_sub_u32 v93, v65, v93
    v_lshrrev_b32 v81, 3, v81
    v_and_b32 v81, 28, v81
    v_mad_u32_u24 v94, v82, s73, 15
    v_lshrrev_b32 v94, 4, v94
    v_sub_u32 v94, v66, v94
    v_lshrrev_b32 v82, 3, v82
    v_and_b32 v82, 28, v82
    s_waitcnt lgkmcnt(0)
    v_add_u32 v11, v100, v101
    v_add3_u32 v11, v11, v102, v103
    v_mov_b32 v12, v11
    s_nop 1
    v_add_u32_dpp v12, v12, v12 row_shr:1 row_mask:0xf bank_mask:0xf
    s_nop 1
    v_add_u32_dpp v12, v12, v12 row_shr:2 row_mask:0xf bank_mask:0xf
    s_nop 1
    v_add_u32_dpp v12, v12, v12 row_shr:4 row_mask:0xf bank_mask:0xf
    s_nop 1
    v_add_u32_dpp v12, v12, v12 row_shr:8 row_mask:0xf bank_mask:0xf
    s_nop 1
    v_add_u32_dpp v12, v12, v12 row_bcast:15 row_mask:0xa bank_mask:0xf
    s_nop 1
    v_add_u32_dpp v12, v12, v12 row_bcast:31 row_mask:0xc bank_mask:0xf
    v_sub_u32 v104, v12, v11
    v_add_u32 v105, v104, v100
    v_add_u32 v106, v105, v101
    v_add_u32 v107, v106, v102
    ds_write_b128 v2, v[104:107] offset:57344
    ds_read_b32 v108, v84 offset:57344
    ds_read_b32 v109, v85 offset:57344
    ds_read_b32 v110, v86 offset:57344
    s_waitcnt vmcnt(5)
    v_mul_u32_u24 v96, s74, v68
    v_lshrrev_b32 v96, 18, v96
    v_sub_u32 v96, v96, v80
    v_and_b32 v96, 31, v96
    v_lshl_or_b32 v96, v92, 5, v96
    v_lshlrev_b32 v96, 21, v96
    v_lshl_or_b32 v96, v68, 7, v96
    v_mul_u32_u24 v97, s74, v69
    v_lshrrev_b32 v97, 18, v97
    v_sub_u32 v97, v97, v81
    v_and_b32 v97, 31, v97
    v_lshl_or_b32 v97, v93, 5, v97
    v_lshlrev_b32 v97, 21, v97
    v_lshl_or_b32 v97, v69, 7, v97
    v_mul_u32_u24 v98, s74, v70
    v_lshrrev_b32 v98, 18, v98
    v_sub_u32 v98, v98, v82
    v_and_b32 v98, 31, v98
    v_lshl_or_b32 v98, v94, 5, v98
    v_lshlrev_b32 v98, 21, v98
    v_lshl_or_b32 v98, v70, 7, v98
    v_lshlrev_b32 v92, 5, v0
    v_add_u32 v93, 16384, v92
    v_add_u32 v94, 32768, v92
    s_mov_b32 s55, 63488
    s_waitcnt vmcnt(2) lgkmcnt(0)
    v_add_u32 v108, v108, v88
    v_lshlrev_b32 v84, 2, v108
    v_mad_u32_u24 v108, v108, 12, s55
    ds_write_b32 v84, v92 offset:58368
    ds_write2_b32 v108, v72, v73 offset0:0 offset1:1
    ds_write_b32 v108, v96 offset:8
    v_add_u32 v109, v109, v89
    v_lshlrev_b32 v85, 2, v109
    v_mad_u32_u24 v109, v109, 12, s55
    ds_write_b32 v85, v93 offset:58368
    ds_write2_b32 v109, v74, v75 offset0:0 offset1:1
    ds_write_b32 v109, v97 offset:8
    v_add_u32 v110, v110, v90
    v_lshlrev_b32 v86, 2, v110
    v_mad_u32_u24 v110, v110, 12, s55
    s_mov_b64 exec, s[84:85]
    ds_write_b32 v86, v94 offset:58368
    ds_write2_b32 v110, v76, v77 offset0:0 offset1:1
    ds_write_b32 v110, v98 offset:8
    s_mov_b64 exec, -1
    s_add_u32 m0, s52, 16384
    s_mov_b32 s54, 16384
    buffer_load_dwordx4 v15, s[28:31], s54 offen nt lds
    s_add_u32 m0, s52, 24576
    s_mov_b32 s54, 24576
    buffer_load_dwordx4 v15, s[28:31], s54 offen nt lds
    s_add_u32 m0, s52, 32768
    s_mov_b32 s54, 32768
    buffer_load_dwordx4 v15, s[28:31], s54 offen nt lds
    s_lshl_b32 s54, s3, 7
    v_lshl_add_u32 v11, v1, 3, s54
    ds_read_b64 v[100:101], v11 offset:56320
    ds_read_b64 v[104:105], v11 offset:57344
    s_mul_i32 s54, s2, 15360
    s_add_u32 s54, s54, 1048576
    s_add_u32 s32, s14, s54
    s_addc_u32 s33, s15, 0
    s_mov_b32 s34, 15360
    s_mov_b32 s35, 0x20000
    s_mul_i32 s54, s2, 40960
    s_add_u32 s54, s54, 5242880
    s_add_u32 s36, s14, s54
    s_addc_u32 s37, s15, 0
    s_mov_b32 s38, 40000
    s_mov_b32 s39, 0x20000
    v_lshrrev_b32 v11, 1, v0
    v_lshlrev_b32 v11, 2, v11
    v_and_b32 v12, 1, v0
    v_lshlrev_b32 v12, 4, v12
    v_add_u32 v12, 81920, v12
    v_add_u32 v14, 63488, v15
    s_waitcnt lgkmcnt(0)
    s_barrier
    ds_read_b128 v[128:131], v14
    ds_read_b128 v[132:135], v14 offset:8192
    ds_read_b32 v156, v11 offset:58368
    ds_read_b32 v157, v11 offset:59392
    ds_read_b32 v158, v11 offset:60416
    ds_read_b32 v159, v11 offset:61440
    ds_read_b32 v160, v11 offset:62464
    s_cmp_lt_u32 s3, 4
    s_cselect_b32 s16, s68, s66
    s_cselect_b32 s17, s69, s67
    s_movk_i32 s54, 128
    s_cselect_b32 s18, s53, s54
    s_mov_b32 s19, 0x20000
    s_min_u32 s54, s3, 5
    s_lshl_b32 s54, s54, 10
    s_add_u32 m0, s54, 17408
    s_and_b32 s54, s54, 0xc00
    buffer_load_dwordx4 v2, s[16:19], s54 offen lds
    s_mov_b32 s40, s70
    s_mov_b32 s41, s71
    s_mov_b32 s42, 32768
    s_mov_b32 s43, 0x20000
    s_lshl_b32 s55, s3, 12
    s_add_u32 m0, s55, 23552
    s_nop 0
    buffer_load_dwordx4 v2, s[40:43], s55 offen offset:0 lds
    buffer_load_dwordx4 v2, s[40:43], s55 offen offset:1024 lds
    buffer_load_dwordx4 v2, s[40:43], s55 offen offset:2048 lds
    buffer_load_dwordx4 v2, s[40:43], s55 offen offset:3072 lds
    s_waitcnt lgkmcnt(0)
    v_add_u32 v156, v12, v156
    v_add_u32 v157, v12, v157
    v_add_u32 v158, v12, v158
    v_add_u32 v159, v12, v159
    v_add_u32 v160, v12, v160
    v_lshl_or_b32 v112, v100, 11, v104
    v_or_b32 v112, s63, v112
    v_mov_b32 v113, s62
    v_lshl_or_b32 v114, v101, 11, v105
    v_or_b32 v114, s63, v114
    v_mov_b32 v115, s62
    s_waitcnt vmcnt(0)
    s_barrier
    ds_read_b128 v[136:139], v156
    ds_read_b128 v[140:143], v157
    ds_read_b128 v[144:147], v158
    ds_read_b128 v[148:151], v159
    ds_read_b128 v[152:155], v160
    buffer_store_dwordx4 v[128:131], v15, s[32:35], 0 offen sc1
    buffer_store_dwordx4 v[132:135], v15, s[32:35], s50 offen sc1
    s_mov_b32 s54, 0
    s_waitcnt lgkmcnt(4)
    buffer_store_dwordx4 v[136:139], v15, s[36:39], s54 offen sc1
    s_mov_b32 s54, 8192
    s_waitcnt lgkmcnt(3)
    buffer_store_dwordx4 v[140:143], v15, s[36:39], s54 offen sc1
    s_mov_b32 s54, 16384
    s_waitcnt lgkmcnt(2)
    buffer_store_dwordx4 v[144:147], v15, s[36:39], s54 offen sc1
    s_mov_b32 s54, 24576
    s_waitcnt lgkmcnt(1)
    buffer_store_dwordx4 v[148:151], v15, s[36:39], s54 offen sc1
    s_mov_b32 s54, 32768
    s_waitcnt lgkmcnt(0)
    buffer_store_dwordx4 v[152:155], v15, s[36:39], s54 offen sc1
    s_and_b32 s44, s2, 7
    s_lshl_b32 s44, s44, 5
    s_lshr_b32 s54, s2, 3
    s_add_u32 s44, s44, s54
    s_mul_i32 s45, s44, 625
    s_add_u32 s46, s45, 640
    s_add_u32 s45, s45, 15
    s_lshr_b32 s45, s45, 4
    s_lshr_b32 s46, s46, 4
    s_sub_u32 s46, s46, s45
    s_mov_b32 s86, 0x0f0f0f0f
    s_mov_b32 s87, 0x0f0f0f0f
    s_mov_b32 s88, 0xf0f0f0f0
    s_mov_b32 s89, 0xf0f0f0f0
    v_mov_b32 v164, 0
    v_mov_b32 v165, 0
    v_mov_b32 v166, 0
    v_mov_b32 v167, 0
    v_mov_b32 v168, 0
    v_mov_b32 v169, 0
    v_mov_b32 v170, 0
    v_mov_b32 v171, 0
    v_and_b32 v11, 4, v1
    v_lshlrev_b32 v11, 2, v11
    v_mov_b32 v12, 0xffff
    v_lshlrev_b32 v12, v11, v12
    v_bfe_i32 v11, v1, 3, 1
    v_and_b32 v191, v11, v12
    v_xor_b32 v190, v191, v12
    v_lshrrev_b32 v200, 5, v1
    v_lshlrev_b32 v200, 4, v200
    v_add_u32 v200, 81920, v200
    v_and_b32 v201, 15, v1
    v_lshlrev_b32 v201, 2, v201
    v_bfe_u32 v11, v1, 3, 2
    v_and_b32 v12, 3, v1
    v_lshl_add_u32 v11, v11, 2, v12
    v_lshlrev_b32 v202, 2, v11
    v_bfe_i32 v240, v0, 0, 1
    s_lshl_b32 s54, s3, 10
    v_and_b32 v241, 4, v240
    v_add_u32 v241, s54, v241
    v_lshl_add_u32 v242, v1, 2, s54
    v_lshrrev_b32 v243, 1, v1
    v_lshl_add_u32 v243, v243, 2, s54
    v_mul_u32_u24 v244, 12, v1
    v_and_b32 v245, 12, v242
    v_and_b32 v250, 124, v242
    v_lshlrev_b32 v246, 1, v242
    v_add_u32 v246, 65536, v246
    v_lshlrev_b32 v247, 19, v242
    s_mul_i32 s54, s3, 640
    v_add_u32 v248, s54, v250
    v_sub_u32 v249, 63, v1
    s_lshl_b32 s54, s3, 5
    v_lshl_add_u32 v251, v1, 2, s54
    v_lshrrev_b32 v252, 3, v1
    v_mul_u32_u24 v252, 64, v252
    v_add_u32 v252, 56320, v252
    s_cmp_eq_u32 s46, 40
    v_mov_b32 v203, 0
    s_mov_b32 s54, 671321104
    s_cselect_b32 s54, 276856880, s54
    s_mov_b32 exec_lo, 31
    s_mov_b32 exec_hi, 0
    v_mov_b32 v203, s54
    s_mov_b32 s54, 405087304
    s_cselect_b32 s54, 159876648, s54
    s_mov_b32 exec_lo, 992
    s_mov_b32 exec_hi, 0
    v_mov_b32 v203, s54
    s_mov_b32 s54, 424579168
    s_cselect_b32 s54, 296066625, s54
    s_mov_b32 exec_lo, 31744
    s_mov_b32 exec_hi, 0
    v_mov_b32 v203, s54
    s_mov_b32 s54, 577443961
    s_cselect_b32 s54, 980068482, s54
    s_mov_b32 exec_lo, 1015808
    s_mov_b32 exec_hi, 0
    v_mov_b32 v203, s54
    s_mov_b32 s54, 600547466
    s_cselect_b32 s54, 466166449, s54
    s_mov_b32 exec_lo, 32505856
    s_mov_b32 exec_hi, 0
    v_mov_b32 v203, s54
    s_mov_b32 s54, 734837403
    s_cselect_b32 s54, 590166779, s54
    s_mov_b32 exec_lo, 1040187392
    s_mov_b32 exec_hi, 0
    v_mov_b32 v203, s54
    s_mov_b32 s54, 481444091
    s_cselect_b32 s54, 754136323, s54
    s_mov_b32 exec_lo, 3221225472
    s_mov_b32 exec_hi, 7
    v_mov_b32 v203, s54
    s_mov_b32 s54, 338903356
    s_cselect_b32 s54, 76598556, s54
    s_mov_b32 exec_lo, 0
    s_mov_b32 exec_hi, 248
    v_mov_b32 v203, s54
    s_mov_b64 exec, -1
    v_mul_u32_u24 v11, 52, v1
    v_lshrrev_b32 v11, 8, v11
    v_mad_i32_i24 v11, v11, -5, v1
    v_mul_u32_u24 v11, 6, v11
    v_lshrrev_b32 v203, v11, v203
    v_and_b32 v11, 7, v203
    v_bfe_u32 v203, v203, 3, 3
    v_lshlrev_b32 v11, 12, v11
    v_lshl_or_b32 v203, v203, 7, v11
    s_add_u32 s24, s14, 1048576
    s_addc_u32 s25, s15, 0
    s_mov_b32 s26, 3932160
    s_mov_b32 s27, 0x20000
    v_mov_b32 v16, 0
    v_mov_b32 v17, 0
    v_mov_b32 v18, 0
    v_mov_b32 v19, 0
    v_mov_b32 v20, 0
    v_mov_b32 v21, 0
    v_mov_b32 v22, 0
    v_mov_b32 v23, 0
    v_mov_b32 v24, 0
    v_mov_b32 v25, 0
    v_mov_b32 v26, 0
    v_mov_b32 v27, 0
    v_mov_b32 v28, 0
    v_mov_b32 v29, 0
    v_mov_b32 v30, 0
    v_mov_b32 v31, 0
    v_mov_b32 v32, 0
    v_mov_b32 v33, 0
    v_mov_b32 v34, 0
    v_mov_b32 v35, 0
    v_mov_b32 v36, 0
    v_mov_b32 v37, 0
    v_mov_b32 v38, 0
    v_mov_b32 v39, 0
    v_mov_b32 v40, 0
    v_mov_b32 v41, 0
    v_mov_b32 v42, 0
    v_mov_b32 v43, 0
    v_mov_b32 v44, 0
    v_mov_b32 v45, 0
    v_mov_b32 v46, 0
    v_mov_b32 v47, 0
    v_mov_b32 v48, 0
    v_mov_b32 v49, 0
    v_mov_b32 v50, 0
    v_mov_b32 v51, 0
    v_mov_b32 v52, 0
    v_mov_b32 v53, 0
    v_mov_b32 v54, 0
    v_mov_b32 v55, 0
    v_mov_b32 v56, 0
    v_mov_b32 v57, 0
    v_mov_b32 v58, 0
    v_mov_b32 v59, 0
    v_mov_b32 v60, 0
    v_mov_b32 v61, 0
    v_mov_b32 v62, 0
    v_mov_b32 v63, 0
    s_lshl_b32 s54, s2, 3
    s_add_u32 s54, s54, s3
    s_lshl_b32 s54, s54, 8
    s_mov_b32 s16, s64
    s_mov_b32 s17, s65
    s_mov_b32 s18, 10240000
    s_mov_b32 s19, 0x20000
    s_add_u32 s28, s14, 5242880
    s_addc_u32 s29, s15, 0
    s_mov_b32 s30, 10485760
    s_mov_b32 s31, 0x20000
    s_and_b32 s51, s2, 7
    s_mul_i32 s51, s51, 1282048
    s_and_b32 s55, s2, 0xf8
    s_add_u32 s55, s55, s3
    s_mul_i32 s55, s55, 3328
    s_add_u32 s51, s51, s55
    v_min_u32 v14, 25, v1
    v_lshlrev_b32 v14, 7, v14
    s_waitcnt vmcnt(0)
    s_barrier
    s_mov_b64 exec, 0xffff
    buffer_store_dwordx4 v[112:115], v2, s[20:23], s54 offen sc1
    s_mov_b64 exec, -1
    buffer_load_dword v7, v14, s[16:19], s51 offen
    s_lshl_b32 s54, s45, 10
    s_add_u32 s40, s12, s54
    s_addc_u32 s41, s13, 0
    s_lshl_b32 s42, s46, 10
    s_mov_b32 s43, 0x20000
    v_lshrrev_b32 v8, 5, v1
    v_lshlrev_b32 v8, 11, v8
    v_and_b32 v9, 15, v1
    v_lshl_add_u32 v8, v9, 4, v8
    ds_read_b128 v[64:67], v8 offset:17408
    ds_read_b128 v[68:71], v8 offset:17664
    ds_read_b128 v[72:75], v8 offset:17920
    ds_read_b128 v[76:79], v8 offset:18176
    ds_read_b128 v[80:83], v8 offset:18432
    ds_read_b128 v[84:87], v8 offset:18688
    ds_read_b128 v[88:91], v8 offset:18944
    ds_read_b128 v[92:95], v8 offset:19200
    v_lshrrev_b32 v8, 4, v1
    v_lshlrev_b32 v8, 5, v8
    v_and_b32 v9, 3, v1
    v_lshl_add_u32 v8, v9, 1, v8
    ds_read_u16 v96, v8 offset:21504
    ds_read_u16 v97, v8 offset:21512
    ds_read_u16 v98, v8 offset:21520
    ds_read_u16 v99, v8 offset:21528
    v_bfe_i32 v10, v1, 4, 1
    v_and_b32 v10, 0x02020202, v10
    v_add_u32 v10, 0x05040100, v10
    s_waitcnt lgkmcnt(0)
    v_perm_b32 v172, v68, v64, v10
    v_perm_b32 v173, v76, v72, v10
    v_perm_b32 v174, v84, v80, v10
    v_perm_b32 v175, v92, v88, v10
    v_perm_b32 v176, v69, v65, v10
    v_perm_b32 v177, v77, v73, v10
    v_perm_b32 v178, v85, v81, v10
    v_perm_b32 v179, v93, v89, v10
    v_perm_b32 v180, v70, v66, v10
    v_perm_b32 v181, v78, v74, v10
    v_perm_b32 v182, v86, v82, v10
    v_perm_b32 v183, v94, v90, v10
    v_perm_b32 v184, v71, v67, v10
    v_perm_b32 v185, v79, v75, v10
    v_perm_b32 v186, v87, v83, v10
    v_perm_b32 v187, v95, v91, v10
    v_lshl_or_b32 v188, v97, 16, v96
    v_lshl_or_b32 v189, v99, 16, v98
    v_and_b32 v9, 15, v1
    v_lshrrev_b32 v8, 4, v1
    v_lshlrev_b32 v8, 13, v8
    v_lshl_add_u32 v8, v9, 2, v8
    s_and_b32 s72, s3, 3
    s_lshl_b32 s72, s72, 6
    s_add_u32 s72, s72, 23552
    v_add_u32 v8, s72, v8
    ds_read2st64_b32 v[128:129], v8 offset0:0 offset1:4
    ds_read2st64_b32 v[130:131], v8 offset0:8 offset1:12
    ds_read2st64_b32 v[132:133], v8 offset0:16 offset1:20
    ds_read2st64_b32 v[134:135], v8 offset0:24 offset1:28
    ds_read2st64_b32 v[136:137], v8 offset0:1 offset1:5
    ds_read2st64_b32 v[138:139], v8 offset0:9 offset1:13
    ds_read2st64_b32 v[140:141], v8 offset0:17 offset1:21
    ds_read2st64_b32 v[142:143], v8 offset0:25 offset1:29
    ds_read2st64_b32 v[144:145], v8 offset0:2 offset1:6
    ds_read2st64_b32 v[146:147], v8 offset0:10 offset1:14
    ds_read2st64_b32 v[148:149], v8 offset0:18 offset1:22
    ds_read2st64_b32 v[150:151], v8 offset0:26 offset1:30
    ds_read2st64_b32 v[152:153], v8 offset0:3 offset1:7
    ds_read2st64_b32 v[154:155], v8 offset0:11 offset1:15
    ds_read2st64_b32 v[156:157], v8 offset0:19 offset1:23
    ds_read2st64_b32 v[158:159], v8 offset0:27 offset1:31
    s_mov_b32 s72, 0x05040100
    s_mov_b32 s73, 0x07060302
    s_waitcnt lgkmcnt(12)
    v_perm_b32 v208, v129, v128, s72
    v_perm_b32 v209, v131, v130, s72
    v_perm_b32 v210, v133, v132, s72
    v_perm_b32 v211, v135, v134, s72
    v_perm_b32 v212, v129, v128, s73
    v_perm_b32 v213, v131, v130, s73
    v_perm_b32 v214, v133, v132, s73
    v_perm_b32 v215, v135, v134, s73
    s_waitcnt lgkmcnt(8)
    v_perm_b32 v216, v137, v136, s72
    v_perm_b32 v217, v139, v138, s72
    v_perm_b32 v218, v141, v140, s72
    v_perm_b32 v219, v143, v142, s72
    v_perm_b32 v220, v137, v136, s73
    v_perm_b32 v221, v139, v138, s73
    v_perm_b32 v222, v141, v140, s73
    v_perm_b32 v223, v143, v142, s73
    s_waitcnt lgkmcnt(4)
    v_perm_b32 v224, v145, v144, s72
    v_perm_b32 v225, v147, v146, s72
    v_perm_b32 v226, v149, v148, s72
    v_perm_b32 v227, v151, v150, s72
    v_perm_b32 v228, v145, v144, s73
    v_perm_b32 v229, v147, v146, s73
    v_perm_b32 v230, v149, v148, s73
    v_perm_b32 v231, v151, v150, s73
    s_waitcnt lgkmcnt(0)
    v_perm_b32 v232, v153, v152, s72
    v_perm_b32 v233, v155, v154, s72
    v_perm_b32 v234, v157, v156, s72
    v_perm_b32 v235, v159, v158, s72
    v_perm_b32 v236, v153, v152, s73
    v_perm_b32 v237, v155, v154, s73
    v_perm_b32 v238, v157, v156, s73
    v_perm_b32 v239, v159, v158, s73
    v_lshrrev_b32 v9, 1, v0
    v_lshlrev_b32 v10, 11, v9
    s_lshl_b32 s49, s44, 3
    v_mul_u32_u24 v5, 1280, v9
    s_mov_b32 s48, 0
    s_mov_b32 s53, 200000
    s_mov_b32 s55, 0xffc00000
    s_lshl_b32 s52, s3, 13
    s_add_u32 s52, s52, 81920
    s_movk_i32 s98, 4096
    s_waitcnt vmcnt(0)
    s_barrier
    buffer_load_dwordx2 v[206:207], v10, s[20:23], s49 offen sc1
    s_waitcnt vmcnt(0)
    v_xor_b32 v11, s63, v206
    v_xor_b32 v12, s62, v207
    v_and_or_b32 v11, v11, s55, v12
    v_cmpx_ne_u32 vcc, 0, v11
    s_cbranch_execnz L_poll
L_polled:
    s_mov_b64 exec, -1
    v_bfe_u32 v3, v206, 11, 11
    v_and_b32 v4, v3, v240
    v_add_u32 v10, v3, v240
    v_and_b32 v11, 0x7ff, v206
    v_add_u32_dpp v4, v4, v4 row_shr:1 row_mask:0xf bank_mask:0xf
    v_cmp_lt_i32 s[64:65], 0, v10
    v_cmp_lt_i32 s[66:67], 2, v10
    v_add_u32_dpp v4, v4, v4 row_shr:2 row_mask:0xf bank_mask:0xf
    v_cmp_lt_i32 s[68:69], 4, v10
    v_cmp_lt_i32 s[70:71], 6, v10
    v_add_u32_dpp v4, v4, v4 row_shr:4 row_mask:0xf bank_mask:0xf
    v_cmp_lt_i32 s[72:73], 8, v10
    v_cmp_lt_i32 s[74:75], 10, v10
    v_add_u32_dpp v4, v4, v4 row_shr:8 row_mask:0xf bank_mask:0xf
    v_cmp_lt_i32 s[76:77], 12, v10
    v_cmp_lt_i32 s[78:79], 14, v10
    v_add_u32_dpp v4, v4, v4 row_bcast:15 row_mask:0xa bank_mask:0xf
    v_add_u32 v5, v5, v11
    s_nop 0
    v_add_u32_dpp v4, v4, v4 row_bcast:31 row_mask:0xc bank_mask:0xf
    s_nop 0
    v_readlane_b32 s95, v4, 63
    v_mov_b32_dpp v4, v4 quad_perm:[0,0,2,2] row_mask:0xf bank_mask:0xf
    v_sub_u32 v5, v5, v4
    v_lshl_add_u32 v8, v4, 2, v241
    s_cmp_gt_u32 s95, 256
    s_cbranch_scc1 L_clip
L_mapw:
    s_mov_b64 exec, s[64:65]
    ds_write_b32 v8, v5 offset:0
    s_mov_b64 exec, s[66:67]
    ds_write_b32 v8, v5 offset:8
    s_mov_b64 exec, s[68:69]
    ds_write_b32 v8, v5 offset:16
    s_mov_b64 exec, s[70:71]
    ds_write_b32 v8, v5 offset:24
    s_mov_b64 exec, s[72:73]
    ds_write_b32 v8, v5 offset:32
    s_mov_b64 exec, s[74:75]
    ds_write_b32 v8, v5 offset:40
    s_mov_b64 exec, s[76:77]
    ds_write_b32 v8, v5 offset:48
    s_mov_b64 exec, -1
    s_cmp_lg_u64 s[78:79], 0
    s_cbranch_scc1 L_map2
    ds_read_b32 v64, v242 offset:0
    ds_read_b32 v65, v242 offset:256
    ds_read_b32 v66, v242 offset:512
    ds_read_b32 v68, v243 offset:0
    ds_read_b32 v69, v243 offset:128
    ds_read_b32 v70, v243 offset:256
    ds_read_b32 v71, v243 offset:384
    ds_read_b32 v72, v243 offset:512
    ds_read_b32 v73, v243 offset:640
    s_cmp_gt_i32 s95, 192
    s_cbranch_scc1 L_r1
L_r1b:
    s_waitcnt lgkmcnt(6)
    v_mad_u32_u24 v64, v64, 12, v244
    buffer_load_dwordx3 v[76:78], v64, s[24:27], 0 offen offset:0 sc1
    v_mad_u32_u24 v65, v65, 12, v244
    buffer_load_dwordx3 v[80:82], v65, s[24:27], 0 offen offset:768 sc1
    v_mad_u32_u24 v66, v66, 12, v244
    buffer_load_dwordx3 v[84:86], v66, s[24:27], 0 offen offset:1536 sc1
    v_mov_b32 v11, s95
    s_mov_b64 exec, 1
    ds_max_i32 v13, v11 offset:15360
    s_mov_b64 exec, -1
    s_waitcnt lgkmcnt(1)
    v_lshl_add_u32 v68, v68, 5, v2
    v_lshl_add_u32 v69, v69, 5, v2
    v_lshl_add_u32 v70, v70, 5, v2
    v_lshl_add_u32 v71, v71, 5, v2
    v_lshl_add_u32 v72, v72, 5, v2
    v_lshl_add_u32 v73, v73, 5, v2
    s_barrier
    s_add_u32 m0, s52, 0
    s_nop 0
    buffer_load_dwordx4 v68, s[28:31], 0 offen offset:0 sc1 lds
    v_add_u32 v11, 0, v1
    v_cmp_gt_i32 s[80:81], s95, v11
    v_add_u32 v11, 64, v1
    v_cmp_gt_i32 s[82:83], s95, v11
    v_add_u32 v11, 128, v1
    v_cmp_gt_i32 s[84:85], s95, v11
    v_add_u32 v11, 192, v1
    v_cmp_gt_i32 s[96:97], s95, v11
    s_mov_b32 s55, 0x1fff80
    s_mul_i32 s61, s3, 5
    s_waitcnt vmcnt(3)
    v_lshrrev_b32 v132, 21, v78
    v_lshlrev_b32 v132, 2, v132
    v_lshrrev_b32 v11, 26, v78
    v_lshl_or_b32 v11, v11, 4, v245
    s_mov_b64 exec, s[80:81]
    ds_add_rtn_u32 v128, v132, v6 offset:8192
    ds_add_u32 v11, v6 offset:14336
    s_mov_b64 exec, -1
    s_waitcnt vmcnt(2)
    v_lshrrev_b32 v133, 21, v82
    v_lshlrev_b32 v133, 2, v133
    v_lshrrev_b32 v11, 26, v82
    v_lshl_or_b32 v11, v11, 4, v245
    s_mov_b64 exec, s[82:83]
    ds_add_rtn_u32 v129, v133, v6 offset:8192
    ds_add_u32 v11, v6 offset:14336
    s_mov_b64 exec, -1
    s_waitcnt vmcnt(1)
    v_lshrrev_b32 v134, 21, v86
    v_lshlrev_b32 v134, 2, v134
    v_lshrrev_b32 v11, 26, v86
    v_lshl_or_b32 v11, v11, 4, v245
    s_mov_b64 exec, s[84:85]
    ds_add_rtn_u32 v130, v134, v6 offset:8192
    ds_add_u32 v11, v6 offset:14336
    s_mov_b64 exec, -1
    s_cmp_gt_i32 s95, 192
    s_cbranch_scc1 L_r2
L_r2b:
    ds_write_b64 v246, v[76:77] offset:0
    v_and_or_b32 v78, v78, s55, v247
    ds_write_b64 v246, v[80:81] offset:512
    v_and_or_b32 v82, v82, s55, v247
    v_add_u32 v82, 134217728, v82
    ds_write_b64 v246, v[84:85] offset:1024
    v_and_or_b32 v86, v86, s55, v247
    v_add_u32 v86, 268435456, v86
    s_add_u32 m0, s52, 0
    s_nop 0
    buffer_load_dwordx4 v69, s[28:31], 0 offen offset:1024 sc1 lds
    s_add_u32 m0, s52, 0
    s_nop 0
    buffer_load_dwordx4 v70, s[28:31], 0 offen offset:2048 sc1 lds
    s_waitcnt lgkmcnt(3)
    s_barrier
    s_cmp_lg_u32 s48, 0
    s_cbranch_scc1 L_rank2
    ds_read_b128 v[104:107], v2 offset:14336
    ds_read_b32 v96, v248 offset:8192
    ds_read_b32 v97, v248 offset:8320
    ds_read_b32 v98, v248 offset:8448
    ds_read_b32 v99, v248 offset:8576
    ds_read_b32 v100, v248 offset:8704
    ds_read_b32 v14, v13 offset:15360
    s_add_u32 s65, s61, 1
    s_add_u32 s66, s61, 2
    s_add_u32 s67, s61, 3
    s_add_u32 s68, s61, 4
    s_waitcnt lgkmcnt(6)
    v_add_u32 v9, v104, v105
    v_add3_u32 v9, v9, v106, v107
    v_lshl_or_b32 v9, v9, 6, v249
    s_nop 0
    v_readlane_b32 s64, v9, s61
    v_readlane_b32 s65, v9, s65
    v_readlane_b32 s66, v9, s66
    v_readlane_b32 s67, v9, s67
    v_readlane_b32 s68, v9, s68
    v_cmp_lt_u32 s[70:71], s64, v9
    v_cmp_lt_u32 s[72:73], s65, v9
    v_cmp_lt_u32 s[74:75], s66, v9
    v_cmp_lt_u32 s[76:77], s67, v9
    v_cmp_lt_u32 s[78:79], s68, v9
    s_bcnt1_i32_b64 s64, s[70:71]
    s_bcnt1_i32_b64 s65, s[72:73]
    s_bcnt1_i32_b64 s66, s[74:75]
    s_bcnt1_i32_b64 s67, s[76:77]
    s_bcnt1_i32_b64 s68, s[78:79]
    s_waitcnt lgkmcnt(0)
    v_readlane_b32 s90, v203, s64
    v_readlane_b32 s91, v203, s65
    v_readlane_b32 s92, v203, s66
    v_readlane_b32 s93, v203, s67
    v_readlane_b32 s94, v203, s68
    v_readfirstlane_b32 s47, v14
L_ranked:
    s_mov_b32 exec_hi, 0
    s_and_b32 s54, s90, 0x380
    v_add_u32 v104, s54, v250
    ds_add_rtn_u32 v96, v104, v96 offset:13312
    s_and_b32 s54, s91, 0x380
    v_add_u32 v105, s54, v250
    ds_add_rtn_u32 v97, v105, v97 offset:13312
    s_and_b32 s54, s92, 0x380
    v_add_u32 v106, s54, v250
    ds_add_rtn_u32 v98, v106, v98 offset:13312
    s_and_b32 s54, s93, 0x380
    v_add_u32 v107, s54, v250
    ds_add_rtn_u32 v99, v107, v99 offset:13312
    s_and_b32 s54, s94, 0x380
    v_add_u32 v108, s54, v250
    ds_add_rtn_u32 v100, v108, v100 offset:13312
    v_or_b32 v104, s90, v104
    v_or_b32 v105, s91, v105
    v_or_b32 v106, s92, v106
    v_or_b32 v107, s93, v107
    v_or_b32 v108, s94, v108
    v_writelane_b32 v11, s90, 0
    v_writelane_b32 v11, s91, 1
    v_writelane_b32 v11, s92, 2
    v_writelane_b32 v11, s93, 3
    v_writelane_b32 v11, s94, 4
    s_waitcnt lgkmcnt(4)
    v_lshl_or_b32 v96, v96, 16, v104
    ds_write_b32 v248, v96 offset:8192
    s_waitcnt lgkmcnt(4)
    v_lshl_or_b32 v97, v97, 16, v105
    ds_write_b32 v248, v97 offset:8320
    s_waitcnt lgkmcnt(4)
    v_lshl_or_b32 v98, v98, 16, v106
    ds_write_b32 v248, v98 offset:8448
    s_waitcnt lgkmcnt(4)
    v_lshl_or_b32 v99, v99, 16, v107
    ds_write_b32 v248, v99 offset:8576
    s_waitcnt lgkmcnt(4)
    v_lshl_or_b32 v100, v100, 16, v108
    ds_write_b32 v248, v100 offset:8704
    v_add_lshl_u32 v12, v1, s61, 7
    v_lshrrev_b32 v9, 10, v11
    v_bfe_u32 v11, v11, 2, 8
    v_or_b32 v11, v11, v9
    s_mov_b32 exec_lo, 31
    ds_write_b32 v11, v12 offset:15616
    s_mov_b64 exec, -1
    s_add_u32 m0, s52, 0
    s_nop 0
    buffer_load_dwordx4 v71, s[28:31], 0 offen offset:3072 sc1 lds
    s_add_u32 m0, s52, 4096
    s_nop 0
    buffer_load_dwordx4 v72, s[28:31], s98 offen offset:0 sc1 lds
    s_add_u32 m0, s52, 4096
    s_nop 0
    buffer_load_dwordx4 v73, s[28:31], s98 offen offset:1024 sc1 lds
    s_lshl_b32 s54, s3, 3
    s_add_u32 s55, s54, 7
    s_waitcnt lgkmcnt(0)
    s_barrier
    ds_read_b128 v[96:99], v2 offset:13312
    ds_read_b32 v132, v132 offset:8192
    ds_read_b32 v133, v133 offset:8192
    ds_read_b32 v134, v134 offset:8192
    ds_read_b32 v11, v251 offset:15616
    s_waitcnt lgkmcnt(4)
    v_add_u32 v9, v96, v97
    v_add3_u32 v9, v9, v98, v99
    v_mov_b32 v10, v9
    s_waitcnt lgkmcnt(1)
    v_bfe_u32 v15, v132, 12, 3
    v_add_u32_dpp v10, v10, v10 row_shr:1 row_mask:0xf bank_mask:0xf
    v_or_b32 v78, v15, v78
    v_and_b32 v64, 0x3ff, v132
    v_add_u32_dpp v10, v10, v10 row_shr:2 row_mask:0xf bank_mask:0xf
    v_lshrrev_b32 v132, 16, v132
    v_add_u32 v132, v132, v128
    v_add_u32_dpp v10, v10, v10 row_shr:4 row_mask:0xf bank_mask:0xf
    v_bfe_u32 v15, v133, 12, 3
    v_or_b32 v82, v15, v82
    v_add_u32_dpp v10, v10, v10 row_shr:8 row_mask:0xf bank_mask:0xf
    v_and_b32 v65, 0x3ff, v133
    v_lshrrev_b32 v133, 16, v133
    v_add_u32_dpp v10, v10, v10 row_bcast:15 row_mask:0xa bank_mask:0xf
    v_add_u32 v133, v133, v129
    v_bfe_u32 v15, v134, 12, 3
    v_add_u32_dpp v10, v10, v10 row_bcast:31 row_mask:0xc bank_mask:0xf
    v_or_b32 v86, v15, v86
    v_and_b32 v66, 0x3ff, v134
    v_sub_u32 v9, v10, v9
    v_lshl_add_u32 v104, v9, 2, v252
    v_lshl_add_u32 v105, v96, 2, v104
    v_lshl_add_u32 v106, v97, 2, v105
    v_lshl_add_u32 v107, v98, 2, v106
    ds_write_b128 v2, v[104:107] offset:16384
    ds_read_b32 v64, v64 offset:16384
    ds_read_b32 v65, v65 offset:16384
    ds_read_b32 v66, v66 offset:16384
    v_lshrrev_b32 v134, 16, v134
    v_add_u32 v134, v134, v130
    v_readlane_b32 s50, v10, s55
    v_readlane_b32 s53, v9, s54
    v_readlane_b32 s51, v104, s54
    v_mov_b32 v12, 2097029
    s_sub_u32 s50, s50, s53
    s_lshl_b32 s54, s50, 2
    v_add_u32 v198, s51, v201
    v_add_u32 v199, s51, v202
    v_add_u32 v9, s54, v198
    s_waitcnt lgkmcnt(2)
    v_lshl_add_u32 v132, v132, 2, v64
    s_mov_b64 exec, s[80:81]
    ds_write_b32 v132, v78
    s_mov_b64 exec, -1
    s_waitcnt lgkmcnt(2)
    v_lshl_add_u32 v133, v133, 2, v65
    s_mov_b64 exec, s[82:83]
    ds_write_b32 v133, v82
    s_mov_b64 exec, -1
    s_waitcnt lgkmcnt(2)
    v_lshl_add_u32 v134, v134, 2, v66
    s_mov_b64 exec, s[84:85]
    ds_write_b32 v134, v86
    s_mov_b64 exec, -1
    ds_write_b32 v9, v12
    s_cmp_gt_i32 s95, 192
    s_cbranch_scc1 L_r3
L_r3b:
    v_readlane_b32 s56, v11, 0
    v_readlane_b32 s57, v11, 1
    v_readlane_b32 s58, v11, 2
    v_readlane_b32 s59, v11, 3
    v_readlane_b32 s60, v11, 4
    s_add_u32 s54, s50, 1
    s_and_b32 s54, s54, -2
    s_add_u32 s53, s54, 15
    s_lshr_b32 s53, s53, 4
    s_sub_u32 s54, 0, s54
    s_and_b32 s54, s54, 15
    s_sub_u32 s53, s53, 1
    s_cmp_gt_i32 s53, 0
    s_cselect_b32 s54, s54, 0
    s_lshl_b32 s61, s54, 2
    v_subrev_u32 v198, s61, v198
    v_subrev_u32 v199, s61, v199
    s_and_b32 s61, s61, 32
    v_add_u32 v12, s61, v198
    s_and_b32 s72, s54, 6
    s_mov_b32 s55, 0x00fffc38
    s_mov_b32 s49, 0xffffff00
    s_mov_b32 s51, 65536
    s_cmp_lt_u32 s3, 4
    s_cbranch_scc1 L_np
    s_setprio 1
L_np:
    s_waitcnt vmcnt(0) lgkmcnt(0)
    s_barrier
    ds_read_b32 v196, v12
    ds_read_b32 v194, v199
    ds_read_b32 v197, v198 offset:24
    s_cmp_eq_u32 s50, 0
    s_cbranch_scc1 L_swept
    s_waitcnt lgkmcnt(1)
    v_lshlrev_b32 v196, 3, v196
    v_and_b32 v196, s55, v196
    v_lshrrev_b32 v8, 21, v194
    v_lshl_add_u32 v11, v8, 3, s51
    v_lshl_add_u32 v8, v8, 5, v200
    ds_read_b64 v[192:193], v11
    s_mov_b64 exec, s[86:87]
    ds_read_b128 v[164:167], v8
    s_mov_b64 exec, s[88:89]
    ds_read_b128 v[168:171], v8
    s_mov_b64 exec, -1
    s_cmp_eq_u32 s72, 2
    s_cbranch_scc1 L_p2
    s_cmp_eq_u32 s72, 4
    s_cbranch_scc1 L_p4
    s_cmp_eq_u32 s72, 6
    s_cbranch_scc1 L_p6
L_p0:
    v_readlane_b32 s64, v196, 0
    v_readlane_b32 s65, v196, 1
    s_and_b32 s61, s64, s49
    buffer_load_dwordx4 v[96:99], v2, s[16:19], s61 offen
    s_and_b32 s61, s65, s49
    buffer_load_dwordx4 v[100:103], v2, s[16:19], s61 offen
L_p2:
    v_readlane_b32 s66, v196, 2
    v_readlane_b32 s67, v196, 3
    s_and_b32 s61, s66, s49
    buffer_load_dwordx4 v[104:107], v2, s[16:19], s61 offen
    s_and_b32 s61, s67, s49
    buffer_load_dwordx4 v[108:111], v2, s[16:19], s61 offen
L_p4:
    v_readlane_b32 s68, v196, 4
    v_readlane_b32 s69, v196, 5
    s_and_b32 s61, s68, s49
    buffer_load_dwordx4 v[112:115], v2, s[16:19], s61 offen
    s_and_b32 s61, s69, s49
    buffer_load_dwordx4 v[116:119], v2, s[16:19], s61 offen
    s_cmp_eq_u32 s72, 0
    s_cbranch_scc1 L_pd
L_p6:
    v_readlane_b32 s70, v196, 6
    v_readlane_b32 s71, v196, 7
    s_and_b32 s61, s70, s49
    buffer_load_dwordx4 v[120:123], v2, s[16:19], s61 offen
    s_and_b32 s61, s71, s49
    buffer_load_dwordx4 v[124:127], v2, s[16:19], s61 offen
    s_cmp_eq_u32 s72, 2
    s_cbranch_scc1 L_pd
L_p8:
    v_readlane_b32 s64, v196, 8
    v_readlane_b32 s65, v196, 9
    s_and_b32 s61, s64, s49
    buffer_load_dwordx4 v[96:99], v2, s[16:19], s61 offen
    s_and_b32 s61, s65, s49
    buffer_load_dwordx4 v[100:103], v2, s[16:19], s61 offen
    s_cmp_eq_u32 s72, 4
    s_cbranch_scc1 L_pd
L_p10:
    v_readlane_b32 s66, v196, 10
    v_readlane_b32 s67, v196, 11
    s_and_b32 s61, s66, s49
    buffer_load_dwordx4 v[104:107], v2, s[16:19], s61 offen
    s_and_b32 s61, s67, s49
    buffer_load_dwordx4 v[108:111], v2, s[16:19], s61 offen
L_pd:
    s_waitcnt lgkmcnt(0)
.p2align 3
    v_mfma_f32_4x4x4_16b_bf16 v[144:147], v[192:193], v[188:189], 0 cbsz:4 abid:0
    v_mfma_f32_4x4x4_16b_bf16 v[148:151], v[192:193], v[188:189], 0 cbsz:4 abid:2
    v_mfma_f32_4x4x4_16b_bf16 v[152:155], v[192:193], v[188:189], 0 cbsz:4 abid:4
    v_mfma_f32_4x4x4_16b_bf16 v[156:159], v[192:193], v[188:189], 0 cbsz:4 abid:6
    v_mfma_f32_32x32x16_bf16 v[64:79], v[164:167], v[172:175], 0
    v_lshlrev_b32 v196, 3, v197
    v_and_b32 v196, s55, v196
    v_add_u32 v198, 64, v198
    v_add_u32 v199, 64, v199
    v_mfma_f32_32x32x16_bf16 v[80:95], v[164:167], v[180:183], 0
    ds_read_b32 v197, v198 offset:24
    ds_read_b32 v194, v199
    v_mfma_f32_32x32x16_bf16 v[64:79], v[168:171], v[176:179], v[64:79]
    v_mfma_f32_32x32x16_bf16 v[80:95], v[168:171], v[184:187], v[80:95]
    s_set_gpr_idx_on s54, gpr_idx(SRC0,SRC1)
    v_cvt_pk_bf16_f32 v9, v144, v144
    s_set_gpr_idx_off
    v_and_b32 v160, v190, v9
    v_and_b32 v161, v191, v9
    s_waitcnt lgkmcnt(0)
    v_lshrrev_b32 v8, 21, v194
    v_lshl_add_u32 v11, v8, 3, s51
    v_lshl_add_u32 v8, v8, 5, v200
    ds_read_b64 v[192:193], v11
    s_mov_b64 exec, s[86:87]
    ds_read_b128 v[164:167], v8
    s_mov_b64 exec, s[88:89]
    ds_read_b128 v[168:171], v8
    s_mov_b64 exec, -1
    s_cmp_eq_u32 s53, 0
    s_cbranch_scc1 L_f0
    s_cmp_eq_u32 s54, 2
    s_cbranch_scc1 L_j2
    s_cmp_eq_u32 s54, 4
    s_cbranch_scc1 L_j4
    s_cmp_eq_u32 s54, 6
    s_cbranch_scc1 L_j6
    s_cmp_eq_u32 s54, 8
    s_cbranch_scc1 L_j8
    s_cmp_eq_u32 s54, 10
    s_cbranch_scc1 L_j10
    s_cmp_eq_u32 s54, 12
    s_cbranch_scc1 L_j12
    s_cmp_eq_u32 s54, 14
    s_cbranch_scc1 L_j14
    s_branch L_j0
.p2align 3
L_loop:
    s_waitcnt lgkmcnt(0)
.p2align 3
    v_mfma_f32_4x4x4_16b_bf16 v[144:147], v[192:193], v[188:189], 0 cbsz:4 abid:0
    v_mfma_f32_4x4x4_16b_bf16 v[148:151], v[192:193], v[188:189], 0 cbsz:4 abid:2
    v_mfma_f32_4x4x4_16b_bf16 v[152:155], v[192:193], v[188:189], 0 cbsz:4 abid:4
    v_mfma_f32_4x4x4_16b_bf16 v[156:159], v[192:193], v[188:189], 0 cbsz:4 abid:6
    v_mfma_f32_32x32x16_bf16 v[64:79], v[164:167], v[172:175], 0
    v_lshlrev_b32 v196, 3, v197
    v_and_b32 v196, s55, v196
    v_add_u32 v198, 64, v198
    v_add_u32 v199, 64, v199
    v_mfma_f32_32x32x16_bf16 v[80:95], v[164:167], v[180:183], 0
    ds_read_b32 v197, v198 offset:24
    ds_read_b32 v194, v199
    v_mfma_f32_32x32x16_bf16 v[64:79], v[168:171], v[176:179], v[64:79]
    v_cvt_pk_bf16_f32 v9, v144, v144
    v_and_b32 v160, v190, v9
    v_and_b32 v161, v191, v9
    v_mfma_f32_32x32x16_bf16 v[80:95], v[168:171], v[184:187], v[80:95]
L_j0:
    s_waitcnt vmcnt(5)
.p2align 3
    v_mfma_f32_16x16x16_bf16 v[128:131], v[160:161], v[96:97], 0
    v_readlane_b32 s70, v196, 0
    v_cvt_pk_bf16_f32 v10, v145, v145
    v_mfma_f32_16x16x16_bf16 v[132:135], v[160:161], v[98:99], 0
    v_and_b32 v162, v190, v10
    v_and_b32 v163, v191, v10
    s_and_b32 s61, s70, s49
    s_waitcnt vmcnt(4)
    buffer_load_dwordx4 v[120:123], v2, s[16:19], s61 offen
    v_mfma_f32_16x16x16_bf16 v[136:139], v[162:163], v[100:101], 0
    v_readlane_b32 s71, v196, 1
    v_cvt_pk_bf16_f32 v9, v146, v146
    v_mfma_f32_16x16x16_bf16 v[140:143], v[162:163], v[102:103], 0
    v_and_b32 v160, v190, v9
    v_and_b32 v161, v191, v9
    s_and_b32 s61, s71, s49
    s_set_gpr_idx_on s64, gpr_idx(SRC2,DST)
    buffer_load_dwordx4 v[124:127], v2, s[16:19], s61 offen
    v_pk_fma_f32 v[16:17], v[128:129], v[64:65], v[16:17] op_sel_hi:[1,0,1]
    v_pk_fma_f32 v[18:19], v[130:131], v[64:65], v[18:19] op_sel_hi:[1,0,1]
    v_pk_fma_f32 v[20:21], v[132:133], v[80:81], v[20:21] op_sel_hi:[1,0,1]
    v_pk_fma_f32 v[22:23], v[134:135], v[80:81], v[22:23] op_sel_hi:[1,0,1]
    s_set_gpr_idx_idx s65
.p2align 3
    v_pk_fma_f32 v[16:17], v[136:137], v[64:65], v[16:17] op_sel:[0,1,0] op_sel_hi:[1,1,1]
    v_pk_fma_f32 v[18:19], v[138:139], v[64:65], v[18:19] op_sel:[0,1,0] op_sel_hi:[1,1,1]
    v_pk_fma_f32 v[20:21], v[140:141], v[80:81], v[20:21] op_sel:[0,1,0] op_sel_hi:[1,1,1]
    v_pk_fma_f32 v[22:23], v[142:143], v[80:81], v[22:23] op_sel:[0,1,0] op_sel_hi:[1,1,1]
    s_set_gpr_idx_off
L_j2:
    s_waitcnt vmcnt(5)
.p2align 3
    v_mfma_f32_16x16x16_bf16 v[128:131], v[160:161], v[104:105], 0
    v_readlane_b32 s64, v196, 2
    v_cvt_pk_bf16_f32 v10, v147, v147
    v_mfma_f32_16x16x16_bf16 v[132:135], v[160:161], v[106:107], 0
    v_and_b32 v162, v190, v10
    v_and_b32 v163, v191, v10
    s_and_b32 s61, s64, s49
    s_waitcnt vmcnt(4)
    buffer_load_dwordx4 v[96:99], v2, s[16:19], s61 offen
    v_mfma_f32_16x16x16_bf16 v[136:139], v[162:163], v[108:109], 0
    v_readlane_b32 s65, v196, 3
    v_cvt_pk_bf16_f32 v9, v148, v148
    v_mfma_f32_16x16x16_bf16 v[140:143], v[162:163], v[110:111], 0
    v_and_b32 v160, v190, v9
    v_and_b32 v161, v191, v9
    s_waitcnt lgkmcnt(0)
    v_lshrrev_b32 v8, 21, v194
    v_lshl_add_u32 v11, v8, 3, s51
    v_lshl_add_u32 v8, v8, 5, v200
    ds_read_b64 v[192:193], v11
    s_mov_b64 exec, s[86:87]
    ds_read_b128 v[164:167], v8
    s_mov_b64 exec, s[88:89]
    ds_read_b128 v[168:171], v8
    s_mov_b64 exec, -1
.p2align 3
    s_and_b32 s61, s65, s49
    s_set_gpr_idx_on s66, gpr_idx(SRC2,DST)
    buffer_load_dwordx4 v[100:103], v2, s[16:19], s61 offen
    v_pk_fma_f32 v[16:17], v[128:129], v[66:67], v[16:17] op_sel_hi:[1,0,1]
    v_pk_fma_f32 v[18:19], v[130:131], v[66:67], v[18:19] op_sel_hi:[1,0,1]
    v_pk_fma_f32 v[20:21], v[132:133], v[82:83], v[20:21] op_sel_hi:[1,0,1]
    v_pk_fma_f32 v[22:23], v[134:135], v[82:83], v[22:23] op_sel_hi:[1,0,1]
    s_set_gpr_idx_idx s67
.p2align 3
    v_pk_fma_f32 v[16:17], v[136:137], v[66:67], v[16:17] op_sel:[0,1,0] op_sel_hi:[1,1,1]
    v_pk_fma_f32 v[18:19], v[138:139], v[66:67], v[18:19] op_sel:[0,1,0] op_sel_hi:[1,1,1]
    v_pk_fma_f32 v[20:21], v[140:141], v[82:83], v[20:21] op_sel:[0,1,0] op_sel_hi:[1,1,1]
    v_pk_fma_f32 v[22:23], v[142:143], v[82:83], v[22:23] op_sel:[0,1,0] op_sel_hi:[1,1,1]
    s_set_gpr_idx_off
L_j4:
    s_waitcnt vmcnt(5)
.p2align 3
    v_mfma_f32_16x16x16_bf16 v[128:131], v[160:161], v[112:113], 0
    v_readlane_b32 s66, v196, 4
    v_cvt_pk_bf16_f32 v10, v149, v149
    v_mfma_f32_16x16x16_bf16 v[132:135], v[160:161], v[114:115], 0
    v_and_b32 v162, v190, v10
    v_and_b32 v163, v191, v10
    s_and_b32 s61, s66, s49
    s_waitcnt vmcnt(4)
    buffer_load_dwordx4 v[104:107], v2, s[16:19], s61 offen
    v_mfma_f32_16x16x16_bf16 v[136:139], v[162:163], v[116:117], 0
    v_readlane_b32 s67, v196, 5
    v_cvt_pk_bf16_f32 v9, v150, v150
    v_mfma_f32_16x16x16_bf16 v[140:143], v[162:163], v[118:119], 0
    v_and_b32 v160, v190, v9
    v_and_b32 v161, v191, v9
    s_and_b32 s61, s67, s49
    s_set_gpr_idx_on s68, gpr_idx(SRC2,DST)
    buffer_load_dwordx4 v[108:111], v2, s[16:19], s61 offen
    v_pk_fma_f32 v[16:17], v[128:129], v[68:69], v[16:17] op_sel_hi:[1,0,1]
    v_pk_fma_f32 v[18:19], v[130:131], v[68:69], v[18:19] op_sel_hi:[1,0,1]
    v_pk_fma_f32 v[20:21], v[132:133], v[84:85], v[20:21] op_sel_hi:[1,0,1]
    v_pk_fma_f32 v[22:23], v[134:135], v[84:85], v[22:23] op_sel_hi:[1,0,1]
    s_set_gpr_idx_idx s69
.p2align 3
    v_pk_fma_f32 v[16:17], v[136:137], v[68:69], v[16:17] op_sel:[0,1,0] op_sel_hi:[1,1,1]
    v_pk_fma_f32 v[18:19], v[138:139], v[68:69], v[18:19] op_sel:[0,1,0] op_sel_hi:[1,1,1]
    v_pk_fma_f32 v[20:21], v[140:141], v[84:85], v[20:21] op_sel:[0,1,0] op_sel_hi:[1,1,1]
    v_pk_fma_f32 v[22:23], v[142:143], v[84:85], v[22:23] op_sel:[0,1,0] op_sel_hi:[1,1,1]
    s_set_gpr_idx_off
L_j6:
    s_waitcnt vmcnt(5)
.p2align 3
    v_mfma_f32_16x16x16_bf16 v[128:131], v[160:161], v[120:121], 0
    v_readlane_b32 s68, v196, 6
    v_cvt_pk_bf16_f32 v10, v151, v151
    v_mfma_f32_16x16x16_bf16 v[132:135], v[160:161], v[122:123], 0
    v_and_b32 v162, v190, v10
    v_and_b32 v163, v191, v10
    s_and_b32 s61, s68, s49
    s_waitcnt vmcnt(4)
    buffer_load_dwordx4 v[112:115], v2, s[16:19], s61 offen
    v_mfma_f32_16x16x16_bf16 v[136:139], v[162:163], v[124:125], 0
    v_readlane_b32 s69, v196, 7
    v_cvt_pk_bf16_f32 v9, v152, v152
    v_mfma_f32_16x16x16_bf16 v[140:143], v[162:163], v[126:127], 0
    v_and_b32 v160, v190, v9
    v_and_b32 v161, v191, v9
    s_and_b32 s61, s69, s49
    s_set_gpr_idx_on s70, gpr_idx(SRC2,DST)
    buffer_load_dwordx4 v[116:119], v2, s[16:19], s61 offen
    v_pk_fma_f32 v[16:17], v[128:129], v[70:71], v[16:17] op_sel_hi:[1,0,1]
    v_pk_fma_f32 v[18:19], v[130:131], v[70:71], v[18:19] op_sel_hi:[1,0,1]
    v_pk_fma_f32 v[20:21], v[132:133], v[86:87], v[20:21] op_sel_hi:[1,0,1]
    v_pk_fma_f32 v[22:23], v[134:135], v[86:87], v[22:23] op_sel_hi:[1,0,1]
    s_set_gpr_idx_idx s71
.p2align 3
    v_pk_fma_f32 v[16:17], v[136:137], v[70:71], v[16:17] op_sel:[0,1,0] op_sel_hi:[1,1,1]
    v_pk_fma_f32 v[18:19], v[138:139], v[70:71], v[18:19] op_sel:[0,1,0] op_sel_hi:[1,1,1]
    v_pk_fma_f32 v[20:21], v[140:141], v[86:87], v[20:21] op_sel:[0,1,0] op_sel_hi:[1,1,1]
    v_pk_fma_f32 v[22:23], v[142:143], v[86:87], v[22:23] op_sel:[0,1,0] op_sel_hi:[1,1,1]
    s_set_gpr_idx_off
L_j8:
    s_waitcnt vmcnt(5)
.p2align 3
    v_mfma_f32_16x16x16_bf16 v[128:131], v[160:161], v[96:97], 0
    v_readlane_b32 s70, v196, 8
    v_cvt_pk_bf16_f32 v10, v153, v153
    v_mfma_f32_16x16x16_bf16 v[132:135], v[160:161], v[98:99], 0
    v_and_b32 v162, v190, v10
    v_and_b32 v163, v191, v10
    s_and_b32 s61, s70, s49
    s_waitcnt vmcnt(4)
    buffer_load_dwordx4 v[120:123], v2, s[16:19], s61 offen
    v_mfma_f32_16x16x16_bf16 v[136:139], v[162:163], v[100:101], 0
    v_readlane_b32 s71, v196, 9
    v_cvt_pk_bf16_f32 v9, v154, v154
    v_mfma_f32_16x16x16_bf16 v[140:143], v[162:163], v[102:103], 0
    v_and_b32 v160, v190, v9
    v_and_b32 v161, v191, v9
    s_and_b32 s61, s71, s49
    s_set_gpr_idx_on s64, gpr_idx(SRC2,DST)
    buffer_load_dwordx4 v[124:127], v2, s[16:19], s61 offen
    v_pk_fma_f32 v[16:17], v[128:129], v[72:73], v[16:17] op_sel_hi:[1,0,1]
    v_pk_fma_f32 v[18:19], v[130:131], v[72:73], v[18:19] op_sel_hi:[1,0,1]
    v_pk_fma_f32 v[20:21], v[132:133], v[88:89], v[20:21] op_sel_hi:[1,0,1]
    v_pk_fma_f32 v[22:23], v[134:135], v[88:89], v[22:23] op_sel_hi:[1,0,1]
    s_set_gpr_idx_idx s65
.p2align 3
    v_pk_fma_f32 v[16:17], v[136:137], v[72:73], v[16:17] op_sel:[0,1,0] op_sel_hi:[1,1,1]
    v_pk_fma_f32 v[18:19], v[138:139], v[72:73], v[18:19] op_sel:[0,1,0] op_sel_hi:[1,1,1]
    v_pk_fma_f32 v[20:21], v[140:141], v[88:89], v[20:21] op_sel:[0,1,0] op_sel_hi:[1,1,1]
    v_pk_fma_f32 v[22:23], v[142:143], v[88:89], v[22:23] op_sel:[0,1,0] op_sel_hi:[1,1,1]
    s_set_gpr_idx_off
L_j10:
    s_waitcnt vmcnt(5)
.p2align 3
    v_mfma_f32_16x16x16_bf16 v[128:131], v[160:161], v[104:105], 0
    v_readlane_b32 s64, v196, 10
    v_cvt_pk_bf16_f32 v10, v155, v155
    v_mfma_f32_16x16x16_bf16 v[132:135], v[160:161], v[106:107], 0
    v_and_b32 v162, v190, v10
    v_and_b32 v163, v191, v10
    s_and_b32 s61, s64, s49
    s_waitcnt vmcnt(4)
    buffer_load_dwordx4 v[96:99], v2, s[16:19], s61 offen
    v_mfma_f32_16x16x16_bf16 v[136:139], v[162:163], v[108:109], 0
    v_readlane_b32 s65, v196, 11
    v_cvt_pk_bf16_f32 v9, v156, v156
    v_mfma_f32_16x16x16_bf16 v[140:143], v[162:163], v[110:111], 0
    v_and_b32 v160, v190, v9
    v_and_b32 v161, v191, v9
    s_and_b32 s61, s65, s49
    s_set_gpr_idx_on s66, gpr_idx(SRC2,DST)
    buffer_load_dwordx4 v[100:103], v2, s[16:19], s61 offen
    v_pk_fma_f32 v[16:17], v[128:129], v[74:75], v[16:17] op_sel_hi:[1,0,1]
    v_pk_fma_f32 v[18:19], v[130:131], v[74:75], v[18:19] op_sel_hi:[1,0,1]
    v_pk_fma_f32 v[20:21], v[132:133], v[90:91], v[20:21] op_sel_hi:[1,0,1]
    v_pk_fma_f32 v[22:23], v[134:135], v[90:91], v[22:23] op_sel_hi:[1,0,1]
    s_set_gpr_idx_idx s67
.p2align 3
    v_pk_fma_f32 v[16:17], v[136:137], v[74:75], v[16:17] op_sel:[0,1,0] op_sel_hi:[1,1,1]
    v_pk_fma_f32 v[18:19], v[138:139], v[74:75], v[18:19] op_sel:[0,1,0] op_sel_hi:[1,1,1]
    v_pk_fma_f32 v[20:21], v[140:141], v[90:91], v[20:21] op_sel:[0,1,0] op_sel_hi:[1,1,1]
    v_pk_fma_f32 v[22:23], v[142:143], v[90:91], v[22:23] op_sel:[0,1,0] op_sel_hi:[1,1,1]
    s_set_gpr_idx_off
L_j12:
    s_waitcnt vmcnt(5)
.p2align 3
    v_mfma_f32_16x16x16_bf16 v[128:131], v[160:161], v[112:113], 0
    v_readlane_b32 s66, v196, 12
    v_cvt_pk_bf16_f32 v10, v157, v157
    v_mfma_f32_16x16x16_bf16 v[132:135], v[160:161], v[114:115], 0
    v_and_b32 v162, v190, v10
    v_and_b32 v163, v191, v10
    s_and_b32 s61, s66, s49
    s_waitcnt vmcnt(4)
    buffer_load_dwordx4 v[104:107], v2, s[16:19], s61 offen
    v_mfma_f32_16x16x16_bf16 v[136:139], v[162:163], v[116:117], 0
    v_readlane_b32 s67, v196, 13
    v_cvt_pk_bf16_f32 v9, v158, v158
    v_mfma_f32_16x16x16_bf16 v[140:143], v[162:163], v[118:119], 0
    v_and_b32 v160, v190, v9
    v_and_b32 v161, v191, v9
    s_and_b32 s61, s67, s49
    s_set_gpr_idx_on s68, gpr_idx(SRC2,DST)
    buffer_load_dwordx4 v[108:111], v2, s[16:19], s61 offen
    v_pk_fma_f32 v[16:17], v[128:129], v[76:77], v[16:17] op_sel_hi:[1,0,1]
    v_pk_fma_f32 v[18:19], v[130:131], v[76:77], v[18:19] op_sel_hi:[1,0,1]
    v_pk_fma_f32 v[20:21], v[132:133], v[92:93], v[20:21] op_sel_hi:[1,0,1]
    v_pk_fma_f32 v[22:23], v[134:135], v[92:93], v[22:23] op_sel_hi:[1,0,1]
    s_set_gpr_idx_idx s69
.p2align 3
    v_pk_fma_f32 v[16:17], v[136:137], v[76:77], v[16:17] op_sel:[0,1,0] op_sel_hi:[1,1,1]
    v_pk_fma_f32 v[18:19], v[138:139], v[76:77], v[18:19] op_sel:[0,1,0] op_sel_hi:[1,1,1]
    v_pk_fma_f32 v[20:21], v[140:141], v[92:93], v[20:21] op_sel:[0,1,0] op_sel_hi:[1,1,1]
    v_pk_fma_f32 v[22:23], v[142:143], v[92:93], v[22:23] op_sel:[0,1,0] op_sel_hi:[1,1,1]
    s_set_gpr_idx_off
L_j14:
    s_waitcnt vmcnt(5)
.p2align 3
    v_mfma_f32_16x16x16_bf16 v[128:131], v[160:161], v[120:121], 0
    v_readlane_b32 s68, v196, 14
    v_cvt_pk_bf16_f32 v10, v159, v159
    v_mfma_f32_16x16x16_bf16 v[132:135], v[160:161], v[122:123], 0
    v_and_b32 v162, v190, v10
    v_and_b32 v163, v191, v10
    s_and_b32 s61, s68, s49
    s_waitcnt vmcnt(4)
    buffer_load_dwordx4 v[112:115], v2, s[16:19], s61 offen
    v_mfma_f32_16x16x16_bf16 v[136:139], v[162:163], v[124:125], 0
    v_readlane_b32 s69, v196, 15
    v_mfma_f32_16x16x16_bf16 v[140:143], v[162:163], v[126:127], 0
    s_and_b32 s61, s69, s49
    s_set_gpr_idx_on s70, gpr_idx(SRC2,DST)
    buffer_load_dwordx4 v[116:119], v2, s[16:19], s61 offen
    v_pk_fma_f32 v[16:17], v[128:129], v[78:79], v[16:17] op_sel_hi:[1,0,1]
    v_pk_fma_f32 v[18:19], v[130:131], v[78:79], v[18:19] op_sel_hi:[1,0,1]
    v_pk_fma_f32 v[20:21], v[132:133], v[94:95], v[20:21] op_sel_hi:[1,0,1]
    v_pk_fma_f32 v[22:23], v[134:135], v[94:95], v[22:23] op_sel_hi:[1,0,1]
    s_set_gpr_idx_idx s71
    s_sub_u32 s53, s53, 1
.p2align 3
    v_pk_fma_f32 v[16:17], v[136:137], v[78:79], v[16:17] op_sel:[0,1,0] op_sel_hi:[1,1,1]
    v_pk_fma_f32 v[18:19], v[138:139], v[78:79], v[18:19] op_sel:[0,1,0] op_sel_hi:[1,1,1]
    v_pk_fma_f32 v[20:21], v[140:141], v[94:95], v[20:21] op_sel:[0,1,0] op_sel_hi:[1,1,1]
    v_pk_fma_f32 v[22:23], v[142:143], v[94:95], v[22:23] op_sel:[0,1,0] op_sel_hi:[1,1,1]
    s_set_gpr_idx_off
    s_cmp_lg_u32 s53, 0
    s_cbranch_scc1 L_loop
    s_waitcnt lgkmcnt(0)
.p2align 3
    v_mfma_f32_4x4x4_16b_bf16 v[144:147], v[192:193], v[188:189], 0 cbsz:4 abid:0
    v_mfma_f32_4x4x4_16b_bf16 v[148:151], v[192:193], v[188:189], 0 cbsz:4 abid:2
    v_mfma_f32_4x4x4_16b_bf16 v[152:155], v[192:193], v[188:189], 0 cbsz:4 abid:4
    v_mfma_f32_4x4x4_16b_bf16 v[156:159], v[192:193], v[188:189], 0 cbsz:4 abid:6
    v_mfma_f32_32x32x16_bf16 v[64:79], v[164:167], v[172:175], 0
    v_lshlrev_b32 v196, 3, v197
    v_and_b32 v196, s55, v196
    v_mfma_f32_32x32x16_bf16 v[80:95], v[164:167], v[180:183], 0
    v_mfma_f32_32x32x16_bf16 v[64:79], v[168:171], v[176:179], v[64:79]
    v_cvt_pk_bf16_f32 v9, v144, v144
    v_and_b32 v160, v190, v9
    v_and_b32 v161, v191, v9
    v_mfma_f32_32x32x16_bf16 v[80:95], v[168:171], v[184:187], v[80:95]
L_f0:
    s_waitcnt vmcnt(5)
.p2align 3
    v_mfma_f32_16x16x16_bf16 v[128:131], v[160:161], v[96:97], 0
    v_readlane_b32 s70, v196, 0
    v_cvt_pk_bf16_f32 v10, v145, v145
    v_mfma_f32_16x16x16_bf16 v[132:135], v[160:161], v[98:99], 0
    v_and_b32 v162, v190, v10
    v_and_b32 v163, v191, v10
    s_and_b32 s61, s70, s49
    s_waitcnt vmcnt(4)
    buffer_load_dwordx4 v[120:123], v2, s[16:19], s61 offen
    v_mfma_f32_16x16x16_bf16 v[136:139], v[162:163], v[100:101], 0
    v_readlane_b32 s71, v196, 1
    v_cvt_pk_bf16_f32 v9, v146, v146
    v_mfma_f32_16x16x16_bf16 v[140:143], v[162:163], v[102:103], 0
    v_and_b32 v160, v190, v9
    v_and_b32 v161, v191, v9
    s_and_b32 s61, s71, s49
    s_set_gpr_idx_on s64, gpr_idx(SRC2,DST)
    buffer_load_dwordx4 v[124:127], v2, s[16:19], s61 offen
    v_pk_fma_f32 v[16:17], v[128:129], v[64:65], v[16:17] op_sel_hi:[1,0,1]
    v_pk_fma_f32 v[18:19], v[130:131], v[64:65], v[18:19] op_sel_hi:[1,0,1]
    v_pk_fma_f32 v[20:21], v[132:133], v[80:81], v[20:21] op_sel_hi:[1,0,1]
    v_pk_fma_f32 v[22:23], v[134:135], v[80:81], v[22:23] op_sel_hi:[1,0,1]
    s_set_gpr_idx_idx s65
.p2align 3
    v_pk_fma_f32 v[16:17], v[136:137], v[64:65], v[16:17] op_sel:[0,1,0] op_sel_hi:[1,1,1]
    v_pk_fma_f32 v[18:19], v[138:139], v[64:65], v[18:19] op_sel:[0,1,0] op_sel_hi:[1,1,1]
    v_pk_fma_f32 v[20:21], v[140:141], v[80:81], v[20:21] op_sel:[0,1,0] op_sel_hi:[1,1,1]
    v_pk_fma_f32 v[22:23], v[142:143], v[80:81], v[22:23] op_sel:[0,1,0] op_sel_hi:[1,1,1]
    s_set_gpr_idx_off
    s_waitcnt vmcnt(5)
.p2align 3
    v_mfma_f32_16x16x16_bf16 v[128:131], v[160:161], v[104:105], 0
    v_readlane_b32 s64, v196, 2
    v_cvt_pk_bf16_f32 v10, v147, v147
    v_mfma_f32_16x16x16_bf16 v[132:135], v[160:161], v[106:107], 0
    v_and_b32 v162, v190, v10
    v_and_b32 v163, v191, v10
    s_and_b32 s61, s64, s49
    s_waitcnt vmcnt(4)
    buffer_load_dwordx4 v[96:99], v2, s[16:19], s61 offen
    v_mfma_f32_16x16x16_bf16 v[136:139], v[162:163], v[108:109], 0
    v_readlane_b32 s65, v196, 3
    v_cvt_pk_bf16_f32 v9, v148, v148
    v_mfma_f32_16x16x16_bf16 v[140:143], v[162:163], v[110:111], 0
    v_and_b32 v160, v190, v9
    v_and_b32 v161, v191, v9
    s_and_b32 s61, s65, s49
    s_set_gpr_idx_on s66, gpr_idx(SRC2,DST)
    buffer_load_dwordx4 v[100:103], v2, s[16:19], s61 offen
    v_pk_fma_f32 v[16:17], v[128:129], v[66:67], v[16:17] op_sel_hi:[1,0,1]
    v_pk_fma_f32 v[18:19], v[130:131], v[66:67], v[18:19] op_sel_hi:[1,0,1]
    v_pk_fma_f32 v[20:21], v[132:133], v[82:83], v[20:21] op_sel_hi:[1,0,1]
    v_pk_fma_f32 v[22:23], v[134:135], v[82:83], v[22:23] op_sel_hi:[1,0,1]
    s_set_gpr_idx_idx s67
.p2align 3
    v_pk_fma_f32 v[16:17], v[136:137], v[66:67], v[16:17] op_sel:[0,1,0] op_sel_hi:[1,1,1]
    v_pk_fma_f32 v[18:19], v[138:139], v[66:67], v[18:19] op_sel:[0,1,0] op_sel_hi:[1,1,1]
    v_pk_fma_f32 v[20:21], v[140:141], v[82:83], v[20:21] op_sel:[0,1,0] op_sel_hi:[1,1,1]
    v_pk_fma_f32 v[22:23], v[142:143], v[82:83], v[22:23] op_sel:[0,1,0] op_sel_hi:[1,1,1]
    s_set_gpr_idx_off
    s_waitcnt vmcnt(5)
.p2align 3
    v_mfma_f32_16x16x16_bf16 v[128:131], v[160:161], v[112:113], 0
    v_readlane_b32 s66, v196, 4
    v_cvt_pk_bf16_f32 v10, v149, v149
    v_mfma_f32_16x16x16_bf16 v[132:135], v[160:161], v[114:115], 0
    v_and_b32 v162, v190, v10
    v_and_b32 v163, v191, v10
    s_and_b32 s61, s66, s49
    s_waitcnt vmcnt(4)
    buffer_load_dwordx4 v[104:107], v2, s[16:19], s61 offen
    v_mfma_f32_16x16x16_bf16 v[136:139], v[162:163], v[116:117], 0
    v_readlane_b32 s67, v196, 5
    v_cvt_pk_bf16_f32 v9, v150, v150
    v_mfma_f32_16x16x16_bf16 v[140:143], v[162:163], v[118:119], 0
    v_and_b32 v160, v190, v9
    v_and_b32 v161, v191, v9
    s_and_b32 s61, s67, s49
    s_set_gpr_idx_on s68, gpr_idx(SRC2,DST)
    buffer_load_dwordx4 v[108:111], v2, s[16:19], s61 offen
    v_pk_fma_f32 v[16:17], v[128:129], v[68:69], v[16:17] op_sel_hi:[1,0,1]
    v_pk_fma_f32 v[18:19], v[130:131], v[68:69], v[18:19] op_sel_hi:[1,0,1]
    v_pk_fma_f32 v[20:21], v[132:133], v[84:85], v[20:21] op_sel_hi:[1,0,1]
    v_pk_fma_f32 v[22:23], v[134:135], v[84:85], v[22:23] op_sel_hi:[1,0,1]
    s_set_gpr_idx_idx s69
.p2align 3
    v_pk_fma_f32 v[16:17], v[136:137], v[68:69], v[16:17] op_sel:[0,1,0] op_sel_hi:[1,1,1]
    v_pk_fma_f32 v[18:19], v[138:139], v[68:69], v[18:19] op_sel:[0,1,0] op_sel_hi:[1,1,1]
    v_pk_fma_f32 v[20:21], v[140:141], v[84:85], v[20:21] op_sel:[0,1,0] op_sel_hi:[1,1,1]
    v_pk_fma_f32 v[22:23], v[142:143], v[84:85], v[22:23] op_sel:[0,1,0] op_sel_hi:[1,1,1]
    s_set_gpr_idx_off
    s_waitcnt vmcnt(5)
.p2align 3
    v_mfma_f32_16x16x16_bf16 v[128:131], v[160:161], v[120:121], 0
    v_readlane_b32 s68, v196, 6
    v_cvt_pk_bf16_f32 v10, v151, v151
    v_mfma_f32_16x16x16_bf16 v[132:135], v[160:161], v[122:123], 0
    v_and_b32 v162, v190, v10
    v_and_b32 v163, v191, v10
    s_and_b32 s61, s68, s49
    s_waitcnt vmcnt(4)
    buffer_load_dwordx4 v[112:115], v2, s[16:19], s61 offen
    v_mfma_f32_16x16x16_bf16 v[136:139], v[162:163], v[124:125], 0
    v_readlane_b32 s69, v196, 7
    v_cvt_pk_bf16_f32 v9, v152, v152
    v_mfma_f32_16x16x16_bf16 v[140:143], v[162:163], v[126:127], 0
    v_and_b32 v160, v190, v9
    v_and_b32 v161, v191, v9
    s_and_b32 s61, s69, s49
    s_set_gpr_idx_on s70, gpr_idx(SRC2,DST)
    buffer_load_dwordx4 v[116:119], v2, s[16:19], s61 offen
    v_pk_fma_f32 v[16:17], v[128:129], v[70:71], v[16:17] op_sel_hi:[1,0,1]
    v_pk_fma_f32 v[18:19], v[130:131], v[70:71], v[18:19] op_sel_hi:[1,0,1]
    v_pk_fma_f32 v[20:21], v[132:133], v[86:87], v[20:21] op_sel_hi:[1,0,1]
    v_pk_fma_f32 v[22:23], v[134:135], v[86:87], v[22:23] op_sel_hi:[1,0,1]
    s_set_gpr_idx_idx s71
.p2align 3
    v_pk_fma_f32 v[16:17], v[136:137], v[70:71], v[16:17] op_sel:[0,1,0] op_sel_hi:[1,1,1]
    v_pk_fma_f32 v[18:19], v[138:139], v[70:71], v[18:19] op_sel:[0,1,0] op_sel_hi:[1,1,1]
    v_pk_fma_f32 v[20:21], v[140:141], v[86:87], v[20:21] op_sel:[0,1,0] op_sel_hi:[1,1,1]
    v_pk_fma_f32 v[22:23], v[142:143], v[86:87], v[22:23] op_sel:[0,1,0] op_sel_hi:[1,1,1]
    s_set_gpr_idx_off
    s_waitcnt vmcnt(5)
.p2align 3
    v_mfma_f32_16x16x16_bf16 v[128:131], v[160:161], v[96:97], 0
    v_readlane_b32 s70, v196, 8
    v_cvt_pk_bf16_f32 v10, v153, v153
    v_mfma_f32_16x16x16_bf16 v[132:135], v[160:161], v[98:99], 0
    v_and_b32 v162, v190, v10
    v_and_b32 v163, v191, v10
    s_and_b32 s61, s70, s49
    s_waitcnt vmcnt(4)
    buffer_load_dwordx4 v[120:123], v2, s[16:19], s61 offen
    v_mfma_f32_16x16x16_bf16 v[136:139], v[162:163], v[100:101], 0
    v_readlane_b32 s71, v196, 9
    v_cvt_pk_bf16_f32 v9, v154, v154
    v_mfma_f32_16x16x16_bf16 v[140:143], v[162:163], v[102:103], 0
    v_and_b32 v160, v190, v9
    v_and_b32 v161, v191, v9
    s_and_b32 s61, s71, s49
    s_set_gpr_idx_on s64, gpr_idx(SRC2,DST)
    buffer_load_dwordx4 v[124:127], v2, s[16:19], s61 offen
    v_pk_fma_f32 v[16:17], v[128:129], v[72:73], v[16:17] op_sel_hi:[1,0,1]
    v_pk_fma_f32 v[18:19], v[130:131], v[72:73], v[18:19] op_sel_hi:[1,0,1]
    v_pk_fma_f32 v[20:21], v[132:133], v[88:89], v[20:21] op_sel_hi:[1,0,1]
    v_pk_fma_f32 v[22:23], v[134:135], v[88:89], v[22:23] op_sel_hi:[1,0,1]
    s_set_gpr_idx_idx s65
.p2align 3
    v_pk_fma_f32 v[16:17], v[136:137], v[72:73], v[16:17] op_sel:[0,1,0] op_sel_hi:[1,1,1]
    v_pk_fma_f32 v[18:19], v[138:139], v[72:73], v[18:19] op_sel:[0,1,0] op_sel_hi:[1,1,1]
    v_pk_fma_f32 v[20:21], v[140:141], v[88:89], v[20:21] op_sel:[0,1,0] op_sel_hi:[1,1,1]
    v_pk_fma_f32 v[22:23], v[142:143], v[88:89], v[22:23] op_sel:[0,1,0] op_sel_hi:[1,1,1]
    s_set_gpr_idx_off
    s_waitcnt vmcnt(5)
.p2align 3
    v_mfma_f32_16x16x16_bf16 v[128:131], v[160:161], v[104:105], 0
    v_cvt_pk_bf16_f32 v10, v155, v155
    v_mfma_f32_16x16x16_bf16 v[132:135], v[160:161], v[106:107], 0
    v_and_b32 v162, v190, v10
    v_and_b32 v163, v191, v10
    s_waitcnt vmcnt(4)
.p2align 3
    s_nop 0
    v_mfma_f32_16x16x16_bf16 v[136:139], v[162:163], v[108:109], 0
    v_cvt_pk_bf16_f32 v9, v156, v156
    v_mfma_f32_16x16x16_bf16 v[140:143], v[162:163], v[110:111], 0
    v_and_b32 v160, v190, v9
    v_and_b32 v161, v191, v9
    s_set_gpr_idx_on s66, gpr_idx(SRC2,DST)
.p2align 3
    v_pk_fma_f32 v[16:17], v[128:129], v[74:75], v[16:17] op_sel_hi:[1,0,1]
    v_pk_fma_f32 v[18:19], v[130:131], v[74:75], v[18:19] op_sel_hi:[1,0,1]
    v_pk_fma_f32 v[20:21], v[132:133], v[90:91], v[20:21] op_sel_hi:[1,0,1]
    v_pk_fma_f32 v[22:23], v[134:135], v[90:91], v[22:23] op_sel_hi:[1,0,1]
    s_set_gpr_idx_idx s67
.p2align 3
    v_pk_fma_f32 v[16:17], v[136:137], v[74:75], v[16:17] op_sel:[0,1,0] op_sel_hi:[1,1,1]
    v_pk_fma_f32 v[18:19], v[138:139], v[74:75], v[18:19] op_sel:[0,1,0] op_sel_hi:[1,1,1]
    v_pk_fma_f32 v[20:21], v[140:141], v[90:91], v[20:21] op_sel:[0,1,0] op_sel_hi:[1,1,1]
    v_pk_fma_f32 v[22:23], v[142:143], v[90:91], v[22:23] op_sel:[0,1,0] op_sel_hi:[1,1,1]
    s_set_gpr_idx_off
    s_waitcnt vmcnt(3)
.p2align 3
    v_mfma_f32_16x16x16_bf16 v[128:131], v[160:161], v[112:113], 0
    v_cvt_pk_bf16_f32 v10, v157, v157
    v_mfma_f32_16x16x16_bf16 v[132:135], v[160:161], v[114:115], 0
    v_and_b32 v162, v190, v10
    v_and_b32 v163, v191, v10
    s_waitcnt vmcnt(2)
.p2align 3
    s_nop 0
    v_mfma_f32_16x16x16_bf16 v[136:139], v[162:163], v[116:117], 0
    v_cvt_pk_bf16_f32 v9, v158, v158
    v_mfma_f32_16x16x16_bf16 v[140:143], v[162:163], v[118:119], 0
    v_and_b32 v160, v190, v9
    v_and_b32 v161, v191, v9
    s_set_gpr_idx_on s68, gpr_idx(SRC2,DST)
.p2align 3
    v_pk_fma_f32 v[16:17], v[128:129], v[76:77], v[16:17] op_sel_hi:[1,0,1]
    v_pk_fma_f32 v[18:19], v[130:131], v[76:77], v[18:19] op_sel_hi:[1,0,1]
    v_pk_fma_f32 v[20:21], v[132:133], v[92:93], v[20:21] op_sel_hi:[1,0,1]
    v_pk_fma_f32 v[22:23], v[134:135], v[92:93], v[22:23] op_sel_hi:[1,0,1]
    s_set_gpr_idx_idx s69
.p2align 3
    v_pk_fma_f32 v[16:17], v[136:137], v[76:77], v[16:17] op_sel:[0,1,0] op_sel_hi:[1,1,1]
    v_pk_fma_f32 v[18:19], v[138:139], v[76:77], v[18:19] op_sel:[0,1,0] op_sel_hi:[1,1,1]
    v_pk_fma_f32 v[20:21], v[140:141], v[92:93], v[20:21] op_sel:[0,1,0] op_sel_hi:[1,1,1]
    v_pk_fma_f32 v[22:23], v[142:143], v[92:93], v[22:23] op_sel:[0,1,0] op_sel_hi:[1,1,1]
    s_set_gpr_idx_off
    s_waitcnt vmcnt(1)
.p2align 3
    v_mfma_f32_16x16x16_bf16 v[128:131], v[160:161], v[120:121], 0
    v_cvt_pk_bf16_f32 v10, v159, v159
    v_mfma_f32_16x16x16_bf16 v[132:135], v[160:161], v[122:123], 0
    v_and_b32 v162, v190, v10
    v_and_b32 v163, v191, v10
    s_waitcnt vmcnt(0)
.p2align 3
    s_nop 0
    v_mfma_f32_16x16x16_bf16 v[136:139], v[162:163], v[124:125], 0
    v_mfma_f32_16x16x16_bf16 v[140:143], v[162:163], v[126:127], 0
    s_set_gpr_idx_on s70, gpr_idx(SRC2,DST)
.p2align 3
    v_pk_fma_f32 v[16:17], v[128:129], v[78:79], v[16:17] op_sel_hi:[1,0,1]
    v_pk_fma_f32 v[18:19], v[130:131], v[78:79], v[18:19] op_sel_hi:[1,0,1]
    v_pk_fma_f32 v[20:21], v[132:133], v[94:95], v[20:21] op_sel_hi:[1,0,1]
    v_pk_fma_f32 v[22:23], v[134:135], v[94:95], v[22:23] op_sel_hi:[1,0,1]
    s_set_gpr_idx_idx s71
.p2align 3
    s_nop 0
    v_pk_fma_f32 v[16:17], v[136:137], v[78:79], v[16:17] op_sel:[0,1,0] op_sel_hi:[1,1,1]
    v_pk_fma_f32 v[18:19], v[138:139], v[78:79], v[18:19] op_sel:[0,1,0] op_sel_hi:[1,1,1]
    v_pk_fma_f32 v[20:21], v[140:141], v[94:95], v[20:21] op_sel:[0,1,0] op_sel_hi:[1,1,1]
    v_pk_fma_f32 v[22:23], v[142:143], v[94:95], v[22:23] op_sel:[0,1,0] op_sel_hi:[1,1,1]
    s_set_gpr_idx_off
L_swept:
    s_add_u32 s48, s48, 256
    s_cmp_lt_u32 s48, s47
    s_cbranch_scc1 L_again
    v_lshlrev_b32 v8, 2, v1
    s_mul_i32 s54, s56, 9
    v_cvt_pk_bf16_f32 v64, v16, v20
    v_cvt_pk_bf16_f32 v65, v17, v21
    v_cvt_pk_bf16_f32 v66, v18, v22
    v_cvt_pk_bf16_f32 v67, v19, v23
    v_add_u32 v84, s54, v8
    ds_write2_b32 v84, v64, v65 offset0:0 offset1:72
    ds_write2_b32 v84, v66, v67 offset0:144 offset1:216
    s_mul_i32 s54, s57, 9
    v_cvt_pk_bf16_f32 v68, v24, v28
    v_cvt_pk_bf16_f32 v69, v25, v29
    v_cvt_pk_bf16_f32 v70, v26, v30
    v_cvt_pk_bf16_f32 v71, v27, v31
    v_add_u32 v85, s54, v8
    ds_write2_b32 v85, v68, v69 offset0:0 offset1:72
    ds_write2_b32 v85, v70, v71 offset0:144 offset1:216
    s_mul_i32 s54, s58, 9
    v_cvt_pk_bf16_f32 v72, v32, v36
    v_cvt_pk_bf16_f32 v73, v33, v37
    v_cvt_pk_bf16_f32 v74, v34, v38
    v_cvt_pk_bf16_f32 v75, v35, v39
    v_add_u32 v86, s54, v8
    ds_write2_b32 v86, v72, v73 offset0:0 offset1:72
    ds_write2_b32 v86, v74, v75 offset0:144 offset1:216
    s_mul_i32 s54, s59, 9
    v_cvt_pk_bf16_f32 v76, v40, v44
    v_cvt_pk_bf16_f32 v77, v41, v45
    v_cvt_pk_bf16_f32 v78, v42, v46
    v_cvt_pk_bf16_f32 v79, v43, v47
    v_add_u32 v87, s54, v8
    ds_write2_b32 v87, v76, v77 offset0:0 offset1:72
    ds_write2_b32 v87, v78, v79 offset0:144 offset1:216
    s_mul_i32 s54, s60, 9
    v_cvt_pk_bf16_f32 v80, v48, v52
    v_cvt_pk_bf16_f32 v81, v49, v53
    v_cvt_pk_bf16_f32 v82, v50, v54
    v_cvt_pk_bf16_f32 v83, v51, v55
    v_add_u32 v88, s54, v8
    ds_write2_b32 v88, v80, v81 offset0:0 offset1:72
    ds_write2_b32 v88, v82, v83 offset0:144 offset1:216
    v_and_b32 v8, 15, v1
    v_lshrrev_b32 v9, 4, v1
    s_lshr_b32 s54, s3, 2
    s_mul_i32 s55, s54, 23040
    v_mul_u32_u24 v10, 288, v8
    v_lshl_add_u32 v10, v9, 4, v10
    v_add_u32 v10, s55, v10
    v_lshlrev_b32 v9, 10, v9
    v_lshl_add_u32 v9, v8, 2, v9
    s_mul_i32 s54, s54, 20480
    s_and_b32 s55, s3, 3
    s_lshl_b32 s55, s55, 6
    s_add_u32 s54, s54, s55
    s_waitcnt lgkmcnt(0)
    s_barrier
    ds_read_b128 v[16:19], v10 offset:0
    ds_read_b128 v[20:23], v10 offset:64
    ds_read_b128 v[24:27], v10 offset:128
    ds_read_b128 v[28:31], v10 offset:192
    ds_read_b128 v[32:35], v10 offset:4608
    ds_read_b128 v[36:39], v10 offset:4672
    ds_read_b128 v[40:43], v10 offset:4736
    ds_read_b128 v[44:47], v10 offset:4800
    ds_read_b128 v[48:51], v10 offset:9216
    ds_read_b128 v[52:55], v10 offset:9280
    ds_read_b128 v[56:59], v10 offset:9344
    ds_read_b128 v[60:63], v10 offset:9408
    s_waitcnt lgkmcnt(11)
    v_mfma_f32_16x16x32_bf16 v[128:131], v[16:19], v[208:211], 0
    v_mfma_f32_16x16x32_bf16 v[132:135], v[16:19], v[212:215], 0
    s_waitcnt lgkmcnt(10)
    v_mfma_f32_16x16x32_bf16 v[128:131], v[20:23], v[216:219], v[128:131]
    v_mfma_f32_16x16x32_bf16 v[132:135], v[20:23], v[220:223], v[132:135]
    s_waitcnt lgkmcnt(9)
    v_mfma_f32_16x16x32_bf16 v[128:131], v[24:27], v[224:227], v[128:131]
    v_mfma_f32_16x16x32_bf16 v[132:135], v[24:27], v[228:231], v[132:135]
    s_waitcnt lgkmcnt(8)
    v_mfma_f32_16x16x32_bf16 v[128:131], v[28:31], v[232:235], v[128:131]
    v_mfma_f32_16x16x32_bf16 v[132:135], v[28:31], v[236:239], v[132:135]
    ds_read_b128 v[64:67], v10 offset:13824
    ds_read_b128 v[68:71], v10 offset:13888
    ds_read_b128 v[72:75], v10 offset:13952
    ds_read_b128 v[76:79], v10 offset:14016
    s_waitcnt lgkmcnt(8)
    v_mfma_f32_16x16x32_bf16 v[136:139], v[32:35], v[208:211], 0
    v_mfma_f32_16x16x32_bf16 v[140:143], v[32:35], v[212:215], 0
    v_mfma_f32_16x16x32_bf16 v[136:139], v[36:39], v[216:219], v[136:139]
    v_mfma_f32_16x16x32_bf16 v[140:143], v[36:39], v[220:223], v[140:143]
    v_mfma_f32_16x16x32_bf16 v[136:139], v[40:43], v[224:227], v[136:139]
    v_mfma_f32_16x16x32_bf16 v[140:143], v[40:43], v[228:231], v[140:143]
    v_mfma_f32_16x16x32_bf16 v[136:139], v[44:47], v[232:235], v[136:139]
    v_mfma_f32_16x16x32_bf16 v[140:143], v[44:47], v[236:239], v[140:143]
    v_cvt_pk_bf16_f32 v168, v128, v132
    buffer_store_dword v168, v9, s[40:43], s54 offen offset:0 sc1
    v_cvt_pk_bf16_f32 v169, v129, v133
    buffer_store_dword v169, v9, s[40:43], s54 offen offset:256 sc1
    v_cvt_pk_bf16_f32 v170, v130, v134
    buffer_store_dword v170, v9, s[40:43], s54 offen offset:512 sc1
    v_cvt_pk_bf16_f32 v171, v131, v135
    buffer_store_dword v171, v9, s[40:43], s54 offen offset:768 sc1
    s_add_u32 s54, s54, 4096
    ds_read_b128 v[80:83], v10 offset:18432
    ds_read_b128 v[84:87], v10 offset:18496
    ds_read_b128 v[88:91], v10 offset:18560
    ds_read_b128 v[92:95], v10 offset:18624
    s_waitcnt lgkmcnt(8)
    v_mfma_f32_16x16x32_bf16 v[144:147], v[48:51], v[208:211], 0
    v_mfma_f32_16x16x32_bf16 v[148:151], v[48:51], v[212:215], 0
    v_mfma_f32_16x16x32_bf16 v[144:147], v[52:55], v[216:219], v[144:147]
    v_mfma_f32_16x16x32_bf16 v[148:151], v[52:55], v[220:223], v[148:151]
    v_mfma_f32_16x16x32_bf16 v[144:147], v[56:59], v[224:227], v[144:147]
    v_mfma_f32_16x16x32_bf16 v[148:151], v[56:59], v[228:231], v[148:151]
    v_mfma_f32_16x16x32_bf16 v[144:147], v[60:63], v[232:235], v[144:147]
    v_mfma_f32_16x16x32_bf16 v[148:151], v[60:63], v[236:239], v[148:151]
    v_cvt_pk_bf16_f32 v172, v136, v140
    buffer_store_dword v172, v9, s[40:43], s54 offen offset:0 sc1
    v_cvt_pk_bf16_f32 v173, v137, v141
    buffer_store_dword v173, v9, s[40:43], s54 offen offset:256 sc1
    v_cvt_pk_bf16_f32 v174, v138, v142
    buffer_store_dword v174, v9, s[40:43], s54 offen offset:512 sc1
    v_cvt_pk_bf16_f32 v175, v139, v143
    buffer_store_dword v175, v9, s[40:43], s54 offen offset:768 sc1
    s_add_u32 s54, s54, 4096
    s_waitcnt lgkmcnt(4)
    v_mfma_f32_16x16x32_bf16 v[152:155], v[64:67], v[208:211], 0
    v_mfma_f32_16x16x32_bf16 v[156:159], v[64:67], v[212:215], 0
    v_mfma_f32_16x16x32_bf16 v[152:155], v[68:71], v[216:219], v[152:155]
    v_mfma_f32_16x16x32_bf16 v[156:159], v[68:71], v[220:223], v[156:159]
    v_mfma_f32_16x16x32_bf16 v[152:155], v[72:75], v[224:227], v[152:155]
    v_mfma_f32_16x16x32_bf16 v[156:159], v[72:75], v[228:231], v[156:159]
    v_mfma_f32_16x16x32_bf16 v[152:155], v[76:79], v[232:235], v[152:155]
    v_mfma_f32_16x16x32_bf16 v[156:159], v[76:79], v[236:239], v[156:159]
    v_cvt_pk_bf16_f32 v176, v144, v148
    buffer_store_dword v176, v9, s[40:43], s54 offen offset:0 sc1
    v_cvt_pk_bf16_f32 v177, v145, v149
    buffer_store_dword v177, v9, s[40:43], s54 offen offset:256 sc1
    v_cvt_pk_bf16_f32 v178, v146, v150
    buffer_store_dword v178, v9, s[40:43], s54 offen offset:512 sc1
    v_cvt_pk_bf16_f32 v179, v147, v151
    buffer_store_dword v179, v9, s[40:43], s54 offen offset:768 sc1
    s_add_u32 s54, s54, 4096
    s_waitcnt lgkmcnt(0)
    v_mfma_f32_16x16x32_bf16 v[160:163], v[80:83], v[208:211], 0
    v_mfma_f32_16x16x32_bf16 v[164:167], v[80:83], v[212:215], 0
    v_mfma_f32_16x16x32_bf16 v[160:163], v[84:87], v[216:219], v[160:163]
    v_mfma_f32_16x16x32_bf16 v[164:167], v[84:87], v[220:223], v[164:167]
    v_mfma_f32_16x16x32_bf16 v[160:163], v[88:91], v[224:227], v[160:163]
    v_mfma_f32_16x16x32_bf16 v[164:167], v[88:91], v[228:231], v[164:167]
    v_mfma_f32_16x16x32_bf16 v[160:163], v[92:95], v[232:235], v[160:163]
    v_mfma_f32_16x16x32_bf16 v[164:167], v[92:95], v[236:239], v[164:167]
    v_cvt_pk_bf16_f32 v180, v152, v156
    buffer_store_dword v180, v9, s[40:43], s54 offen offset:0 sc1
    v_cvt_pk_bf16_f32 v181, v153, v157
    buffer_store_dword v181, v9, s[40:43], s54 offen offset:256 sc1
    v_cvt_pk_bf16_f32 v182, v154, v158
    buffer_store_dword v182, v9, s[40:43], s54 offen offset:512 sc1
    v_cvt_pk_bf16_f32 v183, v155, v159
    buffer_store_dword v183, v9, s[40:43], s54 offen offset:768 sc1
    s_add_u32 s54, s54, 4096
    v_cvt_pk_bf16_f32 v184, v160, v164
    buffer_store_dword v184, v9, s[40:43], s54 offen offset:0 sc1
    v_cvt_pk_bf16_f32 v185, v161, v165
    buffer_store_dword v185, v9, s[40:43], s54 offen offset:256 sc1
    v_cvt_pk_bf16_f32 v186, v162, v166
    buffer_store_dword v186, v9, s[40:43], s54 offen offset:512 sc1
    v_cvt_pk_bf16_f32 v187, v163, v167
    buffer_store_dword v187, v9, s[40:43], s54 offen offset:768 sc1
    s_add_u32 s54, s54, 4096
    s_or_b32 s4, s2, s3
    s_cbranch_scc1 L_notag
    v_mov_b32 v8, s62
    v_lshlrev_b32 v10, 2, v1
    s_mov_b32 s54, 524288
    buffer_store_dword v8, v10, s[20:23], s54 offen sc1
L_notag:
L_done:
    s_endpgm
L_again:
    s_waitcnt vmcnt(0) lgkmcnt(0)
    s_barrier
    v_lshlrev_b32 v11, 2, v0
    v_mov_b32 v12, 0x00700000
    v_mov_b32 v13, 0
    ds_write_b32 v11, v12 offset:0
    ds_write_b32 v11, v12 offset:2048
    ds_write_b32 v11, v12 offset:4096
    ds_write_b32 v11, v12 offset:6144
    ds_write_b32 v11, v13 offset:8192
    ds_write_b32 v11, v13 offset:10240
    ds_write_b32 v11, v13 offset:12288
    v_add_u32 v3, v3, v4
    v_subrev_u32 v3, 256, v3
    v_max_i32 v3, 0, v3
    v_subrev_u32 v4, 256, v4
    v_max_i32 v4, 0, v4
    v_sub_u32 v3, v3, v4
    v_add_u32 v5, 256, v5
    s_sub_i32 s95, s95, 256
    v_lshl_add_u32 v8, v4, 2, v241
    s_waitcnt lgkmcnt(0)
    s_barrier
L_clip:
    v_add_u32 v10, v4, v3
    v_min_i32 v10, 256, v10
    v_sub_u32 v10, v10, v4
    v_add_u32 v10, v10, v240
L_masks:
    v_cmp_lt_i32 s[64:65], 0, v10
    v_cmp_lt_i32 s[66:67], 2, v10
    v_cmp_lt_i32 s[68:69], 4, v10
    v_cmp_lt_i32 s[70:71], 6, v10
    v_cmp_lt_i32 s[72:73], 8, v10
    v_cmp_lt_i32 s[74:75], 10, v10
    v_cmp_lt_i32 s[76:77], 12, v10
    v_cmp_lt_i32 s[78:79], 14, v10
    s_nop 0
    s_branch L_mapw
L_map2:
    v_add_u32 v8, 56, v8
    v_subrev_u32 v10, 14, v10
    s_branch L_masks
L_r1:
    ds_read_b32 v67, v242 offset:768
    ds_read_b32 v74, v243 offset:768
    ds_read_b32 v75, v243 offset:896
    s_waitcnt lgkmcnt(0)
    v_mad_u32_u24 v67, v67, 12, v244
    buffer_load_dwordx3 v[88:90], v67, s[24:27], 0 offen offset:2304 sc1
    v_lshl_add_u32 v74, v74, 5, v2
    s_add_u32 m0, s52, 4096
    s_nop 0
    buffer_load_dwordx4 v74, s[28:31], s98 offen offset:2048 sc1 lds
    v_lshl_add_u32 v75, v75, 5, v2
    s_add_u32 m0, s52, 4096
    s_nop 0
    buffer_load_dwordx4 v75, s[28:31], s98 offen offset:3072 sc1 lds
    s_branch L_r1b
L_r2:
    v_lshrrev_b32 v135, 21, v90
    v_lshlrev_b32 v135, 2, v135
    v_lshrrev_b32 v11, 26, v90
    v_lshl_or_b32 v11, v11, 4, v245
    s_mov_b64 exec, s[96:97]
    ds_add_rtn_u32 v131, v135, v6 offset:8192
    ds_add_u32 v11, v6 offset:14336
    s_mov_b64 exec, -1
    ds_write_b64 v246, v[88:89] offset:1536
    v_and_or_b32 v90, v90, s55, v247
    v_add_u32 v90, 402653184, v90
    s_branch L_r2b
L_r3:
    ds_read_b32 v135, v135 offset:8192
    s_waitcnt lgkmcnt(0)
    v_bfe_u32 v15, v135, 12, 3
    v_or_b32 v90, v15, v90
    v_and_b32 v67, 0x3ff, v135
    v_lshrrev_b32 v135, 16, v135
    v_add_u32 v135, v135, v131
    ds_read_b32 v67, v67 offset:16384
    s_waitcnt lgkmcnt(0)
    v_lshl_add_u32 v135, v135, 2, v67
    s_mov_b64 exec, s[96:97]
    ds_write_b32 v135, v90
    s_mov_b64 exec, -1
    s_branch L_r3b
L_poll:
    buffer_load_dwordx2 v[206:207], v10, s[20:23], s49 offen sc1
    s_sub_u32 s53, s53, 1
    s_cbranch_scc1 L_done
    s_waitcnt vmcnt(0)
    v_xor_b32 v11, s63, v206
    v_xor_b32 v12, s62, v207
    v_and_or_b32 v11, v11, s55, v12
    v_cmpx_ne_u32 vcc, 0, v11
    s_cbranch_execnz L_poll
    s_branch L_polled
L_rank2:
    ds_read_b32 v96, v248 offset:8192
    ds_read_b32 v97, v248 offset:8320
    ds_read_b32 v98, v248 offset:8448
    ds_read_b32 v99, v248 offset:8576
    ds_read_b32 v100, v248 offset:8704
    s_waitcnt lgkmcnt(0)
L_end:
    s_branch L_ranked
.section .rodata,"a"
.p2align 6
.amdhsa_kernel gather_scatter__tensor_product_equiv_mace__graph_kernel
  .amdhsa_next_free_vgpr 256
  .amdhsa_next_free_sgpr 102
  .amdhsa_accum_offset 256
  .amdhsa_group_segment_fixed_size 0
  .amdhsa_kernarg_size 88
  .amdhsa_user_sgpr_count 2
  .amdhsa_user_sgpr_kernarg_segment_ptr 1
  .amdhsa_system_sgpr_workgroup_id_x 1
  .amdhsa_float_denorm_mode_32 3
.end_amdhsa_kernel
```

```asm
; @launch grid=(256,1,1) block=(512,1,1) lds=147456
.amdgcn_target "amdgcn-amd-amdhsa--gfx950"
.text
.globl gather_scatter__tensor_product_equiv_mace__graph_kernel
.p2align 8
.type gather_scatter__tensor_product_equiv_mace__graph_kernel,@function
gather_scatter__tensor_product_equiv_mace__graph_kernel:
    s_cmp_ge_u32 s2, 256
    s_cbranch_scc1 L_done
    s_load_dwordx4 s[4:7], s[0:1], 8
    s_load_dwordx4 s[8:11], s[0:1], 24
    s_load_dwordx2 s[14:15], s[0:1], 80
    s_load_dwordx2 s[64:65], s[0:1], 0
    s_load_dwordx2 s[66:67], s[0:1], 40
    s_load_dwordx4 s[68:71], s[0:1], 48
    s_load_dwordx2 s[12:13], s[0:1], 64
    v_lshlrev_b32 v10, 3, v0
    s_getpc_b64 s[80:81]
L_pc:
    s_and_b32 s44, s2, 0xf8
    s_lshl_b32 s44, s44, 6
    v_and_b32 v11, 0x180, v10
    v_add_u32 v11, s44, v11
    v_min_u32 v11, L_end-L_pc, v11
    v_mov_b32 v113, s81
    v_add_co_u32 v112, vcc, s80, v11
    s_nop 1
    v_addc_co_u32 v113, vcc, 0, v113, vcc
    global_load_dword v205, v[112:113], off
    v_lshrrev_b32 v8, 6, v0
    v_and_b32 v1, 63, v0
    v_lshlrev_b32 v9, 2, v0
    v_mov_b32 v13, 0
    v_readfirstlane_b32 s3, v8
    ds_write_b32 v9, v13 offset:56320
    ds_write_b32 v9, v13 offset:61440
    s_mul_i32 s54, s2, 5000
    s_mul_i32 s55, s2, 10000
    s_mul_i32 s61, s2, 40000
    v_lshlrev_b32 v2, 4, v1
    v_lshlrev_b32 v15, 4, v0
    v_mov_b32 v6, 1
    s_lshl_b32 s52, s3, 10
    s_add_u32 s52, s52, 81920
    s_movk_i32 s53, 4096
    s_movk_i32 s50, 8192
    s_mov_b32 s34, 5000
    s_mov_b32 s35, 0x20000
    s_mov_b32 s38, 5000
    s_mov_b32 s39, 0x20000
    s_mov_b32 s98, 10000
    s_mov_b32 s99, 0x20000
    s_mov_b32 s30, 40000
    s_mov_b32 s31, 0x20000
    s_waitcnt lgkmcnt(0)
    s_add_u32 s32, s6, s54
    s_addc_u32 s33, s7, 0
    buffer_load_dword v64, v9, s[32:35], 0 offen offset:0 nt
    buffer_load_dword v65, v9, s[32:35], 0 offen offset:2048 nt
    buffer_load_dword v66, v9, s[32:35], s53 offen nt
    s_add_u32 s36, s4, s54
    s_addc_u32 s37, s5, 0
    s_barrier
    buffer_load_dword v68, v9, s[36:39], 0 offen offset:0 nt
    buffer_load_dword v69, v9, s[36:39], 0 offen offset:2048 nt
    buffer_load_dword v70, v9, s[36:39], s53 offen nt
    s_load_dword s62, s[14:15], 524288
    s_add_u32 s96, s8, s55
    s_addc_u32 s97, s9, 0
    s_add_u32 s28, s10, s61
    s_addc_u32 s29, s11, 0
    buffer_load_dwordx2 v[72:73], v10, s[96:99], 0 offen nt
    buffer_load_dwordx2 v[74:75], v10, s[96:99], s53 offen nt
    buffer_load_dwordx2 v[76:77], v10, s[96:99], s50 offen nt
    s_add_u32 m0, s52, 0
    s_mov_b32 s54, 0
    buffer_load_dwordx4 v15, s[28:31], s54 offen nt lds
    s_add_u32 m0, s52, 8192
    s_mov_b32 s54, 8192
    buffer_load_dwordx4 v15, s[28:31], s54 offen nt lds
    s_add_u32 m0, s52, 16384
    s_mov_b32 s54, 16384
    buffer_load_dwordx4 v15, s[28:31], s54 offen nt lds
    s_mov_b32 s72, 109951168
    s_movk_i32 s73, 625
    s_movk_i32 s74, 838
    s_movk_i32 s54, 226
    v_cmp_gt_u32 s[84:85], s54, v0
    s_mov_b32 s20, s14
    s_mov_b32 s21, s15
    s_mov_b32 s22, 598016
    s_mov_b32 s23, 0x20000
    v_lshlrev_b32 v11, 2, v0
    v_mov_b32 v12, 0x00700000
    v_mov_b32 v13, 0
    ds_write_b32 v11, v12 offset:0
    ds_write_b32 v11, v12 offset:2048
    ds_write_b32 v11, v12 offset:4096
    ds_write_b32 v11, v12 offset:6144
    ds_write_b32 v11, v13 offset:8192
    ds_write_b32 v11, v13 offset:10240
    ds_write_b32 v11, v13 offset:12288
    ds_write_b32 v11, v13 offset:14336
    s_waitcnt vmcnt(9)
    v_mul_hi_u32 v80, v64, s72
    v_mul_hi_u32 v81, v65, s72
    v_mul_hi_u32 v82, v66, s72
    v_lshlrev_b32 v84, 2, v80
    ds_add_rtn_u32 v88, v84, v6 offset:56320
    v_lshlrev_b32 v85, 2, v81
    ds_add_rtn_u32 v89, v85, v6 offset:56320
    v_lshlrev_b32 v86, 2, v82
    s_mov_b64 exec, s[84:85]
    ds_add_rtn_u32 v90, v86, v6 offset:56320
    s_mov_b64 exec, -1
    s_waitcnt lgkmcnt(0)
    s_barrier
    ds_read_b128 v[100:103], v2 offset:56320
    s_mul_i32 s62, s62, 0x9e3779b1
    s_add_u32 s62, s62, 0x7f4a7c15
    s_mul_i32 s63, s62, 0x85ebca6b
    s_and_b32 s63, s63, 0xffc00000
    s_add_u32 m0, s52, 24576
    s_mov_b32 s54, 24576
    buffer_load_dwordx4 v15, s[28:31], s54 offen nt lds
    s_add_u32 m0, s52, 32768
    s_mov_b32 s54, 32768
    buffer_load_dwordx4 v15, s[28:31], s54 offen nt lds
    v_mad_u32_u24 v92, v80, s73, 15
    v_lshrrev_b32 v92, 4, v92
    v_sub_u32 v92, v64, v92
    v_lshrrev_b32 v80, 3, v80
    v_and_b32 v80, 28, v80
    v_mad_u32_u24 v93, v81, s73, 15
    v_lshrrev_b32 v93, 4, v93
    v_sub_u32 v93, v65, v93
    v_lshrrev_b32 v81, 3, v81
    v_and_b32 v81, 28, v81
    v_mad_u32_u24 v94, v82, s73, 15
    v_lshrrev_b32 v94, 4, v94
    v_sub_u32 v94, v66, v94
    v_lshrrev_b32 v82, 3, v82
    v_and_b32 v82, 28, v82
    s_waitcnt lgkmcnt(0)
    v_add_u32 v11, v100, v101
    v_add3_u32 v11, v11, v102, v103
    v_mov_b32 v12, v11
    s_nop 1
    v_add_u32_dpp v12, v12, v12 row_shr:1 row_mask:0xf bank_mask:0xf
    s_nop 1
    v_add_u32_dpp v12, v12, v12 row_shr:2 row_mask:0xf bank_mask:0xf
    s_nop 1
    v_add_u32_dpp v12, v12, v12 row_shr:4 row_mask:0xf bank_mask:0xf
    s_nop 1
    v_add_u32_dpp v12, v12, v12 row_shr:8 row_mask:0xf bank_mask:0xf
    s_nop 1
    v_add_u32_dpp v12, v12, v12 row_bcast:15 row_mask:0xa bank_mask:0xf
    s_nop 1
    v_add_u32_dpp v12, v12, v12 row_bcast:31 row_mask:0xc bank_mask:0xf
    v_sub_u32 v104, v12, v11
    v_add_u32 v105, v104, v100
    v_add_u32 v106, v105, v101
    v_add_u32 v107, v106, v102
    ds_write_b128 v2, v[104:107] offset:57344
    ds_read_b32 v108, v84 offset:57344
    ds_read_b32 v109, v85 offset:57344
    ds_read_b32 v110, v86 offset:57344
    s_waitcnt vmcnt(8)
    v_mul_u32_u24 v96, s74, v68
    v_lshrrev_b32 v96, 18, v96
    v_sub_u32 v96, v96, v80
    v_and_b32 v96, 31, v96
    v_lshl_or_b32 v96, v92, 5, v96
    v_lshlrev_b32 v96, 21, v96
    v_lshl_or_b32 v96, v68, 7, v96
    v_mul_u32_u24 v97, s74, v69
    v_lshrrev_b32 v97, 18, v97
    v_sub_u32 v97, v97, v81
    v_and_b32 v97, 31, v97
    v_lshl_or_b32 v97, v93, 5, v97
    v_lshlrev_b32 v97, 21, v97
    v_lshl_or_b32 v97, v69, 7, v97
    v_mul_u32_u24 v98, s74, v70
    v_lshrrev_b32 v98, 18, v98
    v_sub_u32 v98, v98, v82
    v_and_b32 v98, 31, v98
    v_lshl_or_b32 v98, v94, 5, v98
    v_lshlrev_b32 v98, 21, v98
    v_lshl_or_b32 v98, v70, 7, v98
    v_lshlrev_b32 v92, 5, v0
    v_add_u32 v93, 16384, v92
    v_add_u32 v94, 32768, v92
    s_mov_b32 s55, 63488
    s_waitcnt vmcnt(5) lgkmcnt(0)
    v_add_u32 v108, v108, v88
    v_lshlrev_b32 v84, 2, v108
    v_mad_u32_u24 v108, v108, 12, s55
    ds_write_b32 v84, v92 offset:58368
    ds_write2_b32 v108, v72, v73 offset0:0 offset1:1
    ds_write_b32 v108, v96 offset:8
    v_add_u32 v109, v109, v89
    v_lshlrev_b32 v85, 2, v109
    v_mad_u32_u24 v109, v109, 12, s55
    ds_write_b32 v85, v93 offset:58368
    ds_write2_b32 v109, v74, v75 offset0:0 offset1:1
    ds_write_b32 v109, v97 offset:8
    v_add_u32 v110, v110, v90
    v_lshlrev_b32 v86, 2, v110
    v_mad_u32_u24 v110, v110, 12, s55
    s_mov_b64 exec, s[84:85]
    ds_write_b32 v86, v94 offset:58368
    ds_write2_b32 v110, v76, v77 offset0:0 offset1:1
    ds_write_b32 v110, v98 offset:8
    s_mov_b64 exec, -1
    s_lshl_b32 s54, s3, 7
    v_lshl_add_u32 v11, v1, 3, s54
    ds_read_b64 v[100:101], v11 offset:56320
    ds_read_b64 v[104:105], v11 offset:57344
    s_mul_i32 s54, s2, 15360
    s_add_u32 s54, s54, 1048576
    s_add_u32 s32, s14, s54
    s_addc_u32 s33, s15, 0
    s_mov_b32 s34, 15360
    s_mov_b32 s35, 0x20000
    s_mul_i32 s54, s2, 40960
    s_add_u32 s54, s54, 5242880
    s_add_u32 s36, s14, s54
    s_addc_u32 s37, s15, 0
    s_mov_b32 s38, 40000
    s_mov_b32 s39, 0x20000
    v_lshrrev_b32 v11, 1, v0
    v_lshlrev_b32 v11, 2, v11
    v_and_b32 v12, 1, v0
    v_lshlrev_b32 v12, 4, v12
    v_add_u32 v12, 81920, v12
    v_add_u32 v14, 63488, v15
    s_waitcnt lgkmcnt(0)
    s_barrier
    ds_read_b128 v[128:131], v14
    ds_read_b128 v[132:135], v14 offset:8192
    ds_read_b32 v156, v11 offset:58368
    ds_read_b32 v157, v11 offset:59392
    ds_read_b32 v158, v11 offset:60416
    ds_read_b32 v159, v11 offset:61440
    ds_read_b32 v160, v11 offset:62464
    s_cmp_lt_u32 s3, 4
    s_cselect_b32 s16, s68, s66
    s_cselect_b32 s17, s69, s67
    s_movk_i32 s54, 128
    s_cselect_b32 s18, s53, s54
    s_mov_b32 s19, 0x20000
    s_min_u32 s54, s3, 5
    s_lshl_b32 s54, s54, 10
    s_add_u32 m0, s54, 17408
    s_and_b32 s54, s54, 0xc00
    buffer_load_dwordx4 v2, s[16:19], s54 offen lds
    s_mov_b32 s40, s70
    s_mov_b32 s41, s71
    s_mov_b32 s42, 32768
    s_mov_b32 s43, 0x20000
    s_lshl_b32 s55, s3, 12
    s_add_u32 m0, s55, 23552
    s_nop 0
    buffer_load_dwordx4 v2, s[40:43], s55 offen offset:0 lds
    buffer_load_dwordx4 v2, s[40:43], s55 offen offset:1024 lds
    buffer_load_dwordx4 v2, s[40:43], s55 offen offset:2048 lds
    buffer_load_dwordx4 v2, s[40:43], s55 offen offset:3072 lds
    s_waitcnt lgkmcnt(0)
    v_add_u32 v156, v12, v156
    v_add_u32 v157, v12, v157
    v_add_u32 v158, v12, v158
    v_add_u32 v159, v12, v159
    v_add_u32 v160, v12, v160
    v_lshl_or_b32 v112, v100, 11, v104
    v_or_b32 v112, s63, v112
    v_mov_b32 v113, s62
    v_lshl_or_b32 v114, v101, 11, v105
    v_or_b32 v114, s63, v114
    v_mov_b32 v115, s62
    s_waitcnt vmcnt(0)
    s_barrier
    ds_read_b128 v[136:139], v156
    ds_read_b128 v[140:143], v157
    ds_read_b128 v[144:147], v158
    ds_read_b128 v[148:151], v159
    ds_read_b128 v[152:155], v160
    buffer_store_dwordx4 v[128:131], v15, s[32:35], 0 offen sc1
    buffer_store_dwordx4 v[132:135], v15, s[32:35], s50 offen sc1
    s_mov_b32 s54, 0
    s_waitcnt lgkmcnt(4)
    buffer_store_dwordx4 v[136:139], v15, s[36:39], s54 offen sc1
    s_mov_b32 s54, 8192
    s_waitcnt lgkmcnt(3)
    buffer_store_dwordx4 v[140:143], v15, s[36:39], s54 offen sc1
    s_mov_b32 s54, 16384
    s_waitcnt lgkmcnt(2)
    buffer_store_dwordx4 v[144:147], v15, s[36:39], s54 offen sc1
    s_mov_b32 s54, 24576
    s_waitcnt lgkmcnt(1)
    buffer_store_dwordx4 v[148:151], v15, s[36:39], s54 offen sc1
    s_mov_b32 s54, 32768
    s_waitcnt lgkmcnt(0)
    buffer_store_dwordx4 v[152:155], v15, s[36:39], s54 offen sc1
    s_and_b32 s44, s2, 7
    s_lshl_b32 s44, s44, 5
    s_lshr_b32 s54, s2, 3
    s_add_u32 s44, s44, s54
    s_mul_i32 s45, s44, 625
    s_add_u32 s46, s45, 640
    s_add_u32 s45, s45, 15
    s_lshr_b32 s45, s45, 4
    s_lshr_b32 s46, s46, 4
    s_sub_u32 s46, s46, s45
    s_mov_b32 s86, 0x0f0f0f0f
    s_mov_b32 s87, 0x0f0f0f0f
    s_mov_b32 s88, 0xf0f0f0f0
    s_mov_b32 s89, 0xf0f0f0f0
    v_mov_b32 v164, 0
    v_mov_b32 v165, 0
    v_mov_b32 v166, 0
    v_mov_b32 v167, 0
    v_mov_b32 v168, 0
    v_mov_b32 v169, 0
    v_mov_b32 v170, 0
    v_mov_b32 v171, 0
    v_and_b32 v11, 4, v1
    v_lshlrev_b32 v11, 2, v11
    v_mov_b32 v12, 0xffff
    v_lshlrev_b32 v12, v11, v12
    v_bfe_i32 v11, v1, 3, 1
    v_and_b32 v191, v11, v12
    v_xor_b32 v190, v191, v12
    v_lshrrev_b32 v200, 5, v1
    v_lshlrev_b32 v200, 4, v200
    v_add_u32 v200, 81920, v200
    v_and_b32 v201, 15, v1
    v_lshlrev_b32 v201, 2, v201
    v_bfe_u32 v11, v1, 3, 2
    v_and_b32 v12, 3, v1
    v_lshl_add_u32 v11, v11, 2, v12
    v_lshlrev_b32 v202, 2, v11
    v_bfe_i32 v240, v0, 0, 1
    s_lshl_b32 s54, s3, 10
    v_and_b32 v241, 4, v240
    v_add_u32 v241, s54, v241
    v_lshl_add_u32 v242, v1, 2, s54
    v_lshrrev_b32 v243, 1, v1
    v_lshl_add_u32 v243, v243, 2, s54
    v_mul_u32_u24 v244, 12, v1
    v_and_b32 v245, 12, v242
    v_and_b32 v250, 124, v242
    v_lshlrev_b32 v246, 1, v242
    v_add_u32 v246, 65536, v246
    v_lshlrev_b32 v247, 19, v242
    s_mul_i32 s54, s3, 640
    v_add_u32 v248, s54, v250
    v_sub_u32 v249, 63, v1
    s_lshl_b32 s54, s3, 5
    v_lshl_add_u32 v251, v1, 2, s54
    v_lshrrev_b32 v252, 3, v1
    v_mul_u32_u24 v252, 64, v252
    v_add_u32 v252, 56320, v252
    s_cmp_eq_u32 s46, 40
    v_mov_b32 v203, 0
    s_mov_b32 s54, 685900808
    s_cselect_b32 s54, 568459824, s54
    s_mov_b32 exec_lo, 31
    s_mov_b32 exec_hi, 0
    v_mov_b32 v203, s54
    s_mov_b32 s54, 182814793
    s_cselect_b32 s54, 23232528, s54
    s_mov_b32 exec_lo, 992
    s_mov_b32 exec_hi, 0
    v_mov_b32 v203, s54
    s_mov_b32 s54, 984091248
    s_cselect_b32 s54, 719688297, s54
    s_mov_b32 exec_lo, 31744
    s_mov_b32 exec_hi, 0
    v_mov_b32 v203, s54
    s_mov_b32 s54, 424091761
    s_cselect_b32 s54, 984423522, s54
    s_mov_b32 exec_lo, 1015808
    s_mov_b32 exec_hi, 0
    v_mov_b32 v203, s54
    s_mov_b32 s54, 586001611
    s_cselect_b32 s54, 172635826, s54
    s_mov_b32 exec_lo, 32505856
    s_mov_b32 exec_hi, 0
    v_mov_b32 v203, s54
    s_mov_b32 s54, 64039106
    s_cselect_b32 s54, 454017211, s54
    s_mov_b32 exec_lo, 1040187392
    s_mov_b32 exec_hi, 0
    v_mov_b32 v203, s54
    s_mov_b32 s54, 330320603
    s_cselect_b32 s54, 743654643, s54
    s_mov_b32 exec_lo, 3221225472
    s_mov_b32 exec_hi, 7
    v_mov_b32 v203, s54
    s_mov_b32 s54, 217139484
    s_cselect_b32 s54, 607143691, s54
    s_mov_b32 exec_lo, 0
    s_mov_b32 exec_hi, 248
    v_mov_b32 v203, s54
    s_mov_b64 exec, -1
    v_mul_u32_u24 v11, 52, v1
    v_lshrrev_b32 v11, 8, v11
    v_mad_i32_i24 v11, v11, -5, v1
    v_mul_u32_u24 v11, 6, v11
    v_lshrrev_b32 v203, v11, v203
    v_and_b32 v11, 7, v203
    v_bfe_u32 v203, v203, 3, 3
    v_lshlrev_b32 v11, 12, v11
    v_lshl_or_b32 v203, v203, 7, v11
    s_add_u32 s24, s14, 1048576
    s_addc_u32 s25, s15, 0
    s_mov_b32 s26, 3932160
    s_mov_b32 s27, 0x20000
    v_mov_b32 v16, 0
    v_mov_b32 v17, 0
    v_mov_b32 v18, 0
    v_mov_b32 v19, 0
    v_mov_b32 v20, 0
    v_mov_b32 v21, 0
    v_mov_b32 v22, 0
    v_mov_b32 v23, 0
    v_mov_b32 v24, 0
    v_mov_b32 v25, 0
    v_mov_b32 v26, 0
    v_mov_b32 v27, 0
    v_mov_b32 v28, 0
    v_mov_b32 v29, 0
    v_mov_b32 v30, 0
    v_mov_b32 v31, 0
    v_mov_b32 v32, 0
    v_mov_b32 v33, 0
    v_mov_b32 v34, 0
    v_mov_b32 v35, 0
    v_mov_b32 v36, 0
    v_mov_b32 v37, 0
    v_mov_b32 v38, 0
    v_mov_b32 v39, 0
    v_mov_b32 v40, 0
    v_mov_b32 v41, 0
    v_mov_b32 v42, 0
    v_mov_b32 v43, 0
    v_mov_b32 v44, 0
    v_mov_b32 v45, 0
    v_mov_b32 v46, 0
    v_mov_b32 v47, 0
    v_mov_b32 v48, 0
    v_mov_b32 v49, 0
    v_mov_b32 v50, 0
    v_mov_b32 v51, 0
    v_mov_b32 v52, 0
    v_mov_b32 v53, 0
    v_mov_b32 v54, 0
    v_mov_b32 v55, 0
    v_mov_b32 v56, 0
    v_mov_b32 v57, 0
    v_mov_b32 v58, 0
    v_mov_b32 v59, 0
    v_mov_b32 v60, 0
    v_mov_b32 v61, 0
    v_mov_b32 v62, 0
    v_mov_b32 v63, 0
    s_lshl_b32 s54, s2, 3
    s_add_u32 s54, s54, s3
    s_lshl_b32 s54, s54, 8
    s_mov_b32 s16, s64
    s_mov_b32 s17, s65
    s_mov_b32 s18, 10240000
    s_mov_b32 s19, 0x20000
    s_add_u32 s28, s14, 5242880
    s_addc_u32 s29, s15, 0
    s_mov_b32 s30, 10485760
    s_mov_b32 s31, 0x20000
    s_and_b32 s51, s2, 7
    s_mul_i32 s51, s51, 1282048
    s_and_b32 s55, s2, 0xf8
    s_add_u32 s55, s55, s3
    s_mul_i32 s55, s55, 3328
    s_add_u32 s51, s51, s55
    v_min_u32 v14, 25, v1
    v_lshlrev_b32 v14, 7, v14
    s_waitcnt vmcnt(0)
    s_barrier
    s_mov_b64 exec, 0xffff
    buffer_store_dwordx4 v[112:115], v2, s[20:23], s54 offen sc1
    s_mov_b64 exec, -1
    buffer_load_dword v7, v14, s[16:19], s51 offen
    s_lshl_b32 s54, s45, 10
    s_add_u32 s40, s12, s54
    s_addc_u32 s41, s13, 0
    s_lshl_b32 s42, s46, 10
    s_mov_b32 s43, 0x20000
    v_lshrrev_b32 v8, 5, v1
    v_lshlrev_b32 v8, 11, v8
    v_and_b32 v9, 15, v1
    v_lshl_add_u32 v8, v9, 4, v8
    ds_read_b128 v[64:67], v8 offset:17408
    ds_read_b128 v[68:71], v8 offset:17664
    ds_read_b128 v[72:75], v8 offset:17920
    ds_read_b128 v[76:79], v8 offset:18176
    ds_read_b128 v[80:83], v8 offset:18432
    ds_read_b128 v[84:87], v8 offset:18688
    ds_read_b128 v[88:91], v8 offset:18944
    ds_read_b128 v[92:95], v8 offset:19200
    v_lshrrev_b32 v8, 4, v1
    v_lshlrev_b32 v8, 5, v8
    v_and_b32 v9, 3, v1
    v_lshl_add_u32 v8, v9, 1, v8
    ds_read_u16 v96, v8 offset:21504
    ds_read_u16 v97, v8 offset:21512
    ds_read_u16 v98, v8 offset:21520
    ds_read_u16 v99, v8 offset:21528
    v_bfe_i32 v10, v1, 4, 1
    v_and_b32 v10, 0x02020202, v10
    v_add_u32 v10, 0x05040100, v10
    s_waitcnt lgkmcnt(0)
    v_perm_b32 v172, v68, v64, v10
    v_perm_b32 v173, v76, v72, v10
    v_perm_b32 v174, v84, v80, v10
    v_perm_b32 v175, v92, v88, v10
    v_perm_b32 v176, v69, v65, v10
    v_perm_b32 v177, v77, v73, v10
    v_perm_b32 v178, v85, v81, v10
    v_perm_b32 v179, v93, v89, v10
    v_perm_b32 v180, v70, v66, v10
    v_perm_b32 v181, v78, v74, v10
    v_perm_b32 v182, v86, v82, v10
    v_perm_b32 v183, v94, v90, v10
    v_perm_b32 v184, v71, v67, v10
    v_perm_b32 v185, v79, v75, v10
    v_perm_b32 v186, v87, v83, v10
    v_perm_b32 v187, v95, v91, v10
    v_lshl_or_b32 v188, v97, 16, v96
    v_lshl_or_b32 v189, v99, 16, v98
    v_and_b32 v9, 15, v1
    v_lshrrev_b32 v8, 4, v1
    v_lshlrev_b32 v8, 13, v8
    v_lshl_add_u32 v8, v9, 2, v8
    s_and_b32 s72, s3, 3
    s_lshl_b32 s72, s72, 6
    s_add_u32 s72, s72, 23552
    v_add_u32 v8, s72, v8
    ds_read2st64_b32 v[128:129], v8 offset0:0 offset1:4
    ds_read2st64_b32 v[130:131], v8 offset0:8 offset1:12
    ds_read2st64_b32 v[132:133], v8 offset0:16 offset1:20
    ds_read2st64_b32 v[134:135], v8 offset0:24 offset1:28
    ds_read2st64_b32 v[136:137], v8 offset0:1 offset1:5
    ds_read2st64_b32 v[138:139], v8 offset0:9 offset1:13
    ds_read2st64_b32 v[140:141], v8 offset0:17 offset1:21
    ds_read2st64_b32 v[142:143], v8 offset0:25 offset1:29
    ds_read2st64_b32 v[144:145], v8 offset0:2 offset1:6
    ds_read2st64_b32 v[146:147], v8 offset0:10 offset1:14
    ds_read2st64_b32 v[148:149], v8 offset0:18 offset1:22
    ds_read2st64_b32 v[150:151], v8 offset0:26 offset1:30
    ds_read2st64_b32 v[152:153], v8 offset0:3 offset1:7
    ds_read2st64_b32 v[154:155], v8 offset0:11 offset1:15
    ds_read2st64_b32 v[156:157], v8 offset0:19 offset1:23
    ds_read2st64_b32 v[158:159], v8 offset0:27 offset1:31
    s_mov_b32 s72, 0x05040100
    s_mov_b32 s73, 0x07060302
    s_waitcnt lgkmcnt(12)
    v_perm_b32 v208, v129, v128, s72
    v_perm_b32 v209, v131, v130, s72
    v_perm_b32 v210, v133, v132, s72
    v_perm_b32 v211, v135, v134, s72
    v_perm_b32 v212, v129, v128, s73
    v_perm_b32 v213, v131, v130, s73
    v_perm_b32 v214, v133, v132, s73
    v_perm_b32 v215, v135, v134, s73
    s_waitcnt lgkmcnt(8)
    v_perm_b32 v216, v137, v136, s72
    v_perm_b32 v217, v139, v138, s72
    v_perm_b32 v218, v141, v140, s72
    v_perm_b32 v219, v143, v142, s72
    v_perm_b32 v220, v137, v136, s73
    v_perm_b32 v221, v139, v138, s73
    v_perm_b32 v222, v141, v140, s73
    v_perm_b32 v223, v143, v142, s73
    s_waitcnt lgkmcnt(4)
    v_perm_b32 v224, v145, v144, s72
    v_perm_b32 v225, v147, v146, s72
    v_perm_b32 v226, v149, v148, s72
    v_perm_b32 v227, v151, v150, s72
    v_perm_b32 v228, v145, v144, s73
    v_perm_b32 v229, v147, v146, s73
    v_perm_b32 v230, v149, v148, s73
    v_perm_b32 v231, v151, v150, s73
    s_waitcnt lgkmcnt(0)
    v_perm_b32 v232, v153, v152, s72
    v_perm_b32 v233, v155, v154, s72
    v_perm_b32 v234, v157, v156, s72
    v_perm_b32 v235, v159, v158, s72
    v_perm_b32 v236, v153, v152, s73
    v_perm_b32 v237, v155, v154, s73
    v_perm_b32 v238, v157, v156, s73
    v_perm_b32 v239, v159, v158, s73
    v_lshrrev_b32 v9, 1, v0
    v_lshlrev_b32 v10, 11, v9
    s_lshl_b32 s49, s44, 3
    v_mul_u32_u24 v5, 1280, v9
    s_mov_b32 s48, 0
    s_mov_b32 s53, 200000
    s_mov_b32 s55, 0xffc00000
    s_lshl_b32 s52, s3, 13
    s_add_u32 s52, s52, 81920
    s_movk_i32 s98, 4096
    s_waitcnt vmcnt(0)
    s_barrier
    buffer_load_dwordx2 v[206:207], v10, s[20:23], s49 offen sc1
    s_waitcnt vmcnt(0)
    v_xor_b32 v11, s63, v206
    v_xor_b32 v12, s62, v207
    v_and_or_b32 v11, v11, s55, v12
    v_cmpx_ne_u32 vcc, 0, v11
    s_cbranch_execnz L_poll
L_polled:
    s_mov_b64 exec, -1
    v_bfe_u32 v3, v206, 11, 11
    v_and_b32 v4, v3, v240
    v_add_u32 v10, v3, v240
    v_and_b32 v11, 0x7ff, v206
    v_add_u32_dpp v4, v4, v4 row_shr:1 row_mask:0xf bank_mask:0xf
    v_cmp_lt_i32 s[64:65], 0, v10
    v_cmp_lt_i32 s[66:67], 2, v10
    v_add_u32_dpp v4, v4, v4 row_shr:2 row_mask:0xf bank_mask:0xf
    v_cmp_lt_i32 s[68:69], 4, v10
    v_cmp_lt_i32 s[70:71], 6, v10
    v_add_u32_dpp v4, v4, v4 row_shr:4 row_mask:0xf bank_mask:0xf
    v_cmp_lt_i32 s[72:73], 8, v10
    v_cmp_lt_i32 s[74:75], 10, v10
    v_add_u32_dpp v4, v4, v4 row_shr:8 row_mask:0xf bank_mask:0xf
    v_cmp_lt_i32 s[76:77], 12, v10
    v_cmp_lt_i32 s[78:79], 14, v10
    v_add_u32_dpp v4, v4, v4 row_bcast:15 row_mask:0xa bank_mask:0xf
    v_add_u32 v5, v5, v11
    s_nop 0
    v_add_u32_dpp v4, v4, v4 row_bcast:31 row_mask:0xc bank_mask:0xf
    s_nop 0
    v_readlane_b32 s95, v4, 63
    v_mov_b32_dpp v4, v4 quad_perm:[0,0,2,2] row_mask:0xf bank_mask:0xf
    v_sub_u32 v5, v5, v4
    v_lshl_add_u32 v8, v4, 2, v241
    s_cmp_gt_u32 s95, 256
    s_cbranch_scc1 L_clip
L_mapw:
    s_mov_b64 exec, s[64:65]
    ds_write_b32 v8, v5 offset:0
    s_mov_b64 exec, s[66:67]
    ds_write_b32 v8, v5 offset:8
    s_mov_b64 exec, s[68:69]
    ds_write_b32 v8, v5 offset:16
    s_mov_b64 exec, s[70:71]
    ds_write_b32 v8, v5 offset:24
    s_mov_b64 exec, s[72:73]
    ds_write_b32 v8, v5 offset:32
    s_mov_b64 exec, s[74:75]
    ds_write_b32 v8, v5 offset:40
    s_mov_b64 exec, s[76:77]
    ds_write_b32 v8, v5 offset:48
    s_mov_b64 exec, -1
    s_cmp_lg_u64 s[78:79], 0
    s_cbranch_scc1 L_map2
    ds_read_b32 v64, v242 offset:0
    ds_read_b32 v65, v242 offset:256
    ds_read_b32 v66, v242 offset:512
    ds_read_b32 v68, v243 offset:0
    ds_read_b32 v69, v243 offset:128
    ds_read_b32 v70, v243 offset:256
    ds_read_b32 v71, v243 offset:384
    ds_read_b32 v72, v243 offset:512
    ds_read_b32 v73, v243 offset:640
    s_cmp_gt_i32 s95, 192
    s_cbranch_scc1 L_r1
L_r1b:
    s_waitcnt lgkmcnt(6)
    v_mad_u32_u24 v64, v64, 12, v244
    buffer_load_dwordx3 v[76:78], v64, s[24:27], 0 offen offset:0 sc1
    v_mad_u32_u24 v65, v65, 12, v244
    buffer_load_dwordx3 v[80:82], v65, s[24:27], 0 offen offset:768 sc1
    v_mad_u32_u24 v66, v66, 12, v244
    buffer_load_dwordx3 v[84:86], v66, s[24:27], 0 offen offset:1536 sc1
    v_mov_b32 v11, s95
    s_mov_b64 exec, 1
    ds_max_i32 v13, v11 offset:15360
    s_mov_b64 exec, -1
    s_waitcnt lgkmcnt(1)
    v_lshl_add_u32 v68, v68, 5, v2
    v_lshl_add_u32 v69, v69, 5, v2
    v_lshl_add_u32 v70, v70, 5, v2
    v_lshl_add_u32 v71, v71, 5, v2
    v_lshl_add_u32 v72, v72, 5, v2
    v_lshl_add_u32 v73, v73, 5, v2
    s_barrier
    s_add_u32 m0, s52, 0
    s_nop 0
    buffer_load_dwordx4 v68, s[28:31], 0 offen offset:0 sc1 lds
    v_add_u32 v11, 0, v1
    v_cmp_gt_i32 s[80:81], s95, v11
    v_add_u32 v11, 64, v1
    v_cmp_gt_i32 s[82:83], s95, v11
    v_add_u32 v11, 128, v1
    v_cmp_gt_i32 s[84:85], s95, v11
    v_add_u32 v11, 192, v1
    v_cmp_gt_i32 s[96:97], s95, v11
    s_mov_b32 s55, 0x1fff80
    s_mul_i32 s61, s3, 5
    s_waitcnt vmcnt(3)
    v_lshrrev_b32 v132, 21, v78
    v_lshlrev_b32 v132, 2, v132
    v_lshrrev_b32 v11, 26, v78
    v_lshl_or_b32 v11, v11, 4, v245
    s_mov_b64 exec, s[80:81]
    ds_add_rtn_u32 v128, v132, v6 offset:8192
    ds_add_u32 v11, v6 offset:14336
    s_mov_b64 exec, -1
    s_waitcnt vmcnt(2)
    v_lshrrev_b32 v133, 21, v82
    v_lshlrev_b32 v133, 2, v133
    v_lshrrev_b32 v11, 26, v82
    v_lshl_or_b32 v11, v11, 4, v245
    s_mov_b64 exec, s[82:83]
    ds_add_rtn_u32 v129, v133, v6 offset:8192
    ds_add_u32 v11, v6 offset:14336
    s_mov_b64 exec, -1
    s_waitcnt vmcnt(1)
    v_lshrrev_b32 v134, 21, v86
    v_lshlrev_b32 v134, 2, v134
    v_lshrrev_b32 v11, 26, v86
    v_lshl_or_b32 v11, v11, 4, v245
    s_mov_b64 exec, s[84:85]
    ds_add_rtn_u32 v130, v134, v6 offset:8192
    ds_add_u32 v11, v6 offset:14336
    s_mov_b64 exec, -1
    s_cmp_gt_i32 s95, 192
    s_cbranch_scc1 L_r2
L_r2b:
    ds_write_b64 v246, v[76:77] offset:0
    v_and_or_b32 v78, v78, s55, v247
    ds_write_b64 v246, v[80:81] offset:512
    v_and_or_b32 v82, v82, s55, v247
    v_add_u32 v82, 134217728, v82
    ds_write_b64 v246, v[84:85] offset:1024
    v_and_or_b32 v86, v86, s55, v247
    v_add_u32 v86, 268435456, v86
    s_add_u32 m0, s52, 0
    s_nop 0
    buffer_load_dwordx4 v69, s[28:31], 0 offen offset:1024 sc1 lds
    s_add_u32 m0, s52, 0
    s_nop 0
    buffer_load_dwordx4 v70, s[28:31], 0 offen offset:2048 sc1 lds
    s_waitcnt lgkmcnt(3)
    s_barrier
    s_cmp_lg_u32 s48, 0
    s_cbranch_scc1 L_rank2
    ds_read_b128 v[104:107], v2 offset:14336
    ds_read_b32 v96, v248 offset:8192
    ds_read_b32 v97, v248 offset:8320
    ds_read_b32 v98, v248 offset:8448
    ds_read_b32 v99, v248 offset:8576
    ds_read_b32 v100, v248 offset:8704
    ds_read_b32 v14, v13 offset:15360
    s_add_u32 s65, s61, 1
    s_add_u32 s66, s61, 2
    s_add_u32 s67, s61, 3
    s_add_u32 s68, s61, 4
    s_waitcnt lgkmcnt(6)
    v_add_u32 v9, v104, v105
    v_add3_u32 v9, v9, v106, v107
    v_lshl_or_b32 v9, v9, 6, v249
    s_nop 0
    v_readlane_b32 s64, v9, s61
    v_readlane_b32 s65, v9, s65
    v_readlane_b32 s66, v9, s66
    v_readlane_b32 s67, v9, s67
    v_readlane_b32 s68, v9, s68
    v_cmp_lt_u32 s[70:71], s64, v9
    v_cmp_lt_u32 s[72:73], s65, v9
    v_cmp_lt_u32 s[74:75], s66, v9
    v_cmp_lt_u32 s[76:77], s67, v9
    v_cmp_lt_u32 s[78:79], s68, v9
    s_bcnt1_i32_b64 s64, s[70:71]
    s_bcnt1_i32_b64 s65, s[72:73]
    s_bcnt1_i32_b64 s66, s[74:75]
    s_bcnt1_i32_b64 s67, s[76:77]
    s_bcnt1_i32_b64 s68, s[78:79]
    s_waitcnt lgkmcnt(0)
    v_readlane_b32 s90, v203, s64
    v_readlane_b32 s91, v203, s65
    v_readlane_b32 s92, v203, s66
    v_readlane_b32 s93, v203, s67
    v_readlane_b32 s94, v203, s68
    v_readfirstlane_b32 s47, v14
L_ranked:
    s_mov_b32 exec_hi, 0
    s_and_b32 s54, s90, 0x380
    v_add_u32 v104, s54, v250
    ds_add_rtn_u32 v96, v104, v96 offset:13312
    s_and_b32 s54, s91, 0x380
    v_add_u32 v105, s54, v250
    ds_add_rtn_u32 v97, v105, v97 offset:13312
    s_and_b32 s54, s92, 0x380
    v_add_u32 v106, s54, v250
    ds_add_rtn_u32 v98, v106, v98 offset:13312
    s_and_b32 s54, s93, 0x380
    v_add_u32 v107, s54, v250
    ds_add_rtn_u32 v99, v107, v99 offset:13312
    s_and_b32 s54, s94, 0x380
    v_add_u32 v108, s54, v250
    ds_add_rtn_u32 v100, v108, v100 offset:13312
    v_or_b32 v104, s90, v104
    v_or_b32 v105, s91, v105
    v_or_b32 v106, s92, v106
    v_or_b32 v107, s93, v107
    v_or_b32 v108, s94, v108
    v_writelane_b32 v11, s90, 0
    v_writelane_b32 v11, s91, 1
    v_writelane_b32 v11, s92, 2
    v_writelane_b32 v11, s93, 3
    v_writelane_b32 v11, s94, 4
    s_waitcnt lgkmcnt(4)
    v_lshl_or_b32 v96, v96, 16, v104
    ds_write_b32 v248, v96 offset:8192
    s_waitcnt lgkmcnt(4)
    v_lshl_or_b32 v97, v97, 16, v105
    ds_write_b32 v248, v97 offset:8320
    s_waitcnt lgkmcnt(4)
    v_lshl_or_b32 v98, v98, 16, v106
    ds_write_b32 v248, v98 offset:8448
    s_waitcnt lgkmcnt(4)
    v_lshl_or_b32 v99, v99, 16, v107
    ds_write_b32 v248, v99 offset:8576
    s_waitcnt lgkmcnt(4)
    v_lshl_or_b32 v100, v100, 16, v108
    ds_write_b32 v248, v100 offset:8704
    v_add_lshl_u32 v12, v1, s61, 7
    v_lshrrev_b32 v9, 10, v11
    v_bfe_u32 v11, v11, 2, 8
    v_or_b32 v11, v11, v9
    s_mov_b32 exec_lo, 31
    ds_write_b32 v11, v12 offset:15616
    s_mov_b64 exec, -1
    s_add_u32 m0, s52, 0
    s_nop 0
    buffer_load_dwordx4 v71, s[28:31], 0 offen offset:3072 sc1 lds
    s_add_u32 m0, s52, 4096
    s_nop 0
    buffer_load_dwordx4 v72, s[28:31], s98 offen offset:0 sc1 lds
    s_add_u32 m0, s52, 4096
    s_nop 0
    buffer_load_dwordx4 v73, s[28:31], s98 offen offset:1024 sc1 lds
    s_lshl_b32 s54, s3, 3
    s_add_u32 s55, s54, 7
    s_waitcnt lgkmcnt(0)
    s_barrier
    ds_read_b128 v[96:99], v2 offset:13312
    ds_read_b32 v132, v132 offset:8192
    ds_read_b32 v133, v133 offset:8192
    ds_read_b32 v134, v134 offset:8192
    ds_read_b32 v11, v251 offset:15616
    s_waitcnt lgkmcnt(4)
    v_add_u32 v9, v96, v97
    v_add3_u32 v9, v9, v98, v99
    v_mov_b32 v10, v9
    s_waitcnt lgkmcnt(1)
    v_bfe_u32 v15, v132, 12, 3
    v_add_u32_dpp v10, v10, v10 row_shr:1 row_mask:0xf bank_mask:0xf
    v_or_b32 v78, v15, v78
    v_and_b32 v64, 0x3ff, v132
    v_add_u32_dpp v10, v10, v10 row_shr:2 row_mask:0xf bank_mask:0xf
    v_lshrrev_b32 v132, 16, v132
    v_add_u32 v132, v132, v128
    v_add_u32_dpp v10, v10, v10 row_shr:4 row_mask:0xf bank_mask:0xf
    v_bfe_u32 v15, v133, 12, 3
    v_or_b32 v82, v15, v82
    v_add_u32_dpp v10, v10, v10 row_shr:8 row_mask:0xf bank_mask:0xf
    v_and_b32 v65, 0x3ff, v133
    v_lshrrev_b32 v133, 16, v133
    v_add_u32_dpp v10, v10, v10 row_bcast:15 row_mask:0xa bank_mask:0xf
    v_add_u32 v133, v133, v129
    v_bfe_u32 v15, v134, 12, 3
    v_add_u32_dpp v10, v10, v10 row_bcast:31 row_mask:0xc bank_mask:0xf
    v_or_b32 v86, v15, v86
    v_and_b32 v66, 0x3ff, v134
    v_sub_u32 v9, v10, v9
    v_lshl_add_u32 v104, v9, 2, v252
    v_lshl_add_u32 v105, v96, 2, v104
    v_lshl_add_u32 v106, v97, 2, v105
    v_lshl_add_u32 v107, v98, 2, v106
    ds_write_b128 v2, v[104:107] offset:16384
    ds_read_b32 v64, v64 offset:16384
    ds_read_b32 v65, v65 offset:16384
    ds_read_b32 v66, v66 offset:16384
    v_lshrrev_b32 v134, 16, v134
    v_add_u32 v134, v134, v130
    v_readlane_b32 s50, v10, s55
    v_readlane_b32 s53, v9, s54
    v_readlane_b32 s51, v104, s54
    v_mov_b32 v12, 2097029
    s_sub_u32 s50, s50, s53
    s_lshl_b32 s54, s50, 2
    v_add_u32 v198, s51, v201
    v_add_u32 v199, s51, v202
    v_add_u32 v9, s54, v198
    s_waitcnt lgkmcnt(2)
    v_lshl_add_u32 v132, v132, 2, v64
    s_mov_b64 exec, s[80:81]
    ds_write_b32 v132, v78
    s_mov_b64 exec, -1
    s_waitcnt lgkmcnt(2)
    v_lshl_add_u32 v133, v133, 2, v65
    s_mov_b64 exec, s[82:83]
    ds_write_b32 v133, v82
    s_mov_b64 exec, -1
    s_waitcnt lgkmcnt(2)
    v_lshl_add_u32 v134, v134, 2, v66
    s_mov_b64 exec, s[84:85]
    ds_write_b32 v134, v86
    s_mov_b64 exec, -1
    ds_write_b32 v9, v12
    s_cmp_gt_i32 s95, 192
    s_cbranch_scc1 L_r3
L_r3b:
    v_readlane_b32 s56, v11, 0
    v_readlane_b32 s57, v11, 1
    v_readlane_b32 s58, v11, 2
    v_readlane_b32 s59, v11, 3
    v_readlane_b32 s60, v11, 4
    s_add_u32 s54, s50, 1
    s_and_b32 s54, s54, -2
    s_add_u32 s53, s54, 15
    s_lshr_b32 s53, s53, 4
    s_sub_u32 s54, 0, s54
    s_and_b32 s54, s54, 15
    s_sub_u32 s53, s53, 1
    s_cmp_gt_i32 s53, 0
    s_cselect_b32 s54, s54, 0
    s_lshl_b32 s61, s54, 2
    v_subrev_u32 v198, s61, v198
    v_subrev_u32 v199, s61, v199
    s_and_b32 s61, s61, 32
    v_add_u32 v12, s61, v198
    s_and_b32 s72, s54, 6
    s_mov_b32 s55, 0x00fffc38
    s_mov_b32 s49, 0xffffff00
    s_mov_b32 s51, 65536
    s_cmp_lt_u32 s3, 4
    s_cbranch_scc1 L_np
    s_setprio 1
L_np:
    s_waitcnt vmcnt(0) lgkmcnt(0)
    s_barrier
    ds_read_b32 v196, v12
    ds_read_b32 v194, v199
    ds_read_b32 v197, v198 offset:24
    s_cmp_eq_u32 s50, 0
    s_cbranch_scc1 L_swept
    s_waitcnt lgkmcnt(1)
    v_lshlrev_b32 v196, 3, v196
    v_and_b32 v196, s55, v196
    v_lshrrev_b32 v8, 21, v194
    v_lshl_add_u32 v11, v8, 3, s51
    v_lshl_add_u32 v8, v8, 5, v200
    ds_read_b64 v[192:193], v11
    s_mov_b64 exec, s[86:87]
    ds_read_b128 v[164:167], v8
    s_mov_b64 exec, s[88:89]
    ds_read_b128 v[168:171], v8
    s_mov_b64 exec, -1
    s_cmp_eq_u32 s72, 2
    s_cbranch_scc1 L_p2
    s_cmp_eq_u32 s72, 4
    s_cbranch_scc1 L_p4
    s_cmp_eq_u32 s72, 6
    s_cbranch_scc1 L_p6
L_p0:
    v_readlane_b32 s64, v196, 0
    v_readlane_b32 s65, v196, 1
    s_and_b32 s61, s64, s49
    buffer_load_dwordx4 v[96:99], v2, s[16:19], s61 offen
    s_and_b32 s61, s65, s49
    buffer_load_dwordx4 v[100:103], v2, s[16:19], s61 offen
L_p2:
    v_readlane_b32 s66, v196, 2
    v_readlane_b32 s67, v196, 3
    s_and_b32 s61, s66, s49
    buffer_load_dwordx4 v[104:107], v2, s[16:19], s61 offen
    s_and_b32 s61, s67, s49
    buffer_load_dwordx4 v[108:111], v2, s[16:19], s61 offen
L_p4:
    v_readlane_b32 s68, v196, 4
    v_readlane_b32 s69, v196, 5
    s_and_b32 s61, s68, s49
    buffer_load_dwordx4 v[112:115], v2, s[16:19], s61 offen
    s_and_b32 s61, s69, s49
    buffer_load_dwordx4 v[116:119], v2, s[16:19], s61 offen
    s_cmp_eq_u32 s72, 0
    s_cbranch_scc1 L_pd
L_p6:
    v_readlane_b32 s70, v196, 6
    v_readlane_b32 s71, v196, 7
    s_and_b32 s61, s70, s49
    buffer_load_dwordx4 v[120:123], v2, s[16:19], s61 offen
    s_and_b32 s61, s71, s49
    buffer_load_dwordx4 v[124:127], v2, s[16:19], s61 offen
    s_cmp_eq_u32 s72, 2
    s_cbranch_scc1 L_pd
L_p8:
    v_readlane_b32 s64, v196, 8
    v_readlane_b32 s65, v196, 9
    s_and_b32 s61, s64, s49
    buffer_load_dwordx4 v[96:99], v2, s[16:19], s61 offen
    s_and_b32 s61, s65, s49
    buffer_load_dwordx4 v[100:103], v2, s[16:19], s61 offen
    s_cmp_eq_u32 s72, 4
    s_cbranch_scc1 L_pd
L_p10:
    v_readlane_b32 s66, v196, 10
    v_readlane_b32 s67, v196, 11
    s_and_b32 s61, s66, s49
    buffer_load_dwordx4 v[104:107], v2, s[16:19], s61 offen
    s_and_b32 s61, s67, s49
    buffer_load_dwordx4 v[108:111], v2, s[16:19], s61 offen
L_pd:
    s_waitcnt lgkmcnt(0)
.p2align 3
    v_mfma_f32_4x4x4_16b_bf16 v[144:147], v[192:193], v[188:189], 0 cbsz:4 abid:0
    v_mfma_f32_4x4x4_16b_bf16 v[148:151], v[192:193], v[188:189], 0 cbsz:4 abid:2
    v_mfma_f32_4x4x4_16b_bf16 v[152:155], v[192:193], v[188:189], 0 cbsz:4 abid:4
    v_mfma_f32_4x4x4_16b_bf16 v[156:159], v[192:193], v[188:189], 0 cbsz:4 abid:6
    v_mfma_f32_32x32x16_bf16 v[64:79], v[164:167], v[172:175], 0
    v_lshlrev_b32 v196, 3, v197
    v_and_b32 v196, s55, v196
    v_add_u32 v198, 64, v198
    v_add_u32 v199, 64, v199
    v_mfma_f32_32x32x16_bf16 v[80:95], v[164:167], v[180:183], 0
    ds_read_b32 v197, v198 offset:24
    ds_read_b32 v194, v199
    v_mfma_f32_32x32x16_bf16 v[64:79], v[168:171], v[176:179], v[64:79]
    v_mfma_f32_32x32x16_bf16 v[80:95], v[168:171], v[184:187], v[80:95]
    s_set_gpr_idx_on s54, gpr_idx(SRC0,SRC1)
    v_cvt_pk_bf16_f32 v9, v144, v144
    s_set_gpr_idx_off
    v_and_b32 v160, v190, v9
    v_and_b32 v161, v191, v9
    s_waitcnt lgkmcnt(0)
    v_lshrrev_b32 v8, 21, v194
    v_lshl_add_u32 v11, v8, 3, s51
    v_lshl_add_u32 v8, v8, 5, v200
    ds_read_b64 v[192:193], v11
    s_mov_b64 exec, s[86:87]
    ds_read_b128 v[164:167], v8
    s_mov_b64 exec, s[88:89]
    ds_read_b128 v[168:171], v8
    s_mov_b64 exec, -1
    s_cmp_eq_u32 s53, 0
    s_cbranch_scc1 L_f0
    s_cmp_eq_u32 s54, 2
    s_cbranch_scc1 L_j2
    s_cmp_eq_u32 s54, 4
    s_cbranch_scc1 L_j4
    s_cmp_eq_u32 s54, 6
    s_cbranch_scc1 L_j6
    s_cmp_eq_u32 s54, 8
    s_cbranch_scc1 L_j8
    s_cmp_eq_u32 s54, 10
    s_cbranch_scc1 L_j10
    s_cmp_eq_u32 s54, 12
    s_cbranch_scc1 L_j12
    s_cmp_eq_u32 s54, 14
    s_cbranch_scc1 L_j14
    s_branch L_j0
.p2align 3
L_loop:
    s_waitcnt lgkmcnt(0)
.p2align 3
    v_mfma_f32_4x4x4_16b_bf16 v[144:147], v[192:193], v[188:189], 0 cbsz:4 abid:0
    v_mfma_f32_4x4x4_16b_bf16 v[148:151], v[192:193], v[188:189], 0 cbsz:4 abid:2
    v_mfma_f32_4x4x4_16b_bf16 v[152:155], v[192:193], v[188:189], 0 cbsz:4 abid:4
    v_mfma_f32_4x4x4_16b_bf16 v[156:159], v[192:193], v[188:189], 0 cbsz:4 abid:6
    v_mfma_f32_32x32x16_bf16 v[64:79], v[164:167], v[172:175], 0
    v_lshlrev_b32 v196, 3, v197
    v_and_b32 v196, s55, v196
    v_add_u32 v198, 64, v198
    v_add_u32 v199, 64, v199
    v_mfma_f32_32x32x16_bf16 v[80:95], v[164:167], v[180:183], 0
    ds_read_b32 v197, v198 offset:24
    ds_read_b32 v194, v199
    v_mfma_f32_32x32x16_bf16 v[64:79], v[168:171], v[176:179], v[64:79]
    v_cvt_pk_bf16_f32 v9, v144, v144
    v_and_b32 v160, v190, v9
    v_and_b32 v161, v191, v9
    v_mfma_f32_32x32x16_bf16 v[80:95], v[168:171], v[184:187], v[80:95]
L_j0:
    s_waitcnt vmcnt(5)
.p2align 3
    v_mfma_f32_16x16x16_bf16 v[128:131], v[160:161], v[96:97], 0
    v_readlane_b32 s70, v196, 0
    v_cvt_pk_bf16_f32 v10, v145, v145
    v_mfma_f32_16x16x16_bf16 v[132:135], v[160:161], v[98:99], 0
    v_and_b32 v162, v190, v10
    v_and_b32 v163, v191, v10
    s_and_b32 s61, s70, s49
    s_waitcnt vmcnt(4)
    buffer_load_dwordx4 v[120:123], v2, s[16:19], s61 offen
    v_mfma_f32_16x16x16_bf16 v[136:139], v[162:163], v[100:101], 0
    v_readlane_b32 s71, v196, 1
    v_cvt_pk_bf16_f32 v9, v146, v146
    v_mfma_f32_16x16x16_bf16 v[140:143], v[162:163], v[102:103], 0
    v_and_b32 v160, v190, v9
    v_and_b32 v161, v191, v9
    s_and_b32 s61, s71, s49
    s_set_gpr_idx_on s64, gpr_idx(SRC2,DST)
    buffer_load_dwordx4 v[124:127], v2, s[16:19], s61 offen
    v_pk_fma_f32 v[16:17], v[128:129], v[64:65], v[16:17] op_sel_hi:[1,0,1]
    v_pk_fma_f32 v[18:19], v[130:131], v[64:65], v[18:19] op_sel_hi:[1,0,1]
    v_pk_fma_f32 v[20:21], v[132:133], v[80:81], v[20:21] op_sel_hi:[1,0,1]
    v_pk_fma_f32 v[22:23], v[134:135], v[80:81], v[22:23] op_sel_hi:[1,0,1]
    s_set_gpr_idx_idx s65
.p2align 3
    v_pk_fma_f32 v[16:17], v[136:137], v[64:65], v[16:17] op_sel:[0,1,0] op_sel_hi:[1,1,1]
    v_pk_fma_f32 v[18:19], v[138:139], v[64:65], v[18:19] op_sel:[0,1,0] op_sel_hi:[1,1,1]
    v_pk_fma_f32 v[20:21], v[140:141], v[80:81], v[20:21] op_sel:[0,1,0] op_sel_hi:[1,1,1]
    v_pk_fma_f32 v[22:23], v[142:143], v[80:81], v[22:23] op_sel:[0,1,0] op_sel_hi:[1,1,1]
    s_set_gpr_idx_off
L_j2:
    s_waitcnt vmcnt(5)
.p2align 3
    v_mfma_f32_16x16x16_bf16 v[128:131], v[160:161], v[104:105], 0
    v_readlane_b32 s64, v196, 2
    v_cvt_pk_bf16_f32 v10, v147, v147
    v_mfma_f32_16x16x16_bf16 v[132:135], v[160:161], v[106:107], 0
    v_and_b32 v162, v190, v10
    v_and_b32 v163, v191, v10
    s_and_b32 s61, s64, s49
    s_waitcnt vmcnt(4)
    buffer_load_dwordx4 v[96:99], v2, s[16:19], s61 offen
    v_mfma_f32_16x16x16_bf16 v[136:139], v[162:163], v[108:109], 0
    v_readlane_b32 s65, v196, 3
    v_cvt_pk_bf16_f32 v9, v148, v148
    v_mfma_f32_16x16x16_bf16 v[140:143], v[162:163], v[110:111], 0
    v_and_b32 v160, v190, v9
    v_and_b32 v161, v191, v9
    s_waitcnt lgkmcnt(0)
    v_lshrrev_b32 v8, 21, v194
    v_lshl_add_u32 v11, v8, 3, s51
    v_lshl_add_u32 v8, v8, 5, v200
    ds_read_b64 v[192:193], v11
    s_mov_b64 exec, s[86:87]
    ds_read_b128 v[164:167], v8
    s_mov_b64 exec, s[88:89]
    ds_read_b128 v[168:171], v8
    s_mov_b64 exec, -1
.p2align 3
    s_and_b32 s61, s65, s49
    s_set_gpr_idx_on s66, gpr_idx(SRC2,DST)
    buffer_load_dwordx4 v[100:103], v2, s[16:19], s61 offen
    v_pk_fma_f32 v[16:17], v[128:129], v[66:67], v[16:17] op_sel_hi:[1,0,1]
    v_pk_fma_f32 v[18:19], v[130:131], v[66:67], v[18:19] op_sel_hi:[1,0,1]
    v_pk_fma_f32 v[20:21], v[132:133], v[82:83], v[20:21] op_sel_hi:[1,0,1]
    v_pk_fma_f32 v[22:23], v[134:135], v[82:83], v[22:23] op_sel_hi:[1,0,1]
    s_set_gpr_idx_idx s67
.p2align 3
    v_pk_fma_f32 v[16:17], v[136:137], v[66:67], v[16:17] op_sel:[0,1,0] op_sel_hi:[1,1,1]
    v_pk_fma_f32 v[18:19], v[138:139], v[66:67], v[18:19] op_sel:[0,1,0] op_sel_hi:[1,1,1]
    v_pk_fma_f32 v[20:21], v[140:141], v[82:83], v[20:21] op_sel:[0,1,0] op_sel_hi:[1,1,1]
    v_pk_fma_f32 v[22:23], v[142:143], v[82:83], v[22:23] op_sel:[0,1,0] op_sel_hi:[1,1,1]
    s_set_gpr_idx_off
L_j4:
    s_waitcnt vmcnt(5)
.p2align 3
    v_mfma_f32_16x16x16_bf16 v[128:131], v[160:161], v[112:113], 0
    v_readlane_b32 s66, v196, 4
    v_cvt_pk_bf16_f32 v10, v149, v149
    v_mfma_f32_16x16x16_bf16 v[132:135], v[160:161], v[114:115], 0
    v_and_b32 v162, v190, v10
    v_and_b32 v163, v191, v10
    s_and_b32 s61, s66, s49
    s_waitcnt vmcnt(4)
    buffer_load_dwordx4 v[104:107], v2, s[16:19], s61 offen
    v_mfma_f32_16x16x16_bf16 v[136:139], v[162:163], v[116:117], 0
    v_readlane_b32 s67, v196, 5
    v_cvt_pk_bf16_f32 v9, v150, v150
    v_mfma_f32_16x16x16_bf16 v[140:143], v[162:163], v[118:119], 0
    v_and_b32 v160, v190, v9
    v_and_b32 v161, v191, v9
    s_and_b32 s61, s67, s49
    s_set_gpr_idx_on s68, gpr_idx(SRC2,DST)
    buffer_load_dwordx4 v[108:111], v2, s[16:19], s61 offen
    v_pk_fma_f32 v[16:17], v[128:129], v[68:69], v[16:17] op_sel_hi:[1,0,1]
    v_pk_fma_f32 v[18:19], v[130:131], v[68:69], v[18:19] op_sel_hi:[1,0,1]
    v_pk_fma_f32 v[20:21], v[132:133], v[84:85], v[20:21] op_sel_hi:[1,0,1]
    v_pk_fma_f32 v[22:23], v[134:135], v[84:85], v[22:23] op_sel_hi:[1,0,1]
    s_set_gpr_idx_idx s69
.p2align 3
    v_pk_fma_f32 v[16:17], v[136:137], v[68:69], v[16:17] op_sel:[0,1,0] op_sel_hi:[1,1,1]
    v_pk_fma_f32 v[18:19], v[138:139], v[68:69], v[18:19] op_sel:[0,1,0] op_sel_hi:[1,1,1]
    v_pk_fma_f32 v[20:21], v[140:141], v[84:85], v[20:21] op_sel:[0,1,0] op_sel_hi:[1,1,1]
    v_pk_fma_f32 v[22:23], v[142:143], v[84:85], v[22:23] op_sel:[0,1,0] op_sel_hi:[1,1,1]
    s_set_gpr_idx_off
L_j6:
    s_waitcnt vmcnt(5)
.p2align 3
    v_mfma_f32_16x16x16_bf16 v[128:131], v[160:161], v[120:121], 0
    v_readlane_b32 s68, v196, 6
    v_cvt_pk_bf16_f32 v10, v151, v151
    v_mfma_f32_16x16x16_bf16 v[132:135], v[160:161], v[122:123], 0
    v_and_b32 v162, v190, v10
    v_and_b32 v163, v191, v10
    s_and_b32 s61, s68, s49
    s_waitcnt vmcnt(4)
    buffer_load_dwordx4 v[112:115], v2, s[16:19], s61 offen
    v_mfma_f32_16x16x16_bf16 v[136:139], v[162:163], v[124:125], 0
    v_readlane_b32 s69, v196, 7
    v_cvt_pk_bf16_f32 v9, v152, v152
    v_mfma_f32_16x16x16_bf16 v[140:143], v[162:163], v[126:127], 0
    v_and_b32 v160, v190, v9
    v_and_b32 v161, v191, v9
    s_and_b32 s61, s69, s49
    s_set_gpr_idx_on s70, gpr_idx(SRC2,DST)
    buffer_load_dwordx4 v[116:119], v2, s[16:19], s61 offen
    v_pk_fma_f32 v[16:17], v[128:129], v[70:71], v[16:17] op_sel_hi:[1,0,1]
    v_pk_fma_f32 v[18:19], v[130:131], v[70:71], v[18:19] op_sel_hi:[1,0,1]
    v_pk_fma_f32 v[20:21], v[132:133], v[86:87], v[20:21] op_sel_hi:[1,0,1]
    v_pk_fma_f32 v[22:23], v[134:135], v[86:87], v[22:23] op_sel_hi:[1,0,1]
    s_set_gpr_idx_idx s71
.p2align 3
    v_pk_fma_f32 v[16:17], v[136:137], v[70:71], v[16:17] op_sel:[0,1,0] op_sel_hi:[1,1,1]
    v_pk_fma_f32 v[18:19], v[138:139], v[70:71], v[18:19] op_sel:[0,1,0] op_sel_hi:[1,1,1]
    v_pk_fma_f32 v[20:21], v[140:141], v[86:87], v[20:21] op_sel:[0,1,0] op_sel_hi:[1,1,1]
    v_pk_fma_f32 v[22:23], v[142:143], v[86:87], v[22:23] op_sel:[0,1,0] op_sel_hi:[1,1,1]
    s_set_gpr_idx_off
L_j8:
    s_waitcnt vmcnt(5)
.p2align 3
    v_mfma_f32_16x16x16_bf16 v[128:131], v[160:161], v[96:97], 0
    v_readlane_b32 s70, v196, 8
    v_cvt_pk_bf16_f32 v10, v153, v153
    v_mfma_f32_16x16x16_bf16 v[132:135], v[160:161], v[98:99], 0
    v_and_b32 v162, v190, v10
    v_and_b32 v163, v191, v10
    s_and_b32 s61, s70, s49
    s_waitcnt vmcnt(4)
    buffer_load_dwordx4 v[120:123], v2, s[16:19], s61 offen
    v_mfma_f32_16x16x16_bf16 v[136:139], v[162:163], v[100:101], 0
    v_readlane_b32 s71, v196, 9
    v_cvt_pk_bf16_f32 v9, v154, v154
    v_mfma_f32_16x16x16_bf16 v[140:143], v[162:163], v[102:103], 0
    v_and_b32 v160, v190, v9
    v_and_b32 v161, v191, v9
    s_and_b32 s61, s71, s49
    s_set_gpr_idx_on s64, gpr_idx(SRC2,DST)
    buffer_load_dwordx4 v[124:127], v2, s[16:19], s61 offen
    v_pk_fma_f32 v[16:17], v[128:129], v[72:73], v[16:17] op_sel_hi:[1,0,1]
    v_pk_fma_f32 v[18:19], v[130:131], v[72:73], v[18:19] op_sel_hi:[1,0,1]
    v_pk_fma_f32 v[20:21], v[132:133], v[88:89], v[20:21] op_sel_hi:[1,0,1]
    v_pk_fma_f32 v[22:23], v[134:135], v[88:89], v[22:23] op_sel_hi:[1,0,1]
    s_set_gpr_idx_idx s65
.p2align 3
    v_pk_fma_f32 v[16:17], v[136:137], v[72:73], v[16:17] op_sel:[0,1,0] op_sel_hi:[1,1,1]
    v_pk_fma_f32 v[18:19], v[138:139], v[72:73], v[18:19] op_sel:[0,1,0] op_sel_hi:[1,1,1]
    v_pk_fma_f32 v[20:21], v[140:141], v[88:89], v[20:21] op_sel:[0,1,0] op_sel_hi:[1,1,1]
    v_pk_fma_f32 v[22:23], v[142:143], v[88:89], v[22:23] op_sel:[0,1,0] op_sel_hi:[1,1,1]
    s_set_gpr_idx_off
L_j10:
    s_waitcnt vmcnt(5)
.p2align 3
    v_mfma_f32_16x16x16_bf16 v[128:131], v[160:161], v[104:105], 0
    v_readlane_b32 s64, v196, 10
    v_cvt_pk_bf16_f32 v10, v155, v155
    v_mfma_f32_16x16x16_bf16 v[132:135], v[160:161], v[106:107], 0
    v_and_b32 v162, v190, v10
    v_and_b32 v163, v191, v10
    s_and_b32 s61, s64, s49
    s_waitcnt vmcnt(4)
    buffer_load_dwordx4 v[96:99], v2, s[16:19], s61 offen
    v_mfma_f32_16x16x16_bf16 v[136:139], v[162:163], v[108:109], 0
    v_readlane_b32 s65, v196, 11
    v_cvt_pk_bf16_f32 v9, v156, v156
    v_mfma_f32_16x16x16_bf16 v[140:143], v[162:163], v[110:111], 0
    v_and_b32 v160, v190, v9
    v_and_b32 v161, v191, v9
    s_and_b32 s61, s65, s49
    s_set_gpr_idx_on s66, gpr_idx(SRC2,DST)
    buffer_load_dwordx4 v[100:103], v2, s[16:19], s61 offen
    v_pk_fma_f32 v[16:17], v[128:129], v[74:75], v[16:17] op_sel_hi:[1,0,1]
    v_pk_fma_f32 v[18:19], v[130:131], v[74:75], v[18:19] op_sel_hi:[1,0,1]
    v_pk_fma_f32 v[20:21], v[132:133], v[90:91], v[20:21] op_sel_hi:[1,0,1]
    v_pk_fma_f32 v[22:23], v[134:135], v[90:91], v[22:23] op_sel_hi:[1,0,1]
    s_set_gpr_idx_idx s67
.p2align 3
    v_pk_fma_f32 v[16:17], v[136:137], v[74:75], v[16:17] op_sel:[0,1,0] op_sel_hi:[1,1,1]
    v_pk_fma_f32 v[18:19], v[138:139], v[74:75], v[18:19] op_sel:[0,1,0] op_sel_hi:[1,1,1]
    v_pk_fma_f32 v[20:21], v[140:141], v[90:91], v[20:21] op_sel:[0,1,0] op_sel_hi:[1,1,1]
    v_pk_fma_f32 v[22:23], v[142:143], v[90:91], v[22:23] op_sel:[0,1,0] op_sel_hi:[1,1,1]
    s_set_gpr_idx_off
L_j12:
    s_waitcnt vmcnt(5)
.p2align 3
    v_mfma_f32_16x16x16_bf16 v[128:131], v[160:161], v[112:113], 0
    v_readlane_b32 s66, v196, 12
    v_cvt_pk_bf16_f32 v10, v157, v157
    v_mfma_f32_16x16x16_bf16 v[132:135], v[160:161], v[114:115], 0
    v_and_b32 v162, v190, v10
    v_and_b32 v163, v191, v10
    s_and_b32 s61, s66, s49
    s_waitcnt vmcnt(4)
    buffer_load_dwordx4 v[104:107], v2, s[16:19], s61 offen
    v_mfma_f32_16x16x16_bf16 v[136:139], v[162:163], v[116:117], 0
    v_readlane_b32 s67, v196, 13
    v_cvt_pk_bf16_f32 v9, v158, v158
    v_mfma_f32_16x16x16_bf16 v[140:143], v[162:163], v[118:119], 0
    v_and_b32 v160, v190, v9
    v_and_b32 v161, v191, v9
    s_and_b32 s61, s67, s49
    s_set_gpr_idx_on s68, gpr_idx(SRC2,DST)
    buffer_load_dwordx4 v[108:111], v2, s[16:19], s61 offen
    v_pk_fma_f32 v[16:17], v[128:129], v[76:77], v[16:17] op_sel_hi:[1,0,1]
    v_pk_fma_f32 v[18:19], v[130:131], v[76:77], v[18:19] op_sel_hi:[1,0,1]
    v_pk_fma_f32 v[20:21], v[132:133], v[92:93], v[20:21] op_sel_hi:[1,0,1]
    v_pk_fma_f32 v[22:23], v[134:135], v[92:93], v[22:23] op_sel_hi:[1,0,1]
    s_set_gpr_idx_idx s69
.p2align 3
    v_pk_fma_f32 v[16:17], v[136:137], v[76:77], v[16:17] op_sel:[0,1,0] op_sel_hi:[1,1,1]
    v_pk_fma_f32 v[18:19], v[138:139], v[76:77], v[18:19] op_sel:[0,1,0] op_sel_hi:[1,1,1]
    v_pk_fma_f32 v[20:21], v[140:141], v[92:93], v[20:21] op_sel:[0,1,0] op_sel_hi:[1,1,1]
    v_pk_fma_f32 v[22:23], v[142:143], v[92:93], v[22:23] op_sel:[0,1,0] op_sel_hi:[1,1,1]
    s_set_gpr_idx_off
L_j14:
    s_waitcnt vmcnt(5)
.p2align 3
    v_mfma_f32_16x16x16_bf16 v[128:131], v[160:161], v[120:121], 0
    v_readlane_b32 s68, v196, 14
    v_cvt_pk_bf16_f32 v10, v159, v159
    v_mfma_f32_16x16x16_bf16 v[132:135], v[160:161], v[122:123], 0
    v_and_b32 v162, v190, v10
    v_and_b32 v163, v191, v10
    s_and_b32 s61, s68, s49
    s_waitcnt vmcnt(4)
    buffer_load_dwordx4 v[112:115], v2, s[16:19], s61 offen
    v_mfma_f32_16x16x16_bf16 v[136:139], v[162:163], v[124:125], 0
    v_readlane_b32 s69, v196, 15
    v_mfma_f32_16x16x16_bf16 v[140:143], v[162:163], v[126:127], 0
    s_and_b32 s61, s69, s49
    s_set_gpr_idx_on s70, gpr_idx(SRC2,DST)
    buffer_load_dwordx4 v[116:119], v2, s[16:19], s61 offen
    v_pk_fma_f32 v[16:17], v[128:129], v[78:79], v[16:17] op_sel_hi:[1,0,1]
    v_pk_fma_f32 v[18:19], v[130:131], v[78:79], v[18:19] op_sel_hi:[1,0,1]
    v_pk_fma_f32 v[20:21], v[132:133], v[94:95], v[20:21] op_sel_hi:[1,0,1]
    v_pk_fma_f32 v[22:23], v[134:135], v[94:95], v[22:23] op_sel_hi:[1,0,1]
    s_set_gpr_idx_idx s71
    s_sub_u32 s53, s53, 1
.p2align 3
    v_pk_fma_f32 v[16:17], v[136:137], v[78:79], v[16:17] op_sel:[0,1,0] op_sel_hi:[1,1,1]
    v_pk_fma_f32 v[18:19], v[138:139], v[78:79], v[18:19] op_sel:[0,1,0] op_sel_hi:[1,1,1]
    v_pk_fma_f32 v[20:21], v[140:141], v[94:95], v[20:21] op_sel:[0,1,0] op_sel_hi:[1,1,1]
    v_pk_fma_f32 v[22:23], v[142:143], v[94:95], v[22:23] op_sel:[0,1,0] op_sel_hi:[1,1,1]
    s_set_gpr_idx_off
    s_cmp_lg_u32 s53, 0
    s_cbranch_scc1 L_loop
    s_waitcnt lgkmcnt(0)
.p2align 3
    v_mfma_f32_4x4x4_16b_bf16 v[144:147], v[192:193], v[188:189], 0 cbsz:4 abid:0
    v_mfma_f32_4x4x4_16b_bf16 v[148:151], v[192:193], v[188:189], 0 cbsz:4 abid:2
    v_mfma_f32_4x4x4_16b_bf16 v[152:155], v[192:193], v[188:189], 0 cbsz:4 abid:4
    v_mfma_f32_4x4x4_16b_bf16 v[156:159], v[192:193], v[188:189], 0 cbsz:4 abid:6
    v_mfma_f32_32x32x16_bf16 v[64:79], v[164:167], v[172:175], 0
    v_lshlrev_b32 v196, 3, v197
    v_and_b32 v196, s55, v196
    v_mfma_f32_32x32x16_bf16 v[80:95], v[164:167], v[180:183], 0
    v_mfma_f32_32x32x16_bf16 v[64:79], v[168:171], v[176:179], v[64:79]
    v_cvt_pk_bf16_f32 v9, v144, v144
    v_and_b32 v160, v190, v9
    v_and_b32 v161, v191, v9
    v_mfma_f32_32x32x16_bf16 v[80:95], v[168:171], v[184:187], v[80:95]
L_f0:
    s_waitcnt vmcnt(5)
.p2align 3
    v_mfma_f32_16x16x16_bf16 v[128:131], v[160:161], v[96:97], 0
    v_readlane_b32 s70, v196, 0
    v_cvt_pk_bf16_f32 v10, v145, v145
    v_mfma_f32_16x16x16_bf16 v[132:135], v[160:161], v[98:99], 0
    v_and_b32 v162, v190, v10
    v_and_b32 v163, v191, v10
    s_and_b32 s61, s70, s49
    s_waitcnt vmcnt(4)
    buffer_load_dwordx4 v[120:123], v2, s[16:19], s61 offen
    v_mfma_f32_16x16x16_bf16 v[136:139], v[162:163], v[100:101], 0
    v_readlane_b32 s71, v196, 1
    v_cvt_pk_bf16_f32 v9, v146, v146
    v_mfma_f32_16x16x16_bf16 v[140:143], v[162:163], v[102:103], 0
    v_and_b32 v160, v190, v9
    v_and_b32 v161, v191, v9
    s_and_b32 s61, s71, s49
    s_set_gpr_idx_on s64, gpr_idx(SRC2,DST)
    buffer_load_dwordx4 v[124:127], v2, s[16:19], s61 offen
    v_pk_fma_f32 v[16:17], v[128:129], v[64:65], v[16:17] op_sel_hi:[1,0,1]
    v_pk_fma_f32 v[18:19], v[130:131], v[64:65], v[18:19] op_sel_hi:[1,0,1]
    v_pk_fma_f32 v[20:21], v[132:133], v[80:81], v[20:21] op_sel_hi:[1,0,1]
    v_pk_fma_f32 v[22:23], v[134:135], v[80:81], v[22:23] op_sel_hi:[1,0,1]
    s_set_gpr_idx_idx s65
.p2align 3
    v_pk_fma_f32 v[16:17], v[136:137], v[64:65], v[16:17] op_sel:[0,1,0] op_sel_hi:[1,1,1]
    v_pk_fma_f32 v[18:19], v[138:139], v[64:65], v[18:19] op_sel:[0,1,0] op_sel_hi:[1,1,1]
    v_pk_fma_f32 v[20:21], v[140:141], v[80:81], v[20:21] op_sel:[0,1,0] op_sel_hi:[1,1,1]
    v_pk_fma_f32 v[22:23], v[142:143], v[80:81], v[22:23] op_sel:[0,1,0] op_sel_hi:[1,1,1]
    s_set_gpr_idx_off
    s_waitcnt vmcnt(5)
.p2align 3
    v_mfma_f32_16x16x16_bf16 v[128:131], v[160:161], v[104:105], 0
    v_readlane_b32 s64, v196, 2
    v_cvt_pk_bf16_f32 v10, v147, v147
    v_mfma_f32_16x16x16_bf16 v[132:135], v[160:161], v[106:107], 0
    v_and_b32 v162, v190, v10
    v_and_b32 v163, v191, v10
    s_and_b32 s61, s64, s49
    s_waitcnt vmcnt(4)
    buffer_load_dwordx4 v[96:99], v2, s[16:19], s61 offen
    v_mfma_f32_16x16x16_bf16 v[136:139], v[162:163], v[108:109], 0
    v_readlane_b32 s65, v196, 3
    v_cvt_pk_bf16_f32 v9, v148, v148
    v_mfma_f32_16x16x16_bf16 v[140:143], v[162:163], v[110:111], 0
    v_and_b32 v160, v190, v9
    v_and_b32 v161, v191, v9
    s_and_b32 s61, s65, s49
    s_set_gpr_idx_on s66, gpr_idx(SRC2,DST)
    buffer_load_dwordx4 v[100:103], v2, s[16:19], s61 offen
    v_pk_fma_f32 v[16:17], v[128:129], v[66:67], v[16:17] op_sel_hi:[1,0,1]
    v_pk_fma_f32 v[18:19], v[130:131], v[66:67], v[18:19] op_sel_hi:[1,0,1]
    v_pk_fma_f32 v[20:21], v[132:133], v[82:83], v[20:21] op_sel_hi:[1,0,1]
    v_pk_fma_f32 v[22:23], v[134:135], v[82:83], v[22:23] op_sel_hi:[1,0,1]
    s_set_gpr_idx_idx s67
.p2align 3
    v_pk_fma_f32 v[16:17], v[136:137], v[66:67], v[16:17] op_sel:[0,1,0] op_sel_hi:[1,1,1]
    v_pk_fma_f32 v[18:19], v[138:139], v[66:67], v[18:19] op_sel:[0,1,0] op_sel_hi:[1,1,1]
    v_pk_fma_f32 v[20:21], v[140:141], v[82:83], v[20:21] op_sel:[0,1,0] op_sel_hi:[1,1,1]
    v_pk_fma_f32 v[22:23], v[142:143], v[82:83], v[22:23] op_sel:[0,1,0] op_sel_hi:[1,1,1]
    s_set_gpr_idx_off
    s_waitcnt vmcnt(5)
.p2align 3
    v_mfma_f32_16x16x16_bf16 v[128:131], v[160:161], v[112:113], 0
    v_readlane_b32 s66, v196, 4
    v_cvt_pk_bf16_f32 v10, v149, v149
    v_mfma_f32_16x16x16_bf16 v[132:135], v[160:161], v[114:115], 0
    v_and_b32 v162, v190, v10
    v_and_b32 v163, v191, v10
    s_and_b32 s61, s66, s49
    s_waitcnt vmcnt(4)
    buffer_load_dwordx4 v[104:107], v2, s[16:19], s61 offen
    v_mfma_f32_16x16x16_bf16 v[136:139], v[162:163], v[116:117], 0
    v_readlane_b32 s67, v196, 5
    v_cvt_pk_bf16_f32 v9, v150, v150
    v_mfma_f32_16x16x16_bf16 v[140:143], v[162:163], v[118:119], 0
    v_and_b32 v160, v190, v9
    v_and_b32 v161, v191, v9
    s_and_b32 s61, s67, s49
    s_set_gpr_idx_on s68, gpr_idx(SRC2,DST)
    buffer_load_dwordx4 v[108:111], v2, s[16:19], s61 offen
    v_pk_fma_f32 v[16:17], v[128:129], v[68:69], v[16:17] op_sel_hi:[1,0,1]
    v_pk_fma_f32 v[18:19], v[130:131], v[68:69], v[18:19] op_sel_hi:[1,0,1]
    v_pk_fma_f32 v[20:21], v[132:133], v[84:85], v[20:21] op_sel_hi:[1,0,1]
    v_pk_fma_f32 v[22:23], v[134:135], v[84:85], v[22:23] op_sel_hi:[1,0,1]
    s_set_gpr_idx_idx s69
.p2align 3
    v_pk_fma_f32 v[16:17], v[136:137], v[68:69], v[16:17] op_sel:[0,1,0] op_sel_hi:[1,1,1]
    v_pk_fma_f32 v[18:19], v[138:139], v[68:69], v[18:19] op_sel:[0,1,0] op_sel_hi:[1,1,1]
    v_pk_fma_f32 v[20:21], v[140:141], v[84:85], v[20:21] op_sel:[0,1,0] op_sel_hi:[1,1,1]
    v_pk_fma_f32 v[22:23], v[142:143], v[84:85], v[22:23] op_sel:[0,1,0] op_sel_hi:[1,1,1]
    s_set_gpr_idx_off
    s_waitcnt vmcnt(5)
.p2align 3
    v_mfma_f32_16x16x16_bf16 v[128:131], v[160:161], v[120:121], 0
    v_readlane_b32 s68, v196, 6
    v_cvt_pk_bf16_f32 v10, v151, v151
    v_mfma_f32_16x16x16_bf16 v[132:135], v[160:161], v[122:123], 0
    v_and_b32 v162, v190, v10
    v_and_b32 v163, v191, v10
    s_and_b32 s61, s68, s49
    s_waitcnt vmcnt(4)
    buffer_load_dwordx4 v[112:115], v2, s[16:19], s61 offen
    v_mfma_f32_16x16x16_bf16 v[136:139], v[162:163], v[124:125], 0
    v_readlane_b32 s69, v196, 7
    v_cvt_pk_bf16_f32 v9, v152, v152
    v_mfma_f32_16x16x16_bf16 v[140:143], v[162:163], v[126:127], 0
    v_and_b32 v160, v190, v9
    v_and_b32 v161, v191, v9
    s_and_b32 s61, s69, s49
    s_set_gpr_idx_on s70, gpr_idx(SRC2,DST)
    buffer_load_dwordx4 v[116:119], v2, s[16:19], s61 offen
    v_pk_fma_f32 v[16:17], v[128:129], v[70:71], v[16:17] op_sel_hi:[1,0,1]
    v_pk_fma_f32 v[18:19], v[130:131], v[70:71], v[18:19] op_sel_hi:[1,0,1]
    v_pk_fma_f32 v[20:21], v[132:133], v[86:87], v[20:21] op_sel_hi:[1,0,1]
    v_pk_fma_f32 v[22:23], v[134:135], v[86:87], v[22:23] op_sel_hi:[1,0,1]
    s_set_gpr_idx_idx s71
.p2align 3
    v_pk_fma_f32 v[16:17], v[136:137], v[70:71], v[16:17] op_sel:[0,1,0] op_sel_hi:[1,1,1]
    v_pk_fma_f32 v[18:19], v[138:139], v[70:71], v[18:19] op_sel:[0,1,0] op_sel_hi:[1,1,1]
    v_pk_fma_f32 v[20:21], v[140:141], v[86:87], v[20:21] op_sel:[0,1,0] op_sel_hi:[1,1,1]
    v_pk_fma_f32 v[22:23], v[142:143], v[86:87], v[22:23] op_sel:[0,1,0] op_sel_hi:[1,1,1]
    s_set_gpr_idx_off
    s_waitcnt vmcnt(5)
.p2align 3
    v_mfma_f32_16x16x16_bf16 v[128:131], v[160:161], v[96:97], 0
    v_readlane_b32 s70, v196, 8
    v_cvt_pk_bf16_f32 v10, v153, v153
    v_mfma_f32_16x16x16_bf16 v[132:135], v[160:161], v[98:99], 0
    v_and_b32 v162, v190, v10
    v_and_b32 v163, v191, v10
    s_and_b32 s61, s70, s49
    s_waitcnt vmcnt(4)
    buffer_load_dwordx4 v[120:123], v2, s[16:19], s61 offen
    v_mfma_f32_16x16x16_bf16 v[136:139], v[162:163], v[100:101], 0
    v_readlane_b32 s71, v196, 9
    v_cvt_pk_bf16_f32 v9, v154, v154
    v_mfma_f32_16x16x16_bf16 v[140:143], v[162:163], v[102:103], 0
    v_and_b32 v160, v190, v9
    v_and_b32 v161, v191, v9
    s_and_b32 s61, s71, s49
    s_set_gpr_idx_on s64, gpr_idx(SRC2,DST)
    buffer_load_dwordx4 v[124:127], v2, s[16:19], s61 offen
    v_pk_fma_f32 v[16:17], v[128:129], v[72:73], v[16:17] op_sel_hi:[1,0,1]
    v_pk_fma_f32 v[18:19], v[130:131], v[72:73], v[18:19] op_sel_hi:[1,0,1]
    v_pk_fma_f32 v[20:21], v[132:133], v[88:89], v[20:21] op_sel_hi:[1,0,1]
    v_pk_fma_f32 v[22:23], v[134:135], v[88:89], v[22:23] op_sel_hi:[1,0,1]
    s_set_gpr_idx_idx s65
.p2align 3
    v_pk_fma_f32 v[16:17], v[136:137], v[72:73], v[16:17] op_sel:[0,1,0] op_sel_hi:[1,1,1]
    v_pk_fma_f32 v[18:19], v[138:139], v[72:73], v[18:19] op_sel:[0,1,0] op_sel_hi:[1,1,1]
    v_pk_fma_f32 v[20:21], v[140:141], v[88:89], v[20:21] op_sel:[0,1,0] op_sel_hi:[1,1,1]
    v_pk_fma_f32 v[22:23], v[142:143], v[88:89], v[22:23] op_sel:[0,1,0] op_sel_hi:[1,1,1]
    s_set_gpr_idx_off
    s_waitcnt vmcnt(5)
.p2align 3
    v_mfma_f32_16x16x16_bf16 v[128:131], v[160:161], v[104:105], 0
    v_cvt_pk_bf16_f32 v10, v155, v155
    v_mfma_f32_16x16x16_bf16 v[132:135], v[160:161], v[106:107], 0
    v_and_b32 v162, v190, v10
    v_and_b32 v163, v191, v10
    s_waitcnt vmcnt(4)
.p2align 3
    s_nop 0
    v_mfma_f32_16x16x16_bf16 v[136:139], v[162:163], v[108:109], 0
    v_cvt_pk_bf16_f32 v9, v156, v156
    v_mfma_f32_16x16x16_bf16 v[140:143], v[162:163], v[110:111], 0
    v_and_b32 v160, v190, v9
    v_and_b32 v161, v191, v9
    s_set_gpr_idx_on s66, gpr_idx(SRC2,DST)
.p2align 3
    v_pk_fma_f32 v[16:17], v[128:129], v[74:75], v[16:17] op_sel_hi:[1,0,1]
    v_pk_fma_f32 v[18:19], v[130:131], v[74:75], v[18:19] op_sel_hi:[1,0,1]
    v_pk_fma_f32 v[20:21], v[132:133], v[90:91], v[20:21] op_sel_hi:[1,0,1]
    v_pk_fma_f32 v[22:23], v[134:135], v[90:91], v[22:23] op_sel_hi:[1,0,1]
    s_set_gpr_idx_idx s67
.p2align 3
    v_pk_fma_f32 v[16:17], v[136:137], v[74:75], v[16:17] op_sel:[0,1,0] op_sel_hi:[1,1,1]
    v_pk_fma_f32 v[18:19], v[138:139], v[74:75], v[18:19] op_sel:[0,1,0] op_sel_hi:[1,1,1]
    v_pk_fma_f32 v[20:21], v[140:141], v[90:91], v[20:21] op_sel:[0,1,0] op_sel_hi:[1,1,1]
    v_pk_fma_f32 v[22:23], v[142:143], v[90:91], v[22:23] op_sel:[0,1,0] op_sel_hi:[1,1,1]
    s_set_gpr_idx_off
    s_waitcnt vmcnt(3)
.p2align 3
    v_mfma_f32_16x16x16_bf16 v[128:131], v[160:161], v[112:113], 0
    v_cvt_pk_bf16_f32 v10, v157, v157
    v_mfma_f32_16x16x16_bf16 v[132:135], v[160:161], v[114:115], 0
    v_and_b32 v162, v190, v10
    v_and_b32 v163, v191, v10
    s_waitcnt vmcnt(2)
.p2align 3
    s_nop 0
    v_mfma_f32_16x16x16_bf16 v[136:139], v[162:163], v[116:117], 0
    v_cvt_pk_bf16_f32 v9, v158, v158
    v_mfma_f32_16x16x16_bf16 v[140:143], v[162:163], v[118:119], 0
    v_and_b32 v160, v190, v9
    v_and_b32 v161, v191, v9
    s_set_gpr_idx_on s68, gpr_idx(SRC2,DST)
.p2align 3
    v_pk_fma_f32 v[16:17], v[128:129], v[76:77], v[16:17] op_sel_hi:[1,0,1]
    v_pk_fma_f32 v[18:19], v[130:131], v[76:77], v[18:19] op_sel_hi:[1,0,1]
    v_pk_fma_f32 v[20:21], v[132:133], v[92:93], v[20:21] op_sel_hi:[1,0,1]
    v_pk_fma_f32 v[22:23], v[134:135], v[92:93], v[22:23] op_sel_hi:[1,0,1]
    s_set_gpr_idx_idx s69
.p2align 3
    v_pk_fma_f32 v[16:17], v[136:137], v[76:77], v[16:17] op_sel:[0,1,0] op_sel_hi:[1,1,1]
    v_pk_fma_f32 v[18:19], v[138:139], v[76:77], v[18:19] op_sel:[0,1,0] op_sel_hi:[1,1,1]
    v_pk_fma_f32 v[20:21], v[140:141], v[92:93], v[20:21] op_sel:[0,1,0] op_sel_hi:[1,1,1]
    v_pk_fma_f32 v[22:23], v[142:143], v[92:93], v[22:23] op_sel:[0,1,0] op_sel_hi:[1,1,1]
    s_set_gpr_idx_off
    s_waitcnt vmcnt(1)
.p2align 3
    v_mfma_f32_16x16x16_bf16 v[128:131], v[160:161], v[120:121], 0
    v_cvt_pk_bf16_f32 v10, v159, v159
    v_mfma_f32_16x16x16_bf16 v[132:135], v[160:161], v[122:123], 0
    v_and_b32 v162, v190, v10
    v_and_b32 v163, v191, v10
    s_waitcnt vmcnt(0)
.p2align 3
    s_nop 0
    v_mfma_f32_16x16x16_bf16 v[136:139], v[162:163], v[124:125], 0
    v_mfma_f32_16x16x16_bf16 v[140:143], v[162:163], v[126:127], 0
    s_set_gpr_idx_on s70, gpr_idx(SRC2,DST)
.p2align 3
    v_pk_fma_f32 v[16:17], v[128:129], v[78:79], v[16:17] op_sel_hi:[1,0,1]
    v_pk_fma_f32 v[18:19], v[130:131], v[78:79], v[18:19] op_sel_hi:[1,0,1]
    v_pk_fma_f32 v[20:21], v[132:133], v[94:95], v[20:21] op_sel_hi:[1,0,1]
    v_pk_fma_f32 v[22:23], v[134:135], v[94:95], v[22:23] op_sel_hi:[1,0,1]
    s_set_gpr_idx_idx s71
.p2align 3
    s_nop 0
    v_pk_fma_f32 v[16:17], v[136:137], v[78:79], v[16:17] op_sel:[0,1,0] op_sel_hi:[1,1,1]
    v_pk_fma_f32 v[18:19], v[138:139], v[78:79], v[18:19] op_sel:[0,1,0] op_sel_hi:[1,1,1]
    v_pk_fma_f32 v[20:21], v[140:141], v[94:95], v[20:21] op_sel:[0,1,0] op_sel_hi:[1,1,1]
    v_pk_fma_f32 v[22:23], v[142:143], v[94:95], v[22:23] op_sel:[0,1,0] op_sel_hi:[1,1,1]
    s_set_gpr_idx_off
L_swept:
    s_add_u32 s48, s48, 256
    s_cmp_lt_u32 s48, s47
    s_cbranch_scc1 L_again
    v_lshlrev_b32 v8, 2, v1
    s_mul_i32 s54, s56, 9
    v_cvt_pk_bf16_f32 v64, v16, v20
    v_cvt_pk_bf16_f32 v65, v17, v21
    v_cvt_pk_bf16_f32 v66, v18, v22
    v_cvt_pk_bf16_f32 v67, v19, v23
    v_add_u32 v84, s54, v8
    ds_write2_b32 v84, v64, v65 offset0:0 offset1:72
    ds_write2_b32 v84, v66, v67 offset0:144 offset1:216
    s_mul_i32 s54, s57, 9
    v_cvt_pk_bf16_f32 v68, v24, v28
    v_cvt_pk_bf16_f32 v69, v25, v29
    v_cvt_pk_bf16_f32 v70, v26, v30
    v_cvt_pk_bf16_f32 v71, v27, v31
    v_add_u32 v85, s54, v8
    ds_write2_b32 v85, v68, v69 offset0:0 offset1:72
    ds_write2_b32 v85, v70, v71 offset0:144 offset1:216
    s_mul_i32 s54, s58, 9
    v_cvt_pk_bf16_f32 v72, v32, v36
    v_cvt_pk_bf16_f32 v73, v33, v37
    v_cvt_pk_bf16_f32 v74, v34, v38
    v_cvt_pk_bf16_f32 v75, v35, v39
    v_add_u32 v86, s54, v8
    ds_write2_b32 v86, v72, v73 offset0:0 offset1:72
    ds_write2_b32 v86, v74, v75 offset0:144 offset1:216
    s_mul_i32 s54, s59, 9
    v_cvt_pk_bf16_f32 v76, v40, v44
    v_cvt_pk_bf16_f32 v77, v41, v45
    v_cvt_pk_bf16_f32 v78, v42, v46
    v_cvt_pk_bf16_f32 v79, v43, v47
    v_add_u32 v87, s54, v8
    ds_write2_b32 v87, v76, v77 offset0:0 offset1:72
    ds_write2_b32 v87, v78, v79 offset0:144 offset1:216
    s_mul_i32 s54, s60, 9
    v_cvt_pk_bf16_f32 v80, v48, v52
    v_cvt_pk_bf16_f32 v81, v49, v53
    v_cvt_pk_bf16_f32 v82, v50, v54
    v_cvt_pk_bf16_f32 v83, v51, v55
    v_add_u32 v88, s54, v8
    ds_write2_b32 v88, v80, v81 offset0:0 offset1:72
    ds_write2_b32 v88, v82, v83 offset0:144 offset1:216
    v_and_b32 v8, 15, v1
    v_lshrrev_b32 v9, 4, v1
    s_lshr_b32 s54, s3, 2
    s_mul_i32 s55, s54, 23040
    v_mul_u32_u24 v10, 288, v8
    v_lshl_add_u32 v10, v9, 4, v10
    v_add_u32 v10, s55, v10
    v_lshlrev_b32 v9, 10, v9
    v_lshl_add_u32 v9, v8, 2, v9
    s_mul_i32 s54, s54, 20480
    s_and_b32 s55, s3, 3
    s_lshl_b32 s55, s55, 6
    s_add_u32 s54, s54, s55
    s_waitcnt lgkmcnt(0)
    s_barrier
    ds_read_b128 v[16:19], v10 offset:0
    ds_read_b128 v[20:23], v10 offset:64
    ds_read_b128 v[24:27], v10 offset:128
    ds_read_b128 v[28:31], v10 offset:192
    ds_read_b128 v[32:35], v10 offset:4608
    ds_read_b128 v[36:39], v10 offset:4672
    ds_read_b128 v[40:43], v10 offset:4736
    ds_read_b128 v[44:47], v10 offset:4800
    ds_read_b128 v[48:51], v10 offset:9216
    ds_read_b128 v[52:55], v10 offset:9280
    ds_read_b128 v[56:59], v10 offset:9344
    ds_read_b128 v[60:63], v10 offset:9408
    s_waitcnt lgkmcnt(11)
    v_mfma_f32_16x16x32_bf16 v[128:131], v[16:19], v[208:211], 0
    v_mfma_f32_16x16x32_bf16 v[132:135], v[16:19], v[212:215], 0
    s_waitcnt lgkmcnt(10)
    v_mfma_f32_16x16x32_bf16 v[128:131], v[20:23], v[216:219], v[128:131]
    v_mfma_f32_16x16x32_bf16 v[132:135], v[20:23], v[220:223], v[132:135]
    s_waitcnt lgkmcnt(9)
    v_mfma_f32_16x16x32_bf16 v[128:131], v[24:27], v[224:227], v[128:131]
    v_mfma_f32_16x16x32_bf16 v[132:135], v[24:27], v[228:231], v[132:135]
    s_waitcnt lgkmcnt(8)
    v_mfma_f32_16x16x32_bf16 v[128:131], v[28:31], v[232:235], v[128:131]
    v_mfma_f32_16x16x32_bf16 v[132:135], v[28:31], v[236:239], v[132:135]
    ds_read_b128 v[64:67], v10 offset:13824
    ds_read_b128 v[68:71], v10 offset:13888
    ds_read_b128 v[72:75], v10 offset:13952
    ds_read_b128 v[76:79], v10 offset:14016
    s_waitcnt lgkmcnt(8)
    v_mfma_f32_16x16x32_bf16 v[136:139], v[32:35], v[208:211], 0
    v_mfma_f32_16x16x32_bf16 v[140:143], v[32:35], v[212:215], 0
    v_mfma_f32_16x16x32_bf16 v[136:139], v[36:39], v[216:219], v[136:139]
    v_mfma_f32_16x16x32_bf16 v[140:143], v[36:39], v[220:223], v[140:143]
    v_mfma_f32_16x16x32_bf16 v[136:139], v[40:43], v[224:227], v[136:139]
    v_mfma_f32_16x16x32_bf16 v[140:143], v[40:43], v[228:231], v[140:143]
    v_mfma_f32_16x16x32_bf16 v[136:139], v[44:47], v[232:235], v[136:139]
    v_mfma_f32_16x16x32_bf16 v[140:143], v[44:47], v[236:239], v[140:143]
    v_cvt_pk_bf16_f32 v168, v128, v132
    buffer_store_dword v168, v9, s[40:43], s54 offen offset:0 sc1
    v_cvt_pk_bf16_f32 v169, v129, v133
    buffer_store_dword v169, v9, s[40:43], s54 offen offset:256 sc1
    v_cvt_pk_bf16_f32 v170, v130, v134
    buffer_store_dword v170, v9, s[40:43], s54 offen offset:512 sc1
    v_cvt_pk_bf16_f32 v171, v131, v135
    buffer_store_dword v171, v9, s[40:43], s54 offen offset:768 sc1
    s_add_u32 s54, s54, 4096
    ds_read_b128 v[80:83], v10 offset:18432
    ds_read_b128 v[84:87], v10 offset:18496
    ds_read_b128 v[88:91], v10 offset:18560
    ds_read_b128 v[92:95], v10 offset:18624
    s_waitcnt lgkmcnt(8)
    v_mfma_f32_16x16x32_bf16 v[144:147], v[48:51], v[208:211], 0
    v_mfma_f32_16x16x32_bf16 v[148:151], v[48:51], v[212:215], 0
    v_mfma_f32_16x16x32_bf16 v[144:147], v[52:55], v[216:219], v[144:147]
    v_mfma_f32_16x16x32_bf16 v[148:151], v[52:55], v[220:223], v[148:151]
    v_mfma_f32_16x16x32_bf16 v[144:147], v[56:59], v[224:227], v[144:147]
    v_mfma_f32_16x16x32_bf16 v[148:151], v[56:59], v[228:231], v[148:151]
    v_mfma_f32_16x16x32_bf16 v[144:147], v[60:63], v[232:235], v[144:147]
    v_mfma_f32_16x16x32_bf16 v[148:151], v[60:63], v[236:239], v[148:151]
    v_cvt_pk_bf16_f32 v172, v136, v140
    buffer_store_dword v172, v9, s[40:43], s54 offen offset:0 sc1
    v_cvt_pk_bf16_f32 v173, v137, v141
    buffer_store_dword v173, v9, s[40:43], s54 offen offset:256 sc1
    v_cvt_pk_bf16_f32 v174, v138, v142
    buffer_store_dword v174, v9, s[40:43], s54 offen offset:512 sc1
    v_cvt_pk_bf16_f32 v175, v139, v143
    buffer_store_dword v175, v9, s[40:43], s54 offen offset:768 sc1
    s_add_u32 s54, s54, 4096
    s_waitcnt lgkmcnt(4)
    v_mfma_f32_16x16x32_bf16 v[152:155], v[64:67], v[208:211], 0
    v_mfma_f32_16x16x32_bf16 v[156:159], v[64:67], v[212:215], 0
    v_mfma_f32_16x16x32_bf16 v[152:155], v[68:71], v[216:219], v[152:155]
    v_mfma_f32_16x16x32_bf16 v[156:159], v[68:71], v[220:223], v[156:159]
    v_mfma_f32_16x16x32_bf16 v[152:155], v[72:75], v[224:227], v[152:155]
    v_mfma_f32_16x16x32_bf16 v[156:159], v[72:75], v[228:231], v[156:159]
    v_mfma_f32_16x16x32_bf16 v[152:155], v[76:79], v[232:235], v[152:155]
    v_mfma_f32_16x16x32_bf16 v[156:159], v[76:79], v[236:239], v[156:159]
    v_cvt_pk_bf16_f32 v176, v144, v148
    buffer_store_dword v176, v9, s[40:43], s54 offen offset:0 sc1
    v_cvt_pk_bf16_f32 v177, v145, v149
    buffer_store_dword v177, v9, s[40:43], s54 offen offset:256 sc1
    v_cvt_pk_bf16_f32 v178, v146, v150
    buffer_store_dword v178, v9, s[40:43], s54 offen offset:512 sc1
    v_cvt_pk_bf16_f32 v179, v147, v151
    buffer_store_dword v179, v9, s[40:43], s54 offen offset:768 sc1
    s_add_u32 s54, s54, 4096
    s_waitcnt lgkmcnt(0)
    v_mfma_f32_16x16x32_bf16 v[160:163], v[80:83], v[208:211], 0
    v_mfma_f32_16x16x32_bf16 v[164:167], v[80:83], v[212:215], 0
    v_mfma_f32_16x16x32_bf16 v[160:163], v[84:87], v[216:219], v[160:163]
    v_mfma_f32_16x16x32_bf16 v[164:167], v[84:87], v[220:223], v[164:167]
    v_mfma_f32_16x16x32_bf16 v[160:163], v[88:91], v[224:227], v[160:163]
    v_mfma_f32_16x16x32_bf16 v[164:167], v[88:91], v[228:231], v[164:167]
    v_mfma_f32_16x16x32_bf16 v[160:163], v[92:95], v[232:235], v[160:163]
    v_mfma_f32_16x16x32_bf16 v[164:167], v[92:95], v[236:239], v[164:167]
    v_cvt_pk_bf16_f32 v180, v152, v156
    buffer_store_dword v180, v9, s[40:43], s54 offen offset:0 sc1
    v_cvt_pk_bf16_f32 v181, v153, v157
    buffer_store_dword v181, v9, s[40:43], s54 offen offset:256 sc1
    v_cvt_pk_bf16_f32 v182, v154, v158
    buffer_store_dword v182, v9, s[40:43], s54 offen offset:512 sc1
    v_cvt_pk_bf16_f32 v183, v155, v159
    buffer_store_dword v183, v9, s[40:43], s54 offen offset:768 sc1
    s_add_u32 s54, s54, 4096
    v_cvt_pk_bf16_f32 v184, v160, v164
    buffer_store_dword v184, v9, s[40:43], s54 offen offset:0 sc1
    v_cvt_pk_bf16_f32 v185, v161, v165
    buffer_store_dword v185, v9, s[40:43], s54 offen offset:256 sc1
    v_cvt_pk_bf16_f32 v186, v162, v166
    buffer_store_dword v186, v9, s[40:43], s54 offen offset:512 sc1
    v_cvt_pk_bf16_f32 v187, v163, v167
    buffer_store_dword v187, v9, s[40:43], s54 offen offset:768 sc1
    s_add_u32 s54, s54, 4096
    s_or_b32 s4, s2, s3
    s_cbranch_scc1 L_notag
    v_mov_b32 v8, s62
    v_lshlrev_b32 v10, 2, v1
    s_mov_b32 s54, 524288
    buffer_store_dword v8, v10, s[20:23], s54 offen sc1
L_notag:
L_done:
    s_endpgm
L_again:
    s_waitcnt vmcnt(0) lgkmcnt(0)
    s_barrier
    v_lshlrev_b32 v11, 2, v0
    v_mov_b32 v12, 0x00700000
    v_mov_b32 v13, 0
    ds_write_b32 v11, v12 offset:0
    ds_write_b32 v11, v12 offset:2048
    ds_write_b32 v11, v12 offset:4096
    ds_write_b32 v11, v12 offset:6144
    ds_write_b32 v11, v13 offset:8192
    ds_write_b32 v11, v13 offset:10240
    ds_write_b32 v11, v13 offset:12288
    v_add_u32 v3, v3, v4
    v_subrev_u32 v3, 256, v3
    v_max_i32 v3, 0, v3
    v_subrev_u32 v4, 256, v4
    v_max_i32 v4, 0, v4
    v_sub_u32 v3, v3, v4
    v_add_u32 v5, 256, v5
    s_sub_i32 s95, s95, 256
    v_lshl_add_u32 v8, v4, 2, v241
    s_waitcnt lgkmcnt(0)
    s_barrier
L_clip:
    v_add_u32 v10, v4, v3
    v_min_i32 v10, 256, v10
    v_sub_u32 v10, v10, v4
    v_add_u32 v10, v10, v240
L_masks:
    v_cmp_lt_i32 s[64:65], 0, v10
    v_cmp_lt_i32 s[66:67], 2, v10
    v_cmp_lt_i32 s[68:69], 4, v10
    v_cmp_lt_i32 s[70:71], 6, v10
    v_cmp_lt_i32 s[72:73], 8, v10
    v_cmp_lt_i32 s[74:75], 10, v10
    v_cmp_lt_i32 s[76:77], 12, v10
    v_cmp_lt_i32 s[78:79], 14, v10
    s_nop 0
    s_branch L_mapw
L_map2:
    v_add_u32 v8, 56, v8
    v_subrev_u32 v10, 14, v10
    s_branch L_masks
L_r1:
    ds_read_b32 v67, v242 offset:768
    ds_read_b32 v74, v243 offset:768
    ds_read_b32 v75, v243 offset:896
    s_waitcnt lgkmcnt(0)
    v_mad_u32_u24 v67, v67, 12, v244
    buffer_load_dwordx3 v[88:90], v67, s[24:27], 0 offen offset:2304 sc1
    v_lshl_add_u32 v74, v74, 5, v2
    s_add_u32 m0, s52, 4096
    s_nop 0
    buffer_load_dwordx4 v74, s[28:31], s98 offen offset:2048 sc1 lds
    v_lshl_add_u32 v75, v75, 5, v2
    s_add_u32 m0, s52, 4096
    s_nop 0
    buffer_load_dwordx4 v75, s[28:31], s98 offen offset:3072 sc1 lds
    s_branch L_r1b
L_r2:
    v_lshrrev_b32 v135, 21, v90
    v_lshlrev_b32 v135, 2, v135
    v_lshrrev_b32 v11, 26, v90
    v_lshl_or_b32 v11, v11, 4, v245
    s_mov_b64 exec, s[96:97]
    ds_add_rtn_u32 v131, v135, v6 offset:8192
    ds_add_u32 v11, v6 offset:14336
    s_mov_b64 exec, -1
    ds_write_b64 v246, v[88:89] offset:1536
    v_and_or_b32 v90, v90, s55, v247
    v_add_u32 v90, 402653184, v90
    s_branch L_r2b
L_r3:
    ds_read_b32 v135, v135 offset:8192
    s_waitcnt lgkmcnt(0)
    v_bfe_u32 v15, v135, 12, 3
    v_or_b32 v90, v15, v90
    v_and_b32 v67, 0x3ff, v135
    v_lshrrev_b32 v135, 16, v135
    v_add_u32 v135, v135, v131
    ds_read_b32 v67, v67 offset:16384
    s_waitcnt lgkmcnt(0)
    v_lshl_add_u32 v135, v135, 2, v67
    s_mov_b64 exec, s[96:97]
    ds_write_b32 v135, v90
    s_mov_b64 exec, -1
    s_branch L_r3b
L_poll:
    buffer_load_dwordx2 v[206:207], v10, s[20:23], s49 offen sc1
    s_sub_u32 s53, s53, 1
    s_cbranch_scc1 L_done
    s_waitcnt vmcnt(0)
    v_xor_b32 v11, s63, v206
    v_xor_b32 v12, s62, v207
    v_and_or_b32 v11, v11, s55, v12
    v_cmpx_ne_u32 vcc, 0, v11
    s_cbranch_execnz L_poll
    s_branch L_polled
L_rank2:
    ds_read_b32 v96, v248 offset:8192
    ds_read_b32 v97, v248 offset:8320
    ds_read_b32 v98, v248 offset:8448
    ds_read_b32 v99, v248 offset:8576
    ds_read_b32 v100, v248 offset:8704
    s_waitcnt lgkmcnt(0)
L_end:
    s_branch L_ranked
.section .rodata,"a"
.p2align 6
.amdhsa_kernel gather_scatter__tensor_product_equiv_mace__graph_kernel
  .amdhsa_next_free_vgpr 256
  .amdhsa_next_free_sgpr 102
  .amdhsa_accum_offset 256
  .amdhsa_group_segment_fixed_size 0
  .amdhsa_kernarg_size 88
  .amdhsa_user_sgpr_count 2
  .amdhsa_user_sgpr_kernarg_segment_ptr 1
  .amdhsa_system_sgpr_workgroup_id_x 1
  .amdhsa_float_denorm_mode_32 3
.end_amdhsa_kernel
```

```asm
; @launch grid=(256,1,1) block=(512,1,1) lds=158720
.amdgcn_target "amdgcn-amd-amdhsa--gfx950"
.text
.globl gather_scatter__tensor_product_equiv_mace__graph_kernel
.p2align 8
.type gather_scatter__tensor_product_equiv_mace__graph_kernel,@function
gather_scatter__tensor_product_equiv_mace__graph_kernel:
    s_cmp_ge_u32 s2, 256
    s_cbranch_scc1 L_done
    s_load_dwordx4 s[4:7], s[0:1], 8
    s_load_dwordx4 s[8:11], s[0:1], 24
    s_load_dwordx2 s[14:15], s[0:1], 80
    s_load_dwordx2 s[64:65], s[0:1], 0
    s_load_dwordx2 s[66:67], s[0:1], 40
    s_load_dwordx4 s[68:71], s[0:1], 48
    s_load_dwordx2 s[12:13], s[0:1], 64
    v_lshlrev_b32 v10, 3, v0
    s_getpc_b64 s[80:81]
L_pc:
    s_and_b32 s44, s2, 0xf8
    s_lshl_b32 s44, s44, 6
    v_and_b32 v11, 0x180, v10
    v_add_u32 v11, s44, v11
    v_min_u32 v11, L_end-L_pc, v11
    v_mov_b32 v113, s81
    v_add_co_u32 v112, vcc, s80, v11
    s_nop 1
    v_addc_co_u32 v113, vcc, 0, v113, vcc
    global_load_dword v205, v[112:113], off
    v_lshrrev_b32 v8, 6, v0
    v_and_b32 v1, 63, v0
    v_lshlrev_b32 v9, 2, v0
    v_mov_b32 v13, 0
    v_readfirstlane_b32 s3, v8
    ds_write_b32 v9, v13 offset:23552
    ds_write_b32 v9, v13 offset:28672
    s_mul_i32 s54, s2, 5000
    s_mul_i32 s55, s2, 10000
    s_mul_i32 s61, s2, 40000
    v_lshlrev_b32 v2, 4, v1
    v_lshlrev_b32 v15, 4, v0
    v_mov_b32 v6, 1
    s_lshl_b32 s52, s3, 10
    s_add_u32 s52, s52, 101376
    s_movk_i32 s53, 4096
    s_movk_i32 s50, 8192
    s_mov_b32 s34, 5000
    s_mov_b32 s35, 0x20000
    s_mov_b32 s38, 5000
    s_mov_b32 s39, 0x20000
    s_mov_b32 s98, 10000
    s_mov_b32 s99, 0x20000
    s_mov_b32 s30, 40000
    s_mov_b32 s31, 0x20000
    s_waitcnt lgkmcnt(0)
    s_add_u32 s32, s6, s54
    s_addc_u32 s33, s7, 0
    buffer_load_dword v64, v9, s[32:35], 0 offen offset:0 nt
    buffer_load_dword v65, v9, s[32:35], 0 offen offset:2048 nt
    buffer_load_dword v66, v9, s[32:35], s53 offen nt
    s_add_u32 s36, s4, s54
    s_addc_u32 s37, s5, 0
    s_barrier
    buffer_load_dword v68, v9, s[36:39], 0 offen offset:0 nt
    buffer_load_dword v69, v9, s[36:39], 0 offen offset:2048 nt
    buffer_load_dword v70, v9, s[36:39], s53 offen nt
    s_load_dword s62, s[14:15], 524288
    s_add_u32 s96, s8, s55
    s_addc_u32 s97, s9, 0
    s_add_u32 s28, s10, s61
    s_addc_u32 s29, s11, 0
    buffer_load_dwordx2 v[72:73], v10, s[96:99], 0 offen nt
    buffer_load_dwordx2 v[74:75], v10, s[96:99], s53 offen nt
    buffer_load_dwordx2 v[76:77], v10, s[96:99], s50 offen nt
    s_add_u32 m0, s52, 0
    s_mov_b32 s54, 0
    buffer_load_dwordx4 v15, s[28:31], s54 offen nt lds
    s_add_u32 m0, s52, 8192
    s_mov_b32 s54, 8192
    buffer_load_dwordx4 v15, s[28:31], s54 offen nt lds
    s_add_u32 m0, s52, 16384
    s_mov_b32 s54, 16384
    buffer_load_dwordx4 v15, s[28:31], s54 offen nt lds
    s_mov_b32 s72, 109951168
    s_movk_i32 s73, 625
    s_movk_i32 s74, 838
    s_movk_i32 s54, 226
    v_cmp_gt_u32 s[84:85], s54, v0
    s_mov_b32 s20, s14
    s_mov_b32 s21, s15
    s_mov_b32 s22, 598016
    s_mov_b32 s23, 0x20000
    v_lshlrev_b32 v11, 2, v0
    v_mov_b32 v12, 0x00700000
    v_mov_b32 v13, 0
    ds_write_b32 v11, v12 offset:0
    ds_write_b32 v11, v12 offset:2048
    ds_write_b32 v11, v12 offset:4096
    ds_write_b32 v11, v12 offset:6144
    ds_write_b32 v11, v13 offset:8192
    ds_write_b32 v11, v13 offset:10240
    ds_write_b32 v11, v13 offset:12288
    ds_write_b32 v11, v13 offset:14336
    s_waitcnt vmcnt(9)
    v_mul_hi_u32 v80, v64, s72
    v_mul_hi_u32 v81, v65, s72
    v_mul_hi_u32 v82, v66, s72
    v_lshlrev_b32 v84, 2, v80
    ds_add_rtn_u32 v88, v84, v6 offset:23552
    v_lshlrev_b32 v85, 2, v81
    ds_add_rtn_u32 v89, v85, v6 offset:23552
    v_lshlrev_b32 v86, 2, v82
    s_mov_b64 exec, s[84:85]
    ds_add_rtn_u32 v90, v86, v6 offset:23552
    s_mov_b64 exec, -1
    s_waitcnt lgkmcnt(0)
    s_barrier
    ds_read_b128 v[100:103], v2 offset:23552
    s_mul_i32 s62, s62, 0x9e3779b1
    s_add_u32 s62, s62, 0x7f4a7c15
    s_mul_i32 s63, s62, 0x85ebca6b
    s_and_b32 s63, s63, 0xffc00000
    s_add_u32 m0, s52, 24576
    s_mov_b32 s54, 24576
    buffer_load_dwordx4 v15, s[28:31], s54 offen nt lds
    s_add_u32 m0, s52, 32768
    s_mov_b32 s54, 32768
    buffer_load_dwordx4 v15, s[28:31], s54 offen nt lds
    v_mad_u32_u24 v92, v80, s73, 15
    v_lshrrev_b32 v92, 4, v92
    v_sub_u32 v92, v64, v92
    v_lshrrev_b32 v80, 3, v80
    v_and_b32 v80, 28, v80
    v_mad_u32_u24 v93, v81, s73, 15
    v_lshrrev_b32 v93, 4, v93
    v_sub_u32 v93, v65, v93
    v_lshrrev_b32 v81, 3, v81
    v_and_b32 v81, 28, v81
    v_mad_u32_u24 v94, v82, s73, 15
    v_lshrrev_b32 v94, 4, v94
    v_sub_u32 v94, v66, v94
    v_lshrrev_b32 v82, 3, v82
    v_and_b32 v82, 28, v82
    s_waitcnt lgkmcnt(0)
    v_add_u32 v11, v100, v101
    v_add3_u32 v11, v11, v102, v103
    v_mov_b32 v12, v11
    s_nop 1
    v_add_u32_dpp v12, v12, v12 row_shr:1 row_mask:0xf bank_mask:0xf
    s_nop 1
    v_add_u32_dpp v12, v12, v12 row_shr:2 row_mask:0xf bank_mask:0xf
    s_nop 1
    v_add_u32_dpp v12, v12, v12 row_shr:4 row_mask:0xf bank_mask:0xf
    s_nop 1
    v_add_u32_dpp v12, v12, v12 row_shr:8 row_mask:0xf bank_mask:0xf
    s_nop 1
    v_add_u32_dpp v12, v12, v12 row_bcast:15 row_mask:0xa bank_mask:0xf
    s_nop 1
    v_add_u32_dpp v12, v12, v12 row_bcast:31 row_mask:0xc bank_mask:0xf
    v_sub_u32 v104, v12, v11
    v_add_u32 v105, v104, v100
    v_add_u32 v106, v105, v101
    v_add_u32 v107, v106, v102
    ds_write_b128 v2, v[104:107] offset:24576
    ds_read_b32 v108, v84 offset:24576
    ds_read_b32 v109, v85 offset:24576
    ds_read_b32 v110, v86 offset:24576
    s_waitcnt vmcnt(8)
    v_mul_u32_u24 v96, s74, v68
    v_lshrrev_b32 v96, 18, v96
    v_sub_u32 v96, v96, v80
    v_and_b32 v96, 31, v96
    v_lshl_or_b32 v96, v92, 5, v96
    v_lshlrev_b32 v96, 21, v96
    v_lshl_or_b32 v96, v68, 7, v96
    v_mul_u32_u24 v97, s74, v69
    v_lshrrev_b32 v97, 18, v97
    v_sub_u32 v97, v97, v81
    v_and_b32 v97, 31, v97
    v_lshl_or_b32 v97, v93, 5, v97
    v_lshlrev_b32 v97, 21, v97
    v_lshl_or_b32 v97, v69, 7, v97
    v_mul_u32_u24 v98, s74, v70
    v_lshrrev_b32 v98, 18, v98
    v_sub_u32 v98, v98, v82
    v_and_b32 v98, 31, v98
    v_lshl_or_b32 v98, v94, 5, v98
    v_lshlrev_b32 v98, 21, v98
    v_lshl_or_b32 v98, v70, 7, v98
    v_lshlrev_b32 v92, 5, v0
    v_add_u32 v93, 16384, v92
    v_add_u32 v94, 32768, v92
    s_mov_b32 s55, 30720
    s_waitcnt vmcnt(5) lgkmcnt(0)
    v_add_u32 v108, v108, v88
    v_lshlrev_b32 v84, 2, v108
    v_mad_u32_u24 v108, v108, 12, s55
    ds_write_b32 v84, v92 offset:25600
    ds_write2_b32 v108, v72, v73 offset0:0 offset1:1
    ds_write_b32 v108, v96 offset:8
    v_add_u32 v109, v109, v89
    v_lshlrev_b32 v85, 2, v109
    v_mad_u32_u24 v109, v109, 12, s55
    ds_write_b32 v85, v93 offset:25600
    ds_write2_b32 v109, v74, v75 offset0:0 offset1:1
    ds_write_b32 v109, v97 offset:8
    v_add_u32 v110, v110, v90
    v_lshlrev_b32 v86, 2, v110
    v_mad_u32_u24 v110, v110, 12, s55
    s_mov_b64 exec, s[84:85]
    ds_write_b32 v86, v94 offset:25600
    ds_write2_b32 v110, v76, v77 offset0:0 offset1:1
    ds_write_b32 v110, v98 offset:8
    s_mov_b64 exec, -1
    s_lshl_b32 s54, s3, 7
    v_lshl_add_u32 v11, v1, 3, s54
    ds_read_b64 v[100:101], v11 offset:23552
    ds_read_b64 v[104:105], v11 offset:24576
    s_mul_i32 s54, s2, 15360
    s_add_u32 s54, s54, 1048576
    s_add_u32 s32, s14, s54
    s_addc_u32 s33, s15, 0
    s_mov_b32 s34, 15360
    s_mov_b32 s35, 0x20000
    s_mul_i32 s54, s2, 40960
    s_add_u32 s54, s54, 5242880
    s_add_u32 s36, s14, s54
    s_addc_u32 s37, s15, 0
    s_mov_b32 s38, 40000
    s_mov_b32 s39, 0x20000
    v_lshrrev_b32 v11, 1, v0
    v_lshlrev_b32 v11, 2, v11
    v_and_b32 v12, 1, v0
    v_lshlrev_b32 v12, 4, v12
    v_add_u32 v12, 101376, v12
    v_add_u32 v14, 30720, v15
    s_waitcnt lgkmcnt(0)
    s_barrier
    ds_read_b128 v[128:131], v14
    ds_read_b128 v[132:135], v14 offset:8192
    ds_read_b32 v156, v11 offset:25600
    ds_read_b32 v157, v11 offset:26624
    ds_read_b32 v158, v11 offset:27648
    ds_read_b32 v159, v11 offset:28672
    ds_read_b32 v160, v11 offset:29696
    s_cmp_lt_u32 s3, 4
    s_cselect_b32 s16, s68, s66
    s_cselect_b32 s17, s69, s67
    s_movk_i32 s54, 128
    s_cselect_b32 s18, s53, s54
    s_mov_b32 s19, 0x20000
    s_min_u32 s54, s3, 5
    s_lshl_b32 s54, s54, 10
    s_add_u32 m0, s54, 17408
    s_and_b32 s54, s54, 0xc00
    buffer_load_dwordx4 v2, s[16:19], s54 offen lds
    s_mov_b32 s40, s70
    s_mov_b32 s41, s71
    s_mov_b32 s42, 32768
    s_mov_b32 s43, 0x20000
    s_lshl_b32 s55, s3, 12
    s_add_u32 m0, s55, 46080
    s_nop 0
    buffer_load_dwordx4 v2, s[40:43], s55 offen offset:0 lds
    buffer_load_dwordx4 v2, s[40:43], s55 offen offset:1024 lds
    buffer_load_dwordx4 v2, s[40:43], s55 offen offset:2048 lds
    buffer_load_dwordx4 v2, s[40:43], s55 offen offset:3072 lds
    s_waitcnt lgkmcnt(0)
    v_add_u32 v156, v12, v156
    v_add_u32 v157, v12, v157
    v_add_u32 v158, v12, v158
    v_add_u32 v159, v12, v159
    v_add_u32 v160, v12, v160
    v_lshl_or_b32 v112, v100, 11, v104
    v_or_b32 v112, s63, v112
    v_mov_b32 v113, s62
    v_lshl_or_b32 v114, v101, 11, v105
    v_or_b32 v114, s63, v114
    v_mov_b32 v115, s62
    s_waitcnt vmcnt(0)
    s_barrier
    ds_read_b128 v[136:139], v156
    ds_read_b128 v[140:143], v157
    ds_read_b128 v[144:147], v158
    ds_read_b128 v[148:151], v159
    ds_read_b128 v[152:155], v160
    buffer_store_dwordx4 v[128:131], v15, s[32:35], 0 offen sc1
    buffer_store_dwordx4 v[132:135], v15, s[32:35], s50 offen sc1
    s_mov_b32 s54, 0
    s_waitcnt lgkmcnt(4)
    buffer_store_dwordx4 v[136:139], v15, s[36:39], s54 offen sc1
    s_mov_b32 s54, 8192
    s_waitcnt lgkmcnt(3)
    buffer_store_dwordx4 v[140:143], v15, s[36:39], s54 offen sc1
    s_mov_b32 s54, 16384
    s_waitcnt lgkmcnt(2)
    buffer_store_dwordx4 v[144:147], v15, s[36:39], s54 offen sc1
    s_mov_b32 s54, 24576
    s_waitcnt lgkmcnt(1)
    buffer_store_dwordx4 v[148:151], v15, s[36:39], s54 offen sc1
    s_mov_b32 s54, 32768
    s_waitcnt lgkmcnt(0)
    buffer_store_dwordx4 v[152:155], v15, s[36:39], s54 offen sc1
    s_and_b32 s44, s2, 7
    s_lshl_b32 s44, s44, 5
    s_lshr_b32 s54, s2, 3
    s_add_u32 s44, s44, s54
    s_mul_i32 s45, s44, 625
    s_add_u32 s46, s45, 640
    s_add_u32 s45, s45, 15
    s_lshr_b32 s45, s45, 4
    s_lshr_b32 s46, s46, 4
    s_sub_u32 s46, s46, s45
    s_mov_b32 s86, 0x0f0f0f0f
    s_mov_b32 s87, 0x0f0f0f0f
    s_mov_b32 s88, 0xf0f0f0f0
    s_mov_b32 s89, 0xf0f0f0f0
    v_mov_b32 v164, 0
    v_mov_b32 v165, 0
    v_mov_b32 v166, 0
    v_mov_b32 v167, 0
    v_mov_b32 v168, 0
    v_mov_b32 v169, 0
    v_mov_b32 v170, 0
    v_mov_b32 v171, 0
    v_and_b32 v11, 4, v1
    v_lshlrev_b32 v11, 2, v11
    v_mov_b32 v12, 0xffff
    v_lshlrev_b32 v12, v11, v12
    v_bfe_i32 v11, v1, 3, 1
    v_and_b32 v191, v11, v12
    v_xor_b32 v190, v191, v12
    v_lshrrev_b32 v200, 5, v1
    v_lshlrev_b32 v200, 4, v200
    v_add_u32 v200, 101376, v200
    v_and_b32 v201, 15, v1
    v_lshlrev_b32 v201, 2, v201
    v_bfe_u32 v11, v1, 3, 2
    v_and_b32 v12, 3, v1
    v_lshl_add_u32 v11, v11, 2, v12
    v_lshlrev_b32 v202, 2, v11
    v_bfe_i32 v240, v0, 0, 1
    s_lshl_b32 s54, s3, 10
    v_and_b32 v241, 4, v240
    v_add_u32 v241, s54, v241
    v_lshl_add_u32 v242, v1, 2, s54
    v_lshrrev_b32 v243, 1, v1
    v_lshl_add_u32 v243, v243, 2, s54
    v_mul_u32_u24 v244, 12, v1
    v_and_b32 v245, 12, v242
    v_and_b32 v250, 124, v242
    s_mul_i32 s54, s3, 224
    v_add_u32 v247, s54, v1
    v_lshlrev_b32 v246, 3, v247
    v_add_u32 v246, 87040, v246
    v_lshlrev_b32 v247, 21, v247
    s_mul_i32 s54, s3, 640
    v_add_u32 v248, s54, v250
    v_sub_u32 v249, 63, v1
    s_lshl_b32 s54, s3, 5
    v_lshl_add_u32 v251, v1, 2, s54
    v_lshrrev_b32 v252, 3, v1
    v_mul_u32_u24 v252, 64, v252
    v_add_u32 v252, 78848, v252
    s_cmp_eq_u32 s46, 40
    v_mov_b32 v203, 0
    s_mov_b32 s54, 685900808
    s_cselect_b32 s54, 568459824, s54
    s_mov_b32 exec_lo, 31
    s_mov_b32 exec_hi, 0
    v_mov_b32 v203, s54
    s_mov_b32 s54, 182814793
    s_cselect_b32 s54, 23232528, s54
    s_mov_b32 exec_lo, 992
    s_mov_b32 exec_hi, 0
    v_mov_b32 v203, s54
    s_mov_b32 s54, 984091248
    s_cselect_b32 s54, 719688297, s54
    s_mov_b32 exec_lo, 31744
    s_mov_b32 exec_hi, 0
    v_mov_b32 v203, s54
    s_mov_b32 s54, 424091761
    s_cselect_b32 s54, 984423522, s54
    s_mov_b32 exec_lo, 1015808
    s_mov_b32 exec_hi, 0
    v_mov_b32 v203, s54
    s_mov_b32 s54, 586001611
    s_cselect_b32 s54, 172635826, s54
    s_mov_b32 exec_lo, 32505856
    s_mov_b32 exec_hi, 0
    v_mov_b32 v203, s54
    s_mov_b32 s54, 64039106
    s_cselect_b32 s54, 454017211, s54
    s_mov_b32 exec_lo, 1040187392
    s_mov_b32 exec_hi, 0
    v_mov_b32 v203, s54
    s_mov_b32 s54, 330320603
    s_cselect_b32 s54, 743654643, s54
    s_mov_b32 exec_lo, 3221225472
    s_mov_b32 exec_hi, 7
    v_mov_b32 v203, s54
    s_mov_b32 s54, 217139484
    s_cselect_b32 s54, 607143691, s54
    s_mov_b32 exec_lo, 0
    s_mov_b32 exec_hi, 248
    v_mov_b32 v203, s54
    s_mov_b64 exec, -1
    v_mul_u32_u24 v11, 52, v1
    v_lshrrev_b32 v11, 8, v11
    v_mad_i32_i24 v11, v11, -5, v1
    v_mul_u32_u24 v11, 6, v11
    v_lshrrev_b32 v203, v11, v203
    v_and_b32 v11, 7, v203
    v_bfe_u32 v203, v203, 3, 3
    v_lshlrev_b32 v11, 12, v11
    v_lshl_or_b32 v203, v203, 7, v11
    s_add_u32 s24, s14, 1048576
    s_addc_u32 s25, s15, 0
    s_mov_b32 s26, 3932160
    s_mov_b32 s27, 0x20000
    v_mov_b32 v16, 0
    v_mov_b32 v17, 0
    v_mov_b32 v18, 0
    v_mov_b32 v19, 0
    v_mov_b32 v20, 0
    v_mov_b32 v21, 0
    v_mov_b32 v22, 0
    v_mov_b32 v23, 0
    v_mov_b32 v24, 0
    v_mov_b32 v25, 0
    v_mov_b32 v26, 0
    v_mov_b32 v27, 0
    v_mov_b32 v28, 0
    v_mov_b32 v29, 0
    v_mov_b32 v30, 0
    v_mov_b32 v31, 0
    v_mov_b32 v32, 0
    v_mov_b32 v33, 0
    v_mov_b32 v34, 0
    v_mov_b32 v35, 0
    v_mov_b32 v36, 0
    v_mov_b32 v37, 0
    v_mov_b32 v38, 0
    v_mov_b32 v39, 0
    v_mov_b32 v40, 0
    v_mov_b32 v41, 0
    v_mov_b32 v42, 0
    v_mov_b32 v43, 0
    v_mov_b32 v44, 0
    v_mov_b32 v45, 0
    v_mov_b32 v46, 0
    v_mov_b32 v47, 0
    v_mov_b32 v48, 0
    v_mov_b32 v49, 0
    v_mov_b32 v50, 0
    v_mov_b32 v51, 0
    v_mov_b32 v52, 0
    v_mov_b32 v53, 0
    v_mov_b32 v54, 0
    v_mov_b32 v55, 0
    v_mov_b32 v56, 0
    v_mov_b32 v57, 0
    v_mov_b32 v58, 0
    v_mov_b32 v59, 0
    v_mov_b32 v60, 0
    v_mov_b32 v61, 0
    v_mov_b32 v62, 0
    v_mov_b32 v63, 0
    s_lshl_b32 s54, s2, 3
    s_add_u32 s54, s54, s3
    s_lshl_b32 s54, s54, 8
    s_mov_b32 s16, s64
    s_mov_b32 s17, s65
    s_mov_b32 s18, 10240000
    s_mov_b32 s19, 0x20000
    s_add_u32 s28, s14, 5242880
    s_addc_u32 s29, s15, 0
    s_mov_b32 s30, 10485760
    s_mov_b32 s31, 0x20000
    s_and_b32 s51, s2, 7
    s_mul_i32 s51, s51, 1282048
    s_and_b32 s55, s2, 0xf8
    s_add_u32 s55, s55, s3
    s_mul_i32 s55, s55, 3328
    s_add_u32 s51, s51, s55
    v_min_u32 v14, 25, v1
    v_lshlrev_b32 v14, 7, v14
    s_waitcnt vmcnt(0)
    s_barrier
    s_mov_b64 exec, 0xffff
    buffer_store_dwordx4 v[112:115], v2, s[20:23], s54 offen sc1
    s_mov_b64 exec, -1
    buffer_load_dword v7, v14, s[16:19], s51 offen
    s_lshl_b32 s54, s45, 10
    s_add_u32 s40, s12, s54
    s_addc_u32 s41, s13, 0
    s_lshl_b32 s42, s46, 10
    s_mov_b32 s43, 0x20000
    v_lshrrev_b32 v8, 5, v1
    v_lshlrev_b32 v8, 11, v8
    v_and_b32 v9, 15, v1
    v_lshl_add_u32 v8, v9, 4, v8
    ds_read_b128 v[64:67], v8 offset:17408
    ds_read_b128 v[68:71], v8 offset:17664
    ds_read_b128 v[72:75], v8 offset:17920
    ds_read_b128 v[76:79], v8 offset:18176
    ds_read_b128 v[80:83], v8 offset:18432
    ds_read_b128 v[84:87], v8 offset:18688
    ds_read_b128 v[88:91], v8 offset:18944
    ds_read_b128 v[92:95], v8 offset:19200
    v_lshrrev_b32 v8, 4, v1
    v_lshlrev_b32 v8, 5, v8
    v_and_b32 v9, 3, v1
    v_lshl_add_u32 v8, v9, 1, v8
    ds_read_u16 v96, v8 offset:21504
    ds_read_u16 v97, v8 offset:21512
    ds_read_u16 v98, v8 offset:21520
    ds_read_u16 v99, v8 offset:21528
    v_bfe_i32 v10, v1, 4, 1
    v_and_b32 v10, 0x02020202, v10
    v_add_u32 v10, 0x05040100, v10
    s_waitcnt lgkmcnt(0)
    v_perm_b32 v172, v68, v64, v10
    v_perm_b32 v173, v76, v72, v10
    v_perm_b32 v174, v84, v80, v10
    v_perm_b32 v175, v92, v88, v10
    v_perm_b32 v176, v69, v65, v10
    v_perm_b32 v177, v77, v73, v10
    v_perm_b32 v178, v85, v81, v10
    v_perm_b32 v179, v93, v89, v10
    v_perm_b32 v180, v70, v66, v10
    v_perm_b32 v181, v78, v74, v10
    v_perm_b32 v182, v86, v82, v10
    v_perm_b32 v183, v94, v90, v10
    v_perm_b32 v184, v71, v67, v10
    v_perm_b32 v185, v79, v75, v10
    v_perm_b32 v186, v87, v83, v10
    v_perm_b32 v187, v95, v91, v10
    v_lshl_or_b32 v188, v97, 16, v96
    v_lshl_or_b32 v189, v99, 16, v98
    v_and_b32 v9, 7, v1
    v_lshrrev_b32 v8, 4, v1
    v_lshlrev_b32 v8, 13, v8
    v_lshl_add_u32 v8, v9, 4, v8
    v_and_b32 v9, 8, v1
    s_and_b32 s72, s3, 3
    s_lshl_b32 s72, s72, 8
    s_lshr_b32 s73, s3, 2
    s_lshl_b32 s73, s73, 7
    s_add_u32 s72, s72, s73
    s_add_u32 s72, s72, 46080
    v_add3_u32 v8, v8, v9, s72
    ds_read2st64_b64 v[128:131], v8 offset0:0 offset1:2
    ds_read2st64_b64 v[132:135], v8 offset0:4 offset1:6
    ds_read2st64_b64 v[136:139], v8 offset0:8 offset1:10
    ds_read2st64_b64 v[140:143], v8 offset0:12 offset1:14
    s_mov_b32 s72, 0x05040100
    s_mov_b32 s73, 0x07060302
    s_waitcnt lgkmcnt(3)
    v_perm_b32 v144, v130, v128, s72
    v_perm_b32 v148, v130, v128, s73
    v_perm_b32 v152, v131, v129, s72
    v_perm_b32 v156, v131, v129, s73
    s_waitcnt lgkmcnt(2)
    v_perm_b32 v145, v134, v132, s72
    v_perm_b32 v149, v134, v132, s73
    v_perm_b32 v153, v135, v133, s72
    v_perm_b32 v157, v135, v133, s73
    s_waitcnt lgkmcnt(1)
    v_perm_b32 v146, v138, v136, s72
    v_perm_b32 v150, v138, v136, s73
    v_perm_b32 v154, v139, v137, s72
    v_perm_b32 v158, v139, v137, s73
    s_waitcnt lgkmcnt(0)
    v_perm_b32 v147, v142, v140, s72
    v_perm_b32 v151, v142, v140, s73
    v_perm_b32 v155, v143, v141, s72
    v_perm_b32 v159, v143, v141, s73
    s_lshl_b32 s54, s3, 12
    v_add_u32 v8, s54, v2
    v_lshrrev_b32 v9, 1, v0
    v_lshlrev_b32 v10, 11, v9
    s_lshl_b32 s49, s44, 3
    v_mul_u32_u24 v5, 1280, v9
    s_mov_b32 s48, 0
    s_mov_b32 s53, 200000
    s_mov_b32 s55, 0xffc00000
    s_mul_i32 s52, s3, 7168
    s_add_u32 s52, s52, 101376
    s_movk_i32 s98, 4096
    s_waitcnt vmcnt(0)
    s_barrier
    buffer_load_dwordx2 v[206:207], v10, s[20:23], s49 offen sc1
    ds_write_b128 v8, v[144:147] offset:46080
    ds_write_b128 v8, v[148:151] offset:47104
    ds_write_b128 v8, v[152:155] offset:48128
    ds_write_b128 v8, v[156:159] offset:49152
    s_waitcnt vmcnt(0)
    v_xor_b32 v11, s63, v206
    v_xor_b32 v12, s62, v207
    v_and_or_b32 v11, v11, s55, v12
    v_cmpx_ne_u32 vcc, 0, v11
    s_cbranch_execnz L_poll
L_polled:
    s_mov_b64 exec, -1
    v_bfe_u32 v3, v206, 11, 11
    v_and_b32 v4, v3, v240
    v_add_u32 v10, v3, v240
    v_and_b32 v11, 0x7ff, v206
    v_add_u32_dpp v4, v4, v4 row_shr:1 row_mask:0xf bank_mask:0xf
    v_cmp_lt_i32 s[64:65], 0, v10
    v_cmp_lt_i32 s[66:67], 2, v10
    v_add_u32_dpp v4, v4, v4 row_shr:2 row_mask:0xf bank_mask:0xf
    v_cmp_lt_i32 s[68:69], 4, v10
    v_cmp_lt_i32 s[70:71], 6, v10
    v_add_u32_dpp v4, v4, v4 row_shr:4 row_mask:0xf bank_mask:0xf
    v_cmp_lt_i32 s[72:73], 8, v10
    v_cmp_lt_i32 s[74:75], 10, v10
    v_add_u32_dpp v4, v4, v4 row_shr:8 row_mask:0xf bank_mask:0xf
    v_cmp_lt_i32 s[76:77], 12, v10
    v_cmp_lt_i32 s[78:79], 14, v10
    v_add_u32_dpp v4, v4, v4 row_bcast:15 row_mask:0xa bank_mask:0xf
    v_add_u32 v5, v5, v11
    s_nop 0
    v_add_u32_dpp v4, v4, v4 row_bcast:31 row_mask:0xc bank_mask:0xf
    s_nop 0
    v_readlane_b32 s95, v4, 63
    v_mov_b32_dpp v4, v4 quad_perm:[0,0,2,2] row_mask:0xf bank_mask:0xf
    v_sub_u32 v5, v5, v4
    v_lshl_add_u32 v8, v4, 2, v241
    s_cmp_gt_u32 s95, 224
    s_cbranch_scc1 L_clip
L_mapw:
    s_mov_b64 exec, s[64:65]
    ds_write_b32 v8, v5 offset:0
    s_mov_b64 exec, s[66:67]
    ds_write_b32 v8, v5 offset:8
    s_mov_b64 exec, s[68:69]
    ds_write_b32 v8, v5 offset:16
    s_mov_b64 exec, s[70:71]
    ds_write_b32 v8, v5 offset:24
    s_mov_b64 exec, s[72:73]
    ds_write_b32 v8, v5 offset:32
    s_mov_b64 exec, s[74:75]
    ds_write_b32 v8, v5 offset:40
    s_mov_b64 exec, s[76:77]
    ds_write_b32 v8, v5 offset:48
    s_mov_b64 exec, -1
    s_cmp_lg_u64 s[78:79], 0
    s_cbranch_scc1 L_map2
    ds_read_b32 v64, v242 offset:0
    ds_read_b32 v65, v242 offset:256
    ds_read_b32 v66, v242 offset:512
    ds_read_b32 v68, v243 offset:0
    ds_read_b32 v69, v243 offset:128
    ds_read_b32 v70, v243 offset:256
    ds_read_b32 v71, v243 offset:384
    ds_read_b32 v72, v243 offset:512
    ds_read_b32 v73, v243 offset:640
    s_cmp_gt_i32 s95, 192
    s_cbranch_scc1 L_r1
L_r1b:
    s_waitcnt lgkmcnt(6)
    v_mad_u32_u24 v64, v64, 12, v244
    buffer_load_dwordx3 v[76:78], v64, s[24:27], 0 offen offset:0 sc1
    v_mad_u32_u24 v65, v65, 12, v244
    buffer_load_dwordx3 v[80:82], v65, s[24:27], 0 offen offset:768 sc1
    v_mad_u32_u24 v66, v66, 12, v244
    buffer_load_dwordx3 v[84:86], v66, s[24:27], 0 offen offset:1536 sc1
    v_mov_b32 v11, s95
    s_mov_b64 exec, 1
    ds_max_i32 v13, v11 offset:15360
    s_mov_b64 exec, -1
    s_waitcnt lgkmcnt(1)
    v_lshl_add_u32 v68, v68, 5, v2
    v_lshl_add_u32 v69, v69, 5, v2
    v_lshl_add_u32 v70, v70, 5, v2
    v_lshl_add_u32 v71, v71, 5, v2
    v_lshl_add_u32 v72, v72, 5, v2
    v_lshl_add_u32 v73, v73, 5, v2
    s_barrier
    s_add_u32 m0, s52, 0
    s_nop 0
    buffer_load_dwordx4 v68, s[28:31], 0 offen offset:0 sc1 lds
    v_add_u32 v11, 0, v1
    v_cmp_gt_i32 s[80:81], s95, v11
    v_add_u32 v11, 64, v1
    v_cmp_gt_i32 s[82:83], s95, v11
    v_add_u32 v11, 128, v1
    v_cmp_gt_i32 s[84:85], s95, v11
    v_add_u32 v11, 192, v1
    v_cmp_gt_i32 s[96:97], s95, v11
    s_mov_b32 s55, 0x1fff80
    s_mul_i32 s61, s3, 5
    s_mov_b32 s97, 0
    s_waitcnt vmcnt(3)
    v_lshrrev_b32 v132, 21, v78
    v_lshlrev_b32 v132, 2, v132
    v_lshrrev_b32 v11, 26, v78
    v_lshl_or_b32 v11, v11, 4, v245
    s_mov_b64 exec, s[80:81]
    ds_add_rtn_u32 v128, v132, v6 offset:8192
    ds_add_u32 v11, v6 offset:14336
    s_mov_b64 exec, -1
    s_waitcnt vmcnt(2)
    v_lshrrev_b32 v133, 21, v82
    v_lshlrev_b32 v133, 2, v133
    v_lshrrev_b32 v11, 26, v82
    v_lshl_or_b32 v11, v11, 4, v245
    s_mov_b64 exec, s[82:83]
    ds_add_rtn_u32 v129, v133, v6 offset:8192
    ds_add_u32 v11, v6 offset:14336
    s_mov_b64 exec, -1
    s_waitcnt vmcnt(1)
    v_lshrrev_b32 v134, 21, v86
    v_lshlrev_b32 v134, 2, v134
    v_lshrrev_b32 v11, 26, v86
    v_lshl_or_b32 v11, v11, 4, v245
    s_mov_b64 exec, s[84:85]
    ds_add_rtn_u32 v130, v134, v6 offset:8192
    ds_add_u32 v11, v6 offset:14336
    s_mov_b64 exec, -1
    s_cmp_gt_i32 s95, 192
    s_cbranch_scc1 L_r2
L_r2b:
    ds_write_b64 v246, v[76:77] offset:0
    v_and_or_b32 v78, v78, s55, v247
    ds_write_b64 v246, v[80:81] offset:512
    v_and_or_b32 v82, v82, s55, v247
    v_add_u32 v82, 134217728, v82
    ds_write_b64 v246, v[84:85] offset:1024
    v_and_or_b32 v86, v86, s55, v247
    v_add_u32 v86, 268435456, v86
    s_add_u32 m0, s52, 0
    s_nop 0
    buffer_load_dwordx4 v69, s[28:31], 0 offen offset:1024 sc1 lds
    s_add_u32 m0, s52, 0
    s_nop 0
    buffer_load_dwordx4 v70, s[28:31], 0 offen offset:2048 sc1 lds
    s_waitcnt lgkmcnt(3)
    s_barrier
    s_cmp_lg_u32 s48, 0
    s_cbranch_scc1 L_rank2
    ds_read_b128 v[104:107], v2 offset:14336
    ds_read_b32 v96, v248 offset:8192
    ds_read_b32 v97, v248 offset:8320
    ds_read_b32 v98, v248 offset:8448
    ds_read_b32 v99, v248 offset:8576
    ds_read_b32 v100, v248 offset:8704
    ds_read_b32 v14, v13 offset:15360
    s_add_u32 s65, s61, 1
    s_add_u32 s66, s61, 2
    s_add_u32 s67, s61, 3
    s_add_u32 s68, s61, 4
    s_waitcnt lgkmcnt(6)
    v_add_u32 v9, v104, v105
    v_add3_u32 v9, v9, v106, v107
    v_lshl_or_b32 v9, v9, 6, v249
    s_nop 0
    v_readlane_b32 s64, v9, s61
    v_readlane_b32 s65, v9, s65
    v_readlane_b32 s66, v9, s66
    v_readlane_b32 s67, v9, s67
    v_readlane_b32 s68, v9, s68
    v_cmp_lt_u32 s[70:71], s64, v9
    v_cmp_lt_u32 s[72:73], s65, v9
    v_cmp_lt_u32 s[74:75], s66, v9
    v_cmp_lt_u32 s[76:77], s67, v9
    v_cmp_lt_u32 s[78:79], s68, v9
    s_bcnt1_i32_b64 s64, s[70:71]
    s_bcnt1_i32_b64 s65, s[72:73]
    s_bcnt1_i32_b64 s66, s[74:75]
    s_bcnt1_i32_b64 s67, s[76:77]
    s_bcnt1_i32_b64 s68, s[78:79]
    s_waitcnt lgkmcnt(0)
    v_readlane_b32 s90, v203, s64
    v_readlane_b32 s91, v203, s65
    v_readlane_b32 s92, v203, s66
    v_readlane_b32 s93, v203, s67
    v_readlane_b32 s94, v203, s68
    v_readfirstlane_b32 s47, v14
L_ranked:
    s_mov_b32 exec_hi, 0
    s_and_b32 s54, s90, 0x380
    v_add_u32 v104, s54, v250
    ds_add_rtn_u32 v96, v104, v96 offset:13312
    s_and_b32 s54, s91, 0x380
    v_add_u32 v105, s54, v250
    ds_add_rtn_u32 v97, v105, v97 offset:13312
    s_and_b32 s54, s92, 0x380
    v_add_u32 v106, s54, v250
    ds_add_rtn_u32 v98, v106, v98 offset:13312
    s_and_b32 s54, s93, 0x380
    v_add_u32 v107, s54, v250
    ds_add_rtn_u32 v99, v107, v99 offset:13312
    s_and_b32 s54, s94, 0x380
    v_add_u32 v108, s54, v250
    ds_add_rtn_u32 v100, v108, v100 offset:13312
    v_or_b32 v104, s90, v104
    v_or_b32 v105, s91, v105
    v_or_b32 v106, s92, v106
    v_or_b32 v107, s93, v107
    v_or_b32 v108, s94, v108
    v_writelane_b32 v11, s90, 0
    v_writelane_b32 v11, s91, 1
    v_writelane_b32 v11, s92, 2
    v_writelane_b32 v11, s93, 3
    v_writelane_b32 v11, s94, 4
    s_waitcnt lgkmcnt(4)
    v_lshl_or_b32 v96, v96, 16, v104
    ds_write_b32 v248, v96 offset:8192
    s_waitcnt lgkmcnt(4)
    v_lshl_or_b32 v97, v97, 16, v105
    ds_write_b32 v248, v97 offset:8320
    s_waitcnt lgkmcnt(4)
    v_lshl_or_b32 v98, v98, 16, v106
    ds_write_b32 v248, v98 offset:8448
    s_waitcnt lgkmcnt(4)
    v_lshl_or_b32 v99, v99, 16, v107
    ds_write_b32 v248, v99 offset:8576
    s_waitcnt lgkmcnt(4)
    v_lshl_or_b32 v100, v100, 16, v108
    ds_write_b32 v248, v100 offset:8704
    v_add_lshl_u32 v12, v1, s61, 7
    v_lshrrev_b32 v9, 10, v11
    v_bfe_u32 v11, v11, 2, 8
    v_or_b32 v11, v11, v9
    s_mov_b32 exec_lo, 31
    ds_write_b32 v11, v12 offset:15616
    s_mov_b64 exec, -1
    s_add_u32 m0, s52, 0
    s_nop 0
    buffer_load_dwordx4 v71, s[28:31], 0 offen offset:3072 sc1 lds
    s_add_u32 m0, s52, 4096
    s_nop 0
    buffer_load_dwordx4 v72, s[28:31], s98 offen offset:0 sc1 lds
    s_add_u32 m0, s52, 4096
    s_nop 0
    buffer_load_dwordx4 v73, s[28:31], s98 offen offset:1024 sc1 lds
    s_lshl_b32 s54, s3, 3
    s_add_u32 s55, s54, 7
    s_waitcnt lgkmcnt(0)
    s_barrier
    ds_read_b128 v[96:99], v2 offset:13312
    ds_read_b32 v132, v132 offset:8192
    ds_read_b32 v133, v133 offset:8192
    ds_read_b32 v134, v134 offset:8192
    ds_read_b32 v11, v251 offset:15616
    s_waitcnt lgkmcnt(4)
    v_add_u32 v9, v96, v97
    v_add3_u32 v9, v9, v98, v99
    v_mov_b32 v10, v9
    s_waitcnt lgkmcnt(1)
    v_bfe_u32 v15, v132, 12, 3
    v_add_u32_dpp v10, v10, v10 row_shr:1 row_mask:0xf bank_mask:0xf
    v_or_b32 v78, v15, v78
    v_and_b32 v64, 0x3ff, v132
    v_add_u32_dpp v10, v10, v10 row_shr:2 row_mask:0xf bank_mask:0xf
    v_lshrrev_b32 v132, 16, v132
    v_add_u32 v132, v132, v128
    v_add_u32_dpp v10, v10, v10 row_shr:4 row_mask:0xf bank_mask:0xf
    v_bfe_u32 v15, v133, 12, 3
    v_or_b32 v82, v15, v82
    v_add_u32_dpp v10, v10, v10 row_shr:8 row_mask:0xf bank_mask:0xf
    v_and_b32 v65, 0x3ff, v133
    v_lshrrev_b32 v133, 16, v133
    v_add_u32_dpp v10, v10, v10 row_bcast:15 row_mask:0xa bank_mask:0xf
    v_add_u32 v133, v133, v129
    v_bfe_u32 v15, v134, 12, 3
    v_add_u32_dpp v10, v10, v10 row_bcast:31 row_mask:0xc bank_mask:0xf
    v_or_b32 v86, v15, v86
    v_and_b32 v66, 0x3ff, v134
    v_sub_u32 v9, v10, v9
    v_lshl_add_u32 v104, v9, 2, v252
    v_lshl_add_u32 v105, v96, 2, v104
    v_lshl_add_u32 v106, v97, 2, v105
    v_lshl_add_u32 v107, v98, 2, v106
    ds_write_b128 v2, v[104:107] offset:16384
    ds_read_b32 v64, v64 offset:16384
    ds_read_b32 v65, v65 offset:16384
    ds_read_b32 v66, v66 offset:16384
    v_lshrrev_b32 v134, 16, v134
    v_add_u32 v134, v134, v130
    v_readlane_b32 s50, v10, s55
    v_readlane_b32 s53, v9, s54
    v_readlane_b32 s51, v104, s54
    v_mov_b32 v12, 2097029
    s_sub_u32 s50, s50, s53
    s_lshl_b32 s54, s50, 2
    v_add_u32 v198, s51, v201
    v_add_u32 v199, s51, v202
    v_add_u32 v9, s54, v198
    s_waitcnt lgkmcnt(2)
    v_lshl_add_u32 v132, v132, 2, v64
    s_mov_b64 exec, s[80:81]
    ds_write_b32 v132, v78
    s_mov_b64 exec, -1
    s_waitcnt lgkmcnt(2)
    v_lshl_add_u32 v133, v133, 2, v65
    s_mov_b64 exec, s[82:83]
    ds_write_b32 v133, v82
    s_mov_b64 exec, -1
    s_waitcnt lgkmcnt(2)
    v_lshl_add_u32 v134, v134, 2, v66
    s_mov_b64 exec, s[84:85]
    ds_write_b32 v134, v86
    s_mov_b64 exec, -1
    ds_write_b32 v9, v12
    s_cmp_gt_i32 s95, 192
    s_cbranch_scc1 L_r3
L_r3b:
    v_readlane_b32 s56, v11, 0
    v_readlane_b32 s57, v11, 1
    v_readlane_b32 s58, v11, 2
    v_readlane_b32 s59, v11, 3
    v_readlane_b32 s60, v11, 4
    v_lshlrev_b32 v8, 2, v1
    s_mul_i32 s54, s56, 9
    v_add_u32 v208, s54, v8
    s_mul_i32 s54, s57, 9
    v_add_u32 v209, s54, v8
    s_mul_i32 s54, s58, 9
    v_add_u32 v210, s54, v8
    s_mul_i32 s54, s59, 9
    v_add_u32 v211, s54, v8
    s_mul_i32 s54, s60, 9
    v_add_u32 v212, s54, v8
    s_lshr_b32 s99, s3, 1
    s_mul_i32 s99, s99, 3
    s_min_u32 s99, s99, 8
    s_mul_i32 s55, s99, 4608
    v_and_b32 v8, 15, v1
    v_lshrrev_b32 v9, 4, v1
    v_mul_u32_u24 v213, 288, v8
    v_lshl_add_u32 v213, v9, 4, v213
    v_add_u32 v213, s55, v213
    v_lshrrev_b32 v9, 3, v1
    v_lshlrev_b32 v9, 9, v9
    v_and_b32 v8, 7, v1
    v_lshl_add_u32 v214, v8, 4, v9
    s_lshl_b32 s99, s99, 12
    s_and_b32 s55, s3, 1
    s_lshl_b32 s54, s55, 7
    s_add_u32 s99, s99, s54
    s_lshl_b32 s55, s55, 14
    s_add_u32 s55, s55, 46080
    v_add_u32 v215, s55, v2
    ds_read_b128 v[216:219], v215 offset:0
    ds_read_b128 v[220:223], v215 offset:1024
    ds_read_b128 v[224:227], v215 offset:2048
    ds_read_b128 v[228:231], v215 offset:3072
    ds_read_b128 v[232:235], v215 offset:4096
    ds_read_b128 v[236:239], v215 offset:5120
    s_add_u32 s54, s50, 1
    s_and_b32 s54, s54, -2
    s_add_u32 s53, s54, 15
    s_lshr_b32 s53, s53, 4
    s_sub_u32 s54, 0, s54
    s_and_b32 s54, s54, 15
    s_sub_u32 s53, s53, 1
    s_cmp_gt_i32 s53, 0
    s_cselect_b32 s54, s54, 0
    s_lshl_b32 s61, s54, 2
    v_subrev_u32 v198, s61, v198
    v_subrev_u32 v199, s61, v199
    s_and_b32 s61, s61, 32
    v_add_u32 v12, s61, v198
    s_and_b32 s72, s54, 6
    s_mov_b32 s55, 0x00fffc38
    s_mov_b32 s49, 0xffffff00
    s_mov_b32 s51, 87040
    s_cmp_lt_u32 s3, 4
    s_cbranch_scc1 L_np
    s_setprio 1
L_np:
    s_waitcnt vmcnt(0) lgkmcnt(0)
    s_barrier
    ds_read_b32 v196, v12
    ds_read_b32 v194, v199
    ds_read_b32 v197, v198 offset:24
    s_cmp_eq_u32 s50, 0
    s_cbranch_scc1 L_swept
    s_waitcnt lgkmcnt(1)
    v_lshlrev_b32 v196, 3, v196
    v_and_b32 v196, s55, v196
    v_lshrrev_b32 v8, 21, v194
    v_lshl_add_u32 v11, v8, 3, s51
    v_lshl_add_u32 v8, v8, 5, v200
    ds_read_b64 v[192:193], v11
    s_mov_b64 exec, s[86:87]
    ds_read_b128 v[164:167], v8
    s_mov_b64 exec, s[88:89]
    ds_read_b128 v[168:171], v8
    s_mov_b64 exec, -1
    s_cmp_eq_u32 s72, 2
    s_cbranch_scc1 L_p2
    s_cmp_eq_u32 s72, 4
    s_cbranch_scc1 L_p4
    s_cmp_eq_u32 s72, 6
    s_cbranch_scc1 L_p6
L_p0:
    v_readlane_b32 s64, v196, 0
    v_readlane_b32 s65, v196, 1
    s_and_b32 s61, s64, s49
    buffer_load_dwordx4 v[96:99], v2, s[16:19], s61 offen
    s_and_b32 s61, s65, s49
    buffer_load_dwordx4 v[100:103], v2, s[16:19], s61 offen
L_p2:
    v_readlane_b32 s66, v196, 2
    v_readlane_b32 s67, v196, 3
    s_and_b32 s61, s66, s49
    buffer_load_dwordx4 v[104:107], v2, s[16:19], s61 offen
    s_and_b32 s61, s67, s49
    buffer_load_dwordx4 v[108:111], v2, s[16:19], s61 offen
L_p4:
    v_readlane_b32 s68, v196, 4
    v_readlane_b32 s69, v196, 5
    s_and_b32 s61, s68, s49
    buffer_load_dwordx4 v[112:115], v2, s[16:19], s61 offen
    s_and_b32 s61, s69, s49
    buffer_load_dwordx4 v[116:119], v2, s[16:19], s61 offen
    s_cmp_eq_u32 s72, 0
    s_cbranch_scc1 L_pd
L_p6:
    v_readlane_b32 s70, v196, 6
    v_readlane_b32 s71, v196, 7
    s_and_b32 s61, s70, s49
    buffer_load_dwordx4 v[120:123], v2, s[16:19], s61 offen
    s_and_b32 s61, s71, s49
    buffer_load_dwordx4 v[124:127], v2, s[16:19], s61 offen
    s_cmp_eq_u32 s72, 2
    s_cbranch_scc1 L_pd
L_p8:
    v_readlane_b32 s64, v196, 8
    v_readlane_b32 s65, v196, 9
    s_and_b32 s61, s64, s49
    buffer_load_dwordx4 v[96:99], v2, s[16:19], s61 offen
    s_and_b32 s61, s65, s49
    buffer_load_dwordx4 v[100:103], v2, s[16:19], s61 offen
    s_cmp_eq_u32 s72, 4
    s_cbranch_scc1 L_pd
L_p10:
    v_readlane_b32 s66, v196, 10
    v_readlane_b32 s67, v196, 11
    s_and_b32 s61, s66, s49
    buffer_load_dwordx4 v[104:107], v2, s[16:19], s61 offen
    s_and_b32 s61, s67, s49
    buffer_load_dwordx4 v[108:111], v2, s[16:19], s61 offen
L_pd:
    s_waitcnt lgkmcnt(0)
.p2align 3
    v_mfma_f32_4x4x4_16b_bf16 v[144:147], v[192:193], v[188:189], 0 cbsz:4 abid:0
    v_mfma_f32_4x4x4_16b_bf16 v[148:151], v[192:193], v[188:189], 0 cbsz:4 abid:2
    v_mfma_f32_4x4x4_16b_bf16 v[152:155], v[192:193], v[188:189], 0 cbsz:4 abid:4
    v_mfma_f32_4x4x4_16b_bf16 v[156:159], v[192:193], v[188:189], 0 cbsz:4 abid:6
    v_mfma_f32_32x32x16_bf16 v[64:79], v[164:167], v[172:175], 0
    v_lshlrev_b32 v196, 3, v197
    v_and_b32 v196, s55, v196
    v_add_u32 v198, 64, v198
    v_add_u32 v199, 64, v199
    v_mfma_f32_32x32x16_bf16 v[80:95], v[164:167], v[180:183], 0
    ds_read_b32 v197, v198 offset:24
    ds_read_b32 v194, v199
    v_mfma_f32_32x32x16_bf16 v[64:79], v[168:171], v[176:179], v[64:79]
    v_mfma_f32_32x32x16_bf16 v[80:95], v[168:171], v[184:187], v[80:95]
    s_set_gpr_idx_on s54, gpr_idx(SRC0,SRC1)
    v_cvt_pk_bf16_f32 v9, v144, v144
    s_set_gpr_idx_off
    v_and_b32 v160, v190, v9
    v_and_b32 v161, v191, v9
    s_waitcnt lgkmcnt(0)
    v_lshrrev_b32 v8, 21, v194
    v_lshl_add_u32 v11, v8, 3, s51
    v_lshl_add_u32 v8, v8, 5, v200
    ds_read_b64 v[192:193], v11
    s_mov_b64 exec, s[86:87]
    ds_read_b128 v[164:167], v8
    s_mov_b64 exec, s[88:89]
    ds_read_b128 v[168:171], v8
    s_mov_b64 exec, -1
    s_cmp_eq_u32 s53, 0
    s_cbranch_scc1 L_f0
    s_cmp_eq_u32 s54, 2
    s_cbranch_scc1 L_j2
    s_cmp_eq_u32 s54, 4
    s_cbranch_scc1 L_j4
    s_cmp_eq_u32 s54, 6
    s_cbranch_scc1 L_j6
    s_cmp_eq_u32 s54, 8
    s_cbranch_scc1 L_j8
    s_cmp_eq_u32 s54, 10
    s_cbranch_scc1 L_j10
    s_cmp_eq_u32 s54, 12
    s_cbranch_scc1 L_j12
    s_cmp_eq_u32 s54, 14
    s_cbranch_scc1 L_j14
    s_branch L_j0
.p2align 3
L_loop:
    s_waitcnt lgkmcnt(0)
.p2align 3
    v_mfma_f32_4x4x4_16b_bf16 v[144:147], v[192:193], v[188:189], 0 cbsz:4 abid:0
    v_mfma_f32_4x4x4_16b_bf16 v[148:151], v[192:193], v[188:189], 0 cbsz:4 abid:2
    v_mfma_f32_4x4x4_16b_bf16 v[152:155], v[192:193], v[188:189], 0 cbsz:4 abid:4
    v_mfma_f32_4x4x4_16b_bf16 v[156:159], v[192:193], v[188:189], 0 cbsz:4 abid:6
    v_mfma_f32_32x32x16_bf16 v[64:79], v[164:167], v[172:175], 0
    v_lshlrev_b32 v196, 3, v197
    v_and_b32 v196, s55, v196
    v_add_u32 v198, 64, v198
    v_add_u32 v199, 64, v199
    v_mfma_f32_32x32x16_bf16 v[80:95], v[164:167], v[180:183], 0
    ds_read_b32 v197, v198 offset:24
    ds_read_b32 v194, v199
    v_mfma_f32_32x32x16_bf16 v[64:79], v[168:171], v[176:179], v[64:79]
    v_cvt_pk_bf16_f32 v9, v144, v144
    v_and_b32 v160, v190, v9
    v_and_b32 v161, v191, v9
    v_mfma_f32_32x32x16_bf16 v[80:95], v[168:171], v[184:187], v[80:95]
L_j0:
    s_waitcnt vmcnt(5)
.p2align 3
    v_mfma_f32_16x16x16_bf16 v[128:131], v[160:161], v[96:97], 0
    v_readlane_b32 s70, v196, 0
    v_cvt_pk_bf16_f32 v10, v145, v145
    v_mfma_f32_16x16x16_bf16 v[132:135], v[160:161], v[98:99], 0
    v_and_b32 v162, v190, v10
    v_and_b32 v163, v191, v10
    s_and_b32 s61, s70, s49
    s_waitcnt vmcnt(4)
    buffer_load_dwordx4 v[120:123], v2, s[16:19], s61 offen
    v_mfma_f32_16x16x16_bf16 v[136:139], v[162:163], v[100:101], 0
    v_readlane_b32 s71, v196, 1
    v_cvt_pk_bf16_f32 v9, v146, v146
    v_mfma_f32_16x16x16_bf16 v[140:143], v[162:163], v[102:103], 0
    v_and_b32 v160, v190, v9
    v_and_b32 v161, v191, v9
    s_and_b32 s61, s71, s49
    s_set_gpr_idx_on s64, gpr_idx(SRC2,DST)
    buffer_load_dwordx4 v[124:127], v2, s[16:19], s61 offen
    v_pk_fma_f32 v[16:17], v[128:129], v[64:65], v[16:17] op_sel_hi:[1,0,1]
    v_pk_fma_f32 v[18:19], v[130:131], v[64:65], v[18:19] op_sel_hi:[1,0,1]
    v_pk_fma_f32 v[20:21], v[132:133], v[80:81], v[20:21] op_sel_hi:[1,0,1]
    v_pk_fma_f32 v[22:23], v[134:135], v[80:81], v[22:23] op_sel_hi:[1,0,1]
    s_set_gpr_idx_idx s65
.p2align 3
    v_pk_fma_f32 v[16:17], v[136:137], v[64:65], v[16:17] op_sel:[0,1,0] op_sel_hi:[1,1,1]
    v_pk_fma_f32 v[18:19], v[138:139], v[64:65], v[18:19] op_sel:[0,1,0] op_sel_hi:[1,1,1]
    v_pk_fma_f32 v[20:21], v[140:141], v[80:81], v[20:21] op_sel:[0,1,0] op_sel_hi:[1,1,1]
    v_pk_fma_f32 v[22:23], v[142:143], v[80:81], v[22:23] op_sel:[0,1,0] op_sel_hi:[1,1,1]
    s_set_gpr_idx_off
L_j2:
    s_waitcnt vmcnt(5)
.p2align 3
    v_mfma_f32_16x16x16_bf16 v[128:131], v[160:161], v[104:105], 0
    v_readlane_b32 s64, v196, 2
    v_cvt_pk_bf16_f32 v10, v147, v147
    v_mfma_f32_16x16x16_bf16 v[132:135], v[160:161], v[106:107], 0
    v_and_b32 v162, v190, v10
    v_and_b32 v163, v191, v10
    s_and_b32 s61, s64, s49
    s_waitcnt vmcnt(4)
    buffer_load_dwordx4 v[96:99], v2, s[16:19], s61 offen
    v_mfma_f32_16x16x16_bf16 v[136:139], v[162:163], v[108:109], 0
    v_readlane_b32 s65, v196, 3
    v_cvt_pk_bf16_f32 v9, v148, v148
    v_mfma_f32_16x16x16_bf16 v[140:143], v[162:163], v[110:111], 0
    v_and_b32 v160, v190, v9
    v_and_b32 v161, v191, v9
    s_waitcnt lgkmcnt(0)
    v_lshrrev_b32 v8, 21, v194
    v_lshl_add_u32 v11, v8, 3, s51
    v_lshl_add_u32 v8, v8, 5, v200
    ds_read_b64 v[192:193], v11
    s_mov_b64 exec, s[86:87]
    ds_read_b128 v[164:167], v8
    s_mov_b64 exec, s[88:89]
    ds_read_b128 v[168:171], v8
    s_mov_b64 exec, -1
.p2align 3
    s_and_b32 s61, s65, s49
    s_set_gpr_idx_on s66, gpr_idx(SRC2,DST)
    buffer_load_dwordx4 v[100:103], v2, s[16:19], s61 offen
    v_pk_fma_f32 v[16:17], v[128:129], v[66:67], v[16:17] op_sel_hi:[1,0,1]
    v_pk_fma_f32 v[18:19], v[130:131], v[66:67], v[18:19] op_sel_hi:[1,0,1]
    v_pk_fma_f32 v[20:21], v[132:133], v[82:83], v[20:21] op_sel_hi:[1,0,1]
    v_pk_fma_f32 v[22:23], v[134:135], v[82:83], v[22:23] op_sel_hi:[1,0,1]
    s_set_gpr_idx_idx s67
.p2align 3
    v_pk_fma_f32 v[16:17], v[136:137], v[66:67], v[16:17] op_sel:[0,1,0] op_sel_hi:[1,1,1]
    v_pk_fma_f32 v[18:19], v[138:139], v[66:67], v[18:19] op_sel:[0,1,0] op_sel_hi:[1,1,1]
    v_pk_fma_f32 v[20:21], v[140:141], v[82:83], v[20:21] op_sel:[0,1,0] op_sel_hi:[1,1,1]
    v_pk_fma_f32 v[22:23], v[142:143], v[82:83], v[22:23] op_sel:[0,1,0] op_sel_hi:[1,1,1]
    s_set_gpr_idx_off
L_j4:
    s_waitcnt vmcnt(5)
.p2align 3
    v_mfma_f32_16x16x16_bf16 v[128:131], v[160:161], v[112:113], 0
    v_readlane_b32 s66, v196, 4
    v_cvt_pk_bf16_f32 v10, v149, v149
    v_mfma_f32_16x16x16_bf16 v[132:135], v[160:161], v[114:115], 0
    v_and_b32 v162, v190, v10
    v_and_b32 v163, v191, v10
    s_and_b32 s61, s66, s49
    s_waitcnt vmcnt(4)
    buffer_load_dwordx4 v[104:107], v2, s[16:19], s61 offen
    v_mfma_f32_16x16x16_bf16 v[136:139], v[162:163], v[116:117], 0
    v_readlane_b32 s67, v196, 5
    v_cvt_pk_bf16_f32 v9, v150, v150
    v_mfma_f32_16x16x16_bf16 v[140:143], v[162:163], v[118:119], 0
    v_and_b32 v160, v190, v9
    v_and_b32 v161, v191, v9
    s_and_b32 s61, s67, s49
    s_set_gpr_idx_on s68, gpr_idx(SRC2,DST)
    buffer_load_dwordx4 v[108:111], v2, s[16:19], s61 offen
    v_pk_fma_f32 v[16:17], v[128:129], v[68:69], v[16:17] op_sel_hi:[1,0,1]
    v_pk_fma_f32 v[18:19], v[130:131], v[68:69], v[18:19] op_sel_hi:[1,0,1]
    v_pk_fma_f32 v[20:21], v[132:133], v[84:85], v[20:21] op_sel_hi:[1,0,1]
    v_pk_fma_f32 v[22:23], v[134:135], v[84:85], v[22:23] op_sel_hi:[1,0,1]
    s_set_gpr_idx_idx s69
.p2align 3
    v_pk_fma_f32 v[16:17], v[136:137], v[68:69], v[16:17] op_sel:[0,1,0] op_sel_hi:[1,1,1]
    v_pk_fma_f32 v[18:19], v[138:139], v[68:69], v[18:19] op_sel:[0,1,0] op_sel_hi:[1,1,1]
    v_pk_fma_f32 v[20:21], v[140:141], v[84:85], v[20:21] op_sel:[0,1,0] op_sel_hi:[1,1,1]
    v_pk_fma_f32 v[22:23], v[142:143], v[84:85], v[22:23] op_sel:[0,1,0] op_sel_hi:[1,1,1]
    s_set_gpr_idx_off
L_j6:
    s_waitcnt vmcnt(5)
.p2align 3
    v_mfma_f32_16x16x16_bf16 v[128:131], v[160:161], v[120:121], 0
    v_readlane_b32 s68, v196, 6
    v_cvt_pk_bf16_f32 v10, v151, v151
    v_mfma_f32_16x16x16_bf16 v[132:135], v[160:161], v[122:123], 0
    v_and_b32 v162, v190, v10
    v_and_b32 v163, v191, v10
    s_and_b32 s61, s68, s49
    s_waitcnt vmcnt(4)
    buffer_load_dwordx4 v[112:115], v2, s[16:19], s61 offen
    v_mfma_f32_16x16x16_bf16 v[136:139], v[162:163], v[124:125], 0
    v_readlane_b32 s69, v196, 7
    v_cvt_pk_bf16_f32 v9, v152, v152
    v_mfma_f32_16x16x16_bf16 v[140:143], v[162:163], v[126:127], 0
    v_and_b32 v160, v190, v9
    v_and_b32 v161, v191, v9
    s_and_b32 s61, s69, s49
    s_set_gpr_idx_on s70, gpr_idx(SRC2,DST)
    buffer_load_dwordx4 v[116:119], v2, s[16:19], s61 offen
    v_pk_fma_f32 v[16:17], v[128:129], v[70:71], v[16:17] op_sel_hi:[1,0,1]
    v_pk_fma_f32 v[18:19], v[130:131], v[70:71], v[18:19] op_sel_hi:[1,0,1]
    v_pk_fma_f32 v[20:21], v[132:133], v[86:87], v[20:21] op_sel_hi:[1,0,1]
    v_pk_fma_f32 v[22:23], v[134:135], v[86:87], v[22:23] op_sel_hi:[1,0,1]
    s_set_gpr_idx_idx s71
.p2align 3
    v_pk_fma_f32 v[16:17], v[136:137], v[70:71], v[16:17] op_sel:[0,1,0] op_sel_hi:[1,1,1]
    v_pk_fma_f32 v[18:19], v[138:139], v[70:71], v[18:19] op_sel:[0,1,0] op_sel_hi:[1,1,1]
    v_pk_fma_f32 v[20:21], v[140:141], v[86:87], v[20:21] op_sel:[0,1,0] op_sel_hi:[1,1,1]
    v_pk_fma_f32 v[22:23], v[142:143], v[86:87], v[22:23] op_sel:[0,1,0] op_sel_hi:[1,1,1]
    s_set_gpr_idx_off
L_j8:
    s_waitcnt vmcnt(5)
.p2align 3
    v_mfma_f32_16x16x16_bf16 v[128:131], v[160:161], v[96:97], 0
    v_readlane_b32 s70, v196, 8
    v_cvt_pk_bf16_f32 v10, v153, v153
    v_mfma_f32_16x16x16_bf16 v[132:135], v[160:161], v[98:99], 0
    v_and_b32 v162, v190, v10
    v_and_b32 v163, v191, v10
    s_and_b32 s61, s70, s49
    s_waitcnt vmcnt(4)
    buffer_load_dwordx4 v[120:123], v2, s[16:19], s61 offen
    v_mfma_f32_16x16x16_bf16 v[136:139], v[162:163], v[100:101], 0
    v_readlane_b32 s71, v196, 9
    v_cvt_pk_bf16_f32 v9, v154, v154
    v_mfma_f32_16x16x16_bf16 v[140:143], v[162:163], v[102:103], 0
    v_and_b32 v160, v190, v9
    v_and_b32 v161, v191, v9
    s_and_b32 s61, s71, s49
    s_set_gpr_idx_on s64, gpr_idx(SRC2,DST)
    buffer_load_dwordx4 v[124:127], v2, s[16:19], s61 offen
    v_pk_fma_f32 v[16:17], v[128:129], v[72:73], v[16:17] op_sel_hi:[1,0,1]
    v_pk_fma_f32 v[18:19], v[130:131], v[72:73], v[18:19] op_sel_hi:[1,0,1]
    v_pk_fma_f32 v[20:21], v[132:133], v[88:89], v[20:21] op_sel_hi:[1,0,1]
    v_pk_fma_f32 v[22:23], v[134:135], v[88:89], v[22:23] op_sel_hi:[1,0,1]
    s_set_gpr_idx_idx s65
.p2align 3
    v_pk_fma_f32 v[16:17], v[136:137], v[72:73], v[16:17] op_sel:[0,1,0] op_sel_hi:[1,1,1]
    v_pk_fma_f32 v[18:19], v[138:139], v[72:73], v[18:19] op_sel:[0,1,0] op_sel_hi:[1,1,1]
    v_pk_fma_f32 v[20:21], v[140:141], v[88:89], v[20:21] op_sel:[0,1,0] op_sel_hi:[1,1,1]
    v_pk_fma_f32 v[22:23], v[142:143], v[88:89], v[22:23] op_sel:[0,1,0] op_sel_hi:[1,1,1]
    s_set_gpr_idx_off
L_j10:
    s_waitcnt vmcnt(5)
.p2align 3
    v_mfma_f32_16x16x16_bf16 v[128:131], v[160:161], v[104:105], 0
    v_readlane_b32 s64, v196, 10
    v_cvt_pk_bf16_f32 v10, v155, v155
    v_mfma_f32_16x16x16_bf16 v[132:135], v[160:161], v[106:107], 0
    v_and_b32 v162, v190, v10
    v_and_b32 v163, v191, v10
    s_and_b32 s61, s64, s49
    s_waitcnt vmcnt(4)
    buffer_load_dwordx4 v[96:99], v2, s[16:19], s61 offen
    v_mfma_f32_16x16x16_bf16 v[136:139], v[162:163], v[108:109], 0
    v_readlane_b32 s65, v196, 11
    v_cvt_pk_bf16_f32 v9, v156, v156
    v_mfma_f32_16x16x16_bf16 v[140:143], v[162:163], v[110:111], 0
    v_and_b32 v160, v190, v9
    v_and_b32 v161, v191, v9
    s_and_b32 s61, s65, s49
    s_set_gpr_idx_on s66, gpr_idx(SRC2,DST)
    buffer_load_dwordx4 v[100:103], v2, s[16:19], s61 offen
    v_pk_fma_f32 v[16:17], v[128:129], v[74:75], v[16:17] op_sel_hi:[1,0,1]
    v_pk_fma_f32 v[18:19], v[130:131], v[74:75], v[18:19] op_sel_hi:[1,0,1]
    v_pk_fma_f32 v[20:21], v[132:133], v[90:91], v[20:21] op_sel_hi:[1,0,1]
    v_pk_fma_f32 v[22:23], v[134:135], v[90:91], v[22:23] op_sel_hi:[1,0,1]
    s_set_gpr_idx_idx s67
.p2align 3
    v_pk_fma_f32 v[16:17], v[136:137], v[74:75], v[16:17] op_sel:[0,1,0] op_sel_hi:[1,1,1]
    v_pk_fma_f32 v[18:19], v[138:139], v[74:75], v[18:19] op_sel:[0,1,0] op_sel_hi:[1,1,1]
    v_pk_fma_f32 v[20:21], v[140:141], v[90:91], v[20:21] op_sel:[0,1,0] op_sel_hi:[1,1,1]
    v_pk_fma_f32 v[22:23], v[142:143], v[90:91], v[22:23] op_sel:[0,1,0] op_sel_hi:[1,1,1]
    s_set_gpr_idx_off
L_j12:
    s_waitcnt vmcnt(5)
.p2align 3
    v_mfma_f32_16x16x16_bf16 v[128:131], v[160:161], v[112:113], 0
    v_readlane_b32 s66, v196, 12
    v_cvt_pk_bf16_f32 v10, v157, v157
    v_mfma_f32_16x16x16_bf16 v[132:135], v[160:161], v[114:115], 0
    v_and_b32 v162, v190, v10
    v_and_b32 v163, v191, v10
    s_and_b32 s61, s66, s49
    s_waitcnt vmcnt(4)
    buffer_load_dwordx4 v[104:107], v2, s[16:19], s61 offen
    v_mfma_f32_16x16x16_bf16 v[136:139], v[162:163], v[116:117], 0
    v_readlane_b32 s67, v196, 13
    v_cvt_pk_bf16_f32 v9, v158, v158
    v_mfma_f32_16x16x16_bf16 v[140:143], v[162:163], v[118:119], 0
    v_and_b32 v160, v190, v9
    v_and_b32 v161, v191, v9
    s_and_b32 s61, s67, s49
    s_set_gpr_idx_on s68, gpr_idx(SRC2,DST)
    buffer_load_dwordx4 v[108:111], v2, s[16:19], s61 offen
    v_pk_fma_f32 v[16:17], v[128:129], v[76:77], v[16:17] op_sel_hi:[1,0,1]
    v_pk_fma_f32 v[18:19], v[130:131], v[76:77], v[18:19] op_sel_hi:[1,0,1]
    v_pk_fma_f32 v[20:21], v[132:133], v[92:93], v[20:21] op_sel_hi:[1,0,1]
    v_pk_fma_f32 v[22:23], v[134:135], v[92:93], v[22:23] op_sel_hi:[1,0,1]
    s_set_gpr_idx_idx s69
.p2align 3
    v_pk_fma_f32 v[16:17], v[136:137], v[76:77], v[16:17] op_sel:[0,1,0] op_sel_hi:[1,1,1]
    v_pk_fma_f32 v[18:19], v[138:139], v[76:77], v[18:19] op_sel:[0,1,0] op_sel_hi:[1,1,1]
    v_pk_fma_f32 v[20:21], v[140:141], v[92:93], v[20:21] op_sel:[0,1,0] op_sel_hi:[1,1,1]
    v_pk_fma_f32 v[22:23], v[142:143], v[92:93], v[22:23] op_sel:[0,1,0] op_sel_hi:[1,1,1]
    s_set_gpr_idx_off
L_j14:
    s_waitcnt vmcnt(5)
.p2align 3
    v_mfma_f32_16x16x16_bf16 v[128:131], v[160:161], v[120:121], 0
    v_readlane_b32 s68, v196, 14
    v_cvt_pk_bf16_f32 v10, v159, v159
    v_mfma_f32_16x16x16_bf16 v[132:135], v[160:161], v[122:123], 0
    v_and_b32 v162, v190, v10
    v_and_b32 v163, v191, v10
    s_and_b32 s61, s68, s49
    s_waitcnt vmcnt(4)
    buffer_load_dwordx4 v[112:115], v2, s[16:19], s61 offen
    v_mfma_f32_16x16x16_bf16 v[136:139], v[162:163], v[124:125], 0
    v_readlane_b32 s69, v196, 15
    v_mfma_f32_16x16x16_bf16 v[140:143], v[162:163], v[126:127], 0
    s_and_b32 s61, s69, s49
    s_set_gpr_idx_on s70, gpr_idx(SRC2,DST)
    buffer_load_dwordx4 v[116:119], v2, s[16:19], s61 offen
    v_pk_fma_f32 v[16:17], v[128:129], v[78:79], v[16:17] op_sel_hi:[1,0,1]
    v_pk_fma_f32 v[18:19], v[130:131], v[78:79], v[18:19] op_sel_hi:[1,0,1]
    v_pk_fma_f32 v[20:21], v[132:133], v[94:95], v[20:21] op_sel_hi:[1,0,1]
    v_pk_fma_f32 v[22:23], v[134:135], v[94:95], v[22:23] op_sel_hi:[1,0,1]
    s_set_gpr_idx_idx s71
    s_sub_u32 s53, s53, 1
.p2align 3
    v_pk_fma_f32 v[16:17], v[136:137], v[78:79], v[16:17] op_sel:[0,1,0] op_sel_hi:[1,1,1]
    v_pk_fma_f32 v[18:19], v[138:139], v[78:79], v[18:19] op_sel:[0,1,0] op_sel_hi:[1,1,1]
    v_pk_fma_f32 v[20:21], v[140:141], v[94:95], v[20:21] op_sel:[0,1,0] op_sel_hi:[1,1,1]
    v_pk_fma_f32 v[22:23], v[142:143], v[94:95], v[22:23] op_sel:[0,1,0] op_sel_hi:[1,1,1]
    s_set_gpr_idx_off
    s_cmp_lg_u32 s53, 0
    s_cbranch_scc1 L_loop
    s_waitcnt lgkmcnt(0)
.p2align 3
    v_mfma_f32_4x4x4_16b_bf16 v[144:147], v[192:193], v[188:189], 0 cbsz:4 abid:0
    v_mfma_f32_4x4x4_16b_bf16 v[148:151], v[192:193], v[188:189], 0 cbsz:4 abid:2
    v_mfma_f32_4x4x4_16b_bf16 v[152:155], v[192:193], v[188:189], 0 cbsz:4 abid:4
    v_mfma_f32_4x4x4_16b_bf16 v[156:159], v[192:193], v[188:189], 0 cbsz:4 abid:6
    v_mfma_f32_32x32x16_bf16 v[64:79], v[164:167], v[172:175], 0
    v_lshlrev_b32 v196, 3, v197
    v_and_b32 v196, s55, v196
    v_mfma_f32_32x32x16_bf16 v[80:95], v[164:167], v[180:183], 0
    v_mfma_f32_32x32x16_bf16 v[64:79], v[168:171], v[176:179], v[64:79]
    v_cvt_pk_bf16_f32 v9, v144, v144
    v_and_b32 v160, v190, v9
    v_and_b32 v161, v191, v9
    v_mfma_f32_32x32x16_bf16 v[80:95], v[168:171], v[184:187], v[80:95]
L_f0:
    s_waitcnt vmcnt(5)
.p2align 3
    v_mfma_f32_16x16x16_bf16 v[128:131], v[160:161], v[96:97], 0
    v_readlane_b32 s70, v196, 0
    v_cvt_pk_bf16_f32 v10, v145, v145
    v_mfma_f32_16x16x16_bf16 v[132:135], v[160:161], v[98:99], 0
    v_and_b32 v162, v190, v10
    v_and_b32 v163, v191, v10
    s_and_b32 s61, s70, s49
    s_waitcnt vmcnt(4)
    buffer_load_dwordx4 v[120:123], v2, s[16:19], s61 offen
    v_mfma_f32_16x16x16_bf16 v[136:139], v[162:163], v[100:101], 0
    v_readlane_b32 s71, v196, 1
    v_cvt_pk_bf16_f32 v9, v146, v146
    v_mfma_f32_16x16x16_bf16 v[140:143], v[162:163], v[102:103], 0
    v_and_b32 v160, v190, v9
    v_and_b32 v161, v191, v9
    s_and_b32 s61, s71, s49
    s_set_gpr_idx_on s64, gpr_idx(SRC2,DST)
    buffer_load_dwordx4 v[124:127], v2, s[16:19], s61 offen
    v_pk_fma_f32 v[16:17], v[128:129], v[64:65], v[16:17] op_sel_hi:[1,0,1]
    v_pk_fma_f32 v[18:19], v[130:131], v[64:65], v[18:19] op_sel_hi:[1,0,1]
    v_pk_fma_f32 v[20:21], v[132:133], v[80:81], v[20:21] op_sel_hi:[1,0,1]
    v_pk_fma_f32 v[22:23], v[134:135], v[80:81], v[22:23] op_sel_hi:[1,0,1]
    s_set_gpr_idx_idx s65
.p2align 3
    v_pk_fma_f32 v[16:17], v[136:137], v[64:65], v[16:17] op_sel:[0,1,0] op_sel_hi:[1,1,1]
    v_pk_fma_f32 v[18:19], v[138:139], v[64:65], v[18:19] op_sel:[0,1,0] op_sel_hi:[1,1,1]
    v_pk_fma_f32 v[20:21], v[140:141], v[80:81], v[20:21] op_sel:[0,1,0] op_sel_hi:[1,1,1]
    v_pk_fma_f32 v[22:23], v[142:143], v[80:81], v[22:23] op_sel:[0,1,0] op_sel_hi:[1,1,1]
    s_set_gpr_idx_off
    s_waitcnt vmcnt(5)
.p2align 3
    v_mfma_f32_16x16x16_bf16 v[128:131], v[160:161], v[104:105], 0
    v_readlane_b32 s64, v196, 2
    v_cvt_pk_bf16_f32 v10, v147, v147
    v_mfma_f32_16x16x16_bf16 v[132:135], v[160:161], v[106:107], 0
    v_and_b32 v162, v190, v10
    v_and_b32 v163, v191, v10
    s_and_b32 s61, s64, s49
    s_waitcnt vmcnt(4)
    buffer_load_dwordx4 v[96:99], v2, s[16:19], s61 offen
    v_mfma_f32_16x16x16_bf16 v[136:139], v[162:163], v[108:109], 0
    v_readlane_b32 s65, v196, 3
    v_cvt_pk_bf16_f32 v9, v148, v148
    v_mfma_f32_16x16x16_bf16 v[140:143], v[162:163], v[110:111], 0
    v_and_b32 v160, v190, v9
    v_and_b32 v161, v191, v9
    s_and_b32 s61, s65, s49
    s_set_gpr_idx_on s66, gpr_idx(SRC2,DST)
    buffer_load_dwordx4 v[100:103], v2, s[16:19], s61 offen
    v_pk_fma_f32 v[16:17], v[128:129], v[66:67], v[16:17] op_sel_hi:[1,0,1]
    v_pk_fma_f32 v[18:19], v[130:131], v[66:67], v[18:19] op_sel_hi:[1,0,1]
    v_pk_fma_f32 v[20:21], v[132:133], v[82:83], v[20:21] op_sel_hi:[1,0,1]
    v_pk_fma_f32 v[22:23], v[134:135], v[82:83], v[22:23] op_sel_hi:[1,0,1]
    s_set_gpr_idx_idx s67
.p2align 3
    v_pk_fma_f32 v[16:17], v[136:137], v[66:67], v[16:17] op_sel:[0,1,0] op_sel_hi:[1,1,1]
    v_pk_fma_f32 v[18:19], v[138:139], v[66:67], v[18:19] op_sel:[0,1,0] op_sel_hi:[1,1,1]
    v_pk_fma_f32 v[20:21], v[140:141], v[82:83], v[20:21] op_sel:[0,1,0] op_sel_hi:[1,1,1]
    v_pk_fma_f32 v[22:23], v[142:143], v[82:83], v[22:23] op_sel:[0,1,0] op_sel_hi:[1,1,1]
    s_set_gpr_idx_off
    s_waitcnt vmcnt(5)
.p2align 3
    v_mfma_f32_16x16x16_bf16 v[128:131], v[160:161], v[112:113], 0
    v_readlane_b32 s66, v196, 4
    v_cvt_pk_bf16_f32 v10, v149, v149
    v_mfma_f32_16x16x16_bf16 v[132:135], v[160:161], v[114:115], 0
    v_and_b32 v162, v190, v10
    v_and_b32 v163, v191, v10
    s_and_b32 s61, s66, s49
    s_waitcnt vmcnt(4)
    buffer_load_dwordx4 v[104:107], v2, s[16:19], s61 offen
    v_mfma_f32_16x16x16_bf16 v[136:139], v[162:163], v[116:117], 0
    v_readlane_b32 s67, v196, 5
    v_cvt_pk_bf16_f32 v9, v150, v150
    v_mfma_f32_16x16x16_bf16 v[140:143], v[162:163], v[118:119], 0
    v_and_b32 v160, v190, v9
    v_and_b32 v161, v191, v9
    s_and_b32 s61, s67, s49
    s_set_gpr_idx_on s68, gpr_idx(SRC2,DST)
    buffer_load_dwordx4 v[108:111], v2, s[16:19], s61 offen
    v_pk_fma_f32 v[16:17], v[128:129], v[68:69], v[16:17] op_sel_hi:[1,0,1]
    v_pk_fma_f32 v[18:19], v[130:131], v[68:69], v[18:19] op_sel_hi:[1,0,1]
    v_pk_fma_f32 v[20:21], v[132:133], v[84:85], v[20:21] op_sel_hi:[1,0,1]
    v_pk_fma_f32 v[22:23], v[134:135], v[84:85], v[22:23] op_sel_hi:[1,0,1]
    s_set_gpr_idx_idx s69
.p2align 3
    v_pk_fma_f32 v[16:17], v[136:137], v[68:69], v[16:17] op_sel:[0,1,0] op_sel_hi:[1,1,1]
    v_pk_fma_f32 v[18:19], v[138:139], v[68:69], v[18:19] op_sel:[0,1,0] op_sel_hi:[1,1,1]
    v_pk_fma_f32 v[20:21], v[140:141], v[84:85], v[20:21] op_sel:[0,1,0] op_sel_hi:[1,1,1]
    v_pk_fma_f32 v[22:23], v[142:143], v[84:85], v[22:23] op_sel:[0,1,0] op_sel_hi:[1,1,1]
    s_set_gpr_idx_off
    s_waitcnt vmcnt(5)
.p2align 3
    v_mfma_f32_16x16x16_bf16 v[128:131], v[160:161], v[120:121], 0
    v_readlane_b32 s68, v196, 6
    v_cvt_pk_bf16_f32 v10, v151, v151
    v_mfma_f32_16x16x16_bf16 v[132:135], v[160:161], v[122:123], 0
    v_and_b32 v162, v190, v10
    v_and_b32 v163, v191, v10
    s_and_b32 s61, s68, s49
    s_waitcnt vmcnt(4)
    buffer_load_dwordx4 v[112:115], v2, s[16:19], s61 offen
    v_mfma_f32_16x16x16_bf16 v[136:139], v[162:163], v[124:125], 0
    v_readlane_b32 s69, v196, 7
    v_cvt_pk_bf16_f32 v9, v152, v152
    v_mfma_f32_16x16x16_bf16 v[140:143], v[162:163], v[126:127], 0
    v_and_b32 v160, v190, v9
    v_and_b32 v161, v191, v9
    s_and_b32 s61, s69, s49
    s_set_gpr_idx_on s70, gpr_idx(SRC2,DST)
    buffer_load_dwordx4 v[116:119], v2, s[16:19], s61 offen
    v_pk_fma_f32 v[16:17], v[128:129], v[70:71], v[16:17] op_sel_hi:[1,0,1]
    v_pk_fma_f32 v[18:19], v[130:131], v[70:71], v[18:19] op_sel_hi:[1,0,1]
    v_pk_fma_f32 v[20:21], v[132:133], v[86:87], v[20:21] op_sel_hi:[1,0,1]
    v_pk_fma_f32 v[22:23], v[134:135], v[86:87], v[22:23] op_sel_hi:[1,0,1]
    s_set_gpr_idx_idx s71
.p2align 3
    v_pk_fma_f32 v[16:17], v[136:137], v[70:71], v[16:17] op_sel:[0,1,0] op_sel_hi:[1,1,1]
    v_pk_fma_f32 v[18:19], v[138:139], v[70:71], v[18:19] op_sel:[0,1,0] op_sel_hi:[1,1,1]
    v_pk_fma_f32 v[20:21], v[140:141], v[86:87], v[20:21] op_sel:[0,1,0] op_sel_hi:[1,1,1]
    v_pk_fma_f32 v[22:23], v[142:143], v[86:87], v[22:23] op_sel:[0,1,0] op_sel_hi:[1,1,1]
    s_set_gpr_idx_off
    s_waitcnt vmcnt(5)
.p2align 3
    v_mfma_f32_16x16x16_bf16 v[128:131], v[160:161], v[96:97], 0
    v_readlane_b32 s70, v196, 8
    v_cvt_pk_bf16_f32 v10, v153, v153
    v_mfma_f32_16x16x16_bf16 v[132:135], v[160:161], v[98:99], 0
    v_and_b32 v162, v190, v10
    v_and_b32 v163, v191, v10
    s_and_b32 s61, s70, s49
    s_waitcnt vmcnt(4)
    buffer_load_dwordx4 v[120:123], v2, s[16:19], s61 offen
    v_mfma_f32_16x16x16_bf16 v[136:139], v[162:163], v[100:101], 0
    v_readlane_b32 s71, v196, 9
    v_cvt_pk_bf16_f32 v9, v154, v154
    v_mfma_f32_16x16x16_bf16 v[140:143], v[162:163], v[102:103], 0
    v_and_b32 v160, v190, v9
    v_and_b32 v161, v191, v9
    s_and_b32 s61, s71, s49
    s_set_gpr_idx_on s64, gpr_idx(SRC2,DST)
    buffer_load_dwordx4 v[124:127], v2, s[16:19], s61 offen
    v_pk_fma_f32 v[16:17], v[128:129], v[72:73], v[16:17] op_sel_hi:[1,0,1]
    v_pk_fma_f32 v[18:19], v[130:131], v[72:73], v[18:19] op_sel_hi:[1,0,1]
    v_pk_fma_f32 v[20:21], v[132:133], v[88:89], v[20:21] op_sel_hi:[1,0,1]
    v_pk_fma_f32 v[22:23], v[134:135], v[88:89], v[22:23] op_sel_hi:[1,0,1]
    s_set_gpr_idx_idx s65
.p2align 3
    v_pk_fma_f32 v[16:17], v[136:137], v[72:73], v[16:17] op_sel:[0,1,0] op_sel_hi:[1,1,1]
    v_pk_fma_f32 v[18:19], v[138:139], v[72:73], v[18:19] op_sel:[0,1,0] op_sel_hi:[1,1,1]
    v_pk_fma_f32 v[20:21], v[140:141], v[88:89], v[20:21] op_sel:[0,1,0] op_sel_hi:[1,1,1]
    v_pk_fma_f32 v[22:23], v[142:143], v[88:89], v[22:23] op_sel:[0,1,0] op_sel_hi:[1,1,1]
    s_set_gpr_idx_off
    s_waitcnt vmcnt(5)
.p2align 3
    v_mfma_f32_16x16x16_bf16 v[128:131], v[160:161], v[104:105], 0
    v_cvt_pk_bf16_f32 v10, v155, v155
    v_mfma_f32_16x16x16_bf16 v[132:135], v[160:161], v[106:107], 0
    v_and_b32 v162, v190, v10
    v_and_b32 v163, v191, v10
    s_waitcnt vmcnt(4)
.p2align 3
    s_nop 0
    v_mfma_f32_16x16x16_bf16 v[136:139], v[162:163], v[108:109], 0
    v_cvt_pk_bf16_f32 v9, v156, v156
    v_mfma_f32_16x16x16_bf16 v[140:143], v[162:163], v[110:111], 0
    v_and_b32 v160, v190, v9
    v_and_b32 v161, v191, v9
    s_set_gpr_idx_on s66, gpr_idx(SRC2,DST)
.p2align 3
    v_pk_fma_f32 v[16:17], v[128:129], v[74:75], v[16:17] op_sel_hi:[1,0,1]
    v_pk_fma_f32 v[18:19], v[130:131], v[74:75], v[18:19] op_sel_hi:[1,0,1]
    v_pk_fma_f32 v[20:21], v[132:133], v[90:91], v[20:21] op_sel_hi:[1,0,1]
    v_pk_fma_f32 v[22:23], v[134:135], v[90:91], v[22:23] op_sel_hi:[1,0,1]
    s_set_gpr_idx_idx s67
.p2align 3
    v_pk_fma_f32 v[16:17], v[136:137], v[74:75], v[16:17] op_sel:[0,1,0] op_sel_hi:[1,1,1]
    v_pk_fma_f32 v[18:19], v[138:139], v[74:75], v[18:19] op_sel:[0,1,0] op_sel_hi:[1,1,1]
    v_pk_fma_f32 v[20:21], v[140:141], v[90:91], v[20:21] op_sel:[0,1,0] op_sel_hi:[1,1,1]
    v_pk_fma_f32 v[22:23], v[142:143], v[90:91], v[22:23] op_sel:[0,1,0] op_sel_hi:[1,1,1]
    s_set_gpr_idx_off
    s_waitcnt vmcnt(3)
.p2align 3
    v_mfma_f32_16x16x16_bf16 v[128:131], v[160:161], v[112:113], 0
    v_cvt_pk_bf16_f32 v10, v157, v157
    v_mfma_f32_16x16x16_bf16 v[132:135], v[160:161], v[114:115], 0
    v_and_b32 v162, v190, v10
    v_and_b32 v163, v191, v10
    s_waitcnt vmcnt(2)
.p2align 3
    s_nop 0
    v_mfma_f32_16x16x16_bf16 v[136:139], v[162:163], v[116:117], 0
    v_cvt_pk_bf16_f32 v9, v158, v158
    v_mfma_f32_16x16x16_bf16 v[140:143], v[162:163], v[118:119], 0
    v_and_b32 v160, v190, v9
    v_and_b32 v161, v191, v9
    s_set_gpr_idx_on s68, gpr_idx(SRC2,DST)
.p2align 3
    v_pk_fma_f32 v[16:17], v[128:129], v[76:77], v[16:17] op_sel_hi:[1,0,1]
    v_pk_fma_f32 v[18:19], v[130:131], v[76:77], v[18:19] op_sel_hi:[1,0,1]
    v_pk_fma_f32 v[20:21], v[132:133], v[92:93], v[20:21] op_sel_hi:[1,0,1]
    v_pk_fma_f32 v[22:23], v[134:135], v[92:93], v[22:23] op_sel_hi:[1,0,1]
    s_set_gpr_idx_idx s69
.p2align 3
    v_pk_fma_f32 v[16:17], v[136:137], v[76:77], v[16:17] op_sel:[0,1,0] op_sel_hi:[1,1,1]
    v_pk_fma_f32 v[18:19], v[138:139], v[76:77], v[18:19] op_sel:[0,1,0] op_sel_hi:[1,1,1]
    v_pk_fma_f32 v[20:21], v[140:141], v[92:93], v[20:21] op_sel:[0,1,0] op_sel_hi:[1,1,1]
    v_pk_fma_f32 v[22:23], v[142:143], v[92:93], v[22:23] op_sel:[0,1,0] op_sel_hi:[1,1,1]
    s_set_gpr_idx_off
    s_waitcnt vmcnt(1)
.p2align 3
    v_mfma_f32_16x16x16_bf16 v[128:131], v[160:161], v[120:121], 0
    v_cvt_pk_bf16_f32 v10, v159, v159
    v_mfma_f32_16x16x16_bf16 v[132:135], v[160:161], v[122:123], 0
    v_and_b32 v162, v190, v10
    v_and_b32 v163, v191, v10
    s_waitcnt vmcnt(0)
.p2align 3
    s_nop 0
    v_mfma_f32_16x16x16_bf16 v[136:139], v[162:163], v[124:125], 0
    v_mfma_f32_16x16x16_bf16 v[140:143], v[162:163], v[126:127], 0
    s_set_gpr_idx_on s70, gpr_idx(SRC2,DST)
.p2align 3
    v_pk_fma_f32 v[16:17], v[128:129], v[78:79], v[16:17] op_sel_hi:[1,0,1]
    v_pk_fma_f32 v[18:19], v[130:131], v[78:79], v[18:19] op_sel_hi:[1,0,1]
    v_pk_fma_f32 v[20:21], v[132:133], v[94:95], v[20:21] op_sel_hi:[1,0,1]
    v_pk_fma_f32 v[22:23], v[134:135], v[94:95], v[22:23] op_sel_hi:[1,0,1]
    s_set_gpr_idx_idx s71
.p2align 3
    s_nop 0
    v_pk_fma_f32 v[16:17], v[136:137], v[78:79], v[16:17] op_sel:[0,1,0] op_sel_hi:[1,1,1]
    v_pk_fma_f32 v[18:19], v[138:139], v[78:79], v[18:19] op_sel:[0,1,0] op_sel_hi:[1,1,1]
    v_pk_fma_f32 v[20:21], v[140:141], v[94:95], v[20:21] op_sel:[0,1,0] op_sel_hi:[1,1,1]
    v_pk_fma_f32 v[22:23], v[142:143], v[94:95], v[22:23] op_sel:[0,1,0] op_sel_hi:[1,1,1]
    s_set_gpr_idx_off
L_swept:
    s_add_u32 s48, s48, 224
    s_cmp_lt_u32 s48, s47
    s_cbranch_scc1 L_again
    s_setprio 0
    v_cvt_pk_bf16_f32 v64, v16, v20
    v_cvt_pk_bf16_f32 v65, v17, v21
    v_cvt_pk_bf16_f32 v66, v18, v22
    v_cvt_pk_bf16_f32 v67, v19, v23
    ds_write2_b32 v208, v64, v65 offset0:0 offset1:72
    ds_write2_b32 v208, v66, v67 offset0:144 offset1:216
    v_cvt_pk_bf16_f32 v68, v24, v28
    v_cvt_pk_bf16_f32 v69, v25, v29
    v_cvt_pk_bf16_f32 v70, v26, v30
    v_cvt_pk_bf16_f32 v71, v27, v31
    ds_write2_b32 v209, v68, v69 offset0:0 offset1:72
    ds_write2_b32 v209, v70, v71 offset0:144 offset1:216
    v_cvt_pk_bf16_f32 v72, v32, v36
    v_cvt_pk_bf16_f32 v73, v33, v37
    v_cvt_pk_bf16_f32 v74, v34, v38
    v_cvt_pk_bf16_f32 v75, v35, v39
    ds_write2_b32 v210, v72, v73 offset0:0 offset1:72
    ds_write2_b32 v210, v74, v75 offset0:144 offset1:216
    v_cvt_pk_bf16_f32 v76, v40, v44
    v_cvt_pk_bf16_f32 v77, v41, v45
    v_cvt_pk_bf16_f32 v78, v42, v46
    v_cvt_pk_bf16_f32 v79, v43, v47
    ds_write2_b32 v211, v76, v77 offset0:0 offset1:72
    ds_write2_b32 v211, v78, v79 offset0:144 offset1:216
    v_cvt_pk_bf16_f32 v80, v48, v52
    v_cvt_pk_bf16_f32 v81, v49, v53
    v_cvt_pk_bf16_f32 v82, v50, v54
    v_cvt_pk_bf16_f32 v83, v51, v55
    ds_write2_b32 v212, v80, v81 offset0:0 offset1:72
    ds_write2_b32 v212, v82, v83 offset0:144 offset1:216
    ds_read_b128 v[96:99], v215 offset:6144
    ds_read_b128 v[100:103], v215 offset:7168
    ds_read_b128 v[104:107], v215 offset:8192
    ds_read_b128 v[108:111], v215 offset:9216
    ds_read_b128 v[112:115], v215 offset:10240
    ds_read_b128 v[116:119], v215 offset:11264
    ds_read_b128 v[120:123], v215 offset:12288
    ds_read_b128 v[124:127], v215 offset:13312
    ds_read_b128 v[128:131], v215 offset:14336
    ds_read_b128 v[132:135], v215 offset:15360
    s_waitcnt lgkmcnt(10)
    s_barrier
    ds_read_b128 v[16:19], v213 offset:0
    ds_read_b128 v[20:23], v213 offset:64
    ds_read_b128 v[24:27], v213 offset:128
    ds_read_b128 v[28:31], v213 offset:192
    s_waitcnt lgkmcnt(3)
    v_mfma_f32_16x16x32_bf16 v[160:163], v[16:19], v[216:219], 0
    v_mfma_f32_16x16x32_bf16 v[164:167], v[16:19], v[220:223], 0
    v_mfma_f32_16x16x32_bf16 v[168:171], v[16:19], v[224:227], 0
    v_mfma_f32_16x16x32_bf16 v[172:175], v[16:19], v[228:231], 0
    ds_read_b128 v[32:35], v213 offset:4608
    ds_read_b128 v[36:39], v213 offset:4672
    ds_read_b128 v[40:43], v213 offset:4736
    ds_read_b128 v[44:47], v213 offset:4800
    s_waitcnt lgkmcnt(6)
    v_mfma_f32_16x16x32_bf16 v[160:163], v[20:23], v[232:235], v[160:163]
    v_mfma_f32_16x16x32_bf16 v[164:167], v[20:23], v[236:239], v[164:167]
    v_mfma_f32_16x16x32_bf16 v[168:171], v[20:23], v[96:99], v[168:171]
    v_mfma_f32_16x16x32_bf16 v[172:175], v[20:23], v[100:103], v[172:175]
    ds_read_b128 v[48:51], v213 offset:9216
    ds_read_b128 v[52:55], v213 offset:9280
    ds_read_b128 v[56:59], v213 offset:9344
    ds_read_b128 v[60:63], v213 offset:9408
    s_waitcnt lgkmcnt(9)
    v_mfma_f32_16x16x32_bf16 v[160:163], v[24:27], v[104:107], v[160:163]
    v_mfma_f32_16x16x32_bf16 v[164:167], v[24:27], v[108:111], v[164:167]
    v_mfma_f32_16x16x32_bf16 v[168:171], v[24:27], v[112:115], v[168:171]
    v_mfma_f32_16x16x32_bf16 v[172:175], v[24:27], v[116:119], v[172:175]
    s_waitcnt lgkmcnt(8)
    v_mfma_f32_16x16x32_bf16 v[160:163], v[28:31], v[120:123], v[160:163]
    v_mfma_f32_16x16x32_bf16 v[164:167], v[28:31], v[124:127], v[164:167]
    v_mfma_f32_16x16x32_bf16 v[168:171], v[28:31], v[128:131], v[168:171]
    v_mfma_f32_16x16x32_bf16 v[172:175], v[28:31], v[132:135], v[172:175]
    s_waitcnt lgkmcnt(4)
    v_mfma_f32_16x16x32_bf16 v[176:179], v[32:35], v[216:219], 0
    v_mfma_f32_16x16x32_bf16 v[180:183], v[32:35], v[220:223], 0
    v_mfma_f32_16x16x32_bf16 v[184:187], v[32:35], v[224:227], 0
    v_mfma_f32_16x16x32_bf16 v[188:191], v[32:35], v[228:231], 0
    v_mfma_f32_16x16x32_bf16 v[176:179], v[36:39], v[232:235], v[176:179]
    v_cvt_pk_bf16_f32 v64, v160, v164
    v_cvt_pk_bf16_f32 v80, v160, v164
    v_mfma_f32_16x16x32_bf16 v[180:183], v[36:39], v[236:239], v[180:183]
    v_cvt_pk_bf16_f32 v66, v162, v166
    v_cvt_pk_bf16_f32 v65, v168, v172
    v_mfma_f32_16x16x32_bf16 v[184:187], v[36:39], v[96:99], v[184:187]
    v_cvt_pk_bf16_f32 v81, v168, v172
    v_cvt_pk_bf16_f32 v67, v170, v174
    v_mfma_f32_16x16x32_bf16 v[188:191], v[36:39], v[100:103], v[188:191]
    v_mov_b32_dpp v64, v66 row_ror:8 row_mask:0xf bank_mask:0xc
    v_mov_b32_dpp v65, v67 row_ror:8 row_mask:0xf bank_mask:0xc
    v_mfma_f32_16x16x32_bf16 v[176:179], v[40:43], v[104:107], v[176:179]
    v_mov_b32_dpp v66, v80 row_ror:8 row_mask:0xf bank_mask:0x3
    v_mov_b32_dpp v67, v81 row_ror:8 row_mask:0xf bank_mask:0x3
    v_mfma_f32_16x16x32_bf16 v[180:183], v[40:43], v[108:111], v[180:183]
    buffer_store_dwordx4 v[64:67], v214, s[40:43], s99 offen offset:0 sc1
    v_cvt_pk_bf16_f32 v68, v161, v165
    v_mfma_f32_16x16x32_bf16 v[184:187], v[40:43], v[112:115], v[184:187]
    v_cvt_pk_bf16_f32 v82, v161, v165
    v_cvt_pk_bf16_f32 v70, v163, v167
    v_mfma_f32_16x16x32_bf16 v[188:191], v[40:43], v[116:119], v[188:191]
    v_cvt_pk_bf16_f32 v69, v169, v173
    v_cvt_pk_bf16_f32 v83, v169, v173
    v_mfma_f32_16x16x32_bf16 v[176:179], v[44:47], v[120:123], v[176:179]
    v_cvt_pk_bf16_f32 v71, v171, v175
    v_mov_b32_dpp v68, v70 row_ror:8 row_mask:0xf bank_mask:0xc
    v_mfma_f32_16x16x32_bf16 v[180:183], v[44:47], v[124:127], v[180:183]
    v_mov_b32_dpp v69, v71 row_ror:8 row_mask:0xf bank_mask:0xc
    v_mov_b32_dpp v70, v82 row_ror:8 row_mask:0xf bank_mask:0x3
    v_mfma_f32_16x16x32_bf16 v[184:187], v[44:47], v[128:131], v[184:187]
    v_mov_b32_dpp v71, v83 row_ror:8 row_mask:0xf bank_mask:0x3
    buffer_store_dwordx4 v[68:71], v214, s[40:43], s99 offen offset:256 sc1
    v_mfma_f32_16x16x32_bf16 v[188:191], v[44:47], v[132:135], v[188:191]
    s_add_u32 s99, s99, 4096
    s_cmp_ge_u32 s3, 4
    s_cbranch_scc1 L_two
    s_waitcnt lgkmcnt(0)
    v_mfma_f32_16x16x32_bf16 v[160:163], v[48:51], v[216:219], 0
    v_mfma_f32_16x16x32_bf16 v[164:167], v[48:51], v[220:223], 0
    v_mfma_f32_16x16x32_bf16 v[168:171], v[48:51], v[224:227], 0
    v_mfma_f32_16x16x32_bf16 v[172:175], v[48:51], v[228:231], 0
    v_mfma_f32_16x16x32_bf16 v[160:163], v[52:55], v[232:235], v[160:163]
    v_cvt_pk_bf16_f32 v72, v176, v180
    v_cvt_pk_bf16_f32 v80, v176, v180
    v_mfma_f32_16x16x32_bf16 v[164:167], v[52:55], v[236:239], v[164:167]
    v_cvt_pk_bf16_f32 v74, v178, v182
    v_cvt_pk_bf16_f32 v73, v184, v188
    v_mfma_f32_16x16x32_bf16 v[168:171], v[52:55], v[96:99], v[168:171]
    v_cvt_pk_bf16_f32 v81, v184, v188
    v_cvt_pk_bf16_f32 v75, v186, v190
    v_mfma_f32_16x16x32_bf16 v[172:175], v[52:55], v[100:103], v[172:175]
    v_mov_b32_dpp v72, v74 row_ror:8 row_mask:0xf bank_mask:0xc
    v_mov_b32_dpp v73, v75 row_ror:8 row_mask:0xf bank_mask:0xc
    v_mfma_f32_16x16x32_bf16 v[160:163], v[56:59], v[104:107], v[160:163]
    v_mov_b32_dpp v74, v80 row_ror:8 row_mask:0xf bank_mask:0x3
    v_mov_b32_dpp v75, v81 row_ror:8 row_mask:0xf bank_mask:0x3
    v_mfma_f32_16x16x32_bf16 v[164:167], v[56:59], v[108:111], v[164:167]
    buffer_store_dwordx4 v[72:75], v214, s[40:43], s99 offen offset:0 sc1
    v_cvt_pk_bf16_f32 v76, v177, v181
    v_mfma_f32_16x16x32_bf16 v[168:171], v[56:59], v[112:115], v[168:171]
    v_cvt_pk_bf16_f32 v82, v177, v181
    v_cvt_pk_bf16_f32 v78, v179, v183
    v_mfma_f32_16x16x32_bf16 v[172:175], v[56:59], v[116:119], v[172:175]
    v_cvt_pk_bf16_f32 v77, v185, v189
    v_cvt_pk_bf16_f32 v83, v185, v189
    v_mfma_f32_16x16x32_bf16 v[160:163], v[60:63], v[120:123], v[160:163]
    v_cvt_pk_bf16_f32 v79, v187, v191
    v_mov_b32_dpp v76, v78 row_ror:8 row_mask:0xf bank_mask:0xc
    v_mfma_f32_16x16x32_bf16 v[164:167], v[60:63], v[124:127], v[164:167]
    v_mov_b32_dpp v77, v79 row_ror:8 row_mask:0xf bank_mask:0xc
    v_mov_b32_dpp v78, v82 row_ror:8 row_mask:0xf bank_mask:0x3
    v_mfma_f32_16x16x32_bf16 v[168:171], v[60:63], v[128:131], v[168:171]
    v_mov_b32_dpp v79, v83 row_ror:8 row_mask:0xf bank_mask:0x3
    buffer_store_dwordx4 v[76:79], v214, s[40:43], s99 offen offset:256 sc1
    v_mfma_f32_16x16x32_bf16 v[172:175], v[60:63], v[132:135], v[172:175]
    s_add_u32 s99, s99, 4096
    s_nop 0
    v_cvt_pk_bf16_f32 v64, v160, v164
    v_cvt_pk_bf16_f32 v80, v160, v164
    v_cvt_pk_bf16_f32 v66, v162, v166
    s_nop 2
    v_cvt_pk_bf16_f32 v65, v168, v172
    v_cvt_pk_bf16_f32 v81, v168, v172
    v_cvt_pk_bf16_f32 v67, v170, v174
    v_mov_b32_dpp v64, v66 row_ror:8 row_mask:0xf bank_mask:0xc
    s_nop 0
    v_mov_b32_dpp v65, v67 row_ror:8 row_mask:0xf bank_mask:0xc
    v_mov_b32_dpp v66, v80 row_ror:8 row_mask:0xf bank_mask:0x3
    v_mov_b32_dpp v67, v81 row_ror:8 row_mask:0xf bank_mask:0x3
    buffer_store_dwordx4 v[64:67], v214, s[40:43], s99 offen offset:0 sc1
    v_cvt_pk_bf16_f32 v68, v161, v165
    v_cvt_pk_bf16_f32 v82, v161, v165
    v_cvt_pk_bf16_f32 v70, v163, v167
    v_cvt_pk_bf16_f32 v69, v169, v173
    v_cvt_pk_bf16_f32 v83, v169, v173
    v_cvt_pk_bf16_f32 v71, v171, v175
    v_mov_b32_dpp v68, v70 row_ror:8 row_mask:0xf bank_mask:0xc
    s_nop 0
    v_mov_b32_dpp v69, v71 row_ror:8 row_mask:0xf bank_mask:0xc
    v_mov_b32_dpp v70, v82 row_ror:8 row_mask:0xf bank_mask:0x3
    v_mov_b32_dpp v71, v83 row_ror:8 row_mask:0xf bank_mask:0x3
    buffer_store_dwordx4 v[68:71], v214, s[40:43], s99 offen offset:256 sc1
    s_add_u32 s99, s99, 4096
L_stored:
    s_or_b32 s4, s2, s3
    s_cbranch_scc1 L_notag
    v_mov_b32 v8, s62
    v_lshlrev_b32 v10, 2, v1
    s_mov_b32 s54, 524288
    buffer_store_dword v8, v10, s[20:23], s54 offen sc1
L_notag:
L_done:
    s_endpgm
L_again:
    s_waitcnt vmcnt(0) lgkmcnt(0)
    s_barrier
    v_lshlrev_b32 v11, 2, v0
    v_mov_b32 v12, 0x00700000
    v_mov_b32 v13, 0
    ds_write_b32 v11, v12 offset:0
    ds_write_b32 v11, v12 offset:2048
    ds_write_b32 v11, v12 offset:4096
    ds_write_b32 v11, v12 offset:6144
    ds_write_b32 v11, v13 offset:8192
    ds_write_b32 v11, v13 offset:10240
    ds_write_b32 v11, v13 offset:12288
    v_add_u32 v3, v3, v4
    v_subrev_u32 v3, 224, v3
    v_max_i32 v3, 0, v3
    v_subrev_u32 v4, 224, v4
    v_max_i32 v4, 0, v4
    v_sub_u32 v3, v3, v4
    v_add_u32 v5, 224, v5
    s_sub_i32 s95, s95, 224
    v_lshl_add_u32 v8, v4, 2, v241
    s_waitcnt lgkmcnt(0)
    s_barrier
L_clip:
    v_add_u32 v10, v4, v3
    v_min_i32 v10, 224, v10
    v_sub_u32 v10, v10, v4
    v_add_u32 v10, v10, v240
L_masks:
    v_cmp_lt_i32 s[64:65], 0, v10
    v_cmp_lt_i32 s[66:67], 2, v10
    v_cmp_lt_i32 s[68:69], 4, v10
    v_cmp_lt_i32 s[70:71], 6, v10
    v_cmp_lt_i32 s[72:73], 8, v10
    v_cmp_lt_i32 s[74:75], 10, v10
    v_cmp_lt_i32 s[76:77], 12, v10
    v_cmp_lt_i32 s[78:79], 14, v10
    s_nop 0
    s_branch L_mapw
L_map2:
    v_add_u32 v8, 56, v8
    v_subrev_u32 v10, 14, v10
    s_branch L_masks
L_r1:
    ds_read_b32 v67, v242 offset:768
    ds_read_b32 v74, v243 offset:768
    s_waitcnt lgkmcnt(0)
    v_mad_u32_u24 v67, v67, 12, v244
    buffer_load_dwordx3 v[88:90], v67, s[24:27], 0 offen offset:2304 sc1
    v_lshl_add_u32 v74, v74, 5, v2
    s_add_u32 m0, s52, 4096
    s_nop 0
    buffer_load_dwordx4 v74, s[28:31], s98 offen offset:2048 sc1 lds
    s_branch L_r1b
L_r2:
    v_lshrrev_b32 v135, 21, v90
    v_lshlrev_b32 v135, 2, v135
    v_lshrrev_b32 v11, 26, v90
    v_lshl_or_b32 v11, v11, 4, v245
    s_mov_b64 exec, s[96:97]
    ds_add_rtn_u32 v131, v135, v6 offset:8192
    ds_add_u32 v11, v6 offset:14336
    s_mov_b64 exec, -1
    s_mov_b32 exec_hi, 0
    ds_write_b64 v246, v[88:89] offset:1536
    s_mov_b32 exec_hi, -1
    v_and_or_b32 v90, v90, s55, v247
    v_add_u32 v90, 402653184, v90
    s_branch L_r2b
L_r3:
    ds_read_b32 v135, v135 offset:8192
    s_waitcnt lgkmcnt(0)
    v_bfe_u32 v15, v135, 12, 3
    v_or_b32 v90, v15, v90
    v_and_b32 v67, 0x3ff, v135
    v_lshrrev_b32 v135, 16, v135
    v_add_u32 v135, v135, v131
    ds_read_b32 v67, v67 offset:16384
    s_waitcnt lgkmcnt(0)
    v_lshl_add_u32 v135, v135, 2, v67
    s_mov_b64 exec, s[96:97]
    ds_write_b32 v135, v90
    s_mov_b64 exec, -1
    s_branch L_r3b
L_two:
    s_nop 7
    v_cvt_pk_bf16_f32 v72, v176, v180
    v_cvt_pk_bf16_f32 v80, v176, v180
    v_cvt_pk_bf16_f32 v74, v178, v182
    v_cvt_pk_bf16_f32 v73, v184, v188
    v_cvt_pk_bf16_f32 v81, v184, v188
    v_cvt_pk_bf16_f32 v75, v186, v190
    v_mov_b32_dpp v72, v74 row_ror:8 row_mask:0xf bank_mask:0xc
    s_nop 0
    v_mov_b32_dpp v73, v75 row_ror:8 row_mask:0xf bank_mask:0xc
    v_mov_b32_dpp v74, v80 row_ror:8 row_mask:0xf bank_mask:0x3
    v_mov_b32_dpp v75, v81 row_ror:8 row_mask:0xf bank_mask:0x3
    buffer_store_dwordx4 v[72:75], v214, s[40:43], s99 offen offset:0 sc1
    v_cvt_pk_bf16_f32 v76, v177, v181
    v_cvt_pk_bf16_f32 v82, v177, v181
    v_cvt_pk_bf16_f32 v78, v179, v183
    v_cvt_pk_bf16_f32 v77, v185, v189
    v_cvt_pk_bf16_f32 v83, v185, v189
    v_cvt_pk_bf16_f32 v79, v187, v191
    v_mov_b32_dpp v76, v78 row_ror:8 row_mask:0xf bank_mask:0xc
    s_nop 0
    v_mov_b32_dpp v77, v79 row_ror:8 row_mask:0xf bank_mask:0xc
    v_mov_b32_dpp v78, v82 row_ror:8 row_mask:0xf bank_mask:0x3
    v_mov_b32_dpp v79, v83 row_ror:8 row_mask:0xf bank_mask:0x3
    buffer_store_dwordx4 v[76:79], v214, s[40:43], s99 offen offset:256 sc1
    s_add_u32 s99, s99, 4096
    s_branch L_stored
L_poll:
    buffer_load_dwordx2 v[206:207], v10, s[20:23], s49 offen sc1
    s_sub_u32 s53, s53, 1
    s_cbranch_scc1 L_done
    s_waitcnt vmcnt(0)
    v_xor_b32 v11, s63, v206
    v_xor_b32 v12, s62, v207
    v_and_or_b32 v11, v11, s55, v12
    v_cmpx_ne_u32 vcc, 0, v11
    s_cbranch_execnz L_poll
    s_branch L_polled
L_rank2:
    ds_read_b32 v96, v248 offset:8192
    ds_read_b32 v97, v248 offset:8320
    ds_read_b32 v98, v248 offset:8448
    ds_read_b32 v99, v248 offset:8576
    ds_read_b32 v100, v248 offset:8704
    s_waitcnt lgkmcnt(0)
L_end:
    s_branch L_ranked
.section .rodata,"a"
.p2align 6
.amdhsa_kernel gather_scatter__tensor_product_equiv_mace__graph_kernel
  .amdhsa_next_free_vgpr 256
  .amdhsa_next_free_sgpr 102
  .amdhsa_accum_offset 256
  .amdhsa_group_segment_fixed_size 0
  .amdhsa_kernarg_size 88
  .amdhsa_user_sgpr_count 2
  .amdhsa_user_sgpr_kernarg_segment_ptr 1
  .amdhsa_system_sgpr_workgroup_id_x 1
  .amdhsa_float_denorm_mode_32 3
.end_amdhsa_kernel
```

```asm
; @launch grid=(256,1,1) block=(512,1,1) lds=158784
.amdgcn_target "amdgcn-amd-amdhsa--gfx950"
.text
.globl gather_scatter__tensor_product_equiv_mace__graph_kernel
.p2align 8
.type gather_scatter__tensor_product_equiv_mace__graph_kernel,@function
gather_scatter__tensor_product_equiv_mace__graph_kernel:
    s_cmp_ge_u32 s2, 256
    s_cbranch_scc1 L_done
    s_load_dwordx4 s[4:7], s[0:1], 8
    s_load_dwordx4 s[8:11], s[0:1], 24
    s_load_dwordx2 s[14:15], s[0:1], 80
    s_load_dwordx2 s[64:65], s[0:1], 0
    s_load_dwordx2 s[66:67], s[0:1], 40
    s_load_dwordx4 s[68:71], s[0:1], 48
    s_load_dwordx2 s[12:13], s[0:1], 64
    v_lshlrev_b32 v10, 3, v0
    s_getpc_b64 s[80:81]
L_pc:
    s_and_b32 s44, s2, 0xf8
    s_lshl_b32 s44, s44, 6
    v_and_b32 v11, 0x180, v10
    v_add_u32 v11, s44, v11
    v_min_u32 v11, L_end-L_pc, v11
    v_mov_b32 v113, s81
    v_add_co_u32 v112, vcc, s80, v11
    s_nop 1
    v_addc_co_u32 v113, vcc, 0, v113, vcc
    global_load_dword v205, v[112:113], off
    v_lshrrev_b32 v8, 6, v0
    v_and_b32 v1, 63, v0
    v_lshlrev_b32 v9, 2, v0
    v_mov_b32 v13, 0
    v_readfirstlane_b32 s3, v8
    ds_write_b32 v9, v13 offset:23552
    ds_write_b32 v9, v13 offset:28672
    s_mul_i32 s54, s2, 5000
    s_mul_i32 s55, s2, 10000
    s_mul_i32 s61, s2, 40000
    v_lshlrev_b32 v2, 4, v1
    v_lshlrev_b32 v15, 4, v0
    v_mov_b32 v6, 1
    s_lshl_b32 s52, s3, 10
    s_add_u32 s52, s52, 101376
    s_movk_i32 s53, 4096
    s_movk_i32 s50, 8192
    s_mov_b32 s34, 5000
    s_mov_b32 s35, 0x20000
    s_mov_b32 s38, 5000
    s_mov_b32 s39, 0x20000
    s_mov_b32 s98, 10000
    s_mov_b32 s99, 0x20000
    s_mov_b32 s30, 40000
    s_mov_b32 s31, 0x20000
    s_waitcnt lgkmcnt(0)
    s_add_u32 s32, s6, s54
    s_addc_u32 s33, s7, 0
    buffer_load_dword v64, v9, s[32:35], 0 offen offset:0 nt
    buffer_load_dword v65, v9, s[32:35], 0 offen offset:2048 nt
    buffer_load_dword v66, v9, s[32:35], s53 offen nt
    s_add_u32 s36, s4, s54
    s_addc_u32 s37, s5, 0
    s_barrier
    buffer_load_dword v68, v9, s[36:39], 0 offen offset:0 nt
    buffer_load_dword v69, v9, s[36:39], 0 offen offset:2048 nt
    buffer_load_dword v70, v9, s[36:39], s53 offen nt
    s_load_dword s62, s[14:15], 524288
    s_add_u32 s96, s8, s55
    s_addc_u32 s97, s9, 0
    s_add_u32 s28, s10, s61
    s_addc_u32 s29, s11, 0
    buffer_load_dwordx2 v[72:73], v10, s[96:99], 0 offen nt
    buffer_load_dwordx2 v[74:75], v10, s[96:99], s53 offen nt
    buffer_load_dwordx2 v[76:77], v10, s[96:99], s50 offen nt
    s_add_u32 m0, s52, 0
    s_mov_b32 s54, 0
    buffer_load_dwordx4 v15, s[28:31], s54 offen nt lds
    s_add_u32 m0, s52, 8192
    s_mov_b32 s54, 8192
    buffer_load_dwordx4 v15, s[28:31], s54 offen nt lds
    s_mov_b32 s72, 109951168
    s_movk_i32 s73, 625
    s_movk_i32 s74, 838
    s_movk_i32 s54, 226
    v_cmp_gt_u32 s[84:85], s54, v0
    s_mov_b32 s20, s14
    s_mov_b32 s21, s15
    s_mov_b32 s22, 598016
    s_mov_b32 s23, 0x20000
    v_lshlrev_b32 v11, 2, v0
    v_mov_b32 v12, 0x00700000
    v_mov_b32 v13, 0
    ds_write_b32 v11, v12 offset:0
    ds_write_b32 v11, v12 offset:2048
    ds_write_b32 v11, v12 offset:4096
    ds_write_b32 v11, v12 offset:6144
    ds_write_b32 v11, v13 offset:8192
    ds_write_b32 v11, v13 offset:10240
    ds_write_b32 v11, v13 offset:12288
    ds_write_b32 v11, v13 offset:14336
    s_waitcnt vmcnt(8)
    v_mul_hi_u32 v80, v64, s72
    v_mul_hi_u32 v81, v65, s72
    v_mul_hi_u32 v82, v66, s72
    v_lshlrev_b32 v84, 2, v80
    ds_add_rtn_u32 v88, v84, v6 offset:23552
    v_lshlrev_b32 v85, 2, v81
    ds_add_rtn_u32 v89, v85, v6 offset:23552
    v_lshlrev_b32 v86, 2, v82
    s_mov_b64 exec, s[84:85]
    ds_add_rtn_u32 v90, v86, v6 offset:23552
    s_mov_b64 exec, -1
    s_waitcnt lgkmcnt(0)
    s_barrier
    ds_read_b128 v[100:103], v2 offset:23552
    s_mul_i32 s62, s62, 0x9e3779b1
    s_add_u32 s62, s62, 0x7f4a7c15
    s_mul_i32 s63, s62, 0x85ebca6b
    s_and_b32 s63, s63, 0xffc00000
    v_mad_u32_u24 v92, v80, s73, 15
    v_lshrrev_b32 v92, 4, v92
    v_sub_u32 v92, v64, v92
    v_lshrrev_b32 v80, 3, v80
    v_and_b32 v80, 28, v80
    v_mad_u32_u24 v93, v81, s73, 15
    v_lshrrev_b32 v93, 4, v93
    v_sub_u32 v93, v65, v93
    v_lshrrev_b32 v81, 3, v81
    v_and_b32 v81, 28, v81
    v_mad_u32_u24 v94, v82, s73, 15
    v_lshrrev_b32 v94, 4, v94
    v_sub_u32 v94, v66, v94
    v_lshrrev_b32 v82, 3, v82
    v_and_b32 v82, 28, v82
    s_waitcnt lgkmcnt(0)
    v_add_u32 v11, v100, v101
    v_add3_u32 v11, v11, v102, v103
    v_mov_b32 v12, v11
    s_nop 1
    v_add_u32_dpp v12, v12, v12 row_shr:1 row_mask:0xf bank_mask:0xf
    s_nop 1
    v_add_u32_dpp v12, v12, v12 row_shr:2 row_mask:0xf bank_mask:0xf
    s_nop 1
    v_add_u32_dpp v12, v12, v12 row_shr:4 row_mask:0xf bank_mask:0xf
    s_nop 1
    v_add_u32_dpp v12, v12, v12 row_shr:8 row_mask:0xf bank_mask:0xf
    s_nop 1
    v_add_u32_dpp v12, v12, v12 row_bcast:15 row_mask:0xa bank_mask:0xf
    s_nop 1
    v_add_u32_dpp v12, v12, v12 row_bcast:31 row_mask:0xc bank_mask:0xf
    v_sub_u32 v104, v12, v11
    v_add_u32 v105, v104, v100
    v_add_u32 v106, v105, v101
    v_add_u32 v107, v106, v102
    ds_write_b128 v2, v[104:107] offset:24576
    ds_read_b32 v108, v84 offset:24576
    ds_read_b32 v109, v85 offset:24576
    ds_read_b32 v110, v86 offset:24576
    s_waitcnt vmcnt(5)
    v_mul_u32_u24 v96, s74, v68
    v_lshrrev_b32 v96, 18, v96
    v_sub_u32 v96, v96, v80
    v_and_b32 v96, 31, v96
    v_lshl_or_b32 v96, v92, 5, v96
    v_lshlrev_b32 v96, 21, v96
    v_lshl_or_b32 v96, v68, 7, v96
    v_mul_u32_u24 v97, s74, v69
    v_lshrrev_b32 v97, 18, v97
    v_sub_u32 v97, v97, v81
    v_and_b32 v97, 31, v97
    v_lshl_or_b32 v97, v93, 5, v97
    v_lshlrev_b32 v97, 21, v97
    v_lshl_or_b32 v97, v69, 7, v97
    v_mul_u32_u24 v98, s74, v70
    v_lshrrev_b32 v98, 18, v98
    v_sub_u32 v98, v98, v82
    v_and_b32 v98, 31, v98
    v_lshl_or_b32 v98, v94, 5, v98
    v_lshlrev_b32 v98, 21, v98
    v_lshl_or_b32 v98, v70, 7, v98
    v_lshlrev_b32 v92, 5, v0
    v_add_u32 v93, 16384, v92
    v_add_u32 v94, 32768, v92
    s_mov_b32 s55, 30720
    s_waitcnt vmcnt(2) lgkmcnt(0)
    v_add_u32 v108, v108, v88
    v_lshlrev_b32 v84, 2, v108
    v_mad_u32_u24 v108, v108, 12, s55
    ds_write_b32 v84, v92 offset:25600
    ds_write2_b32 v108, v72, v73 offset0:0 offset1:1
    ds_write_b32 v108, v96 offset:8
    v_add_u32 v109, v109, v89
    v_lshlrev_b32 v85, 2, v109
    v_mad_u32_u24 v109, v109, 12, s55
    ds_write_b32 v85, v93 offset:25600
    ds_write2_b32 v109, v74, v75 offset0:0 offset1:1
    ds_write_b32 v109, v97 offset:8
    v_add_u32 v110, v110, v90
    v_lshlrev_b32 v86, 2, v110
    v_mad_u32_u24 v110, v110, 12, s55
    s_mov_b64 exec, s[84:85]
    ds_write_b32 v86, v94 offset:25600
    ds_write2_b32 v110, v76, v77 offset0:0 offset1:1
    ds_write_b32 v110, v98 offset:8
    s_mov_b64 exec, -1
    s_add_u32 m0, s52, 16384
    s_mov_b32 s54, 16384
    buffer_load_dwordx4 v15, s[28:31], s54 offen nt lds
    s_add_u32 m0, s52, 24576
    s_mov_b32 s54, 24576
    buffer_load_dwordx4 v15, s[28:31], s54 offen nt lds
    s_add_u32 m0, s52, 32768
    s_mov_b32 s54, 32768
    buffer_load_dwordx4 v15, s[28:31], s54 offen nt lds
    s_lshl_b32 s54, s3, 7
    v_lshl_add_u32 v11, v1, 3, s54
    ds_read_b64 v[100:101], v11 offset:23552
    ds_read_b64 v[104:105], v11 offset:24576
    s_mul_i32 s54, s2, 15360
    s_add_u32 s54, s54, 1048576
    s_add_u32 s32, s14, s54
    s_addc_u32 s33, s15, 0
    s_mov_b32 s34, 15360
    s_mov_b32 s35, 0x20000
    s_mul_i32 s54, s2, 40960
    s_add_u32 s54, s54, 5242880
    s_add_u32 s36, s14, s54
    s_addc_u32 s37, s15, 0
    s_mov_b32 s38, 40000
    s_mov_b32 s39, 0x20000
    v_lshrrev_b32 v11, 1, v0
    v_lshlrev_b32 v11, 2, v11
    v_and_b32 v12, 1, v0
    v_lshlrev_b32 v12, 4, v12
    v_add_u32 v12, 101376, v12
    v_add_u32 v14, 30720, v15
    s_waitcnt lgkmcnt(0)
    s_barrier
    ds_read_b128 v[128:131], v14
    ds_read_b128 v[132:135], v14 offset:8192
    ds_read_b32 v156, v11 offset:25600
    ds_read_b32 v157, v11 offset:26624
    ds_read_b32 v158, v11 offset:27648
    ds_read_b32 v159, v11 offset:28672
    ds_read_b32 v160, v11 offset:29696
    s_cmp_lt_u32 s3, 4
    s_cselect_b32 s16, s68, s66
    s_cselect_b32 s17, s69, s67
    s_movk_i32 s54, 128
    s_cselect_b32 s18, s53, s54
    s_mov_b32 s19, 0x20000
    s_min_u32 s54, s3, 5
    s_lshl_b32 s54, s54, 10
    s_add_u32 m0, s54, 17408
    s_and_b32 s54, s54, 0xc00
    buffer_load_dwordx4 v2, s[16:19], s54 offen lds
    s_mov_b32 s40, s70
    s_mov_b32 s41, s71
    s_mov_b32 s42, 32768
    s_mov_b32 s43, 0x20000
    s_lshl_b32 s55, s3, 12
    s_add_u32 m0, s55, 46080
    s_nop 0
    buffer_load_dwordx4 v2, s[40:43], s55 offen offset:0 lds
    buffer_load_dwordx4 v2, s[40:43], s55 offen offset:1024 lds
    buffer_load_dwordx4 v2, s[40:43], s55 offen offset:2048 lds
    buffer_load_dwordx4 v2, s[40:43], s55 offen offset:3072 lds
    s_waitcnt lgkmcnt(0)
    v_add_u32 v156, v12, v156
    v_add_u32 v157, v12, v157
    v_add_u32 v158, v12, v158
    v_add_u32 v159, v12, v159
    v_add_u32 v160, v12, v160
    v_lshl_or_b32 v112, v100, 11, v104
    v_or_b32 v112, s63, v112
    v_mov_b32 v113, s62
    v_lshl_or_b32 v114, v101, 11, v105
    v_or_b32 v114, s63, v114
    v_mov_b32 v115, s62
    s_waitcnt vmcnt(0)
    s_barrier
    ds_read_b128 v[136:139], v156
    ds_read_b128 v[140:143], v157
    ds_read_b128 v[144:147], v158
    ds_read_b128 v[148:151], v159
    ds_read_b128 v[152:155], v160
    buffer_store_dwordx4 v[128:131], v15, s[32:35], 0 offen sc1
    buffer_store_dwordx4 v[132:135], v15, s[32:35], s50 offen sc1
    s_mov_b32 s54, 0
    s_waitcnt lgkmcnt(4)
    buffer_store_dwordx4 v[136:139], v15, s[36:39], s54 offen sc1
    s_mov_b32 s54, 8192
    s_waitcnt lgkmcnt(3)
    buffer_store_dwordx4 v[140:143], v15, s[36:39], s54 offen sc1
    s_mov_b32 s54, 16384
    s_waitcnt lgkmcnt(2)
    buffer_store_dwordx4 v[144:147], v15, s[36:39], s54 offen sc1
    s_mov_b32 s54, 24576
    s_waitcnt lgkmcnt(1)
    buffer_store_dwordx4 v[148:151], v15, s[36:39], s54 offen sc1
    s_mov_b32 s54, 32768
    s_waitcnt lgkmcnt(0)
    buffer_store_dwordx4 v[152:155], v15, s[36:39], s54 offen sc1
    s_and_b32 s44, s2, 7
    s_lshl_b32 s44, s44, 5
    s_lshr_b32 s54, s2, 3
    s_add_u32 s44, s44, s54
    s_mul_i32 s45, s44, 625
    s_add_u32 s46, s45, 640
    s_add_u32 s45, s45, 15
    s_lshr_b32 s45, s45, 4
    s_lshr_b32 s46, s46, 4
    s_sub_u32 s46, s46, s45
    v_bfe_i32 v168, v1, 2, 1
    v_and_b32 v168, 0xaaaa, v168
    v_add_u32 v168, 0x4444, v168
    v_mov_b32 v169, 158720
    v_and_b32 v11, 60, v9
    v_add_u32 v11, v11, v169
    ds_write_b32 v11, v13
    v_and_b32 v11, 4, v1
    v_lshlrev_b32 v11, 2, v11
    v_mov_b32 v12, 0xffff
    v_lshlrev_b32 v12, v11, v12
    v_bfe_i32 v11, v1, 3, 1
    v_and_b32 v191, v11, v12
    v_xor_b32 v190, v191, v12
    v_lshrrev_b32 v200, 5, v1
    v_lshlrev_b32 v200, 4, v200
    v_add_u32 v200, 101376, v200
    v_and_b32 v201, 15, v1
    v_lshlrev_b32 v201, 2, v201
    v_bfe_u32 v11, v1, 3, 2
    v_and_b32 v12, 3, v1
    v_lshl_add_u32 v11, v11, 2, v12
    v_lshlrev_b32 v202, 2, v11
    v_bfe_i32 v240, v0, 0, 1
    s_lshl_b32 s54, s3, 10
    v_and_b32 v241, 4, v240
    v_add_u32 v241, s54, v241
    v_lshl_add_u32 v242, v1, 2, s54
    v_lshrrev_b32 v243, 1, v1
    v_lshl_add_u32 v243, v243, 2, s54
    v_mul_u32_u24 v244, 12, v1
    v_and_b32 v245, 12, v242
    v_and_b32 v250, 124, v242
    s_mul_i32 s54, s3, 224
    v_add_u32 v247, s54, v1
    v_lshlrev_b32 v246, 3, v247
    v_add_u32 v246, 87040, v246
    v_lshlrev_b32 v247, 21, v247
    s_mul_i32 s54, s3, 640
    v_add_u32 v248, s54, v250
    v_sub_u32 v249, 63, v1
    s_lshl_b32 s54, s3, 5
    v_lshl_add_u32 v251, v1, 2, s54
    v_lshrrev_b32 v252, 3, v1
    v_mul_u32_u24 v252, 64, v252
    v_add_u32 v252, 78848, v252
    s_cmp_eq_u32 s46, 40
    v_mov_b32 v203, 0
    s_mov_b32 s54, 685900808
    s_cselect_b32 s54, 568459824, s54
    s_mov_b32 exec_lo, 31
    s_mov_b32 exec_hi, 0
    v_mov_b32 v203, s54
    s_mov_b32 s54, 182814793
    s_cselect_b32 s54, 23232528, s54
    s_mov_b32 exec_lo, 992
    s_mov_b32 exec_hi, 0
    v_mov_b32 v203, s54
    s_mov_b32 s54, 984091248
    s_cselect_b32 s54, 719688297, s54
    s_mov_b32 exec_lo, 31744
    s_mov_b32 exec_hi, 0
    v_mov_b32 v203, s54
    s_mov_b32 s54, 424091761
    s_cselect_b32 s54, 984423522, s54
    s_mov_b32 exec_lo, 1015808
    s_mov_b32 exec_hi, 0
    v_mov_b32 v203, s54
    s_mov_b32 s54, 586001611
    s_cselect_b32 s54, 172635826, s54
    s_mov_b32 exec_lo, 32505856
    s_mov_b32 exec_hi, 0
    v_mov_b32 v203, s54
    s_mov_b32 s54, 64039106
    s_cselect_b32 s54, 454017211, s54
    s_mov_b32 exec_lo, 1040187392
    s_mov_b32 exec_hi, 0
    v_mov_b32 v203, s54
    s_mov_b32 s54, 330320603
    s_cselect_b32 s54, 743654643, s54
    s_mov_b32 exec_lo, 3221225472
    s_mov_b32 exec_hi, 7
    v_mov_b32 v203, s54
    s_mov_b32 s54, 217139484
    s_cselect_b32 s54, 607143691, s54
    s_mov_b32 exec_lo, 0
    s_mov_b32 exec_hi, 248
    v_mov_b32 v203, s54
    s_mov_b64 exec, -1
    v_mul_u32_u24 v11, 52, v1
    v_lshrrev_b32 v11, 8, v11
    v_mad_i32_i24 v11, v11, -5, v1
    v_mul_u32_u24 v11, 6, v11
    v_lshrrev_b32 v203, v11, v203
    v_and_b32 v11, 7, v203
    v_bfe_u32 v203, v203, 3, 3
    v_lshlrev_b32 v11, 12, v11
    v_lshl_or_b32 v203, v203, 7, v11
    s_add_u32 s24, s14, 1048576
    s_addc_u32 s25, s15, 0
    s_mov_b32 s26, 3932160
    s_mov_b32 s27, 0x20000
    v_mov_b32 v16, 0
    v_mov_b32 v17, 0
    v_mov_b32 v18, 0
    v_mov_b32 v19, 0
    v_mov_b32 v20, 0
    v_mov_b32 v21, 0
    v_mov_b32 v22, 0
    v_mov_b32 v23, 0
    v_mov_b32 v24, 0
    v_mov_b32 v25, 0
    v_mov_b32 v26, 0
    v_mov_b32 v27, 0
    v_mov_b32 v28, 0
    v_mov_b32 v29, 0
    v_mov_b32 v30, 0
    v_mov_b32 v31, 0
    v_mov_b32 v32, 0
    v_mov_b32 v33, 0
    v_mov_b32 v34, 0
    v_mov_b32 v35, 0
    v_mov_b32 v36, 0
    v_mov_b32 v37, 0
    v_mov_b32 v38, 0
    v_mov_b32 v39, 0
    v_mov_b32 v40, 0
    v_mov_b32 v41, 0
    v_mov_b32 v42, 0
    v_mov_b32 v43, 0
    v_mov_b32 v44, 0
    v_mov_b32 v45, 0
    v_mov_b32 v46, 0
    v_mov_b32 v47, 0
    v_mov_b32 v48, 0
    v_mov_b32 v49, 0
    v_mov_b32 v50, 0
    v_mov_b32 v51, 0
    v_mov_b32 v52, 0
    v_mov_b32 v53, 0
    v_mov_b32 v54, 0
    v_mov_b32 v55, 0
    v_mov_b32 v56, 0
    v_mov_b32 v57, 0
    v_mov_b32 v58, 0
    v_mov_b32 v59, 0
    v_mov_b32 v60, 0
    v_mov_b32 v61, 0
    v_mov_b32 v62, 0
    v_mov_b32 v63, 0
    s_lshl_b32 s54, s2, 3
    s_add_u32 s54, s54, s3
    s_lshl_b32 s54, s54, 8
    s_mov_b32 s16, s64
    s_mov_b32 s17, s65
    s_mov_b32 s18, 10240000
    s_mov_b32 s19, 0x20000
    s_add_u32 s28, s14, 5242880
    s_addc_u32 s29, s15, 0
    s_mov_b32 s30, 10485760
    s_mov_b32 s31, 0x20000
    s_and_b32 s51, s2, 7
    s_mul_i32 s51, s51, 1282048
    s_and_b32 s55, s2, 0xf8
    s_add_u32 s55, s55, s3
    s_mul_i32 s55, s55, 2304
    s_add_u32 s51, s51, s55
    v_min_u32 v14, 17, v1
    v_lshlrev_b32 v14, 7, v14
    s_waitcnt vmcnt(0)
    s_barrier
    s_mov_b64 exec, 0xffff
    buffer_store_dwordx4 v[112:115], v2, s[20:23], s54 offen sc1
    s_mov_b64 exec, -1
    buffer_load_dword v7, v14, s[16:19], s51 offen
    s_lshl_b32 s54, s45, 10
    s_add_u32 s40, s12, s54
    s_addc_u32 s41, s13, 0
    s_lshl_b32 s42, s46, 10
    s_mov_b32 s43, 0x20000
    v_lshrrev_b32 v8, 5, v1
    v_lshlrev_b32 v8, 10, v8
    v_and_b32 v9, 15, v1
    v_lshl_add_u32 v8, v9, 4, v8
    ds_read_b128 v[64:67], v8 offset:17408
    ds_read_b128 v[68:71], v8 offset:17664
    ds_read_b128 v[72:75], v8 offset:17920
    ds_read_b128 v[76:79], v8 offset:18176
    ds_read_b128 v[80:83], v8 offset:19456
    ds_read_b128 v[84:87], v8 offset:19712
    ds_read_b128 v[88:91], v8 offset:19968
    ds_read_b128 v[92:95], v8 offset:20224
    v_lshrrev_b32 v8, 4, v1
    v_lshlrev_b32 v8, 5, v8
    v_and_b32 v9, 3, v1
    v_lshl_add_u32 v8, v9, 1, v8
    ds_read_u16 v96, v8 offset:21504
    ds_read_u16 v97, v8 offset:21512
    ds_read_u16 v98, v8 offset:21520
    ds_read_u16 v99, v8 offset:21528
    v_bfe_i32 v10, v1, 4, 1
    v_and_b32 v10, 0x02020202, v10
    v_add_u32 v10, 0x05040100, v10
    s_waitcnt lgkmcnt(0)
    v_perm_b32 v172, v68, v64, v10
    v_perm_b32 v174, v76, v72, v10
    v_perm_b32 v176, v84, v80, v10
    v_perm_b32 v178, v92, v88, v10
    v_perm_b32 v173, v69, v65, v10
    v_perm_b32 v175, v77, v73, v10
    v_perm_b32 v177, v85, v81, v10
    v_perm_b32 v179, v93, v89, v10
    v_perm_b32 v180, v70, v66, v10
    v_perm_b32 v182, v78, v74, v10
    v_perm_b32 v184, v86, v82, v10
    v_perm_b32 v186, v94, v90, v10
    v_perm_b32 v181, v71, v67, v10
    v_perm_b32 v183, v79, v75, v10
    v_perm_b32 v185, v87, v83, v10
    v_perm_b32 v187, v95, v91, v10
    v_lshl_or_b32 v188, v97, 16, v96
    v_lshl_or_b32 v189, v99, 16, v98
    v_and_b32 v9, 7, v1
    v_lshrrev_b32 v8, 4, v1
    v_lshlrev_b32 v8, 13, v8
    v_lshl_add_u32 v8, v9, 4, v8
    v_and_b32 v9, 8, v1
    s_and_b32 s72, s3, 3
    s_lshl_b32 s72, s72, 8
    s_lshr_b32 s73, s3, 2
    s_lshl_b32 s73, s73, 7
    s_add_u32 s72, s72, s73
    s_add_u32 s72, s72, 46080
    v_add3_u32 v8, v8, v9, s72
    ds_read2st64_b64 v[128:131], v8 offset0:0 offset1:2
    ds_read2st64_b64 v[132:135], v8 offset0:4 offset1:6
    ds_read2st64_b64 v[136:139], v8 offset0:8 offset1:10
    ds_read2st64_b64 v[140:143], v8 offset0:12 offset1:14
    s_mov_b32 s72, 0x05040100
    s_mov_b32 s73, 0x07060302
    s_waitcnt lgkmcnt(3)
    v_perm_b32 v144, v130, v128, s72
    v_perm_b32 v148, v130, v128, s73
    v_perm_b32 v152, v131, v129, s72
    v_perm_b32 v156, v131, v129, s73
    s_waitcnt lgkmcnt(2)
    v_perm_b32 v145, v134, v132, s72
    v_perm_b32 v149, v134, v132, s73
    v_perm_b32 v153, v135, v133, s72
    v_perm_b32 v157, v135, v133, s73
    s_waitcnt lgkmcnt(1)
    v_perm_b32 v146, v138, v136, s72
    v_perm_b32 v150, v138, v136, s73
    v_perm_b32 v154, v139, v137, s72
    v_perm_b32 v158, v139, v137, s73
    s_waitcnt lgkmcnt(0)
    v_perm_b32 v147, v142, v140, s72
    v_perm_b32 v151, v142, v140, s73
    v_perm_b32 v155, v143, v141, s72
    v_perm_b32 v159, v143, v141, s73
    s_lshl_b32 s54, s3, 12
    v_add_u32 v8, s54, v2
    v_lshrrev_b32 v9, 1, v0
    v_lshlrev_b32 v10, 11, v9
    s_lshl_b32 s49, s44, 3
    v_mul_u32_u24 v5, 1280, v9
    s_mov_b32 s48, 0
    s_mov_b32 s53, 200000
    s_mov_b32 s55, 0xffc00000
    s_mul_i32 s52, s3, 7168
    s_add_u32 s52, s52, 101376
    s_movk_i32 s98, 4096
    s_waitcnt vmcnt(0)
    s_barrier
    buffer_load_dwordx2 v[206:207], v10, s[20:23], s49 offen sc1
    ds_write_b128 v8, v[144:147] offset:46080
    ds_write_b128 v8, v[148:151] offset:47104
    ds_write_b128 v8, v[152:155] offset:48128
    ds_write_b128 v8, v[156:159] offset:49152
    s_waitcnt vmcnt(0)
    v_xor_b32 v11, s63, v206
    v_xor_b32 v12, s62, v207
    v_and_or_b32 v11, v11, s55, v12
    v_cmpx_ne_u32 vcc, 0, v11
    s_cbranch_execnz L_poll
L_polled:
    s_mov_b64 exec, -1
    v_bfe_u32 v3, v206, 11, 11
    v_and_b32 v4, v3, v240
    v_add_u32 v10, v3, v240
    v_and_b32 v11, 0x7ff, v206
    v_add_u32_dpp v4, v4, v4 row_shr:1 row_mask:0xf bank_mask:0xf
    v_cmp_lt_i32 s[64:65], 0, v10
    v_cmp_lt_i32 s[66:67], 2, v10
    v_add_u32_dpp v4, v4, v4 row_shr:2 row_mask:0xf bank_mask:0xf
    v_cmp_lt_i32 s[68:69], 4, v10
    v_cmp_lt_i32 s[70:71], 6, v10
    v_add_u32_dpp v4, v4, v4 row_shr:4 row_mask:0xf bank_mask:0xf
    v_cmp_lt_i32 s[72:73], 8, v10
    v_cmp_lt_i32 s[74:75], 10, v10
    v_add_u32_dpp v4, v4, v4 row_shr:8 row_mask:0xf bank_mask:0xf
    v_cmp_lt_i32 s[76:77], 12, v10
    v_cmp_lt_i32 s[78:79], 14, v10
    v_add_u32_dpp v4, v4, v4 row_bcast:15 row_mask:0xa bank_mask:0xf
    v_add_u32 v5, v5, v11
    s_nop 0
    v_add_u32_dpp v4, v4, v4 row_bcast:31 row_mask:0xc bank_mask:0xf
    s_nop 0
    v_readlane_b32 s95, v4, 63
    v_mov_b32_dpp v4, v4 quad_perm:[0,0,2,2] row_mask:0xf bank_mask:0xf
    v_sub_u32 v5, v5, v4
    v_lshl_add_u32 v8, v4, 2, v241
    s_cmp_gt_u32 s95, 224
    s_cbranch_scc1 L_clip
L_mapw:
    s_mov_b64 exec, s[64:65]
    ds_write_b32 v8, v5 offset:0
    s_mov_b64 exec, s[66:67]
    ds_write_b32 v8, v5 offset:8
    s_mov_b64 exec, s[68:69]
    ds_write_b32 v8, v5 offset:16
    s_mov_b64 exec, s[70:71]
    ds_write_b32 v8, v5 offset:24
    s_mov_b64 exec, s[72:73]
    ds_write_b32 v8, v5 offset:32
    s_mov_b64 exec, s[74:75]
    ds_write_b32 v8, v5 offset:40
    s_mov_b64 exec, s[76:77]
    ds_write_b32 v8, v5 offset:48
    s_mov_b64 exec, -1
    s_cmp_lg_u64 s[78:79], 0
    s_cbranch_scc1 L_map2
    ds_read_b32 v64, v242 offset:0
    ds_read_b32 v65, v242 offset:256
    ds_read_b32 v66, v242 offset:512
    ds_read_b32 v68, v243 offset:0
    ds_read_b32 v69, v243 offset:128
    ds_read_b32 v70, v243 offset:256
    ds_read_b32 v71, v243 offset:384
    ds_read_b32 v72, v243 offset:512
    ds_read_b32 v73, v243 offset:640
    s_cmp_gt_i32 s95, 192
    s_cbranch_scc1 L_r1
L_r1b:
    s_waitcnt lgkmcnt(6)
    v_mad_u32_u24 v64, v64, 12, v244
    buffer_load_dwordx3 v[76:78], v64, s[24:27], 0 offen offset:0 sc1
    v_mad_u32_u24 v65, v65, 12, v244
    buffer_load_dwordx3 v[80:82], v65, s[24:27], 0 offen offset:768 sc1
    v_mad_u32_u24 v66, v66, 12, v244
    buffer_load_dwordx3 v[84:86], v66, s[24:27], 0 offen offset:1536 sc1
    v_mov_b32 v11, s95
    s_mov_b64 exec, 1
    ds_max_i32 v13, v11 offset:15360
    s_mov_b64 exec, -1
    s_waitcnt lgkmcnt(1)
    v_lshl_add_u32 v68, v68, 5, v2
    v_lshl_add_u32 v69, v69, 5, v2
    v_lshl_add_u32 v70, v70, 5, v2
    v_lshl_add_u32 v71, v71, 5, v2
    v_lshl_add_u32 v72, v72, 5, v2
    v_lshl_add_u32 v73, v73, 5, v2
    s_barrier
    s_add_u32 m0, s52, 0
    s_nop 0
    buffer_load_dwordx4 v68, s[28:31], 0 offen offset:0 sc1 lds
    v_add_u32 v11, 0, v1
    v_cmp_gt_i32 s[80:81], s95, v11
    v_add_u32 v11, 64, v1
    v_cmp_gt_i32 s[82:83], s95, v11
    v_add_u32 v11, 128, v1
    v_cmp_gt_i32 s[84:85], s95, v11
    v_add_u32 v11, 192, v1
    v_cmp_gt_i32 s[96:97], s95, v11
    s_mov_b32 s55, 0x1fff80
    s_mul_i32 s61, s3, 5
    s_mov_b32 s97, 0
    s_waitcnt vmcnt(3)
    v_lshrrev_b32 v132, 21, v78
    v_lshlrev_b32 v132, 2, v132
    v_lshrrev_b32 v11, 26, v78
    v_lshl_or_b32 v11, v11, 4, v245
    s_mov_b64 exec, s[80:81]
    ds_add_rtn_u32 v128, v132, v6 offset:8192
    ds_add_u32 v11, v6 offset:14336
    s_mov_b64 exec, -1
    s_waitcnt vmcnt(2)
    v_lshrrev_b32 v133, 21, v82
    v_lshlrev_b32 v133, 2, v133
    v_lshrrev_b32 v11, 26, v82
    v_lshl_or_b32 v11, v11, 4, v245
    s_mov_b64 exec, s[82:83]
    ds_add_rtn_u32 v129, v133, v6 offset:8192
    ds_add_u32 v11, v6 offset:14336
    s_mov_b64 exec, -1
    s_waitcnt vmcnt(1)
    v_lshrrev_b32 v134, 21, v86
    v_lshlrev_b32 v134, 2, v134
    v_lshrrev_b32 v11, 26, v86
    v_lshl_or_b32 v11, v11, 4, v245
    s_mov_b64 exec, s[84:85]
    ds_add_rtn_u32 v130, v134, v6 offset:8192
    ds_add_u32 v11, v6 offset:14336
    s_mov_b64 exec, -1
    s_cmp_gt_i32 s95, 192
    s_cbranch_scc1 L_r2
L_r2b:
    ds_write_b64 v246, v[76:77] offset:0
    v_and_or_b32 v78, v78, s55, v247
    ds_write_b64 v246, v[80:81] offset:512
    v_and_or_b32 v82, v82, s55, v247
    v_add_u32 v82, 134217728, v82
    ds_write_b64 v246, v[84:85] offset:1024
    v_and_or_b32 v86, v86, s55, v247
    v_add_u32 v86, 268435456, v86
    s_add_u32 m0, s52, 0
    s_nop 0
    buffer_load_dwordx4 v69, s[28:31], 0 offen offset:1024 sc1 lds
    s_add_u32 m0, s52, 0
    s_nop 0
    buffer_load_dwordx4 v70, s[28:31], 0 offen offset:2048 sc1 lds
    s_waitcnt lgkmcnt(3)
    s_barrier
    s_cmp_lg_u32 s48, 0
    s_cbranch_scc1 L_rank2
    ds_read_b128 v[104:107], v2 offset:14336
    ds_read_b32 v96, v248 offset:8192
    ds_read_b32 v97, v248 offset:8320
    ds_read_b32 v98, v248 offset:8448
    ds_read_b32 v99, v248 offset:8576
    ds_read_b32 v100, v248 offset:8704
    ds_read_b32 v14, v13 offset:15360
    s_add_u32 s65, s61, 1
    s_add_u32 s66, s61, 2
    s_add_u32 s67, s61, 3
    s_add_u32 s68, s61, 4
    s_waitcnt lgkmcnt(6)
    v_add_u32 v9, v104, v105
    v_add3_u32 v9, v9, v106, v107
    v_lshl_or_b32 v9, v9, 6, v249
    s_nop 0
    v_readlane_b32 s64, v9, s61
    v_readlane_b32 s65, v9, s65
    v_readlane_b32 s66, v9, s66
    v_readlane_b32 s67, v9, s67
    v_readlane_b32 s68, v9, s68
    v_cmp_lt_u32 s[70:71], s64, v9
    v_cmp_lt_u32 s[72:73], s65, v9
    v_cmp_lt_u32 s[74:75], s66, v9
    v_cmp_lt_u32 s[76:77], s67, v9
    v_cmp_lt_u32 s[78:79], s68, v9
    s_bcnt1_i32_b64 s64, s[70:71]
    s_bcnt1_i32_b64 s65, s[72:73]
    s_bcnt1_i32_b64 s66, s[74:75]
    s_bcnt1_i32_b64 s67, s[76:77]
    s_bcnt1_i32_b64 s68, s[78:79]
    s_waitcnt lgkmcnt(0)
    v_readlane_b32 s90, v203, s64
    v_readlane_b32 s91, v203, s65
    v_readlane_b32 s92, v203, s66
    v_readlane_b32 s93, v203, s67
    v_readlane_b32 s94, v203, s68
    v_readfirstlane_b32 s47, v14
L_ranked:
    s_mov_b32 exec_hi, 0
    s_and_b32 s54, s90, 0x380
    v_add_u32 v104, s54, v250
    ds_add_rtn_u32 v96, v104, v96 offset:13312
    s_and_b32 s54, s91, 0x380
    v_add_u32 v105, s54, v250
    ds_add_rtn_u32 v97, v105, v97 offset:13312
    s_and_b32 s54, s92, 0x380
    v_add_u32 v106, s54, v250
    ds_add_rtn_u32 v98, v106, v98 offset:13312
    s_and_b32 s54, s93, 0x380
    v_add_u32 v107, s54, v250
    ds_add_rtn_u32 v99, v107, v99 offset:13312
    s_and_b32 s54, s94, 0x380
    v_add_u32 v108, s54, v250
    ds_add_rtn_u32 v100, v108, v100 offset:13312
    v_or_b32 v104, s90, v104
    v_or_b32 v105, s91, v105
    v_or_b32 v106, s92, v106
    v_or_b32 v107, s93, v107
    v_or_b32 v108, s94, v108
    v_writelane_b32 v11, s90, 0
    v_writelane_b32 v11, s91, 1
    v_writelane_b32 v11, s92, 2
    v_writelane_b32 v11, s93, 3
    v_writelane_b32 v11, s94, 4
    s_waitcnt lgkmcnt(4)
    v_lshl_or_b32 v96, v96, 16, v104
    ds_write_b32 v248, v96 offset:8192
    s_waitcnt lgkmcnt(4)
    v_lshl_or_b32 v97, v97, 16, v105
    ds_write_b32 v248, v97 offset:8320
    s_waitcnt lgkmcnt(4)
    v_lshl_or_b32 v98, v98, 16, v106
    ds_write_b32 v248, v98 offset:8448
    s_waitcnt lgkmcnt(4)
    v_lshl_or_b32 v99, v99, 16, v107
    ds_write_b32 v248, v99 offset:8576
    s_waitcnt lgkmcnt(4)
    v_lshl_or_b32 v100, v100, 16, v108
    ds_write_b32 v248, v100 offset:8704
    v_add_lshl_u32 v12, v1, s61, 7
    v_lshrrev_b32 v9, 10, v11
    v_bfe_u32 v11, v11, 2, 8
    v_or_b32 v11, v11, v9
    s_mov_b32 exec_lo, 31
    ds_write_b32 v11, v12 offset:15616
    s_mov_b64 exec, -1
    s_add_u32 m0, s52, 0
    s_nop 0
    buffer_load_dwordx4 v71, s[28:31], 0 offen offset:3072 sc1 lds
    s_add_u32 m0, s52, 4096
    s_nop 0
    buffer_load_dwordx4 v72, s[28:31], s98 offen offset:0 sc1 lds
    s_add_u32 m0, s52, 4096
    s_nop 0
    buffer_load_dwordx4 v73, s[28:31], s98 offen offset:1024 sc1 lds
    s_lshl_b32 s54, s3, 3
    s_add_u32 s55, s54, 7
    s_waitcnt lgkmcnt(0)
    s_barrier
    ds_read_b128 v[96:99], v2 offset:13312
    ds_read_b32 v132, v132 offset:8192
    ds_read_b32 v133, v133 offset:8192
    ds_read_b32 v134, v134 offset:8192
    ds_read_b32 v11, v251 offset:15616
    s_waitcnt lgkmcnt(4)
    v_add_u32 v9, v96, v97
    v_add3_u32 v9, v9, v98, v99
    v_mov_b32 v10, v9
    s_waitcnt lgkmcnt(1)
    v_bfe_u32 v15, v132, 12, 3
    v_add_u32_dpp v10, v10, v10 row_shr:1 row_mask:0xf bank_mask:0xf
    v_or_b32 v78, v15, v78
    v_and_b32 v64, 0x3ff, v132
    v_add_u32_dpp v10, v10, v10 row_shr:2 row_mask:0xf bank_mask:0xf
    v_lshrrev_b32 v132, 16, v132
    v_add_u32 v132, v132, v128
    v_add_u32_dpp v10, v10, v10 row_shr:4 row_mask:0xf bank_mask:0xf
    v_bfe_u32 v15, v133, 12, 3
    v_or_b32 v82, v15, v82
    v_add_u32_dpp v10, v10, v10 row_shr:8 row_mask:0xf bank_mask:0xf
    v_and_b32 v65, 0x3ff, v133
    v_lshrrev_b32 v133, 16, v133
    v_add_u32_dpp v10, v10, v10 row_bcast:15 row_mask:0xa bank_mask:0xf
    v_add_u32 v133, v133, v129
    v_bfe_u32 v15, v134, 12, 3
    v_add_u32_dpp v10, v10, v10 row_bcast:31 row_mask:0xc bank_mask:0xf
    v_or_b32 v86, v15, v86
    v_and_b32 v66, 0x3ff, v134
    v_sub_u32 v9, v10, v9
    v_lshl_add_u32 v104, v9, 2, v252
    v_lshl_add_u32 v105, v96, 2, v104
    v_lshl_add_u32 v106, v97, 2, v105
    v_lshl_add_u32 v107, v98, 2, v106
    ds_write_b128 v2, v[104:107] offset:16384
    ds_read_b32 v64, v64 offset:16384
    ds_read_b32 v65, v65 offset:16384
    ds_read_b32 v66, v66 offset:16384
    v_lshrrev_b32 v134, 16, v134
    v_add_u32 v134, v134, v130
    v_readlane_b32 s50, v10, s55
    v_readlane_b32 s53, v9, s54
    v_readlane_b32 s51, v104, s54
    v_mov_b32 v12, 2097029
    s_sub_u32 s50, s50, s53
    s_lshl_b32 s54, s50, 2
    v_add_u32 v198, s51, v201
    v_add_u32 v199, s51, v202
    v_add_u32 v9, s54, v198
    s_waitcnt lgkmcnt(2)
    v_lshl_add_u32 v132, v132, 2, v64
    s_mov_b64 exec, s[80:81]
    ds_write_b32 v132, v78
    s_mov_b64 exec, -1
    s_waitcnt lgkmcnt(2)
    v_lshl_add_u32 v133, v133, 2, v65
    s_mov_b64 exec, s[82:83]
    ds_write_b32 v133, v82
    s_mov_b64 exec, -1
    s_waitcnt lgkmcnt(2)
    v_lshl_add_u32 v134, v134, 2, v66
    s_mov_b64 exec, s[84:85]
    ds_write_b32 v134, v86
    s_mov_b64 exec, -1
    ds_write_b32 v9, v12
    s_cmp_gt_i32 s95, 192
    s_cbranch_scc1 L_r3
L_r3b:
    v_readlane_b32 s56, v11, 0
    v_readlane_b32 s57, v11, 1
    v_readlane_b32 s58, v11, 2
    v_readlane_b32 s59, v11, 3
    v_readlane_b32 s60, v11, 4
    v_lshlrev_b32 v8, 2, v1
    s_mul_i32 s54, s56, 9
    v_add_u32 v208, s54, v8
    s_mul_i32 s54, s57, 9
    v_add_u32 v209, s54, v8
    s_mul_i32 s54, s58, 9
    v_add_u32 v210, s54, v8
    s_mul_i32 s54, s59, 9
    v_add_u32 v211, s54, v8
    s_mul_i32 s54, s60, 9
    v_add_u32 v212, s54, v8
    s_lshr_b32 s99, s3, 1
    s_mul_i32 s99, s99, 3
    s_min_u32 s99, s99, 8
    s_mul_i32 s55, s99, 4608
    v_and_b32 v8, 15, v1
    v_lshrrev_b32 v9, 4, v1
    v_mul_u32_u24 v213, 288, v8
    v_lshl_add_u32 v213, v9, 4, v213
    v_add_u32 v213, s55, v213
    v_lshrrev_b32 v9, 3, v1
    v_lshlrev_b32 v9, 9, v9
    v_and_b32 v8, 7, v1
    v_lshl_add_u32 v214, v8, 4, v9
    s_lshl_b32 s99, s99, 12
    s_and_b32 s55, s3, 1
    s_lshl_b32 s54, s55, 7
    s_add_u32 s99, s99, s54
    s_lshl_b32 s55, s55, 14
    s_add_u32 s55, s55, 46080
    v_add_u32 v215, s55, v2
    v_mov_b32 v64, 0
    v_mov_b32 v65, 0
    v_mov_b32 v66, 0
    v_mov_b32 v67, 0
    v_mov_b32 v68, 0
    v_mov_b32 v69, 0
    v_mov_b32 v70, 0
    v_mov_b32 v71, 0
    v_mov_b32 v72, 0
    v_mov_b32 v73, 0
    v_mov_b32 v74, 0
    v_mov_b32 v75, 0
    v_mov_b32 v76, 0
    v_mov_b32 v77, 0
    v_mov_b32 v78, 0
    v_mov_b32 v79, 0
    v_mov_b32 v80, 0
    v_mov_b32 v81, 0
    v_mov_b32 v82, 0
    v_mov_b32 v83, 0
    v_mov_b32 v84, 0
    v_mov_b32 v85, 0
    v_mov_b32 v86, 0
    v_mov_b32 v87, 0
    v_mov_b32 v88, 0
    v_mov_b32 v89, 0
    v_mov_b32 v90, 0
    v_mov_b32 v91, 0
    v_mov_b32 v92, 0
    v_mov_b32 v93, 0
    v_mov_b32 v94, 0
    v_mov_b32 v95, 0
    ds_read_b128 v[216:219], v215 offset:0
    ds_read_b128 v[220:223], v215 offset:1024
    ds_read_b128 v[224:227], v215 offset:2048
    ds_read_b128 v[228:231], v215 offset:3072
    ds_read_b128 v[232:235], v215 offset:4096
    ds_read_b128 v[236:239], v215 offset:5120
    s_add_u32 s54, s50, 1
    s_and_b32 s54, s54, -2
    s_add_u32 s53, s54, 15
    s_lshr_b32 s53, s53, 4
    s_sub_u32 s54, 0, s54
    s_and_b32 s54, s54, 15
    s_sub_u32 s53, s53, 1
    s_cmp_gt_i32 s53, 0
    s_cselect_b32 s54, s54, 0
    s_lshl_b32 s61, s54, 2
    v_subrev_u32 v198, s61, v198
    v_subrev_u32 v199, s61, v199
    s_and_b32 s61, s61, 32
    v_add_u32 v12, s61, v198
    s_and_b32 s72, s54, 6
    s_mov_b32 s55, 0x00fffc38
    s_mov_b32 s49, 0xffffff00
    s_mov_b32 s51, 87040
    s_cmp_lt_u32 s3, 4
    s_cbranch_scc1 L_np
    s_setprio 1
L_np:
    s_waitcnt vmcnt(0) lgkmcnt(0)
    s_barrier
    ds_read_b32 v196, v12
    ds_read_b32 v194, v199
    ds_read_b32 v197, v198 offset:24
    s_cmp_eq_u32 s50, 0
    s_cbranch_scc1 L_swept
    s_waitcnt lgkmcnt(1)
    v_lshlrev_b32 v196, 3, v196
    v_and_b32 v196, s55, v196
    v_lshrrev_b32 v8, 21, v194
    v_lshl_add_u32 v11, v8, 3, s51
    v_lshl_add_u32 v8, v8, 5, v200
    ds_read_b64 v[192:193], v11
    ds_read_b128 v[164:167], v8
    s_cmp_eq_u32 s72, 2
    s_cbranch_scc1 L_p2
    s_cmp_eq_u32 s72, 4
    s_cbranch_scc1 L_p4
    s_cmp_eq_u32 s72, 6
    s_cbranch_scc1 L_p6
L_p0:
    v_readlane_b32 s64, v196, 0
    v_readlane_b32 s65, v196, 1
    s_and_b32 s61, s64, s49
    buffer_load_dwordx4 v[96:99], v2, s[16:19], s61 offen
    s_and_b32 s61, s65, s49
    buffer_load_dwordx4 v[100:103], v2, s[16:19], s61 offen
L_p2:
    v_readlane_b32 s66, v196, 2
    v_readlane_b32 s67, v196, 3
    s_and_b32 s61, s66, s49
    buffer_load_dwordx4 v[104:107], v2, s[16:19], s61 offen
    s_and_b32 s61, s67, s49
    buffer_load_dwordx4 v[108:111], v2, s[16:19], s61 offen
L_p4:
    v_readlane_b32 s68, v196, 4
    v_readlane_b32 s69, v196, 5
    s_and_b32 s61, s68, s49
    buffer_load_dwordx4 v[112:115], v2, s[16:19], s61 offen
    s_and_b32 s61, s69, s49
    buffer_load_dwordx4 v[116:119], v2, s[16:19], s61 offen
    s_cmp_eq_u32 s72, 0
    s_cbranch_scc1 L_pd
L_p6:
    v_readlane_b32 s70, v196, 6
    v_readlane_b32 s71, v196, 7
    s_and_b32 s61, s70, s49
    buffer_load_dwordx4 v[120:123], v2, s[16:19], s61 offen
    s_and_b32 s61, s71, s49
    buffer_load_dwordx4 v[124:127], v2, s[16:19], s61 offen
    s_cmp_eq_u32 s72, 2
    s_cbranch_scc1 L_pd
L_p8:
    v_readlane_b32 s64, v196, 8
    v_readlane_b32 s65, v196, 9
    s_and_b32 s61, s64, s49
    buffer_load_dwordx4 v[96:99], v2, s[16:19], s61 offen
    s_and_b32 s61, s65, s49
    buffer_load_dwordx4 v[100:103], v2, s[16:19], s61 offen
    s_cmp_eq_u32 s72, 4
    s_cbranch_scc1 L_pd
L_p10:
    v_readlane_b32 s66, v196, 10
    v_readlane_b32 s67, v196, 11
    s_and_b32 s61, s66, s49
    buffer_load_dwordx4 v[104:107], v2, s[16:19], s61 offen
    s_and_b32 s61, s67, s49
    buffer_load_dwordx4 v[108:111], v2, s[16:19], s61 offen
L_pd:
    s_waitcnt lgkmcnt(0)
.p2align 3
    v_mfma_f32_4x4x4_16b_bf16 v[144:147], v[192:193], v[188:189], 0 cbsz:4 abid:0
    v_mfma_f32_4x4x4_16b_bf16 v[148:151], v[192:193], v[188:189], 0 cbsz:4 abid:2
    v_mfma_f32_4x4x4_16b_bf16 v[152:155], v[192:193], v[188:189], 0 cbsz:4 abid:4
    v_mfma_f32_4x4x4_16b_bf16 v[156:159], v[192:193], v[188:189], 0 cbsz:4 abid:6
    v_lshlrev_b32 v196, 3, v197
    v_and_b32 v196, s55, v196
    v_add_u32 v198, 64, v198
    v_add_u32 v199, 64, v199
    v_smfmac_f32_32x32x32_bf16 v[64:79], v[164:167], v[172:179], v168
    ds_read_b32 v197, v198 offset:24
    ds_read_b32 v194, v199
    v_smfmac_f32_32x32x32_bf16 v[80:95], v[164:167], v[180:187], v168
    s_set_gpr_idx_on s54, gpr_idx(SRC0,SRC1)
    v_cvt_pk_bf16_f32 v9, v144, v144
    s_set_gpr_idx_off
    v_and_b32 v160, v190, v9
    v_and_b32 v161, v191, v9
    s_waitcnt lgkmcnt(0)
    v_lshrrev_b32 v8, 21, v194
    v_lshl_add_u32 v11, v8, 3, s51
    v_lshl_add_u32 v8, v8, 5, v200
    ds_read_b64 v[192:193], v11
    ds_read_b128 v[164:167], v8
    s_cmp_eq_u32 s53, 0
    s_cbranch_scc1 L_f0
    s_cmp_eq_u32 s54, 0
    s_cbranch_scc1 L_j0
    s_cmp_eq_u32 s54, 2
    s_cbranch_scc1 L_j2
    ds_read_b128 v[64:67], v169
    ds_read_b128 v[80:83], v169
    s_cmp_eq_u32 s54, 4
    s_cbranch_scc1 L_j4
    s_cmp_eq_u32 s54, 6
    s_cbranch_scc1 L_j6
    ds_read_b128 v[68:71], v169
    ds_read_b128 v[84:87], v169
    s_cmp_eq_u32 s54, 8
    s_cbranch_scc1 L_j8
    s_cmp_eq_u32 s54, 10
    s_cbranch_scc1 L_j10
    ds_read_b128 v[72:75], v169
    ds_read_b128 v[88:91], v169
    s_cmp_eq_u32 s54, 12
    s_cbranch_scc1 L_j12
    s_branch L_j14
.p2align 3
L_loop:
    s_waitcnt lgkmcnt(2)
.p2align 3
    v_mfma_f32_4x4x4_16b_bf16 v[144:147], v[192:193], v[188:189], 0 cbsz:4 abid:0
    v_mfma_f32_4x4x4_16b_bf16 v[148:151], v[192:193], v[188:189], 0 cbsz:4 abid:2
    v_mfma_f32_4x4x4_16b_bf16 v[152:155], v[192:193], v[188:189], 0 cbsz:4 abid:4
    v_mfma_f32_4x4x4_16b_bf16 v[156:159], v[192:193], v[188:189], 0 cbsz:4 abid:6
    v_lshlrev_b32 v196, 3, v197
    v_and_b32 v196, s55, v196
    v_add_u32 v198, 64, v198
    v_add_u32 v199, 64, v199
    s_waitcnt lgkmcnt(0)
.p2align 3
    v_smfmac_f32_32x32x32_bf16 v[64:79], v[164:167], v[172:179], v168
    ds_read_b32 v197, v198 offset:24
    ds_read_b32 v194, v199
    v_cvt_pk_bf16_f32 v9, v144, v144
    v_and_b32 v160, v190, v9
    v_and_b32 v161, v191, v9
    v_smfmac_f32_32x32x32_bf16 v[80:95], v[164:167], v[180:187], v168
L_j0:
    s_waitcnt vmcnt(5)
.p2align 3
    v_mfma_f32_16x16x16_bf16 v[128:131], v[160:161], v[96:97], 0
    v_readlane_b32 s70, v196, 0
    v_cvt_pk_bf16_f32 v10, v145, v145
    v_mfma_f32_16x16x16_bf16 v[132:135], v[160:161], v[98:99], 0
    v_and_b32 v162, v190, v10
    v_and_b32 v163, v191, v10
    s_and_b32 s61, s70, s49
    s_waitcnt vmcnt(4)
    buffer_load_dwordx4 v[120:123], v2, s[16:19], s61 offen
    v_mfma_f32_16x16x16_bf16 v[136:139], v[162:163], v[100:101], 0
    v_readlane_b32 s71, v196, 1
    v_cvt_pk_bf16_f32 v9, v146, v146
    v_mfma_f32_16x16x16_bf16 v[140:143], v[162:163], v[102:103], 0
    v_and_b32 v160, v190, v9
    v_and_b32 v161, v191, v9
    s_and_b32 s61, s71, s49
    s_set_gpr_idx_on s64, gpr_idx(SRC2,DST)
    buffer_load_dwordx4 v[124:127], v2, s[16:19], s61 offen
    v_pk_fma_f32 v[16:17], v[128:129], v[64:65], v[16:17] op_sel_hi:[1,0,1]
    v_pk_fma_f32 v[18:19], v[130:131], v[64:65], v[18:19] op_sel_hi:[1,0,1]
    v_pk_fma_f32 v[20:21], v[132:133], v[80:81], v[20:21] op_sel_hi:[1,0,1]
    v_pk_fma_f32 v[22:23], v[134:135], v[80:81], v[22:23] op_sel_hi:[1,0,1]
    s_set_gpr_idx_idx s65
.p2align 3
    v_pk_fma_f32 v[16:17], v[136:137], v[64:65], v[16:17] op_sel:[0,1,0] op_sel_hi:[1,1,1]
    v_pk_fma_f32 v[18:19], v[138:139], v[64:65], v[18:19] op_sel:[0,1,0] op_sel_hi:[1,1,1]
    v_pk_fma_f32 v[20:21], v[140:141], v[80:81], v[20:21] op_sel:[0,1,0] op_sel_hi:[1,1,1]
    v_pk_fma_f32 v[22:23], v[142:143], v[80:81], v[22:23] op_sel:[0,1,0] op_sel_hi:[1,1,1]
    s_set_gpr_idx_off
L_j2:
    s_waitcnt vmcnt(5)
.p2align 3
    v_mfma_f32_16x16x16_bf16 v[128:131], v[160:161], v[104:105], 0
    v_readlane_b32 s64, v196, 2
    v_cvt_pk_bf16_f32 v10, v147, v147
    v_mfma_f32_16x16x16_bf16 v[132:135], v[160:161], v[106:107], 0
    v_and_b32 v162, v190, v10
    v_and_b32 v163, v191, v10
    s_and_b32 s61, s64, s49
    s_waitcnt vmcnt(4)
    buffer_load_dwordx4 v[96:99], v2, s[16:19], s61 offen
    v_mfma_f32_16x16x16_bf16 v[136:139], v[162:163], v[108:109], 0
    v_readlane_b32 s65, v196, 3
    v_cvt_pk_bf16_f32 v9, v148, v148
    v_mfma_f32_16x16x16_bf16 v[140:143], v[162:163], v[110:111], 0
    v_and_b32 v160, v190, v9
    v_and_b32 v161, v191, v9
    s_waitcnt lgkmcnt(0)
    v_lshrrev_b32 v8, 21, v194
    v_lshl_add_u32 v11, v8, 3, s51
    v_lshl_add_u32 v8, v8, 5, v200
    ds_read_b64 v[192:193], v11
    ds_read_b128 v[164:167], v8
.p2align 3
    s_and_b32 s61, s65, s49
    s_set_gpr_idx_on s66, gpr_idx(SRC2,DST)
    buffer_load_dwordx4 v[100:103], v2, s[16:19], s61 offen
    v_pk_fma_f32 v[16:17], v[128:129], v[66:67], v[16:17] op_sel_hi:[1,0,1]
    v_pk_fma_f32 v[18:19], v[130:131], v[66:67], v[18:19] op_sel_hi:[1,0,1]
    v_pk_fma_f32 v[20:21], v[132:133], v[82:83], v[20:21] op_sel_hi:[1,0,1]
    v_pk_fma_f32 v[22:23], v[134:135], v[82:83], v[22:23] op_sel_hi:[1,0,1]
    s_set_gpr_idx_idx s67
.p2align 3
    v_pk_fma_f32 v[16:17], v[136:137], v[66:67], v[16:17] op_sel:[0,1,0] op_sel_hi:[1,1,1]
    v_pk_fma_f32 v[18:19], v[138:139], v[66:67], v[18:19] op_sel:[0,1,0] op_sel_hi:[1,1,1]
    v_pk_fma_f32 v[20:21], v[140:141], v[82:83], v[20:21] op_sel:[0,1,0] op_sel_hi:[1,1,1]
    v_pk_fma_f32 v[22:23], v[142:143], v[82:83], v[22:23] op_sel:[0,1,0] op_sel_hi:[1,1,1]
    ds_read_b128 v[64:67], v169
    ds_read_b128 v[80:83], v169
    s_set_gpr_idx_off
L_j4:
    s_waitcnt vmcnt(5)
.p2align 3
    v_mfma_f32_16x16x16_bf16 v[128:131], v[160:161], v[112:113], 0
    v_readlane_b32 s66, v196, 4
    v_cvt_pk_bf16_f32 v10, v149, v149
    v_mfma_f32_16x16x16_bf16 v[132:135], v[160:161], v[114:115], 0
    v_and_b32 v162, v190, v10
    v_and_b32 v163, v191, v10
    s_and_b32 s61, s66, s49
    s_waitcnt vmcnt(4)
    buffer_load_dwordx4 v[104:107], v2, s[16:19], s61 offen
    v_mfma_f32_16x16x16_bf16 v[136:139], v[162:163], v[116:117], 0
    v_readlane_b32 s67, v196, 5
    v_cvt_pk_bf16_f32 v9, v150, v150
    v_mfma_f32_16x16x16_bf16 v[140:143], v[162:163], v[118:119], 0
    v_and_b32 v160, v190, v9
    v_and_b32 v161, v191, v9
    s_and_b32 s61, s67, s49
    s_set_gpr_idx_on s68, gpr_idx(SRC2,DST)
    buffer_load_dwordx4 v[108:111], v2, s[16:19], s61 offen
    v_pk_fma_f32 v[16:17], v[128:129], v[68:69], v[16:17] op_sel_hi:[1,0,1]
    v_pk_fma_f32 v[18:19], v[130:131], v[68:69], v[18:19] op_sel_hi:[1,0,1]
    v_pk_fma_f32 v[20:21], v[132:133], v[84:85], v[20:21] op_sel_hi:[1,0,1]
    v_pk_fma_f32 v[22:23], v[134:135], v[84:85], v[22:23] op_sel_hi:[1,0,1]
    s_set_gpr_idx_idx s69
.p2align 3
    v_pk_fma_f32 v[16:17], v[136:137], v[68:69], v[16:17] op_sel:[0,1,0] op_sel_hi:[1,1,1]
    v_pk_fma_f32 v[18:19], v[138:139], v[68:69], v[18:19] op_sel:[0,1,0] op_sel_hi:[1,1,1]
    v_pk_fma_f32 v[20:21], v[140:141], v[84:85], v[20:21] op_sel:[0,1,0] op_sel_hi:[1,1,1]
    v_pk_fma_f32 v[22:23], v[142:143], v[84:85], v[22:23] op_sel:[0,1,0] op_sel_hi:[1,1,1]
    s_set_gpr_idx_off
L_j6:
    s_waitcnt vmcnt(5)
.p2align 3
    v_mfma_f32_16x16x16_bf16 v[128:131], v[160:161], v[120:121], 0
    v_readlane_b32 s68, v196, 6
    v_cvt_pk_bf16_f32 v10, v151, v151
    v_mfma_f32_16x16x16_bf16 v[132:135], v[160:161], v[122:123], 0
    v_and_b32 v162, v190, v10
    v_and_b32 v163, v191, v10
    s_and_b32 s61, s68, s49
    s_waitcnt vmcnt(4)
    buffer_load_dwordx4 v[112:115], v2, s[16:19], s61 offen
    v_mfma_f32_16x16x16_bf16 v[136:139], v[162:163], v[124:125], 0
    v_readlane_b32 s69, v196, 7
    v_cvt_pk_bf16_f32 v9, v152, v152
    v_mfma_f32_16x16x16_bf16 v[140:143], v[162:163], v[126:127], 0
    v_and_b32 v160, v190, v9
    v_and_b32 v161, v191, v9
    s_and_b32 s61, s69, s49
    s_set_gpr_idx_on s70, gpr_idx(SRC2,DST)
    buffer_load_dwordx4 v[116:119], v2, s[16:19], s61 offen
    v_pk_fma_f32 v[16:17], v[128:129], v[70:71], v[16:17] op_sel_hi:[1,0,1]
    v_pk_fma_f32 v[18:19], v[130:131], v[70:71], v[18:19] op_sel_hi:[1,0,1]
    v_pk_fma_f32 v[20:21], v[132:133], v[86:87], v[20:21] op_sel_hi:[1,0,1]
    v_pk_fma_f32 v[22:23], v[134:135], v[86:87], v[22:23] op_sel_hi:[1,0,1]
    s_set_gpr_idx_idx s71
.p2align 3
    v_pk_fma_f32 v[16:17], v[136:137], v[70:71], v[16:17] op_sel:[0,1,0] op_sel_hi:[1,1,1]
    v_pk_fma_f32 v[18:19], v[138:139], v[70:71], v[18:19] op_sel:[0,1,0] op_sel_hi:[1,1,1]
    v_pk_fma_f32 v[20:21], v[140:141], v[86:87], v[20:21] op_sel:[0,1,0] op_sel_hi:[1,1,1]
    v_pk_fma_f32 v[22:23], v[142:143], v[86:87], v[22:23] op_sel:[0,1,0] op_sel_hi:[1,1,1]
    ds_read_b128 v[68:71], v169
    ds_read_b128 v[84:87], v169
    s_set_gpr_idx_off
L_j8:
    s_waitcnt vmcnt(5)
.p2align 3
    v_mfma_f32_16x16x16_bf16 v[128:131], v[160:161], v[96:97], 0
    v_readlane_b32 s70, v196, 8
    v_cvt_pk_bf16_f32 v10, v153, v153
    v_mfma_f32_16x16x16_bf16 v[132:135], v[160:161], v[98:99], 0
    v_and_b32 v162, v190, v10
    v_and_b32 v163, v191, v10
    s_and_b32 s61, s70, s49
    s_waitcnt vmcnt(4)
    buffer_load_dwordx4 v[120:123], v2, s[16:19], s61 offen
    v_mfma_f32_16x16x16_bf16 v[136:139], v[162:163], v[100:101], 0
    v_readlane_b32 s71, v196, 9
    v_cvt_pk_bf16_f32 v9, v154, v154
    v_mfma_f32_16x16x16_bf16 v[140:143], v[162:163], v[102:103], 0
    v_and_b32 v160, v190, v9
    v_and_b32 v161, v191, v9
    s_and_b32 s61, s71, s49
    s_set_gpr_idx_on s64, gpr_idx(SRC2,DST)
    buffer_load_dwordx4 v[124:127], v2, s[16:19], s61 offen
    v_pk_fma_f32 v[16:17], v[128:129], v[72:73], v[16:17] op_sel_hi:[1,0,1]
    v_pk_fma_f32 v[18:19], v[130:131], v[72:73], v[18:19] op_sel_hi:[1,0,1]
    v_pk_fma_f32 v[20:21], v[132:133], v[88:89], v[20:21] op_sel_hi:[1,0,1]
    v_pk_fma_f32 v[22:23], v[134:135], v[88:89], v[22:23] op_sel_hi:[1,0,1]
    s_set_gpr_idx_idx s65
.p2align 3
    v_pk_fma_f32 v[16:17], v[136:137], v[72:73], v[16:17] op_sel:[0,1,0] op_sel_hi:[1,1,1]
    v_pk_fma_f32 v[18:19], v[138:139], v[72:73], v[18:19] op_sel:[0,1,0] op_sel_hi:[1,1,1]
    v_pk_fma_f32 v[20:21], v[140:141], v[88:89], v[20:21] op_sel:[0,1,0] op_sel_hi:[1,1,1]
    v_pk_fma_f32 v[22:23], v[142:143], v[88:89], v[22:23] op_sel:[0,1,0] op_sel_hi:[1,1,1]
    s_set_gpr_idx_off
L_j10:
    s_waitcnt vmcnt(5)
.p2align 3
    v_mfma_f32_16x16x16_bf16 v[128:131], v[160:161], v[104:105], 0
    v_readlane_b32 s64, v196, 10
    v_cvt_pk_bf16_f32 v10, v155, v155
    v_mfma_f32_16x16x16_bf16 v[132:135], v[160:161], v[106:107], 0
    v_and_b32 v162, v190, v10
    v_and_b32 v163, v191, v10
    s_and_b32 s61, s64, s49
    s_waitcnt vmcnt(4)
    buffer_load_dwordx4 v[96:99], v2, s[16:19], s61 offen
    v_mfma_f32_16x16x16_bf16 v[136:139], v[162:163], v[108:109], 0
    v_readlane_b32 s65, v196, 11
    v_cvt_pk_bf16_f32 v9, v156, v156
    v_mfma_f32_16x16x16_bf16 v[140:143], v[162:163], v[110:111], 0
    v_and_b32 v160, v190, v9
    v_and_b32 v161, v191, v9
    s_and_b32 s61, s65, s49
    s_set_gpr_idx_on s66, gpr_idx(SRC2,DST)
    buffer_load_dwordx4 v[100:103], v2, s[16:19], s61 offen
    v_pk_fma_f32 v[16:17], v[128:129], v[74:75], v[16:17] op_sel_hi:[1,0,1]
    v_pk_fma_f32 v[18:19], v[130:131], v[74:75], v[18:19] op_sel_hi:[1,0,1]
    v_pk_fma_f32 v[20:21], v[132:133], v[90:91], v[20:21] op_sel_hi:[1,0,1]
    v_pk_fma_f32 v[22:23], v[134:135], v[90:91], v[22:23] op_sel_hi:[1,0,1]
    s_set_gpr_idx_idx s67
.p2align 3
    v_pk_fma_f32 v[16:17], v[136:137], v[74:75], v[16:17] op_sel:[0,1,0] op_sel_hi:[1,1,1]
    v_pk_fma_f32 v[18:19], v[138:139], v[74:75], v[18:19] op_sel:[0,1,0] op_sel_hi:[1,1,1]
    v_pk_fma_f32 v[20:21], v[140:141], v[90:91], v[20:21] op_sel:[0,1,0] op_sel_hi:[1,1,1]
    v_pk_fma_f32 v[22:23], v[142:143], v[90:91], v[22:23] op_sel:[0,1,0] op_sel_hi:[1,1,1]
    ds_read_b128 v[72:75], v169
    ds_read_b128 v[88:91], v169
    s_set_gpr_idx_off
L_j12:
    s_waitcnt vmcnt(5)
.p2align 3
    v_mfma_f32_16x16x16_bf16 v[128:131], v[160:161], v[112:113], 0
    v_readlane_b32 s66, v196, 12
    v_cvt_pk_bf16_f32 v10, v157, v157
    v_mfma_f32_16x16x16_bf16 v[132:135], v[160:161], v[114:115], 0
    v_and_b32 v162, v190, v10
    v_and_b32 v163, v191, v10
    s_and_b32 s61, s66, s49
    s_waitcnt vmcnt(4)
    buffer_load_dwordx4 v[104:107], v2, s[16:19], s61 offen
    v_mfma_f32_16x16x16_bf16 v[136:139], v[162:163], v[116:117], 0
    v_readlane_b32 s67, v196, 13
    v_cvt_pk_bf16_f32 v9, v158, v158
    v_mfma_f32_16x16x16_bf16 v[140:143], v[162:163], v[118:119], 0
    v_and_b32 v160, v190, v9
    v_and_b32 v161, v191, v9
    s_and_b32 s61, s67, s49
    s_set_gpr_idx_on s68, gpr_idx(SRC2,DST)
    buffer_load_dwordx4 v[108:111], v2, s[16:19], s61 offen
    v_pk_fma_f32 v[16:17], v[128:129], v[76:77], v[16:17] op_sel_hi:[1,0,1]
    v_pk_fma_f32 v[18:19], v[130:131], v[76:77], v[18:19] op_sel_hi:[1,0,1]
    v_pk_fma_f32 v[20:21], v[132:133], v[92:93], v[20:21] op_sel_hi:[1,0,1]
    v_pk_fma_f32 v[22:23], v[134:135], v[92:93], v[22:23] op_sel_hi:[1,0,1]
    s_set_gpr_idx_idx s69
.p2align 3
    v_pk_fma_f32 v[16:17], v[136:137], v[76:77], v[16:17] op_sel:[0,1,0] op_sel_hi:[1,1,1]
    v_pk_fma_f32 v[18:19], v[138:139], v[76:77], v[18:19] op_sel:[0,1,0] op_sel_hi:[1,1,1]
    v_pk_fma_f32 v[20:21], v[140:141], v[92:93], v[20:21] op_sel:[0,1,0] op_sel_hi:[1,1,1]
    v_pk_fma_f32 v[22:23], v[142:143], v[92:93], v[22:23] op_sel:[0,1,0] op_sel_hi:[1,1,1]
    s_set_gpr_idx_off
L_j14:
    s_waitcnt vmcnt(5)
.p2align 3
    v_mfma_f32_16x16x16_bf16 v[128:131], v[160:161], v[120:121], 0
    v_readlane_b32 s68, v196, 14
    v_cvt_pk_bf16_f32 v10, v159, v159
    v_mfma_f32_16x16x16_bf16 v[132:135], v[160:161], v[122:123], 0
    v_and_b32 v162, v190, v10
    v_and_b32 v163, v191, v10
    s_and_b32 s61, s68, s49
    s_waitcnt vmcnt(4)
    buffer_load_dwordx4 v[112:115], v2, s[16:19], s61 offen
    v_mfma_f32_16x16x16_bf16 v[136:139], v[162:163], v[124:125], 0
    v_readlane_b32 s69, v196, 15
    v_mfma_f32_16x16x16_bf16 v[140:143], v[162:163], v[126:127], 0
    s_and_b32 s61, s69, s49
    s_set_gpr_idx_on s70, gpr_idx(SRC2,DST)
    buffer_load_dwordx4 v[116:119], v2, s[16:19], s61 offen
    v_pk_fma_f32 v[16:17], v[128:129], v[78:79], v[16:17] op_sel_hi:[1,0,1]
    v_pk_fma_f32 v[18:19], v[130:131], v[78:79], v[18:19] op_sel_hi:[1,0,1]
    v_pk_fma_f32 v[20:21], v[132:133], v[94:95], v[20:21] op_sel_hi:[1,0,1]
    v_pk_fma_f32 v[22:23], v[134:135], v[94:95], v[22:23] op_sel_hi:[1,0,1]
    s_set_gpr_idx_idx s71
    s_sub_u32 s53, s53, 1
.p2align 3
    v_pk_fma_f32 v[16:17], v[136:137], v[78:79], v[16:17] op_sel:[0,1,0] op_sel_hi:[1,1,1]
    v_pk_fma_f32 v[18:19], v[138:139], v[78:79], v[18:19] op_sel:[0,1,0] op_sel_hi:[1,1,1]
    v_pk_fma_f32 v[20:21], v[140:141], v[94:95], v[20:21] op_sel:[0,1,0] op_sel_hi:[1,1,1]
    v_pk_fma_f32 v[22:23], v[142:143], v[94:95], v[22:23] op_sel:[0,1,0] op_sel_hi:[1,1,1]
    ds_read_b128 v[76:79], v169
    ds_read_b128 v[92:95], v169
    s_set_gpr_idx_off
    s_cmp_lg_u32 s53, 0
    s_cbranch_scc1 L_loop
    s_waitcnt lgkmcnt(2)
.p2align 3
    v_mfma_f32_4x4x4_16b_bf16 v[144:147], v[192:193], v[188:189], 0 cbsz:4 abid:0
    v_mfma_f32_4x4x4_16b_bf16 v[148:151], v[192:193], v[188:189], 0 cbsz:4 abid:2
    v_mfma_f32_4x4x4_16b_bf16 v[152:155], v[192:193], v[188:189], 0 cbsz:4 abid:4
    v_mfma_f32_4x4x4_16b_bf16 v[156:159], v[192:193], v[188:189], 0 cbsz:4 abid:6
    v_lshlrev_b32 v196, 3, v197
    v_and_b32 v196, s55, v196
    s_waitcnt lgkmcnt(0)
.p2align 3
    v_smfmac_f32_32x32x32_bf16 v[64:79], v[164:167], v[172:179], v168
    v_cvt_pk_bf16_f32 v9, v144, v144
    v_and_b32 v160, v190, v9
    v_and_b32 v161, v191, v9
    v_smfmac_f32_32x32x32_bf16 v[80:95], v[164:167], v[180:187], v168
L_f0:
    s_waitcnt vmcnt(5)
.p2align 3
    v_mfma_f32_16x16x16_bf16 v[128:131], v[160:161], v[96:97], 0
    v_readlane_b32 s70, v196, 0
    v_cvt_pk_bf16_f32 v10, v145, v145
    v_mfma_f32_16x16x16_bf16 v[132:135], v[160:161], v[98:99], 0
    v_and_b32 v162, v190, v10
    v_and_b32 v163, v191, v10
    s_and_b32 s61, s70, s49
    s_waitcnt vmcnt(4)
    buffer_load_dwordx4 v[120:123], v2, s[16:19], s61 offen
    v_mfma_f32_16x16x16_bf16 v[136:139], v[162:163], v[100:101], 0
    v_readlane_b32 s71, v196, 1
    v_cvt_pk_bf16_f32 v9, v146, v146
    v_mfma_f32_16x16x16_bf16 v[140:143], v[162:163], v[102:103], 0
    v_and_b32 v160, v190, v9
    v_and_b32 v161, v191, v9
    s_and_b32 s61, s71, s49
    s_set_gpr_idx_on s64, gpr_idx(SRC2,DST)
    buffer_load_dwordx4 v[124:127], v2, s[16:19], s61 offen
    v_pk_fma_f32 v[16:17], v[128:129], v[64:65], v[16:17] op_sel_hi:[1,0,1]
    v_pk_fma_f32 v[18:19], v[130:131], v[64:65], v[18:19] op_sel_hi:[1,0,1]
    v_pk_fma_f32 v[20:21], v[132:133], v[80:81], v[20:21] op_sel_hi:[1,0,1]
    v_pk_fma_f32 v[22:23], v[134:135], v[80:81], v[22:23] op_sel_hi:[1,0,1]
    s_set_gpr_idx_idx s65
.p2align 3
    v_pk_fma_f32 v[16:17], v[136:137], v[64:65], v[16:17] op_sel:[0,1,0] op_sel_hi:[1,1,1]
    v_pk_fma_f32 v[18:19], v[138:139], v[64:65], v[18:19] op_sel:[0,1,0] op_sel_hi:[1,1,1]
    v_pk_fma_f32 v[20:21], v[140:141], v[80:81], v[20:21] op_sel:[0,1,0] op_sel_hi:[1,1,1]
    v_pk_fma_f32 v[22:23], v[142:143], v[80:81], v[22:23] op_sel:[0,1,0] op_sel_hi:[1,1,1]
    s_set_gpr_idx_off
    s_waitcnt vmcnt(5)
.p2align 3
    v_mfma_f32_16x16x16_bf16 v[128:131], v[160:161], v[104:105], 0
    v_readlane_b32 s64, v196, 2
    v_cvt_pk_bf16_f32 v10, v147, v147
    v_mfma_f32_16x16x16_bf16 v[132:135], v[160:161], v[106:107], 0
    v_and_b32 v162, v190, v10
    v_and_b32 v163, v191, v10
    s_and_b32 s61, s64, s49
    s_waitcnt vmcnt(4)
    buffer_load_dwordx4 v[96:99], v2, s[16:19], s61 offen
    v_mfma_f32_16x16x16_bf16 v[136:139], v[162:163], v[108:109], 0
    v_readlane_b32 s65, v196, 3
    v_cvt_pk_bf16_f32 v9, v148, v148
    v_mfma_f32_16x16x16_bf16 v[140:143], v[162:163], v[110:111], 0
    v_and_b32 v160, v190, v9
    v_and_b32 v161, v191, v9
    s_and_b32 s61, s65, s49
    s_set_gpr_idx_on s66, gpr_idx(SRC2,DST)
    buffer_load_dwordx4 v[100:103], v2, s[16:19], s61 offen
    v_pk_fma_f32 v[16:17], v[128:129], v[66:67], v[16:17] op_sel_hi:[1,0,1]
    v_pk_fma_f32 v[18:19], v[130:131], v[66:67], v[18:19] op_sel_hi:[1,0,1]
    v_pk_fma_f32 v[20:21], v[132:133], v[82:83], v[20:21] op_sel_hi:[1,0,1]
    v_pk_fma_f32 v[22:23], v[134:135], v[82:83], v[22:23] op_sel_hi:[1,0,1]
    s_set_gpr_idx_idx s67
.p2align 3
    v_pk_fma_f32 v[16:17], v[136:137], v[66:67], v[16:17] op_sel:[0,1,0] op_sel_hi:[1,1,1]
    v_pk_fma_f32 v[18:19], v[138:139], v[66:67], v[18:19] op_sel:[0,1,0] op_sel_hi:[1,1,1]
    v_pk_fma_f32 v[20:21], v[140:141], v[82:83], v[20:21] op_sel:[0,1,0] op_sel_hi:[1,1,1]
    v_pk_fma_f32 v[22:23], v[142:143], v[82:83], v[22:23] op_sel:[0,1,0] op_sel_hi:[1,1,1]
    s_set_gpr_idx_off
    s_waitcnt vmcnt(5)
.p2align 3
    v_mfma_f32_16x16x16_bf16 v[128:131], v[160:161], v[112:113], 0
    v_readlane_b32 s66, v196, 4
    v_cvt_pk_bf16_f32 v10, v149, v149
    v_mfma_f32_16x16x16_bf16 v[132:135], v[160:161], v[114:115], 0
    v_and_b32 v162, v190, v10
    v_and_b32 v163, v191, v10
    s_and_b32 s61, s66, s49
    s_waitcnt vmcnt(4)
    buffer_load_dwordx4 v[104:107], v2, s[16:19], s61 offen
    v_mfma_f32_16x16x16_bf16 v[136:139], v[162:163], v[116:117], 0
    v_readlane_b32 s67, v196, 5
    v_cvt_pk_bf16_f32 v9, v150, v150
    v_mfma_f32_16x16x16_bf16 v[140:143], v[162:163], v[118:119], 0
    v_and_b32 v160, v190, v9
    v_and_b32 v161, v191, v9
    s_and_b32 s61, s67, s49
    s_set_gpr_idx_on s68, gpr_idx(SRC2,DST)
    buffer_load_dwordx4 v[108:111], v2, s[16:19], s61 offen
    v_pk_fma_f32 v[16:17], v[128:129], v[68:69], v[16:17] op_sel_hi:[1,0,1]
    v_pk_fma_f32 v[18:19], v[130:131], v[68:69], v[18:19] op_sel_hi:[1,0,1]
    v_pk_fma_f32 v[20:21], v[132:133], v[84:85], v[20:21] op_sel_hi:[1,0,1]
    v_pk_fma_f32 v[22:23], v[134:135], v[84:85], v[22:23] op_sel_hi:[1,0,1]
    s_set_gpr_idx_idx s69
.p2align 3
    v_pk_fma_f32 v[16:17], v[136:137], v[68:69], v[16:17] op_sel:[0,1,0] op_sel_hi:[1,1,1]
    v_pk_fma_f32 v[18:19], v[138:139], v[68:69], v[18:19] op_sel:[0,1,0] op_sel_hi:[1,1,1]
    v_pk_fma_f32 v[20:21], v[140:141], v[84:85], v[20:21] op_sel:[0,1,0] op_sel_hi:[1,1,1]
    v_pk_fma_f32 v[22:23], v[142:143], v[84:85], v[22:23] op_sel:[0,1,0] op_sel_hi:[1,1,1]
    s_set_gpr_idx_off
    s_waitcnt vmcnt(5)
.p2align 3
    v_mfma_f32_16x16x16_bf16 v[128:131], v[160:161], v[120:121], 0
    v_readlane_b32 s68, v196, 6
    v_cvt_pk_bf16_f32 v10, v151, v151
    v_mfma_f32_16x16x16_bf16 v[132:135], v[160:161], v[122:123], 0
    v_and_b32 v162, v190, v10
    v_and_b32 v163, v191, v10
    s_and_b32 s61, s68, s49
    s_waitcnt vmcnt(4)
    buffer_load_dwordx4 v[112:115], v2, s[16:19], s61 offen
    v_mfma_f32_16x16x16_bf16 v[136:139], v[162:163], v[124:125], 0
    v_readlane_b32 s69, v196, 7
    v_cvt_pk_bf16_f32 v9, v152, v152
    v_mfma_f32_16x16x16_bf16 v[140:143], v[162:163], v[126:127], 0
    v_and_b32 v160, v190, v9
    v_and_b32 v161, v191, v9
    s_and_b32 s61, s69, s49
    s_set_gpr_idx_on s70, gpr_idx(SRC2,DST)
    buffer_load_dwordx4 v[116:119], v2, s[16:19], s61 offen
    v_pk_fma_f32 v[16:17], v[128:129], v[70:71], v[16:17] op_sel_hi:[1,0,1]
    v_pk_fma_f32 v[18:19], v[130:131], v[70:71], v[18:19] op_sel_hi:[1,0,1]
    v_pk_fma_f32 v[20:21], v[132:133], v[86:87], v[20:21] op_sel_hi:[1,0,1]
    v_pk_fma_f32 v[22:23], v[134:135], v[86:87], v[22:23] op_sel_hi:[1,0,1]
    s_set_gpr_idx_idx s71
.p2align 3
    v_pk_fma_f32 v[16:17], v[136:137], v[70:71], v[16:17] op_sel:[0,1,0] op_sel_hi:[1,1,1]
    v_pk_fma_f32 v[18:19], v[138:139], v[70:71], v[18:19] op_sel:[0,1,0] op_sel_hi:[1,1,1]
    v_pk_fma_f32 v[20:21], v[140:141], v[86:87], v[20:21] op_sel:[0,1,0] op_sel_hi:[1,1,1]
    v_pk_fma_f32 v[22:23], v[142:143], v[86:87], v[22:23] op_sel:[0,1,0] op_sel_hi:[1,1,1]
    s_set_gpr_idx_off
    s_waitcnt vmcnt(5)
.p2align 3
    v_mfma_f32_16x16x16_bf16 v[128:131], v[160:161], v[96:97], 0
    v_readlane_b32 s70, v196, 8
    v_cvt_pk_bf16_f32 v10, v153, v153
    v_mfma_f32_16x16x16_bf16 v[132:135], v[160:161], v[98:99], 0
    v_and_b32 v162, v190, v10
    v_and_b32 v163, v191, v10
    s_and_b32 s61, s70, s49
    s_waitcnt vmcnt(4)
    buffer_load_dwordx4 v[120:123], v2, s[16:19], s61 offen
    v_mfma_f32_16x16x16_bf16 v[136:139], v[162:163], v[100:101], 0
    v_readlane_b32 s71, v196, 9
    v_cvt_pk_bf16_f32 v9, v154, v154
    v_mfma_f32_16x16x16_bf16 v[140:143], v[162:163], v[102:103], 0
    v_and_b32 v160, v190, v9
    v_and_b32 v161, v191, v9
    s_and_b32 s61, s71, s49
    s_set_gpr_idx_on s64, gpr_idx(SRC2,DST)
    buffer_load_dwordx4 v[124:127], v2, s[16:19], s61 offen
    v_pk_fma_f32 v[16:17], v[128:129], v[72:73], v[16:17] op_sel_hi:[1,0,1]
    v_pk_fma_f32 v[18:19], v[130:131], v[72:73], v[18:19] op_sel_hi:[1,0,1]
    v_pk_fma_f32 v[20:21], v[132:133], v[88:89], v[20:21] op_sel_hi:[1,0,1]
    v_pk_fma_f32 v[22:23], v[134:135], v[88:89], v[22:23] op_sel_hi:[1,0,1]
    s_set_gpr_idx_idx s65
.p2align 3
    v_pk_fma_f32 v[16:17], v[136:137], v[72:73], v[16:17] op_sel:[0,1,0] op_sel_hi:[1,1,1]
    v_pk_fma_f32 v[18:19], v[138:139], v[72:73], v[18:19] op_sel:[0,1,0] op_sel_hi:[1,1,1]
    v_pk_fma_f32 v[20:21], v[140:141], v[88:89], v[20:21] op_sel:[0,1,0] op_sel_hi:[1,1,1]
    v_pk_fma_f32 v[22:23], v[142:143], v[88:89], v[22:23] op_sel:[0,1,0] op_sel_hi:[1,1,1]
    s_set_gpr_idx_off
    s_waitcnt vmcnt(5)
.p2align 3
    v_mfma_f32_16x16x16_bf16 v[128:131], v[160:161], v[104:105], 0
    v_cvt_pk_bf16_f32 v10, v155, v155
    v_mfma_f32_16x16x16_bf16 v[132:135], v[160:161], v[106:107], 0
    v_and_b32 v162, v190, v10
    v_and_b32 v163, v191, v10
    s_waitcnt vmcnt(4)
.p2align 3
    s_nop 0
    v_mfma_f32_16x16x16_bf16 v[136:139], v[162:163], v[108:109], 0
    v_cvt_pk_bf16_f32 v9, v156, v156
    v_mfma_f32_16x16x16_bf16 v[140:143], v[162:163], v[110:111], 0
    v_and_b32 v160, v190, v9
    v_and_b32 v161, v191, v9
    s_set_gpr_idx_on s66, gpr_idx(SRC2,DST)
.p2align 3
    v_pk_fma_f32 v[16:17], v[128:129], v[74:75], v[16:17] op_sel_hi:[1,0,1]
    v_pk_fma_f32 v[18:19], v[130:131], v[74:75], v[18:19] op_sel_hi:[1,0,1]
    v_pk_fma_f32 v[20:21], v[132:133], v[90:91], v[20:21] op_sel_hi:[1,0,1]
    v_pk_fma_f32 v[22:23], v[134:135], v[90:91], v[22:23] op_sel_hi:[1,0,1]
    s_set_gpr_idx_idx s67
.p2align 3
    v_pk_fma_f32 v[16:17], v[136:137], v[74:75], v[16:17] op_sel:[0,1,0] op_sel_hi:[1,1,1]
    v_pk_fma_f32 v[18:19], v[138:139], v[74:75], v[18:19] op_sel:[0,1,0] op_sel_hi:[1,1,1]
    v_pk_fma_f32 v[20:21], v[140:141], v[90:91], v[20:21] op_sel:[0,1,0] op_sel_hi:[1,1,1]
    v_pk_fma_f32 v[22:23], v[142:143], v[90:91], v[22:23] op_sel:[0,1,0] op_sel_hi:[1,1,1]
    s_set_gpr_idx_off
    s_waitcnt vmcnt(3)
.p2align 3
    v_mfma_f32_16x16x16_bf16 v[128:131], v[160:161], v[112:113], 0
    v_cvt_pk_bf16_f32 v10, v157, v157
    v_mfma_f32_16x16x16_bf16 v[132:135], v[160:161], v[114:115], 0
    v_and_b32 v162, v190, v10
    v_and_b32 v163, v191, v10
    s_waitcnt vmcnt(2)
.p2align 3
    s_nop 0
    v_mfma_f32_16x16x16_bf16 v[136:139], v[162:163], v[116:117], 0
    v_cvt_pk_bf16_f32 v9, v158, v158
    v_mfma_f32_16x16x16_bf16 v[140:143], v[162:163], v[118:119], 0
    v_and_b32 v160, v190, v9
    v_and_b32 v161, v191, v9
    s_set_gpr_idx_on s68, gpr_idx(SRC2,DST)
.p2align 3
    v_pk_fma_f32 v[16:17], v[128:129], v[76:77], v[16:17] op_sel_hi:[1,0,1]
    v_pk_fma_f32 v[18:19], v[130:131], v[76:77], v[18:19] op_sel_hi:[1,0,1]
    v_pk_fma_f32 v[20:21], v[132:133], v[92:93], v[20:21] op_sel_hi:[1,0,1]
    v_pk_fma_f32 v[22:23], v[134:135], v[92:93], v[22:23] op_sel_hi:[1,0,1]
    s_set_gpr_idx_idx s69
.p2align 3
    v_pk_fma_f32 v[16:17], v[136:137], v[76:77], v[16:17] op_sel:[0,1,0] op_sel_hi:[1,1,1]
    v_pk_fma_f32 v[18:19], v[138:139], v[76:77], v[18:19] op_sel:[0,1,0] op_sel_hi:[1,1,1]
    v_pk_fma_f32 v[20:21], v[140:141], v[92:93], v[20:21] op_sel:[0,1,0] op_sel_hi:[1,1,1]
    v_pk_fma_f32 v[22:23], v[142:143], v[92:93], v[22:23] op_sel:[0,1,0] op_sel_hi:[1,1,1]
    s_set_gpr_idx_off
    s_waitcnt vmcnt(1)
.p2align 3
    v_mfma_f32_16x16x16_bf16 v[128:131], v[160:161], v[120:121], 0
    v_cvt_pk_bf16_f32 v10, v159, v159
    v_mfma_f32_16x16x16_bf16 v[132:135], v[160:161], v[122:123], 0
    v_and_b32 v162, v190, v10
    v_and_b32 v163, v191, v10
    s_waitcnt vmcnt(0)
.p2align 3
    s_nop 0
    v_mfma_f32_16x16x16_bf16 v[136:139], v[162:163], v[124:125], 0
    v_mfma_f32_16x16x16_bf16 v[140:143], v[162:163], v[126:127], 0
    s_set_gpr_idx_on s70, gpr_idx(SRC2,DST)
.p2align 3
    v_pk_fma_f32 v[16:17], v[128:129], v[78:79], v[16:17] op_sel_hi:[1,0,1]
    v_pk_fma_f32 v[18:19], v[130:131], v[78:79], v[18:19] op_sel_hi:[1,0,1]
    v_pk_fma_f32 v[20:21], v[132:133], v[94:95], v[20:21] op_sel_hi:[1,0,1]
    v_pk_fma_f32 v[22:23], v[134:135], v[94:95], v[22:23] op_sel_hi:[1,0,1]
    s_set_gpr_idx_idx s71
.p2align 3
    s_nop 0
    v_pk_fma_f32 v[16:17], v[136:137], v[78:79], v[16:17] op_sel:[0,1,0] op_sel_hi:[1,1,1]
    v_pk_fma_f32 v[18:19], v[138:139], v[78:79], v[18:19] op_sel:[0,1,0] op_sel_hi:[1,1,1]
    v_pk_fma_f32 v[20:21], v[140:141], v[94:95], v[20:21] op_sel:[0,1,0] op_sel_hi:[1,1,1]
    v_pk_fma_f32 v[22:23], v[142:143], v[94:95], v[22:23] op_sel:[0,1,0] op_sel_hi:[1,1,1]
    s_set_gpr_idx_off
L_swept:
    s_add_u32 s48, s48, 224
    s_cmp_lt_u32 s48, s47
    s_cbranch_scc1 L_again
    s_setprio 0
    v_cvt_pk_bf16_f32 v64, v16, v20
    v_cvt_pk_bf16_f32 v65, v17, v21
    v_cvt_pk_bf16_f32 v66, v18, v22
    v_cvt_pk_bf16_f32 v67, v19, v23
    ds_write2_b32 v208, v64, v65 offset0:0 offset1:72
    ds_write2_b32 v208, v66, v67 offset0:144 offset1:216
    v_cvt_pk_bf16_f32 v68, v24, v28
    v_cvt_pk_bf16_f32 v69, v25, v29
    v_cvt_pk_bf16_f32 v70, v26, v30
    v_cvt_pk_bf16_f32 v71, v27, v31
    ds_write2_b32 v209, v68, v69 offset0:0 offset1:72
    ds_write2_b32 v209, v70, v71 offset0:144 offset1:216
    v_cvt_pk_bf16_f32 v72, v32, v36
    v_cvt_pk_bf16_f32 v73, v33, v37
    v_cvt_pk_bf16_f32 v74, v34, v38
    v_cvt_pk_bf16_f32 v75, v35, v39
    ds_write2_b32 v210, v72, v73 offset0:0 offset1:72
    ds_write2_b32 v210, v74, v75 offset0:144 offset1:216
    v_cvt_pk_bf16_f32 v76, v40, v44
    v_cvt_pk_bf16_f32 v77, v41, v45
    v_cvt_pk_bf16_f32 v78, v42, v46
    v_cvt_pk_bf16_f32 v79, v43, v47
    ds_write2_b32 v211, v76, v77 offset0:0 offset1:72
    ds_write2_b32 v211, v78, v79 offset0:144 offset1:216
    v_cvt_pk_bf16_f32 v80, v48, v52
    v_cvt_pk_bf16_f32 v81, v49, v53
    v_cvt_pk_bf16_f32 v82, v50, v54
    v_cvt_pk_bf16_f32 v83, v51, v55
    ds_write2_b32 v212, v80, v81 offset0:0 offset1:72
    ds_write2_b32 v212, v82, v83 offset0:144 offset1:216
    ds_read_b128 v[96:99], v215 offset:6144
    ds_read_b128 v[100:103], v215 offset:7168
    ds_read_b128 v[104:107], v215 offset:8192
    ds_read_b128 v[108:111], v215 offset:9216
    ds_read_b128 v[112:115], v215 offset:10240
    ds_read_b128 v[116:119], v215 offset:11264
    ds_read_b128 v[120:123], v215 offset:12288
    ds_read_b128 v[124:127], v215 offset:13312
    ds_read_b128 v[128:131], v215 offset:14336
    ds_read_b128 v[132:135], v215 offset:15360
    s_waitcnt lgkmcnt(10)
    s_barrier
    ds_read_b128 v[16:19], v213 offset:0
    ds_read_b128 v[20:23], v213 offset:64
    ds_read_b128 v[24:27], v213 offset:128
    ds_read_b128 v[28:31], v213 offset:192
    s_waitcnt lgkmcnt(3)
    v_mfma_f32_16x16x32_bf16 v[160:163], v[16:19], v[216:219], 0
    v_mfma_f32_16x16x32_bf16 v[164:167], v[16:19], v[220:223], 0
    v_mfma_f32_16x16x32_bf16 v[168:171], v[16:19], v[224:227], 0
    v_mfma_f32_16x16x32_bf16 v[172:175], v[16:19], v[228:231], 0
    ds_read_b128 v[32:35], v213 offset:4608
    ds_read_b128 v[36:39], v213 offset:4672
    ds_read_b128 v[40:43], v213 offset:4736
    ds_read_b128 v[44:47], v213 offset:4800
    s_waitcnt lgkmcnt(6)
    v_mfma_f32_16x16x32_bf16 v[160:163], v[20:23], v[232:235], v[160:163]
    v_mfma_f32_16x16x32_bf16 v[164:167], v[20:23], v[236:239], v[164:167]
    v_mfma_f32_16x16x32_bf16 v[168:171], v[20:23], v[96:99], v[168:171]
    v_mfma_f32_16x16x32_bf16 v[172:175], v[20:23], v[100:103], v[172:175]
    ds_read_b128 v[48:51], v213 offset:9216
    ds_read_b128 v[52:55], v213 offset:9280
    ds_read_b128 v[56:59], v213 offset:9344
    ds_read_b128 v[60:63], v213 offset:9408
    s_waitcnt lgkmcnt(9)
    v_mfma_f32_16x16x32_bf16 v[160:163], v[24:27], v[104:107], v[160:163]
    v_mfma_f32_16x16x32_bf16 v[164:167], v[24:27], v[108:111], v[164:167]
    v_mfma_f32_16x16x32_bf16 v[168:171], v[24:27], v[112:115], v[168:171]
    v_mfma_f32_16x16x32_bf16 v[172:175], v[24:27], v[116:119], v[172:175]
    s_waitcnt lgkmcnt(8)
    v_mfma_f32_16x16x32_bf16 v[160:163], v[28:31], v[120:123], v[160:163]
    v_mfma_f32_16x16x32_bf16 v[164:167], v[28:31], v[124:127], v[164:167]
    v_mfma_f32_16x16x32_bf16 v[168:171], v[28:31], v[128:131], v[168:171]
    v_mfma_f32_16x16x32_bf16 v[172:175], v[28:31], v[132:135], v[172:175]
    s_waitcnt lgkmcnt(4)
    v_mfma_f32_16x16x32_bf16 v[176:179], v[32:35], v[216:219], 0
    v_mfma_f32_16x16x32_bf16 v[180:183], v[32:35], v[220:223], 0
    v_mfma_f32_16x16x32_bf16 v[184:187], v[32:35], v[224:227], 0
    v_mfma_f32_16x16x32_bf16 v[188:191], v[32:35], v[228:231], 0
    v_mfma_f32_16x16x32_bf16 v[176:179], v[36:39], v[232:235], v[176:179]
    v_cvt_pk_bf16_f32 v64, v160, v164
    v_cvt_pk_bf16_f32 v80, v160, v164
    v_mfma_f32_16x16x32_bf16 v[180:183], v[36:39], v[236:239], v[180:183]
    v_cvt_pk_bf16_f32 v66, v162, v166
    v_cvt_pk_bf16_f32 v65, v168, v172
    v_mfma_f32_16x16x32_bf16 v[184:187], v[36:39], v[96:99], v[184:187]
    v_cvt_pk_bf16_f32 v81, v168, v172
    v_cvt_pk_bf16_f32 v67, v170, v174
    v_mfma_f32_16x16x32_bf16 v[188:191], v[36:39], v[100:103], v[188:191]
    v_mov_b32_dpp v64, v66 row_ror:8 row_mask:0xf bank_mask:0xc
    v_mov_b32_dpp v65, v67 row_ror:8 row_mask:0xf bank_mask:0xc
    v_mfma_f32_16x16x32_bf16 v[176:179], v[40:43], v[104:107], v[176:179]
    v_mov_b32_dpp v66, v80 row_ror:8 row_mask:0xf bank_mask:0x3
    v_mov_b32_dpp v67, v81 row_ror:8 row_mask:0xf bank_mask:0x3
    v_mfma_f32_16x16x32_bf16 v[180:183], v[40:43], v[108:111], v[180:183]
    buffer_store_dwordx4 v[64:67], v214, s[40:43], s99 offen offset:0 sc1
    v_cvt_pk_bf16_f32 v68, v161, v165
    v_mfma_f32_16x16x32_bf16 v[184:187], v[40:43], v[112:115], v[184:187]
    v_cvt_pk_bf16_f32 v82, v161, v165
    v_cvt_pk_bf16_f32 v70, v163, v167
    v_mfma_f32_16x16x32_bf16 v[188:191], v[40:43], v[116:119], v[188:191]
    v_cvt_pk_bf16_f32 v69, v169, v173
    v_cvt_pk_bf16_f32 v83, v169, v173
    v_mfma_f32_16x16x32_bf16 v[176:179], v[44:47], v[120:123], v[176:179]
    v_cvt_pk_bf16_f32 v71, v171, v175
    v_mov_b32_dpp v68, v70 row_ror:8 row_mask:0xf bank_mask:0xc
    v_mfma_f32_16x16x32_bf16 v[180:183], v[44:47], v[124:127], v[180:183]
    v_mov_b32_dpp v69, v71 row_ror:8 row_mask:0xf bank_mask:0xc
    v_mov_b32_dpp v70, v82 row_ror:8 row_mask:0xf bank_mask:0x3
    v_mfma_f32_16x16x32_bf16 v[184:187], v[44:47], v[128:131], v[184:187]
    v_mov_b32_dpp v71, v83 row_ror:8 row_mask:0xf bank_mask:0x3
    buffer_store_dwordx4 v[68:71], v214, s[40:43], s99 offen offset:256 sc1
    v_mfma_f32_16x16x32_bf16 v[188:191], v[44:47], v[132:135], v[188:191]
    s_add_u32 s99, s99, 4096
    s_cmp_ge_u32 s3, 4
    s_cbranch_scc1 L_two
    s_waitcnt lgkmcnt(0)
    v_mfma_f32_16x16x32_bf16 v[160:163], v[48:51], v[216:219], 0
    v_mfma_f32_16x16x32_bf16 v[164:167], v[48:51], v[220:223], 0
    v_mfma_f32_16x16x32_bf16 v[168:171], v[48:51], v[224:227], 0
    v_mfma_f32_16x16x32_bf16 v[172:175], v[48:51], v[228:231], 0
    v_mfma_f32_16x16x32_bf16 v[160:163], v[52:55], v[232:235], v[160:163]
    v_cvt_pk_bf16_f32 v72, v176, v180
    v_cvt_pk_bf16_f32 v80, v176, v180
    v_mfma_f32_16x16x32_bf16 v[164:167], v[52:55], v[236:239], v[164:167]
    v_cvt_pk_bf16_f32 v74, v178, v182
    v_cvt_pk_bf16_f32 v73, v184, v188
    v_mfma_f32_16x16x32_bf16 v[168:171], v[52:55], v[96:99], v[168:171]
    v_cvt_pk_bf16_f32 v81, v184, v188
    v_cvt_pk_bf16_f32 v75, v186, v190
    v_mfma_f32_16x16x32_bf16 v[172:175], v[52:55], v[100:103], v[172:175]
    v_mov_b32_dpp v72, v74 row_ror:8 row_mask:0xf bank_mask:0xc
    v_mov_b32_dpp v73, v75 row_ror:8 row_mask:0xf bank_mask:0xc
    v_mfma_f32_16x16x32_bf16 v[160:163], v[56:59], v[104:107], v[160:163]
    v_mov_b32_dpp v74, v80 row_ror:8 row_mask:0xf bank_mask:0x3
    v_mov_b32_dpp v75, v81 row_ror:8 row_mask:0xf bank_mask:0x3
    v_mfma_f32_16x16x32_bf16 v[164:167], v[56:59], v[108:111], v[164:167]
    buffer_store_dwordx4 v[72:75], v214, s[40:43], s99 offen offset:0 sc1
    v_cvt_pk_bf16_f32 v76, v177, v181
    v_mfma_f32_16x16x32_bf16 v[168:171], v[56:59], v[112:115], v[168:171]
    v_cvt_pk_bf16_f32 v82, v177, v181
    v_cvt_pk_bf16_f32 v78, v179, v183
    v_mfma_f32_16x16x32_bf16 v[172:175], v[56:59], v[116:119], v[172:175]
    v_cvt_pk_bf16_f32 v77, v185, v189
    v_cvt_pk_bf16_f32 v83, v185, v189
    v_mfma_f32_16x16x32_bf16 v[160:163], v[60:63], v[120:123], v[160:163]
    v_cvt_pk_bf16_f32 v79, v187, v191
    v_mov_b32_dpp v76, v78 row_ror:8 row_mask:0xf bank_mask:0xc
    v_mfma_f32_16x16x32_bf16 v[164:167], v[60:63], v[124:127], v[164:167]
    v_mov_b32_dpp v77, v79 row_ror:8 row_mask:0xf bank_mask:0xc
    v_mov_b32_dpp v78, v82 row_ror:8 row_mask:0xf bank_mask:0x3
    v_mfma_f32_16x16x32_bf16 v[168:171], v[60:63], v[128:131], v[168:171]
    v_mov_b32_dpp v79, v83 row_ror:8 row_mask:0xf bank_mask:0x3
    buffer_store_dwordx4 v[76:79], v214, s[40:43], s99 offen offset:256 sc1
    v_mfma_f32_16x16x32_bf16 v[172:175], v[60:63], v[132:135], v[172:175]
    s_add_u32 s99, s99, 4096
    s_nop 0
    v_cvt_pk_bf16_f32 v64, v160, v164
    v_cvt_pk_bf16_f32 v80, v160, v164
    v_cvt_pk_bf16_f32 v66, v162, v166
    s_nop 2
    v_cvt_pk_bf16_f32 v65, v168, v172
    v_cvt_pk_bf16_f32 v81, v168, v172
    v_cvt_pk_bf16_f32 v67, v170, v174
    v_mov_b32_dpp v64, v66 row_ror:8 row_mask:0xf bank_mask:0xc
    s_nop 0
    v_mov_b32_dpp v65, v67 row_ror:8 row_mask:0xf bank_mask:0xc
    v_mov_b32_dpp v66, v80 row_ror:8 row_mask:0xf bank_mask:0x3
    v_mov_b32_dpp v67, v81 row_ror:8 row_mask:0xf bank_mask:0x3
    buffer_store_dwordx4 v[64:67], v214, s[40:43], s99 offen offset:0 sc1
    v_cvt_pk_bf16_f32 v68, v161, v165
    v_cvt_pk_bf16_f32 v82, v161, v165
    v_cvt_pk_bf16_f32 v70, v163, v167
    v_cvt_pk_bf16_f32 v69, v169, v173
    v_cvt_pk_bf16_f32 v83, v169, v173
    v_cvt_pk_bf16_f32 v71, v171, v175
    v_mov_b32_dpp v68, v70 row_ror:8 row_mask:0xf bank_mask:0xc
    s_nop 0
    v_mov_b32_dpp v69, v71 row_ror:8 row_mask:0xf bank_mask:0xc
    v_mov_b32_dpp v70, v82 row_ror:8 row_mask:0xf bank_mask:0x3
    v_mov_b32_dpp v71, v83 row_ror:8 row_mask:0xf bank_mask:0x3
    buffer_store_dwordx4 v[68:71], v214, s[40:43], s99 offen offset:256 sc1
    s_add_u32 s99, s99, 4096
L_stored:
    s_or_b32 s4, s2, s3
    s_cbranch_scc1 L_notag
    v_mov_b32 v8, s62
    v_lshlrev_b32 v10, 2, v1
    s_mov_b32 s54, 524288
    buffer_store_dword v8, v10, s[20:23], s54 offen sc1
L_notag:
L_done:
    s_endpgm
L_again:
    s_waitcnt vmcnt(0) lgkmcnt(0)
    s_barrier
    v_lshlrev_b32 v11, 2, v0
    v_mov_b32 v12, 0x00700000
    v_mov_b32 v13, 0
    ds_write_b32 v11, v12 offset:0
    ds_write_b32 v11, v12 offset:2048
    ds_write_b32 v11, v12 offset:4096
    ds_write_b32 v11, v12 offset:6144
    ds_write_b32 v11, v13 offset:8192
    ds_write_b32 v11, v13 offset:10240
    ds_write_b32 v11, v13 offset:12288
    v_add_u32 v3, v3, v4
    v_subrev_u32 v3, 224, v3
    v_max_i32 v3, 0, v3
    v_subrev_u32 v4, 224, v4
    v_max_i32 v4, 0, v4
    v_sub_u32 v3, v3, v4
    v_add_u32 v5, 224, v5
    s_sub_i32 s95, s95, 224
    v_lshl_add_u32 v8, v4, 2, v241
    s_waitcnt lgkmcnt(0)
    s_barrier
L_clip:
    v_add_u32 v10, v4, v3
    v_min_i32 v10, 224, v10
    v_sub_u32 v10, v10, v4
    v_add_u32 v10, v10, v240
L_masks:
    v_cmp_lt_i32 s[64:65], 0, v10
    v_cmp_lt_i32 s[66:67], 2, v10
    v_cmp_lt_i32 s[68:69], 4, v10
    v_cmp_lt_i32 s[70:71], 6, v10
    v_cmp_lt_i32 s[72:73], 8, v10
    v_cmp_lt_i32 s[74:75], 10, v10
    v_cmp_lt_i32 s[76:77], 12, v10
    v_cmp_lt_i32 s[78:79], 14, v10
    s_nop 0
    s_branch L_mapw
L_map2:
    v_add_u32 v8, 56, v8
    v_subrev_u32 v10, 14, v10
    s_branch L_masks
L_r1:
    ds_read_b32 v67, v242 offset:768
    ds_read_b32 v74, v243 offset:768
    s_waitcnt lgkmcnt(0)
    v_mad_u32_u24 v67, v67, 12, v244
    buffer_load_dwordx3 v[88:90], v67, s[24:27], 0 offen offset:2304 sc1
    v_lshl_add_u32 v74, v74, 5, v2
    s_add_u32 m0, s52, 4096
    s_nop 0
    buffer_load_dwordx4 v74, s[28:31], s98 offen offset:2048 sc1 lds
    s_branch L_r1b
L_r2:
    v_lshrrev_b32 v135, 21, v90
    v_lshlrev_b32 v135, 2, v135
    v_lshrrev_b32 v11, 26, v90
    v_lshl_or_b32 v11, v11, 4, v245
    s_mov_b64 exec, s[96:97]
    ds_add_rtn_u32 v131, v135, v6 offset:8192
    ds_add_u32 v11, v6 offset:14336
    s_mov_b64 exec, -1
    s_mov_b32 exec_hi, 0
    ds_write_b64 v246, v[88:89] offset:1536
    s_mov_b32 exec_hi, -1
    v_and_or_b32 v90, v90, s55, v247
    v_add_u32 v90, 402653184, v90
    s_branch L_r2b
L_r3:
    ds_read_b32 v135, v135 offset:8192
    s_waitcnt lgkmcnt(0)
    v_bfe_u32 v15, v135, 12, 3
    v_or_b32 v90, v15, v90
    v_and_b32 v67, 0x3ff, v135
    v_lshrrev_b32 v135, 16, v135
    v_add_u32 v135, v135, v131
    ds_read_b32 v67, v67 offset:16384
    s_waitcnt lgkmcnt(0)
    v_lshl_add_u32 v135, v135, 2, v67
    s_mov_b64 exec, s[96:97]
    ds_write_b32 v135, v90
    s_mov_b64 exec, -1
    s_branch L_r3b
L_two:
    s_nop 7
    v_cvt_pk_bf16_f32 v72, v176, v180
    v_cvt_pk_bf16_f32 v80, v176, v180
    v_cvt_pk_bf16_f32 v74, v178, v182
    v_cvt_pk_bf16_f32 v73, v184, v188
    v_cvt_pk_bf16_f32 v81, v184, v188
    v_cvt_pk_bf16_f32 v75, v186, v190
    v_mov_b32_dpp v72, v74 row_ror:8 row_mask:0xf bank_mask:0xc
    s_nop 0
    v_mov_b32_dpp v73, v75 row_ror:8 row_mask:0xf bank_mask:0xc
    v_mov_b32_dpp v74, v80 row_ror:8 row_mask:0xf bank_mask:0x3
    v_mov_b32_dpp v75, v81 row_ror:8 row_mask:0xf bank_mask:0x3
    buffer_store_dwordx4 v[72:75], v214, s[40:43], s99 offen offset:0 sc1
    v_cvt_pk_bf16_f32 v76, v177, v181
    v_cvt_pk_bf16_f32 v82, v177, v181
    v_cvt_pk_bf16_f32 v78, v179, v183
    v_cvt_pk_bf16_f32 v77, v185, v189
    v_cvt_pk_bf16_f32 v83, v185, v189
    v_cvt_pk_bf16_f32 v79, v187, v191
    v_mov_b32_dpp v76, v78 row_ror:8 row_mask:0xf bank_mask:0xc
    s_nop 0
    v_mov_b32_dpp v77, v79 row_ror:8 row_mask:0xf bank_mask:0xc
    v_mov_b32_dpp v78, v82 row_ror:8 row_mask:0xf bank_mask:0x3
    v_mov_b32_dpp v79, v83 row_ror:8 row_mask:0xf bank_mask:0x3
    buffer_store_dwordx4 v[76:79], v214, s[40:43], s99 offen offset:256 sc1
    s_add_u32 s99, s99, 4096
    s_branch L_stored
L_poll:
    buffer_load_dwordx2 v[206:207], v10, s[20:23], s49 offen sc1
    s_sub_u32 s53, s53, 1
    s_cbranch_scc1 L_done
    s_waitcnt vmcnt(0)
    v_xor_b32 v11, s63, v206
    v_xor_b32 v12, s62, v207
    v_and_or_b32 v11, v11, s55, v12
    v_cmpx_ne_u32 vcc, 0, v11
    s_cbranch_execnz L_poll
    s_branch L_polled
L_rank2:
    ds_read_b32 v96, v248 offset:8192
    ds_read_b32 v97, v248 offset:8320
    ds_read_b32 v98, v248 offset:8448
    ds_read_b32 v99, v248 offset:8576
    ds_read_b32 v100, v248 offset:8704
    s_waitcnt lgkmcnt(0)
L_end:
    s_branch L_ranked
.section .rodata,"a"
.p2align 6
.amdhsa_kernel gather_scatter__tensor_product_equiv_mace__graph_kernel
  .amdhsa_next_free_vgpr 256
  .amdhsa_next_free_sgpr 102
  .amdhsa_accum_offset 256
  .amdhsa_group_segment_fixed_size 0
  .amdhsa_kernarg_size 88
  .amdhsa_user_sgpr_count 2
  .amdhsa_user_sgpr_kernarg_segment_ptr 1
  .amdhsa_system_sgpr_workgroup_id_x 1
  .amdhsa_float_denorm_mode_32 3
.end_amdhsa_kernel
```

```asm
; @launch grid=(256,1,1) block=(512,1,1) lds=158784
.amdgcn_target "amdgcn-amd-amdhsa--gfx950"
.text
.globl gather_scatter__tensor_product_equiv_mace__graph_kernel
.p2align 8
.type gather_scatter__tensor_product_equiv_mace__graph_kernel,@function
gather_scatter__tensor_product_equiv_mace__graph_kernel:
    s_cmp_ge_u32 s2, 256
    s_cbranch_scc1 L_done
    s_load_dwordx4 s[4:7], s[0:1], 8
    s_load_dwordx4 s[8:11], s[0:1], 24
    s_load_dwordx2 s[14:15], s[0:1], 80
    s_load_dwordx2 s[64:65], s[0:1], 0
    s_load_dwordx2 s[66:67], s[0:1], 40
    s_load_dwordx4 s[68:71], s[0:1], 48
    s_load_dwordx2 s[12:13], s[0:1], 64
    v_lshlrev_b32 v10, 3, v0
    s_getpc_b64 s[80:81]
L_pc:
    s_and_b32 s44, s2, 0xf8
    s_lshl_b32 s44, s44, 6
    v_and_b32 v11, 0x180, v10
    v_add_u32 v11, s44, v11
    v_min_u32 v11, L_end-L_pc, v11
    v_mov_b32 v113, s81
    v_add_co_u32 v112, vcc, s80, v11
    s_nop 1
    v_addc_co_u32 v113, vcc, 0, v113, vcc
    global_load_dword v205, v[112:113], off
    v_lshrrev_b32 v8, 6, v0
    v_and_b32 v1, 63, v0
    v_lshlrev_b32 v9, 2, v0
    v_mov_b32 v13, 0
    v_readfirstlane_b32 s3, v8
    ds_write_b32 v9, v13 offset:23552
    ds_write_b32 v9, v13 offset:28672
    s_mul_i32 s54, s2, 5000
    s_mul_i32 s55, s2, 10000
    s_mul_i32 s61, s2, 40000
    v_lshlrev_b32 v2, 4, v1
    v_lshlrev_b32 v15, 4, v0
    v_mov_b32 v6, 1
    s_lshl_b32 s52, s3, 10
    s_add_u32 s52, s52, 101376
    s_movk_i32 s53, 4096
    s_movk_i32 s50, 8192
    s_mov_b32 s34, 5000
    s_mov_b32 s35, 0x20000
    s_mov_b32 s38, 5000
    s_mov_b32 s39, 0x20000
    s_mov_b32 s98, 10000
    s_mov_b32 s99, 0x20000
    s_mov_b32 s30, 40000
    s_mov_b32 s31, 0x20000
    s_waitcnt lgkmcnt(0)
    s_add_u32 s32, s6, s54
    s_addc_u32 s33, s7, 0
    buffer_load_dword v64, v9, s[32:35], 0 offen offset:0 nt
    buffer_load_dword v65, v9, s[32:35], 0 offen offset:2048 nt
    buffer_load_dword v66, v9, s[32:35], s53 offen nt
    s_add_u32 s36, s4, s54
    s_addc_u32 s37, s5, 0
    s_barrier
    buffer_load_dword v68, v9, s[36:39], 0 offen offset:0 nt
    buffer_load_dword v69, v9, s[36:39], 0 offen offset:2048 nt
    buffer_load_dword v70, v9, s[36:39], s53 offen nt
    s_load_dword s62, s[14:15], 524288
    s_add_u32 s96, s8, s55
    s_addc_u32 s97, s9, 0
    s_add_u32 s28, s10, s61
    s_addc_u32 s29, s11, 0
    buffer_load_dwordx2 v[72:73], v10, s[96:99], 0 offen nt
    buffer_load_dwordx2 v[74:75], v10, s[96:99], s53 offen nt
    buffer_load_dwordx2 v[76:77], v10, s[96:99], s50 offen nt
    s_add_u32 m0, s52, 0
    s_mov_b32 s54, 0
    buffer_load_dwordx4 v15, s[28:31], s54 offen nt lds
    s_add_u32 m0, s52, 8192
    s_mov_b32 s54, 8192
    buffer_load_dwordx4 v15, s[28:31], s54 offen nt lds
    s_mov_b32 s72, 109951168
    s_movk_i32 s73, 625
    s_movk_i32 s74, 838
    s_movk_i32 s54, 226
    v_cmp_gt_u32 s[84:85], s54, v0
    s_mov_b32 s20, s14
    s_mov_b32 s21, s15
    s_mov_b32 s22, 524352
    s_mov_b32 s23, 0x20000
    v_lshlrev_b32 v11, 2, v0
    v_mov_b32 v12, 0x00700000
    v_mov_b32 v13, 0
    ds_write_b32 v11, v12 offset:0
    ds_write_b32 v11, v12 offset:2048
    ds_write_b32 v11, v12 offset:4096
    ds_write_b32 v11, v12 offset:6144
    ds_write_b32 v11, v13 offset:8192
    ds_write_b32 v11, v13 offset:10240
    ds_write_b32 v11, v13 offset:12288
    ds_write_b32 v11, v13 offset:14336
    s_waitcnt vmcnt(8)
    v_mul_hi_u32 v80, v64, s72
    v_mul_hi_u32 v81, v65, s72
    v_mul_hi_u32 v82, v66, s72
    v_lshlrev_b32 v84, 2, v80
    ds_add_rtn_u32 v88, v84, v6 offset:23552
    v_lshlrev_b32 v85, 2, v81
    ds_add_rtn_u32 v89, v85, v6 offset:23552
    v_lshlrev_b32 v86, 2, v82
    s_mov_b64 exec, s[84:85]
    ds_add_rtn_u32 v90, v86, v6 offset:23552
    s_mov_b64 exec, -1
    s_waitcnt lgkmcnt(0)
    s_barrier
    ds_read_b128 v[100:103], v2 offset:23552
    s_mul_i32 s62, s62, 0x9e3779b1
    s_add_u32 s62, s62, 0x7f4a7c15
    s_mul_i32 s63, s62, 0x85ebca6b
    s_and_b32 s63, s63, 0xffc00000
    v_mad_u32_u24 v92, v80, s73, 15
    v_lshrrev_b32 v92, 4, v92
    v_sub_u32 v92, v64, v92
    v_mad_u32_u24 v93, v81, s73, 15
    v_lshrrev_b32 v93, 4, v93
    v_sub_u32 v93, v65, v93
    v_mad_u32_u24 v94, v82, s73, 15
    v_lshrrev_b32 v94, 4, v94
    v_sub_u32 v94, v66, v94
    s_waitcnt lgkmcnt(0)
    v_add_u32 v11, v100, v101
    v_add3_u32 v11, v11, v102, v103
    v_mov_b32 v12, v11
    s_nop 1
    v_add_u32_dpp v12, v12, v12 row_shr:1 row_mask:0xf bank_mask:0xf
    s_nop 1
    v_add_u32_dpp v12, v12, v12 row_shr:2 row_mask:0xf bank_mask:0xf
    s_nop 1
    v_add_u32_dpp v12, v12, v12 row_shr:4 row_mask:0xf bank_mask:0xf
    s_nop 1
    v_add_u32_dpp v12, v12, v12 row_shr:8 row_mask:0xf bank_mask:0xf
    s_nop 1
    v_add_u32_dpp v12, v12, v12 row_bcast:15 row_mask:0xa bank_mask:0xf
    s_nop 1
    v_add_u32_dpp v12, v12, v12 row_bcast:31 row_mask:0xc bank_mask:0xf
    v_sub_u32 v104, v12, v11
    v_add_u32 v105, v104, v100
    v_add_u32 v106, v105, v101
    v_add_u32 v107, v106, v102
    ds_write_b128 v2, v[104:107] offset:24576
    ds_read_b32 v108, v84 offset:24576
    ds_read_b32 v109, v85 offset:24576
    ds_read_b32 v110, v86 offset:24576
    s_waitcnt vmcnt(5)
    v_mul_u32_u24 v96, s74, v68
    v_bfe_u32 v96, v96, 18, 5
    v_lshl_or_b32 v96, v92, 5, v96
    v_lshlrev_b32 v96, 21, v96
    v_lshl_or_b32 v96, v68, 7, v96
    v_mul_u32_u24 v97, s74, v69
    v_bfe_u32 v97, v97, 18, 5
    v_lshl_or_b32 v97, v93, 5, v97
    v_lshlrev_b32 v97, 21, v97
    v_lshl_or_b32 v97, v69, 7, v97
    v_mul_u32_u24 v98, s74, v70
    v_bfe_u32 v98, v98, 18, 5
    v_lshl_or_b32 v98, v94, 5, v98
    v_lshlrev_b32 v98, 21, v98
    v_lshl_or_b32 v98, v70, 7, v98
    v_lshlrev_b32 v92, 5, v0
    v_add_u32 v93, 16384, v92
    v_add_u32 v94, 32768, v92
    s_mov_b32 s55, 30720
    s_waitcnt vmcnt(2) lgkmcnt(0)
    v_add_u32 v108, v108, v88
    v_lshlrev_b32 v84, 2, v108
    v_mad_u32_u24 v108, v108, 12, s55
    ds_write_b32 v84, v92 offset:25600
    ds_write2_b32 v108, v72, v73 offset0:0 offset1:1
    ds_write_b32 v108, v96 offset:8
    v_add_u32 v109, v109, v89
    v_lshlrev_b32 v85, 2, v109
    v_mad_u32_u24 v109, v109, 12, s55
    ds_write_b32 v85, v93 offset:25600
    ds_write2_b32 v109, v74, v75 offset0:0 offset1:1
    ds_write_b32 v109, v97 offset:8
    v_add_u32 v110, v110, v90
    v_lshlrev_b32 v86, 2, v110
    v_mad_u32_u24 v110, v110, 12, s55
    s_mov_b64 exec, s[84:85]
    ds_write_b32 v86, v94 offset:25600
    ds_write2_b32 v110, v76, v77 offset0:0 offset1:1
    ds_write_b32 v110, v98 offset:8
    s_mov_b64 exec, -1
    s_add_u32 m0, s52, 16384
    s_mov_b32 s54, 16384
    buffer_load_dwordx4 v15, s[28:31], s54 offen nt lds
    s_add_u32 m0, s52, 24576
    s_mov_b32 s54, 24576
    buffer_load_dwordx4 v15, s[28:31], s54 offen nt lds
    s_add_u32 m0, s52, 32768
    s_mov_b32 s54, 32768
    buffer_load_dwordx4 v15, s[28:31], s54 offen nt lds
    s_lshl_b32 s54, s3, 7
    v_lshl_add_u32 v11, v1, 3, s54
    ds_read_b64 v[100:101], v11 offset:23552
    ds_read_b64 v[104:105], v11 offset:24576
    s_mul_i32 s54, s2, 15360
    s_add_u32 s54, s54, 1048576
    s_add_u32 s32, s14, s54
    s_addc_u32 s33, s15, 0
    s_mov_b32 s34, 15360
    s_mov_b32 s35, 0x20000
    s_mul_i32 s54, s2, 40960
    s_add_u32 s54, s54, 5242880
    s_add_u32 s36, s14, s54
    s_addc_u32 s37, s15, 0
    s_mov_b32 s38, 40000
    s_mov_b32 s39, 0x20000
    v_lshrrev_b32 v11, 1, v0
    v_lshlrev_b32 v11, 2, v11
    v_and_b32 v12, 1, v0
    v_lshlrev_b32 v12, 4, v12
    v_add_u32 v12, 101376, v12
    v_add_u32 v14, 30720, v15
    s_waitcnt lgkmcnt(0)
    s_barrier
    ds_read_b128 v[128:131], v14
    ds_read_b128 v[132:135], v14 offset:8192
    ds_read_b32 v156, v11 offset:25600
    ds_read_b32 v157, v11 offset:26624
    ds_read_b32 v158, v11 offset:27648
    ds_read_b32 v159, v11 offset:28672
    ds_read_b32 v160, v11 offset:29696
    s_cmp_lt_u32 s3, 4
    s_cselect_b32 s16, s68, s66
    s_cselect_b32 s17, s69, s67
    s_movk_i32 s54, 128
    s_cselect_b32 s18, s53, s54
    s_mov_b32 s19, 0x20000
    s_min_u32 s54, s3, 5
    s_lshl_b32 s54, s54, 10
    s_add_u32 m0, s54, 17408
    s_and_b32 s54, s54, 0xc00
    buffer_load_dwordx4 v2, s[16:19], s54 offen lds
    s_mov_b32 s40, s70
    s_mov_b32 s41, s71
    s_mov_b32 s42, 32768
    s_mov_b32 s43, 0x20000
    s_lshl_b32 s55, s3, 12
    s_add_u32 m0, s55, 46080
    s_nop 0
    buffer_load_dwordx4 v2, s[40:43], s55 offen offset:0 lds
    buffer_load_dwordx4 v2, s[40:43], s55 offen offset:1024 lds
    buffer_load_dwordx4 v2, s[40:43], s55 offen offset:2048 lds
    buffer_load_dwordx4 v2, s[40:43], s55 offen offset:3072 lds
    s_waitcnt lgkmcnt(0)
    v_add_u32 v156, v12, v156
    v_add_u32 v157, v12, v157
    v_add_u32 v158, v12, v158
    v_add_u32 v159, v12, v159
    v_add_u32 v160, v12, v160
    v_lshl_or_b32 v112, v100, 11, v104
    v_or_b32 v112, s63, v112
    v_mov_b32 v113, s62
    v_lshl_or_b32 v114, v101, 11, v105
    v_or_b32 v114, s63, v114
    v_mov_b32 v115, s62
    s_waitcnt vmcnt(0)
    s_barrier
    ds_read_b128 v[136:139], v156
    ds_read_b128 v[140:143], v157
    ds_read_b128 v[144:147], v158
    ds_read_b128 v[148:151], v159
    ds_read_b128 v[152:155], v160
    buffer_store_dwordx4 v[128:131], v15, s[32:35], 0 offen sc1
    buffer_store_dwordx4 v[132:135], v15, s[32:35], s50 offen sc1
    s_mov_b32 s54, 0
    s_waitcnt lgkmcnt(4)
    buffer_store_dwordx4 v[136:139], v15, s[36:39], s54 offen sc1
    s_mov_b32 s54, 8192
    s_waitcnt lgkmcnt(3)
    buffer_store_dwordx4 v[140:143], v15, s[36:39], s54 offen sc1
    s_mov_b32 s54, 16384
    s_waitcnt lgkmcnt(2)
    buffer_store_dwordx4 v[144:147], v15, s[36:39], s54 offen sc1
    s_mov_b32 s54, 24576
    s_waitcnt lgkmcnt(1)
    buffer_store_dwordx4 v[148:151], v15, s[36:39], s54 offen sc1
    s_mov_b32 s54, 32768
    s_waitcnt lgkmcnt(0)
    buffer_store_dwordx4 v[152:155], v15, s[36:39], s54 offen sc1
    s_and_b32 s44, s2, 7
    s_lshl_b32 s44, s44, 5
    s_lshr_b32 s54, s2, 3
    s_add_u32 s44, s44, s54
    s_mul_i32 s45, s44, 625
    s_add_u32 s46, s45, 640
    s_add_u32 s45, s45, 15
    s_lshr_b32 s45, s45, 4
    s_lshr_b32 s46, s46, 4
    s_sub_u32 s46, s46, s45
    v_bfe_i32 v168, v1, 2, 1
    v_and_b32 v168, 0xaaaa, v168
    v_add_u32 v168, 0x4444, v168
    v_mov_b32 v169, 158720
    v_and_b32 v11, 60, v9
    v_add_u32 v11, v11, v169
    ds_write_b32 v11, v13
    v_and_b32 v11, 4, v1
    v_lshlrev_b32 v11, 2, v11
    v_mov_b32 v12, 0xffff
    v_lshlrev_b32 v12, v11, v12
    v_bfe_i32 v11, v1, 3, 1
    v_and_b32 v191, v11, v12
    v_xor_b32 v190, v191, v12
    v_lshrrev_b32 v200, 5, v1
    v_lshlrev_b32 v200, 4, v200
    v_add_u32 v200, 101376, v200
    v_and_b32 v201, 15, v1
    v_lshlrev_b32 v201, 2, v201
    v_bfe_u32 v11, v1, 3, 2
    v_and_b32 v12, 3, v1
    v_lshl_add_u32 v11, v11, 2, v12
    v_lshlrev_b32 v202, 2, v11
    v_bfe_i32 v240, v0, 0, 1
    s_lshl_b32 s54, s3, 10
    v_and_b32 v241, 4, v240
    v_add_u32 v241, s54, v241
    v_lshl_add_u32 v242, v1, 2, s54
    v_lshrrev_b32 v243, 1, v1
    v_lshl_add_u32 v243, v243, 2, s54
    v_mul_u32_u24 v244, 12, v1
    v_and_b32 v245, 12, v242
    v_and_b32 v250, 124, v242
    s_mul_i32 s54, s3, 224
    v_add_u32 v247, s54, v1
    v_lshlrev_b32 v246, 3, v247
    v_add_u32 v246, 87040, v246
    v_lshlrev_b32 v247, 21, v247
    s_mul_i32 s54, s3, 640
    v_add_u32 v248, s54, v250
    v_sub_u32 v249, 63, v1
    s_getreg_b32 s86, hwreg(HW_REG_XCC_ID, 0, 3)
    s_lshl_b32 s54, s86, 4
    v_subrev_u32 v250, s54, v250
    v_and_b32 v250, 124, v250
    s_lshl_b32 s54, s3, 5
    v_lshl_add_u32 v251, v1, 2, s54
    v_lshrrev_b32 v252, 3, v1
    v_mul_u32_u24 v252, 64, v252
    v_add_u32 v252, 78848, v252
    s_cmp_eq_u32 s46, 40
    v_mov_b32 v203, 0
    s_mov_b32 s54, 685900808
    s_cselect_b32 s54, 568459824, s54
    s_mov_b32 exec_lo, 31
    s_mov_b32 exec_hi, 0
    v_mov_b32 v203, s54
    s_mov_b32 s54, 182814793
    s_cselect_b32 s54, 23232528, s54
    s_mov_b32 exec_lo, 992
    s_mov_b32 exec_hi, 0
    v_mov_b32 v203, s54
    s_mov_b32 s54, 984091248
    s_cselect_b32 s54, 719688297, s54
    s_mov_b32 exec_lo, 31744
    s_mov_b32 exec_hi, 0
    v_mov_b32 v203, s54
    s_mov_b32 s54, 424091761
    s_cselect_b32 s54, 984423522, s54
    s_mov_b32 exec_lo, 1015808
    s_mov_b32 exec_hi, 0
    v_mov_b32 v203, s54
    s_mov_b32 s54, 586001611
    s_cselect_b32 s54, 172635826, s54
    s_mov_b32 exec_lo, 32505856
    s_mov_b32 exec_hi, 0
    v_mov_b32 v203, s54
    s_mov_b32 s54, 64039106
    s_cselect_b32 s54, 454017211, s54
    s_mov_b32 exec_lo, 1040187392
    s_mov_b32 exec_hi, 0
    v_mov_b32 v203, s54
    s_mov_b32 s54, 330320603
    s_cselect_b32 s54, 743654643, s54
    s_mov_b32 exec_lo, 3221225472
    s_mov_b32 exec_hi, 7
    v_mov_b32 v203, s54
    s_mov_b32 s54, 217139484
    s_cselect_b32 s54, 607143691, s54
    s_mov_b32 exec_lo, 0
    s_mov_b32 exec_hi, 248
    v_mov_b32 v203, s54
    s_mov_b64 exec, -1
    v_mul_u32_u24 v11, 52, v1
    v_lshrrev_b32 v11, 8, v11
    v_mad_i32_i24 v11, v11, -5, v1
    v_mul_u32_u24 v11, 6, v11
    v_lshrrev_b32 v203, v11, v203
    v_and_b32 v11, 7, v203
    v_bfe_u32 v203, v203, 3, 3
    v_lshlrev_b32 v11, 12, v11
    v_lshl_or_b32 v203, v203, 7, v11
    s_add_u32 s24, s14, 1048576
    s_addc_u32 s25, s15, 0
    s_mov_b32 s26, 3932160
    s_mov_b32 s27, 0x20000
    v_mov_b32 v16, 0
    v_mov_b32 v17, 0
    v_mov_b32 v18, 0
    v_mov_b32 v19, 0
    v_mov_b32 v20, 0
    v_mov_b32 v21, 0
    v_mov_b32 v22, 0
    v_mov_b32 v23, 0
    v_mov_b32 v24, 0
    v_mov_b32 v25, 0
    v_mov_b32 v26, 0
    v_mov_b32 v27, 0
    v_mov_b32 v28, 0
    v_mov_b32 v29, 0
    v_mov_b32 v30, 0
    v_mov_b32 v31, 0
    v_mov_b32 v32, 0
    v_mov_b32 v33, 0
    v_mov_b32 v34, 0
    v_mov_b32 v35, 0
    v_mov_b32 v36, 0
    v_mov_b32 v37, 0
    v_mov_b32 v38, 0
    v_mov_b32 v39, 0
    v_mov_b32 v40, 0
    v_mov_b32 v41, 0
    v_mov_b32 v42, 0
    v_mov_b32 v43, 0
    v_mov_b32 v44, 0
    v_mov_b32 v45, 0
    v_mov_b32 v46, 0
    v_mov_b32 v47, 0
    v_mov_b32 v48, 0
    v_mov_b32 v49, 0
    v_mov_b32 v50, 0
    v_mov_b32 v51, 0
    v_mov_b32 v52, 0
    v_mov_b32 v53, 0
    v_mov_b32 v54, 0
    v_mov_b32 v55, 0
    v_mov_b32 v56, 0
    v_mov_b32 v57, 0
    v_mov_b32 v58, 0
    v_mov_b32 v59, 0
    v_mov_b32 v60, 0
    v_mov_b32 v61, 0
    v_mov_b32 v62, 0
    v_mov_b32 v63, 0
    s_lshl_b32 s54, s2, 3
    s_add_u32 s54, s54, s3
    s_lshl_b32 s54, s54, 8
    s_mov_b32 s16, s64
    s_mov_b32 s17, s65
    s_mov_b32 s18, 10240000
    s_mov_b32 s19, 0x20000
    s_add_u32 s28, s14, 5242880
    s_addc_u32 s29, s15, 0
    s_mov_b32 s30, 10485760
    s_mov_b32 s31, 0x20000
    s_and_b32 s51, s86, 7
    s_mul_i32 s51, s51, 1282048
    s_and_b32 s55, s2, 0xf8
    s_add_u32 s55, s55, s3
    s_mul_i32 s55, s55, 2304
    s_add_u32 s51, s51, s55
    v_min_u32 v14, 17, v1
    v_lshlrev_b32 v14, 7, v14
    s_waitcnt vmcnt(0)
    s_barrier
    s_mov_b64 exec, 0xffff
    buffer_store_dwordx4 v[112:115], v2, s[20:23], s54 offen sc1
    s_mov_b64 exec, -1
    buffer_load_dword v7, v14, s[16:19], s51 offen
    s_lshl_b32 s54, s45, 10
    s_add_u32 s40, s12, s54
    s_addc_u32 s41, s13, 0
    s_lshl_b32 s42, s46, 10
    s_mov_b32 s43, 0x20000
    v_lshrrev_b32 v8, 5, v1
    v_lshlrev_b32 v8, 10, v8
    v_and_b32 v9, 15, v1
    v_lshl_add_u32 v8, v9, 4, v8
    ds_read_b128 v[64:67], v8 offset:17408
    ds_read_b128 v[68:71], v8 offset:17664
    ds_read_b128 v[72:75], v8 offset:17920
    ds_read_b128 v[76:79], v8 offset:18176
    ds_read_b128 v[80:83], v8 offset:19456
    ds_read_b128 v[84:87], v8 offset:19712
    ds_read_b128 v[88:91], v8 offset:19968
    ds_read_b128 v[92:95], v8 offset:20224
    v_lshrrev_b32 v8, 4, v1
    v_lshlrev_b32 v8, 5, v8
    v_and_b32 v9, 3, v1
    v_lshl_add_u32 v8, v9, 1, v8
    ds_read_u16 v96, v8 offset:21504
    ds_read_u16 v97, v8 offset:21512
    ds_read_u16 v98, v8 offset:21520
    ds_read_u16 v99, v8 offset:21528
    v_bfe_i32 v10, v1, 4, 1
    v_and_b32 v10, 0x02020202, v10
    v_add_u32 v10, 0x05040100, v10
    s_waitcnt lgkmcnt(0)
    v_perm_b32 v172, v68, v64, v10
    v_perm_b32 v174, v76, v72, v10
    v_perm_b32 v176, v84, v80, v10
    v_perm_b32 v178, v92, v88, v10
    v_perm_b32 v173, v69, v65, v10
    v_perm_b32 v175, v77, v73, v10
    v_perm_b32 v177, v85, v81, v10
    v_perm_b32 v179, v93, v89, v10
    v_perm_b32 v180, v70, v66, v10
    v_perm_b32 v182, v78, v74, v10
    v_perm_b32 v184, v86, v82, v10
    v_perm_b32 v186, v94, v90, v10
    v_perm_b32 v181, v71, v67, v10
    v_perm_b32 v183, v79, v75, v10
    v_perm_b32 v185, v87, v83, v10
    v_perm_b32 v187, v95, v91, v10
    v_lshl_or_b32 v188, v97, 16, v96
    v_lshl_or_b32 v189, v99, 16, v98
    v_and_b32 v9, 7, v1
    v_lshrrev_b32 v8, 4, v1
    v_lshlrev_b32 v8, 13, v8
    v_lshl_add_u32 v8, v9, 4, v8
    v_and_b32 v9, 8, v1
    s_and_b32 s72, s3, 3
    s_lshl_b32 s72, s72, 8
    s_lshr_b32 s73, s3, 2
    s_lshl_b32 s73, s73, 7
    s_add_u32 s72, s72, s73
    s_add_u32 s72, s72, 46080
    v_add3_u32 v8, v8, v9, s72
    ds_read2st64_b64 v[128:131], v8 offset0:0 offset1:2
    ds_read2st64_b64 v[132:135], v8 offset0:4 offset1:6
    ds_read2st64_b64 v[136:139], v8 offset0:8 offset1:10
    ds_read2st64_b64 v[140:143], v8 offset0:12 offset1:14
    s_mov_b32 s72, 0x05040100
    s_mov_b32 s73, 0x07060302
    s_waitcnt lgkmcnt(3)
    v_perm_b32 v144, v130, v128, s72
    v_perm_b32 v148, v130, v128, s73
    v_perm_b32 v152, v131, v129, s72
    v_perm_b32 v156, v131, v129, s73
    s_waitcnt lgkmcnt(2)
    v_perm_b32 v145, v134, v132, s72
    v_perm_b32 v149, v134, v132, s73
    v_perm_b32 v153, v135, v133, s72
    v_perm_b32 v157, v135, v133, s73
    s_waitcnt lgkmcnt(1)
    v_perm_b32 v146, v138, v136, s72
    v_perm_b32 v150, v138, v136, s73
    v_perm_b32 v154, v139, v137, s72
    v_perm_b32 v158, v139, v137, s73
    s_waitcnt lgkmcnt(0)
    v_perm_b32 v147, v142, v140, s72
    v_perm_b32 v151, v142, v140, s73
    v_perm_b32 v155, v143, v141, s72
    v_perm_b32 v159, v143, v141, s73
    s_lshl_b32 s54, s3, 12
    v_add_u32 v8, s54, v2
    v_lshrrev_b32 v9, 1, v0
    v_lshlrev_b32 v10, 11, v9
    s_lshl_b32 s49, s44, 3
    v_mul_u32_u24 v5, 1280, v9
    s_mov_b32 s48, 0
    s_mov_b32 s53, 200000
    s_mov_b32 s55, 0xffc00000
    s_mul_i32 s52, s3, 7168
    s_add_u32 s52, s52, 101376
    s_movk_i32 s98, 4096
    s_waitcnt vmcnt(0)
    s_barrier
    buffer_load_dwordx2 v[206:207], v10, s[20:23], s49 offen sc1
    ds_write_b128 v8, v[144:147] offset:46080
    ds_write_b128 v8, v[148:151] offset:47104
    ds_write_b128 v8, v[152:155] offset:48128
    ds_write_b128 v8, v[156:159] offset:49152
    s_waitcnt vmcnt(0)
    v_xor_b32 v11, s63, v206
    v_xor_b32 v12, s62, v207
    v_and_or_b32 v11, v11, s55, v12
    v_cmpx_ne_u32 vcc, 0, v11
    s_cbranch_execnz L_poll
L_polled:
    s_mov_b64 exec, -1
    v_bfe_u32 v3, v206, 11, 11
    v_and_b32 v4, v3, v240
    v_add_u32 v10, v3, v240
    v_and_b32 v11, 0x7ff, v206
    v_add_u32_dpp v4, v4, v4 row_shr:1 row_mask:0xf bank_mask:0xf
    v_cmp_lt_i32 s[64:65], 0, v10
    v_cmp_lt_i32 s[66:67], 2, v10
    v_add_u32_dpp v4, v4, v4 row_shr:2 row_mask:0xf bank_mask:0xf
    v_cmp_lt_i32 s[68:69], 4, v10
    v_cmp_lt_i32 s[70:71], 6, v10
    v_add_u32_dpp v4, v4, v4 row_shr:4 row_mask:0xf bank_mask:0xf
    v_cmp_lt_i32 s[72:73], 8, v10
    v_cmp_lt_i32 s[74:75], 10, v10
    v_add_u32_dpp v4, v4, v4 row_shr:8 row_mask:0xf bank_mask:0xf
    v_cmp_lt_i32 s[76:77], 12, v10
    v_cmp_lt_i32 s[78:79], 14, v10
    v_add_u32_dpp v4, v4, v4 row_bcast:15 row_mask:0xa bank_mask:0xf
    v_add_u32 v5, v5, v11
    s_nop 0
    v_add_u32_dpp v4, v4, v4 row_bcast:31 row_mask:0xc bank_mask:0xf
    s_nop 0
    v_readlane_b32 s95, v4, 63
    v_mov_b32_dpp v4, v4 quad_perm:[0,0,2,2] row_mask:0xf bank_mask:0xf
    v_sub_u32 v5, v5, v4
    v_lshl_add_u32 v8, v4, 2, v241
    s_cmp_gt_u32 s95, 224
    s_cbranch_scc1 L_clip
L_mapw:
    s_mov_b64 exec, s[64:65]
    ds_write_b32 v8, v5 offset:0
    s_mov_b64 exec, s[66:67]
    ds_write_b32 v8, v5 offset:8
    s_mov_b64 exec, s[68:69]
    ds_write_b32 v8, v5 offset:16
    s_mov_b64 exec, s[70:71]
    ds_write_b32 v8, v5 offset:24
    s_mov_b64 exec, s[72:73]
    ds_write_b32 v8, v5 offset:32
    s_mov_b64 exec, s[74:75]
    ds_write_b32 v8, v5 offset:40
    s_mov_b64 exec, s[76:77]
    ds_write_b32 v8, v5 offset:48
    s_mov_b64 exec, -1
    s_cmp_lg_u64 s[78:79], 0
    s_cbranch_scc1 L_map2
    ds_read_b32 v64, v242 offset:0
    ds_read_b32 v65, v242 offset:256
    ds_read_b32 v66, v242 offset:512
    ds_read_b32 v68, v243 offset:0
    ds_read_b32 v69, v243 offset:128
    ds_read_b32 v70, v243 offset:256
    ds_read_b32 v71, v243 offset:384
    ds_read_b32 v72, v243 offset:512
    ds_read_b32 v73, v243 offset:640
    s_cmp_gt_i32 s95, 192
    s_cbranch_scc1 L_r1
L_r1b:
    s_waitcnt lgkmcnt(6)
    v_mad_u32_u24 v64, v64, 12, v244
    buffer_load_dwordx3 v[76:78], v64, s[24:27], 0 offen offset:0 sc1
    v_mad_u32_u24 v65, v65, 12, v244
    buffer_load_dwordx3 v[80:82], v65, s[24:27], 0 offen offset:768 sc1
    v_mad_u32_u24 v66, v66, 12, v244
    buffer_load_dwordx3 v[84:86], v66, s[24:27], 0 offen offset:1536 sc1
    v_mov_b32 v11, s95
    s_mov_b64 exec, 1
    ds_max_i32 v13, v11 offset:15360
    s_mov_b64 exec, -1
    s_waitcnt lgkmcnt(1)
    v_lshl_add_u32 v68, v68, 5, v2
    v_lshl_add_u32 v69, v69, 5, v2
    v_lshl_add_u32 v70, v70, 5, v2
    v_lshl_add_u32 v71, v71, 5, v2
    v_lshl_add_u32 v72, v72, 5, v2
    v_lshl_add_u32 v73, v73, 5, v2
    s_barrier
    s_add_u32 m0, s52, 0
    s_nop 0
    buffer_load_dwordx4 v68, s[28:31], 0 offen offset:0 sc1 lds
    v_add_u32 v11, 0, v1
    v_cmp_gt_i32 s[80:81], s95, v11
    v_add_u32 v11, 64, v1
    v_cmp_gt_i32 s[82:83], s95, v11
    v_add_u32 v11, 128, v1
    v_cmp_gt_i32 s[84:85], s95, v11
    v_add_u32 v11, 192, v1
    v_cmp_gt_i32 s[96:97], s95, v11
    s_mov_b32 s55, 0x1fff80
    s_mul_i32 s61, s3, 5
    s_mov_b32 s97, 0
    s_waitcnt vmcnt(3)
    v_lshrrev_b32 v132, 21, v78
    v_lshlrev_b32 v132, 2, v132
    v_lshrrev_b32 v11, 26, v78
    v_lshl_or_b32 v11, v11, 4, v245
    s_mov_b64 exec, s[80:81]
    ds_add_rtn_u32 v128, v132, v6 offset:8192
    ds_add_u32 v11, v6 offset:14336
    s_mov_b64 exec, -1
    s_waitcnt vmcnt(2)
    v_lshrrev_b32 v133, 21, v82
    v_lshlrev_b32 v133, 2, v133
    v_lshrrev_b32 v11, 26, v82
    v_lshl_or_b32 v11, v11, 4, v245
    s_mov_b64 exec, s[82:83]
    ds_add_rtn_u32 v129, v133, v6 offset:8192
    ds_add_u32 v11, v6 offset:14336
    s_mov_b64 exec, -1
    s_waitcnt vmcnt(1)
    v_lshrrev_b32 v134, 21, v86
    v_lshlrev_b32 v134, 2, v134
    v_lshrrev_b32 v11, 26, v86
    v_lshl_or_b32 v11, v11, 4, v245
    s_mov_b64 exec, s[84:85]
    ds_add_rtn_u32 v130, v134, v6 offset:8192
    ds_add_u32 v11, v6 offset:14336
    s_mov_b64 exec, -1
    s_cmp_gt_i32 s95, 192
    s_cbranch_scc1 L_r2
L_r2b:
    ds_write_b64 v246, v[76:77] offset:0
    v_and_or_b32 v78, v78, s55, v247
    ds_write_b64 v246, v[80:81] offset:512
    v_and_or_b32 v82, v82, s55, v247
    v_add_u32 v82, 134217728, v82
    ds_write_b64 v246, v[84:85] offset:1024
    v_and_or_b32 v86, v86, s55, v247
    v_add_u32 v86, 268435456, v86
    s_add_u32 m0, s52, 0
    s_nop 0
    buffer_load_dwordx4 v69, s[28:31], 0 offen offset:1024 sc1 lds
    s_add_u32 m0, s52, 0
    s_nop 0
    buffer_load_dwordx4 v70, s[28:31], 0 offen offset:2048 sc1 lds
    s_waitcnt lgkmcnt(3)
    s_barrier
    s_cmp_lg_u32 s48, 0
    s_cbranch_scc1 L_rank2
    ds_read_b128 v[104:107], v2 offset:14336
    ds_read_b32 v96, v248 offset:8192
    ds_read_b32 v97, v248 offset:8320
    ds_read_b32 v98, v248 offset:8448
    ds_read_b32 v99, v248 offset:8576
    ds_read_b32 v100, v248 offset:8704
    ds_read_b32 v14, v13 offset:15360
    s_add_u32 s65, s61, 1
    s_add_u32 s66, s61, 2
    s_add_u32 s67, s61, 3
    s_add_u32 s68, s61, 4
    s_waitcnt lgkmcnt(6)
    v_add_u32 v9, v104, v105
    v_add3_u32 v9, v9, v106, v107
    v_lshl_or_b32 v9, v9, 6, v249
    s_nop 0
    v_readlane_b32 s64, v9, s61
    v_readlane_b32 s65, v9, s65
    v_readlane_b32 s66, v9, s66
    v_readlane_b32 s67, v9, s67
    v_readlane_b32 s68, v9, s68
    v_cmp_lt_u32 s[70:71], s64, v9
    v_cmp_lt_u32 s[72:73], s65, v9
    v_cmp_lt_u32 s[74:75], s66, v9
    v_cmp_lt_u32 s[76:77], s67, v9
    v_cmp_lt_u32 s[78:79], s68, v9
    s_bcnt1_i32_b64 s64, s[70:71]
    s_bcnt1_i32_b64 s65, s[72:73]
    s_bcnt1_i32_b64 s66, s[74:75]
    s_bcnt1_i32_b64 s67, s[76:77]
    s_bcnt1_i32_b64 s68, s[78:79]
    s_waitcnt lgkmcnt(0)
    v_readlane_b32 s90, v203, s64
    v_readlane_b32 s91, v203, s65
    v_readlane_b32 s92, v203, s66
    v_readlane_b32 s93, v203, s67
    v_readlane_b32 s94, v203, s68
    v_readfirstlane_b32 s47, v14
L_ranked:
    s_mov_b32 exec_hi, 0
    s_and_b32 s54, s90, 0x380
    v_add_u32 v104, s54, v250
    ds_add_rtn_u32 v96, v104, v96 offset:13312
    s_and_b32 s54, s91, 0x380
    v_add_u32 v105, s54, v250
    ds_add_rtn_u32 v97, v105, v97 offset:13312
    s_and_b32 s54, s92, 0x380
    v_add_u32 v106, s54, v250
    ds_add_rtn_u32 v98, v106, v98 offset:13312
    s_and_b32 s54, s93, 0x380
    v_add_u32 v107, s54, v250
    ds_add_rtn_u32 v99, v107, v99 offset:13312
    s_and_b32 s54, s94, 0x380
    v_add_u32 v108, s54, v250
    ds_add_rtn_u32 v100, v108, v100 offset:13312
    v_or_b32 v104, s90, v104
    v_or_b32 v105, s91, v105
    v_or_b32 v106, s92, v106
    v_or_b32 v107, s93, v107
    v_or_b32 v108, s94, v108
    v_writelane_b32 v11, s90, 0
    v_writelane_b32 v11, s91, 1
    v_writelane_b32 v11, s92, 2
    v_writelane_b32 v11, s93, 3
    v_writelane_b32 v11, s94, 4
    s_waitcnt lgkmcnt(4)
    v_lshl_or_b32 v96, v96, 16, v104
    ds_write_b32 v248, v96 offset:8192
    s_waitcnt lgkmcnt(4)
    v_lshl_or_b32 v97, v97, 16, v105
    ds_write_b32 v248, v97 offset:8320
    s_waitcnt lgkmcnt(4)
    v_lshl_or_b32 v98, v98, 16, v106
    ds_write_b32 v248, v98 offset:8448
    s_waitcnt lgkmcnt(4)
    v_lshl_or_b32 v99, v99, 16, v107
    ds_write_b32 v248, v99 offset:8576
    s_waitcnt lgkmcnt(4)
    v_lshl_or_b32 v100, v100, 16, v108
    ds_write_b32 v248, v100 offset:8704
    v_add_lshl_u32 v12, v1, s61, 7
    v_lshrrev_b32 v9, 10, v11
    v_bfe_u32 v11, v11, 2, 8
    v_or_b32 v11, v11, v9
    s_mov_b32 exec_lo, 31
    ds_write_b32 v11, v12 offset:15616
    s_mov_b64 exec, -1
    s_add_u32 m0, s52, 0
    s_nop 0
    buffer_load_dwordx4 v71, s[28:31], 0 offen offset:3072 sc1 lds
    s_add_u32 m0, s52, 4096
    s_nop 0
    buffer_load_dwordx4 v72, s[28:31], s98 offen offset:0 sc1 lds
    s_add_u32 m0, s52, 4096
    s_nop 0
    buffer_load_dwordx4 v73, s[28:31], s98 offen offset:1024 sc1 lds
    s_lshl_b32 s54, s3, 3
    s_add_u32 s55, s54, 7
    s_waitcnt lgkmcnt(0)
    s_barrier
    ds_read_b128 v[96:99], v2 offset:13312
    ds_read_b32 v132, v132 offset:8192
    ds_read_b32 v133, v133 offset:8192
    ds_read_b32 v134, v134 offset:8192
    ds_read_b32 v11, v251 offset:15616
    s_waitcnt lgkmcnt(4)
    v_add_u32 v9, v96, v97
    v_add3_u32 v9, v9, v98, v99
    v_mov_b32 v10, v9
    s_waitcnt lgkmcnt(1)
    v_bfe_u32 v15, v132, 12, 3
    v_add_u32_dpp v10, v10, v10 row_shr:1 row_mask:0xf bank_mask:0xf
    v_or_b32 v78, v15, v78
    v_and_b32 v64, 0x3ff, v132
    v_add_u32_dpp v10, v10, v10 row_shr:2 row_mask:0xf bank_mask:0xf
    v_lshrrev_b32 v132, 16, v132
    v_add_u32 v132, v132, v128
    v_add_u32_dpp v10, v10, v10 row_shr:4 row_mask:0xf bank_mask:0xf
    v_bfe_u32 v15, v133, 12, 3
    v_or_b32 v82, v15, v82
    v_add_u32_dpp v10, v10, v10 row_shr:8 row_mask:0xf bank_mask:0xf
    v_and_b32 v65, 0x3ff, v133
    v_lshrrev_b32 v133, 16, v133
    v_add_u32_dpp v10, v10, v10 row_bcast:15 row_mask:0xa bank_mask:0xf
    v_add_u32 v133, v133, v129
    v_bfe_u32 v15, v134, 12, 3
    v_add_u32_dpp v10, v10, v10 row_bcast:31 row_mask:0xc bank_mask:0xf
    v_or_b32 v86, v15, v86
    v_and_b32 v66, 0x3ff, v134
    v_sub_u32 v9, v10, v9
    v_lshl_add_u32 v104, v9, 2, v252
    v_lshl_add_u32 v105, v96, 2, v104
    v_lshl_add_u32 v106, v97, 2, v105
    v_lshl_add_u32 v107, v98, 2, v106
    ds_write_b128 v2, v[104:107] offset:16384
    ds_read_b32 v64, v64 offset:16384
    ds_read_b32 v65, v65 offset:16384
    ds_read_b32 v66, v66 offset:16384
    v_lshrrev_b32 v134, 16, v134
    v_add_u32 v134, v134, v130
    v_readlane_b32 s50, v10, s55
    v_readlane_b32 s53, v9, s54
    v_readlane_b32 s51, v104, s54
    v_mov_b32 v12, 2097029
    s_sub_u32 s50, s50, s53
    s_lshl_b32 s54, s50, 2
    v_add_u32 v198, s51, v201
    v_add_u32 v199, s51, v202
    v_add_u32 v9, s54, v198
    s_waitcnt lgkmcnt(2)
    v_lshl_add_u32 v132, v132, 2, v64
    s_mov_b64 exec, s[80:81]
    ds_write_b32 v132, v78
    s_mov_b64 exec, -1
    s_waitcnt lgkmcnt(2)
    v_lshl_add_u32 v133, v133, 2, v65
    s_mov_b64 exec, s[82:83]
    ds_write_b32 v133, v82
    s_mov_b64 exec, -1
    s_waitcnt lgkmcnt(2)
    v_lshl_add_u32 v134, v134, 2, v66
    s_mov_b64 exec, s[84:85]
    ds_write_b32 v134, v86
    s_mov_b64 exec, -1
    ds_write_b32 v9, v12
    s_cmp_gt_i32 s95, 192
    s_cbranch_scc1 L_r3
L_r3b:
    v_readlane_b32 s56, v11, 0
    v_readlane_b32 s57, v11, 1
    v_readlane_b32 s58, v11, 2
    v_readlane_b32 s59, v11, 3
    v_readlane_b32 s60, v11, 4
    v_lshlrev_b32 v8, 2, v1
    s_mul_i32 s54, s56, 9
    v_add_u32 v208, s54, v8
    s_mul_i32 s54, s57, 9
    v_add_u32 v209, s54, v8
    s_mul_i32 s54, s58, 9
    v_add_u32 v210, s54, v8
    s_mul_i32 s54, s59, 9
    v_add_u32 v211, s54, v8
    s_mul_i32 s54, s60, 9
    v_add_u32 v212, s54, v8
    s_lshr_b32 s99, s3, 1
    s_mul_i32 s99, s99, 3
    s_min_u32 s99, s99, 8
    s_mul_i32 s55, s99, 4608
    v_and_b32 v8, 15, v1
    v_lshrrev_b32 v9, 4, v1
    v_mul_u32_u24 v213, 288, v8
    v_lshl_add_u32 v213, v9, 4, v213
    v_add_u32 v213, s55, v213
    v_lshrrev_b32 v9, 3, v1
    v_lshlrev_b32 v9, 9, v9
    v_and_b32 v8, 7, v1
    v_lshl_add_u32 v214, v8, 4, v9
    s_lshl_b32 s99, s99, 12
    s_and_b32 s55, s3, 1
    s_lshl_b32 s54, s55, 7
    s_add_u32 s99, s99, s54
    s_lshl_b32 s55, s55, 14
    s_add_u32 s55, s55, 46080
    v_add_u32 v215, s55, v2
    v_mov_b32 v64, 0
    v_mov_b32 v65, 0
    v_mov_b32 v66, 0
    v_mov_b32 v67, 0
    v_mov_b32 v68, 0
    v_mov_b32 v69, 0
    v_mov_b32 v70, 0
    v_mov_b32 v71, 0
    v_mov_b32 v72, 0
    v_mov_b32 v73, 0
    v_mov_b32 v74, 0
    v_mov_b32 v75, 0
    v_mov_b32 v76, 0
    v_mov_b32 v77, 0
    v_mov_b32 v78, 0
    v_mov_b32 v79, 0
    v_mov_b32 v80, 0
    v_mov_b32 v81, 0
    v_mov_b32 v82, 0
    v_mov_b32 v83, 0
    v_mov_b32 v84, 0
    v_mov_b32 v85, 0
    v_mov_b32 v86, 0
    v_mov_b32 v87, 0
    v_mov_b32 v88, 0
    v_mov_b32 v89, 0
    v_mov_b32 v90, 0
    v_mov_b32 v91, 0
    v_mov_b32 v92, 0
    v_mov_b32 v93, 0
    v_mov_b32 v94, 0
    v_mov_b32 v95, 0
    ds_read_b128 v[216:219], v215 offset:0
    ds_read_b128 v[220:223], v215 offset:1024
    ds_read_b128 v[224:227], v215 offset:2048
    ds_read_b128 v[228:231], v215 offset:3072
    ds_read_b128 v[232:235], v215 offset:4096
    ds_read_b128 v[236:239], v215 offset:5120
    s_add_u32 s54, s50, 1
    s_and_b32 s54, s54, -2
    s_add_u32 s53, s54, 15
    s_lshr_b32 s53, s53, 4
    s_sub_u32 s54, 0, s54
    s_and_b32 s54, s54, 15
    s_sub_u32 s53, s53, 1
    s_cmp_gt_i32 s53, 0
    s_cselect_b32 s54, s54, 0
    s_lshl_b32 s61, s54, 2
    v_subrev_u32 v198, s61, v198
    v_subrev_u32 v199, s61, v199
    s_and_b32 s61, s61, 32
    v_add_u32 v12, s61, v198
    s_and_b32 s72, s54, 6
    s_mov_b32 s55, 0x00fffc38
    s_mov_b32 s49, 0xffffff00
    s_mov_b32 s51, 87040
    s_cmp_lt_u32 s3, 4
    s_cbranch_scc1 L_np
    s_setprio 1
L_np:
    s_waitcnt vmcnt(0) lgkmcnt(0)
    s_barrier
    ds_read_b32 v196, v12
    ds_read_b32 v194, v199
    ds_read_b32 v197, v198 offset:24
    s_cmp_eq_u32 s50, 0
    s_cbranch_scc1 L_swept
    s_waitcnt lgkmcnt(1)
    v_lshlrev_b32 v196, 3, v196
    v_and_b32 v196, s55, v196
    v_lshrrev_b32 v8, 21, v194
    v_lshl_add_u32 v11, v8, 3, s51
    v_lshl_add_u32 v8, v8, 5, v200
    ds_read_b64 v[192:193], v11
    ds_read_b128 v[164:167], v8
    s_cmp_eq_u32 s72, 2
    s_cbranch_scc1 L_p2
    s_cmp_eq_u32 s72, 4
    s_cbranch_scc1 L_p4
    s_cmp_eq_u32 s72, 6
    s_cbranch_scc1 L_p6
L_p0:
    v_readlane_b32 s64, v196, 0
    v_readlane_b32 s65, v196, 1
    s_and_b32 s61, s64, s49
    buffer_load_dwordx4 v[96:99], v2, s[16:19], s61 offen
    s_and_b32 s61, s65, s49
    buffer_load_dwordx4 v[100:103], v2, s[16:19], s61 offen
L_p2:
    v_readlane_b32 s66, v196, 2
    v_readlane_b32 s67, v196, 3
    s_and_b32 s61, s66, s49
    buffer_load_dwordx4 v[104:107], v2, s[16:19], s61 offen
    s_and_b32 s61, s67, s49
    buffer_load_dwordx4 v[108:111], v2, s[16:19], s61 offen
L_p4:
    v_readlane_b32 s68, v196, 4
    v_readlane_b32 s69, v196, 5
    s_and_b32 s61, s68, s49
    buffer_load_dwordx4 v[112:115], v2, s[16:19], s61 offen
    s_and_b32 s61, s69, s49
    buffer_load_dwordx4 v[116:119], v2, s[16:19], s61 offen
    s_cmp_eq_u32 s72, 0
    s_cbranch_scc1 L_pd
L_p6:
    v_readlane_b32 s70, v196, 6
    v_readlane_b32 s71, v196, 7
    s_and_b32 s61, s70, s49
    buffer_load_dwordx4 v[120:123], v2, s[16:19], s61 offen
    s_and_b32 s61, s71, s49
    buffer_load_dwordx4 v[124:127], v2, s[16:19], s61 offen
    s_cmp_eq_u32 s72, 2
    s_cbranch_scc1 L_pd
L_p8:
    v_readlane_b32 s64, v196, 8
    v_readlane_b32 s65, v196, 9
    s_and_b32 s61, s64, s49
    buffer_load_dwordx4 v[96:99], v2, s[16:19], s61 offen
    s_and_b32 s61, s65, s49
    buffer_load_dwordx4 v[100:103], v2, s[16:19], s61 offen
    s_cmp_eq_u32 s72, 4
    s_cbranch_scc1 L_pd
L_p10:
    v_readlane_b32 s66, v196, 10
    v_readlane_b32 s67, v196, 11
    s_and_b32 s61, s66, s49
    buffer_load_dwordx4 v[104:107], v2, s[16:19], s61 offen
    s_and_b32 s61, s67, s49
    buffer_load_dwordx4 v[108:111], v2, s[16:19], s61 offen
L_pd:
    s_waitcnt lgkmcnt(0)
.p2align 3
    v_mfma_f32_4x4x4_16b_bf16 v[144:147], v[192:193], v[188:189], 0 cbsz:4 abid:0
    v_mfma_f32_4x4x4_16b_bf16 v[148:151], v[192:193], v[188:189], 0 cbsz:4 abid:2
    v_mfma_f32_4x4x4_16b_bf16 v[152:155], v[192:193], v[188:189], 0 cbsz:4 abid:4
    v_mfma_f32_4x4x4_16b_bf16 v[156:159], v[192:193], v[188:189], 0 cbsz:4 abid:6
    v_lshlrev_b32 v196, 3, v197
    v_and_b32 v196, s55, v196
    v_add_u32 v198, 64, v198
    v_add_u32 v199, 64, v199
    v_smfmac_f32_32x32x32_bf16 v[64:79], v[164:167], v[172:179], v168
    ds_read_b32 v197, v198 offset:24
    ds_read_b32 v194, v199
    v_smfmac_f32_32x32x32_bf16 v[80:95], v[164:167], v[180:187], v168
    s_set_gpr_idx_on s54, gpr_idx(SRC0,SRC1)
    v_cvt_pk_bf16_f32 v9, v144, v144
    s_set_gpr_idx_off
    v_and_b32 v160, v190, v9
    v_and_b32 v161, v191, v9
    s_waitcnt lgkmcnt(0)
    v_lshrrev_b32 v8, 21, v194
    v_lshl_add_u32 v11, v8, 3, s51
    v_lshl_add_u32 v8, v8, 5, v200
    ds_read_b64 v[192:193], v11
    ds_read_b128 v[164:167], v8
    s_cmp_eq_u32 s53, 0
    s_cbranch_scc1 L_f0
    s_cmp_eq_u32 s54, 0
    s_cbranch_scc1 L_j0
    s_cmp_eq_u32 s54, 2
    s_cbranch_scc1 L_j2
    ds_read_b128 v[64:67], v169
    ds_read_b128 v[80:83], v169
    s_cmp_eq_u32 s54, 4
    s_cbranch_scc1 L_j4
    s_cmp_eq_u32 s54, 6
    s_cbranch_scc1 L_j6
    ds_read_b128 v[68:71], v169
    ds_read_b128 v[84:87], v169
    s_cmp_eq_u32 s54, 8
    s_cbranch_scc1 L_j8
    s_cmp_eq_u32 s54, 10
    s_cbranch_scc1 L_j10
    ds_read_b128 v[72:75], v169
    ds_read_b128 v[88:91], v169
    s_cmp_eq_u32 s54, 12
    s_cbranch_scc1 L_j12
    s_branch L_j14
.p2align 3
L_loop:
    s_waitcnt lgkmcnt(2)
.p2align 3
    v_mfma_f32_4x4x4_16b_bf16 v[144:147], v[192:193], v[188:189], 0 cbsz:4 abid:0
    v_mfma_f32_4x4x4_16b_bf16 v[148:151], v[192:193], v[188:189], 0 cbsz:4 abid:2
    v_mfma_f32_4x4x4_16b_bf16 v[152:155], v[192:193], v[188:189], 0 cbsz:4 abid:4
    v_mfma_f32_4x4x4_16b_bf16 v[156:159], v[192:193], v[188:189], 0 cbsz:4 abid:6
    v_lshlrev_b32 v196, 3, v197
    v_and_b32 v196, s55, v196
    v_add_u32 v198, 64, v198
    v_add_u32 v199, 64, v199
    s_waitcnt lgkmcnt(0)
.p2align 3
    v_smfmac_f32_32x32x32_bf16 v[64:79], v[164:167], v[172:179], v168
    ds_read_b32 v197, v198 offset:24
    ds_read_b32 v194, v199
    v_cvt_pk_bf16_f32 v9, v144, v144
    v_and_b32 v160, v190, v9
    v_and_b32 v161, v191, v9
    v_smfmac_f32_32x32x32_bf16 v[80:95], v[164:167], v[180:187], v168
L_j0:
    s_waitcnt vmcnt(5)
.p2align 3
    v_mfma_f32_16x16x16_bf16 v[128:131], v[160:161], v[96:97], 0
    v_readlane_b32 s70, v196, 0
    v_cvt_pk_bf16_f32 v10, v145, v145
    v_mfma_f32_16x16x16_bf16 v[132:135], v[160:161], v[98:99], 0
    v_and_b32 v162, v190, v10
    v_and_b32 v163, v191, v10
    s_and_b32 s61, s70, s49
    s_waitcnt vmcnt(4)
    buffer_load_dwordx4 v[120:123], v2, s[16:19], s61 offen
    v_mfma_f32_16x16x16_bf16 v[136:139], v[162:163], v[100:101], 0
    v_readlane_b32 s71, v196, 1
    v_cvt_pk_bf16_f32 v9, v146, v146
    v_mfma_f32_16x16x16_bf16 v[140:143], v[162:163], v[102:103], 0
    v_and_b32 v160, v190, v9
    v_and_b32 v161, v191, v9
    s_and_b32 s61, s71, s49
    s_set_gpr_idx_on s64, gpr_idx(SRC2,DST)
    buffer_load_dwordx4 v[124:127], v2, s[16:19], s61 offen
    v_pk_fma_f32 v[16:17], v[128:129], v[64:65], v[16:17] op_sel_hi:[1,0,1]
    v_pk_fma_f32 v[18:19], v[130:131], v[64:65], v[18:19] op_sel_hi:[1,0,1]
    v_pk_fma_f32 v[20:21], v[132:133], v[80:81], v[20:21] op_sel_hi:[1,0,1]
    v_pk_fma_f32 v[22:23], v[134:135], v[80:81], v[22:23] op_sel_hi:[1,0,1]
    s_set_gpr_idx_idx s65
.p2align 3
    v_pk_fma_f32 v[16:17], v[136:137], v[64:65], v[16:17] op_sel:[0,1,0] op_sel_hi:[1,1,1]
    v_pk_fma_f32 v[18:19], v[138:139], v[64:65], v[18:19] op_sel:[0,1,0] op_sel_hi:[1,1,1]
    v_pk_fma_f32 v[20:21], v[140:141], v[80:81], v[20:21] op_sel:[0,1,0] op_sel_hi:[1,1,1]
    v_pk_fma_f32 v[22:23], v[142:143], v[80:81], v[22:23] op_sel:[0,1,0] op_sel_hi:[1,1,1]
    s_set_gpr_idx_off
L_j2:
    s_waitcnt vmcnt(5)
.p2align 3
    v_mfma_f32_16x16x16_bf16 v[128:131], v[160:161], v[104:105], 0
    v_readlane_b32 s64, v196, 2
    v_cvt_pk_bf16_f32 v10, v147, v147
    v_mfma_f32_16x16x16_bf16 v[132:135], v[160:161], v[106:107], 0
    v_and_b32 v162, v190, v10
    v_and_b32 v163, v191, v10
    s_and_b32 s61, s64, s49
    s_waitcnt vmcnt(4)
    buffer_load_dwordx4 v[96:99], v2, s[16:19], s61 offen
    v_mfma_f32_16x16x16_bf16 v[136:139], v[162:163], v[108:109], 0
    v_readlane_b32 s65, v196, 3
    v_cvt_pk_bf16_f32 v9, v148, v148
    v_mfma_f32_16x16x16_bf16 v[140:143], v[162:163], v[110:111], 0
    v_and_b32 v160, v190, v9
    v_and_b32 v161, v191, v9
    s_waitcnt lgkmcnt(0)
    v_lshrrev_b32 v8, 21, v194
    v_lshl_add_u32 v11, v8, 3, s51
    v_lshl_add_u32 v8, v8, 5, v200
    ds_read_b64 v[192:193], v11
    ds_read_b128 v[164:167], v8
.p2align 3
    s_and_b32 s61, s65, s49
    s_set_gpr_idx_on s66, gpr_idx(SRC2,DST)
    buffer_load_dwordx4 v[100:103], v2, s[16:19], s61 offen
    v_pk_fma_f32 v[16:17], v[128:129], v[66:67], v[16:17] op_sel_hi:[1,0,1]
    v_pk_fma_f32 v[18:19], v[130:131], v[66:67], v[18:19] op_sel_hi:[1,0,1]
    v_pk_fma_f32 v[20:21], v[132:133], v[82:83], v[20:21] op_sel_hi:[1,0,1]
    v_pk_fma_f32 v[22:23], v[134:135], v[82:83], v[22:23] op_sel_hi:[1,0,1]
    s_set_gpr_idx_idx s67
.p2align 3
    v_pk_fma_f32 v[16:17], v[136:137], v[66:67], v[16:17] op_sel:[0,1,0] op_sel_hi:[1,1,1]
    v_pk_fma_f32 v[18:19], v[138:139], v[66:67], v[18:19] op_sel:[0,1,0] op_sel_hi:[1,1,1]
    v_pk_fma_f32 v[20:21], v[140:141], v[82:83], v[20:21] op_sel:[0,1,0] op_sel_hi:[1,1,1]
    v_pk_fma_f32 v[22:23], v[142:143], v[82:83], v[22:23] op_sel:[0,1,0] op_sel_hi:[1,1,1]
    ds_read_b128 v[64:67], v169
    ds_read_b128 v[80:83], v169
    s_set_gpr_idx_off
L_j4:
    s_waitcnt vmcnt(5)
.p2align 3
    v_mfma_f32_16x16x16_bf16 v[128:131], v[160:161], v[112:113], 0
    v_readlane_b32 s66, v196, 4
    v_cvt_pk_bf16_f32 v10, v149, v149
    v_mfma_f32_16x16x16_bf16 v[132:135], v[160:161], v[114:115], 0
    v_and_b32 v162, v190, v10
    v_and_b32 v163, v191, v10
    s_and_b32 s61, s66, s49
    s_waitcnt vmcnt(4)
    buffer_load_dwordx4 v[104:107], v2, s[16:19], s61 offen
    v_mfma_f32_16x16x16_bf16 v[136:139], v[162:163], v[116:117], 0
    v_readlane_b32 s67, v196, 5
    v_cvt_pk_bf16_f32 v9, v150, v150
    v_mfma_f32_16x16x16_bf16 v[140:143], v[162:163], v[118:119], 0
    v_and_b32 v160, v190, v9
    v_and_b32 v161, v191, v9
    s_and_b32 s61, s67, s49
    s_set_gpr_idx_on s68, gpr_idx(SRC2,DST)
    buffer_load_dwordx4 v[108:111], v2, s[16:19], s61 offen
    v_pk_fma_f32 v[16:17], v[128:129], v[68:69], v[16:17] op_sel_hi:[1,0,1]
    v_pk_fma_f32 v[18:19], v[130:131], v[68:69], v[18:19] op_sel_hi:[1,0,1]
    v_pk_fma_f32 v[20:21], v[132:133], v[84:85], v[20:21] op_sel_hi:[1,0,1]
    v_pk_fma_f32 v[22:23], v[134:135], v[84:85], v[22:23] op_sel_hi:[1,0,1]
    s_set_gpr_idx_idx s69
.p2align 3
    v_pk_fma_f32 v[16:17], v[136:137], v[68:69], v[16:17] op_sel:[0,1,0] op_sel_hi:[1,1,1]
    v_pk_fma_f32 v[18:19], v[138:139], v[68:69], v[18:19] op_sel:[0,1,0] op_sel_hi:[1,1,1]
    v_pk_fma_f32 v[20:21], v[140:141], v[84:85], v[20:21] op_sel:[0,1,0] op_sel_hi:[1,1,1]
    v_pk_fma_f32 v[22:23], v[142:143], v[84:85], v[22:23] op_sel:[0,1,0] op_sel_hi:[1,1,1]
    s_set_gpr_idx_off
L_j6:
    s_waitcnt vmcnt(5)
.p2align 3
    v_mfma_f32_16x16x16_bf16 v[128:131], v[160:161], v[120:121], 0
    v_readlane_b32 s68, v196, 6
    v_cvt_pk_bf16_f32 v10, v151, v151
    v_mfma_f32_16x16x16_bf16 v[132:135], v[160:161], v[122:123], 0
    v_and_b32 v162, v190, v10
    v_and_b32 v163, v191, v10
    s_and_b32 s61, s68, s49
    s_waitcnt vmcnt(4)
    buffer_load_dwordx4 v[112:115], v2, s[16:19], s61 offen
    v_mfma_f32_16x16x16_bf16 v[136:139], v[162:163], v[124:125], 0
    v_readlane_b32 s69, v196, 7
    v_cvt_pk_bf16_f32 v9, v152, v152
    v_mfma_f32_16x16x16_bf16 v[140:143], v[162:163], v[126:127], 0
    v_and_b32 v160, v190, v9
    v_and_b32 v161, v191, v9
    s_and_b32 s61, s69, s49
    s_set_gpr_idx_on s70, gpr_idx(SRC2,DST)
    buffer_load_dwordx4 v[116:119], v2, s[16:19], s61 offen
    v_pk_fma_f32 v[16:17], v[128:129], v[70:71], v[16:17] op_sel_hi:[1,0,1]
    v_pk_fma_f32 v[18:19], v[130:131], v[70:71], v[18:19] op_sel_hi:[1,0,1]
    v_pk_fma_f32 v[20:21], v[132:133], v[86:87], v[20:21] op_sel_hi:[1,0,1]
    v_pk_fma_f32 v[22:23], v[134:135], v[86:87], v[22:23] op_sel_hi:[1,0,1]
    s_set_gpr_idx_idx s71
.p2align 3
    v_pk_fma_f32 v[16:17], v[136:137], v[70:71], v[16:17] op_sel:[0,1,0] op_sel_hi:[1,1,1]
    v_pk_fma_f32 v[18:19], v[138:139], v[70:71], v[18:19] op_sel:[0,1,0] op_sel_hi:[1,1,1]
    v_pk_fma_f32 v[20:21], v[140:141], v[86:87], v[20:21] op_sel:[0,1,0] op_sel_hi:[1,1,1]
    v_pk_fma_f32 v[22:23], v[142:143], v[86:87], v[22:23] op_sel:[0,1,0] op_sel_hi:[1,1,1]
    ds_read_b128 v[68:71], v169
    ds_read_b128 v[84:87], v169
    s_set_gpr_idx_off
L_j8:
    s_waitcnt vmcnt(5)
.p2align 3
    v_mfma_f32_16x16x16_bf16 v[128:131], v[160:161], v[96:97], 0
    v_readlane_b32 s70, v196, 8
    v_cvt_pk_bf16_f32 v10, v153, v153
    v_mfma_f32_16x16x16_bf16 v[132:135], v[160:161], v[98:99], 0
    v_and_b32 v162, v190, v10
    v_and_b32 v163, v191, v10
    s_and_b32 s61, s70, s49
    s_waitcnt vmcnt(4)
    buffer_load_dwordx4 v[120:123], v2, s[16:19], s61 offen
    v_mfma_f32_16x16x16_bf16 v[136:139], v[162:163], v[100:101], 0
    v_readlane_b32 s71, v196, 9
    v_cvt_pk_bf16_f32 v9, v154, v154
    v_mfma_f32_16x16x16_bf16 v[140:143], v[162:163], v[102:103], 0
    v_and_b32 v160, v190, v9
    v_and_b32 v161, v191, v9
    s_and_b32 s61, s71, s49
    s_set_gpr_idx_on s64, gpr_idx(SRC2,DST)
    buffer_load_dwordx4 v[124:127], v2, s[16:19], s61 offen
    v_pk_fma_f32 v[16:17], v[128:129], v[72:73], v[16:17] op_sel_hi:[1,0,1]
    v_pk_fma_f32 v[18:19], v[130:131], v[72:73], v[18:19] op_sel_hi:[1,0,1]
    v_pk_fma_f32 v[20:21], v[132:133], v[88:89], v[20:21] op_sel_hi:[1,0,1]
    v_pk_fma_f32 v[22:23], v[134:135], v[88:89], v[22:23] op_sel_hi:[1,0,1]
    s_set_gpr_idx_idx s65
.p2align 3
    v_pk_fma_f32 v[16:17], v[136:137], v[72:73], v[16:17] op_sel:[0,1,0] op_sel_hi:[1,1,1]
    v_pk_fma_f32 v[18:19], v[138:139], v[72:73], v[18:19] op_sel:[0,1,0] op_sel_hi:[1,1,1]
    v_pk_fma_f32 v[20:21], v[140:141], v[88:89], v[20:21] op_sel:[0,1,0] op_sel_hi:[1,1,1]
    v_pk_fma_f32 v[22:23], v[142:143], v[88:89], v[22:23] op_sel:[0,1,0] op_sel_hi:[1,1,1]
    s_set_gpr_idx_off
L_j10:
    s_waitcnt vmcnt(5)
.p2align 3
    v_mfma_f32_16x16x16_bf16 v[128:131], v[160:161], v[104:105], 0
    v_readlane_b32 s64, v196, 10
    v_cvt_pk_bf16_f32 v10, v155, v155
    v_mfma_f32_16x16x16_bf16 v[132:135], v[160:161], v[106:107], 0
    v_and_b32 v162, v190, v10
    v_and_b32 v163, v191, v10
    s_and_b32 s61, s64, s49
    s_waitcnt vmcnt(4)
    buffer_load_dwordx4 v[96:99], v2, s[16:19], s61 offen
    v_mfma_f32_16x16x16_bf16 v[136:139], v[162:163], v[108:109], 0
    v_readlane_b32 s65, v196, 11
    v_cvt_pk_bf16_f32 v9, v156, v156
    v_mfma_f32_16x16x16_bf16 v[140:143], v[162:163], v[110:111], 0
    v_and_b32 v160, v190, v9
    v_and_b32 v161, v191, v9
    s_and_b32 s61, s65, s49
    s_set_gpr_idx_on s66, gpr_idx(SRC2,DST)
    buffer_load_dwordx4 v[100:103], v2, s[16:19], s61 offen
    v_pk_fma_f32 v[16:17], v[128:129], v[74:75], v[16:17] op_sel_hi:[1,0,1]
    v_pk_fma_f32 v[18:19], v[130:131], v[74:75], v[18:19] op_sel_hi:[1,0,1]
    v_pk_fma_f32 v[20:21], v[132:133], v[90:91], v[20:21] op_sel_hi:[1,0,1]
    v_pk_fma_f32 v[22:23], v[134:135], v[90:91], v[22:23] op_sel_hi:[1,0,1]
    s_set_gpr_idx_idx s67
.p2align 3
    v_pk_fma_f32 v[16:17], v[136:137], v[74:75], v[16:17] op_sel:[0,1,0] op_sel_hi:[1,1,1]
    v_pk_fma_f32 v[18:19], v[138:139], v[74:75], v[18:19] op_sel:[0,1,0] op_sel_hi:[1,1,1]
    v_pk_fma_f32 v[20:21], v[140:141], v[90:91], v[20:21] op_sel:[0,1,0] op_sel_hi:[1,1,1]
    v_pk_fma_f32 v[22:23], v[142:143], v[90:91], v[22:23] op_sel:[0,1,0] op_sel_hi:[1,1,1]
    ds_read_b128 v[72:75], v169
    ds_read_b128 v[88:91], v169
    s_set_gpr_idx_off
L_j12:
    s_waitcnt vmcnt(5)
.p2align 3
    v_mfma_f32_16x16x16_bf16 v[128:131], v[160:161], v[112:113], 0
    v_readlane_b32 s66, v196, 12
    v_cvt_pk_bf16_f32 v10, v157, v157
    v_mfma_f32_16x16x16_bf16 v[132:135], v[160:161], v[114:115], 0
    v_and_b32 v162, v190, v10
    v_and_b32 v163, v191, v10
    s_and_b32 s61, s66, s49
    s_waitcnt vmcnt(4)
    buffer_load_dwordx4 v[104:107], v2, s[16:19], s61 offen
    v_mfma_f32_16x16x16_bf16 v[136:139], v[162:163], v[116:117], 0
    v_readlane_b32 s67, v196, 13
    v_cvt_pk_bf16_f32 v9, v158, v158
    v_mfma_f32_16x16x16_bf16 v[140:143], v[162:163], v[118:119], 0
    v_and_b32 v160, v190, v9
    v_and_b32 v161, v191, v9
    s_and_b32 s61, s67, s49
    s_set_gpr_idx_on s68, gpr_idx(SRC2,DST)
    buffer_load_dwordx4 v[108:111], v2, s[16:19], s61 offen
    v_pk_fma_f32 v[16:17], v[128:129], v[76:77], v[16:17] op_sel_hi:[1,0,1]
    v_pk_fma_f32 v[18:19], v[130:131], v[76:77], v[18:19] op_sel_hi:[1,0,1]
    v_pk_fma_f32 v[20:21], v[132:133], v[92:93], v[20:21] op_sel_hi:[1,0,1]
    v_pk_fma_f32 v[22:23], v[134:135], v[92:93], v[22:23] op_sel_hi:[1,0,1]
    s_set_gpr_idx_idx s69
.p2align 3
    v_pk_fma_f32 v[16:17], v[136:137], v[76:77], v[16:17] op_sel:[0,1,0] op_sel_hi:[1,1,1]
    v_pk_fma_f32 v[18:19], v[138:139], v[76:77], v[18:19] op_sel:[0,1,0] op_sel_hi:[1,1,1]
    v_pk_fma_f32 v[20:21], v[140:141], v[92:93], v[20:21] op_sel:[0,1,0] op_sel_hi:[1,1,1]
    v_pk_fma_f32 v[22:23], v[142:143], v[92:93], v[22:23] op_sel:[0,1,0] op_sel_hi:[1,1,1]
    s_set_gpr_idx_off
L_j14:
    s_waitcnt vmcnt(5)
.p2align 3
    v_mfma_f32_16x16x16_bf16 v[128:131], v[160:161], v[120:121], 0
    v_readlane_b32 s68, v196, 14
    v_cvt_pk_bf16_f32 v10, v159, v159
    v_mfma_f32_16x16x16_bf16 v[132:135], v[160:161], v[122:123], 0
    v_and_b32 v162, v190, v10
    v_and_b32 v163, v191, v10
    s_and_b32 s61, s68, s49
    s_waitcnt vmcnt(4)
    buffer_load_dwordx4 v[112:115], v2, s[16:19], s61 offen
    v_mfma_f32_16x16x16_bf16 v[136:139], v[162:163], v[124:125], 0
    v_readlane_b32 s69, v196, 15
    v_mfma_f32_16x16x16_bf16 v[140:143], v[162:163], v[126:127], 0
    s_and_b32 s61, s69, s49
    s_set_gpr_idx_on s70, gpr_idx(SRC2,DST)
    buffer_load_dwordx4 v[116:119], v2, s[16:19], s61 offen
    v_pk_fma_f32 v[16:17], v[128:129], v[78:79], v[16:17] op_sel_hi:[1,0,1]
    v_pk_fma_f32 v[18:19], v[130:131], v[78:79], v[18:19] op_sel_hi:[1,0,1]
    v_pk_fma_f32 v[20:21], v[132:133], v[94:95], v[20:21] op_sel_hi:[1,0,1]
    v_pk_fma_f32 v[22:23], v[134:135], v[94:95], v[22:23] op_sel_hi:[1,0,1]
    s_set_gpr_idx_idx s71
    s_sub_u32 s53, s53, 1
.p2align 3
    v_pk_fma_f32 v[16:17], v[136:137], v[78:79], v[16:17] op_sel:[0,1,0] op_sel_hi:[1,1,1]
    v_pk_fma_f32 v[18:19], v[138:139], v[78:79], v[18:19] op_sel:[0,1,0] op_sel_hi:[1,1,1]
    v_pk_fma_f32 v[20:21], v[140:141], v[94:95], v[20:21] op_sel:[0,1,0] op_sel_hi:[1,1,1]
    v_pk_fma_f32 v[22:23], v[142:143], v[94:95], v[22:23] op_sel:[0,1,0] op_sel_hi:[1,1,1]
    ds_read_b128 v[76:79], v169
    ds_read_b128 v[92:95], v169
    s_set_gpr_idx_off
    s_cmp_lg_u32 s53, 0
    s_cbranch_scc1 L_loop
    s_waitcnt lgkmcnt(2)
.p2align 3
    v_mfma_f32_4x4x4_16b_bf16 v[144:147], v[192:193], v[188:189], 0 cbsz:4 abid:0
    v_mfma_f32_4x4x4_16b_bf16 v[148:151], v[192:193], v[188:189], 0 cbsz:4 abid:2
    v_mfma_f32_4x4x4_16b_bf16 v[152:155], v[192:193], v[188:189], 0 cbsz:4 abid:4
    v_mfma_f32_4x4x4_16b_bf16 v[156:159], v[192:193], v[188:189], 0 cbsz:4 abid:6
    v_lshlrev_b32 v196, 3, v197
    v_and_b32 v196, s55, v196
    s_waitcnt lgkmcnt(0)
.p2align 3
    v_smfmac_f32_32x32x32_bf16 v[64:79], v[164:167], v[172:179], v168
    v_cvt_pk_bf16_f32 v9, v144, v144
    v_and_b32 v160, v190, v9
    v_and_b32 v161, v191, v9
    v_smfmac_f32_32x32x32_bf16 v[80:95], v[164:167], v[180:187], v168
L_f0:
    s_waitcnt vmcnt(5)
.p2align 3
    v_mfma_f32_16x16x16_bf16 v[128:131], v[160:161], v[96:97], 0
    v_readlane_b32 s70, v196, 0
    v_cvt_pk_bf16_f32 v10, v145, v145
    v_mfma_f32_16x16x16_bf16 v[132:135], v[160:161], v[98:99], 0
    v_and_b32 v162, v190, v10
    v_and_b32 v163, v191, v10
    s_and_b32 s61, s70, s49
    s_waitcnt vmcnt(4)
    buffer_load_dwordx4 v[120:123], v2, s[16:19], s61 offen
    v_mfma_f32_16x16x16_bf16 v[136:139], v[162:163], v[100:101], 0
    v_readlane_b32 s71, v196, 1
    v_cvt_pk_bf16_f32 v9, v146, v146
    v_mfma_f32_16x16x16_bf16 v[140:143], v[162:163], v[102:103], 0
    v_and_b32 v160, v190, v9
    v_and_b32 v161, v191, v9
    s_and_b32 s61, s71, s49
    s_set_gpr_idx_on s64, gpr_idx(SRC2,DST)
    buffer_load_dwordx4 v[124:127], v2, s[16:19], s61 offen
    v_pk_fma_f32 v[16:17], v[128:129], v[64:65], v[16:17] op_sel_hi:[1,0,1]
    v_pk_fma_f32 v[18:19], v[130:131], v[64:65], v[18:19] op_sel_hi:[1,0,1]
    v_pk_fma_f32 v[20:21], v[132:133], v[80:81], v[20:21] op_sel_hi:[1,0,1]
    v_pk_fma_f32 v[22:23], v[134:135], v[80:81], v[22:23] op_sel_hi:[1,0,1]
    s_set_gpr_idx_idx s65
.p2align 3
    v_pk_fma_f32 v[16:17], v[136:137], v[64:65], v[16:17] op_sel:[0,1,0] op_sel_hi:[1,1,1]
    v_pk_fma_f32 v[18:19], v[138:139], v[64:65], v[18:19] op_sel:[0,1,0] op_sel_hi:[1,1,1]
    v_pk_fma_f32 v[20:21], v[140:141], v[80:81], v[20:21] op_sel:[0,1,0] op_sel_hi:[1,1,1]
    v_pk_fma_f32 v[22:23], v[142:143], v[80:81], v[22:23] op_sel:[0,1,0] op_sel_hi:[1,1,1]
    s_set_gpr_idx_off
    s_waitcnt vmcnt(5)
.p2align 3
    v_mfma_f32_16x16x16_bf16 v[128:131], v[160:161], v[104:105], 0
    v_readlane_b32 s64, v196, 2
    v_cvt_pk_bf16_f32 v10, v147, v147
    v_mfma_f32_16x16x16_bf16 v[132:135], v[160:161], v[106:107], 0
    v_and_b32 v162, v190, v10
    v_and_b32 v163, v191, v10
    s_and_b32 s61, s64, s49
    s_waitcnt vmcnt(4)
    buffer_load_dwordx4 v[96:99], v2, s[16:19], s61 offen
    v_mfma_f32_16x16x16_bf16 v[136:139], v[162:163], v[108:109], 0
    v_readlane_b32 s65, v196, 3
    v_cvt_pk_bf16_f32 v9, v148, v148
    v_mfma_f32_16x16x16_bf16 v[140:143], v[162:163], v[110:111], 0
    v_and_b32 v160, v190, v9
    v_and_b32 v161, v191, v9
    s_and_b32 s61, s65, s49
    s_set_gpr_idx_on s66, gpr_idx(SRC2,DST)
    buffer_load_dwordx4 v[100:103], v2, s[16:19], s61 offen
    v_pk_fma_f32 v[16:17], v[128:129], v[66:67], v[16:17] op_sel_hi:[1,0,1]
    v_pk_fma_f32 v[18:19], v[130:131], v[66:67], v[18:19] op_sel_hi:[1,0,1]
    v_pk_fma_f32 v[20:21], v[132:133], v[82:83], v[20:21] op_sel_hi:[1,0,1]
    v_pk_fma_f32 v[22:23], v[134:135], v[82:83], v[22:23] op_sel_hi:[1,0,1]
    s_set_gpr_idx_idx s67
.p2align 3
    v_pk_fma_f32 v[16:17], v[136:137], v[66:67], v[16:17] op_sel:[0,1,0] op_sel_hi:[1,1,1]
    v_pk_fma_f32 v[18:19], v[138:139], v[66:67], v[18:19] op_sel:[0,1,0] op_sel_hi:[1,1,1]
    v_pk_fma_f32 v[20:21], v[140:141], v[82:83], v[20:21] op_sel:[0,1,0] op_sel_hi:[1,1,1]
    v_pk_fma_f32 v[22:23], v[142:143], v[82:83], v[22:23] op_sel:[0,1,0] op_sel_hi:[1,1,1]
    s_set_gpr_idx_off
    s_waitcnt vmcnt(5)
.p2align 3
    v_mfma_f32_16x16x16_bf16 v[128:131], v[160:161], v[112:113], 0
    v_readlane_b32 s66, v196, 4
    v_cvt_pk_bf16_f32 v10, v149, v149
    v_mfma_f32_16x16x16_bf16 v[132:135], v[160:161], v[114:115], 0
    v_and_b32 v162, v190, v10
    v_and_b32 v163, v191, v10
    s_and_b32 s61, s66, s49
    s_waitcnt vmcnt(4)
    buffer_load_dwordx4 v[104:107], v2, s[16:19], s61 offen
    v_mfma_f32_16x16x16_bf16 v[136:139], v[162:163], v[116:117], 0
    v_readlane_b32 s67, v196, 5
    v_cvt_pk_bf16_f32 v9, v150, v150
    v_mfma_f32_16x16x16_bf16 v[140:143], v[162:163], v[118:119], 0
    v_and_b32 v160, v190, v9
    v_and_b32 v161, v191, v9
    s_and_b32 s61, s67, s49
    s_set_gpr_idx_on s68, gpr_idx(SRC2,DST)
    buffer_load_dwordx4 v[108:111], v2, s[16:19], s61 offen
    v_pk_fma_f32 v[16:17], v[128:129], v[68:69], v[16:17] op_sel_hi:[1,0,1]
    v_pk_fma_f32 v[18:19], v[130:131], v[68:69], v[18:19] op_sel_hi:[1,0,1]
    v_pk_fma_f32 v[20:21], v[132:133], v[84:85], v[20:21] op_sel_hi:[1,0,1]
    v_pk_fma_f32 v[22:23], v[134:135], v[84:85], v[22:23] op_sel_hi:[1,0,1]
    s_set_gpr_idx_idx s69
.p2align 3
    v_pk_fma_f32 v[16:17], v[136:137], v[68:69], v[16:17] op_sel:[0,1,0] op_sel_hi:[1,1,1]
    v_pk_fma_f32 v[18:19], v[138:139], v[68:69], v[18:19] op_sel:[0,1,0] op_sel_hi:[1,1,1]
    v_pk_fma_f32 v[20:21], v[140:141], v[84:85], v[20:21] op_sel:[0,1,0] op_sel_hi:[1,1,1]
    v_pk_fma_f32 v[22:23], v[142:143], v[84:85], v[22:23] op_sel:[0,1,0] op_sel_hi:[1,1,1]
    s_set_gpr_idx_off
    s_waitcnt vmcnt(5)
.p2align 3
    v_mfma_f32_16x16x16_bf16 v[128:131], v[160:161], v[120:121], 0
    v_readlane_b32 s68, v196, 6
    v_cvt_pk_bf16_f32 v10, v151, v151
    v_mfma_f32_16x16x16_bf16 v[132:135], v[160:161], v[122:123], 0
    v_and_b32 v162, v190, v10
    v_and_b32 v163, v191, v10
    s_and_b32 s61, s68, s49
    s_waitcnt vmcnt(4)
    buffer_load_dwordx4 v[112:115], v2, s[16:19], s61 offen
    v_mfma_f32_16x16x16_bf16 v[136:139], v[162:163], v[124:125], 0
    v_readlane_b32 s69, v196, 7
    v_cvt_pk_bf16_f32 v9, v152, v152
    v_mfma_f32_16x16x16_bf16 v[140:143], v[162:163], v[126:127], 0
    v_and_b32 v160, v190, v9
    v_and_b32 v161, v191, v9
    s_and_b32 s61, s69, s49
    s_set_gpr_idx_on s70, gpr_idx(SRC2,DST)
    buffer_load_dwordx4 v[116:119], v2, s[16:19], s61 offen
    v_pk_fma_f32 v[16:17], v[128:129], v[70:71], v[16:17] op_sel_hi:[1,0,1]
    v_pk_fma_f32 v[18:19], v[130:131], v[70:71], v[18:19] op_sel_hi:[1,0,1]
    v_pk_fma_f32 v[20:21], v[132:133], v[86:87], v[20:21] op_sel_hi:[1,0,1]
    v_pk_fma_f32 v[22:23], v[134:135], v[86:87], v[22:23] op_sel_hi:[1,0,1]
    s_set_gpr_idx_idx s71
.p2align 3
    v_pk_fma_f32 v[16:17], v[136:137], v[70:71], v[16:17] op_sel:[0,1,0] op_sel_hi:[1,1,1]
    v_pk_fma_f32 v[18:19], v[138:139], v[70:71], v[18:19] op_sel:[0,1,0] op_sel_hi:[1,1,1]
    v_pk_fma_f32 v[20:21], v[140:141], v[86:87], v[20:21] op_sel:[0,1,0] op_sel_hi:[1,1,1]
    v_pk_fma_f32 v[22:23], v[142:143], v[86:87], v[22:23] op_sel:[0,1,0] op_sel_hi:[1,1,1]
    s_set_gpr_idx_off
    s_waitcnt vmcnt(5)
.p2align 3
    v_mfma_f32_16x16x16_bf16 v[128:131], v[160:161], v[96:97], 0
    v_readlane_b32 s70, v196, 8
    v_cvt_pk_bf16_f32 v10, v153, v153
    v_mfma_f32_16x16x16_bf16 v[132:135], v[160:161], v[98:99], 0
    v_and_b32 v162, v190, v10
    v_and_b32 v163, v191, v10
    s_and_b32 s61, s70, s49
    s_waitcnt vmcnt(4)
    buffer_load_dwordx4 v[120:123], v2, s[16:19], s61 offen
    v_mfma_f32_16x16x16_bf16 v[136:139], v[162:163], v[100:101], 0
    v_readlane_b32 s71, v196, 9
    v_cvt_pk_bf16_f32 v9, v154, v154
    v_mfma_f32_16x16x16_bf16 v[140:143], v[162:163], v[102:103], 0
    v_and_b32 v160, v190, v9
    v_and_b32 v161, v191, v9
    s_and_b32 s61, s71, s49
    s_set_gpr_idx_on s64, gpr_idx(SRC2,DST)
    buffer_load_dwordx4 v[124:127], v2, s[16:19], s61 offen
    v_pk_fma_f32 v[16:17], v[128:129], v[72:73], v[16:17] op_sel_hi:[1,0,1]
    v_pk_fma_f32 v[18:19], v[130:131], v[72:73], v[18:19] op_sel_hi:[1,0,1]
    v_pk_fma_f32 v[20:21], v[132:133], v[88:89], v[20:21] op_sel_hi:[1,0,1]
    v_pk_fma_f32 v[22:23], v[134:135], v[88:89], v[22:23] op_sel_hi:[1,0,1]
    s_set_gpr_idx_idx s65
.p2align 3
    v_pk_fma_f32 v[16:17], v[136:137], v[72:73], v[16:17] op_sel:[0,1,0] op_sel_hi:[1,1,1]
    v_pk_fma_f32 v[18:19], v[138:139], v[72:73], v[18:19] op_sel:[0,1,0] op_sel_hi:[1,1,1]
    v_pk_fma_f32 v[20:21], v[140:141], v[88:89], v[20:21] op_sel:[0,1,0] op_sel_hi:[1,1,1]
    v_pk_fma_f32 v[22:23], v[142:143], v[88:89], v[22:23] op_sel:[0,1,0] op_sel_hi:[1,1,1]
    s_set_gpr_idx_off
    s_waitcnt vmcnt(5)
.p2align 3
    v_mfma_f32_16x16x16_bf16 v[128:131], v[160:161], v[104:105], 0
    v_cvt_pk_bf16_f32 v10, v155, v155
    v_mfma_f32_16x16x16_bf16 v[132:135], v[160:161], v[106:107], 0
    v_and_b32 v162, v190, v10
    v_and_b32 v163, v191, v10
    s_waitcnt vmcnt(4)
.p2align 3
    s_nop 0
    v_mfma_f32_16x16x16_bf16 v[136:139], v[162:163], v[108:109], 0
    v_cvt_pk_bf16_f32 v9, v156, v156
    v_mfma_f32_16x16x16_bf16 v[140:143], v[162:163], v[110:111], 0
    v_and_b32 v160, v190, v9
    v_and_b32 v161, v191, v9
    s_set_gpr_idx_on s66, gpr_idx(SRC2,DST)
.p2align 3
    v_pk_fma_f32 v[16:17], v[128:129], v[74:75], v[16:17] op_sel_hi:[1,0,1]
    v_pk_fma_f32 v[18:19], v[130:131], v[74:75], v[18:19] op_sel_hi:[1,0,1]
    v_pk_fma_f32 v[20:21], v[132:133], v[90:91], v[20:21] op_sel_hi:[1,0,1]
    v_pk_fma_f32 v[22:23], v[134:135], v[90:91], v[22:23] op_sel_hi:[1,0,1]
    s_set_gpr_idx_idx s67
.p2align 3
    v_pk_fma_f32 v[16:17], v[136:137], v[74:75], v[16:17] op_sel:[0,1,0] op_sel_hi:[1,1,1]
    v_pk_fma_f32 v[18:19], v[138:139], v[74:75], v[18:19] op_sel:[0,1,0] op_sel_hi:[1,1,1]
    v_pk_fma_f32 v[20:21], v[140:141], v[90:91], v[20:21] op_sel:[0,1,0] op_sel_hi:[1,1,1]
    v_pk_fma_f32 v[22:23], v[142:143], v[90:91], v[22:23] op_sel:[0,1,0] op_sel_hi:[1,1,1]
    s_set_gpr_idx_off
    s_waitcnt vmcnt(3)
.p2align 3
    v_mfma_f32_16x16x16_bf16 v[128:131], v[160:161], v[112:113], 0
    v_cvt_pk_bf16_f32 v10, v157, v157
    v_mfma_f32_16x16x16_bf16 v[132:135], v[160:161], v[114:115], 0
    v_and_b32 v162, v190, v10
    v_and_b32 v163, v191, v10
    s_waitcnt vmcnt(2)
.p2align 3
    s_nop 0
    v_mfma_f32_16x16x16_bf16 v[136:139], v[162:163], v[116:117], 0
    v_cvt_pk_bf16_f32 v9, v158, v158
    v_mfma_f32_16x16x16_bf16 v[140:143], v[162:163], v[118:119], 0
    v_and_b32 v160, v190, v9
    v_and_b32 v161, v191, v9
    s_set_gpr_idx_on s68, gpr_idx(SRC2,DST)
.p2align 3
    v_pk_fma_f32 v[16:17], v[128:129], v[76:77], v[16:17] op_sel_hi:[1,0,1]
    v_pk_fma_f32 v[18:19], v[130:131], v[76:77], v[18:19] op_sel_hi:[1,0,1]
    v_pk_fma_f32 v[20:21], v[132:133], v[92:93], v[20:21] op_sel_hi:[1,0,1]
    v_pk_fma_f32 v[22:23], v[134:135], v[92:93], v[22:23] op_sel_hi:[1,0,1]
    s_set_gpr_idx_idx s69
.p2align 3
    v_pk_fma_f32 v[16:17], v[136:137], v[76:77], v[16:17] op_sel:[0,1,0] op_sel_hi:[1,1,1]
    v_pk_fma_f32 v[18:19], v[138:139], v[76:77], v[18:19] op_sel:[0,1,0] op_sel_hi:[1,1,1]
    v_pk_fma_f32 v[20:21], v[140:141], v[92:93], v[20:21] op_sel:[0,1,0] op_sel_hi:[1,1,1]
    v_pk_fma_f32 v[22:23], v[142:143], v[92:93], v[22:23] op_sel:[0,1,0] op_sel_hi:[1,1,1]
    s_set_gpr_idx_off
    s_waitcnt vmcnt(1)
.p2align 3
    v_mfma_f32_16x16x16_bf16 v[128:131], v[160:161], v[120:121], 0
    v_cvt_pk_bf16_f32 v10, v159, v159
    v_mfma_f32_16x16x16_bf16 v[132:135], v[160:161], v[122:123], 0
    v_and_b32 v162, v190, v10
    v_and_b32 v163, v191, v10
    s_waitcnt vmcnt(0)
.p2align 3
    s_nop 0
    v_mfma_f32_16x16x16_bf16 v[136:139], v[162:163], v[124:125], 0
    v_mfma_f32_16x16x16_bf16 v[140:143], v[162:163], v[126:127], 0
    s_set_gpr_idx_on s70, gpr_idx(SRC2,DST)
.p2align 3
    v_pk_fma_f32 v[16:17], v[128:129], v[78:79], v[16:17] op_sel_hi:[1,0,1]
    v_pk_fma_f32 v[18:19], v[130:131], v[78:79], v[18:19] op_sel_hi:[1,0,1]
    v_pk_fma_f32 v[20:21], v[132:133], v[94:95], v[20:21] op_sel_hi:[1,0,1]
    v_pk_fma_f32 v[22:23], v[134:135], v[94:95], v[22:23] op_sel_hi:[1,0,1]
    s_set_gpr_idx_idx s71
.p2align 3
    s_nop 0
    v_pk_fma_f32 v[16:17], v[136:137], v[78:79], v[16:17] op_sel:[0,1,0] op_sel_hi:[1,1,1]
    v_pk_fma_f32 v[18:19], v[138:139], v[78:79], v[18:19] op_sel:[0,1,0] op_sel_hi:[1,1,1]
    v_pk_fma_f32 v[20:21], v[140:141], v[94:95], v[20:21] op_sel:[0,1,0] op_sel_hi:[1,1,1]
    v_pk_fma_f32 v[22:23], v[142:143], v[94:95], v[22:23] op_sel:[0,1,0] op_sel_hi:[1,1,1]
    s_set_gpr_idx_off
L_swept:
    s_add_u32 s48, s48, 224
    s_cmp_lt_u32 s48, s47
    s_cbranch_scc1 L_again
    s_setprio 0
    v_cvt_pk_bf16_f32 v64, v16, v20
    v_cvt_pk_bf16_f32 v65, v17, v21
    v_cvt_pk_bf16_f32 v66, v18, v22
    v_cvt_pk_bf16_f32 v67, v19, v23
    ds_write2_b32 v208, v64, v65 offset0:0 offset1:72
    ds_write2_b32 v208, v66, v67 offset0:144 offset1:216
    v_cvt_pk_bf16_f32 v68, v24, v28
    v_cvt_pk_bf16_f32 v69, v25, v29
    v_cvt_pk_bf16_f32 v70, v26, v30
    v_cvt_pk_bf16_f32 v71, v27, v31
    ds_write2_b32 v209, v68, v69 offset0:0 offset1:72
    ds_write2_b32 v209, v70, v71 offset0:144 offset1:216
    v_cvt_pk_bf16_f32 v72, v32, v36
    v_cvt_pk_bf16_f32 v73, v33, v37
    v_cvt_pk_bf16_f32 v74, v34, v38
    v_cvt_pk_bf16_f32 v75, v35, v39
    ds_write2_b32 v210, v72, v73 offset0:0 offset1:72
    ds_write2_b32 v210, v74, v75 offset0:144 offset1:216
    v_cvt_pk_bf16_f32 v76, v40, v44
    v_cvt_pk_bf16_f32 v77, v41, v45
    v_cvt_pk_bf16_f32 v78, v42, v46
    v_cvt_pk_bf16_f32 v79, v43, v47
    ds_write2_b32 v211, v76, v77 offset0:0 offset1:72
    ds_write2_b32 v211, v78, v79 offset0:144 offset1:216
    v_cvt_pk_bf16_f32 v80, v48, v52
    v_cvt_pk_bf16_f32 v81, v49, v53
    v_cvt_pk_bf16_f32 v82, v50, v54
    v_cvt_pk_bf16_f32 v83, v51, v55
    ds_write2_b32 v212, v80, v81 offset0:0 offset1:72
    ds_write2_b32 v212, v82, v83 offset0:144 offset1:216
    ds_read_b128 v[96:99], v215 offset:6144
    ds_read_b128 v[100:103], v215 offset:7168
    ds_read_b128 v[104:107], v215 offset:8192
    ds_read_b128 v[108:111], v215 offset:9216
    ds_read_b128 v[112:115], v215 offset:10240
    ds_read_b128 v[116:119], v215 offset:11264
    ds_read_b128 v[120:123], v215 offset:12288
    ds_read_b128 v[124:127], v215 offset:13312
    ds_read_b128 v[128:131], v215 offset:14336
    ds_read_b128 v[132:135], v215 offset:15360
    s_waitcnt lgkmcnt(10)
    s_barrier
    ds_read_b128 v[16:19], v213 offset:0
    ds_read_b128 v[20:23], v213 offset:64
    ds_read_b128 v[24:27], v213 offset:128
    ds_read_b128 v[28:31], v213 offset:192
    s_waitcnt lgkmcnt(3)
    v_mfma_f32_16x16x32_bf16 v[160:163], v[16:19], v[216:219], 0
    v_mfma_f32_16x16x32_bf16 v[164:167], v[16:19], v[220:223], 0
    v_mfma_f32_16x16x32_bf16 v[168:171], v[16:19], v[224:227], 0
    v_mfma_f32_16x16x32_bf16 v[172:175], v[16:19], v[228:231], 0
    ds_read_b128 v[32:35], v213 offset:4608
    ds_read_b128 v[36:39], v213 offset:4672
    ds_read_b128 v[40:43], v213 offset:4736
    ds_read_b128 v[44:47], v213 offset:4800
    s_waitcnt lgkmcnt(6)
    v_mfma_f32_16x16x32_bf16 v[160:163], v[20:23], v[232:235], v[160:163]
    v_mfma_f32_16x16x32_bf16 v[164:167], v[20:23], v[236:239], v[164:167]
    v_mfma_f32_16x16x32_bf16 v[168:171], v[20:23], v[96:99], v[168:171]
    v_mfma_f32_16x16x32_bf16 v[172:175], v[20:23], v[100:103], v[172:175]
    ds_read_b128 v[48:51], v213 offset:9216
    ds_read_b128 v[52:55], v213 offset:9280
    ds_read_b128 v[56:59], v213 offset:9344
    ds_read_b128 v[60:63], v213 offset:9408
    s_waitcnt lgkmcnt(9)
    v_mfma_f32_16x16x32_bf16 v[160:163], v[24:27], v[104:107], v[160:163]
    v_mfma_f32_16x16x32_bf16 v[164:167], v[24:27], v[108:111], v[164:167]
    v_mfma_f32_16x16x32_bf16 v[168:171], v[24:27], v[112:115], v[168:171]
    v_mfma_f32_16x16x32_bf16 v[172:175], v[24:27], v[116:119], v[172:175]
    s_waitcnt lgkmcnt(8)
    v_mfma_f32_16x16x32_bf16 v[160:163], v[28:31], v[120:123], v[160:163]
    v_mfma_f32_16x16x32_bf16 v[164:167], v[28:31], v[124:127], v[164:167]
    v_mfma_f32_16x16x32_bf16 v[168:171], v[28:31], v[128:131], v[168:171]
    v_mfma_f32_16x16x32_bf16 v[172:175], v[28:31], v[132:135], v[172:175]
    s_waitcnt lgkmcnt(4)
    v_mfma_f32_16x16x32_bf16 v[176:179], v[32:35], v[216:219], 0
    v_mfma_f32_16x16x32_bf16 v[180:183], v[32:35], v[220:223], 0
    v_mfma_f32_16x16x32_bf16 v[184:187], v[32:35], v[224:227], 0
    v_mfma_f32_16x16x32_bf16 v[188:191], v[32:35], v[228:231], 0
    v_mfma_f32_16x16x32_bf16 v[176:179], v[36:39], v[232:235], v[176:179]
    v_cvt_pk_bf16_f32 v64, v160, v164
    v_cvt_pk_bf16_f32 v80, v160, v164
    v_mfma_f32_16x16x32_bf16 v[180:183], v[36:39], v[236:239], v[180:183]
    v_cvt_pk_bf16_f32 v66, v162, v166
    v_cvt_pk_bf16_f32 v65, v168, v172
    v_mfma_f32_16x16x32_bf16 v[184:187], v[36:39], v[96:99], v[184:187]
    v_cvt_pk_bf16_f32 v81, v168, v172
    v_cvt_pk_bf16_f32 v67, v170, v174
    v_mfma_f32_16x16x32_bf16 v[188:191], v[36:39], v[100:103], v[188:191]
    v_mov_b32_dpp v64, v66 row_ror:8 row_mask:0xf bank_mask:0xc
    v_mov_b32_dpp v65, v67 row_ror:8 row_mask:0xf bank_mask:0xc
    v_mfma_f32_16x16x32_bf16 v[176:179], v[40:43], v[104:107], v[176:179]
    v_mov_b32_dpp v66, v80 row_ror:8 row_mask:0xf bank_mask:0x3
    v_mov_b32_dpp v67, v81 row_ror:8 row_mask:0xf bank_mask:0x3
    v_mfma_f32_16x16x32_bf16 v[180:183], v[40:43], v[108:111], v[180:183]
    buffer_store_dwordx4 v[64:67], v214, s[40:43], s99 offen offset:0 sc1
    v_cvt_pk_bf16_f32 v68, v161, v165
    v_mfma_f32_16x16x32_bf16 v[184:187], v[40:43], v[112:115], v[184:187]
    v_cvt_pk_bf16_f32 v82, v161, v165
    v_cvt_pk_bf16_f32 v70, v163, v167
    v_mfma_f32_16x16x32_bf16 v[188:191], v[40:43], v[116:119], v[188:191]
    v_cvt_pk_bf16_f32 v69, v169, v173
    v_cvt_pk_bf16_f32 v83, v169, v173
    v_mfma_f32_16x16x32_bf16 v[176:179], v[44:47], v[120:123], v[176:179]
    v_cvt_pk_bf16_f32 v71, v171, v175
    v_mov_b32_dpp v68, v70 row_ror:8 row_mask:0xf bank_mask:0xc
    v_mfma_f32_16x16x32_bf16 v[180:183], v[44:47], v[124:127], v[180:183]
    v_mov_b32_dpp v69, v71 row_ror:8 row_mask:0xf bank_mask:0xc
    v_mov_b32_dpp v70, v82 row_ror:8 row_mask:0xf bank_mask:0x3
    v_mfma_f32_16x16x32_bf16 v[184:187], v[44:47], v[128:131], v[184:187]
    v_mov_b32_dpp v71, v83 row_ror:8 row_mask:0xf bank_mask:0x3
    buffer_store_dwordx4 v[68:71], v214, s[40:43], s99 offen offset:256 sc1
    v_mfma_f32_16x16x32_bf16 v[188:191], v[44:47], v[132:135], v[188:191]
    s_add_u32 s99, s99, 4096
    s_cmp_ge_u32 s3, 4
    s_cbranch_scc1 L_two
    s_waitcnt lgkmcnt(0)
    v_mfma_f32_16x16x32_bf16 v[160:163], v[48:51], v[216:219], 0
    v_mfma_f32_16x16x32_bf16 v[164:167], v[48:51], v[220:223], 0
    v_mfma_f32_16x16x32_bf16 v[168:171], v[48:51], v[224:227], 0
    v_mfma_f32_16x16x32_bf16 v[172:175], v[48:51], v[228:231], 0
    v_mfma_f32_16x16x32_bf16 v[160:163], v[52:55], v[232:235], v[160:163]
    v_cvt_pk_bf16_f32 v72, v176, v180
    v_cvt_pk_bf16_f32 v80, v176, v180
    v_mfma_f32_16x16x32_bf16 v[164:167], v[52:55], v[236:239], v[164:167]
    v_cvt_pk_bf16_f32 v74, v178, v182
    v_cvt_pk_bf16_f32 v73, v184, v188
    v_mfma_f32_16x16x32_bf16 v[168:171], v[52:55], v[96:99], v[168:171]
    v_cvt_pk_bf16_f32 v81, v184, v188
    v_cvt_pk_bf16_f32 v75, v186, v190
    v_mfma_f32_16x16x32_bf16 v[172:175], v[52:55], v[100:103], v[172:175]
    v_mov_b32_dpp v72, v74 row_ror:8 row_mask:0xf bank_mask:0xc
    v_mov_b32_dpp v73, v75 row_ror:8 row_mask:0xf bank_mask:0xc
    v_mfma_f32_16x16x32_bf16 v[160:163], v[56:59], v[104:107], v[160:163]
    v_mov_b32_dpp v74, v80 row_ror:8 row_mask:0xf bank_mask:0x3
    v_mov_b32_dpp v75, v81 row_ror:8 row_mask:0xf bank_mask:0x3
    v_mfma_f32_16x16x32_bf16 v[164:167], v[56:59], v[108:111], v[164:167]
    buffer_store_dwordx4 v[72:75], v214, s[40:43], s99 offen offset:0 sc1
    v_cvt_pk_bf16_f32 v76, v177, v181
    v_mfma_f32_16x16x32_bf16 v[168:171], v[56:59], v[112:115], v[168:171]
    v_cvt_pk_bf16_f32 v82, v177, v181
    v_cvt_pk_bf16_f32 v78, v179, v183
    v_mfma_f32_16x16x32_bf16 v[172:175], v[56:59], v[116:119], v[172:175]
    v_cvt_pk_bf16_f32 v77, v185, v189
    v_cvt_pk_bf16_f32 v83, v185, v189
    v_mfma_f32_16x16x32_bf16 v[160:163], v[60:63], v[120:123], v[160:163]
    v_cvt_pk_bf16_f32 v79, v187, v191
    v_mov_b32_dpp v76, v78 row_ror:8 row_mask:0xf bank_mask:0xc
    v_mfma_f32_16x16x32_bf16 v[164:167], v[60:63], v[124:127], v[164:167]
    v_mov_b32_dpp v77, v79 row_ror:8 row_mask:0xf bank_mask:0xc
    v_mov_b32_dpp v78, v82 row_ror:8 row_mask:0xf bank_mask:0x3
    v_mfma_f32_16x16x32_bf16 v[168:171], v[60:63], v[128:131], v[168:171]
    v_mov_b32_dpp v79, v83 row_ror:8 row_mask:0xf bank_mask:0x3
    buffer_store_dwordx4 v[76:79], v214, s[40:43], s99 offen offset:256 sc1
    v_mfma_f32_16x16x32_bf16 v[172:175], v[60:63], v[132:135], v[172:175]
    s_add_u32 s99, s99, 4096
    s_nop 0
    v_cvt_pk_bf16_f32 v64, v160, v164
    v_cvt_pk_bf16_f32 v80, v160, v164
    v_cvt_pk_bf16_f32 v66, v162, v166
    s_nop 2
    v_cvt_pk_bf16_f32 v65, v168, v172
    v_cvt_pk_bf16_f32 v81, v168, v172
    v_cvt_pk_bf16_f32 v67, v170, v174
    v_mov_b32_dpp v64, v66 row_ror:8 row_mask:0xf bank_mask:0xc
    s_nop 0
    v_mov_b32_dpp v65, v67 row_ror:8 row_mask:0xf bank_mask:0xc
    v_mov_b32_dpp v66, v80 row_ror:8 row_mask:0xf bank_mask:0x3
    v_mov_b32_dpp v67, v81 row_ror:8 row_mask:0xf bank_mask:0x3
    buffer_store_dwordx4 v[64:67], v214, s[40:43], s99 offen offset:0 sc1
    v_cvt_pk_bf16_f32 v68, v161, v165
    v_cvt_pk_bf16_f32 v82, v161, v165
    v_cvt_pk_bf16_f32 v70, v163, v167
    v_cvt_pk_bf16_f32 v69, v169, v173
    v_cvt_pk_bf16_f32 v83, v169, v173
    v_cvt_pk_bf16_f32 v71, v171, v175
    v_mov_b32_dpp v68, v70 row_ror:8 row_mask:0xf bank_mask:0xc
    s_nop 0
    v_mov_b32_dpp v69, v71 row_ror:8 row_mask:0xf bank_mask:0xc
    v_mov_b32_dpp v70, v82 row_ror:8 row_mask:0xf bank_mask:0x3
    v_mov_b32_dpp v71, v83 row_ror:8 row_mask:0xf bank_mask:0x3
    buffer_store_dwordx4 v[68:71], v214, s[40:43], s99 offen offset:256 sc1
    s_add_u32 s99, s99, 4096
L_stored:
    s_or_b32 s4, s2, s3
    s_cbranch_scc1 L_notag
    v_mov_b32 v8, s62
    v_lshlrev_b32 v10, 2, v1
    s_mov_b32 s54, 524288
    buffer_store_dword v8, v10, s[20:23], s54 offen sc1
L_notag:
L_done:
    s_endpgm
L_again:
    s_waitcnt vmcnt(0) lgkmcnt(0)
    s_barrier
    v_lshlrev_b32 v11, 2, v0
    v_mov_b32 v12, 0x00700000
    v_mov_b32 v13, 0
    ds_write_b32 v11, v12 offset:0
    ds_write_b32 v11, v12 offset:2048
    ds_write_b32 v11, v12 offset:4096
    ds_write_b32 v11, v12 offset:6144
    ds_write_b32 v11, v13 offset:8192
    ds_write_b32 v11, v13 offset:10240
    ds_write_b32 v11, v13 offset:12288
    v_add_u32 v3, v3, v4
    v_subrev_u32 v3, 224, v3
    v_max_i32 v3, 0, v3
    v_subrev_u32 v4, 224, v4
    v_max_i32 v4, 0, v4
    v_sub_u32 v3, v3, v4
    v_add_u32 v5, 224, v5
    s_sub_i32 s95, s95, 224
    v_lshl_add_u32 v8, v4, 2, v241
    s_waitcnt lgkmcnt(0)
    s_barrier
L_clip:
    v_add_u32 v10, v4, v3
    v_min_i32 v10, 224, v10
    v_sub_u32 v10, v10, v4
    v_add_u32 v10, v10, v240
L_masks:
    v_cmp_lt_i32 s[64:65], 0, v10
    v_cmp_lt_i32 s[66:67], 2, v10
    v_cmp_lt_i32 s[68:69], 4, v10
    v_cmp_lt_i32 s[70:71], 6, v10
    v_cmp_lt_i32 s[72:73], 8, v10
    v_cmp_lt_i32 s[74:75], 10, v10
    v_cmp_lt_i32 s[76:77], 12, v10
    v_cmp_lt_i32 s[78:79], 14, v10
    s_nop 0
    s_branch L_mapw
L_map2:
    v_add_u32 v8, 56, v8
    v_subrev_u32 v10, 14, v10
    s_branch L_masks
L_r1:
    ds_read_b32 v67, v242 offset:768
    ds_read_b32 v74, v243 offset:768
    s_waitcnt lgkmcnt(0)
    v_mad_u32_u24 v67, v67, 12, v244
    buffer_load_dwordx3 v[88:90], v67, s[24:27], 0 offen offset:2304 sc1
    v_lshl_add_u32 v74, v74, 5, v2
    s_add_u32 m0, s52, 4096
    s_nop 0
    buffer_load_dwordx4 v74, s[28:31], s98 offen offset:2048 sc1 lds
    s_branch L_r1b
L_r2:
    v_lshrrev_b32 v135, 21, v90
    v_lshlrev_b32 v135, 2, v135
    v_lshrrev_b32 v11, 26, v90
    v_lshl_or_b32 v11, v11, 4, v245
    s_mov_b64 exec, s[96:97]
    ds_add_rtn_u32 v131, v135, v6 offset:8192
    ds_add_u32 v11, v6 offset:14336
    s_mov_b64 exec, -1
    s_mov_b32 exec_hi, 0
    ds_write_b64 v246, v[88:89] offset:1536
    s_mov_b32 exec_hi, -1
    v_and_or_b32 v90, v90, s55, v247
    v_add_u32 v90, 402653184, v90
    s_branch L_r2b
L_r3:
    ds_read_b32 v135, v135 offset:8192
    s_waitcnt lgkmcnt(0)
    v_bfe_u32 v15, v135, 12, 3
    v_or_b32 v90, v15, v90
    v_and_b32 v67, 0x3ff, v135
    v_lshrrev_b32 v135, 16, v135
    v_add_u32 v135, v135, v131
    ds_read_b32 v67, v67 offset:16384
    s_waitcnt lgkmcnt(0)
    v_lshl_add_u32 v135, v135, 2, v67
    s_mov_b64 exec, s[96:97]
    ds_write_b32 v135, v90
    s_mov_b64 exec, -1
    s_branch L_r3b
L_two:
    s_nop 7
    v_cvt_pk_bf16_f32 v72, v176, v180
    v_cvt_pk_bf16_f32 v80, v176, v180
    v_cvt_pk_bf16_f32 v74, v178, v182
    v_cvt_pk_bf16_f32 v73, v184, v188
    v_cvt_pk_bf16_f32 v81, v184, v188
    v_cvt_pk_bf16_f32 v75, v186, v190
    v_mov_b32_dpp v72, v74 row_ror:8 row_mask:0xf bank_mask:0xc
    s_nop 0
    v_mov_b32_dpp v73, v75 row_ror:8 row_mask:0xf bank_mask:0xc
    v_mov_b32_dpp v74, v80 row_ror:8 row_mask:0xf bank_mask:0x3
    v_mov_b32_dpp v75, v81 row_ror:8 row_mask:0xf bank_mask:0x3
    buffer_store_dwordx4 v[72:75], v214, s[40:43], s99 offen offset:0 sc1
    v_cvt_pk_bf16_f32 v76, v177, v181
    v_cvt_pk_bf16_f32 v82, v177, v181
    v_cvt_pk_bf16_f32 v78, v179, v183
    v_cvt_pk_bf16_f32 v77, v185, v189
    v_cvt_pk_bf16_f32 v83, v185, v189
    v_cvt_pk_bf16_f32 v79, v187, v191
    v_mov_b32_dpp v76, v78 row_ror:8 row_mask:0xf bank_mask:0xc
    s_nop 0
    v_mov_b32_dpp v77, v79 row_ror:8 row_mask:0xf bank_mask:0xc
    v_mov_b32_dpp v78, v82 row_ror:8 row_mask:0xf bank_mask:0x3
    v_mov_b32_dpp v79, v83 row_ror:8 row_mask:0xf bank_mask:0x3
    buffer_store_dwordx4 v[76:79], v214, s[40:43], s99 offen offset:256 sc1
    s_add_u32 s99, s99, 4096
    s_branch L_stored
L_poll:
    buffer_load_dwordx2 v[206:207], v10, s[20:23], s49 offen sc1
    s_sub_u32 s53, s53, 1
    s_cbranch_scc1 L_done
    s_waitcnt vmcnt(0)
    v_xor_b32 v11, s63, v206
    v_xor_b32 v12, s62, v207
    v_and_or_b32 v11, v11, s55, v12
    v_cmpx_ne_u32 vcc, 0, v11
    s_cbranch_execnz L_poll
    s_branch L_polled
L_rank2:
    ds_read_b32 v96, v248 offset:8192
    ds_read_b32 v97, v248 offset:8320
    ds_read_b32 v98, v248 offset:8448
    ds_read_b32 v99, v248 offset:8576
    ds_read_b32 v100, v248 offset:8704
    s_waitcnt lgkmcnt(0)
L_end:
    s_branch L_ranked
.section .rodata,"a"
.p2align 6
.amdhsa_kernel gather_scatter__tensor_product_equiv_mace__graph_kernel
  .amdhsa_next_free_vgpr 256
  .amdhsa_next_free_sgpr 102
  .amdhsa_accum_offset 256
  .amdhsa_group_segment_fixed_size 0
  .amdhsa_kernarg_size 88
  .amdhsa_user_sgpr_count 2
  .amdhsa_user_sgpr_kernarg_segment_ptr 1
  .amdhsa_system_sgpr_workgroup_id_x 1
  .amdhsa_float_denorm_mode_32 3
.end_amdhsa_kernel
```

```asm
; @launch grid=(256,1,1) block=(512,1,1) lds=158784
.amdgcn_target "amdgcn-amd-amdhsa--gfx950"
.text
.globl gather_scatter__tensor_product_equiv_mace__graph_kernel
.p2align 8
.type gather_scatter__tensor_product_equiv_mace__graph_kernel,@function
gather_scatter__tensor_product_equiv_mace__graph_kernel:
    s_cmp_ge_u32 s2, 256
    s_cbranch_scc1 L_done
    s_load_dwordx4 s[4:7], s[0:1], 8
    s_load_dwordx4 s[8:11], s[0:1], 24
    s_load_dwordx2 s[14:15], s[0:1], 80
    s_load_dwordx2 s[64:65], s[0:1], 0
    s_load_dwordx2 s[66:67], s[0:1], 40
    s_load_dwordx4 s[68:71], s[0:1], 48
    s_load_dwordx2 s[12:13], s[0:1], 64
    v_lshlrev_b32 v10, 3, v0
    s_getpc_b64 s[80:81]
L_pc:
    s_and_b32 s44, s2, 0xf8
    s_lshl_b32 s44, s44, 6
    v_and_b32 v11, 0x180, v10
    v_add_u32 v11, s44, v11
    v_min_u32 v11, L_end-L_pc, v11
    v_mov_b32 v113, s81
    v_add_co_u32 v112, vcc, s80, v11
    s_nop 1
    v_addc_co_u32 v113, vcc, 0, v113, vcc
    global_load_dword v205, v[112:113], off
    v_lshrrev_b32 v8, 6, v0
    v_and_b32 v1, 63, v0
    v_lshlrev_b32 v9, 2, v0
    v_mov_b32 v13, 0
    v_readfirstlane_b32 s3, v8
    ds_write_b32 v9, v13 offset:23552
    ds_write_b32 v9, v13 offset:28672
    s_mul_i32 s54, s2, 5000
    s_mul_i32 s55, s2, 10000
    s_mul_i32 s61, s2, 40000
    v_lshlrev_b32 v2, 4, v1
    v_lshlrev_b32 v15, 4, v0
    v_mov_b32 v6, 1
    s_lshl_b32 s52, s3, 10
    s_add_u32 s52, s52, 101376
    s_movk_i32 s53, 4096
    s_movk_i32 s50, 8192
    s_mov_b32 s34, 5000
    s_mov_b32 s35, 0x20000
    s_mov_b32 s38, 5000
    s_mov_b32 s39, 0x20000
    s_mov_b32 s98, 10000
    s_mov_b32 s99, 0x20000
    s_mov_b32 s30, 40000
    s_mov_b32 s31, 0x20000
    s_waitcnt lgkmcnt(0)
    s_add_u32 s32, s6, s54
    s_addc_u32 s33, s7, 0
    buffer_load_dword v64, v9, s[32:35], 0 offen offset:0 nt
    buffer_load_dword v65, v9, s[32:35], 0 offen offset:2048 nt
    buffer_load_dword v66, v9, s[32:35], s53 offen nt
    s_add_u32 s36, s4, s54
    s_addc_u32 s37, s5, 0
    s_barrier
    buffer_load_dword v68, v9, s[36:39], 0 offen offset:0 nt
    buffer_load_dword v69, v9, s[36:39], 0 offen offset:2048 nt
    buffer_load_dword v70, v9, s[36:39], s53 offen nt
    s_load_dword s62, s[14:15], 524288
    s_add_u32 s96, s8, s55
    s_addc_u32 s97, s9, 0
    s_add_u32 s28, s10, s61
    s_addc_u32 s29, s11, 0
    buffer_load_dwordx2 v[72:73], v10, s[96:99], 0 offen nt
    buffer_load_dwordx2 v[74:75], v10, s[96:99], s53 offen nt
    buffer_load_dwordx2 v[76:77], v10, s[96:99], s50 offen nt
    s_add_u32 m0, s52, 0
    s_mov_b32 s54, 0
    buffer_load_dwordx4 v15, s[28:31], s54 offen nt lds
    s_add_u32 m0, s52, 8192
    s_mov_b32 s54, 8192
    buffer_load_dwordx4 v15, s[28:31], s54 offen nt lds
    s_add_u32 m0, s52, 16384
    s_mov_b32 s54, 16384
    buffer_load_dwordx4 v15, s[28:31], s54 offen nt lds
    s_mov_b32 s72, 109951168
    s_movk_i32 s73, 625
    s_movk_i32 s74, 838
    s_movk_i32 s54, 226
    v_cmp_gt_u32 s[84:85], s54, v0
    s_mov_b32 s20, s14
    s_mov_b32 s21, s15
    s_mov_b32 s22, 524352
    s_mov_b32 s23, 0x20000
    v_lshlrev_b32 v11, 2, v0
    v_mov_b32 v12, 0x00700000
    v_mov_b32 v13, 0
    ds_write_b32 v11, v12 offset:0
    ds_write_b32 v11, v12 offset:2048
    ds_write_b32 v11, v12 offset:4096
    ds_write_b32 v11, v12 offset:6144
    ds_write_b32 v11, v13 offset:8192
    ds_write_b32 v11, v13 offset:10240
    ds_write_b32 v11, v13 offset:12288
    ds_write_b32 v11, v13 offset:14336
    s_waitcnt vmcnt(9)
    v_mul_hi_u32 v80, v64, s72
    v_mul_hi_u32 v81, v65, s72
    v_mul_hi_u32 v82, v66, s72
    v_lshlrev_b32 v84, 2, v80
    ds_add_rtn_u32 v88, v84, v6 offset:23552
    v_lshlrev_b32 v85, 2, v81
    ds_add_rtn_u32 v89, v85, v6 offset:23552
    v_lshlrev_b32 v86, 2, v82
    s_mov_b64 exec, s[84:85]
    ds_add_rtn_u32 v90, v86, v6 offset:23552
    s_mov_b64 exec, -1
    s_waitcnt lgkmcnt(0)
    s_barrier
    ds_read_b128 v[100:103], v2 offset:23552
    s_mul_i32 s62, s62, 0x9e3779b1
    s_add_u32 s62, s62, 0x7f4a7c15
    s_mul_i32 s63, s62, 0x85ebca6b
    s_and_b32 s63, s63, 0xffc00000
    s_add_u32 m0, s52, 24576
    s_mov_b32 s54, 24576
    buffer_load_dwordx4 v15, s[28:31], s54 offen nt lds
    s_add_u32 m0, s52, 32768
    s_mov_b32 s54, 32768
    buffer_load_dwordx4 v15, s[28:31], s54 offen nt lds
    v_mad_u32_u24 v92, v80, s73, 15
    v_lshrrev_b32 v92, 4, v92
    v_sub_u32 v92, v64, v92
    v_mad_u32_u24 v93, v81, s73, 15
    v_lshrrev_b32 v93, 4, v93
    v_sub_u32 v93, v65, v93
    v_mad_u32_u24 v94, v82, s73, 15
    v_lshrrev_b32 v94, 4, v94
    v_sub_u32 v94, v66, v94
    s_waitcnt lgkmcnt(0)
    v_add_u32 v11, v100, v101
    v_add3_u32 v11, v11, v102, v103
    v_mov_b32 v12, v11
    s_nop 1
    v_add_u32_dpp v12, v12, v12 row_shr:1 row_mask:0xf bank_mask:0xf
    s_nop 1
    v_add_u32_dpp v12, v12, v12 row_shr:2 row_mask:0xf bank_mask:0xf
    s_nop 1
    v_add_u32_dpp v12, v12, v12 row_shr:4 row_mask:0xf bank_mask:0xf
    s_nop 1
    v_add_u32_dpp v12, v12, v12 row_shr:8 row_mask:0xf bank_mask:0xf
    s_nop 1
    v_add_u32_dpp v12, v12, v12 row_bcast:15 row_mask:0xa bank_mask:0xf
    s_nop 1
    v_add_u32_dpp v12, v12, v12 row_bcast:31 row_mask:0xc bank_mask:0xf
    v_sub_u32 v104, v12, v11
    v_add_u32 v105, v104, v100
    v_add_u32 v106, v105, v101
    v_add_u32 v107, v106, v102
    ds_write_b128 v2, v[104:107] offset:24576
    ds_read_b32 v108, v84 offset:24576
    ds_read_b32 v109, v85 offset:24576
    ds_read_b32 v110, v86 offset:24576
    s_waitcnt vmcnt(8)
    v_mul_u32_u24 v96, s74, v68
    v_bfe_u32 v96, v96, 18, 5
    v_lshl_or_b32 v96, v92, 5, v96
    v_lshlrev_b32 v96, 21, v96
    v_lshl_or_b32 v96, v68, 7, v96
    v_mul_u32_u24 v97, s74, v69
    v_bfe_u32 v97, v97, 18, 5
    v_lshl_or_b32 v97, v93, 5, v97
    v_lshlrev_b32 v97, 21, v97
    v_lshl_or_b32 v97, v69, 7, v97
    v_mul_u32_u24 v98, s74, v70
    v_bfe_u32 v98, v98, 18, 5
    v_lshl_or_b32 v98, v94, 5, v98
    v_lshlrev_b32 v98, 21, v98
    v_lshl_or_b32 v98, v70, 7, v98
    v_lshlrev_b32 v92, 5, v0
    v_add_u32 v93, 16384, v92
    v_add_u32 v94, 32768, v92
    s_mov_b32 s55, 30720
    s_waitcnt vmcnt(5) lgkmcnt(0)
    v_add_u32 v108, v108, v88
    v_lshlrev_b32 v84, 2, v108
    v_mad_u32_u24 v108, v108, 12, s55
    ds_write_b32 v84, v92 offset:25600
    ds_write2_b32 v108, v72, v73 offset0:0 offset1:1
    ds_write_b32 v108, v96 offset:8
    v_add_u32 v109, v109, v89
    v_lshlrev_b32 v85, 2, v109
    v_mad_u32_u24 v109, v109, 12, s55
    ds_write_b32 v85, v93 offset:25600
    ds_write2_b32 v109, v74, v75 offset0:0 offset1:1
    ds_write_b32 v109, v97 offset:8
    v_add_u32 v110, v110, v90
    v_lshlrev_b32 v86, 2, v110
    v_mad_u32_u24 v110, v110, 12, s55
    s_mov_b64 exec, s[84:85]
    ds_write_b32 v86, v94 offset:25600
    ds_write2_b32 v110, v76, v77 offset0:0 offset1:1
    ds_write_b32 v110, v98 offset:8
    s_mov_b64 exec, -1
    s_lshl_b32 s54, s3, 7
    v_lshl_add_u32 v11, v1, 3, s54
    ds_read_b64 v[100:101], v11 offset:23552
    ds_read_b64 v[104:105], v11 offset:24576
    s_mul_i32 s54, s2, 15360
    s_add_u32 s54, s54, 1048576
    s_add_u32 s32, s14, s54
    s_addc_u32 s33, s15, 0
    s_mov_b32 s34, 15360
    s_mov_b32 s35, 0x20000
    s_mul_i32 s54, s2, 40960
    s_add_u32 s54, s54, 5242880
    s_add_u32 s36, s14, s54
    s_addc_u32 s37, s15, 0
    s_mov_b32 s38, 40000
    s_mov_b32 s39, 0x20000
    v_lshrrev_b32 v11, 1, v0
    v_lshlrev_b32 v11, 2, v11
    v_and_b32 v12, 1, v0
    v_lshlrev_b32 v12, 4, v12
    v_add_u32 v12, 101376, v12
    v_add_u32 v14, 30720, v15
    s_waitcnt lgkmcnt(0)
    s_barrier
    ds_read_b128 v[128:131], v14
    ds_read_b128 v[132:135], v14 offset:8192
    ds_read_b32 v156, v11 offset:25600
    ds_read_b32 v157, v11 offset:26624
    ds_read_b32 v158, v11 offset:27648
    ds_read_b32 v159, v11 offset:28672
    ds_read_b32 v160, v11 offset:29696
    s_cmp_lt_u32 s3, 4
    s_cselect_b32 s16, s68, s66
    s_cselect_b32 s17, s69, s67
    s_movk_i32 s54, 128
    s_cselect_b32 s18, s53, s54
    s_mov_b32 s19, 0x20000
    s_min_u32 s54, s3, 5
    s_lshl_b32 s54, s54, 10
    s_add_u32 m0, s54, 17408
    s_and_b32 s54, s54, 0xc00
    buffer_load_dwordx4 v2, s[16:19], s54 offen lds
    s_mov_b32 s40, s70
    s_mov_b32 s41, s71
    s_mov_b32 s42, 32768
    s_mov_b32 s43, 0x20000
    s_lshl_b32 s55, s3, 12
    s_add_u32 m0, s55, 46080
    s_nop 0
    buffer_load_dwordx4 v2, s[40:43], s55 offen offset:0 lds
    buffer_load_dwordx4 v2, s[40:43], s55 offen offset:1024 lds
    buffer_load_dwordx4 v2, s[40:43], s55 offen offset:2048 lds
    buffer_load_dwordx4 v2, s[40:43], s55 offen offset:3072 lds
    s_waitcnt lgkmcnt(0)
    v_add_u32 v156, v12, v156
    v_add_u32 v157, v12, v157
    v_add_u32 v158, v12, v158
    v_add_u32 v159, v12, v159
    v_add_u32 v160, v12, v160
    v_lshl_or_b32 v112, v100, 11, v104
    v_or_b32 v112, s63, v112
    v_mov_b32 v113, s62
    v_lshl_or_b32 v114, v101, 11, v105
    v_or_b32 v114, s63, v114
    v_mov_b32 v115, s62
    s_waitcnt vmcnt(0)
    s_barrier
    ds_read_b128 v[136:139], v156
    ds_read_b128 v[140:143], v157
    ds_read_b128 v[144:147], v158
    ds_read_b128 v[148:151], v159
    ds_read_b128 v[152:155], v160
    buffer_store_dwordx4 v[128:131], v15, s[32:35], 0 offen sc1
    buffer_store_dwordx4 v[132:135], v15, s[32:35], s50 offen sc1
    s_mov_b32 s54, 0
    s_waitcnt lgkmcnt(4)
    buffer_store_dwordx4 v[136:139], v15, s[36:39], s54 offen sc1
    s_mov_b32 s54, 8192
    s_waitcnt lgkmcnt(3)
    buffer_store_dwordx4 v[140:143], v15, s[36:39], s54 offen sc1
    s_mov_b32 s54, 16384
    s_waitcnt lgkmcnt(2)
    buffer_store_dwordx4 v[144:147], v15, s[36:39], s54 offen sc1
    s_mov_b32 s54, 24576
    s_waitcnt lgkmcnt(1)
    buffer_store_dwordx4 v[148:151], v15, s[36:39], s54 offen sc1
    s_mov_b32 s54, 32768
    s_waitcnt lgkmcnt(0)
    buffer_store_dwordx4 v[152:155], v15, s[36:39], s54 offen sc1
    s_and_b32 s44, s2, 7
    s_lshl_b32 s44, s44, 5
    s_lshr_b32 s54, s2, 3
    s_add_u32 s44, s44, s54
    s_mul_i32 s45, s44, 625
    s_add_u32 s46, s45, 640
    s_add_u32 s45, s45, 15
    s_lshr_b32 s45, s45, 4
    s_lshr_b32 s46, s46, 4
    s_sub_u32 s46, s46, s45
    v_bfe_i32 v168, v1, 2, 1
    v_and_b32 v168, 0xaaaa, v168
    v_add_u32 v168, 0x4444, v168
    v_mov_b32 v169, 158720
    v_and_b32 v11, 60, v9
    v_add_u32 v11, v11, v169
    ds_write_b32 v11, v13
    v_and_b32 v11, 4, v1
    v_lshlrev_b32 v11, 2, v11
    v_mov_b32 v12, 0xffff
    v_lshlrev_b32 v12, v11, v12
    v_bfe_i32 v11, v1, 3, 1
    v_and_b32 v191, v11, v12
    v_xor_b32 v190, v191, v12
    v_lshrrev_b32 v200, 5, v1
    v_lshlrev_b32 v200, 4, v200
    v_add_u32 v200, 101376, v200
    v_and_b32 v201, 15, v1
    v_lshlrev_b32 v201, 2, v201
    v_bfe_u32 v11, v1, 3, 2
    v_and_b32 v12, 3, v1
    v_lshl_add_u32 v11, v11, 2, v12
    v_lshlrev_b32 v202, 2, v11
    v_bfe_i32 v240, v0, 0, 1
    s_lshl_b32 s54, s3, 10
    v_and_b32 v241, 4, v240
    v_add_u32 v241, s54, v241
    v_lshl_add_u32 v242, v1, 2, s54
    v_lshrrev_b32 v243, 1, v1
    v_lshl_add_u32 v243, v243, 2, s54
    v_mul_u32_u24 v244, 12, v1
    v_and_b32 v245, 12, v242
    v_and_b32 v250, 124, v242
    s_mul_i32 s54, s3, 224
    v_add_u32 v247, s54, v1
    v_lshlrev_b32 v246, 3, v247
    v_add_u32 v246, 87040, v246
    v_lshlrev_b32 v247, 21, v247
    s_mul_i32 s54, s3, 640
    v_add_u32 v248, s54, v250
    v_sub_u32 v249, 63, v1
    s_getreg_b32 s86, hwreg(HW_REG_XCC_ID, 0, 3)
    s_lshl_b32 s54, s86, 4
    v_subrev_u32 v250, s54, v250
    v_and_b32 v250, 124, v250
    s_lshl_b32 s54, s3, 5
    v_lshl_add_u32 v251, v1, 2, s54
    v_lshrrev_b32 v252, 3, v1
    v_mul_u32_u24 v252, 64, v252
    v_add_u32 v252, 78848, v252
    s_cmp_eq_u32 s46, 40
    v_mov_b32 v203, 0
    s_mov_b32 s54, 685900808
    s_cselect_b32 s54, 568459824, s54
    s_mov_b32 exec_lo, 31
    s_mov_b32 exec_hi, 0
    v_mov_b32 v203, s54
    s_mov_b32 s54, 182814793
    s_cselect_b32 s54, 23232528, s54
    s_mov_b32 exec_lo, 992
    s_mov_b32 exec_hi, 0
    v_mov_b32 v203, s54
    s_mov_b32 s54, 984091248
    s_cselect_b32 s54, 719688297, s54
    s_mov_b32 exec_lo, 31744
    s_mov_b32 exec_hi, 0
    v_mov_b32 v203, s54
    s_mov_b32 s54, 424091761
    s_cselect_b32 s54, 984423522, s54
    s_mov_b32 exec_lo, 1015808
    s_mov_b32 exec_hi, 0
    v_mov_b32 v203, s54
    s_mov_b32 s54, 586001611
    s_cselect_b32 s54, 172635826, s54
    s_mov_b32 exec_lo, 32505856
    s_mov_b32 exec_hi, 0
    v_mov_b32 v203, s54
    s_mov_b32 s54, 64039106
    s_cselect_b32 s54, 454017211, s54
    s_mov_b32 exec_lo, 1040187392
    s_mov_b32 exec_hi, 0
    v_mov_b32 v203, s54
    s_mov_b32 s54, 330320603
    s_cselect_b32 s54, 743654643, s54
    s_mov_b32 exec_lo, 3221225472
    s_mov_b32 exec_hi, 7
    v_mov_b32 v203, s54
    s_mov_b32 s54, 217139484
    s_cselect_b32 s54, 607143691, s54
    s_mov_b32 exec_lo, 0
    s_mov_b32 exec_hi, 248
    v_mov_b32 v203, s54
    s_mov_b64 exec, -1
    v_mul_u32_u24 v11, 52, v1
    v_lshrrev_b32 v11, 8, v11
    v_mad_i32_i24 v11, v11, -5, v1
    v_mul_u32_u24 v11, 6, v11
    v_lshrrev_b32 v203, v11, v203
    v_and_b32 v11, 7, v203
    v_bfe_u32 v203, v203, 3, 3
    v_lshlrev_b32 v11, 12, v11
    v_lshl_or_b32 v203, v203, 7, v11
    s_add_u32 s24, s14, 1048576
    s_addc_u32 s25, s15, 0
    s_mov_b32 s26, 3932160
    s_mov_b32 s27, 0x20000
    v_mov_b32 v16, 0
    v_mov_b32 v17, 0
    v_mov_b32 v18, 0
    v_mov_b32 v19, 0
    v_mov_b32 v20, 0
    v_mov_b32 v21, 0
    v_mov_b32 v22, 0
    v_mov_b32 v23, 0
    v_mov_b32 v24, 0
    v_mov_b32 v25, 0
    v_mov_b32 v26, 0
    v_mov_b32 v27, 0
    v_mov_b32 v28, 0
    v_mov_b32 v29, 0
    v_mov_b32 v30, 0
    v_mov_b32 v31, 0
    v_mov_b32 v32, 0
    v_mov_b32 v33, 0
    v_mov_b32 v34, 0
    v_mov_b32 v35, 0
    v_mov_b32 v36, 0
    v_mov_b32 v37, 0
    v_mov_b32 v38, 0
    v_mov_b32 v39, 0
    v_mov_b32 v40, 0
    v_mov_b32 v41, 0
    v_mov_b32 v42, 0
    v_mov_b32 v43, 0
    v_mov_b32 v44, 0
    v_mov_b32 v45, 0
    v_mov_b32 v46, 0
    v_mov_b32 v47, 0
    v_mov_b32 v48, 0
    v_mov_b32 v49, 0
    v_mov_b32 v50, 0
    v_mov_b32 v51, 0
    v_mov_b32 v52, 0
    v_mov_b32 v53, 0
    v_mov_b32 v54, 0
    v_mov_b32 v55, 0
    v_mov_b32 v56, 0
    v_mov_b32 v57, 0
    v_mov_b32 v58, 0
    v_mov_b32 v59, 0
    v_mov_b32 v60, 0
    v_mov_b32 v61, 0
    v_mov_b32 v62, 0
    v_mov_b32 v63, 0
    s_lshl_b32 s54, s2, 3
    s_add_u32 s54, s54, s3
    s_lshl_b32 s54, s54, 8
    s_mov_b32 s16, s64
    s_mov_b32 s17, s65
    s_mov_b32 s18, 10240000
    s_mov_b32 s19, 0x20000
    s_add_u32 s28, s14, 5242880
    s_addc_u32 s29, s15, 0
    s_mov_b32 s30, 10485760
    s_mov_b32 s31, 0x20000
    s_and_b32 s51, s86, 7
    s_mul_i32 s51, s51, 1282048
    s_and_b32 s55, s2, 0xf8
    s_add_u32 s55, s55, s3
    s_mul_i32 s55, s55, 2304
    s_add_u32 s51, s51, s55
    v_min_u32 v14, 17, v1
    v_lshlrev_b32 v14, 7, v14
    s_waitcnt vmcnt(0)
    s_barrier
    s_mov_b64 exec, 0xffff
    buffer_store_dwordx4 v[112:115], v2, s[20:23], s54 offen sc1
    s_mov_b64 exec, -1
    buffer_load_dword v7, v14, s[16:19], s51 offen
    s_lshl_b32 s54, s45, 10
    s_add_u32 s40, s12, s54
    s_addc_u32 s41, s13, 0
    s_lshl_b32 s42, s46, 10
    s_mov_b32 s43, 0x20000
    v_lshrrev_b32 v8, 5, v1
    v_lshlrev_b32 v8, 10, v8
    v_and_b32 v9, 15, v1
    v_lshl_add_u32 v8, v9, 4, v8
    ds_read_b128 v[64:67], v8 offset:17408
    ds_read_b128 v[68:71], v8 offset:17664
    ds_read_b128 v[72:75], v8 offset:17920
    ds_read_b128 v[76:79], v8 offset:18176
    ds_read_b128 v[80:83], v8 offset:19456
    ds_read_b128 v[84:87], v8 offset:19712
    ds_read_b128 v[88:91], v8 offset:19968
    ds_read_b128 v[92:95], v8 offset:20224
    v_lshrrev_b32 v8, 4, v1
    v_lshlrev_b32 v8, 5, v8
    v_and_b32 v9, 3, v1
    v_lshl_add_u32 v8, v9, 1, v8
    ds_read_u16 v96, v8 offset:21504
    ds_read_u16 v97, v8 offset:21512
    ds_read_u16 v98, v8 offset:21520
    ds_read_u16 v99, v8 offset:21528
    v_bfe_i32 v10, v1, 4, 1
    v_and_b32 v10, 0x02020202, v10
    v_add_u32 v10, 0x05040100, v10
    s_waitcnt lgkmcnt(0)
    v_perm_b32 v172, v68, v64, v10
    v_perm_b32 v174, v76, v72, v10
    v_perm_b32 v176, v84, v80, v10
    v_perm_b32 v178, v92, v88, v10
    v_perm_b32 v173, v69, v65, v10
    v_perm_b32 v175, v77, v73, v10
    v_perm_b32 v177, v85, v81, v10
    v_perm_b32 v179, v93, v89, v10
    v_perm_b32 v180, v70, v66, v10
    v_perm_b32 v182, v78, v74, v10
    v_perm_b32 v184, v86, v82, v10
    v_perm_b32 v186, v94, v90, v10
    v_perm_b32 v181, v71, v67, v10
    v_perm_b32 v183, v79, v75, v10
    v_perm_b32 v185, v87, v83, v10
    v_perm_b32 v187, v95, v91, v10
    v_lshl_or_b32 v188, v97, 16, v96
    v_lshl_or_b32 v189, v99, 16, v98
    v_and_b32 v9, 7, v1
    v_lshrrev_b32 v8, 4, v1
    v_lshlrev_b32 v8, 13, v8
    v_lshl_add_u32 v8, v9, 4, v8
    v_and_b32 v9, 8, v1
    s_and_b32 s72, s3, 3
    s_lshl_b32 s72, s72, 8
    s_lshr_b32 s73, s3, 2
    s_lshl_b32 s73, s73, 7
    s_add_u32 s72, s72, s73
    s_add_u32 s72, s72, 46080
    v_add3_u32 v8, v8, v9, s72
    ds_read2st64_b64 v[128:131], v8 offset0:0 offset1:2
    ds_read2st64_b64 v[132:135], v8 offset0:4 offset1:6
    ds_read2st64_b64 v[136:139], v8 offset0:8 offset1:10
    ds_read2st64_b64 v[140:143], v8 offset0:12 offset1:14
    s_mov_b32 s72, 0x05040100
    s_mov_b32 s73, 0x07060302
    s_waitcnt lgkmcnt(3)
    v_perm_b32 v144, v130, v128, s72
    v_perm_b32 v148, v130, v128, s73
    v_perm_b32 v152, v131, v129, s72
    v_perm_b32 v156, v131, v129, s73
    s_waitcnt lgkmcnt(2)
    v_perm_b32 v145, v134, v132, s72
    v_perm_b32 v149, v134, v132, s73
    v_perm_b32 v153, v135, v133, s72
    v_perm_b32 v157, v135, v133, s73
    s_waitcnt lgkmcnt(1)
    v_perm_b32 v146, v138, v136, s72
    v_perm_b32 v150, v138, v136, s73
    v_perm_b32 v154, v139, v137, s72
    v_perm_b32 v158, v139, v137, s73
    s_waitcnt lgkmcnt(0)
    v_perm_b32 v147, v142, v140, s72
    v_perm_b32 v151, v142, v140, s73
    v_perm_b32 v155, v143, v141, s72
    v_perm_b32 v159, v143, v141, s73
    s_lshl_b32 s54, s3, 12
    v_add_u32 v8, s54, v2
    v_lshrrev_b32 v9, 1, v0
    v_lshlrev_b32 v10, 11, v9
    s_lshl_b32 s49, s44, 3
    v_mul_u32_u24 v5, 1280, v9
    s_mov_b32 s48, 0
    s_mov_b32 s53, 200000
    s_mov_b32 s55, 0xffc00000
    s_mul_i32 s52, s3, 7168
    s_add_u32 s52, s52, 101376
    s_movk_i32 s98, 4096
    s_waitcnt vmcnt(0)
    s_barrier
    buffer_load_dwordx2 v[206:207], v10, s[20:23], s49 offen sc1
    ds_write_b128 v8, v[144:147] offset:46080
    ds_write_b128 v8, v[148:151] offset:47104
    ds_write_b128 v8, v[152:155] offset:48128
    ds_write_b128 v8, v[156:159] offset:49152
    s_waitcnt vmcnt(0)
    v_xor_b32 v11, s63, v206
    v_xor_b32 v12, s62, v207
    v_and_or_b32 v11, v11, s55, v12
    v_cmpx_ne_u32 vcc, 0, v11
    s_cbranch_execnz L_poll
L_polled:
    s_mov_b64 exec, -1
    v_bfe_u32 v3, v206, 11, 11
    v_and_b32 v4, v3, v240
    v_add_u32 v10, v3, v240
    v_and_b32 v11, 0x7ff, v206
    v_add_u32_dpp v4, v4, v4 row_shr:1 row_mask:0xf bank_mask:0xf
    v_cmp_lt_i32 s[64:65], 0, v10
    v_cmp_lt_i32 s[66:67], 2, v10
    v_add_u32_dpp v4, v4, v4 row_shr:2 row_mask:0xf bank_mask:0xf
    v_cmp_lt_i32 s[68:69], 4, v10
    v_cmp_lt_i32 s[70:71], 6, v10
    v_add_u32_dpp v4, v4, v4 row_shr:4 row_mask:0xf bank_mask:0xf
    v_cmp_lt_i32 s[72:73], 8, v10
    v_cmp_lt_i32 s[74:75], 10, v10
    v_add_u32_dpp v4, v4, v4 row_shr:8 row_mask:0xf bank_mask:0xf
    v_cmp_lt_i32 s[76:77], 12, v10
    v_cmp_lt_i32 s[78:79], 14, v10
    v_add_u32_dpp v4, v4, v4 row_bcast:15 row_mask:0xa bank_mask:0xf
    v_add_u32 v5, v5, v11
    s_nop 0
    v_add_u32_dpp v4, v4, v4 row_bcast:31 row_mask:0xc bank_mask:0xf
    s_nop 0
    v_readlane_b32 s95, v4, 63
    v_mov_b32_dpp v4, v4 quad_perm:[0,0,2,2] row_mask:0xf bank_mask:0xf
    v_sub_u32 v5, v5, v4
    v_lshl_add_u32 v8, v4, 2, v241
    s_cmp_gt_u32 s95, 224
    s_cbranch_scc1 L_clip
L_mapw:
    s_mov_b64 exec, s[64:65]
    ds_write_b32 v8, v5 offset:0
    s_mov_b64 exec, s[66:67]
    ds_write_b32 v8, v5 offset:8
    s_mov_b64 exec, s[68:69]
    ds_write_b32 v8, v5 offset:16
    s_mov_b64 exec, s[70:71]
    ds_write_b32 v8, v5 offset:24
    s_mov_b64 exec, s[72:73]
    ds_write_b32 v8, v5 offset:32
    s_mov_b64 exec, s[74:75]
    ds_write_b32 v8, v5 offset:40
    s_mov_b64 exec, s[76:77]
    ds_write_b32 v8, v5 offset:48
    s_mov_b64 exec, -1
    s_cmp_lg_u64 s[78:79], 0
    s_cbranch_scc1 L_map2
    ds_read_b32 v64, v242 offset:0
    ds_read_b32 v65, v242 offset:256
    ds_read_b32 v66, v242 offset:512
    ds_read_b32 v68, v243 offset:0
    ds_read_b32 v69, v243 offset:128
    ds_read_b32 v70, v243 offset:256
    ds_read_b32 v71, v243 offset:384
    ds_read_b32 v72, v243 offset:512
    ds_read_b32 v73, v243 offset:640
    s_cmp_gt_i32 s95, 192
    s_cbranch_scc1 L_r1
L_r1b:
    s_waitcnt lgkmcnt(6)
    v_mad_u32_u24 v64, v64, 12, v244
    buffer_load_dwordx3 v[76:78], v64, s[24:27], 0 offen offset:0 sc1
    v_mad_u32_u24 v65, v65, 12, v244
    buffer_load_dwordx3 v[80:82], v65, s[24:27], 0 offen offset:768 sc1
    v_mad_u32_u24 v66, v66, 12, v244
    buffer_load_dwordx3 v[84:86], v66, s[24:27], 0 offen offset:1536 sc1
    v_mov_b32 v11, s95
    s_mov_b64 exec, 1
    ds_max_i32 v13, v11 offset:15360
    s_mov_b64 exec, -1
    s_waitcnt lgkmcnt(1)
    v_lshl_add_u32 v68, v68, 5, v2
    v_lshl_add_u32 v69, v69, 5, v2
    v_lshl_add_u32 v70, v70, 5, v2
    v_lshl_add_u32 v71, v71, 5, v2
    v_lshl_add_u32 v72, v72, 5, v2
    v_lshl_add_u32 v73, v73, 5, v2
    s_barrier
    s_add_u32 m0, s52, 0
    s_nop 0
    buffer_load_dwordx4 v68, s[28:31], 0 offen offset:0 sc1 lds
    v_add_u32 v11, 0, v1
    v_cmp_gt_i32 s[80:81], s95, v11
    v_add_u32 v11, 64, v1
    v_cmp_gt_i32 s[82:83], s95, v11
    v_add_u32 v11, 128, v1
    v_cmp_gt_i32 s[84:85], s95, v11
    v_add_u32 v11, 192, v1
    v_cmp_gt_i32 s[96:97], s95, v11
    s_mov_b32 s55, 0x1fff80
    s_mul_i32 s61, s3, 5
    s_mov_b32 s97, 0
    s_waitcnt vmcnt(3)
    v_lshrrev_b32 v132, 21, v78
    v_lshlrev_b32 v132, 2, v132
    v_lshrrev_b32 v11, 26, v78
    v_lshl_or_b32 v11, v11, 4, v245
    s_mov_b64 exec, s[80:81]
    ds_add_rtn_u32 v128, v132, v6 offset:8192
    ds_add_u32 v11, v6 offset:14336
    s_mov_b64 exec, -1
    s_waitcnt vmcnt(2)
    v_lshrrev_b32 v133, 21, v82
    v_lshlrev_b32 v133, 2, v133
    v_lshrrev_b32 v11, 26, v82
    v_lshl_or_b32 v11, v11, 4, v245
    s_mov_b64 exec, s[82:83]
    ds_add_rtn_u32 v129, v133, v6 offset:8192
    ds_add_u32 v11, v6 offset:14336
    s_mov_b64 exec, -1
    s_waitcnt vmcnt(1)
    v_lshrrev_b32 v134, 21, v86
    v_lshlrev_b32 v134, 2, v134
    v_lshrrev_b32 v11, 26, v86
    v_lshl_or_b32 v11, v11, 4, v245
    s_mov_b64 exec, s[84:85]
    ds_add_rtn_u32 v130, v134, v6 offset:8192
    ds_add_u32 v11, v6 offset:14336
    s_mov_b64 exec, -1
    s_cmp_gt_i32 s95, 192
    s_cbranch_scc1 L_r2
L_r2b:
    ds_write_b64 v246, v[76:77] offset:0
    v_and_or_b32 v78, v78, s55, v247
    ds_write_b64 v246, v[80:81] offset:512
    v_and_or_b32 v82, v82, s55, v247
    v_add_u32 v82, 134217728, v82
    ds_write_b64 v246, v[84:85] offset:1024
    v_and_or_b32 v86, v86, s55, v247
    v_add_u32 v86, 268435456, v86
    s_add_u32 m0, s52, 0
    s_nop 0
    buffer_load_dwordx4 v69, s[28:31], 0 offen offset:1024 sc1 lds
    s_add_u32 m0, s52, 0
    s_nop 0
    buffer_load_dwordx4 v70, s[28:31], 0 offen offset:2048 sc1 lds
    s_waitcnt lgkmcnt(3)
    s_barrier
    s_cmp_lg_u32 s48, 0
    s_cbranch_scc1 L_rank2
    ds_read_b128 v[104:107], v2 offset:14336
    ds_read_b32 v96, v248 offset:8192
    ds_read_b32 v97, v248 offset:8320
    ds_read_b32 v98, v248 offset:8448
    ds_read_b32 v99, v248 offset:8576
    ds_read_b32 v100, v248 offset:8704
    ds_read_b32 v14, v13 offset:15360
    s_add_u32 s65, s61, 1
    s_add_u32 s66, s61, 2
    s_add_u32 s67, s61, 3
    s_add_u32 s68, s61, 4
    s_waitcnt lgkmcnt(6)
    v_add_u32 v9, v104, v105
    v_add3_u32 v9, v9, v106, v107
    v_lshl_or_b32 v9, v9, 6, v249
    s_nop 0
    v_readlane_b32 s64, v9, s61
    v_readlane_b32 s65, v9, s65
    v_readlane_b32 s66, v9, s66
    v_readlane_b32 s67, v9, s67
    v_readlane_b32 s68, v9, s68
    v_cmp_lt_u32 s[70:71], s64, v9
    v_cmp_lt_u32 s[72:73], s65, v9
    v_cmp_lt_u32 s[74:75], s66, v9
    v_cmp_lt_u32 s[76:77], s67, v9
    v_cmp_lt_u32 s[78:79], s68, v9
    s_bcnt1_i32_b64 s64, s[70:71]
    s_bcnt1_i32_b64 s65, s[72:73]
    s_bcnt1_i32_b64 s66, s[74:75]
    s_bcnt1_i32_b64 s67, s[76:77]
    s_bcnt1_i32_b64 s68, s[78:79]
    s_waitcnt lgkmcnt(0)
    v_readlane_b32 s90, v203, s64
    v_readlane_b32 s91, v203, s65
    v_readlane_b32 s92, v203, s66
    v_readlane_b32 s93, v203, s67
    v_readlane_b32 s94, v203, s68
    v_readfirstlane_b32 s47, v14
L_ranked:
    s_mov_b32 exec_hi, 0
    s_and_b32 s54, s90, 0x380
    v_add_u32 v104, s54, v250
    ds_add_rtn_u32 v96, v104, v96 offset:13312
    s_and_b32 s54, s91, 0x380
    v_add_u32 v105, s54, v250
    ds_add_rtn_u32 v97, v105, v97 offset:13312
    s_and_b32 s54, s92, 0x380
    v_add_u32 v106, s54, v250
    ds_add_rtn_u32 v98, v106, v98 offset:13312
    s_and_b32 s54, s93, 0x380
    v_add_u32 v107, s54, v250
    ds_add_rtn_u32 v99, v107, v99 offset:13312
    s_and_b32 s54, s94, 0x380
    v_add_u32 v108, s54, v250
    ds_add_rtn_u32 v100, v108, v100 offset:13312
    v_or_b32 v104, s90, v104
    v_or_b32 v105, s91, v105
    v_or_b32 v106, s92, v106
    v_or_b32 v107, s93, v107
    v_or_b32 v108, s94, v108
    v_writelane_b32 v11, s90, 0
    v_writelane_b32 v11, s91, 1
    v_writelane_b32 v11, s92, 2
    v_writelane_b32 v11, s93, 3
    v_writelane_b32 v11, s94, 4
    s_waitcnt lgkmcnt(4)
    v_lshl_or_b32 v96, v96, 16, v104
    ds_write_b32 v248, v96 offset:8192
    s_waitcnt lgkmcnt(4)
    v_lshl_or_b32 v97, v97, 16, v105
    ds_write_b32 v248, v97 offset:8320
    s_waitcnt lgkmcnt(4)
    v_lshl_or_b32 v98, v98, 16, v106
    ds_write_b32 v248, v98 offset:8448
    s_waitcnt lgkmcnt(4)
    v_lshl_or_b32 v99, v99, 16, v107
    ds_write_b32 v248, v99 offset:8576
    s_waitcnt lgkmcnt(4)
    v_lshl_or_b32 v100, v100, 16, v108
    ds_write_b32 v248, v100 offset:8704
    v_add_lshl_u32 v12, v1, s61, 7
    v_lshrrev_b32 v9, 10, v11
    v_bfe_u32 v11, v11, 2, 8
    v_or_b32 v11, v11, v9
    s_mov_b32 exec_lo, 31
    ds_write_b32 v11, v12 offset:15616
    s_mov_b64 exec, -1
    s_add_u32 m0, s52, 0
    s_nop 0
    buffer_load_dwordx4 v71, s[28:31], 0 offen offset:3072 sc1 lds
    s_add_u32 m0, s52, 4096
    s_nop 0
    buffer_load_dwordx4 v72, s[28:31], s98 offen offset:0 sc1 lds
    s_add_u32 m0, s52, 4096
    s_nop 0
    buffer_load_dwordx4 v73, s[28:31], s98 offen offset:1024 sc1 lds
    s_lshl_b32 s54, s3, 3
    s_add_u32 s55, s54, 7
    s_waitcnt lgkmcnt(0)
    s_barrier
    ds_read_b128 v[96:99], v2 offset:13312
    ds_read_b32 v132, v132 offset:8192
    ds_read_b32 v133, v133 offset:8192
    ds_read_b32 v134, v134 offset:8192
    ds_read_b32 v11, v251 offset:15616
    s_waitcnt lgkmcnt(4)
    v_add_u32 v9, v96, v97
    v_add3_u32 v9, v9, v98, v99
    v_mov_b32 v10, v9
    s_waitcnt lgkmcnt(1)
    v_bfe_u32 v15, v132, 12, 3
    v_add_u32_dpp v10, v10, v10 row_shr:1 row_mask:0xf bank_mask:0xf
    v_or_b32 v78, v15, v78
    v_and_b32 v64, 0x3ff, v132
    v_add_u32_dpp v10, v10, v10 row_shr:2 row_mask:0xf bank_mask:0xf
    v_lshrrev_b32 v132, 16, v132
    v_add_u32 v132, v132, v128
    v_add_u32_dpp v10, v10, v10 row_shr:4 row_mask:0xf bank_mask:0xf
    v_bfe_u32 v15, v133, 12, 3
    v_or_b32 v82, v15, v82
    v_add_u32_dpp v10, v10, v10 row_shr:8 row_mask:0xf bank_mask:0xf
    v_and_b32 v65, 0x3ff, v133
    v_lshrrev_b32 v133, 16, v133
    v_add_u32_dpp v10, v10, v10 row_bcast:15 row_mask:0xa bank_mask:0xf
    v_add_u32 v133, v133, v129
    v_bfe_u32 v15, v134, 12, 3
    v_add_u32_dpp v10, v10, v10 row_bcast:31 row_mask:0xc bank_mask:0xf
    v_or_b32 v86, v15, v86
    v_and_b32 v66, 0x3ff, v134
    v_sub_u32 v9, v10, v9
    v_lshl_add_u32 v104, v9, 2, v252
    v_lshl_add_u32 v105, v96, 2, v104
    v_lshl_add_u32 v106, v97, 2, v105
    v_lshl_add_u32 v107, v98, 2, v106
    ds_write_b128 v2, v[104:107] offset:16384
    ds_read_b32 v64, v64 offset:16384
    ds_read_b32 v65, v65 offset:16384
    ds_read_b32 v66, v66 offset:16384
    v_lshrrev_b32 v134, 16, v134
    v_add_u32 v134, v134, v130
    v_readlane_b32 s50, v10, s55
    v_readlane_b32 s53, v9, s54
    v_readlane_b32 s51, v104, s54
    v_mov_b32 v12, 2097029
    s_sub_u32 s50, s50, s53
    s_lshl_b32 s54, s50, 2
    v_add_u32 v198, s51, v201
    v_add_u32 v199, s51, v202
    v_add_u32 v9, s54, v198
    s_waitcnt lgkmcnt(2)
    v_lshl_add_u32 v132, v132, 2, v64
    s_mov_b64 exec, s[80:81]
    ds_write_b32 v132, v78
    s_mov_b64 exec, -1
    s_waitcnt lgkmcnt(2)
    v_lshl_add_u32 v133, v133, 2, v65
    s_mov_b64 exec, s[82:83]
    ds_write_b32 v133, v82
    s_mov_b64 exec, -1
    s_waitcnt lgkmcnt(2)
    v_lshl_add_u32 v134, v134, 2, v66
    s_mov_b64 exec, s[84:85]
    ds_write_b32 v134, v86
    s_mov_b64 exec, -1
    ds_write_b32 v9, v12
    s_cmp_gt_i32 s95, 192
    s_cbranch_scc1 L_r3
L_r3b:
    v_readlane_b32 s56, v11, 0
    v_readlane_b32 s57, v11, 1
    v_readlane_b32 s58, v11, 2
    v_readlane_b32 s59, v11, 3
    v_readlane_b32 s60, v11, 4
    v_lshlrev_b32 v8, 2, v1
    s_mul_i32 s54, s56, 9
    v_add_u32 v208, s54, v8
    s_mul_i32 s54, s57, 9
    v_add_u32 v209, s54, v8
    s_mul_i32 s54, s58, 9
    v_add_u32 v210, s54, v8
    s_mul_i32 s54, s59, 9
    v_add_u32 v211, s54, v8
    s_mul_i32 s54, s60, 9
    v_add_u32 v212, s54, v8
    s_lshr_b32 s99, s3, 1
    s_mul_i32 s99, s99, 3
    s_min_u32 s99, s99, 8
    s_mul_i32 s55, s99, 4608
    v_and_b32 v8, 15, v1
    v_lshrrev_b32 v9, 4, v1
    v_mul_u32_u24 v213, 288, v8
    v_lshl_add_u32 v213, v9, 4, v213
    v_add_u32 v213, s55, v213
    v_lshrrev_b32 v9, 3, v1
    v_lshlrev_b32 v9, 9, v9
    v_and_b32 v8, 7, v1
    v_lshl_add_u32 v214, v8, 4, v9
    s_lshl_b32 s99, s99, 12
    s_and_b32 s55, s3, 1
    s_lshl_b32 s54, s55, 7
    s_add_u32 s99, s99, s54
    s_lshl_b32 s55, s55, 14
    s_add_u32 s55, s55, 46080
    v_add_u32 v215, s55, v2
    v_mov_b32 v64, 0
    v_mov_b32 v65, 0
    v_mov_b32 v66, 0
    v_mov_b32 v67, 0
    v_mov_b32 v68, 0
    v_mov_b32 v69, 0
    v_mov_b32 v70, 0
    v_mov_b32 v71, 0
    v_mov_b32 v72, 0
    v_mov_b32 v73, 0
    v_mov_b32 v74, 0
    v_mov_b32 v75, 0
    v_mov_b32 v76, 0
    v_mov_b32 v77, 0
    v_mov_b32 v78, 0
    v_mov_b32 v79, 0
    v_mov_b32 v80, 0
    v_mov_b32 v81, 0
    v_mov_b32 v82, 0
    v_mov_b32 v83, 0
    v_mov_b32 v84, 0
    v_mov_b32 v85, 0
    v_mov_b32 v86, 0
    v_mov_b32 v87, 0
    v_mov_b32 v88, 0
    v_mov_b32 v89, 0
    v_mov_b32 v90, 0
    v_mov_b32 v91, 0
    v_mov_b32 v92, 0
    v_mov_b32 v93, 0
    v_mov_b32 v94, 0
    v_mov_b32 v95, 0
    ds_read_b128 v[216:219], v215 offset:0
    ds_read_b128 v[220:223], v215 offset:1024
    ds_read_b128 v[224:227], v215 offset:2048
    ds_read_b128 v[228:231], v215 offset:3072
    ds_read_b128 v[232:235], v215 offset:4096
    ds_read_b128 v[236:239], v215 offset:5120
    s_add_u32 s54, s50, 1
    s_and_b32 s54, s54, -2
    s_add_u32 s53, s54, 15
    s_lshr_b32 s53, s53, 4
    s_sub_u32 s54, 0, s54
    s_and_b32 s54, s54, 15
    s_sub_u32 s53, s53, 1
    s_cmp_gt_i32 s53, 0
    s_cselect_b32 s54, s54, 0
    s_lshl_b32 s61, s54, 2
    v_subrev_u32 v198, s61, v198
    v_subrev_u32 v199, s61, v199
    s_and_b32 s61, s61, 32
    v_add_u32 v12, s61, v198
    s_and_b32 s72, s54, 6
    s_mov_b32 s55, 0x00fffc38
    s_mov_b32 s49, 0xffffff00
    s_mov_b32 s51, 87040
    s_cmp_lt_u32 s3, 4
    s_cbranch_scc1 L_np
    s_setprio 1
L_np:
    s_waitcnt vmcnt(0) lgkmcnt(0)
    s_barrier
    ds_read_b32 v196, v12
    ds_read_b32 v194, v199
    ds_read_b32 v197, v198 offset:24
    s_cmp_eq_u32 s50, 0
    s_cbranch_scc1 L_swept
    s_waitcnt lgkmcnt(1)
    v_lshlrev_b32 v196, 3, v196
    v_and_b32 v196, s55, v196
    v_lshrrev_b32 v8, 21, v194
    v_lshl_add_u32 v11, v8, 3, s51
    v_lshl_add_u32 v8, v8, 5, v200
    ds_read_b64 v[192:193], v11
    ds_read_b128 v[164:167], v8
    s_cmp_eq_u32 s72, 2
    s_cbranch_scc1 L_p2
    s_cmp_eq_u32 s72, 4
    s_cbranch_scc1 L_p4
    s_cmp_eq_u32 s72, 6
    s_cbranch_scc1 L_p6
L_p0:
    v_readlane_b32 s64, v196, 0
    v_readlane_b32 s65, v196, 1
    s_and_b32 s61, s64, s49
    buffer_load_dwordx4 v[96:99], v2, s[16:19], s61 offen
    s_and_b32 s61, s65, s49
    buffer_load_dwordx4 v[100:103], v2, s[16:19], s61 offen
L_p2:
    v_readlane_b32 s66, v196, 2
    v_readlane_b32 s67, v196, 3
    s_and_b32 s61, s66, s49
    buffer_load_dwordx4 v[104:107], v2, s[16:19], s61 offen
    s_and_b32 s61, s67, s49
    buffer_load_dwordx4 v[108:111], v2, s[16:19], s61 offen
L_p4:
    v_readlane_b32 s68, v196, 4
    v_readlane_b32 s69, v196, 5
    s_and_b32 s61, s68, s49
    buffer_load_dwordx4 v[112:115], v2, s[16:19], s61 offen
    s_and_b32 s61, s69, s49
    buffer_load_dwordx4 v[116:119], v2, s[16:19], s61 offen
    s_cmp_eq_u32 s72, 0
    s_cbranch_scc1 L_pd
L_p6:
    v_readlane_b32 s70, v196, 6
    v_readlane_b32 s71, v196, 7
    s_and_b32 s61, s70, s49
    buffer_load_dwordx4 v[120:123], v2, s[16:19], s61 offen
    s_and_b32 s61, s71, s49
    buffer_load_dwordx4 v[124:127], v2, s[16:19], s61 offen
    s_cmp_eq_u32 s72, 2
    s_cbranch_scc1 L_pd
L_p8:
    v_readlane_b32 s64, v196, 8
    v_readlane_b32 s65, v196, 9
    s_and_b32 s61, s64, s49
    buffer_load_dwordx4 v[96:99], v2, s[16:19], s61 offen
    s_and_b32 s61, s65, s49
    buffer_load_dwordx4 v[100:103], v2, s[16:19], s61 offen
    s_cmp_eq_u32 s72, 4
    s_cbranch_scc1 L_pd
L_p10:
    v_readlane_b32 s66, v196, 10
    v_readlane_b32 s67, v196, 11
    s_and_b32 s61, s66, s49
    buffer_load_dwordx4 v[104:107], v2, s[16:19], s61 offen
    s_and_b32 s61, s67, s49
    buffer_load_dwordx4 v[108:111], v2, s[16:19], s61 offen
L_pd:
    s_waitcnt lgkmcnt(0)
.p2align 3
    v_mfma_f32_4x4x4_16b_bf16 v[144:147], v[192:193], v[188:189], 0 cbsz:4 abid:0
    v_mfma_f32_4x4x4_16b_bf16 v[148:151], v[192:193], v[188:189], 0 cbsz:4 abid:2
    v_mfma_f32_4x4x4_16b_bf16 v[152:155], v[192:193], v[188:189], 0 cbsz:4 abid:4
    v_mfma_f32_4x4x4_16b_bf16 v[156:159], v[192:193], v[188:189], 0 cbsz:4 abid:6
    v_lshlrev_b32 v196, 3, v197
    v_and_b32 v196, s55, v196
    v_add_u32 v198, 64, v198
    v_add_u32 v199, 64, v199
    v_smfmac_f32_32x32x32_bf16 v[64:79], v[164:167], v[172:179], v168
    ds_read_b32 v197, v198 offset:24
    ds_read_b32 v194, v199
    v_smfmac_f32_32x32x32_bf16 v[80:95], v[164:167], v[180:187], v168
    s_set_gpr_idx_on s54, gpr_idx(SRC0,SRC1)
    v_cvt_pk_bf16_f32 v9, v144, v144
    s_set_gpr_idx_off
    v_and_b32 v160, v190, v9
    v_and_b32 v161, v191, v9
    s_waitcnt lgkmcnt(0)
    v_lshrrev_b32 v8, 21, v194
    v_lshl_add_u32 v11, v8, 3, s51
    v_lshl_add_u32 v8, v8, 5, v200
    ds_read_b64 v[192:193], v11
    ds_read_b128 v[164:167], v8
    s_cmp_eq_u32 s53, 0
    s_cbranch_scc1 L_f0
    s_cmp_eq_u32 s54, 0
    s_cbranch_scc1 L_j0
    s_cmp_eq_u32 s54, 2
    s_cbranch_scc1 L_j2
    ds_read_b128 v[64:67], v169
    ds_read_b128 v[80:83], v169
    s_cmp_eq_u32 s54, 4
    s_cbranch_scc1 L_j4
    s_cmp_eq_u32 s54, 6
    s_cbranch_scc1 L_j6
    ds_read_b128 v[68:71], v169
    ds_read_b128 v[84:87], v169
    s_cmp_eq_u32 s54, 8
    s_cbranch_scc1 L_j8
    s_cmp_eq_u32 s54, 10
    s_cbranch_scc1 L_j10
    ds_read_b128 v[72:75], v169
    ds_read_b128 v[88:91], v169
    s_cmp_eq_u32 s54, 12
    s_cbranch_scc1 L_j12
    s_branch L_j14
.p2align 3
L_loop:
    s_waitcnt lgkmcnt(2)
.p2align 3
    v_mfma_f32_4x4x4_16b_bf16 v[144:147], v[192:193], v[188:189], 0 cbsz:4 abid:0
    v_mfma_f32_4x4x4_16b_bf16 v[148:151], v[192:193], v[188:189], 0 cbsz:4 abid:2
    v_mfma_f32_4x4x4_16b_bf16 v[152:155], v[192:193], v[188:189], 0 cbsz:4 abid:4
    v_mfma_f32_4x4x4_16b_bf16 v[156:159], v[192:193], v[188:189], 0 cbsz:4 abid:6
    v_lshlrev_b32 v196, 3, v197
    v_and_b32 v196, s55, v196
    v_add_u32 v198, 64, v198
    v_add_u32 v199, 64, v199
    s_waitcnt lgkmcnt(0)
.p2align 3
    v_smfmac_f32_32x32x32_bf16 v[64:79], v[164:167], v[172:179], v168
    ds_read_b32 v197, v198 offset:24
    ds_read_b32 v194, v199
    v_cvt_pk_bf16_f32 v9, v144, v144
    v_and_b32 v160, v190, v9
    v_and_b32 v161, v191, v9
    v_smfmac_f32_32x32x32_bf16 v[80:95], v[164:167], v[180:187], v168
L_j0:
    s_waitcnt vmcnt(5)
.p2align 3
    v_mfma_f32_16x16x16_bf16 v[128:131], v[160:161], v[96:97], 0
    v_readlane_b32 s70, v196, 0
    v_cvt_pk_bf16_f32 v10, v145, v145
    v_mfma_f32_16x16x16_bf16 v[132:135], v[160:161], v[98:99], 0
    v_and_b32 v162, v190, v10
    v_and_b32 v163, v191, v10
    s_and_b32 s61, s70, s49
    s_waitcnt vmcnt(4)
    buffer_load_dwordx4 v[120:123], v2, s[16:19], s61 offen
    v_mfma_f32_16x16x16_bf16 v[136:139], v[162:163], v[100:101], 0
    v_readlane_b32 s71, v196, 1
    v_cvt_pk_bf16_f32 v9, v146, v146
    v_mfma_f32_16x16x16_bf16 v[140:143], v[162:163], v[102:103], 0
    v_and_b32 v160, v190, v9
    v_and_b32 v161, v191, v9
    s_and_b32 s61, s71, s49
    s_set_gpr_idx_on s64, gpr_idx(SRC2,DST)
    buffer_load_dwordx4 v[124:127], v2, s[16:19], s61 offen
    v_pk_fma_f32 v[16:17], v[128:129], v[64:65], v[16:17] op_sel_hi:[1,0,1]
    v_pk_fma_f32 v[18:19], v[130:131], v[64:65], v[18:19] op_sel_hi:[1,0,1]
    v_pk_fma_f32 v[20:21], v[132:133], v[80:81], v[20:21] op_sel_hi:[1,0,1]
    v_pk_fma_f32 v[22:23], v[134:135], v[80:81], v[22:23] op_sel_hi:[1,0,1]
    s_set_gpr_idx_idx s65
.p2align 3
    v_pk_fma_f32 v[16:17], v[136:137], v[64:65], v[16:17] op_sel:[0,1,0] op_sel_hi:[1,1,1]
    v_pk_fma_f32 v[18:19], v[138:139], v[64:65], v[18:19] op_sel:[0,1,0] op_sel_hi:[1,1,1]
    v_pk_fma_f32 v[20:21], v[140:141], v[80:81], v[20:21] op_sel:[0,1,0] op_sel_hi:[1,1,1]
    v_pk_fma_f32 v[22:23], v[142:143], v[80:81], v[22:23] op_sel:[0,1,0] op_sel_hi:[1,1,1]
    s_set_gpr_idx_off
L_j2:
    s_waitcnt vmcnt(5)
.p2align 3
    v_mfma_f32_16x16x16_bf16 v[128:131], v[160:161], v[104:105], 0
    v_readlane_b32 s64, v196, 2
    v_cvt_pk_bf16_f32 v10, v147, v147
    v_mfma_f32_16x16x16_bf16 v[132:135], v[160:161], v[106:107], 0
    v_and_b32 v162, v190, v10
    v_and_b32 v163, v191, v10
    s_and_b32 s61, s64, s49
    s_waitcnt vmcnt(4)
    buffer_load_dwordx4 v[96:99], v2, s[16:19], s61 offen
    v_mfma_f32_16x16x16_bf16 v[136:139], v[162:163], v[108:109], 0
    v_readlane_b32 s65, v196, 3
    v_cvt_pk_bf16_f32 v9, v148, v148
    v_mfma_f32_16x16x16_bf16 v[140:143], v[162:163], v[110:111], 0
    v_and_b32 v160, v190, v9
    v_and_b32 v161, v191, v9
    s_waitcnt lgkmcnt(0)
    v_lshrrev_b32 v8, 21, v194
    v_lshl_add_u32 v11, v8, 3, s51
    v_lshl_add_u32 v8, v8, 5, v200
    ds_read_b64 v[192:193], v11
    ds_read_b128 v[164:167], v8
.p2align 3
    s_and_b32 s61, s65, s49
    s_set_gpr_idx_on s66, gpr_idx(SRC2,DST)
    buffer_load_dwordx4 v[100:103], v2, s[16:19], s61 offen
    v_pk_fma_f32 v[16:17], v[128:129], v[66:67], v[16:17] op_sel_hi:[1,0,1]
    v_pk_fma_f32 v[18:19], v[130:131], v[66:67], v[18:19] op_sel_hi:[1,0,1]
    v_pk_fma_f32 v[20:21], v[132:133], v[82:83], v[20:21] op_sel_hi:[1,0,1]
    v_pk_fma_f32 v[22:23], v[134:135], v[82:83], v[22:23] op_sel_hi:[1,0,1]
    s_set_gpr_idx_idx s67
.p2align 3
    v_pk_fma_f32 v[16:17], v[136:137], v[66:67], v[16:17] op_sel:[0,1,0] op_sel_hi:[1,1,1]
    v_pk_fma_f32 v[18:19], v[138:139], v[66:67], v[18:19] op_sel:[0,1,0] op_sel_hi:[1,1,1]
    v_pk_fma_f32 v[20:21], v[140:141], v[82:83], v[20:21] op_sel:[0,1,0] op_sel_hi:[1,1,1]
    v_pk_fma_f32 v[22:23], v[142:143], v[82:83], v[22:23] op_sel:[0,1,0] op_sel_hi:[1,1,1]
    ds_read_b128 v[64:67], v169
    ds_read_b128 v[80:83], v169
    s_set_gpr_idx_off
L_j4:
    s_waitcnt vmcnt(5)
.p2align 3
    v_mfma_f32_16x16x16_bf16 v[128:131], v[160:161], v[112:113], 0
    v_readlane_b32 s66, v196, 4
    v_cvt_pk_bf16_f32 v10, v149, v149
    v_mfma_f32_16x16x16_bf16 v[132:135], v[160:161], v[114:115], 0
    v_and_b32 v162, v190, v10
    v_and_b32 v163, v191, v10
    s_and_b32 s61, s66, s49
    s_waitcnt vmcnt(4)
    buffer_load_dwordx4 v[104:107], v2, s[16:19], s61 offen
    v_mfma_f32_16x16x16_bf16 v[136:139], v[162:163], v[116:117], 0
    v_readlane_b32 s67, v196, 5
    v_cvt_pk_bf16_f32 v9, v150, v150
    v_mfma_f32_16x16x16_bf16 v[140:143], v[162:163], v[118:119], 0
    v_and_b32 v160, v190, v9
    v_and_b32 v161, v191, v9
    s_and_b32 s61, s67, s49
    s_set_gpr_idx_on s68, gpr_idx(SRC2,DST)
    buffer_load_dwordx4 v[108:111], v2, s[16:19], s61 offen
    v_pk_fma_f32 v[16:17], v[128:129], v[68:69], v[16:17] op_sel_hi:[1,0,1]
    v_pk_fma_f32 v[18:19], v[130:131], v[68:69], v[18:19] op_sel_hi:[1,0,1]
    v_pk_fma_f32 v[20:21], v[132:133], v[84:85], v[20:21] op_sel_hi:[1,0,1]
    v_pk_fma_f32 v[22:23], v[134:135], v[84:85], v[22:23] op_sel_hi:[1,0,1]
    s_set_gpr_idx_idx s69
.p2align 3
    v_pk_fma_f32 v[16:17], v[136:137], v[68:69], v[16:17] op_sel:[0,1,0] op_sel_hi:[1,1,1]
    v_pk_fma_f32 v[18:19], v[138:139], v[68:69], v[18:19] op_sel:[0,1,0] op_sel_hi:[1,1,1]
    v_pk_fma_f32 v[20:21], v[140:141], v[84:85], v[20:21] op_sel:[0,1,0] op_sel_hi:[1,1,1]
    v_pk_fma_f32 v[22:23], v[142:143], v[84:85], v[22:23] op_sel:[0,1,0] op_sel_hi:[1,1,1]
    s_set_gpr_idx_off
L_j6:
    s_waitcnt vmcnt(5)
.p2align 3
    v_mfma_f32_16x16x16_bf16 v[128:131], v[160:161], v[120:121], 0
    v_readlane_b32 s68, v196, 6
    v_cvt_pk_bf16_f32 v10, v151, v151
    v_mfma_f32_16x16x16_bf16 v[132:135], v[160:161], v[122:123], 0
    v_and_b32 v162, v190, v10
    v_and_b32 v163, v191, v10
    s_and_b32 s61, s68, s49
    s_waitcnt vmcnt(4)
    buffer_load_dwordx4 v[112:115], v2, s[16:19], s61 offen
    v_mfma_f32_16x16x16_bf16 v[136:139], v[162:163], v[124:125], 0
    v_readlane_b32 s69, v196, 7
    v_cvt_pk_bf16_f32 v9, v152, v152
    v_mfma_f32_16x16x16_bf16 v[140:143], v[162:163], v[126:127], 0
    v_and_b32 v160, v190, v9
    v_and_b32 v161, v191, v9
    s_and_b32 s61, s69, s49
    s_set_gpr_idx_on s70, gpr_idx(SRC2,DST)
    buffer_load_dwordx4 v[116:119], v2, s[16:19], s61 offen
    v_pk_fma_f32 v[16:17], v[128:129], v[70:71], v[16:17] op_sel_hi:[1,0,1]
    v_pk_fma_f32 v[18:19], v[130:131], v[70:71], v[18:19] op_sel_hi:[1,0,1]
    v_pk_fma_f32 v[20:21], v[132:133], v[86:87], v[20:21] op_sel_hi:[1,0,1]
    v_pk_fma_f32 v[22:23], v[134:135], v[86:87], v[22:23] op_sel_hi:[1,0,1]
    s_set_gpr_idx_idx s71
.p2align 3
    v_pk_fma_f32 v[16:17], v[136:137], v[70:71], v[16:17] op_sel:[0,1,0] op_sel_hi:[1,1,1]
    v_pk_fma_f32 v[18:19], v[138:139], v[70:71], v[18:19] op_sel:[0,1,0] op_sel_hi:[1,1,1]
    v_pk_fma_f32 v[20:21], v[140:141], v[86:87], v[20:21] op_sel:[0,1,0] op_sel_hi:[1,1,1]
    v_pk_fma_f32 v[22:23], v[142:143], v[86:87], v[22:23] op_sel:[0,1,0] op_sel_hi:[1,1,1]
    ds_read_b128 v[68:71], v169
    ds_read_b128 v[84:87], v169
    s_set_gpr_idx_off
L_j8:
    s_waitcnt vmcnt(5)
.p2align 3
    v_mfma_f32_16x16x16_bf16 v[128:131], v[160:161], v[96:97], 0
    v_readlane_b32 s70, v196, 8
    v_cvt_pk_bf16_f32 v10, v153, v153
    v_mfma_f32_16x16x16_bf16 v[132:135], v[160:161], v[98:99], 0
    v_and_b32 v162, v190, v10
    v_and_b32 v163, v191, v10
    s_and_b32 s61, s70, s49
    s_waitcnt vmcnt(4)
    buffer_load_dwordx4 v[120:123], v2, s[16:19], s61 offen
    v_mfma_f32_16x16x16_bf16 v[136:139], v[162:163], v[100:101], 0
    v_readlane_b32 s71, v196, 9
    v_cvt_pk_bf16_f32 v9, v154, v154
    v_mfma_f32_16x16x16_bf16 v[140:143], v[162:163], v[102:103], 0
    v_and_b32 v160, v190, v9
    v_and_b32 v161, v191, v9
    s_and_b32 s61, s71, s49
    s_set_gpr_idx_on s64, gpr_idx(SRC2,DST)
    buffer_load_dwordx4 v[124:127], v2, s[16:19], s61 offen
    v_pk_fma_f32 v[16:17], v[128:129], v[72:73], v[16:17] op_sel_hi:[1,0,1]
    v_pk_fma_f32 v[18:19], v[130:131], v[72:73], v[18:19] op_sel_hi:[1,0,1]
    v_pk_fma_f32 v[20:21], v[132:133], v[88:89], v[20:21] op_sel_hi:[1,0,1]
    v_pk_fma_f32 v[22:23], v[134:135], v[88:89], v[22:23] op_sel_hi:[1,0,1]
    s_set_gpr_idx_idx s65
.p2align 3
    v_pk_fma_f32 v[16:17], v[136:137], v[72:73], v[16:17] op_sel:[0,1,0] op_sel_hi:[1,1,1]
    v_pk_fma_f32 v[18:19], v[138:139], v[72:73], v[18:19] op_sel:[0,1,0] op_sel_hi:[1,1,1]
    v_pk_fma_f32 v[20:21], v[140:141], v[88:89], v[20:21] op_sel:[0,1,0] op_sel_hi:[1,1,1]
    v_pk_fma_f32 v[22:23], v[142:143], v[88:89], v[22:23] op_sel:[0,1,0] op_sel_hi:[1,1,1]
    s_set_gpr_idx_off
L_j10:
    s_waitcnt vmcnt(5)
.p2align 3
    v_mfma_f32_16x16x16_bf16 v[128:131], v[160:161], v[104:105], 0
    v_readlane_b32 s64, v196, 10
    v_cvt_pk_bf16_f32 v10, v155, v155
    v_mfma_f32_16x16x16_bf16 v[132:135], v[160:161], v[106:107], 0
    v_and_b32 v162, v190, v10
    v_and_b32 v163, v191, v10
    s_and_b32 s61, s64, s49
    s_waitcnt vmcnt(4)
    buffer_load_dwordx4 v[96:99], v2, s[16:19], s61 offen
    v_mfma_f32_16x16x16_bf16 v[136:139], v[162:163], v[108:109], 0
    v_readlane_b32 s65, v196, 11
    v_cvt_pk_bf16_f32 v9, v156, v156
    v_mfma_f32_16x16x16_bf16 v[140:143], v[162:163], v[110:111], 0
    v_and_b32 v160, v190, v9
    v_and_b32 v161, v191, v9
    s_and_b32 s61, s65, s49
    s_set_gpr_idx_on s66, gpr_idx(SRC2,DST)
    buffer_load_dwordx4 v[100:103], v2, s[16:19], s61 offen
    v_pk_fma_f32 v[16:17], v[128:129], v[74:75], v[16:17] op_sel_hi:[1,0,1]
    v_pk_fma_f32 v[18:19], v[130:131], v[74:75], v[18:19] op_sel_hi:[1,0,1]
    v_pk_fma_f32 v[20:21], v[132:133], v[90:91], v[20:21] op_sel_hi:[1,0,1]
    v_pk_fma_f32 v[22:23], v[134:135], v[90:91], v[22:23] op_sel_hi:[1,0,1]
    s_set_gpr_idx_idx s67
.p2align 3
    v_pk_fma_f32 v[16:17], v[136:137], v[74:75], v[16:17] op_sel:[0,1,0] op_sel_hi:[1,1,1]
    v_pk_fma_f32 v[18:19], v[138:139], v[74:75], v[18:19] op_sel:[0,1,0] op_sel_hi:[1,1,1]
    v_pk_fma_f32 v[20:21], v[140:141], v[90:91], v[20:21] op_sel:[0,1,0] op_sel_hi:[1,1,1]
    v_pk_fma_f32 v[22:23], v[142:143], v[90:91], v[22:23] op_sel:[0,1,0] op_sel_hi:[1,1,1]
    ds_read_b128 v[72:75], v169
    ds_read_b128 v[88:91], v169
    s_set_gpr_idx_off
L_j12:
    s_waitcnt vmcnt(5)
.p2align 3
    v_mfma_f32_16x16x16_bf16 v[128:131], v[160:161], v[112:113], 0
    v_readlane_b32 s66, v196, 12
    v_cvt_pk_bf16_f32 v10, v157, v157
    v_mfma_f32_16x16x16_bf16 v[132:135], v[160:161], v[114:115], 0
    v_and_b32 v162, v190, v10
    v_and_b32 v163, v191, v10
    s_and_b32 s61, s66, s49
    s_waitcnt vmcnt(4)
    buffer_load_dwordx4 v[104:107], v2, s[16:19], s61 offen
    v_mfma_f32_16x16x16_bf16 v[136:139], v[162:163], v[116:117], 0
    v_readlane_b32 s67, v196, 13
    v_cvt_pk_bf16_f32 v9, v158, v158
    v_mfma_f32_16x16x16_bf16 v[140:143], v[162:163], v[118:119], 0
    v_and_b32 v160, v190, v9
    v_and_b32 v161, v191, v9
    s_and_b32 s61, s67, s49
    s_set_gpr_idx_on s68, gpr_idx(SRC2,DST)
    buffer_load_dwordx4 v[108:111], v2, s[16:19], s61 offen
    v_pk_fma_f32 v[16:17], v[128:129], v[76:77], v[16:17] op_sel_hi:[1,0,1]
    v_pk_fma_f32 v[18:19], v[130:131], v[76:77], v[18:19] op_sel_hi:[1,0,1]
    v_pk_fma_f32 v[20:21], v[132:133], v[92:93], v[20:21] op_sel_hi:[1,0,1]
    v_pk_fma_f32 v[22:23], v[134:135], v[92:93], v[22:23] op_sel_hi:[1,0,1]
    s_set_gpr_idx_idx s69
.p2align 3
    v_pk_fma_f32 v[16:17], v[136:137], v[76:77], v[16:17] op_sel:[0,1,0] op_sel_hi:[1,1,1]
    v_pk_fma_f32 v[18:19], v[138:139], v[76:77], v[18:19] op_sel:[0,1,0] op_sel_hi:[1,1,1]
    v_pk_fma_f32 v[20:21], v[140:141], v[92:93], v[20:21] op_sel:[0,1,0] op_sel_hi:[1,1,1]
    v_pk_fma_f32 v[22:23], v[142:143], v[92:93], v[22:23] op_sel:[0,1,0] op_sel_hi:[1,1,1]
    s_set_gpr_idx_off
L_j14:
    s_waitcnt vmcnt(5)
.p2align 3
    v_mfma_f32_16x16x16_bf16 v[128:131], v[160:161], v[120:121], 0
    v_readlane_b32 s68, v196, 14
    v_cvt_pk_bf16_f32 v10, v159, v159
    v_mfma_f32_16x16x16_bf16 v[132:135], v[160:161], v[122:123], 0
    v_and_b32 v162, v190, v10
    v_and_b32 v163, v191, v10
    s_and_b32 s61, s68, s49
    s_waitcnt vmcnt(4)
    buffer_load_dwordx4 v[112:115], v2, s[16:19], s61 offen
    v_mfma_f32_16x16x16_bf16 v[136:139], v[162:163], v[124:125], 0
    v_readlane_b32 s69, v196, 15
    v_mfma_f32_16x16x16_bf16 v[140:143], v[162:163], v[126:127], 0
    s_and_b32 s61, s69, s49
    s_set_gpr_idx_on s70, gpr_idx(SRC2,DST)
    buffer_load_dwordx4 v[116:119], v2, s[16:19], s61 offen
    v_pk_fma_f32 v[16:17], v[128:129], v[78:79], v[16:17] op_sel_hi:[1,0,1]
    v_pk_fma_f32 v[18:19], v[130:131], v[78:79], v[18:19] op_sel_hi:[1,0,1]
    v_pk_fma_f32 v[20:21], v[132:133], v[94:95], v[20:21] op_sel_hi:[1,0,1]
    v_pk_fma_f32 v[22:23], v[134:135], v[94:95], v[22:23] op_sel_hi:[1,0,1]
    s_set_gpr_idx_idx s71
    s_sub_u32 s53, s53, 1
.p2align 3
    v_pk_fma_f32 v[16:17], v[136:137], v[78:79], v[16:17] op_sel:[0,1,0] op_sel_hi:[1,1,1]
    v_pk_fma_f32 v[18:19], v[138:139], v[78:79], v[18:19] op_sel:[0,1,0] op_sel_hi:[1,1,1]
    v_pk_fma_f32 v[20:21], v[140:141], v[94:95], v[20:21] op_sel:[0,1,0] op_sel_hi:[1,1,1]
    v_pk_fma_f32 v[22:23], v[142:143], v[94:95], v[22:23] op_sel:[0,1,0] op_sel_hi:[1,1,1]
    ds_read_b128 v[76:79], v169
    ds_read_b128 v[92:95], v169
    s_set_gpr_idx_off
    s_cmp_lg_u32 s53, 0
    s_cbranch_scc1 L_loop
    s_waitcnt lgkmcnt(2)
.p2align 3
    v_mfma_f32_4x4x4_16b_bf16 v[144:147], v[192:193], v[188:189], 0 cbsz:4 abid:0
    v_mfma_f32_4x4x4_16b_bf16 v[148:151], v[192:193], v[188:189], 0 cbsz:4 abid:2
    v_mfma_f32_4x4x4_16b_bf16 v[152:155], v[192:193], v[188:189], 0 cbsz:4 abid:4
    v_mfma_f32_4x4x4_16b_bf16 v[156:159], v[192:193], v[188:189], 0 cbsz:4 abid:6
    v_lshlrev_b32 v196, 3, v197
    v_and_b32 v196, s55, v196
    s_waitcnt lgkmcnt(0)
.p2align 3
    v_smfmac_f32_32x32x32_bf16 v[64:79], v[164:167], v[172:179], v168
    v_cvt_pk_bf16_f32 v9, v144, v144
    v_and_b32 v160, v190, v9
    v_and_b32 v161, v191, v9
    v_smfmac_f32_32x32x32_bf16 v[80:95], v[164:167], v[180:187], v168
L_f0:
    s_waitcnt vmcnt(5)
.p2align 3
    v_mfma_f32_16x16x16_bf16 v[128:131], v[160:161], v[96:97], 0
    v_readlane_b32 s70, v196, 0
    v_cvt_pk_bf16_f32 v10, v145, v145
    v_mfma_f32_16x16x16_bf16 v[132:135], v[160:161], v[98:99], 0
    v_and_b32 v162, v190, v10
    v_and_b32 v163, v191, v10
    s_and_b32 s61, s70, s49
    s_waitcnt vmcnt(4)
    buffer_load_dwordx4 v[120:123], v2, s[16:19], s61 offen
    v_mfma_f32_16x16x16_bf16 v[136:139], v[162:163], v[100:101], 0
    v_readlane_b32 s71, v196, 1
    v_cvt_pk_bf16_f32 v9, v146, v146
    v_mfma_f32_16x16x16_bf16 v[140:143], v[162:163], v[102:103], 0
    v_and_b32 v160, v190, v9
    v_and_b32 v161, v191, v9
    s_and_b32 s61, s71, s49
    s_set_gpr_idx_on s64, gpr_idx(SRC2,DST)
    buffer_load_dwordx4 v[124:127], v2, s[16:19], s61 offen
    v_pk_fma_f32 v[16:17], v[128:129], v[64:65], v[16:17] op_sel_hi:[1,0,1]
    v_pk_fma_f32 v[18:19], v[130:131], v[64:65], v[18:19] op_sel_hi:[1,0,1]
    v_pk_fma_f32 v[20:21], v[132:133], v[80:81], v[20:21] op_sel_hi:[1,0,1]
    v_pk_fma_f32 v[22:23], v[134:135], v[80:81], v[22:23] op_sel_hi:[1,0,1]
    s_set_gpr_idx_idx s65
.p2align 3
    v_pk_fma_f32 v[16:17], v[136:137], v[64:65], v[16:17] op_sel:[0,1,0] op_sel_hi:[1,1,1]
    v_pk_fma_f32 v[18:19], v[138:139], v[64:65], v[18:19] op_sel:[0,1,0] op_sel_hi:[1,1,1]
    v_pk_fma_f32 v[20:21], v[140:141], v[80:81], v[20:21] op_sel:[0,1,0] op_sel_hi:[1,1,1]
    v_pk_fma_f32 v[22:23], v[142:143], v[80:81], v[22:23] op_sel:[0,1,0] op_sel_hi:[1,1,1]
    s_set_gpr_idx_off
    s_waitcnt vmcnt(5)
.p2align 3
    v_mfma_f32_16x16x16_bf16 v[128:131], v[160:161], v[104:105], 0
    v_readlane_b32 s64, v196, 2
    v_cvt_pk_bf16_f32 v10, v147, v147
    v_mfma_f32_16x16x16_bf16 v[132:135], v[160:161], v[106:107], 0
    v_and_b32 v162, v190, v10
    v_and_b32 v163, v191, v10
    s_and_b32 s61, s64, s49
    s_waitcnt vmcnt(4)
    buffer_load_dwordx4 v[96:99], v2, s[16:19], s61 offen
    v_mfma_f32_16x16x16_bf16 v[136:139], v[162:163], v[108:109], 0
    v_readlane_b32 s65, v196, 3
    v_cvt_pk_bf16_f32 v9, v148, v148
    v_mfma_f32_16x16x16_bf16 v[140:143], v[162:163], v[110:111], 0
    v_and_b32 v160, v190, v9
    v_and_b32 v161, v191, v9
    s_and_b32 s61, s65, s49
    s_set_gpr_idx_on s66, gpr_idx(SRC2,DST)
    buffer_load_dwordx4 v[100:103], v2, s[16:19], s61 offen
    v_pk_fma_f32 v[16:17], v[128:129], v[66:67], v[16:17] op_sel_hi:[1,0,1]
    v_pk_fma_f32 v[18:19], v[130:131], v[66:67], v[18:19] op_sel_hi:[1,0,1]
    v_pk_fma_f32 v[20:21], v[132:133], v[82:83], v[20:21] op_sel_hi:[1,0,1]
    v_pk_fma_f32 v[22:23], v[134:135], v[82:83], v[22:23] op_sel_hi:[1,0,1]
    s_set_gpr_idx_idx s67
.p2align 3
    v_pk_fma_f32 v[16:17], v[136:137], v[66:67], v[16:17] op_sel:[0,1,0] op_sel_hi:[1,1,1]
    v_pk_fma_f32 v[18:19], v[138:139], v[66:67], v[18:19] op_sel:[0,1,0] op_sel_hi:[1,1,1]
    v_pk_fma_f32 v[20:21], v[140:141], v[82:83], v[20:21] op_sel:[0,1,0] op_sel_hi:[1,1,1]
    v_pk_fma_f32 v[22:23], v[142:143], v[82:83], v[22:23] op_sel:[0,1,0] op_sel_hi:[1,1,1]
    s_set_gpr_idx_off
    s_waitcnt vmcnt(5)
.p2align 3
    v_mfma_f32_16x16x16_bf16 v[128:131], v[160:161], v[112:113], 0
    v_readlane_b32 s66, v196, 4
    v_cvt_pk_bf16_f32 v10, v149, v149
    v_mfma_f32_16x16x16_bf16 v[132:135], v[160:161], v[114:115], 0
    v_and_b32 v162, v190, v10
    v_and_b32 v163, v191, v10
    s_and_b32 s61, s66, s49
    s_waitcnt vmcnt(4)
    buffer_load_dwordx4 v[104:107], v2, s[16:19], s61 offen
    v_mfma_f32_16x16x16_bf16 v[136:139], v[162:163], v[116:117], 0
    v_readlane_b32 s67, v196, 5
    v_cvt_pk_bf16_f32 v9, v150, v150
    v_mfma_f32_16x16x16_bf16 v[140:143], v[162:163], v[118:119], 0
    v_and_b32 v160, v190, v9
    v_and_b32 v161, v191, v9
    s_and_b32 s61, s67, s49
    s_set_gpr_idx_on s68, gpr_idx(SRC2,DST)
    buffer_load_dwordx4 v[108:111], v2, s[16:19], s61 offen
    v_pk_fma_f32 v[16:17], v[128:129], v[68:69], v[16:17] op_sel_hi:[1,0,1]
    v_pk_fma_f32 v[18:19], v[130:131], v[68:69], v[18:19] op_sel_hi:[1,0,1]
    v_pk_fma_f32 v[20:21], v[132:133], v[84:85], v[20:21] op_sel_hi:[1,0,1]
    v_pk_fma_f32 v[22:23], v[134:135], v[84:85], v[22:23] op_sel_hi:[1,0,1]
    s_set_gpr_idx_idx s69
.p2align 3
    v_pk_fma_f32 v[16:17], v[136:137], v[68:69], v[16:17] op_sel:[0,1,0] op_sel_hi:[1,1,1]
    v_pk_fma_f32 v[18:19], v[138:139], v[68:69], v[18:19] op_sel:[0,1,0] op_sel_hi:[1,1,1]
    v_pk_fma_f32 v[20:21], v[140:141], v[84:85], v[20:21] op_sel:[0,1,0] op_sel_hi:[1,1,1]
    v_pk_fma_f32 v[22:23], v[142:143], v[84:85], v[22:23] op_sel:[0,1,0] op_sel_hi:[1,1,1]
    s_set_gpr_idx_off
    s_waitcnt vmcnt(5)
.p2align 3
    v_mfma_f32_16x16x16_bf16 v[128:131], v[160:161], v[120:121], 0
    v_readlane_b32 s68, v196, 6
    v_cvt_pk_bf16_f32 v10, v151, v151
    v_mfma_f32_16x16x16_bf16 v[132:135], v[160:161], v[122:123], 0
    v_and_b32 v162, v190, v10
    v_and_b32 v163, v191, v10
    s_and_b32 s61, s68, s49
    s_waitcnt vmcnt(4)
    buffer_load_dwordx4 v[112:115], v2, s[16:19], s61 offen
    v_mfma_f32_16x16x16_bf16 v[136:139], v[162:163], v[124:125], 0
    v_readlane_b32 s69, v196, 7
    v_cvt_pk_bf16_f32 v9, v152, v152
    v_mfma_f32_16x16x16_bf16 v[140:143], v[162:163], v[126:127], 0
    v_and_b32 v160, v190, v9
    v_and_b32 v161, v191, v9
    s_and_b32 s61, s69, s49
    s_set_gpr_idx_on s70, gpr_idx(SRC2,DST)
    buffer_load_dwordx4 v[116:119], v2, s[16:19], s61 offen
    v_pk_fma_f32 v[16:17], v[128:129], v[70:71], v[16:17] op_sel_hi:[1,0,1]
    v_pk_fma_f32 v[18:19], v[130:131], v[70:71], v[18:19] op_sel_hi:[1,0,1]
    v_pk_fma_f32 v[20:21], v[132:133], v[86:87], v[20:21] op_sel_hi:[1,0,1]
    v_pk_fma_f32 v[22:23], v[134:135], v[86:87], v[22:23] op_sel_hi:[1,0,1]
    s_set_gpr_idx_idx s71
.p2align 3
    v_pk_fma_f32 v[16:17], v[136:137], v[70:71], v[16:17] op_sel:[0,1,0] op_sel_hi:[1,1,1]
    v_pk_fma_f32 v[18:19], v[138:139], v[70:71], v[18:19] op_sel:[0,1,0] op_sel_hi:[1,1,1]
    v_pk_fma_f32 v[20:21], v[140:141], v[86:87], v[20:21] op_sel:[0,1,0] op_sel_hi:[1,1,1]
    v_pk_fma_f32 v[22:23], v[142:143], v[86:87], v[22:23] op_sel:[0,1,0] op_sel_hi:[1,1,1]
    s_set_gpr_idx_off
    s_waitcnt vmcnt(5)
.p2align 3
    v_mfma_f32_16x16x16_bf16 v[128:131], v[160:161], v[96:97], 0
    v_readlane_b32 s70, v196, 8
    v_cvt_pk_bf16_f32 v10, v153, v153
    v_mfma_f32_16x16x16_bf16 v[132:135], v[160:161], v[98:99], 0
    v_and_b32 v162, v190, v10
    v_and_b32 v163, v191, v10
    s_and_b32 s61, s70, s49
    s_waitcnt vmcnt(4)
    buffer_load_dwordx4 v[120:123], v2, s[16:19], s61 offen
    v_mfma_f32_16x16x16_bf16 v[136:139], v[162:163], v[100:101], 0
    v_readlane_b32 s71, v196, 9
    v_cvt_pk_bf16_f32 v9, v154, v154
    v_mfma_f32_16x16x16_bf16 v[140:143], v[162:163], v[102:103], 0
    v_and_b32 v160, v190, v9
    v_and_b32 v161, v191, v9
    s_and_b32 s61, s71, s49
    s_set_gpr_idx_on s64, gpr_idx(SRC2,DST)
    buffer_load_dwordx4 v[124:127], v2, s[16:19], s61 offen
    v_pk_fma_f32 v[16:17], v[128:129], v[72:73], v[16:17] op_sel_hi:[1,0,1]
    v_pk_fma_f32 v[18:19], v[130:131], v[72:73], v[18:19] op_sel_hi:[1,0,1]
    v_pk_fma_f32 v[20:21], v[132:133], v[88:89], v[20:21] op_sel_hi:[1,0,1]
    v_pk_fma_f32 v[22:23], v[134:135], v[88:89], v[22:23] op_sel_hi:[1,0,1]
    s_set_gpr_idx_idx s65
.p2align 3
    v_pk_fma_f32 v[16:17], v[136:137], v[72:73], v[16:17] op_sel:[0,1,0] op_sel_hi:[1,1,1]
    v_pk_fma_f32 v[18:19], v[138:139], v[72:73], v[18:19] op_sel:[0,1,0] op_sel_hi:[1,1,1]
    v_pk_fma_f32 v[20:21], v[140:141], v[88:89], v[20:21] op_sel:[0,1,0] op_sel_hi:[1,1,1]
    v_pk_fma_f32 v[22:23], v[142:143], v[88:89], v[22:23] op_sel:[0,1,0] op_sel_hi:[1,1,1]
    s_set_gpr_idx_off
    s_waitcnt vmcnt(5)
.p2align 3
    v_mfma_f32_16x16x16_bf16 v[128:131], v[160:161], v[104:105], 0
    v_cvt_pk_bf16_f32 v10, v155, v155
    v_mfma_f32_16x16x16_bf16 v[132:135], v[160:161], v[106:107], 0
    v_and_b32 v162, v190, v10
    v_and_b32 v163, v191, v10
    s_waitcnt vmcnt(4)
.p2align 3
    s_nop 0
    v_mfma_f32_16x16x16_bf16 v[136:139], v[162:163], v[108:109], 0
    v_cvt_pk_bf16_f32 v9, v156, v156
    v_mfma_f32_16x16x16_bf16 v[140:143], v[162:163], v[110:111], 0
    v_and_b32 v160, v190, v9
    v_and_b32 v161, v191, v9
    s_set_gpr_idx_on s66, gpr_idx(SRC2,DST)
.p2align 3
    v_pk_fma_f32 v[16:17], v[128:129], v[74:75], v[16:17] op_sel_hi:[1,0,1]
    v_pk_fma_f32 v[18:19], v[130:131], v[74:75], v[18:19] op_sel_hi:[1,0,1]
    v_pk_fma_f32 v[20:21], v[132:133], v[90:91], v[20:21] op_sel_hi:[1,0,1]
    v_pk_fma_f32 v[22:23], v[134:135], v[90:91], v[22:23] op_sel_hi:[1,0,1]
    s_set_gpr_idx_idx s67
.p2align 3
    v_pk_fma_f32 v[16:17], v[136:137], v[74:75], v[16:17] op_sel:[0,1,0] op_sel_hi:[1,1,1]
    v_pk_fma_f32 v[18:19], v[138:139], v[74:75], v[18:19] op_sel:[0,1,0] op_sel_hi:[1,1,1]
    v_pk_fma_f32 v[20:21], v[140:141], v[90:91], v[20:21] op_sel:[0,1,0] op_sel_hi:[1,1,1]
    v_pk_fma_f32 v[22:23], v[142:143], v[90:91], v[22:23] op_sel:[0,1,0] op_sel_hi:[1,1,1]
    s_set_gpr_idx_off
    s_waitcnt vmcnt(3)
.p2align 3
    v_mfma_f32_16x16x16_bf16 v[128:131], v[160:161], v[112:113], 0
    v_cvt_pk_bf16_f32 v10, v157, v157
    v_mfma_f32_16x16x16_bf16 v[132:135], v[160:161], v[114:115], 0
    v_and_b32 v162, v190, v10
    v_and_b32 v163, v191, v10
    s_waitcnt vmcnt(2)
.p2align 3
    s_nop 0
    v_mfma_f32_16x16x16_bf16 v[136:139], v[162:163], v[116:117], 0
    v_cvt_pk_bf16_f32 v9, v158, v158
    v_mfma_f32_16x16x16_bf16 v[140:143], v[162:163], v[118:119], 0
    v_and_b32 v160, v190, v9
    v_and_b32 v161, v191, v9
    s_set_gpr_idx_on s68, gpr_idx(SRC2,DST)
.p2align 3
    v_pk_fma_f32 v[16:17], v[128:129], v[76:77], v[16:17] op_sel_hi:[1,0,1]
    v_pk_fma_f32 v[18:19], v[130:131], v[76:77], v[18:19] op_sel_hi:[1,0,1]
    v_pk_fma_f32 v[20:21], v[132:133], v[92:93], v[20:21] op_sel_hi:[1,0,1]
    v_pk_fma_f32 v[22:23], v[134:135], v[92:93], v[22:23] op_sel_hi:[1,0,1]
    s_set_gpr_idx_idx s69
.p2align 3
    v_pk_fma_f32 v[16:17], v[136:137], v[76:77], v[16:17] op_sel:[0,1,0] op_sel_hi:[1,1,1]
    v_pk_fma_f32 v[18:19], v[138:139], v[76:77], v[18:19] op_sel:[0,1,0] op_sel_hi:[1,1,1]
    v_pk_fma_f32 v[20:21], v[140:141], v[92:93], v[20:21] op_sel:[0,1,0] op_sel_hi:[1,1,1]
    v_pk_fma_f32 v[22:23], v[142:143], v[92:93], v[22:23] op_sel:[0,1,0] op_sel_hi:[1,1,1]
    s_set_gpr_idx_off
    s_waitcnt vmcnt(1)
.p2align 3
    v_mfma_f32_16x16x16_bf16 v[128:131], v[160:161], v[120:121], 0
    v_cvt_pk_bf16_f32 v10, v159, v159
    v_mfma_f32_16x16x16_bf16 v[132:135], v[160:161], v[122:123], 0
    v_and_b32 v162, v190, v10
    v_and_b32 v163, v191, v10
    s_waitcnt vmcnt(0)
.p2align 3
    s_nop 0
    v_mfma_f32_16x16x16_bf16 v[136:139], v[162:163], v[124:125], 0
    v_mfma_f32_16x16x16_bf16 v[140:143], v[162:163], v[126:127], 0
    s_set_gpr_idx_on s70, gpr_idx(SRC2,DST)
.p2align 3
    v_pk_fma_f32 v[16:17], v[128:129], v[78:79], v[16:17] op_sel_hi:[1,0,1]
    v_pk_fma_f32 v[18:19], v[130:131], v[78:79], v[18:19] op_sel_hi:[1,0,1]
    v_pk_fma_f32 v[20:21], v[132:133], v[94:95], v[20:21] op_sel_hi:[1,0,1]
    v_pk_fma_f32 v[22:23], v[134:135], v[94:95], v[22:23] op_sel_hi:[1,0,1]
    s_set_gpr_idx_idx s71
.p2align 3
    s_nop 0
    v_pk_fma_f32 v[16:17], v[136:137], v[78:79], v[16:17] op_sel:[0,1,0] op_sel_hi:[1,1,1]
    v_pk_fma_f32 v[18:19], v[138:139], v[78:79], v[18:19] op_sel:[0,1,0] op_sel_hi:[1,1,1]
    v_pk_fma_f32 v[20:21], v[140:141], v[94:95], v[20:21] op_sel:[0,1,0] op_sel_hi:[1,1,1]
    v_pk_fma_f32 v[22:23], v[142:143], v[94:95], v[22:23] op_sel:[0,1,0] op_sel_hi:[1,1,1]
    s_set_gpr_idx_off
L_swept:
    s_add_u32 s48, s48, 224
    s_cmp_lt_u32 s48, s47
    s_cbranch_scc1 L_again
    s_setprio 0
    v_cvt_pk_bf16_f32 v64, v16, v20
    v_cvt_pk_bf16_f32 v65, v17, v21
    v_cvt_pk_bf16_f32 v66, v18, v22
    v_cvt_pk_bf16_f32 v67, v19, v23
    ds_write2_b32 v208, v64, v65 offset0:0 offset1:72
    ds_write2_b32 v208, v66, v67 offset0:144 offset1:216
    v_cvt_pk_bf16_f32 v68, v24, v28
    v_cvt_pk_bf16_f32 v69, v25, v29
    v_cvt_pk_bf16_f32 v70, v26, v30
    v_cvt_pk_bf16_f32 v71, v27, v31
    ds_write2_b32 v209, v68, v69 offset0:0 offset1:72
    ds_write2_b32 v209, v70, v71 offset0:144 offset1:216
    v_cvt_pk_bf16_f32 v72, v32, v36
    v_cvt_pk_bf16_f32 v73, v33, v37
    v_cvt_pk_bf16_f32 v74, v34, v38
    v_cvt_pk_bf16_f32 v75, v35, v39
    ds_write2_b32 v210, v72, v73 offset0:0 offset1:72
    ds_write2_b32 v210, v74, v75 offset0:144 offset1:216
    v_cvt_pk_bf16_f32 v76, v40, v44
    v_cvt_pk_bf16_f32 v77, v41, v45
    v_cvt_pk_bf16_f32 v78, v42, v46
    v_cvt_pk_bf16_f32 v79, v43, v47
    ds_write2_b32 v211, v76, v77 offset0:0 offset1:72
    ds_write2_b32 v211, v78, v79 offset0:144 offset1:216
    v_cvt_pk_bf16_f32 v80, v48, v52
    v_cvt_pk_bf16_f32 v81, v49, v53
    v_cvt_pk_bf16_f32 v82, v50, v54
    v_cvt_pk_bf16_f32 v83, v51, v55
    ds_write2_b32 v212, v80, v81 offset0:0 offset1:72
    ds_write2_b32 v212, v82, v83 offset0:144 offset1:216
    ds_read_b128 v[96:99], v215 offset:6144
    ds_read_b128 v[100:103], v215 offset:7168
    ds_read_b128 v[104:107], v215 offset:8192
    ds_read_b128 v[108:111], v215 offset:9216
    ds_read_b128 v[112:115], v215 offset:10240
    ds_read_b128 v[116:119], v215 offset:11264
    ds_read_b128 v[120:123], v215 offset:12288
    ds_read_b128 v[124:127], v215 offset:13312
    ds_read_b128 v[128:131], v215 offset:14336
    ds_read_b128 v[132:135], v215 offset:15360
    s_waitcnt lgkmcnt(10)
    s_barrier
    ds_read_b128 v[16:19], v213 offset:0
    ds_read_b128 v[20:23], v213 offset:64
    ds_read_b128 v[24:27], v213 offset:128
    ds_read_b128 v[28:31], v213 offset:192
    s_waitcnt lgkmcnt(3)
    v_mfma_f32_16x16x32_bf16 v[160:163], v[16:19], v[216:219], 0
    v_mfma_f32_16x16x32_bf16 v[164:167], v[16:19], v[220:223], 0
    v_mfma_f32_16x16x32_bf16 v[168:171], v[16:19], v[224:227], 0
    v_mfma_f32_16x16x32_bf16 v[172:175], v[16:19], v[228:231], 0
    ds_read_b128 v[32:35], v213 offset:4608
    ds_read_b128 v[36:39], v213 offset:4672
    ds_read_b128 v[40:43], v213 offset:4736
    ds_read_b128 v[44:47], v213 offset:4800
    s_waitcnt lgkmcnt(6)
    v_mfma_f32_16x16x32_bf16 v[160:163], v[20:23], v[232:235], v[160:163]
    v_mfma_f32_16x16x32_bf16 v[164:167], v[20:23], v[236:239], v[164:167]
    v_mfma_f32_16x16x32_bf16 v[168:171], v[20:23], v[96:99], v[168:171]
    v_mfma_f32_16x16x32_bf16 v[172:175], v[20:23], v[100:103], v[172:175]
    ds_read_b128 v[48:51], v213 offset:9216
    ds_read_b128 v[52:55], v213 offset:9280
    ds_read_b128 v[56:59], v213 offset:9344
    ds_read_b128 v[60:63], v213 offset:9408
    s_waitcnt lgkmcnt(9)
    v_mfma_f32_16x16x32_bf16 v[160:163], v[24:27], v[104:107], v[160:163]
    v_mfma_f32_16x16x32_bf16 v[164:167], v[24:27], v[108:111], v[164:167]
    v_mfma_f32_16x16x32_bf16 v[168:171], v[24:27], v[112:115], v[168:171]
    v_mfma_f32_16x16x32_bf16 v[172:175], v[24:27], v[116:119], v[172:175]
    s_waitcnt lgkmcnt(8)
    v_mfma_f32_16x16x32_bf16 v[160:163], v[28:31], v[120:123], v[160:163]
    v_mfma_f32_16x16x32_bf16 v[164:167], v[28:31], v[124:127], v[164:167]
    v_mfma_f32_16x16x32_bf16 v[168:171], v[28:31], v[128:131], v[168:171]
    v_mfma_f32_16x16x32_bf16 v[172:175], v[28:31], v[132:135], v[172:175]
    s_waitcnt lgkmcnt(4)
    v_mfma_f32_16x16x32_bf16 v[176:179], v[32:35], v[216:219], 0
    v_mfma_f32_16x16x32_bf16 v[180:183], v[32:35], v[220:223], 0
    v_mfma_f32_16x16x32_bf16 v[184:187], v[32:35], v[224:227], 0
    v_mfma_f32_16x16x32_bf16 v[188:191], v[32:35], v[228:231], 0
    v_mfma_f32_16x16x32_bf16 v[176:179], v[36:39], v[232:235], v[176:179]
    v_cvt_pk_bf16_f32 v64, v160, v164
    v_cvt_pk_bf16_f32 v80, v160, v164
    v_mfma_f32_16x16x32_bf16 v[180:183], v[36:39], v[236:239], v[180:183]
    v_cvt_pk_bf16_f32 v66, v162, v166
    v_cvt_pk_bf16_f32 v65, v168, v172
    v_mfma_f32_16x16x32_bf16 v[184:187], v[36:39], v[96:99], v[184:187]
    v_cvt_pk_bf16_f32 v81, v168, v172
    v_cvt_pk_bf16_f32 v67, v170, v174
    v_mfma_f32_16x16x32_bf16 v[188:191], v[36:39], v[100:103], v[188:191]
    v_mov_b32_dpp v64, v66 row_ror:8 row_mask:0xf bank_mask:0xc
    v_mov_b32_dpp v65, v67 row_ror:8 row_mask:0xf bank_mask:0xc
    v_mfma_f32_16x16x32_bf16 v[176:179], v[40:43], v[104:107], v[176:179]
    v_mov_b32_dpp v66, v80 row_ror:8 row_mask:0xf bank_mask:0x3
    v_mov_b32_dpp v67, v81 row_ror:8 row_mask:0xf bank_mask:0x3
    v_mfma_f32_16x16x32_bf16 v[180:183], v[40:43], v[108:111], v[180:183]
    buffer_store_dwordx4 v[64:67], v214, s[40:43], s99 offen offset:0 sc1
    v_cvt_pk_bf16_f32 v68, v161, v165
    v_mfma_f32_16x16x32_bf16 v[184:187], v[40:43], v[112:115], v[184:187]
    v_cvt_pk_bf16_f32 v82, v161, v165
    v_cvt_pk_bf16_f32 v70, v163, v167
    v_mfma_f32_16x16x32_bf16 v[188:191], v[40:43], v[116:119], v[188:191]
    v_cvt_pk_bf16_f32 v69, v169, v173
    v_cvt_pk_bf16_f32 v83, v169, v173
    v_mfma_f32_16x16x32_bf16 v[176:179], v[44:47], v[120:123], v[176:179]
    v_cvt_pk_bf16_f32 v71, v171, v175
    v_mov_b32_dpp v68, v70 row_ror:8 row_mask:0xf bank_mask:0xc
    v_mfma_f32_16x16x32_bf16 v[180:183], v[44:47], v[124:127], v[180:183]
    v_mov_b32_dpp v69, v71 row_ror:8 row_mask:0xf bank_mask:0xc
    v_mov_b32_dpp v70, v82 row_ror:8 row_mask:0xf bank_mask:0x3
    v_mfma_f32_16x16x32_bf16 v[184:187], v[44:47], v[128:131], v[184:187]
    v_mov_b32_dpp v71, v83 row_ror:8 row_mask:0xf bank_mask:0x3
    buffer_store_dwordx4 v[68:71], v214, s[40:43], s99 offen offset:256 sc1
    v_mfma_f32_16x16x32_bf16 v[188:191], v[44:47], v[132:135], v[188:191]
    s_add_u32 s99, s99, 4096
    s_cmp_ge_u32 s3, 4
    s_cbranch_scc1 L_two
    s_waitcnt lgkmcnt(0)
    v_mfma_f32_16x16x32_bf16 v[160:163], v[48:51], v[216:219], 0
    v_mfma_f32_16x16x32_bf16 v[164:167], v[48:51], v[220:223], 0
    v_mfma_f32_16x16x32_bf16 v[168:171], v[48:51], v[224:227], 0
    v_mfma_f32_16x16x32_bf16 v[172:175], v[48:51], v[228:231], 0
    v_mfma_f32_16x16x32_bf16 v[160:163], v[52:55], v[232:235], v[160:163]
    v_cvt_pk_bf16_f32 v72, v176, v180
    v_cvt_pk_bf16_f32 v80, v176, v180
    v_mfma_f32_16x16x32_bf16 v[164:167], v[52:55], v[236:239], v[164:167]
    v_cvt_pk_bf16_f32 v74, v178, v182
    v_cvt_pk_bf16_f32 v73, v184, v188
    v_mfma_f32_16x16x32_bf16 v[168:171], v[52:55], v[96:99], v[168:171]
    v_cvt_pk_bf16_f32 v81, v184, v188
    v_cvt_pk_bf16_f32 v75, v186, v190
    v_mfma_f32_16x16x32_bf16 v[172:175], v[52:55], v[100:103], v[172:175]
    v_mov_b32_dpp v72, v74 row_ror:8 row_mask:0xf bank_mask:0xc
    v_mov_b32_dpp v73, v75 row_ror:8 row_mask:0xf bank_mask:0xc
    v_mfma_f32_16x16x32_bf16 v[160:163], v[56:59], v[104:107], v[160:163]
    v_mov_b32_dpp v74, v80 row_ror:8 row_mask:0xf bank_mask:0x3
    v_mov_b32_dpp v75, v81 row_ror:8 row_mask:0xf bank_mask:0x3
    v_mfma_f32_16x16x32_bf16 v[164:167], v[56:59], v[108:111], v[164:167]
    buffer_store_dwordx4 v[72:75], v214, s[40:43], s99 offen offset:0 sc1
    v_cvt_pk_bf16_f32 v76, v177, v181
    v_mfma_f32_16x16x32_bf16 v[168:171], v[56:59], v[112:115], v[168:171]
    v_cvt_pk_bf16_f32 v82, v177, v181
    v_cvt_pk_bf16_f32 v78, v179, v183
    v_mfma_f32_16x16x32_bf16 v[172:175], v[56:59], v[116:119], v[172:175]
    v_cvt_pk_bf16_f32 v77, v185, v189
    v_cvt_pk_bf16_f32 v83, v185, v189
    v_mfma_f32_16x16x32_bf16 v[160:163], v[60:63], v[120:123], v[160:163]
    v_cvt_pk_bf16_f32 v79, v187, v191
    v_mov_b32_dpp v76, v78 row_ror:8 row_mask:0xf bank_mask:0xc
    v_mfma_f32_16x16x32_bf16 v[164:167], v[60:63], v[124:127], v[164:167]
    v_mov_b32_dpp v77, v79 row_ror:8 row_mask:0xf bank_mask:0xc
    v_mov_b32_dpp v78, v82 row_ror:8 row_mask:0xf bank_mask:0x3
    v_mfma_f32_16x16x32_bf16 v[168:171], v[60:63], v[128:131], v[168:171]
    v_mov_b32_dpp v79, v83 row_ror:8 row_mask:0xf bank_mask:0x3
    buffer_store_dwordx4 v[76:79], v214, s[40:43], s99 offen offset:256 sc1
    v_mfma_f32_16x16x32_bf16 v[172:175], v[60:63], v[132:135], v[172:175]
    s_add_u32 s99, s99, 4096
    s_nop 0
    v_cvt_pk_bf16_f32 v64, v160, v164
    v_cvt_pk_bf16_f32 v80, v160, v164
    v_cvt_pk_bf16_f32 v66, v162, v166
    s_nop 2
    v_cvt_pk_bf16_f32 v65, v168, v172
    v_cvt_pk_bf16_f32 v81, v168, v172
    v_cvt_pk_bf16_f32 v67, v170, v174
    v_mov_b32_dpp v64, v66 row_ror:8 row_mask:0xf bank_mask:0xc
    s_nop 0
    v_mov_b32_dpp v65, v67 row_ror:8 row_mask:0xf bank_mask:0xc
    v_mov_b32_dpp v66, v80 row_ror:8 row_mask:0xf bank_mask:0x3
    v_mov_b32_dpp v67, v81 row_ror:8 row_mask:0xf bank_mask:0x3
    buffer_store_dwordx4 v[64:67], v214, s[40:43], s99 offen offset:0 sc1
    v_cvt_pk_bf16_f32 v68, v161, v165
    v_cvt_pk_bf16_f32 v82, v161, v165
    v_cvt_pk_bf16_f32 v70, v163, v167
    v_cvt_pk_bf16_f32 v69, v169, v173
    v_cvt_pk_bf16_f32 v83, v169, v173
    v_cvt_pk_bf16_f32 v71, v171, v175
    v_mov_b32_dpp v68, v70 row_ror:8 row_mask:0xf bank_mask:0xc
    s_nop 0
    v_mov_b32_dpp v69, v71 row_ror:8 row_mask:0xf bank_mask:0xc
    v_mov_b32_dpp v70, v82 row_ror:8 row_mask:0xf bank_mask:0x3
    v_mov_b32_dpp v71, v83 row_ror:8 row_mask:0xf bank_mask:0x3
    buffer_store_dwordx4 v[68:71], v214, s[40:43], s99 offen offset:256 sc1
    s_add_u32 s99, s99, 4096
L_stored:
    s_or_b32 s4, s2, s3
    s_cbranch_scc1 L_notag
    v_mov_b32 v8, s62
    v_lshlrev_b32 v10, 2, v1
    s_mov_b32 s54, 524288
    buffer_store_dword v8, v10, s[20:23], s54 offen sc1
L_notag:
L_done:
    s_endpgm
L_again:
    s_waitcnt vmcnt(0) lgkmcnt(0)
    s_barrier
    v_lshlrev_b32 v11, 2, v0
    v_mov_b32 v12, 0x00700000
    v_mov_b32 v13, 0
    ds_write_b32 v11, v12 offset:0
    ds_write_b32 v11, v12 offset:2048
    ds_write_b32 v11, v12 offset:4096
    ds_write_b32 v11, v12 offset:6144
    ds_write_b32 v11, v13 offset:8192
    ds_write_b32 v11, v13 offset:10240
    ds_write_b32 v11, v13 offset:12288
    v_add_u32 v3, v3, v4
    v_subrev_u32 v3, 224, v3
    v_max_i32 v3, 0, v3
    v_subrev_u32 v4, 224, v4
    v_max_i32 v4, 0, v4
    v_sub_u32 v3, v3, v4
    v_add_u32 v5, 224, v5
    s_sub_i32 s95, s95, 224
    v_lshl_add_u32 v8, v4, 2, v241
    s_waitcnt lgkmcnt(0)
    s_barrier
L_clip:
    v_add_u32 v10, v4, v3
    v_min_i32 v10, 224, v10
    v_sub_u32 v10, v10, v4
    v_add_u32 v10, v10, v240
L_masks:
    v_cmp_lt_i32 s[64:65], 0, v10
    v_cmp_lt_i32 s[66:67], 2, v10
    v_cmp_lt_i32 s[68:69], 4, v10
    v_cmp_lt_i32 s[70:71], 6, v10
    v_cmp_lt_i32 s[72:73], 8, v10
    v_cmp_lt_i32 s[74:75], 10, v10
    v_cmp_lt_i32 s[76:77], 12, v10
    v_cmp_lt_i32 s[78:79], 14, v10
    s_nop 0
    s_branch L_mapw
L_map2:
    v_add_u32 v8, 56, v8
    v_subrev_u32 v10, 14, v10
    s_branch L_masks
L_r1:
    ds_read_b32 v67, v242 offset:768
    ds_read_b32 v74, v243 offset:768
    s_waitcnt lgkmcnt(0)
    v_mad_u32_u24 v67, v67, 12, v244
    buffer_load_dwordx3 v[88:90], v67, s[24:27], 0 offen offset:2304 sc1
    v_lshl_add_u32 v74, v74, 5, v2
    s_add_u32 m0, s52, 4096
    s_nop 0
    buffer_load_dwordx4 v74, s[28:31], s98 offen offset:2048 sc1 lds
    s_branch L_r1b
L_r2:
    v_lshrrev_b32 v135, 21, v90
    v_lshlrev_b32 v135, 2, v135
    v_lshrrev_b32 v11, 26, v90
    v_lshl_or_b32 v11, v11, 4, v245
    s_mov_b64 exec, s[96:97]
    ds_add_rtn_u32 v131, v135, v6 offset:8192
    ds_add_u32 v11, v6 offset:14336
    s_mov_b64 exec, -1
    s_mov_b32 exec_hi, 0
    ds_write_b64 v246, v[88:89] offset:1536
    s_mov_b32 exec_hi, -1
    v_and_or_b32 v90, v90, s55, v247
    v_add_u32 v90, 402653184, v90
    s_branch L_r2b
L_r3:
    ds_read_b32 v135, v135 offset:8192
    s_waitcnt lgkmcnt(0)
    v_bfe_u32 v15, v135, 12, 3
    v_or_b32 v90, v15, v90
    v_and_b32 v67, 0x3ff, v135
    v_lshrrev_b32 v135, 16, v135
    v_add_u32 v135, v135, v131
    ds_read_b32 v67, v67 offset:16384
    s_waitcnt lgkmcnt(0)
    v_lshl_add_u32 v135, v135, 2, v67
    s_mov_b64 exec, s[96:97]
    ds_write_b32 v135, v90
    s_mov_b64 exec, -1
    s_branch L_r3b
L_two:
    s_nop 7
    v_cvt_pk_bf16_f32 v72, v176, v180
    v_cvt_pk_bf16_f32 v80, v176, v180
    v_cvt_pk_bf16_f32 v74, v178, v182
    v_cvt_pk_bf16_f32 v73, v184, v188
    v_cvt_pk_bf16_f32 v81, v184, v188
    v_cvt_pk_bf16_f32 v75, v186, v190
    v_mov_b32_dpp v72, v74 row_ror:8 row_mask:0xf bank_mask:0xc
    s_nop 0
    v_mov_b32_dpp v73, v75 row_ror:8 row_mask:0xf bank_mask:0xc
    v_mov_b32_dpp v74, v80 row_ror:8 row_mask:0xf bank_mask:0x3
    v_mov_b32_dpp v75, v81 row_ror:8 row_mask:0xf bank_mask:0x3
    buffer_store_dwordx4 v[72:75], v214, s[40:43], s99 offen offset:0 sc1
    v_cvt_pk_bf16_f32 v76, v177, v181
    v_cvt_pk_bf16_f32 v82, v177, v181
    v_cvt_pk_bf16_f32 v78, v179, v183
    v_cvt_pk_bf16_f32 v77, v185, v189
    v_cvt_pk_bf16_f32 v83, v185, v189
    v_cvt_pk_bf16_f32 v79, v187, v191
    v_mov_b32_dpp v76, v78 row_ror:8 row_mask:0xf bank_mask:0xc
    s_nop 0
    v_mov_b32_dpp v77, v79 row_ror:8 row_mask:0xf bank_mask:0xc
    v_mov_b32_dpp v78, v82 row_ror:8 row_mask:0xf bank_mask:0x3
    v_mov_b32_dpp v79, v83 row_ror:8 row_mask:0xf bank_mask:0x3
    buffer_store_dwordx4 v[76:79], v214, s[40:43], s99 offen offset:256 sc1
    s_add_u32 s99, s99, 4096
    s_branch L_stored
L_poll:
    buffer_load_dwordx2 v[206:207], v10, s[20:23], s49 offen sc1
    s_sub_u32 s53, s53, 1
    s_cbranch_scc1 L_done
    s_waitcnt vmcnt(0)
    v_xor_b32 v11, s63, v206
    v_xor_b32 v12, s62, v207
    v_and_or_b32 v11, v11, s55, v12
    v_cmpx_ne_u32 vcc, 0, v11
    s_cbranch_execnz L_poll
    s_branch L_polled
L_rank2:
    ds_read_b32 v96, v248 offset:8192
    ds_read_b32 v97, v248 offset:8320
    ds_read_b32 v98, v248 offset:8448
    ds_read_b32 v99, v248 offset:8576
    ds_read_b32 v100, v248 offset:8704
    s_waitcnt lgkmcnt(0)
L_end:
    s_branch L_ranked
.section .rodata,"a"
.p2align 6
.amdhsa_kernel gather_scatter__tensor_product_equiv_mace__graph_kernel
  .amdhsa_next_free_vgpr 256
  .amdhsa_next_free_sgpr 102
  .amdhsa_accum_offset 256
  .amdhsa_group_segment_fixed_size 0
  .amdhsa_kernarg_size 88
  .amdhsa_user_sgpr_count 2
  .amdhsa_user_sgpr_kernarg_segment_ptr 1
  .amdhsa_system_sgpr_workgroup_id_x 1
  .amdhsa_float_denorm_mode_32 3
.end_amdhsa_kernel
```

```asm
; @launch grid=(256,1,1) block=(512,1,1) lds=158784
.amdgcn_target "amdgcn-amd-amdhsa--gfx950"
.text
.globl gather_scatter__tensor_product_equiv_mace__graph_kernel
.p2align 8
.type gather_scatter__tensor_product_equiv_mace__graph_kernel,@function
gather_scatter__tensor_product_equiv_mace__graph_kernel:
    s_cmp_ge_u32 s2, 256
    s_cbranch_scc1 L_done
    s_load_dwordx4 s[4:7], s[0:1], 8
    s_load_dwordx4 s[8:11], s[0:1], 24
    s_load_dwordx2 s[14:15], s[0:1], 80
    s_load_dwordx2 s[64:65], s[0:1], 0
    s_load_dwordx2 s[66:67], s[0:1], 40
    s_load_dwordx4 s[68:71], s[0:1], 48
    s_load_dwordx2 s[12:13], s[0:1], 64
    v_lshlrev_b32 v10, 3, v0
    s_getpc_b64 s[80:81]
L_pc:
    s_and_b32 s44, s2, 0xf8
    s_lshl_b32 s44, s44, 6
    v_and_b32 v11, 0x180, v10
    v_add_u32 v11, s44, v11
    v_min_u32 v11, L_end-L_pc, v11
    v_mov_b32 v113, s81
    v_add_co_u32 v112, vcc, s80, v11
    s_nop 1
    v_addc_co_u32 v113, vcc, 0, v113, vcc
    global_load_dword v205, v[112:113], off
    v_lshrrev_b32 v8, 6, v0
    v_and_b32 v1, 63, v0
    v_lshlrev_b32 v9, 2, v0
    v_mov_b32 v13, 0
    v_readfirstlane_b32 s3, v8
    ds_write_b32 v9, v13 offset:23552
    ds_write_b32 v9, v13 offset:28672
    s_mul_i32 s54, s2, 5000
    s_mul_i32 s55, s2, 10000
    s_mul_i32 s61, s2, 40000
    v_lshlrev_b32 v2, 4, v1
    v_lshlrev_b32 v15, 4, v0
    v_mov_b32 v6, 1
    s_lshl_b32 s52, s3, 10
    s_add_u32 s52, s52, 101376
    s_movk_i32 s53, 4096
    s_movk_i32 s50, 8192
    s_mov_b32 s34, 5000
    s_mov_b32 s35, 0x20000
    s_mov_b32 s38, 5000
    s_mov_b32 s39, 0x20000
    s_mov_b32 s98, 10000
    s_mov_b32 s99, 0x20000
    s_mov_b32 s30, 40000
    s_mov_b32 s31, 0x20000
    s_waitcnt lgkmcnt(0)
    s_add_u32 s32, s6, s54
    s_addc_u32 s33, s7, 0
    buffer_load_dword v64, v9, s[32:35], 0 offen offset:0 nt
    buffer_load_dword v65, v9, s[32:35], 0 offen offset:2048 nt
    buffer_load_dword v66, v9, s[32:35], s53 offen nt
    s_add_u32 s36, s4, s54
    s_addc_u32 s37, s5, 0
    s_barrier
    buffer_load_dword v68, v9, s[36:39], 0 offen offset:0 nt
    buffer_load_dword v69, v9, s[36:39], 0 offen offset:2048 nt
    buffer_load_dword v70, v9, s[36:39], s53 offen nt
    s_load_dword s62, s[14:15], 524288
    s_add_u32 s96, s8, s55
    s_addc_u32 s97, s9, 0
    s_add_u32 s28, s10, s61
    s_addc_u32 s29, s11, 0
    buffer_load_dwordx2 v[72:73], v10, s[96:99], 0 offen nt
    buffer_load_dwordx2 v[74:75], v10, s[96:99], s53 offen nt
    buffer_load_dwordx2 v[76:77], v10, s[96:99], s50 offen nt
    s_add_u32 m0, s52, 0
    s_mov_b32 s54, 0
    buffer_load_dwordx4 v15, s[28:31], s54 offen nt lds
    s_add_u32 m0, s52, 8192
    s_mov_b32 s54, 8192
    buffer_load_dwordx4 v15, s[28:31], s54 offen nt lds
    s_add_u32 m0, s52, 16384
    s_mov_b32 s54, 16384
    buffer_load_dwordx4 v15, s[28:31], s54 offen nt lds
    s_mov_b32 s72, 109951168
    s_movk_i32 s73, 625
    s_movk_i32 s74, 838
    s_movk_i32 s54, 226
    v_cmp_gt_u32 s[84:85], s54, v0
    s_mov_b32 s20, s14
    s_mov_b32 s21, s15
    s_mov_b32 s22, 524352
    s_mov_b32 s23, 0x20000
    v_lshlrev_b32 v11, 2, v0
    v_mov_b32 v12, 0x00700000
    v_mov_b32 v13, 0
    ds_write_b32 v11, v12 offset:0
    ds_write_b32 v11, v12 offset:2048
    ds_write_b32 v11, v12 offset:4096
    ds_write_b32 v11, v12 offset:6144
    ds_write_b32 v11, v13 offset:8192
    ds_write_b32 v11, v13 offset:10240
    ds_write_b32 v11, v13 offset:12288
    ds_write_b32 v11, v13 offset:14336
    s_waitcnt vmcnt(9)
    v_mul_hi_u32 v80, v64, s72
    v_mul_hi_u32 v81, v65, s72
    v_mul_hi_u32 v82, v66, s72
    v_lshlrev_b32 v84, 2, v80
    ds_add_rtn_u32 v88, v84, v6 offset:23552
    v_lshlrev_b32 v85, 2, v81
    ds_add_rtn_u32 v89, v85, v6 offset:23552
    v_lshlrev_b32 v86, 2, v82
    s_mov_b64 exec, s[84:85]
    ds_add_rtn_u32 v90, v86, v6 offset:23552
    s_mov_b64 exec, -1
    s_waitcnt lgkmcnt(0)
    s_barrier
    ds_read_b128 v[100:103], v2 offset:23552
    s_mul_i32 s62, s62, 0x9e3779b1
    s_add_u32 s62, s62, 0x7f4a7c15
    s_mul_i32 s63, s62, 0x85ebca6b
    s_and_b32 s63, s63, 0xffc00000
    s_add_u32 m0, s52, 24576
    s_mov_b32 s54, 24576
    buffer_load_dwordx4 v15, s[28:31], s54 offen nt lds
    s_add_u32 m0, s52, 32768
    s_mov_b32 s54, 32768
    buffer_load_dwordx4 v15, s[28:31], s54 offen nt lds
    v_mad_u32_u24 v92, v80, s73, 15
    v_lshrrev_b32 v92, 4, v92
    v_sub_u32 v92, v64, v92
    v_mad_u32_u24 v93, v81, s73, 15
    v_lshrrev_b32 v93, 4, v93
    v_sub_u32 v93, v65, v93
    v_mad_u32_u24 v94, v82, s73, 15
    v_lshrrev_b32 v94, 4, v94
    v_sub_u32 v94, v66, v94
    s_waitcnt lgkmcnt(0)
    v_add_u32 v11, v100, v101
    v_add3_u32 v11, v11, v102, v103
    v_mov_b32 v12, v11
    s_nop 1
    v_add_u32_dpp v12, v12, v12 row_shr:1 row_mask:0xf bank_mask:0xf
    s_nop 1
    v_add_u32_dpp v12, v12, v12 row_shr:2 row_mask:0xf bank_mask:0xf
    s_nop 1
    v_add_u32_dpp v12, v12, v12 row_shr:4 row_mask:0xf bank_mask:0xf
    s_nop 1
    v_add_u32_dpp v12, v12, v12 row_shr:8 row_mask:0xf bank_mask:0xf
    s_nop 1
    v_add_u32_dpp v12, v12, v12 row_bcast:15 row_mask:0xa bank_mask:0xf
    s_nop 1
    v_add_u32_dpp v12, v12, v12 row_bcast:31 row_mask:0xc bank_mask:0xf
    v_sub_u32 v104, v12, v11
    v_add_u32 v105, v104, v100
    v_add_u32 v106, v105, v101
    v_add_u32 v107, v106, v102
    ds_write_b128 v2, v[104:107] offset:24576
    ds_read_b32 v108, v84 offset:24576
    ds_read_b32 v109, v85 offset:24576
    ds_read_b32 v110, v86 offset:24576
    s_waitcnt vmcnt(8)
    v_mul_u32_u24 v96, s74, v68
    v_bfe_u32 v96, v96, 18, 5
    v_lshl_or_b32 v96, v92, 5, v96
    v_lshlrev_b32 v96, 21, v96
    v_lshl_or_b32 v96, v68, 7, v96
    v_mul_u32_u24 v97, s74, v69
    v_bfe_u32 v97, v97, 18, 5
    v_lshl_or_b32 v97, v93, 5, v97
    v_lshlrev_b32 v97, 21, v97
    v_lshl_or_b32 v97, v69, 7, v97
    v_mul_u32_u24 v98, s74, v70
    v_bfe_u32 v98, v98, 18, 5
    v_lshl_or_b32 v98, v94, 5, v98
    v_lshlrev_b32 v98, 21, v98
    v_lshl_or_b32 v98, v70, 7, v98
    v_lshlrev_b32 v92, 5, v0
    v_add_u32 v93, 16384, v92
    v_add_u32 v94, 32768, v92
    s_mov_b32 s55, 30720
    s_waitcnt vmcnt(5) lgkmcnt(0)
    v_add_u32 v108, v108, v88
    v_lshlrev_b32 v84, 2, v108
    v_mad_u32_u24 v108, v108, 12, s55
    ds_write_b32 v84, v92 offset:25600
    ds_write2_b32 v108, v72, v73 offset0:0 offset1:1
    ds_write_b32 v108, v96 offset:8
    v_add_u32 v109, v109, v89
    v_lshlrev_b32 v85, 2, v109
    v_mad_u32_u24 v109, v109, 12, s55
    ds_write_b32 v85, v93 offset:25600
    ds_write2_b32 v109, v74, v75 offset0:0 offset1:1
    ds_write_b32 v109, v97 offset:8
    v_add_u32 v110, v110, v90
    v_lshlrev_b32 v86, 2, v110
    v_mad_u32_u24 v110, v110, 12, s55
    s_mov_b64 exec, s[84:85]
    ds_write_b32 v86, v94 offset:25600
    ds_write2_b32 v110, v76, v77 offset0:0 offset1:1
    ds_write_b32 v110, v98 offset:8
    s_mov_b64 exec, -1
    s_lshl_b32 s54, s3, 7
    v_lshl_add_u32 v11, v1, 3, s54
    ds_read_b64 v[100:101], v11 offset:23552
    ds_read_b64 v[104:105], v11 offset:24576
    s_mul_i32 s54, s2, 15360
    s_add_u32 s54, s54, 1048576
    s_add_u32 s32, s14, s54
    s_addc_u32 s33, s15, 0
    s_mov_b32 s34, 15360
    s_mov_b32 s35, 0x20000
    s_mul_i32 s54, s2, 40960
    s_add_u32 s54, s54, 5242880
    s_add_u32 s36, s14, s54
    s_addc_u32 s37, s15, 0
    s_mov_b32 s38, 40000
    s_mov_b32 s39, 0x20000
    v_lshrrev_b32 v11, 1, v0
    v_lshlrev_b32 v11, 2, v11
    v_and_b32 v12, 1, v0
    v_lshlrev_b32 v12, 4, v12
    v_add_u32 v12, 101376, v12
    v_add_u32 v14, 30720, v15
    s_waitcnt lgkmcnt(0)
    s_barrier
    ds_read_b128 v[128:131], v14
    ds_read_b128 v[132:135], v14 offset:8192
    ds_read_b32 v156, v11 offset:25600
    ds_read_b32 v157, v11 offset:26624
    ds_read_b32 v158, v11 offset:27648
    ds_read_b32 v159, v11 offset:28672
    ds_read_b32 v160, v11 offset:29696
    s_cmp_lt_u32 s3, 4
    s_cselect_b32 s16, s68, s66
    s_cselect_b32 s17, s69, s67
    s_movk_i32 s54, 128
    s_cselect_b32 s18, s53, s54
    s_mov_b32 s19, 0x20000
    s_min_u32 s54, s3, 5
    s_lshl_b32 s54, s54, 10
    s_add_u32 m0, s54, 17408
    s_and_b32 s54, s54, 0xc00
    buffer_load_dwordx4 v2, s[16:19], s54 offen lds
    s_mov_b32 s40, s70
    s_mov_b32 s41, s71
    s_mov_b32 s42, 32768
    s_mov_b32 s43, 0x20000
    s_lshl_b32 s55, s3, 12
    s_add_u32 m0, s55, 46080
    s_nop 0
    buffer_load_dwordx4 v2, s[40:43], s55 offen offset:0 lds
    buffer_load_dwordx4 v2, s[40:43], s55 offen offset:1024 lds
    buffer_load_dwordx4 v2, s[40:43], s55 offen offset:2048 lds
    buffer_load_dwordx4 v2, s[40:43], s55 offen offset:3072 lds
    s_waitcnt lgkmcnt(0)
    v_add_u32 v156, v12, v156
    v_add_u32 v157, v12, v157
    v_add_u32 v158, v12, v158
    v_add_u32 v159, v12, v159
    v_add_u32 v160, v12, v160
    v_lshl_or_b32 v112, v100, 11, v104
    v_or_b32 v112, s63, v112
    v_mov_b32 v113, s62
    v_lshl_or_b32 v114, v101, 11, v105
    v_or_b32 v114, s63, v114
    v_mov_b32 v115, s62
    s_waitcnt vmcnt(0)
    s_barrier
    ds_read_b128 v[136:139], v156
    ds_read_b128 v[140:143], v157
    ds_read_b128 v[144:147], v158
    ds_read_b128 v[148:151], v159
    ds_read_b128 v[152:155], v160
    buffer_store_dwordx4 v[128:131], v15, s[32:35], 0 offen sc1
    buffer_store_dwordx4 v[132:135], v15, s[32:35], s50 offen sc1
    s_mov_b32 s54, 0
    s_waitcnt lgkmcnt(4)
    buffer_store_dwordx4 v[136:139], v15, s[36:39], s54 offen sc1
    s_mov_b32 s54, 8192
    s_waitcnt lgkmcnt(3)
    buffer_store_dwordx4 v[140:143], v15, s[36:39], s54 offen sc1
    s_mov_b32 s54, 16384
    s_waitcnt lgkmcnt(2)
    buffer_store_dwordx4 v[144:147], v15, s[36:39], s54 offen sc1
    s_mov_b32 s54, 24576
    s_waitcnt lgkmcnt(1)
    buffer_store_dwordx4 v[148:151], v15, s[36:39], s54 offen sc1
    s_mov_b32 s54, 32768
    s_waitcnt lgkmcnt(0)
    buffer_store_dwordx4 v[152:155], v15, s[36:39], s54 offen sc1
    s_and_b32 s44, s2, 7
    s_lshl_b32 s44, s44, 5
    s_lshr_b32 s54, s2, 3
    s_add_u32 s44, s44, s54
    s_mul_i32 s45, s44, 625
    s_add_u32 s46, s45, 640
    s_add_u32 s45, s45, 15
    s_lshr_b32 s45, s45, 4
    s_lshr_b32 s46, s46, 4
    s_sub_u32 s46, s46, s45
    v_bfe_i32 v168, v1, 2, 1
    v_and_b32 v168, 0xaaaa, v168
    v_add_u32 v168, 0x4444, v168
    v_mov_b32 v169, 158720
    v_and_b32 v11, 60, v9
    v_add_u32 v11, v11, v169
    ds_write_b32 v11, v13
    v_and_b32 v11, 4, v1
    v_lshlrev_b32 v11, 2, v11
    v_mov_b32 v12, 0xffff
    v_lshlrev_b32 v12, v11, v12
    v_bfe_i32 v11, v1, 3, 1
    v_and_b32 v191, v11, v12
    v_xor_b32 v190, v191, v12
    v_lshrrev_b32 v200, 5, v1
    v_lshlrev_b32 v200, 4, v200
    v_add_u32 v200, 101376, v200
    v_and_b32 v201, 15, v1
    v_lshlrev_b32 v201, 2, v201
    v_bfe_u32 v11, v1, 3, 2
    v_and_b32 v12, 3, v1
    v_lshl_add_u32 v11, v11, 2, v12
    v_lshlrev_b32 v202, 2, v11
    v_bfe_i32 v240, v0, 0, 1
    s_lshl_b32 s54, s3, 10
    v_and_b32 v241, 4, v240
    v_add_u32 v241, s54, v241
    v_lshl_add_u32 v242, v1, 2, s54
    v_lshrrev_b32 v243, 1, v1
    v_lshl_add_u32 v243, v243, 2, s54
    v_mul_u32_u24 v244, 12, v1
    v_and_b32 v245, 12, v242
    v_and_b32 v250, 124, v242
    s_mul_i32 s54, s3, 224
    v_add_u32 v247, s54, v1
    v_lshlrev_b32 v246, 3, v247
    v_add_u32 v246, 87040, v246
    v_lshlrev_b32 v247, 21, v247
    s_mul_i32 s54, s3, 640
    v_add_u32 v248, s54, v250
    v_sub_u32 v249, 63, v1
    s_getreg_b32 s86, hwreg(HW_REG_XCC_ID, 0, 3)
    s_lshl_b32 s54, s86, 4
    v_subrev_u32 v250, s54, v250
    v_and_b32 v250, 124, v250
    s_lshl_b32 s54, s3, 5
    v_lshl_add_u32 v251, v1, 2, s54
    v_lshrrev_b32 v252, 3, v1
    v_mul_u32_u24 v252, 64, v252
    v_add_u32 v252, 78848, v252
    s_lshr_b32 s87, s3, 1
    s_mul_i32 s87, s87, 3
    s_min_u32 s87, s87, 8
    s_mul_i32 s54, s87, 4608
    v_and_b32 v11, 15, v1
    v_lshrrev_b32 v12, 4, v1
    v_mul_u32_u24 v213, 288, v11
    v_lshl_add_u32 v213, v12, 4, v213
    v_add_u32 v213, s54, v213
    v_lshrrev_b32 v12, 3, v1
    v_lshlrev_b32 v12, 9, v12
    v_and_b32 v11, 7, v1
    v_lshl_add_u32 v214, v11, 4, v12
    s_lshl_b32 s87, s87, 12
    s_and_b32 s54, s3, 1
    s_lshl_b32 s54, s54, 7
    s_add_u32 s87, s87, s54
    s_lshl_b32 s54, s54, 7
    s_add_u32 s54, s54, 46080
    v_add_u32 v215, s54, v2
    s_cmp_eq_u32 s46, 40
    v_mov_b32 v203, 0
    s_mov_b32 s54, 685900808
    s_cselect_b32 s54, 568459824, s54
    s_mov_b32 exec_lo, 31
    s_mov_b32 exec_hi, 0
    v_mov_b32 v203, s54
    s_mov_b32 s54, 182814793
    s_cselect_b32 s54, 23232528, s54
    s_mov_b32 exec_lo, 992
    s_mov_b32 exec_hi, 0
    v_mov_b32 v203, s54
    s_mov_b32 s54, 984091248
    s_cselect_b32 s54, 719688297, s54
    s_mov_b32 exec_lo, 31744
    s_mov_b32 exec_hi, 0
    v_mov_b32 v203, s54
    s_mov_b32 s54, 424091761
    s_cselect_b32 s54, 984423522, s54
    s_mov_b32 exec_lo, 1015808
    s_mov_b32 exec_hi, 0
    v_mov_b32 v203, s54
    s_mov_b32 s54, 586001611
    s_cselect_b32 s54, 172635826, s54
    s_mov_b32 exec_lo, 32505856
    s_mov_b32 exec_hi, 0
    v_mov_b32 v203, s54
    s_mov_b32 s54, 64039106
    s_cselect_b32 s54, 454017211, s54
    s_mov_b32 exec_lo, 1040187392
    s_mov_b32 exec_hi, 0
    v_mov_b32 v203, s54
    s_mov_b32 s54, 330320603
    s_cselect_b32 s54, 743654643, s54
    s_mov_b32 exec_lo, 3221225472
    s_mov_b32 exec_hi, 7
    v_mov_b32 v203, s54
    s_mov_b32 s54, 217139484
    s_cselect_b32 s54, 607143691, s54
    s_mov_b32 exec_lo, 0
    s_mov_b32 exec_hi, 248
    v_mov_b32 v203, s54
    s_mov_b64 exec, -1
    v_mul_u32_u24 v11, 52, v1
    v_lshrrev_b32 v11, 8, v11
    v_mad_i32_i24 v11, v11, -5, v1
    v_mul_u32_u24 v11, 6, v11
    v_lshrrev_b32 v203, v11, v203
    v_and_b32 v11, 7, v203
    v_bfe_u32 v203, v203, 3, 3
    v_lshlrev_b32 v11, 12, v11
    v_lshl_or_b32 v203, v203, 7, v11
    s_add_u32 s24, s14, 1048576
    s_addc_u32 s25, s15, 0
    s_mov_b32 s26, 3932160
    s_mov_b32 s27, 0x20000
    v_mov_b32 v16, 0
    v_mov_b32 v17, 0
    v_mov_b32 v18, 0
    v_mov_b32 v19, 0
    v_mov_b32 v20, 0
    v_mov_b32 v21, 0
    v_mov_b32 v22, 0
    v_mov_b32 v23, 0
    v_mov_b32 v24, 0
    v_mov_b32 v25, 0
    v_mov_b32 v26, 0
    v_mov_b32 v27, 0
    v_mov_b32 v28, 0
    v_mov_b32 v29, 0
    v_mov_b32 v30, 0
    v_mov_b32 v31, 0
    v_mov_b32 v32, 0
    v_mov_b32 v33, 0
    v_mov_b32 v34, 0
    v_mov_b32 v35, 0
    v_mov_b32 v36, 0
    v_mov_b32 v37, 0
    v_mov_b32 v38, 0
    v_mov_b32 v39, 0
    v_mov_b32 v40, 0
    v_mov_b32 v41, 0
    v_mov_b32 v42, 0
    v_mov_b32 v43, 0
    v_mov_b32 v44, 0
    v_mov_b32 v45, 0
    v_mov_b32 v46, 0
    v_mov_b32 v47, 0
    v_mov_b32 v48, 0
    v_mov_b32 v49, 0
    v_mov_b32 v50, 0
    v_mov_b32 v51, 0
    v_mov_b32 v52, 0
    v_mov_b32 v53, 0
    v_mov_b32 v54, 0
    v_mov_b32 v55, 0
    v_mov_b32 v56, 0
    v_mov_b32 v57, 0
    v_mov_b32 v58, 0
    v_mov_b32 v59, 0
    v_mov_b32 v60, 0
    v_mov_b32 v61, 0
    v_mov_b32 v62, 0
    v_mov_b32 v63, 0
    s_lshl_b32 s54, s2, 3
    s_add_u32 s54, s54, s3
    s_lshl_b32 s54, s54, 8
    s_mov_b32 s16, s64
    s_mov_b32 s17, s65
    s_mov_b32 s18, 10240000
    s_mov_b32 s19, 0x20000
    s_add_u32 s28, s14, 5242880
    s_addc_u32 s29, s15, 0
    s_mov_b32 s30, 10485760
    s_mov_b32 s31, 0x20000
    s_and_b32 s51, s86, 7
    s_mul_i32 s51, s51, 1282048
    s_and_b32 s55, s2, 0xf8
    s_add_u32 s55, s55, s3
    s_mul_i32 s55, s55, 2304
    s_add_u32 s51, s51, s55
    v_min_u32 v14, 17, v1
    v_lshlrev_b32 v14, 7, v14
    s_waitcnt vmcnt(0)
    s_barrier
    s_mov_b64 exec, 0xffff
    buffer_store_dwordx4 v[112:115], v2, s[20:23], s54 offen sc1
    s_mov_b64 exec, -1
    buffer_load_dword v7, v14, s[16:19], s51 offen
    s_lshl_b32 s54, s45, 10
    s_add_u32 s40, s12, s54
    s_addc_u32 s41, s13, 0
    s_lshl_b32 s42, s46, 10
    s_mov_b32 s43, 0x20000
    v_lshrrev_b32 v8, 5, v1
    v_lshlrev_b32 v8, 10, v8
    v_and_b32 v9, 15, v1
    v_lshl_add_u32 v8, v9, 4, v8
    ds_read_b128 v[64:67], v8 offset:17408
    ds_read_b128 v[68:71], v8 offset:17664
    ds_read_b128 v[72:75], v8 offset:17920
    ds_read_b128 v[76:79], v8 offset:18176
    ds_read_b128 v[80:83], v8 offset:19456
    ds_read_b128 v[84:87], v8 offset:19712
    ds_read_b128 v[88:91], v8 offset:19968
    ds_read_b128 v[92:95], v8 offset:20224
    v_lshrrev_b32 v8, 4, v1
    v_lshlrev_b32 v8, 5, v8
    v_and_b32 v9, 3, v1
    v_lshl_add_u32 v8, v9, 1, v8
    ds_read_u16 v96, v8 offset:21504
    ds_read_u16 v97, v8 offset:21512
    ds_read_u16 v98, v8 offset:21520
    ds_read_u16 v99, v8 offset:21528
    v_bfe_i32 v10, v1, 4, 1
    v_and_b32 v10, 0x02020202, v10
    v_add_u32 v10, 0x05040100, v10
    s_waitcnt lgkmcnt(0)
    v_perm_b32 v172, v68, v64, v10
    v_perm_b32 v174, v76, v72, v10
    v_perm_b32 v176, v84, v80, v10
    v_perm_b32 v178, v92, v88, v10
    v_perm_b32 v173, v69, v65, v10
    v_perm_b32 v175, v77, v73, v10
    v_perm_b32 v177, v85, v81, v10
    v_perm_b32 v179, v93, v89, v10
    v_perm_b32 v180, v70, v66, v10
    v_perm_b32 v182, v78, v74, v10
    v_perm_b32 v184, v86, v82, v10
    v_perm_b32 v186, v94, v90, v10
    v_perm_b32 v181, v71, v67, v10
    v_perm_b32 v183, v79, v75, v10
    v_perm_b32 v185, v87, v83, v10
    v_perm_b32 v187, v95, v91, v10
    v_lshl_or_b32 v188, v97, 16, v96
    v_lshl_or_b32 v189, v99, 16, v98
    v_and_b32 v9, 7, v1
    v_lshrrev_b32 v8, 4, v1
    v_lshlrev_b32 v8, 13, v8
    v_lshl_add_u32 v8, v9, 4, v8
    v_and_b32 v9, 8, v1
    s_and_b32 s72, s3, 3
    s_lshl_b32 s72, s72, 8
    s_lshr_b32 s73, s3, 2
    s_lshl_b32 s73, s73, 7
    s_add_u32 s72, s72, s73
    s_add_u32 s72, s72, 46080
    v_add3_u32 v8, v8, v9, s72
    ds_read2st64_b64 v[128:131], v8 offset0:0 offset1:2
    ds_read2st64_b64 v[132:135], v8 offset0:4 offset1:6
    ds_read2st64_b64 v[136:139], v8 offset0:8 offset1:10
    ds_read2st64_b64 v[140:143], v8 offset0:12 offset1:14
    s_mov_b32 s72, 0x05040100
    s_mov_b32 s73, 0x07060302
    s_waitcnt lgkmcnt(3)
    v_perm_b32 v144, v130, v128, s72
    v_perm_b32 v148, v130, v128, s73
    v_perm_b32 v152, v131, v129, s72
    v_perm_b32 v156, v131, v129, s73
    s_waitcnt lgkmcnt(2)
    v_perm_b32 v145, v134, v132, s72
    v_perm_b32 v149, v134, v132, s73
    v_perm_b32 v153, v135, v133, s72
    v_perm_b32 v157, v135, v133, s73
    s_waitcnt lgkmcnt(1)
    v_perm_b32 v146, v138, v136, s72
    v_perm_b32 v150, v138, v136, s73
    v_perm_b32 v154, v139, v137, s72
    v_perm_b32 v158, v139, v137, s73
    s_waitcnt lgkmcnt(0)
    v_perm_b32 v147, v142, v140, s72
    v_perm_b32 v151, v142, v140, s73
    v_perm_b32 v155, v143, v141, s72
    v_perm_b32 v159, v143, v141, s73
    v_mov_b32 v64, 0
    v_mov_b32 v65, 0
    v_mov_b32 v66, 0
    v_mov_b32 v67, 0
    v_mov_b32 v68, 0
    v_mov_b32 v69, 0
    v_mov_b32 v70, 0
    v_mov_b32 v71, 0
    v_mov_b32 v72, 0
    v_mov_b32 v73, 0
    v_mov_b32 v74, 0
    v_mov_b32 v75, 0
    v_mov_b32 v76, 0
    v_mov_b32 v77, 0
    v_mov_b32 v78, 0
    v_mov_b32 v79, 0
    v_mov_b32 v80, 0
    v_mov_b32 v81, 0
    v_mov_b32 v82, 0
    v_mov_b32 v83, 0
    v_mov_b32 v84, 0
    v_mov_b32 v85, 0
    v_mov_b32 v86, 0
    v_mov_b32 v87, 0
    v_mov_b32 v88, 0
    v_mov_b32 v89, 0
    v_mov_b32 v90, 0
    v_mov_b32 v91, 0
    v_mov_b32 v92, 0
    v_mov_b32 v93, 0
    v_mov_b32 v94, 0
    v_mov_b32 v95, 0
    s_lshl_b32 s54, s3, 12
    v_add_u32 v8, s54, v2
    v_lshrrev_b32 v9, 1, v0
    v_lshlrev_b32 v10, 11, v9
    s_lshl_b32 s49, s44, 3
    v_mul_u32_u24 v5, 1280, v9
    s_mov_b32 s48, 0
    s_mov_b32 s53, 200000
    s_mov_b32 s55, 0xffc00000
    s_mul_i32 s52, s3, 7168
    s_add_u32 s52, s52, 101376
    s_movk_i32 s98, 4096
    s_waitcnt vmcnt(0)
    s_barrier
    buffer_load_dwordx2 v[206:207], v10, s[20:23], s49 offen sc1
    ds_write_b128 v8, v[144:147] offset:46080
    ds_write_b128 v8, v[148:151] offset:47104
    ds_write_b128 v8, v[152:155] offset:48128
    ds_write_b128 v8, v[156:159] offset:49152
    s_waitcnt vmcnt(0)
    v_xor_b32 v11, s63, v206
    v_xor_b32 v12, s62, v207
    v_and_or_b32 v11, v11, s55, v12
    v_cmpx_ne_u32 vcc, 0, v11
    s_cbranch_execnz L_poll
L_polled:
    s_mov_b64 exec, -1
    v_bfe_u32 v3, v206, 11, 11
    v_and_b32 v4, v3, v240
    v_add_u32 v10, v3, v240
    v_and_b32 v11, 0x7ff, v206
    v_add_u32_dpp v4, v4, v4 row_shr:1 row_mask:0xf bank_mask:0xf
    v_cmp_lt_i32 s[64:65], 0, v10
    v_cmp_lt_i32 s[66:67], 2, v10
    v_add_u32_dpp v4, v4, v4 row_shr:2 row_mask:0xf bank_mask:0xf
    v_cmp_lt_i32 s[68:69], 4, v10
    v_cmp_lt_i32 s[70:71], 6, v10
    v_add_u32_dpp v4, v4, v4 row_shr:4 row_mask:0xf bank_mask:0xf
    v_cmp_lt_i32 s[72:73], 8, v10
    v_cmp_lt_i32 s[74:75], 10, v10
    v_add_u32_dpp v4, v4, v4 row_shr:8 row_mask:0xf bank_mask:0xf
    v_cmp_lt_i32 s[76:77], 12, v10
    v_cmp_lt_i32 s[78:79], 14, v10
    v_add_u32_dpp v4, v4, v4 row_bcast:15 row_mask:0xa bank_mask:0xf
    v_add_u32 v5, v5, v11
    s_nop 0
    v_add_u32_dpp v4, v4, v4 row_bcast:31 row_mask:0xc bank_mask:0xf
    s_nop 0
    v_readlane_b32 s95, v4, 63
    v_mov_b32_dpp v4, v4 quad_perm:[0,0,2,2] row_mask:0xf bank_mask:0xf
    v_sub_u32 v5, v5, v4
    v_lshl_add_u32 v8, v4, 2, v241
    s_cmp_gt_u32 s95, 224
    s_cbranch_scc1 L_clip
L_mapw:
    s_mov_b64 exec, s[64:65]
    ds_write_b32 v8, v5 offset:0
    s_mov_b64 exec, s[66:67]
    ds_write_b32 v8, v5 offset:8
    s_mov_b64 exec, s[68:69]
    ds_write_b32 v8, v5 offset:16
    s_mov_b64 exec, s[70:71]
    ds_write_b32 v8, v5 offset:24
    s_mov_b64 exec, s[72:73]
    ds_write_b32 v8, v5 offset:32
    s_mov_b64 exec, s[74:75]
    ds_write_b32 v8, v5 offset:40
    s_mov_b64 exec, s[76:77]
    ds_write_b32 v8, v5 offset:48
    s_mov_b64 exec, -1
    s_cmp_lg_u64 s[78:79], 0
    s_cbranch_scc1 L_map2
    ds_read_b32 v136, v242 offset:0
    ds_read_b32 v137, v242 offset:256
    ds_read_b32 v138, v242 offset:512
    ds_read_b32 v140, v243 offset:0
    ds_read_b32 v141, v243 offset:128
    ds_read_b32 v142, v243 offset:256
    ds_read_b32 v143, v243 offset:384
    ds_read_b32 v144, v243 offset:512
    ds_read_b32 v145, v243 offset:640
    s_cmp_gt_i32 s95, 192
    s_cbranch_scc1 L_r1
L_r1b:
    s_waitcnt lgkmcnt(6)
    v_mad_u32_u24 v136, v136, 12, v244
    buffer_load_dwordx3 v[148:150], v136, s[24:27], 0 offen offset:0 sc1
    v_mad_u32_u24 v137, v137, 12, v244
    buffer_load_dwordx3 v[152:154], v137, s[24:27], 0 offen offset:768 sc1
    v_mad_u32_u24 v138, v138, 12, v244
    buffer_load_dwordx3 v[156:158], v138, s[24:27], 0 offen offset:1536 sc1
    v_mov_b32 v11, s95
    s_mov_b64 exec, 1
    ds_max_i32 v13, v11 offset:15360
    s_mov_b64 exec, -1
    s_waitcnt lgkmcnt(1)
    v_lshl_add_u32 v140, v140, 5, v2
    v_lshl_add_u32 v141, v141, 5, v2
    v_lshl_add_u32 v142, v142, 5, v2
    v_lshl_add_u32 v143, v143, 5, v2
    v_lshl_add_u32 v144, v144, 5, v2
    v_lshl_add_u32 v145, v145, 5, v2
    s_barrier
    s_add_u32 m0, s52, 0
    s_nop 0
    buffer_load_dwordx4 v140, s[28:31], 0 offen offset:0 sc1 lds
    s_min_i32 s54, s95, 224
    v_cmp_gt_i32 s[80:81], s54, v1
    s_sub_i32 s54, s54, 64
    v_cmp_gt_i32 s[82:83], s54, v1
    s_sub_i32 s54, s54, 64
    v_cmp_gt_i32 s[84:85], s54, v1
    s_sub_i32 s54, s54, 64
    v_cmp_gt_i32 s[96:97], s54, v1
    s_sub_i32 s54, s54, 64
    s_mov_b32 s55, 0x1fff80
    s_mul_i32 s61, s3, 5
    ds_read_b128 v[216:219], v215 offset:0
    ds_read_b128 v[220:223], v215 offset:1024
    ds_read_b128 v[224:227], v215 offset:2048
    ds_read_b128 v[228:231], v215 offset:3072
    ds_read_b128 v[232:235], v215 offset:4096
    ds_read_b128 v[236:239], v215 offset:5120
    s_waitcnt vmcnt(3)
    v_lshrrev_b32 v132, 21, v150
    v_lshlrev_b32 v132, 2, v132
    v_lshrrev_b32 v11, 26, v150
    v_lshl_or_b32 v11, v11, 4, v245
    s_mov_b64 exec, s[80:81]
    ds_add_rtn_u32 v128, v132, v6 offset:8192
    ds_add_u32 v11, v6 offset:14336
    s_mov_b64 exec, -1
    s_waitcnt vmcnt(2)
    v_lshrrev_b32 v133, 21, v154
    v_lshlrev_b32 v133, 2, v133
    v_lshrrev_b32 v11, 26, v154
    v_lshl_or_b32 v11, v11, 4, v245
    s_mov_b64 exec, s[82:83]
    ds_add_rtn_u32 v129, v133, v6 offset:8192
    ds_add_u32 v11, v6 offset:14336
    s_mov_b64 exec, -1
    s_waitcnt vmcnt(1)
    v_lshrrev_b32 v134, 21, v158
    v_lshlrev_b32 v134, 2, v134
    v_lshrrev_b32 v11, 26, v158
    v_lshl_or_b32 v11, v11, 4, v245
    s_mov_b64 exec, s[84:85]
    ds_add_rtn_u32 v130, v134, v6 offset:8192
    ds_add_u32 v11, v6 offset:14336
    s_mov_b64 exec, -1
    s_cmp_gt_i32 s95, 192
    s_cbranch_scc1 L_r2
L_r2b:
    ds_write_b64 v246, v[148:149] offset:0
    v_and_or_b32 v150, v150, s55, v247
    ds_write_b64 v246, v[152:153] offset:512
    v_and_or_b32 v154, v154, s55, v247
    v_add_u32 v154, 134217728, v154
    ds_write_b64 v246, v[156:157] offset:1024
    v_and_or_b32 v158, v158, s55, v247
    v_add_u32 v158, 268435456, v158
    buffer_load_dwordx4 v141, s[28:31], 0 offen offset:1024 sc1 lds
    buffer_load_dwordx4 v142, s[28:31], 0 offen offset:2048 sc1 lds
    s_waitcnt lgkmcnt(3)
    s_barrier
    s_cmp_lg_u32 s48, 0
    s_cbranch_scc1 L_rank2
    ds_read_b128 v[104:107], v2 offset:14336
    ds_read_b32 v96, v248 offset:8192
    ds_read_b32 v97, v248 offset:8320
    ds_read_b32 v98, v248 offset:8448
    ds_read_b32 v99, v248 offset:8576
    ds_read_b32 v100, v248 offset:8704
    ds_read_b32 v14, v13 offset:15360
    s_add_u32 s65, s61, 1
    s_add_u32 s66, s61, 2
    s_add_u32 s67, s61, 3
    s_add_u32 s68, s61, 4
    s_waitcnt lgkmcnt(6)
    v_add_u32 v9, v104, v105
    v_add3_u32 v9, v9, v106, v107
    v_lshl_or_b32 v9, v9, 6, v249
    s_nop 0
    v_readlane_b32 s64, v9, s61
    v_readlane_b32 s65, v9, s65
    v_readlane_b32 s66, v9, s66
    v_readlane_b32 s67, v9, s67
    v_readlane_b32 s68, v9, s68
    v_cmp_lt_u32 s[70:71], s64, v9
    v_cmp_lt_u32 s[72:73], s65, v9
    v_cmp_lt_u32 s[74:75], s66, v9
    v_cmp_lt_u32 s[76:77], s67, v9
    v_cmp_lt_u32 s[78:79], s68, v9
    s_bcnt1_i32_b64 s64, s[70:71]
    s_bcnt1_i32_b64 s65, s[72:73]
    s_bcnt1_i32_b64 s66, s[74:75]
    s_bcnt1_i32_b64 s67, s[76:77]
    s_bcnt1_i32_b64 s68, s[78:79]
    s_waitcnt lgkmcnt(0)
    v_readlane_b32 s90, v203, s64
    v_readlane_b32 s91, v203, s65
    v_readlane_b32 s92, v203, s66
    v_readlane_b32 s93, v203, s67
    v_readlane_b32 s94, v203, s68
    v_readfirstlane_b32 s47, v14
L_ranked:
    s_mov_b32 exec_hi, 0
    s_and_b32 s54, s90, 0x380
    v_add_u32 v104, s54, v250
    ds_add_rtn_u32 v96, v104, v96 offset:13312
    s_and_b32 s54, s91, 0x380
    v_add_u32 v105, s54, v250
    ds_add_rtn_u32 v97, v105, v97 offset:13312
    s_and_b32 s54, s92, 0x380
    v_add_u32 v106, s54, v250
    ds_add_rtn_u32 v98, v106, v98 offset:13312
    s_and_b32 s54, s93, 0x380
    v_add_u32 v107, s54, v250
    ds_add_rtn_u32 v99, v107, v99 offset:13312
    s_and_b32 s54, s94, 0x380
    v_add_u32 v108, s54, v250
    ds_add_rtn_u32 v100, v108, v100 offset:13312
    v_or_b32 v104, s90, v104
    v_or_b32 v105, s91, v105
    v_or_b32 v106, s92, v106
    v_or_b32 v107, s93, v107
    v_or_b32 v108, s94, v108
    v_writelane_b32 v11, s90, 0
    v_writelane_b32 v11, s91, 1
    v_writelane_b32 v11, s92, 2
    v_writelane_b32 v11, s93, 3
    v_writelane_b32 v11, s94, 4
    s_waitcnt lgkmcnt(4)
    v_lshl_or_b32 v96, v96, 16, v104
    ds_write_b32 v248, v96 offset:8192
    s_waitcnt lgkmcnt(4)
    v_lshl_or_b32 v97, v97, 16, v105
    ds_write_b32 v248, v97 offset:8320
    s_waitcnt lgkmcnt(4)
    v_lshl_or_b32 v98, v98, 16, v106
    ds_write_b32 v248, v98 offset:8448
    s_waitcnt lgkmcnt(4)
    v_lshl_or_b32 v99, v99, 16, v107
    ds_write_b32 v248, v99 offset:8576
    s_waitcnt lgkmcnt(4)
    v_lshl_or_b32 v100, v100, 16, v108
    ds_write_b32 v248, v100 offset:8704
    v_add_lshl_u32 v12, v1, s61, 7
    v_lshrrev_b32 v9, 10, v11
    v_bfe_u32 v11, v11, 2, 8
    v_or_b32 v11, v11, v9
    s_mov_b32 exec_lo, 31
    ds_write_b32 v11, v12 offset:15616
    s_mov_b64 exec, -1
    buffer_load_dwordx4 v143, s[28:31], 0 offen offset:3072 sc1 lds
    s_add_u32 m0, s52, 4096
    s_nop 0
    buffer_load_dwordx4 v144, s[28:31], s98 offen offset:0 sc1 lds
    s_lshl_b32 s54, s3, 3
    s_add_u32 s55, s54, 7
    s_waitcnt lgkmcnt(0)
    s_barrier
    ds_read_b128 v[96:99], v2 offset:13312
    ds_read_b32 v132, v132 offset:8192
    ds_read_b32 v133, v133 offset:8192
    ds_read_b32 v134, v134 offset:8192
    ds_read_b32 v205, v251 offset:15616
    s_waitcnt lgkmcnt(4)
    v_add_u32 v9, v96, v97
    v_add3_u32 v9, v9, v98, v99
    v_mov_b32 v10, v9
    s_waitcnt lgkmcnt(1)
    v_bfe_u32 v15, v132, 12, 3
    v_add_u32_dpp v10, v10, v10 row_shr:1 row_mask:0xf bank_mask:0xf
    v_or_b32 v150, v15, v150
    v_and_b32 v136, 0x3ff, v132
    v_add_u32_dpp v10, v10, v10 row_shr:2 row_mask:0xf bank_mask:0xf
    v_lshrrev_b32 v132, 16, v132
    v_add_u32 v132, v132, v128
    v_add_u32_dpp v10, v10, v10 row_shr:4 row_mask:0xf bank_mask:0xf
    v_bfe_u32 v15, v133, 12, 3
    v_or_b32 v154, v15, v154
    v_add_u32_dpp v10, v10, v10 row_shr:8 row_mask:0xf bank_mask:0xf
    v_and_b32 v137, 0x3ff, v133
    v_lshrrev_b32 v133, 16, v133
    v_add_u32_dpp v10, v10, v10 row_bcast:15 row_mask:0xa bank_mask:0xf
    v_add_u32 v133, v133, v129
    v_bfe_u32 v15, v134, 12, 3
    v_add_u32_dpp v10, v10, v10 row_bcast:31 row_mask:0xc bank_mask:0xf
    v_or_b32 v158, v15, v158
    v_and_b32 v138, 0x3ff, v134
    v_sub_u32 v9, v10, v9
    v_lshl_add_u32 v104, v9, 2, v252
    v_lshl_add_u32 v105, v96, 2, v104
    v_lshl_add_u32 v106, v97, 2, v105
    v_lshl_add_u32 v107, v98, 2, v106
    ds_write_b128 v2, v[104:107] offset:16384
    ds_read_b32 v136, v136 offset:16384
    ds_read_b32 v137, v137 offset:16384
    ds_read_b32 v138, v138 offset:16384
    v_lshrrev_b32 v134, 16, v134
    v_add_u32 v134, v134, v130
    v_readlane_b32 s50, v10, s55
    v_readlane_b32 s53, v9, s54
    v_readlane_b32 s51, v104, s54
    v_mov_b32 v12, 2097029
    s_sub_u32 s50, s50, s53
    s_lshl_b32 s54, s50, 2
    v_add_u32 v198, s51, v201
    v_add_u32 v199, s51, v202
    v_add_u32 v9, s54, v198
    s_waitcnt lgkmcnt(2)
    v_lshl_add_u32 v132, v132, 2, v136
    s_mov_b64 exec, s[80:81]
    ds_write_b32 v132, v150
    s_mov_b64 exec, -1
    s_waitcnt lgkmcnt(2)
    v_lshl_add_u32 v133, v133, 2, v137
    s_mov_b64 exec, s[82:83]
    ds_write_b32 v133, v154
    s_mov_b64 exec, -1
    s_waitcnt lgkmcnt(2)
    v_lshl_add_u32 v134, v134, 2, v138
    s_mov_b64 exec, s[84:85]
    ds_write_b32 v134, v158
    s_mov_b64 exec, -1
    ds_write_b32 v9, v12
    s_cmp_gt_i32 s95, 192
    s_cbranch_scc1 L_r3
L_r3b:
    buffer_load_dwordx4 v145, s[28:31], s98 offen offset:1024 sc1 lds
    s_add_u32 s54, s50, 1
    s_and_b32 s54, s54, -2
    s_add_u32 s53, s54, 15
    s_lshr_b32 s53, s53, 4
    s_sub_u32 s54, 0, s54
    s_and_b32 s54, s54, 15
    s_sub_u32 s53, s53, 1
    s_cmp_gt_i32 s53, 0
    s_cselect_b32 s54, s54, 0
    s_lshl_b32 s61, s54, 2
    v_subrev_u32 v198, s61, v198
    v_subrev_u32 v199, s61, v199
    s_and_b32 s61, s61, 32
    v_add_u32 v12, s61, v198
    s_and_b32 s72, s54, 6
    s_mov_b32 s55, 0x00fffc38
    s_mov_b32 s49, 0xffffff00
    s_mov_b32 s51, 87040
    s_cmp_lt_u32 s3, 4
    s_cbranch_scc1 L_np
    s_setprio 1
L_np:
    s_waitcnt lgkmcnt(0)
    s_barrier
    ds_read_b32 v196, v12
    ds_read_b32 v194, v199
    ds_read_b32 v197, v198 offset:24
    s_cmp_eq_u32 s50, 0
    s_cbranch_scc1 L_empty
    s_waitcnt lgkmcnt(1)
    v_lshlrev_b32 v196, 3, v196
    v_and_b32 v196, s55, v196
    s_cmp_eq_u32 s72, 2
    s_cbranch_scc1 L_p2
    s_cmp_eq_u32 s72, 4
    s_cbranch_scc1 L_p4
    s_cmp_eq_u32 s72, 6
    s_cbranch_scc1 L_p6
L_p0:
    v_readlane_b32 s64, v196, 0
    v_readlane_b32 s65, v196, 1
    s_and_b32 s61, s64, s49
    buffer_load_dwordx4 v[96:99], v2, s[16:19], s61 offen
    s_and_b32 s61, s65, s49
    buffer_load_dwordx4 v[100:103], v2, s[16:19], s61 offen
L_p2:
    v_readlane_b32 s66, v196, 2
    v_readlane_b32 s67, v196, 3
    s_and_b32 s61, s66, s49
    buffer_load_dwordx4 v[104:107], v2, s[16:19], s61 offen
    s_and_b32 s61, s67, s49
    buffer_load_dwordx4 v[108:111], v2, s[16:19], s61 offen
L_p4:
    v_readlane_b32 s68, v196, 4
    v_readlane_b32 s69, v196, 5
    s_and_b32 s61, s68, s49
    buffer_load_dwordx4 v[112:115], v2, s[16:19], s61 offen
    s_and_b32 s61, s69, s49
    buffer_load_dwordx4 v[116:119], v2, s[16:19], s61 offen
    s_cmp_eq_u32 s72, 0
    s_cbranch_scc1 L_pd
L_p6:
    v_readlane_b32 s70, v196, 6
    v_readlane_b32 s71, v196, 7
    s_and_b32 s61, s70, s49
    buffer_load_dwordx4 v[120:123], v2, s[16:19], s61 offen
    s_and_b32 s61, s71, s49
    buffer_load_dwordx4 v[124:127], v2, s[16:19], s61 offen
    s_cmp_eq_u32 s72, 2
    s_cbranch_scc1 L_pd
L_p8:
    v_readlane_b32 s64, v196, 8
    v_readlane_b32 s65, v196, 9
    s_and_b32 s61, s64, s49
    buffer_load_dwordx4 v[96:99], v2, s[16:19], s61 offen
    s_and_b32 s61, s65, s49
    buffer_load_dwordx4 v[100:103], v2, s[16:19], s61 offen
    s_cmp_eq_u32 s72, 4
    s_cbranch_scc1 L_pd
L_p10:
    v_readlane_b32 s66, v196, 10
    v_readlane_b32 s67, v196, 11
    s_and_b32 s61, s66, s49
    buffer_load_dwordx4 v[104:107], v2, s[16:19], s61 offen
    s_and_b32 s61, s67, s49
    buffer_load_dwordx4 v[108:111], v2, s[16:19], s61 offen
L_pd:
    v_mul_u32_u24 v205, 9, v205
    v_lshlrev_b32 v12, 2, v1
    v_readlane_b32 s56, v205, 0
    v_readlane_b32 s57, v205, 1
    v_readlane_b32 s58, v205, 2
    v_readlane_b32 s59, v205, 3
    v_readlane_b32 s60, v205, 4
    v_add_u32 v208, s56, v12
    v_add_u32 v209, s57, v12
    v_add_u32 v210, s58, v12
    v_add_u32 v211, s59, v12
    v_add_u32 v212, s60, v12
    s_waitcnt vmcnt(6)
    s_barrier
    v_lshrrev_b32 v8, 21, v194
    v_lshl_add_u32 v11, v8, 3, s51
    v_lshl_add_u32 v8, v8, 5, v200
    ds_read_b64 v[192:193], v11
    ds_read_b128 v[164:167], v8
    s_waitcnt lgkmcnt(0)
.p2align 3
    v_mfma_f32_4x4x4_16b_bf16 v[144:147], v[192:193], v[188:189], 0 cbsz:4 abid:0
    v_mfma_f32_4x4x4_16b_bf16 v[148:151], v[192:193], v[188:189], 0 cbsz:4 abid:2
    v_mfma_f32_4x4x4_16b_bf16 v[152:155], v[192:193], v[188:189], 0 cbsz:4 abid:4
    v_mfma_f32_4x4x4_16b_bf16 v[156:159], v[192:193], v[188:189], 0 cbsz:4 abid:6
    v_lshlrev_b32 v196, 3, v197
    v_and_b32 v196, s55, v196
    v_add_u32 v198, 64, v198
    v_add_u32 v199, 64, v199
    v_smfmac_f32_32x32x32_bf16 v[64:79], v[164:167], v[172:179], v168
    ds_read_b32 v197, v198 offset:24
    ds_read_b32 v194, v199
    v_smfmac_f32_32x32x32_bf16 v[80:95], v[164:167], v[180:187], v168
    s_set_gpr_idx_on s54, gpr_idx(SRC0,SRC1)
    v_cvt_pk_bf16_f32 v9, v144, v144
    s_set_gpr_idx_off
    v_and_b32 v160, v190, v9
    v_and_b32 v161, v191, v9
    s_waitcnt lgkmcnt(0)
    v_lshrrev_b32 v8, 21, v194
    v_lshl_add_u32 v11, v8, 3, s51
    v_lshl_add_u32 v8, v8, 5, v200
    ds_read_b64 v[192:193], v11
    ds_read_b128 v[164:167], v8
    s_cmp_eq_u32 s53, 0
    s_cbranch_scc1 L_f0
    s_cmp_eq_u32 s54, 0
    s_cbranch_scc1 L_j0
    s_cmp_eq_u32 s54, 2
    s_cbranch_scc1 L_j2
    ds_read_b128 v[64:67], v169
    ds_read_b128 v[80:83], v169
    s_cmp_eq_u32 s54, 4
    s_cbranch_scc1 L_j4
    s_cmp_eq_u32 s54, 6
    s_cbranch_scc1 L_j6
    ds_read_b128 v[68:71], v169
    ds_read_b128 v[84:87], v169
    s_cmp_eq_u32 s54, 8
    s_cbranch_scc1 L_j8
    s_cmp_eq_u32 s54, 10
    s_cbranch_scc1 L_j10
    ds_read_b128 v[72:75], v169
    ds_read_b128 v[88:91], v169
    s_cmp_eq_u32 s54, 12
    s_cbranch_scc1 L_j12
    s_branch L_j14
.p2align 3
L_loop:
    s_waitcnt lgkmcnt(2)
.p2align 3
    v_mfma_f32_4x4x4_16b_bf16 v[144:147], v[192:193], v[188:189], 0 cbsz:4 abid:0
    v_mfma_f32_4x4x4_16b_bf16 v[148:151], v[192:193], v[188:189], 0 cbsz:4 abid:2
    v_mfma_f32_4x4x4_16b_bf16 v[152:155], v[192:193], v[188:189], 0 cbsz:4 abid:4
    v_mfma_f32_4x4x4_16b_bf16 v[156:159], v[192:193], v[188:189], 0 cbsz:4 abid:6
    v_lshlrev_b32 v196, 3, v197
    v_and_b32 v196, s55, v196
    v_add_u32 v198, 64, v198
    v_add_u32 v199, 64, v199
    s_waitcnt lgkmcnt(0)
.p2align 3
    v_smfmac_f32_32x32x32_bf16 v[64:79], v[164:167], v[172:179], v168
    ds_read_b32 v197, v198 offset:24
    ds_read_b32 v194, v199
    v_cvt_pk_bf16_f32 v9, v144, v144
    v_and_b32 v160, v190, v9
    v_and_b32 v161, v191, v9
    v_smfmac_f32_32x32x32_bf16 v[80:95], v[164:167], v[180:187], v168
L_j0:
    s_waitcnt vmcnt(5)
.p2align 3
    v_mfma_f32_16x16x16_bf16 v[128:131], v[160:161], v[96:97], 0
    v_readlane_b32 s70, v196, 0
    v_cvt_pk_bf16_f32 v10, v145, v145
    v_mfma_f32_16x16x16_bf16 v[132:135], v[160:161], v[98:99], 0
    v_and_b32 v162, v190, v10
    v_and_b32 v163, v191, v10
    s_and_b32 s61, s70, s49
    s_waitcnt vmcnt(4)
    buffer_load_dwordx4 v[120:123], v2, s[16:19], s61 offen
    v_mfma_f32_16x16x16_bf16 v[136:139], v[162:163], v[100:101], 0
    v_readlane_b32 s71, v196, 1
    v_cvt_pk_bf16_f32 v9, v146, v146
    v_mfma_f32_16x16x16_bf16 v[140:143], v[162:163], v[102:103], 0
    v_and_b32 v160, v190, v9
    v_and_b32 v161, v191, v9
    s_and_b32 s61, s71, s49
    s_set_gpr_idx_on s64, gpr_idx(SRC2,DST)
    buffer_load_dwordx4 v[124:127], v2, s[16:19], s61 offen
    v_pk_fma_f32 v[16:17], v[128:129], v[64:65], v[16:17] op_sel_hi:[1,0,1]
    v_pk_fma_f32 v[18:19], v[130:131], v[64:65], v[18:19] op_sel_hi:[1,0,1]
    v_pk_fma_f32 v[20:21], v[132:133], v[80:81], v[20:21] op_sel_hi:[1,0,1]
    v_pk_fma_f32 v[22:23], v[134:135], v[80:81], v[22:23] op_sel_hi:[1,0,1]
    s_set_gpr_idx_idx s65
.p2align 3
    v_pk_fma_f32 v[16:17], v[136:137], v[64:65], v[16:17] op_sel:[0,1,0] op_sel_hi:[1,1,1]
    v_pk_fma_f32 v[18:19], v[138:139], v[64:65], v[18:19] op_sel:[0,1,0] op_sel_hi:[1,1,1]
    v_pk_fma_f32 v[20:21], v[140:141], v[80:81], v[20:21] op_sel:[0,1,0] op_sel_hi:[1,1,1]
    v_pk_fma_f32 v[22:23], v[142:143], v[80:81], v[22:23] op_sel:[0,1,0] op_sel_hi:[1,1,1]
    s_set_gpr_idx_off
L_j2:
    s_waitcnt vmcnt(5)
.p2align 3
    v_mfma_f32_16x16x16_bf16 v[128:131], v[160:161], v[104:105], 0
    v_readlane_b32 s64, v196, 2
    v_cvt_pk_bf16_f32 v10, v147, v147
    v_mfma_f32_16x16x16_bf16 v[132:135], v[160:161], v[106:107], 0
    v_and_b32 v162, v190, v10
    v_and_b32 v163, v191, v10
    s_and_b32 s61, s64, s49
    s_waitcnt vmcnt(4)
    buffer_load_dwordx4 v[96:99], v2, s[16:19], s61 offen
    v_mfma_f32_16x16x16_bf16 v[136:139], v[162:163], v[108:109], 0
    v_readlane_b32 s65, v196, 3
    v_cvt_pk_bf16_f32 v9, v148, v148
    v_mfma_f32_16x16x16_bf16 v[140:143], v[162:163], v[110:111], 0
    v_and_b32 v160, v190, v9
    v_and_b32 v161, v191, v9
    s_waitcnt lgkmcnt(0)
    v_lshrrev_b32 v8, 21, v194
    v_lshl_add_u32 v11, v8, 3, s51
    v_lshl_add_u32 v8, v8, 5, v200
    ds_read_b64 v[192:193], v11
    ds_read_b128 v[164:167], v8
.p2align 3
    s_and_b32 s61, s65, s49
    s_set_gpr_idx_on s66, gpr_idx(SRC2,DST)
    buffer_load_dwordx4 v[100:103], v2, s[16:19], s61 offen
    v_pk_fma_f32 v[16:17], v[128:129], v[66:67], v[16:17] op_sel_hi:[1,0,1]
    v_pk_fma_f32 v[18:19], v[130:131], v[66:67], v[18:19] op_sel_hi:[1,0,1]
    v_pk_fma_f32 v[20:21], v[132:133], v[82:83], v[20:21] op_sel_hi:[1,0,1]
    v_pk_fma_f32 v[22:23], v[134:135], v[82:83], v[22:23] op_sel_hi:[1,0,1]
    s_set_gpr_idx_idx s67
.p2align 3
    v_pk_fma_f32 v[16:17], v[136:137], v[66:67], v[16:17] op_sel:[0,1,0] op_sel_hi:[1,1,1]
    v_pk_fma_f32 v[18:19], v[138:139], v[66:67], v[18:19] op_sel:[0,1,0] op_sel_hi:[1,1,1]
    v_pk_fma_f32 v[20:21], v[140:141], v[82:83], v[20:21] op_sel:[0,1,0] op_sel_hi:[1,1,1]
    v_pk_fma_f32 v[22:23], v[142:143], v[82:83], v[22:23] op_sel:[0,1,0] op_sel_hi:[1,1,1]
    ds_read_b128 v[64:67], v169
    ds_read_b128 v[80:83], v169
    s_set_gpr_idx_off
L_j4:
    s_waitcnt vmcnt(5)
.p2align 3
    v_mfma_f32_16x16x16_bf16 v[128:131], v[160:161], v[112:113], 0
    v_readlane_b32 s66, v196, 4
    v_cvt_pk_bf16_f32 v10, v149, v149
    v_mfma_f32_16x16x16_bf16 v[132:135], v[160:161], v[114:115], 0
    v_and_b32 v162, v190, v10
    v_and_b32 v163, v191, v10
    s_and_b32 s61, s66, s49
    s_waitcnt vmcnt(4)
    buffer_load_dwordx4 v[104:107], v2, s[16:19], s61 offen
    v_mfma_f32_16x16x16_bf16 v[136:139], v[162:163], v[116:117], 0
    v_readlane_b32 s67, v196, 5
    v_cvt_pk_bf16_f32 v9, v150, v150
    v_mfma_f32_16x16x16_bf16 v[140:143], v[162:163], v[118:119], 0
    v_and_b32 v160, v190, v9
    v_and_b32 v161, v191, v9
    s_and_b32 s61, s67, s49
    s_set_gpr_idx_on s68, gpr_idx(SRC2,DST)
    buffer_load_dwordx4 v[108:111], v2, s[16:19], s61 offen
    v_pk_fma_f32 v[16:17], v[128:129], v[68:69], v[16:17] op_sel_hi:[1,0,1]
    v_pk_fma_f32 v[18:19], v[130:131], v[68:69], v[18:19] op_sel_hi:[1,0,1]
    v_pk_fma_f32 v[20:21], v[132:133], v[84:85], v[20:21] op_sel_hi:[1,0,1]
    v_pk_fma_f32 v[22:23], v[134:135], v[84:85], v[22:23] op_sel_hi:[1,0,1]
    s_set_gpr_idx_idx s69
.p2align 3
    v_pk_fma_f32 v[16:17], v[136:137], v[68:69], v[16:17] op_sel:[0,1,0] op_sel_hi:[1,1,1]
    v_pk_fma_f32 v[18:19], v[138:139], v[68:69], v[18:19] op_sel:[0,1,0] op_sel_hi:[1,1,1]
    v_pk_fma_f32 v[20:21], v[140:141], v[84:85], v[20:21] op_sel:[0,1,0] op_sel_hi:[1,1,1]
    v_pk_fma_f32 v[22:23], v[142:143], v[84:85], v[22:23] op_sel:[0,1,0] op_sel_hi:[1,1,1]
    s_set_gpr_idx_off
L_j6:
    s_waitcnt vmcnt(5)
.p2align 3
    v_mfma_f32_16x16x16_bf16 v[128:131], v[160:161], v[120:121], 0
    v_readlane_b32 s68, v196, 6
    v_cvt_pk_bf16_f32 v10, v151, v151
    v_mfma_f32_16x16x16_bf16 v[132:135], v[160:161], v[122:123], 0
    v_and_b32 v162, v190, v10
    v_and_b32 v163, v191, v10
    s_and_b32 s61, s68, s49
    s_waitcnt vmcnt(4)
    buffer_load_dwordx4 v[112:115], v2, s[16:19], s61 offen
    v_mfma_f32_16x16x16_bf16 v[136:139], v[162:163], v[124:125], 0
    v_readlane_b32 s69, v196, 7
    v_cvt_pk_bf16_f32 v9, v152, v152
    v_mfma_f32_16x16x16_bf16 v[140:143], v[162:163], v[126:127], 0
    v_and_b32 v160, v190, v9
    v_and_b32 v161, v191, v9
    s_and_b32 s61, s69, s49
    s_set_gpr_idx_on s70, gpr_idx(SRC2,DST)
    buffer_load_dwordx4 v[116:119], v2, s[16:19], s61 offen
    v_pk_fma_f32 v[16:17], v[128:129], v[70:71], v[16:17] op_sel_hi:[1,0,1]
    v_pk_fma_f32 v[18:19], v[130:131], v[70:71], v[18:19] op_sel_hi:[1,0,1]
    v_pk_fma_f32 v[20:21], v[132:133], v[86:87], v[20:21] op_sel_hi:[1,0,1]
    v_pk_fma_f32 v[22:23], v[134:135], v[86:87], v[22:23] op_sel_hi:[1,0,1]
    s_set_gpr_idx_idx s71
.p2align 3
    v_pk_fma_f32 v[16:17], v[136:137], v[70:71], v[16:17] op_sel:[0,1,0] op_sel_hi:[1,1,1]
    v_pk_fma_f32 v[18:19], v[138:139], v[70:71], v[18:19] op_sel:[0,1,0] op_sel_hi:[1,1,1]
    v_pk_fma_f32 v[20:21], v[140:141], v[86:87], v[20:21] op_sel:[0,1,0] op_sel_hi:[1,1,1]
    v_pk_fma_f32 v[22:23], v[142:143], v[86:87], v[22:23] op_sel:[0,1,0] op_sel_hi:[1,1,1]
    ds_read_b128 v[68:71], v169
    ds_read_b128 v[84:87], v169
    s_set_gpr_idx_off
L_j8:
    s_waitcnt vmcnt(5)
.p2align 3
    v_mfma_f32_16x16x16_bf16 v[128:131], v[160:161], v[96:97], 0
    v_readlane_b32 s70, v196, 8
    v_cvt_pk_bf16_f32 v10, v153, v153
    v_mfma_f32_16x16x16_bf16 v[132:135], v[160:161], v[98:99], 0
    v_and_b32 v162, v190, v10
    v_and_b32 v163, v191, v10
    s_and_b32 s61, s70, s49
    s_waitcnt vmcnt(4)
    buffer_load_dwordx4 v[120:123], v2, s[16:19], s61 offen
    v_mfma_f32_16x16x16_bf16 v[136:139], v[162:163], v[100:101], 0
    v_readlane_b32 s71, v196, 9
    v_cvt_pk_bf16_f32 v9, v154, v154
    v_mfma_f32_16x16x16_bf16 v[140:143], v[162:163], v[102:103], 0
    v_and_b32 v160, v190, v9
    v_and_b32 v161, v191, v9
    s_and_b32 s61, s71, s49
    s_set_gpr_idx_on s64, gpr_idx(SRC2,DST)
    buffer_load_dwordx4 v[124:127], v2, s[16:19], s61 offen
    v_pk_fma_f32 v[16:17], v[128:129], v[72:73], v[16:17] op_sel_hi:[1,0,1]
    v_pk_fma_f32 v[18:19], v[130:131], v[72:73], v[18:19] op_sel_hi:[1,0,1]
    v_pk_fma_f32 v[20:21], v[132:133], v[88:89], v[20:21] op_sel_hi:[1,0,1]
    v_pk_fma_f32 v[22:23], v[134:135], v[88:89], v[22:23] op_sel_hi:[1,0,1]
    s_set_gpr_idx_idx s65
.p2align 3
    v_pk_fma_f32 v[16:17], v[136:137], v[72:73], v[16:17] op_sel:[0,1,0] op_sel_hi:[1,1,1]
    v_pk_fma_f32 v[18:19], v[138:139], v[72:73], v[18:19] op_sel:[0,1,0] op_sel_hi:[1,1,1]
    v_pk_fma_f32 v[20:21], v[140:141], v[88:89], v[20:21] op_sel:[0,1,0] op_sel_hi:[1,1,1]
    v_pk_fma_f32 v[22:23], v[142:143], v[88:89], v[22:23] op_sel:[0,1,0] op_sel_hi:[1,1,1]
    s_set_gpr_idx_off
L_j10:
    s_waitcnt vmcnt(5)
.p2align 3
    v_mfma_f32_16x16x16_bf16 v[128:131], v[160:161], v[104:105], 0
    v_readlane_b32 s64, v196, 10
    v_cvt_pk_bf16_f32 v10, v155, v155
    v_mfma_f32_16x16x16_bf16 v[132:135], v[160:161], v[106:107], 0
    v_and_b32 v162, v190, v10
    v_and_b32 v163, v191, v10
    s_and_b32 s61, s64, s49
    s_waitcnt vmcnt(4)
    buffer_load_dwordx4 v[96:99], v2, s[16:19], s61 offen
    v_mfma_f32_16x16x16_bf16 v[136:139], v[162:163], v[108:109], 0
    v_readlane_b32 s65, v196, 11
    v_cvt_pk_bf16_f32 v9, v156, v156
    v_mfma_f32_16x16x16_bf16 v[140:143], v[162:163], v[110:111], 0
    v_and_b32 v160, v190, v9
    v_and_b32 v161, v191, v9
    s_and_b32 s61, s65, s49
    s_set_gpr_idx_on s66, gpr_idx(SRC2,DST)
    buffer_load_dwordx4 v[100:103], v2, s[16:19], s61 offen
    v_pk_fma_f32 v[16:17], v[128:129], v[74:75], v[16:17] op_sel_hi:[1,0,1]
    v_pk_fma_f32 v[18:19], v[130:131], v[74:75], v[18:19] op_sel_hi:[1,0,1]
    v_pk_fma_f32 v[20:21], v[132:133], v[90:91], v[20:21] op_sel_hi:[1,0,1]
    v_pk_fma_f32 v[22:23], v[134:135], v[90:91], v[22:23] op_sel_hi:[1,0,1]
    s_set_gpr_idx_idx s67
.p2align 3
    v_pk_fma_f32 v[16:17], v[136:137], v[74:75], v[16:17] op_sel:[0,1,0] op_sel_hi:[1,1,1]
    v_pk_fma_f32 v[18:19], v[138:139], v[74:75], v[18:19] op_sel:[0,1,0] op_sel_hi:[1,1,1]
    v_pk_fma_f32 v[20:21], v[140:141], v[90:91], v[20:21] op_sel:[0,1,0] op_sel_hi:[1,1,1]
    v_pk_fma_f32 v[22:23], v[142:143], v[90:91], v[22:23] op_sel:[0,1,0] op_sel_hi:[1,1,1]
    ds_read_b128 v[72:75], v169
    ds_read_b128 v[88:91], v169
    s_set_gpr_idx_off
L_j12:
    s_waitcnt vmcnt(5)
.p2align 3
    v_mfma_f32_16x16x16_bf16 v[128:131], v[160:161], v[112:113], 0
    v_readlane_b32 s66, v196, 12
    v_cvt_pk_bf16_f32 v10, v157, v157
    v_mfma_f32_16x16x16_bf16 v[132:135], v[160:161], v[114:115], 0
    v_and_b32 v162, v190, v10
    v_and_b32 v163, v191, v10
    s_and_b32 s61, s66, s49
    s_waitcnt vmcnt(4)
    buffer_load_dwordx4 v[104:107], v2, s[16:19], s61 offen
    v_mfma_f32_16x16x16_bf16 v[136:139], v[162:163], v[116:117], 0
    v_readlane_b32 s67, v196, 13
    v_cvt_pk_bf16_f32 v9, v158, v158
    v_mfma_f32_16x16x16_bf16 v[140:143], v[162:163], v[118:119], 0
    v_and_b32 v160, v190, v9
    v_and_b32 v161, v191, v9
    s_and_b32 s61, s67, s49
    s_set_gpr_idx_on s68, gpr_idx(SRC2,DST)
    buffer_load_dwordx4 v[108:111], v2, s[16:19], s61 offen
    v_pk_fma_f32 v[16:17], v[128:129], v[76:77], v[16:17] op_sel_hi:[1,0,1]
    v_pk_fma_f32 v[18:19], v[130:131], v[76:77], v[18:19] op_sel_hi:[1,0,1]
    v_pk_fma_f32 v[20:21], v[132:133], v[92:93], v[20:21] op_sel_hi:[1,0,1]
    v_pk_fma_f32 v[22:23], v[134:135], v[92:93], v[22:23] op_sel_hi:[1,0,1]
    s_set_gpr_idx_idx s69
.p2align 3
    v_pk_fma_f32 v[16:17], v[136:137], v[76:77], v[16:17] op_sel:[0,1,0] op_sel_hi:[1,1,1]
    v_pk_fma_f32 v[18:19], v[138:139], v[76:77], v[18:19] op_sel:[0,1,0] op_sel_hi:[1,1,1]
    v_pk_fma_f32 v[20:21], v[140:141], v[92:93], v[20:21] op_sel:[0,1,0] op_sel_hi:[1,1,1]
    v_pk_fma_f32 v[22:23], v[142:143], v[92:93], v[22:23] op_sel:[0,1,0] op_sel_hi:[1,1,1]
    s_set_gpr_idx_off
L_j14:
    s_waitcnt vmcnt(5)
.p2align 3
    v_mfma_f32_16x16x16_bf16 v[128:131], v[160:161], v[120:121], 0
    v_readlane_b32 s68, v196, 14
    v_cvt_pk_bf16_f32 v10, v159, v159
    v_mfma_f32_16x16x16_bf16 v[132:135], v[160:161], v[122:123], 0
    v_and_b32 v162, v190, v10
    v_and_b32 v163, v191, v10
    s_and_b32 s61, s68, s49
    s_waitcnt vmcnt(4)
    buffer_load_dwordx4 v[112:115], v2, s[16:19], s61 offen
    v_mfma_f32_16x16x16_bf16 v[136:139], v[162:163], v[124:125], 0
    v_readlane_b32 s69, v196, 15
    v_mfma_f32_16x16x16_bf16 v[140:143], v[162:163], v[126:127], 0
    s_and_b32 s61, s69, s49
    s_set_gpr_idx_on s70, gpr_idx(SRC2,DST)
    buffer_load_dwordx4 v[116:119], v2, s[16:19], s61 offen
    v_pk_fma_f32 v[16:17], v[128:129], v[78:79], v[16:17] op_sel_hi:[1,0,1]
    v_pk_fma_f32 v[18:19], v[130:131], v[78:79], v[18:19] op_sel_hi:[1,0,1]
    v_pk_fma_f32 v[20:21], v[132:133], v[94:95], v[20:21] op_sel_hi:[1,0,1]
    v_pk_fma_f32 v[22:23], v[134:135], v[94:95], v[22:23] op_sel_hi:[1,0,1]
    s_set_gpr_idx_idx s71
    s_sub_u32 s53, s53, 1
.p2align 3
    v_pk_fma_f32 v[16:17], v[136:137], v[78:79], v[16:17] op_sel:[0,1,0] op_sel_hi:[1,1,1]
    v_pk_fma_f32 v[18:19], v[138:139], v[78:79], v[18:19] op_sel:[0,1,0] op_sel_hi:[1,1,1]
    v_pk_fma_f32 v[20:21], v[140:141], v[94:95], v[20:21] op_sel:[0,1,0] op_sel_hi:[1,1,1]
    v_pk_fma_f32 v[22:23], v[142:143], v[94:95], v[22:23] op_sel:[0,1,0] op_sel_hi:[1,1,1]
    ds_read_b128 v[76:79], v169
    ds_read_b128 v[92:95], v169
    s_set_gpr_idx_off
    s_cmp_lg_u32 s53, 0
    s_cbranch_scc1 L_loop
    s_waitcnt lgkmcnt(2)
.p2align 3
    v_mfma_f32_4x4x4_16b_bf16 v[144:147], v[192:193], v[188:189], 0 cbsz:4 abid:0
    v_mfma_f32_4x4x4_16b_bf16 v[148:151], v[192:193], v[188:189], 0 cbsz:4 abid:2
    v_mfma_f32_4x4x4_16b_bf16 v[152:155], v[192:193], v[188:189], 0 cbsz:4 abid:4
    v_mfma_f32_4x4x4_16b_bf16 v[156:159], v[192:193], v[188:189], 0 cbsz:4 abid:6
    v_lshlrev_b32 v196, 3, v197
    v_and_b32 v196, s55, v196
    s_waitcnt lgkmcnt(0)
.p2align 3
    v_smfmac_f32_32x32x32_bf16 v[64:79], v[164:167], v[172:179], v168
    v_cvt_pk_bf16_f32 v9, v144, v144
    v_and_b32 v160, v190, v9
    v_and_b32 v161, v191, v9
    v_smfmac_f32_32x32x32_bf16 v[80:95], v[164:167], v[180:187], v168
L_f0:
    s_waitcnt vmcnt(5)
.p2align 3
    v_mfma_f32_16x16x16_bf16 v[128:131], v[160:161], v[96:97], 0
    v_readlane_b32 s70, v196, 0
    v_cvt_pk_bf16_f32 v10, v145, v145
    v_mfma_f32_16x16x16_bf16 v[132:135], v[160:161], v[98:99], 0
    v_and_b32 v162, v190, v10
    v_and_b32 v163, v191, v10
    s_and_b32 s61, s70, s49
    s_waitcnt vmcnt(4)
    buffer_load_dwordx4 v[120:123], v2, s[16:19], s61 offen
    v_mfma_f32_16x16x16_bf16 v[136:139], v[162:163], v[100:101], 0
    v_readlane_b32 s71, v196, 1
    v_cvt_pk_bf16_f32 v9, v146, v146
    v_mfma_f32_16x16x16_bf16 v[140:143], v[162:163], v[102:103], 0
    v_and_b32 v160, v190, v9
    v_and_b32 v161, v191, v9
    s_and_b32 s61, s71, s49
    s_set_gpr_idx_on s64, gpr_idx(SRC2,DST)
    buffer_load_dwordx4 v[124:127], v2, s[16:19], s61 offen
    v_pk_fma_f32 v[16:17], v[128:129], v[64:65], v[16:17] op_sel_hi:[1,0,1]
    v_pk_fma_f32 v[18:19], v[130:131], v[64:65], v[18:19] op_sel_hi:[1,0,1]
    v_pk_fma_f32 v[20:21], v[132:133], v[80:81], v[20:21] op_sel_hi:[1,0,1]
    v_pk_fma_f32 v[22:23], v[134:135], v[80:81], v[22:23] op_sel_hi:[1,0,1]
    s_set_gpr_idx_idx s65
.p2align 3
    v_pk_fma_f32 v[16:17], v[136:137], v[64:65], v[16:17] op_sel:[0,1,0] op_sel_hi:[1,1,1]
    v_pk_fma_f32 v[18:19], v[138:139], v[64:65], v[18:19] op_sel:[0,1,0] op_sel_hi:[1,1,1]
    v_pk_fma_f32 v[20:21], v[140:141], v[80:81], v[20:21] op_sel:[0,1,0] op_sel_hi:[1,1,1]
    v_pk_fma_f32 v[22:23], v[142:143], v[80:81], v[22:23] op_sel:[0,1,0] op_sel_hi:[1,1,1]
    s_set_gpr_idx_off
    s_waitcnt vmcnt(5)
.p2align 3
    v_mfma_f32_16x16x16_bf16 v[128:131], v[160:161], v[104:105], 0
    v_readlane_b32 s64, v196, 2
    v_cvt_pk_bf16_f32 v10, v147, v147
    v_mfma_f32_16x16x16_bf16 v[132:135], v[160:161], v[106:107], 0
    v_and_b32 v162, v190, v10
    v_and_b32 v163, v191, v10
    s_and_b32 s61, s64, s49
    s_waitcnt vmcnt(4)
    buffer_load_dwordx4 v[96:99], v2, s[16:19], s61 offen
    v_mfma_f32_16x16x16_bf16 v[136:139], v[162:163], v[108:109], 0
    v_readlane_b32 s65, v196, 3
    v_cvt_pk_bf16_f32 v9, v148, v148
    v_mfma_f32_16x16x16_bf16 v[140:143], v[162:163], v[110:111], 0
    v_and_b32 v160, v190, v9
    v_and_b32 v161, v191, v9
    s_and_b32 s61, s65, s49
    s_set_gpr_idx_on s66, gpr_idx(SRC2,DST)
    buffer_load_dwordx4 v[100:103], v2, s[16:19], s61 offen
    v_pk_fma_f32 v[16:17], v[128:129], v[66:67], v[16:17] op_sel_hi:[1,0,1]
    v_pk_fma_f32 v[18:19], v[130:131], v[66:67], v[18:19] op_sel_hi:[1,0,1]
    v_pk_fma_f32 v[20:21], v[132:133], v[82:83], v[20:21] op_sel_hi:[1,0,1]
    v_pk_fma_f32 v[22:23], v[134:135], v[82:83], v[22:23] op_sel_hi:[1,0,1]
    s_set_gpr_idx_idx s67
.p2align 3
    v_pk_fma_f32 v[16:17], v[136:137], v[66:67], v[16:17] op_sel:[0,1,0] op_sel_hi:[1,1,1]
    v_pk_fma_f32 v[18:19], v[138:139], v[66:67], v[18:19] op_sel:[0,1,0] op_sel_hi:[1,1,1]
    v_pk_fma_f32 v[20:21], v[140:141], v[82:83], v[20:21] op_sel:[0,1,0] op_sel_hi:[1,1,1]
    v_pk_fma_f32 v[22:23], v[142:143], v[82:83], v[22:23] op_sel:[0,1,0] op_sel_hi:[1,1,1]
    s_set_gpr_idx_off
    s_waitcnt vmcnt(5)
.p2align 3
    v_mfma_f32_16x16x16_bf16 v[128:131], v[160:161], v[112:113], 0
    v_readlane_b32 s66, v196, 4
    v_cvt_pk_bf16_f32 v10, v149, v149
    v_mfma_f32_16x16x16_bf16 v[132:135], v[160:161], v[114:115], 0
    v_and_b32 v162, v190, v10
    v_and_b32 v163, v191, v10
    s_and_b32 s61, s66, s49
    s_waitcnt vmcnt(4)
    buffer_load_dwordx4 v[104:107], v2, s[16:19], s61 offen
    v_mfma_f32_16x16x16_bf16 v[136:139], v[162:163], v[116:117], 0
    v_readlane_b32 s67, v196, 5
    v_cvt_pk_bf16_f32 v9, v150, v150
    v_mfma_f32_16x16x16_bf16 v[140:143], v[162:163], v[118:119], 0
    v_and_b32 v160, v190, v9
    v_and_b32 v161, v191, v9
    s_and_b32 s61, s67, s49
    s_set_gpr_idx_on s68, gpr_idx(SRC2,DST)
    buffer_load_dwordx4 v[108:111], v2, s[16:19], s61 offen
    v_pk_fma_f32 v[16:17], v[128:129], v[68:69], v[16:17] op_sel_hi:[1,0,1]
    v_pk_fma_f32 v[18:19], v[130:131], v[68:69], v[18:19] op_sel_hi:[1,0,1]
    v_pk_fma_f32 v[20:21], v[132:133], v[84:85], v[20:21] op_sel_hi:[1,0,1]
    v_pk_fma_f32 v[22:23], v[134:135], v[84:85], v[22:23] op_sel_hi:[1,0,1]
    s_set_gpr_idx_idx s69
.p2align 3
    v_pk_fma_f32 v[16:17], v[136:137], v[68:69], v[16:17] op_sel:[0,1,0] op_sel_hi:[1,1,1]
    v_pk_fma_f32 v[18:19], v[138:139], v[68:69], v[18:19] op_sel:[0,1,0] op_sel_hi:[1,1,1]
    v_pk_fma_f32 v[20:21], v[140:141], v[84:85], v[20:21] op_sel:[0,1,0] op_sel_hi:[1,1,1]
    v_pk_fma_f32 v[22:23], v[142:143], v[84:85], v[22:23] op_sel:[0,1,0] op_sel_hi:[1,1,1]
    s_set_gpr_idx_off
    s_waitcnt vmcnt(5)
.p2align 3
    v_mfma_f32_16x16x16_bf16 v[128:131], v[160:161], v[120:121], 0
    v_readlane_b32 s68, v196, 6
    v_cvt_pk_bf16_f32 v10, v151, v151
    v_mfma_f32_16x16x16_bf16 v[132:135], v[160:161], v[122:123], 0
    v_and_b32 v162, v190, v10
    v_and_b32 v163, v191, v10
    s_and_b32 s61, s68, s49
    s_waitcnt vmcnt(4)
    buffer_load_dwordx4 v[112:115], v2, s[16:19], s61 offen
    v_mfma_f32_16x16x16_bf16 v[136:139], v[162:163], v[124:125], 0
    v_readlane_b32 s69, v196, 7
    v_cvt_pk_bf16_f32 v9, v152, v152
    v_mfma_f32_16x16x16_bf16 v[140:143], v[162:163], v[126:127], 0
    v_and_b32 v160, v190, v9
    v_and_b32 v161, v191, v9
    s_and_b32 s61, s69, s49
    s_set_gpr_idx_on s70, gpr_idx(SRC2,DST)
    buffer_load_dwordx4 v[116:119], v2, s[16:19], s61 offen
    v_pk_fma_f32 v[16:17], v[128:129], v[70:71], v[16:17] op_sel_hi:[1,0,1]
    v_pk_fma_f32 v[18:19], v[130:131], v[70:71], v[18:19] op_sel_hi:[1,0,1]
    v_pk_fma_f32 v[20:21], v[132:133], v[86:87], v[20:21] op_sel_hi:[1,0,1]
    v_pk_fma_f32 v[22:23], v[134:135], v[86:87], v[22:23] op_sel_hi:[1,0,1]
    s_set_gpr_idx_idx s71
.p2align 3
    v_pk_fma_f32 v[16:17], v[136:137], v[70:71], v[16:17] op_sel:[0,1,0] op_sel_hi:[1,1,1]
    v_pk_fma_f32 v[18:19], v[138:139], v[70:71], v[18:19] op_sel:[0,1,0] op_sel_hi:[1,1,1]
    v_pk_fma_f32 v[20:21], v[140:141], v[86:87], v[20:21] op_sel:[0,1,0] op_sel_hi:[1,1,1]
    v_pk_fma_f32 v[22:23], v[142:143], v[86:87], v[22:23] op_sel:[0,1,0] op_sel_hi:[1,1,1]
    s_set_gpr_idx_off
    s_waitcnt vmcnt(5)
.p2align 3
    v_mfma_f32_16x16x16_bf16 v[128:131], v[160:161], v[96:97], 0
    v_readlane_b32 s70, v196, 8
    v_cvt_pk_bf16_f32 v10, v153, v153
    v_mfma_f32_16x16x16_bf16 v[132:135], v[160:161], v[98:99], 0
    v_and_b32 v162, v190, v10
    v_and_b32 v163, v191, v10
    s_and_b32 s61, s70, s49
    s_waitcnt vmcnt(4)
    buffer_load_dwordx4 v[120:123], v2, s[16:19], s61 offen
    v_mfma_f32_16x16x16_bf16 v[136:139], v[162:163], v[100:101], 0
    v_readlane_b32 s71, v196, 9
    v_cvt_pk_bf16_f32 v9, v154, v154
    v_mfma_f32_16x16x16_bf16 v[140:143], v[162:163], v[102:103], 0
    v_and_b32 v160, v190, v9
    v_and_b32 v161, v191, v9
    s_and_b32 s61, s71, s49
    s_set_gpr_idx_on s64, gpr_idx(SRC2,DST)
    buffer_load_dwordx4 v[124:127], v2, s[16:19], s61 offen
    v_pk_fma_f32 v[16:17], v[128:129], v[72:73], v[16:17] op_sel_hi:[1,0,1]
    v_pk_fma_f32 v[18:19], v[130:131], v[72:73], v[18:19] op_sel_hi:[1,0,1]
    v_pk_fma_f32 v[20:21], v[132:133], v[88:89], v[20:21] op_sel_hi:[1,0,1]
    v_pk_fma_f32 v[22:23], v[134:135], v[88:89], v[22:23] op_sel_hi:[1,0,1]
    s_set_gpr_idx_idx s65
.p2align 3
    v_pk_fma_f32 v[16:17], v[136:137], v[72:73], v[16:17] op_sel:[0,1,0] op_sel_hi:[1,1,1]
    v_pk_fma_f32 v[18:19], v[138:139], v[72:73], v[18:19] op_sel:[0,1,0] op_sel_hi:[1,1,1]
    v_pk_fma_f32 v[20:21], v[140:141], v[88:89], v[20:21] op_sel:[0,1,0] op_sel_hi:[1,1,1]
    v_pk_fma_f32 v[22:23], v[142:143], v[88:89], v[22:23] op_sel:[0,1,0] op_sel_hi:[1,1,1]
    s_set_gpr_idx_off
    s_waitcnt vmcnt(5)
.p2align 3
    v_mfma_f32_16x16x16_bf16 v[128:131], v[160:161], v[104:105], 0
    v_cvt_pk_bf16_f32 v10, v155, v155
    v_mfma_f32_16x16x16_bf16 v[132:135], v[160:161], v[106:107], 0
    v_and_b32 v162, v190, v10
    v_and_b32 v163, v191, v10
    s_waitcnt vmcnt(4)
.p2align 3
    s_nop 0
    v_mfma_f32_16x16x16_bf16 v[136:139], v[162:163], v[108:109], 0
    v_cvt_pk_bf16_f32 v9, v156, v156
    v_mfma_f32_16x16x16_bf16 v[140:143], v[162:163], v[110:111], 0
    v_and_b32 v160, v190, v9
    v_and_b32 v161, v191, v9
    s_set_gpr_idx_on s66, gpr_idx(SRC2,DST)
.p2align 3
    v_pk_fma_f32 v[16:17], v[128:129], v[74:75], v[16:17] op_sel_hi:[1,0,1]
    v_pk_fma_f32 v[18:19], v[130:131], v[74:75], v[18:19] op_sel_hi:[1,0,1]
    v_pk_fma_f32 v[20:21], v[132:133], v[90:91], v[20:21] op_sel_hi:[1,0,1]
    v_pk_fma_f32 v[22:23], v[134:135], v[90:91], v[22:23] op_sel_hi:[1,0,1]
    s_set_gpr_idx_idx s67
.p2align 3
    v_pk_fma_f32 v[16:17], v[136:137], v[74:75], v[16:17] op_sel:[0,1,0] op_sel_hi:[1,1,1]
    v_pk_fma_f32 v[18:19], v[138:139], v[74:75], v[18:19] op_sel:[0,1,0] op_sel_hi:[1,1,1]
    v_pk_fma_f32 v[20:21], v[140:141], v[90:91], v[20:21] op_sel:[0,1,0] op_sel_hi:[1,1,1]
    v_pk_fma_f32 v[22:23], v[142:143], v[90:91], v[22:23] op_sel:[0,1,0] op_sel_hi:[1,1,1]
    s_set_gpr_idx_off
    s_waitcnt vmcnt(3)
.p2align 3
    v_mfma_f32_16x16x16_bf16 v[128:131], v[160:161], v[112:113], 0
    v_cvt_pk_bf16_f32 v10, v157, v157
    v_mfma_f32_16x16x16_bf16 v[132:135], v[160:161], v[114:115], 0
    v_and_b32 v162, v190, v10
    v_and_b32 v163, v191, v10
    s_waitcnt vmcnt(2)
.p2align 3
    s_nop 0
    v_mfma_f32_16x16x16_bf16 v[136:139], v[162:163], v[116:117], 0
    v_cvt_pk_bf16_f32 v9, v158, v158
    v_mfma_f32_16x16x16_bf16 v[140:143], v[162:163], v[118:119], 0
    v_and_b32 v160, v190, v9
    v_and_b32 v161, v191, v9
    s_set_gpr_idx_on s68, gpr_idx(SRC2,DST)
.p2align 3
    v_pk_fma_f32 v[16:17], v[128:129], v[76:77], v[16:17] op_sel_hi:[1,0,1]
    v_pk_fma_f32 v[18:19], v[130:131], v[76:77], v[18:19] op_sel_hi:[1,0,1]
    v_pk_fma_f32 v[20:21], v[132:133], v[92:93], v[20:21] op_sel_hi:[1,0,1]
    v_pk_fma_f32 v[22:23], v[134:135], v[92:93], v[22:23] op_sel_hi:[1,0,1]
    s_set_gpr_idx_idx s69
.p2align 3
    v_pk_fma_f32 v[16:17], v[136:137], v[76:77], v[16:17] op_sel:[0,1,0] op_sel_hi:[1,1,1]
    v_pk_fma_f32 v[18:19], v[138:139], v[76:77], v[18:19] op_sel:[0,1,0] op_sel_hi:[1,1,1]
    v_pk_fma_f32 v[20:21], v[140:141], v[92:93], v[20:21] op_sel:[0,1,0] op_sel_hi:[1,1,1]
    v_pk_fma_f32 v[22:23], v[142:143], v[92:93], v[22:23] op_sel:[0,1,0] op_sel_hi:[1,1,1]
    s_set_gpr_idx_off
    s_waitcnt vmcnt(1)
.p2align 3
    v_mfma_f32_16x16x16_bf16 v[128:131], v[160:161], v[120:121], 0
    v_cvt_pk_bf16_f32 v10, v159, v159
    v_mfma_f32_16x16x16_bf16 v[132:135], v[160:161], v[122:123], 0
    v_and_b32 v162, v190, v10
    v_and_b32 v163, v191, v10
    s_waitcnt vmcnt(0)
.p2align 3
    s_nop 0
    v_mfma_f32_16x16x16_bf16 v[136:139], v[162:163], v[124:125], 0
    v_mfma_f32_16x16x16_bf16 v[140:143], v[162:163], v[126:127], 0
    s_set_gpr_idx_on s70, gpr_idx(SRC2,DST)
.p2align 3
    v_pk_fma_f32 v[16:17], v[128:129], v[78:79], v[16:17] op_sel_hi:[1,0,1]
    v_pk_fma_f32 v[18:19], v[130:131], v[78:79], v[18:19] op_sel_hi:[1,0,1]
    v_pk_fma_f32 v[20:21], v[132:133], v[94:95], v[20:21] op_sel_hi:[1,0,1]
    v_pk_fma_f32 v[22:23], v[134:135], v[94:95], v[22:23] op_sel_hi:[1,0,1]
    s_set_gpr_idx_idx s71
.p2align 3
    s_nop 0
    v_pk_fma_f32 v[16:17], v[136:137], v[78:79], v[16:17] op_sel:[0,1,0] op_sel_hi:[1,1,1]
    v_pk_fma_f32 v[18:19], v[138:139], v[78:79], v[18:19] op_sel:[0,1,0] op_sel_hi:[1,1,1]
    v_pk_fma_f32 v[20:21], v[140:141], v[94:95], v[20:21] op_sel:[0,1,0] op_sel_hi:[1,1,1]
    v_pk_fma_f32 v[22:23], v[142:143], v[94:95], v[22:23] op_sel:[0,1,0] op_sel_hi:[1,1,1]
    s_set_gpr_idx_off
L_swept:
    s_add_u32 s48, s48, 224
    s_cmp_lt_u32 s48, s47
    s_cbranch_scc1 L_again
    s_setprio 0
    v_cvt_pk_bf16_f32 v64, v16, v20
    v_cvt_pk_bf16_f32 v65, v17, v21
    v_cvt_pk_bf16_f32 v66, v18, v22
    v_cvt_pk_bf16_f32 v67, v19, v23
    ds_write2_b32 v208, v64, v65 offset0:0 offset1:72
    ds_write2_b32 v208, v66, v67 offset0:144 offset1:216
    v_cvt_pk_bf16_f32 v68, v24, v28
    v_cvt_pk_bf16_f32 v69, v25, v29
    v_cvt_pk_bf16_f32 v70, v26, v30
    v_cvt_pk_bf16_f32 v71, v27, v31
    ds_write2_b32 v209, v68, v69 offset0:0 offset1:72
    ds_write2_b32 v209, v70, v71 offset0:144 offset1:216
    v_cvt_pk_bf16_f32 v72, v32, v36
    v_cvt_pk_bf16_f32 v73, v33, v37
    v_cvt_pk_bf16_f32 v74, v34, v38
    v_cvt_pk_bf16_f32 v75, v35, v39
    ds_write2_b32 v210, v72, v73 offset0:0 offset1:72
    ds_write2_b32 v210, v74, v75 offset0:144 offset1:216
    v_cvt_pk_bf16_f32 v76, v40, v44
    v_cvt_pk_bf16_f32 v77, v41, v45
    v_cvt_pk_bf16_f32 v78, v42, v46
    v_cvt_pk_bf16_f32 v79, v43, v47
    ds_write2_b32 v211, v76, v77 offset0:0 offset1:72
    ds_write2_b32 v211, v78, v79 offset0:144 offset1:216
    v_cvt_pk_bf16_f32 v80, v48, v52
    v_cvt_pk_bf16_f32 v81, v49, v53
    v_cvt_pk_bf16_f32 v82, v50, v54
    v_cvt_pk_bf16_f32 v83, v51, v55
    ds_write2_b32 v212, v80, v81 offset0:0 offset1:72
    ds_write2_b32 v212, v82, v83 offset0:144 offset1:216
    ds_read_b128 v[96:99], v215 offset:6144
    ds_read_b128 v[100:103], v215 offset:7168
    ds_read_b128 v[104:107], v215 offset:8192
    ds_read_b128 v[108:111], v215 offset:9216
    ds_read_b128 v[112:115], v215 offset:10240
    ds_read_b128 v[116:119], v215 offset:11264
    ds_read_b128 v[120:123], v215 offset:12288
    ds_read_b128 v[124:127], v215 offset:13312
    ds_read_b128 v[128:131], v215 offset:14336
    ds_read_b128 v[132:135], v215 offset:15360
    s_waitcnt lgkmcnt(10)
    s_barrier
    ds_read_b128 v[16:19], v213 offset:0
    ds_read_b128 v[20:23], v213 offset:64
    ds_read_b128 v[24:27], v213 offset:128
    ds_read_b128 v[28:31], v213 offset:192
    s_waitcnt lgkmcnt(3)
    v_mfma_f32_16x16x32_bf16 v[160:163], v[16:19], v[216:219], 0
    v_mfma_f32_16x16x32_bf16 v[164:167], v[16:19], v[220:223], 0
    v_mfma_f32_16x16x32_bf16 v[168:171], v[16:19], v[224:227], 0
    v_mfma_f32_16x16x32_bf16 v[172:175], v[16:19], v[228:231], 0
    ds_read_b128 v[32:35], v213 offset:4608
    ds_read_b128 v[36:39], v213 offset:4672
    ds_read_b128 v[40:43], v213 offset:4736
    ds_read_b128 v[44:47], v213 offset:4800
    s_waitcnt lgkmcnt(6)
    v_mfma_f32_16x16x32_bf16 v[160:163], v[20:23], v[232:235], v[160:163]
    v_mfma_f32_16x16x32_bf16 v[164:167], v[20:23], v[236:239], v[164:167]
    v_mfma_f32_16x16x32_bf16 v[168:171], v[20:23], v[96:99], v[168:171]
    v_mfma_f32_16x16x32_bf16 v[172:175], v[20:23], v[100:103], v[172:175]
    ds_read_b128 v[48:51], v213 offset:9216
    ds_read_b128 v[52:55], v213 offset:9280
    ds_read_b128 v[56:59], v213 offset:9344
    ds_read_b128 v[60:63], v213 offset:9408
    s_waitcnt lgkmcnt(9)
    v_mfma_f32_16x16x32_bf16 v[160:163], v[24:27], v[104:107], v[160:163]
    v_mfma_f32_16x16x32_bf16 v[164:167], v[24:27], v[108:111], v[164:167]
    v_mfma_f32_16x16x32_bf16 v[168:171], v[24:27], v[112:115], v[168:171]
    v_mfma_f32_16x16x32_bf16 v[172:175], v[24:27], v[116:119], v[172:175]
    s_waitcnt lgkmcnt(8)
    v_mfma_f32_16x16x32_bf16 v[160:163], v[28:31], v[120:123], v[160:163]
    v_mfma_f32_16x16x32_bf16 v[164:167], v[28:31], v[124:127], v[164:167]
    v_mfma_f32_16x16x32_bf16 v[168:171], v[28:31], v[128:131], v[168:171]
    v_mfma_f32_16x16x32_bf16 v[172:175], v[28:31], v[132:135], v[172:175]
    s_waitcnt lgkmcnt(4)
    v_mfma_f32_16x16x32_bf16 v[176:179], v[32:35], v[216:219], 0
    v_mfma_f32_16x16x32_bf16 v[180:183], v[32:35], v[220:223], 0
    v_mfma_f32_16x16x32_bf16 v[184:187], v[32:35], v[224:227], 0
    v_mfma_f32_16x16x32_bf16 v[188:191], v[32:35], v[228:231], 0
    v_mfma_f32_16x16x32_bf16 v[176:179], v[36:39], v[232:235], v[176:179]
    v_cvt_pk_bf16_f32 v64, v160, v164
    v_cvt_pk_bf16_f32 v80, v160, v164
    v_mfma_f32_16x16x32_bf16 v[180:183], v[36:39], v[236:239], v[180:183]
    v_cvt_pk_bf16_f32 v66, v162, v166
    v_cvt_pk_bf16_f32 v65, v168, v172
    v_mfma_f32_16x16x32_bf16 v[184:187], v[36:39], v[96:99], v[184:187]
    v_cvt_pk_bf16_f32 v81, v168, v172
    v_cvt_pk_bf16_f32 v67, v170, v174
    v_mfma_f32_16x16x32_bf16 v[188:191], v[36:39], v[100:103], v[188:191]
    v_mov_b32_dpp v64, v66 row_ror:8 row_mask:0xf bank_mask:0xc
    v_mov_b32_dpp v65, v67 row_ror:8 row_mask:0xf bank_mask:0xc
    v_mfma_f32_16x16x32_bf16 v[176:179], v[40:43], v[104:107], v[176:179]
    v_mov_b32_dpp v66, v80 row_ror:8 row_mask:0xf bank_mask:0x3
    v_mov_b32_dpp v67, v81 row_ror:8 row_mask:0xf bank_mask:0x3
    v_mfma_f32_16x16x32_bf16 v[180:183], v[40:43], v[108:111], v[180:183]
    buffer_store_dwordx4 v[64:67], v214, s[40:43], s87 offen offset:0 sc1
    v_cvt_pk_bf16_f32 v68, v161, v165
    v_mfma_f32_16x16x32_bf16 v[184:187], v[40:43], v[112:115], v[184:187]
    v_cvt_pk_bf16_f32 v82, v161, v165
    v_cvt_pk_bf16_f32 v70, v163, v167
    v_mfma_f32_16x16x32_bf16 v[188:191], v[40:43], v[116:119], v[188:191]
    v_cvt_pk_bf16_f32 v69, v169, v173
    v_cvt_pk_bf16_f32 v83, v169, v173
    v_mfma_f32_16x16x32_bf16 v[176:179], v[44:47], v[120:123], v[176:179]
    v_cvt_pk_bf16_f32 v71, v171, v175
    v_mov_b32_dpp v68, v70 row_ror:8 row_mask:0xf bank_mask:0xc
    v_mfma_f32_16x16x32_bf16 v[180:183], v[44:47], v[124:127], v[180:183]
    v_mov_b32_dpp v69, v71 row_ror:8 row_mask:0xf bank_mask:0xc
    v_mov_b32_dpp v70, v82 row_ror:8 row_mask:0xf bank_mask:0x3
    v_mfma_f32_16x16x32_bf16 v[184:187], v[44:47], v[128:131], v[184:187]
    v_mov_b32_dpp v71, v83 row_ror:8 row_mask:0xf bank_mask:0x3
    buffer_store_dwordx4 v[68:71], v214, s[40:43], s87 offen offset:256 sc1
    v_mfma_f32_16x16x32_bf16 v[188:191], v[44:47], v[132:135], v[188:191]
    s_add_u32 s87, s87, 4096
    s_cmp_ge_u32 s3, 4
    s_cbranch_scc1 L_two
    s_waitcnt lgkmcnt(0)
    v_mfma_f32_16x16x32_bf16 v[160:163], v[48:51], v[216:219], 0
    v_mfma_f32_16x16x32_bf16 v[164:167], v[48:51], v[220:223], 0
    v_mfma_f32_16x16x32_bf16 v[168:171], v[48:51], v[224:227], 0
    v_mfma_f32_16x16x32_bf16 v[172:175], v[48:51], v[228:231], 0
    v_mfma_f32_16x16x32_bf16 v[160:163], v[52:55], v[232:235], v[160:163]
    v_cvt_pk_bf16_f32 v72, v176, v180
    v_cvt_pk_bf16_f32 v80, v176, v180
    v_mfma_f32_16x16x32_bf16 v[164:167], v[52:55], v[236:239], v[164:167]
    v_cvt_pk_bf16_f32 v74, v178, v182
    v_cvt_pk_bf16_f32 v73, v184, v188
    v_mfma_f32_16x16x32_bf16 v[168:171], v[52:55], v[96:99], v[168:171]
    v_cvt_pk_bf16_f32 v81, v184, v188
    v_cvt_pk_bf16_f32 v75, v186, v190
    v_mfma_f32_16x16x32_bf16 v[172:175], v[52:55], v[100:103], v[172:175]
    v_mov_b32_dpp v72, v74 row_ror:8 row_mask:0xf bank_mask:0xc
    v_mov_b32_dpp v73, v75 row_ror:8 row_mask:0xf bank_mask:0xc
    v_mfma_f32_16x16x32_bf16 v[160:163], v[56:59], v[104:107], v[160:163]
    v_mov_b32_dpp v74, v80 row_ror:8 row_mask:0xf bank_mask:0x3
    v_mov_b32_dpp v75, v81 row_ror:8 row_mask:0xf bank_mask:0x3
    v_mfma_f32_16x16x32_bf16 v[164:167], v[56:59], v[108:111], v[164:167]
    buffer_store_dwordx4 v[72:75], v214, s[40:43], s87 offen offset:0 sc1
    v_cvt_pk_bf16_f32 v76, v177, v181
    v_mfma_f32_16x16x32_bf16 v[168:171], v[56:59], v[112:115], v[168:171]
    v_cvt_pk_bf16_f32 v82, v177, v181
    v_cvt_pk_bf16_f32 v78, v179, v183
    v_mfma_f32_16x16x32_bf16 v[172:175], v[56:59], v[116:119], v[172:175]
    v_cvt_pk_bf16_f32 v77, v185, v189
    v_cvt_pk_bf16_f32 v83, v185, v189
    v_mfma_f32_16x16x32_bf16 v[160:163], v[60:63], v[120:123], v[160:163]
    v_cvt_pk_bf16_f32 v79, v187, v191
    v_mov_b32_dpp v76, v78 row_ror:8 row_mask:0xf bank_mask:0xc
    v_mfma_f32_16x16x32_bf16 v[164:167], v[60:63], v[124:127], v[164:167]
    v_mov_b32_dpp v77, v79 row_ror:8 row_mask:0xf bank_mask:0xc
    v_mov_b32_dpp v78, v82 row_ror:8 row_mask:0xf bank_mask:0x3
    v_mfma_f32_16x16x32_bf16 v[168:171], v[60:63], v[128:131], v[168:171]
    v_mov_b32_dpp v79, v83 row_ror:8 row_mask:0xf bank_mask:0x3
    buffer_store_dwordx4 v[76:79], v214, s[40:43], s87 offen offset:256 sc1
    v_mfma_f32_16x16x32_bf16 v[172:175], v[60:63], v[132:135], v[172:175]
    s_add_u32 s87, s87, 4096
    s_nop 0
    v_cvt_pk_bf16_f32 v64, v160, v164
    v_cvt_pk_bf16_f32 v80, v160, v164
    v_cvt_pk_bf16_f32 v66, v162, v166
    s_nop 2
    v_cvt_pk_bf16_f32 v65, v168, v172
    v_cvt_pk_bf16_f32 v81, v168, v172
    v_cvt_pk_bf16_f32 v67, v170, v174
    v_mov_b32_dpp v64, v66 row_ror:8 row_mask:0xf bank_mask:0xc
    s_nop 0
    v_mov_b32_dpp v65, v67 row_ror:8 row_mask:0xf bank_mask:0xc
    v_mov_b32_dpp v66, v80 row_ror:8 row_mask:0xf bank_mask:0x3
    v_mov_b32_dpp v67, v81 row_ror:8 row_mask:0xf bank_mask:0x3
    buffer_store_dwordx4 v[64:67], v214, s[40:43], s87 offen offset:0 sc1
    v_cvt_pk_bf16_f32 v68, v161, v165
    v_cvt_pk_bf16_f32 v82, v161, v165
    v_cvt_pk_bf16_f32 v70, v163, v167
    v_cvt_pk_bf16_f32 v69, v169, v173
    v_cvt_pk_bf16_f32 v83, v169, v173
    v_cvt_pk_bf16_f32 v71, v171, v175
    v_mov_b32_dpp v68, v70 row_ror:8 row_mask:0xf bank_mask:0xc
    s_nop 0
    v_mov_b32_dpp v69, v71 row_ror:8 row_mask:0xf bank_mask:0xc
    v_mov_b32_dpp v70, v82 row_ror:8 row_mask:0xf bank_mask:0x3
    v_mov_b32_dpp v71, v83 row_ror:8 row_mask:0xf bank_mask:0x3
    buffer_store_dwordx4 v[68:71], v214, s[40:43], s87 offen offset:256 sc1
    s_add_u32 s87, s87, 4096
L_stored:
    s_or_b32 s4, s2, s3
    s_cbranch_scc1 L_notag
    v_mov_b32 v8, s62
    v_lshlrev_b32 v10, 2, v1
    s_mov_b32 s54, 524288
    buffer_store_dword v8, v10, s[20:23], s54 offen sc1
L_notag:
L_done:
    s_endpgm
L_again:
    s_waitcnt vmcnt(0) lgkmcnt(0)
    s_barrier
    v_lshlrev_b32 v11, 2, v0
    v_mov_b32 v12, 0x00700000
    v_mov_b32 v13, 0
    ds_write_b32 v11, v12 offset:0
    ds_write_b32 v11, v12 offset:2048
    ds_write_b32 v11, v12 offset:4096
    ds_write_b32 v11, v12 offset:6144
    ds_write_b32 v11, v13 offset:8192
    ds_write_b32 v11, v13 offset:10240
    ds_write_b32 v11, v13 offset:12288
    v_mov_b32 v64, 0
    v_mov_b32 v65, 0
    v_mov_b32 v66, 0
    v_mov_b32 v67, 0
    v_mov_b32 v68, 0
    v_mov_b32 v69, 0
    v_mov_b32 v70, 0
    v_mov_b32 v71, 0
    v_mov_b32 v72, 0
    v_mov_b32 v73, 0
    v_mov_b32 v74, 0
    v_mov_b32 v75, 0
    v_mov_b32 v76, 0
    v_mov_b32 v77, 0
    v_mov_b32 v78, 0
    v_mov_b32 v79, 0
    v_mov_b32 v80, 0
    v_mov_b32 v81, 0
    v_mov_b32 v82, 0
    v_mov_b32 v83, 0
    v_mov_b32 v84, 0
    v_mov_b32 v85, 0
    v_mov_b32 v86, 0
    v_mov_b32 v87, 0
    v_mov_b32 v88, 0
    v_mov_b32 v89, 0
    v_mov_b32 v90, 0
    v_mov_b32 v91, 0
    v_mov_b32 v92, 0
    v_mov_b32 v93, 0
    v_mov_b32 v94, 0
    v_mov_b32 v95, 0
    v_add_u32 v3, v3, v4
    v_subrev_u32 v3, 224, v3
    v_max_i32 v3, 0, v3
    v_subrev_u32 v4, 224, v4
    v_max_i32 v4, 0, v4
    v_sub_u32 v3, v3, v4
    v_add_u32 v5, 224, v5
    s_sub_i32 s95, s95, 224
    v_lshl_add_u32 v8, v4, 2, v241
    s_waitcnt lgkmcnt(0)
    s_barrier
L_clip:
    v_add_u32 v10, v4, v3
    v_min_i32 v10, 224, v10
    v_sub_u32 v10, v10, v4
    v_add_u32 v10, v10, v240
L_masks:
    v_cmp_lt_i32 s[64:65], 0, v10
    v_cmp_lt_i32 s[66:67], 2, v10
    v_cmp_lt_i32 s[68:69], 4, v10
    v_cmp_lt_i32 s[70:71], 6, v10
    v_cmp_lt_i32 s[72:73], 8, v10
    v_cmp_lt_i32 s[74:75], 10, v10
    v_cmp_lt_i32 s[76:77], 12, v10
    v_cmp_lt_i32 s[78:79], 14, v10
    s_nop 0
    s_branch L_mapw
L_map2:
    v_add_u32 v8, 56, v8
    v_subrev_u32 v10, 14, v10
    s_branch L_masks
L_r1:
    ds_read_b32 v139, v242 offset:768
    ds_read_b32 v146, v243 offset:768
    s_waitcnt lgkmcnt(0)
    v_mad_u32_u24 v139, v139, 12, v244
    buffer_load_dwordx3 v[160:162], v139, s[24:27], 0 offen offset:2304 sc1
    v_lshl_add_u32 v146, v146, 5, v2
    s_add_u32 m0, s52, 4096
    s_nop 0
    buffer_load_dwordx4 v146, s[28:31], s98 offen offset:2048 sc1 lds
    s_branch L_r1b
L_r2:
    v_lshrrev_b32 v135, 21, v162
    v_lshlrev_b32 v135, 2, v135
    v_lshrrev_b32 v11, 26, v162
    v_lshl_or_b32 v11, v11, 4, v245
    s_mov_b64 exec, s[96:97]
    ds_add_rtn_u32 v131, v135, v6 offset:8192
    ds_add_u32 v11, v6 offset:14336
    s_mov_b64 exec, -1
    s_mov_b32 exec_hi, 0
    ds_write_b64 v246, v[160:161] offset:1536
    s_mov_b32 exec_hi, -1
    v_and_or_b32 v162, v162, s55, v247
    v_add_u32 v162, 402653184, v162
    s_branch L_r2b
L_r3:
    ds_read_b32 v135, v135 offset:8192
    s_waitcnt lgkmcnt(0)
    v_bfe_u32 v15, v135, 12, 3
    v_or_b32 v162, v15, v162
    v_and_b32 v139, 0x3ff, v135
    v_lshrrev_b32 v135, 16, v135
    v_add_u32 v135, v135, v131
    ds_read_b32 v139, v139 offset:16384
    s_waitcnt lgkmcnt(0)
    v_lshl_add_u32 v135, v135, 2, v139
    s_mov_b64 exec, s[96:97]
    ds_write_b32 v135, v162
    s_mov_b64 exec, -1
    s_branch L_r3b
L_empty:
    v_mul_u32_u24 v205, 9, v205
    v_lshlrev_b32 v12, 2, v1
    v_readlane_b32 s56, v205, 0
    v_readlane_b32 s57, v205, 1
    v_readlane_b32 s58, v205, 2
    v_readlane_b32 s59, v205, 3
    v_readlane_b32 s60, v205, 4
    v_add_u32 v208, s56, v12
    v_add_u32 v209, s57, v12
    v_add_u32 v210, s58, v12
    v_add_u32 v211, s59, v12
    v_add_u32 v212, s60, v12
    s_waitcnt vmcnt(0)
    s_barrier
    s_branch L_swept
L_two:
    s_nop 7
    v_cvt_pk_bf16_f32 v72, v176, v180
    v_cvt_pk_bf16_f32 v80, v176, v180
    v_cvt_pk_bf16_f32 v74, v178, v182
    v_cvt_pk_bf16_f32 v73, v184, v188
    v_cvt_pk_bf16_f32 v81, v184, v188
    v_cvt_pk_bf16_f32 v75, v186, v190
    v_mov_b32_dpp v72, v74 row_ror:8 row_mask:0xf bank_mask:0xc
    s_nop 0
    v_mov_b32_dpp v73, v75 row_ror:8 row_mask:0xf bank_mask:0xc
    v_mov_b32_dpp v74, v80 row_ror:8 row_mask:0xf bank_mask:0x3
    v_mov_b32_dpp v75, v81 row_ror:8 row_mask:0xf bank_mask:0x3
    buffer_store_dwordx4 v[72:75], v214, s[40:43], s87 offen offset:0 sc1
    v_cvt_pk_bf16_f32 v76, v177, v181
    v_cvt_pk_bf16_f32 v82, v177, v181
    v_cvt_pk_bf16_f32 v78, v179, v183
    v_cvt_pk_bf16_f32 v77, v185, v189
    v_cvt_pk_bf16_f32 v83, v185, v189
    v_cvt_pk_bf16_f32 v79, v187, v191
    v_mov_b32_dpp v76, v78 row_ror:8 row_mask:0xf bank_mask:0xc
    s_nop 0
    v_mov_b32_dpp v77, v79 row_ror:8 row_mask:0xf bank_mask:0xc
    v_mov_b32_dpp v78, v82 row_ror:8 row_mask:0xf bank_mask:0x3
    v_mov_b32_dpp v79, v83 row_ror:8 row_mask:0xf bank_mask:0x3
    buffer_store_dwordx4 v[76:79], v214, s[40:43], s87 offen offset:256 sc1
    s_add_u32 s87, s87, 4096
    s_branch L_stored
L_poll:
    buffer_load_dwordx2 v[206:207], v10, s[20:23], s49 offen sc1
    s_sub_u32 s53, s53, 1
    s_cbranch_scc1 L_done
    s_waitcnt vmcnt(0)
    v_xor_b32 v11, s63, v206
    v_xor_b32 v12, s62, v207
    v_and_or_b32 v11, v11, s55, v12
    v_cmpx_ne_u32 vcc, 0, v11
    s_cbranch_execnz L_poll
    s_branch L_polled
L_rank2:
    ds_read_b32 v96, v248 offset:8192
    ds_read_b32 v97, v248 offset:8320
    ds_read_b32 v98, v248 offset:8448
    ds_read_b32 v99, v248 offset:8576
    ds_read_b32 v100, v248 offset:8704
    s_waitcnt lgkmcnt(0)
L_end:
    s_branch L_ranked
.section .rodata,"a"
.p2align 6
.amdhsa_kernel gather_scatter__tensor_product_equiv_mace__graph_kernel
  .amdhsa_next_free_vgpr 256
  .amdhsa_next_free_sgpr 102
  .amdhsa_accum_offset 256
  .amdhsa_group_segment_fixed_size 0
  .amdhsa_kernarg_size 88
  .amdhsa_user_sgpr_count 2
  .amdhsa_user_sgpr_kernarg_segment_ptr 1
  .amdhsa_system_sgpr_workgroup_id_x 1
  .amdhsa_float_denorm_mode_32 3
.end_amdhsa_kernel
```

```asm
; @launch grid=(256,1,1) block=(512,1,1) lds=158784
.amdgcn_target "amdgcn-amd-amdhsa--gfx950"
.text
.globl gather_scatter__tensor_product_equiv_mace__graph_kernel
.p2align 8
.type gather_scatter__tensor_product_equiv_mace__graph_kernel,@function
gather_scatter__tensor_product_equiv_mace__graph_kernel:
    s_cmp_ge_u32 s2, 256
    s_cbranch_scc1 L_done
    s_load_dwordx4 s[4:7], s[0:1], 8
    s_load_dwordx4 s[8:11], s[0:1], 24
    s_load_dwordx2 s[14:15], s[0:1], 80
    s_load_dwordx2 s[64:65], s[0:1], 0
    s_load_dwordx2 s[66:67], s[0:1], 40
    s_load_dwordx4 s[68:71], s[0:1], 48
    s_load_dwordx2 s[12:13], s[0:1], 64
    v_lshlrev_b32 v10, 3, v0
    s_getpc_b64 s[80:81]
L_pc:
    s_and_b32 s44, s2, 0xf8
    s_lshl_b32 s44, s44, 6
    v_and_b32 v11, 0x180, v10
    v_add_u32 v11, s44, v11
    v_min_u32 v11, L_end-L_pc, v11
    v_mov_b32 v113, s81
    v_add_co_u32 v112, vcc, s80, v11
    s_nop 1
    v_addc_co_u32 v113, vcc, 0, v113, vcc
    global_load_dword v205, v[112:113], off
    v_lshrrev_b32 v8, 6, v0
    v_and_b32 v1, 63, v0
    v_lshlrev_b32 v9, 2, v0
    v_mov_b32 v13, 0
    v_readfirstlane_b32 s3, v8
    ds_write_b32 v9, v13 offset:23552
    ds_write_b32 v9, v13 offset:28672
    s_mul_i32 s54, s2, 5000
    s_mul_i32 s55, s2, 10000
    s_mul_i32 s61, s2, 40000
    v_lshlrev_b32 v2, 4, v1
    v_lshlrev_b32 v15, 4, v0
    v_mov_b32 v6, 1
    s_lshl_b32 s52, s3, 10
    s_add_u32 s52, s52, 101376
    s_movk_i32 s53, 4096
    s_movk_i32 s50, 8192
    s_mov_b32 s34, 5000
    s_mov_b32 s35, 0x20000
    s_mov_b32 s38, 5000
    s_mov_b32 s39, 0x20000
    s_mov_b32 s98, 10000
    s_mov_b32 s99, 0x20000
    s_mov_b32 s30, 40000
    s_mov_b32 s31, 0x20000
    s_waitcnt lgkmcnt(0)
    s_add_u32 s32, s6, s54
    s_addc_u32 s33, s7, 0
    buffer_load_dword v64, v9, s[32:35], 0 offen offset:0 nt
    buffer_load_dword v65, v9, s[32:35], 0 offen offset:2048 nt
    buffer_load_dword v66, v9, s[32:35], s53 offen nt
    s_add_u32 s36, s4, s54
    s_addc_u32 s37, s5, 0
    s_barrier
    buffer_load_dword v68, v9, s[36:39], 0 offen offset:0 nt
    buffer_load_dword v69, v9, s[36:39], 0 offen offset:2048 nt
    buffer_load_dword v70, v9, s[36:39], s53 offen nt
    s_load_dword s62, s[14:15], 524288
    s_add_u32 s96, s8, s55
    s_addc_u32 s97, s9, 0
    s_add_u32 s28, s10, s61
    s_addc_u32 s29, s11, 0
    buffer_load_dwordx2 v[72:73], v10, s[96:99], 0 offen nt
    buffer_load_dwordx2 v[74:75], v10, s[96:99], s53 offen nt
    buffer_load_dwordx2 v[76:77], v10, s[96:99], s50 offen nt
    s_add_u32 m0, s52, 0
    s_mov_b32 s54, 0
    buffer_load_dwordx4 v15, s[28:31], s54 offen nt lds
    s_add_u32 m0, s52, 8192
    s_mov_b32 s54, 8192
    buffer_load_dwordx4 v15, s[28:31], s54 offen nt lds
    s_add_u32 m0, s52, 16384
    s_mov_b32 s54, 16384
    buffer_load_dwordx4 v15, s[28:31], s54 offen nt lds
    s_mov_b32 s72, 109951168
    s_movk_i32 s73, 625
    s_movk_i32 s74, 838
    s_movk_i32 s54, 226
    v_cmp_gt_u32 s[84:85], s54, v0
    s_mov_b32 s20, s14
    s_mov_b32 s21, s15
    s_mov_b32 s22, 524352
    s_mov_b32 s23, 0x20000
    v_lshlrev_b32 v11, 2, v0
    v_mov_b32 v12, 0x00700000
    v_mov_b32 v13, 0
    ds_write_b32 v11, v12 offset:0
    ds_write_b32 v11, v12 offset:2048
    ds_write_b32 v11, v12 offset:4096
    ds_write_b32 v11, v12 offset:6144
    ds_write_b32 v11, v13 offset:8192
    ds_write_b32 v11, v13 offset:10240
    ds_write_b32 v11, v13 offset:12288
    ds_write_b32 v11, v13 offset:14336
    s_waitcnt vmcnt(9)
    v_mul_hi_u32 v80, v64, s72
    v_mul_hi_u32 v81, v65, s72
    v_mul_hi_u32 v82, v66, s72
    v_lshlrev_b32 v84, 2, v80
    ds_add_rtn_u32 v88, v84, v6 offset:23552
    v_lshlrev_b32 v85, 2, v81
    ds_add_rtn_u32 v89, v85, v6 offset:23552
    v_lshlrev_b32 v86, 2, v82
    s_mov_b64 exec, s[84:85]
    ds_add_rtn_u32 v90, v86, v6 offset:23552
    s_mov_b64 exec, -1
    s_waitcnt lgkmcnt(0)
    s_barrier
    ds_read_b128 v[100:103], v2 offset:23552
    s_mul_i32 s62, s62, 0x9e3779b1
    s_add_u32 s62, s62, 0x7f4a7c15
    s_mul_i32 s63, s62, 0x85ebca6b
    s_and_b32 s63, s63, 0xffc00000
    s_add_u32 m0, s52, 24576
    s_mov_b32 s54, 24576
    buffer_load_dwordx4 v15, s[28:31], s54 offen nt lds
    s_add_u32 m0, s52, 32768
    s_mov_b32 s54, 32768
    buffer_load_dwordx4 v15, s[28:31], s54 offen nt lds
    v_mad_u32_u24 v92, v80, s73, 15
    v_lshrrev_b32 v92, 4, v92
    v_sub_u32 v92, v64, v92
    v_mad_u32_u24 v93, v81, s73, 15
    v_lshrrev_b32 v93, 4, v93
    v_sub_u32 v93, v65, v93
    v_mad_u32_u24 v94, v82, s73, 15
    v_lshrrev_b32 v94, 4, v94
    v_sub_u32 v94, v66, v94
    s_waitcnt lgkmcnt(0)
    v_add_u32 v11, v100, v101
    v_add3_u32 v11, v11, v102, v103
    v_mov_b32 v12, v11
    s_nop 1
    v_add_u32_dpp v12, v12, v12 row_shr:1 row_mask:0xf bank_mask:0xf
    s_nop 1
    v_add_u32_dpp v12, v12, v12 row_shr:2 row_mask:0xf bank_mask:0xf
    s_nop 1
    v_add_u32_dpp v12, v12, v12 row_shr:4 row_mask:0xf bank_mask:0xf
    s_nop 1
    v_add_u32_dpp v12, v12, v12 row_shr:8 row_mask:0xf bank_mask:0xf
    s_nop 1
    v_add_u32_dpp v12, v12, v12 row_bcast:15 row_mask:0xa bank_mask:0xf
    s_nop 1
    v_add_u32_dpp v12, v12, v12 row_bcast:31 row_mask:0xc bank_mask:0xf
    v_sub_u32 v104, v12, v11
    v_add_u32 v105, v104, v100
    v_add_u32 v106, v105, v101
    v_add_u32 v107, v106, v102
    ds_write_b128 v2, v[104:107] offset:24576
    ds_read_b32 v108, v84 offset:24576
    ds_read_b32 v109, v85 offset:24576
    ds_read_b32 v110, v86 offset:24576
    s_waitcnt vmcnt(8)
    v_mul_u32_u24 v96, s74, v68
    v_bfe_u32 v96, v96, 18, 5
    v_lshl_or_b32 v96, v92, 5, v96
    v_lshlrev_b32 v96, 21, v96
    v_lshl_or_b32 v96, v68, 7, v96
    v_mul_u32_u24 v97, s74, v69
    v_bfe_u32 v97, v97, 18, 5
    v_lshl_or_b32 v97, v93, 5, v97
    v_lshlrev_b32 v97, 21, v97
    v_lshl_or_b32 v97, v69, 7, v97
    v_mul_u32_u24 v98, s74, v70
    v_bfe_u32 v98, v98, 18, 5
    v_lshl_or_b32 v98, v94, 5, v98
    v_lshlrev_b32 v98, 21, v98
    v_lshl_or_b32 v98, v70, 7, v98
    v_lshlrev_b32 v92, 5, v0
    v_add_u32 v93, 16384, v92
    v_add_u32 v94, 32768, v92
    s_mov_b32 s55, 30720
    s_waitcnt vmcnt(5) lgkmcnt(0)
    v_add_u32 v108, v108, v88
    v_lshlrev_b32 v84, 2, v108
    v_mad_u32_u24 v108, v108, 12, s55
    ds_write_b32 v84, v92 offset:25600
    ds_write2_b32 v108, v72, v73 offset0:0 offset1:1
    ds_write_b32 v108, v96 offset:8
    v_add_u32 v109, v109, v89
    v_lshlrev_b32 v85, 2, v109
    v_mad_u32_u24 v109, v109, 12, s55
    ds_write_b32 v85, v93 offset:25600
    ds_write2_b32 v109, v74, v75 offset0:0 offset1:1
    ds_write_b32 v109, v97 offset:8
    v_add_u32 v110, v110, v90
    v_lshlrev_b32 v86, 2, v110
    v_mad_u32_u24 v110, v110, 12, s55
    s_mov_b64 exec, s[84:85]
    ds_write_b32 v86, v94 offset:25600
    ds_write2_b32 v110, v76, v77 offset0:0 offset1:1
    ds_write_b32 v110, v98 offset:8
    s_mov_b64 exec, -1
    s_lshl_b32 s54, s3, 7
    v_lshl_add_u32 v11, v1, 3, s54
    ds_read_b64 v[100:101], v11 offset:23552
    ds_read_b64 v[104:105], v11 offset:24576
    s_mul_i32 s54, s2, 15360
    s_add_u32 s54, s54, 1048576
    s_add_u32 s32, s14, s54
    s_addc_u32 s33, s15, 0
    s_mov_b32 s34, 15360
    s_mov_b32 s35, 0x20000
    s_mul_i32 s54, s2, 40960
    s_add_u32 s54, s54, 5242880
    s_add_u32 s36, s14, s54
    s_addc_u32 s37, s15, 0
    s_mov_b32 s38, 40000
    s_mov_b32 s39, 0x20000
    v_lshrrev_b32 v11, 1, v0
    v_lshlrev_b32 v11, 2, v11
    v_and_b32 v12, 1, v0
    v_lshlrev_b32 v12, 4, v12
    v_add_u32 v12, 101376, v12
    v_add_u32 v14, 30720, v15
    s_waitcnt lgkmcnt(0)
    s_barrier
    ds_read_b128 v[128:131], v14
    ds_read_b128 v[132:135], v14 offset:8192
    ds_read_b32 v156, v11 offset:25600
    ds_read_b32 v157, v11 offset:26624
    ds_read_b32 v158, v11 offset:27648
    ds_read_b32 v159, v11 offset:28672
    ds_read_b32 v160, v11 offset:29696
    s_cmp_lt_u32 s3, 4
    s_cselect_b32 s16, s68, s66
    s_cselect_b32 s17, s69, s67
    s_movk_i32 s54, 128
    s_cselect_b32 s18, s53, s54
    s_mov_b32 s19, 0x20000
    s_min_u32 s54, s3, 5
    s_lshl_b32 s54, s54, 10
    s_add_u32 m0, s54, 17408
    s_and_b32 s54, s54, 0xc00
    buffer_load_dwordx4 v2, s[16:19], s54 offen lds
    s_mov_b32 s40, s70
    s_mov_b32 s41, s71
    s_mov_b32 s42, 32768
    s_mov_b32 s43, 0x20000
    s_lshl_b32 s55, s3, 12
    s_add_u32 m0, s55, 46080
    s_nop 0
    buffer_load_dwordx4 v2, s[40:43], s55 offen offset:0 lds
    buffer_load_dwordx4 v2, s[40:43], s55 offen offset:1024 lds
    buffer_load_dwordx4 v2, s[40:43], s55 offen offset:2048 lds
    buffer_load_dwordx4 v2, s[40:43], s55 offen offset:3072 lds
    s_waitcnt lgkmcnt(0)
    v_add_u32 v156, v12, v156
    v_add_u32 v157, v12, v157
    v_add_u32 v158, v12, v158
    v_add_u32 v159, v12, v159
    v_add_u32 v160, v12, v160
    v_lshl_or_b32 v112, v100, 11, v104
    v_or_b32 v112, s63, v112
    v_mov_b32 v113, s62
    v_lshl_or_b32 v114, v101, 11, v105
    v_or_b32 v114, s63, v114
    v_mov_b32 v115, s62
    s_waitcnt vmcnt(0)
    s_barrier
    ds_read_b128 v[136:139], v156
    ds_read_b128 v[140:143], v157
    ds_read_b128 v[144:147], v158
    ds_read_b128 v[148:151], v159
    ds_read_b128 v[152:155], v160
    buffer_store_dwordx4 v[128:131], v15, s[32:35], 0 offen sc1
    buffer_store_dwordx4 v[132:135], v15, s[32:35], s50 offen sc1
    s_mov_b32 s54, 0
    s_waitcnt lgkmcnt(4)
    buffer_store_dwordx4 v[136:139], v15, s[36:39], s54 offen sc1
    s_mov_b32 s54, 8192
    s_waitcnt lgkmcnt(3)
    buffer_store_dwordx4 v[140:143], v15, s[36:39], s54 offen sc1
    s_mov_b32 s54, 16384
    s_waitcnt lgkmcnt(2)
    buffer_store_dwordx4 v[144:147], v15, s[36:39], s54 offen sc1
    s_mov_b32 s54, 24576
    s_waitcnt lgkmcnt(1)
    buffer_store_dwordx4 v[148:151], v15, s[36:39], s54 offen sc1
    s_mov_b32 s54, 32768
    s_waitcnt lgkmcnt(0)
    buffer_store_dwordx4 v[152:155], v15, s[36:39], s54 offen sc1
    s_and_b32 s44, s2, 7
    s_lshl_b32 s44, s44, 5
    s_lshr_b32 s54, s2, 3
    s_add_u32 s44, s44, s54
    s_mul_i32 s45, s44, 625
    s_add_u32 s46, s45, 640
    s_add_u32 s45, s45, 15
    s_lshr_b32 s45, s45, 4
    s_lshr_b32 s46, s46, 4
    s_sub_u32 s46, s46, s45
    v_bfe_i32 v168, v1, 2, 1
    v_and_b32 v168, 0xaaaa, v168
    v_add_u32 v168, 0x4444, v168
    v_mov_b32 v169, 158720
    v_and_b32 v11, 60, v9
    v_add_u32 v11, v11, v169
    ds_write_b32 v11, v13
    v_and_b32 v11, 4, v1
    v_lshlrev_b32 v11, 2, v11
    v_mov_b32 v12, 0xffff
    v_lshlrev_b32 v12, v11, v12
    v_bfe_i32 v11, v1, 3, 1
    v_and_b32 v191, v11, v12
    v_xor_b32 v190, v191, v12
    v_lshrrev_b32 v200, 5, v1
    v_lshlrev_b32 v200, 4, v200
    v_add_u32 v200, 101376, v200
    v_and_b32 v201, 15, v1
    v_lshlrev_b32 v201, 2, v201
    v_bfe_u32 v11, v1, 3, 2
    v_and_b32 v12, 3, v1
    v_lshl_add_u32 v11, v11, 2, v12
    v_lshlrev_b32 v202, 2, v11
    v_bfe_i32 v240, v0, 0, 1
    s_lshl_b32 s54, s3, 10
    v_and_b32 v241, 4, v240
    v_add_u32 v241, s54, v241
    v_lshl_add_u32 v242, v1, 2, s54
    v_lshrrev_b32 v243, 1, v1
    v_lshl_add_u32 v243, v243, 2, s54
    v_mul_u32_u24 v244, 12, v1
    v_and_b32 v245, 12, v242
    v_and_b32 v250, 124, v242
    s_mul_i32 s54, s3, 224
    v_add_u32 v247, s54, v1
    v_lshlrev_b32 v246, 3, v247
    v_add_u32 v246, 87040, v246
    v_lshlrev_b32 v247, 21, v247
    s_mul_i32 s54, s3, 640
    v_add_u32 v248, s54, v250
    v_sub_u32 v249, 63, v1
    s_getreg_b32 s86, hwreg(HW_REG_XCC_ID, 0, 3)
    s_lshl_b32 s54, s86, 4
    v_subrev_u32 v250, s54, v250
    v_and_b32 v250, 124, v250
    v_min_u32 v251, 39, v1
    v_lshlrev_b32 v251, 7, v251
    v_mov_b32 v253, 0x380
    v_lshrrev_b32 v252, 3, v1
    v_mul_u32_u24 v252, 64, v252
    v_add_u32 v252, 78848, v252
    s_lshr_b32 s87, s3, 1
    s_mul_i32 s87, s87, 3
    s_min_u32 s87, s87, 8
    s_mul_i32 s54, s87, 4608
    v_and_b32 v11, 15, v1
    v_lshrrev_b32 v12, 4, v1
    v_mul_u32_u24 v213, 288, v11
    v_lshl_add_u32 v213, v12, 4, v213
    v_add_u32 v213, s54, v213
    v_lshrrev_b32 v12, 3, v1
    v_lshlrev_b32 v12, 9, v12
    v_and_b32 v11, 7, v1
    v_lshl_add_u32 v214, v11, 4, v12
    s_lshl_b32 s87, s87, 12
    s_and_b32 s54, s3, 1
    s_lshl_b32 s54, s54, 7
    s_add_u32 s87, s87, s54
    s_lshl_b32 s54, s54, 7
    s_add_u32 s54, s54, 46080
    v_add_u32 v215, s54, v2
    s_cmp_eq_u32 s46, 40
    v_mov_b32 v203, 0
    s_mov_b32 s54, 685900808
    s_cselect_b32 s54, 568459824, s54
    s_mov_b32 exec_lo, 31
    s_mov_b32 exec_hi, 0
    v_mov_b32 v203, s54
    s_mov_b32 s54, 182814793
    s_cselect_b32 s54, 23232528, s54
    s_mov_b32 exec_lo, 992
    s_mov_b32 exec_hi, 0
    v_mov_b32 v203, s54
    s_mov_b32 s54, 984091248
    s_cselect_b32 s54, 719688297, s54
    s_mov_b32 exec_lo, 31744
    s_mov_b32 exec_hi, 0
    v_mov_b32 v203, s54
    s_mov_b32 s54, 424091761
    s_cselect_b32 s54, 984423522, s54
    s_mov_b32 exec_lo, 1015808
    s_mov_b32 exec_hi, 0
    v_mov_b32 v203, s54
    s_mov_b32 s54, 586001611
    s_cselect_b32 s54, 172635826, s54
    s_mov_b32 exec_lo, 32505856
    s_mov_b32 exec_hi, 0
    v_mov_b32 v203, s54
    s_mov_b32 s54, 64039106
    s_cselect_b32 s54, 454017211, s54
    s_mov_b32 exec_lo, 1040187392
    s_mov_b32 exec_hi, 0
    v_mov_b32 v203, s54
    s_mov_b32 s54, 330320603
    s_cselect_b32 s54, 743654643, s54
    s_mov_b32 exec_lo, 3221225472
    s_mov_b32 exec_hi, 7
    v_mov_b32 v203, s54
    s_mov_b32 s54, 217139484
    s_cselect_b32 s54, 607143691, s54
    s_mov_b32 exec_lo, 0
    s_mov_b32 exec_hi, 248
    v_mov_b32 v203, s54
    s_mov_b64 exec, -1
    v_mul_u32_u24 v11, 52, v1
    v_lshrrev_b32 v11, 8, v11
    v_mad_i32_i24 v11, v11, -5, v1
    v_mul_u32_u24 v11, 6, v11
    v_lshrrev_b32 v203, v11, v203
    v_and_b32 v11, 7, v203
    v_bfe_u32 v203, v203, 3, 3
    v_lshlrev_b32 v11, 12, v11
    v_lshl_or_b32 v203, v203, 7, v11
    s_add_u32 s24, s14, 1048576
    s_addc_u32 s25, s15, 0
    s_mov_b32 s26, 3932160
    s_mov_b32 s27, 0x20000
    v_mov_b32 v16, 0
    v_mov_b32 v17, 0
    v_mov_b32 v18, 0
    v_mov_b32 v19, 0
    v_mov_b32 v20, 0
    v_mov_b32 v21, 0
    v_mov_b32 v22, 0
    v_mov_b32 v23, 0
    v_mov_b32 v24, 0
    v_mov_b32 v25, 0
    v_mov_b32 v26, 0
    v_mov_b32 v27, 0
    v_mov_b32 v28, 0
    v_mov_b32 v29, 0
    v_mov_b32 v30, 0
    v_mov_b32 v31, 0
    v_mov_b32 v32, 0
    v_mov_b32 v33, 0
    v_mov_b32 v34, 0
    v_mov_b32 v35, 0
    v_mov_b32 v36, 0
    v_mov_b32 v37, 0
    v_mov_b32 v38, 0
    v_mov_b32 v39, 0
    v_mov_b32 v40, 0
    v_mov_b32 v41, 0
    v_mov_b32 v42, 0
    v_mov_b32 v43, 0
    v_mov_b32 v44, 0
    v_mov_b32 v45, 0
    v_mov_b32 v46, 0
    v_mov_b32 v47, 0
    v_mov_b32 v48, 0
    v_mov_b32 v49, 0
    v_mov_b32 v50, 0
    v_mov_b32 v51, 0
    v_mov_b32 v52, 0
    v_mov_b32 v53, 0
    v_mov_b32 v54, 0
    v_mov_b32 v55, 0
    v_mov_b32 v56, 0
    v_mov_b32 v57, 0
    v_mov_b32 v58, 0
    v_mov_b32 v59, 0
    v_mov_b32 v60, 0
    v_mov_b32 v61, 0
    v_mov_b32 v62, 0
    v_mov_b32 v63, 0
    s_lshl_b32 s54, s2, 3
    s_add_u32 s54, s54, s3
    s_lshl_b32 s54, s54, 8
    s_mov_b32 s16, s64
    s_mov_b32 s17, s65
    s_mov_b32 s18, 10240000
    s_mov_b32 s19, 0x20000
    s_add_u32 s28, s14, 5242880
    s_addc_u32 s29, s15, 0
    s_mov_b32 s30, 10485760
    s_mov_b32 s31, 0x20000
    s_and_b32 s51, s86, 7
    s_mul_i32 s51, s51, 1282048
    s_and_b32 s55, s2, 0xf8
    s_add_u32 s55, s55, s3
    s_mul_i32 s55, s55, 2304
    s_add_u32 s51, s51, s55
    v_min_u32 v14, 17, v1
    v_lshlrev_b32 v14, 7, v14
    s_waitcnt vmcnt(0)
    s_barrier
    s_mov_b64 exec, 0xffff
    buffer_store_dwordx4 v[112:115], v2, s[20:23], s54 offen sc1
    s_mov_b64 exec, -1
    buffer_load_dword v7, v14, s[16:19], s51 offen
    s_lshl_b32 s54, s45, 10
    s_add_u32 s40, s12, s54
    s_addc_u32 s41, s13, 0
    s_lshl_b32 s42, s46, 10
    s_mov_b32 s43, 0x20000
    v_lshrrev_b32 v8, 5, v1
    v_lshlrev_b32 v8, 10, v8
    v_and_b32 v9, 15, v1
    v_lshl_add_u32 v8, v9, 4, v8
    ds_read_b128 v[64:67], v8 offset:17408
    ds_read_b128 v[68:71], v8 offset:17664
    ds_read_b128 v[72:75], v8 offset:17920
    ds_read_b128 v[76:79], v8 offset:18176
    ds_read_b128 v[80:83], v8 offset:19456
    ds_read_b128 v[84:87], v8 offset:19712
    ds_read_b128 v[88:91], v8 offset:19968
    ds_read_b128 v[92:95], v8 offset:20224
    v_lshrrev_b32 v8, 4, v1
    v_lshlrev_b32 v8, 5, v8
    v_and_b32 v9, 3, v1
    v_lshl_add_u32 v8, v9, 1, v8
    ds_read_u16 v96, v8 offset:21504
    ds_read_u16 v97, v8 offset:21512
    ds_read_u16 v98, v8 offset:21520
    ds_read_u16 v99, v8 offset:21528
    v_bfe_i32 v10, v1, 4, 1
    v_and_b32 v10, 0x02020202, v10
    v_add_u32 v10, 0x05040100, v10
    s_waitcnt lgkmcnt(0)
    v_perm_b32 v172, v68, v64, v10
    v_perm_b32 v174, v76, v72, v10
    v_perm_b32 v176, v84, v80, v10
    v_perm_b32 v178, v92, v88, v10
    v_perm_b32 v173, v69, v65, v10
    v_perm_b32 v175, v77, v73, v10
    v_perm_b32 v177, v85, v81, v10
    v_perm_b32 v179, v93, v89, v10
    v_perm_b32 v180, v70, v66, v10
    v_perm_b32 v182, v78, v74, v10
    v_perm_b32 v184, v86, v82, v10
    v_perm_b32 v186, v94, v90, v10
    v_perm_b32 v181, v71, v67, v10
    v_perm_b32 v183, v79, v75, v10
    v_perm_b32 v185, v87, v83, v10
    v_perm_b32 v187, v95, v91, v10
    v_lshl_or_b32 v188, v97, 16, v96
    v_lshl_or_b32 v189, v99, 16, v98
    v_and_b32 v9, 7, v1
    v_lshrrev_b32 v8, 4, v1
    v_lshlrev_b32 v8, 13, v8
    v_lshl_add_u32 v8, v9, 4, v8
    v_and_b32 v9, 8, v1
    s_and_b32 s72, s3, 3
    s_lshl_b32 s72, s72, 8
    s_lshr_b32 s73, s3, 2
    s_lshl_b32 s73, s73, 7
    s_add_u32 s72, s72, s73
    s_add_u32 s72, s72, 46080
    v_add3_u32 v8, v8, v9, s72
    ds_read2st64_b64 v[128:131], v8 offset0:0 offset1:2
    ds_read2st64_b64 v[132:135], v8 offset0:4 offset1:6
    ds_read2st64_b64 v[136:139], v8 offset0:8 offset1:10
    ds_read2st64_b64 v[140:143], v8 offset0:12 offset1:14
    s_mov_b32 s72, 0x05040100
    s_mov_b32 s73, 0x07060302
    s_waitcnt lgkmcnt(3)
    v_perm_b32 v144, v130, v128, s72
    v_perm_b32 v148, v130, v128, s73
    v_perm_b32 v152, v131, v129, s72
    v_perm_b32 v156, v131, v129, s73
    s_waitcnt lgkmcnt(2)
    v_perm_b32 v145, v134, v132, s72
    v_perm_b32 v149, v134, v132, s73
    v_perm_b32 v153, v135, v133, s72
    v_perm_b32 v157, v135, v133, s73
    s_waitcnt lgkmcnt(1)
    v_perm_b32 v146, v138, v136, s72
    v_perm_b32 v150, v138, v136, s73
    v_perm_b32 v154, v139, v137, s72
    v_perm_b32 v158, v139, v137, s73
    s_waitcnt lgkmcnt(0)
    v_perm_b32 v147, v142, v140, s72
    v_perm_b32 v151, v142, v140, s73
    v_perm_b32 v155, v143, v141, s72
    v_perm_b32 v159, v143, v141, s73
    v_mov_b32 v64, 0
    v_mov_b32 v65, 0
    v_mov_b32 v66, 0
    v_mov_b32 v67, 0
    v_mov_b32 v68, 0
    v_mov_b32 v69, 0
    v_mov_b32 v70, 0
    v_mov_b32 v71, 0
    v_mov_b32 v72, 0
    v_mov_b32 v73, 0
    v_mov_b32 v74, 0
    v_mov_b32 v75, 0
    v_mov_b32 v76, 0
    v_mov_b32 v77, 0
    v_mov_b32 v78, 0
    v_mov_b32 v79, 0
    v_mov_b32 v80, 0
    v_mov_b32 v81, 0
    v_mov_b32 v82, 0
    v_mov_b32 v83, 0
    v_mov_b32 v84, 0
    v_mov_b32 v85, 0
    v_mov_b32 v86, 0
    v_mov_b32 v87, 0
    v_mov_b32 v88, 0
    v_mov_b32 v89, 0
    v_mov_b32 v90, 0
    v_mov_b32 v91, 0
    v_mov_b32 v92, 0
    v_mov_b32 v93, 0
    v_mov_b32 v94, 0
    v_mov_b32 v95, 0
    s_lshl_b32 s54, s3, 12
    v_add_u32 v8, s54, v2
    v_lshrrev_b32 v9, 1, v0
    v_lshlrev_b32 v10, 11, v9
    s_lshl_b32 s49, s44, 3
    v_mul_u32_u24 v5, 1280, v9
    s_mov_b32 s48, 0
    s_mov_b32 s53, 200000
    s_mov_b32 s55, 0xffc00000
    s_mul_i32 s52, s3, 7168
    s_add_u32 s52, s52, 101376
    s_movk_i32 s98, 4096
    s_waitcnt vmcnt(0)
    s_barrier
    buffer_load_dwordx2 v[206:207], v10, s[20:23], s49 offen sc1
    ds_write_b128 v8, v[144:147] offset:46080
    ds_write_b128 v8, v[148:151] offset:47104
    ds_write_b128 v8, v[152:155] offset:48128
    ds_write_b128 v8, v[156:159] offset:49152
    s_waitcnt vmcnt(0)
    v_xor_b32 v11, s63, v206
    v_xor_b32 v12, s62, v207
    v_and_or_b32 v11, v11, s55, v12
    v_cmpx_ne_u32 vcc, 0, v11
    s_cbranch_execnz L_poll
L_polled:
    s_mov_b64 exec, -1
    v_bfe_u32 v3, v206, 11, 11
    v_and_b32 v4, v3, v240
    v_add_u32 v10, v3, v240
    v_and_b32 v11, 0x7ff, v206
    v_add_u32_dpp v4, v4, v4 row_shr:1 row_mask:0xf bank_mask:0xf
    v_cmp_lt_i32 s[64:65], 0, v10
    v_cmp_lt_i32 s[66:67], 2, v10
    v_add_u32_dpp v4, v4, v4 row_shr:2 row_mask:0xf bank_mask:0xf
    v_cmp_lt_i32 s[68:69], 4, v10
    v_cmp_lt_i32 s[70:71], 6, v10
    v_add_u32_dpp v4, v4, v4 row_shr:4 row_mask:0xf bank_mask:0xf
    v_cmp_lt_i32 s[72:73], 8, v10
    v_cmp_lt_i32 s[74:75], 10, v10
    v_add_u32_dpp v4, v4, v4 row_shr:8 row_mask:0xf bank_mask:0xf
    v_cmp_lt_i32 s[76:77], 12, v10
    v_cmp_lt_i32 s[78:79], 14, v10
    v_add_u32_dpp v4, v4, v4 row_bcast:15 row_mask:0xa bank_mask:0xf
    v_add_u32 v5, v5, v11
    s_nop 0
    v_add_u32_dpp v4, v4, v4 row_bcast:31 row_mask:0xc bank_mask:0xf
    s_nop 0
    v_readlane_b32 s95, v4, 63
    v_mov_b32_dpp v4, v4 quad_perm:[0,0,2,2] row_mask:0xf bank_mask:0xf
    v_sub_u32 v5, v5, v4
    v_lshl_add_u32 v8, v4, 2, v241
    s_cmp_gt_u32 s95, 224
    s_cbranch_scc1 L_clip
L_mapw:
    s_mov_b64 exec, s[64:65]
    ds_write_b32 v8, v5 offset:0
    s_mov_b64 exec, s[66:67]
    ds_write_b32 v8, v5 offset:8
    s_mov_b64 exec, s[68:69]
    ds_write_b32 v8, v5 offset:16
    s_mov_b64 exec, s[70:71]
    ds_write_b32 v8, v5 offset:24
    s_mov_b64 exec, s[72:73]
    ds_write_b32 v8, v5 offset:32
    s_mov_b64 exec, s[74:75]
    ds_write_b32 v8, v5 offset:40
    s_mov_b64 exec, s[76:77]
    ds_write_b32 v8, v5 offset:48
    s_mov_b64 exec, -1
    s_cmp_lg_u64 s[78:79], 0
    s_cbranch_scc1 L_map2
    ds_read_b32 v136, v242 offset:0
    ds_read_b32 v137, v242 offset:256
    ds_read_b32 v138, v242 offset:512
    ds_read_b32 v140, v243 offset:0
    ds_read_b32 v141, v243 offset:128
    ds_read_b32 v142, v243 offset:256
    ds_read_b32 v143, v243 offset:384
    ds_read_b32 v144, v243 offset:512
    ds_read_b32 v145, v243 offset:640
    s_cmp_gt_i32 s95, 192
    s_cbranch_scc1 L_r1
L_r1b:
    s_waitcnt lgkmcnt(6)
    v_mad_u32_u24 v136, v136, 12, v244
    buffer_load_dwordx3 v[148:150], v136, s[24:27], 0 offen offset:0 sc1
    v_mad_u32_u24 v137, v137, 12, v244
    buffer_load_dwordx3 v[152:154], v137, s[24:27], 0 offen offset:768 sc1
    v_mad_u32_u24 v138, v138, 12, v244
    buffer_load_dwordx3 v[156:158], v138, s[24:27], 0 offen offset:1536 sc1
    v_mov_b32 v11, s95
    s_mov_b64 exec, 1
    ds_max_i32 v13, v11 offset:15360
    s_mov_b64 exec, -1
    s_waitcnt lgkmcnt(1)
    v_lshl_add_u32 v140, v140, 5, v2
    v_lshl_add_u32 v141, v141, 5, v2
    v_lshl_add_u32 v142, v142, 5, v2
    v_lshl_add_u32 v143, v143, 5, v2
    v_lshl_add_u32 v144, v144, 5, v2
    v_lshl_add_u32 v145, v145, 5, v2
    s_barrier
    s_add_u32 m0, s52, 0
    s_nop 0
    buffer_load_dwordx4 v140, s[28:31], 0 offen offset:0 sc1 lds
    s_min_i32 s54, s95, 224
    v_cmp_gt_i32 s[80:81], s54, v1
    s_sub_i32 s54, s54, 64
    v_cmp_gt_i32 s[82:83], s54, v1
    s_sub_i32 s54, s54, 64
    v_cmp_gt_i32 s[84:85], s54, v1
    s_sub_i32 s54, s54, 64
    v_cmp_gt_i32 s[96:97], s54, v1
    s_sub_i32 s54, s54, 64
    s_mov_b32 s55, 0x1fff80
    s_mul_i32 s61, s3, 5
    ds_read_b128 v[216:219], v215 offset:0
    ds_read_b128 v[220:223], v215 offset:1024
    ds_read_b128 v[224:227], v215 offset:2048
    ds_read_b128 v[228:231], v215 offset:3072
    ds_read_b128 v[232:235], v215 offset:4096
    ds_read_b128 v[236:239], v215 offset:5120
    s_waitcnt vmcnt(3)
    v_lshrrev_b32 v132, 21, v150
    v_lshlrev_b32 v132, 2, v132
    v_lshrrev_b32 v11, 26, v150
    v_lshl_or_b32 v11, v11, 4, v245
    s_mov_b64 exec, s[80:81]
    ds_add_rtn_u32 v128, v132, v6 offset:8192
    ds_add_u32 v11, v6 offset:14336
    s_mov_b64 exec, -1
    s_waitcnt vmcnt(2)
    v_lshrrev_b32 v133, 21, v154
    v_lshlrev_b32 v133, 2, v133
    v_lshrrev_b32 v11, 26, v154
    v_lshl_or_b32 v11, v11, 4, v245
    s_mov_b64 exec, s[82:83]
    ds_add_rtn_u32 v129, v133, v6 offset:8192
    ds_add_u32 v11, v6 offset:14336
    s_mov_b64 exec, -1
    s_waitcnt vmcnt(1)
    v_lshrrev_b32 v134, 21, v158
    v_lshlrev_b32 v134, 2, v134
    v_lshrrev_b32 v11, 26, v158
    v_lshl_or_b32 v11, v11, 4, v245
    s_mov_b64 exec, s[84:85]
    ds_add_rtn_u32 v130, v134, v6 offset:8192
    ds_add_u32 v11, v6 offset:14336
    s_mov_b64 exec, -1
    s_cmp_gt_i32 s95, 192
    s_cbranch_scc1 L_r2
L_r2b:
    ds_write_b64 v246, v[148:149] offset:0
    v_and_or_b32 v150, v150, s55, v247
    ds_write_b64 v246, v[152:153] offset:512
    v_and_or_b32 v154, v154, s55, v247
    v_add_u32 v154, 134217728, v154
    ds_write_b64 v246, v[156:157] offset:1024
    v_and_or_b32 v158, v158, s55, v247
    v_add_u32 v158, 268435456, v158
    buffer_load_dwordx4 v141, s[28:31], 0 offen offset:1024 sc1 lds
    buffer_load_dwordx4 v142, s[28:31], 0 offen offset:2048 sc1 lds
    s_waitcnt lgkmcnt(3)
    s_barrier
    s_cmp_lg_u32 s48, 0
    s_cbranch_scc1 L_rank2
    ds_read_b128 v[104:107], v2 offset:14336
    ds_read_b32 v96, v248 offset:8192
    ds_read_b32 v97, v248 offset:8320
    ds_read_b32 v98, v248 offset:8448
    ds_read_b32 v99, v248 offset:8576
    ds_read_b32 v100, v248 offset:8704
    ds_read_b32 v14, v13 offset:15360
    s_add_u32 s65, s61, 1
    s_add_u32 s66, s61, 2
    s_add_u32 s67, s61, 3
    s_add_u32 s68, s61, 4
    s_waitcnt lgkmcnt(6)
    v_add_u32 v9, v104, v105
    v_add3_u32 v9, v9, v106, v107
    v_lshl_or_b32 v9, v9, 6, v249
    s_nop 0
    v_readlane_b32 s64, v9, s61
    v_readlane_b32 s65, v9, s65
    v_readlane_b32 s66, v9, s66
    v_readlane_b32 s67, v9, s67
    v_readlane_b32 s68, v9, s68
    v_cmp_lt_u32 s[70:71], s64, v9
    v_cmp_lt_u32 s[72:73], s65, v9
    v_cmp_lt_u32 s[74:75], s66, v9
    v_cmp_lt_u32 s[76:77], s67, v9
    v_cmp_lt_u32 s[78:79], s68, v9
    s_bcnt1_i32_b64 s64, s[70:71]
    s_bcnt1_i32_b64 s65, s[72:73]
    s_bcnt1_i32_b64 s66, s[74:75]
    s_bcnt1_i32_b64 s67, s[76:77]
    s_bcnt1_i32_b64 s68, s[78:79]
    s_waitcnt lgkmcnt(0)
    v_readlane_b32 s90, v203, s64
    v_readlane_b32 s91, v203, s65
    v_readlane_b32 s92, v203, s66
    v_readlane_b32 s93, v203, s67
    v_readlane_b32 s94, v203, s68
    v_readfirstlane_b32 s47, v14
L_ranked:
    s_mov_b32 exec_hi, 0
    v_and_or_b32 v104, s90, v253, v250
    ds_add_rtn_u32 v96, v104, v96 offset:13312
    v_and_or_b32 v105, s91, v253, v250
    ds_add_rtn_u32 v97, v105, v97 offset:13312
    v_and_or_b32 v106, s92, v253, v250
    ds_add_rtn_u32 v98, v106, v98 offset:13312
    v_and_or_b32 v107, s93, v253, v250
    ds_add_rtn_u32 v99, v107, v99 offset:13312
    v_and_or_b32 v108, s94, v253, v250
    ds_add_rtn_u32 v100, v108, v100 offset:13312
    v_or_b32 v104, s90, v250
    v_or_b32 v105, s91, v250
    v_or_b32 v106, s92, v250
    v_or_b32 v107, s93, v250
    v_or_b32 v108, s94, v250
    s_lshl_b32 s54, s3, 3
    s_add_u32 s55, s54, 7
    s_waitcnt lgkmcnt(3)
    v_lshl_or_b32 v96, v96, 16, v104
    ds_write_b32 v248, v96 offset:8192
    v_lshl_or_b32 v97, v97, 16, v105
    ds_write_b32 v248, v97 offset:8320
    s_waitcnt lgkmcnt(2)
    v_lshl_or_b32 v98, v98, 16, v106
    ds_write_b32 v248, v98 offset:8448
    v_lshl_or_b32 v99, v99, 16, v107
    ds_write_b32 v248, v99 offset:8576
    v_lshl_or_b32 v100, v100, 16, v108
    ds_write_b32 v248, v100 offset:8704
    s_mov_b32 exec_hi, -1
    buffer_load_dwordx4 v143, s[28:31], 0 offen offset:3072 sc1 lds
    s_add_u32 m0, s52, 4096
    s_nop 0
    buffer_load_dwordx4 v144, s[28:31], s98 offen offset:0 sc1 lds
    s_waitcnt lgkmcnt(0)
    s_barrier
    ds_read_b128 v[96:99], v2 offset:13312
    ds_read_b32 v132, v132 offset:8192
    ds_read_b32 v133, v133 offset:8192
    ds_read_b32 v134, v134 offset:8192
    s_waitcnt lgkmcnt(3)
    v_add_u32 v9, v96, v97
    v_add3_u32 v9, v9, v98, v99
    v_mov_b32 v10, v9
    s_waitcnt lgkmcnt(0)
    v_bfe_u32 v15, v132, 12, 3
    v_add_u32_dpp v10, v10, v10 row_shr:1 row_mask:0xf bank_mask:0xf
    v_or_b32 v150, v15, v150
    v_and_b32 v136, 0x3ff, v132
    v_add_u32_dpp v10, v10, v10 row_shr:2 row_mask:0xf bank_mask:0xf
    v_lshrrev_b32 v132, 16, v132
    v_add_u32 v132, v132, v128
    v_add_u32_dpp v10, v10, v10 row_shr:4 row_mask:0xf bank_mask:0xf
    v_bfe_u32 v15, v133, 12, 3
    v_or_b32 v154, v15, v154
    v_add_u32_dpp v10, v10, v10 row_shr:8 row_mask:0xf bank_mask:0xf
    v_and_b32 v137, 0x3ff, v133
    v_lshrrev_b32 v133, 16, v133
    v_add_u32_dpp v10, v10, v10 row_bcast:15 row_mask:0xa bank_mask:0xf
    v_add_u32 v133, v133, v129
    v_bfe_u32 v15, v134, 12, 3
    v_add_u32_dpp v10, v10, v10 row_bcast:31 row_mask:0xc bank_mask:0xf
    v_or_b32 v158, v15, v158
    v_and_b32 v138, 0x3ff, v134
    v_sub_u32 v9, v10, v9
    v_lshl_add_u32 v104, v9, 2, v252
    v_lshl_add_u32 v105, v96, 2, v104
    v_lshl_add_u32 v106, v97, 2, v105
    v_lshl_add_u32 v107, v98, 2, v106
    ds_write_b128 v2, v[104:107] offset:16384
    ds_read_b32 v136, v136 offset:16384
    ds_read_b32 v137, v137 offset:16384
    ds_read_b32 v138, v138 offset:16384
    v_lshrrev_b32 v134, 16, v134
    v_add_u32 v134, v134, v130
    v_readlane_b32 s50, v10, s55
    v_readlane_b32 s53, v9, s54
    v_readlane_b32 s51, v104, s54
    v_mov_b32 v14, 2097029
    s_sub_u32 s50, s50, s53
    s_lshl2_add_u32 s55, s50, s51
    v_add_u32 v9, s55, v201
    ds_write_b32 v9, v14
    s_add_u32 s53, s50, 15
    s_lshr_b32 s53, s53, 4
    s_sub_u32 s54, 0, s50
    s_and_b32 s54, s54, 14
    s_sub_u32 s53, s53, 1
    s_cmp_gt_i32 s53, 0
    s_cselect_b32 s54, s54, 0
    s_lshl_b32 s61, s54, 2
    s_sub_u32 s51, s51, s61
    s_waitcnt lgkmcnt(1)
    v_lshl_add_u32 v132, v132, 2, v136
    v_lshl_add_u32 v133, v133, 2, v137
    v_lshl_add_u32 v134, v134, 2, v138
    s_mov_b64 exec, s[80:81]
    ds_write_b32 v132, v150
    s_mov_b64 exec, s[82:83]
    ds_write_b32 v133, v154
    s_mov_b64 exec, s[84:85]
    ds_write_b32 v134, v158
    s_mov_b64 exec, -1
    s_cmp_gt_i32 s95, 192
    s_cbranch_scc1 L_r3
L_r3b:
    buffer_load_dwordx4 v145, s[28:31], s98 offen offset:1024 sc1 lds
    v_add_u32 v198, s51, v201
    v_add_u32 v199, s51, v202
    s_and_b32 s61, s61, 32
    v_add_u32 v12, s61, v198
    s_and_b32 s72, s54, 6
    s_mov_b32 s55, 0x00fffc38
    s_mov_b32 s49, 0xffffff00
    s_mov_b32 s51, 87040
    s_cmp_lt_u32 s3, 4
    s_cbranch_scc1 L_np
    s_setprio 1
L_np:
    s_waitcnt lgkmcnt(0)
    s_barrier
    ds_read_b32 v196, v12
    ds_read_b32 v194, v199
    ds_read_b32 v197, v198 offset:24
    ds_read_b32 v205, v251 offset:8192
    s_cmp_eq_u32 s50, 0
    s_cbranch_scc1 L_empty
    s_waitcnt lgkmcnt(3)
    v_lshlrev_b32 v196, 3, v196
    v_and_b32 v196, s55, v196
    s_cmp_eq_u32 s72, 2
    s_cbranch_scc1 L_p2
    s_cmp_eq_u32 s72, 4
    s_cbranch_scc1 L_p4
    s_cmp_eq_u32 s72, 6
    s_cbranch_scc1 L_p6
L_p0:
    v_readlane_b32 s64, v196, 0
    v_readlane_b32 s65, v196, 1
    s_and_b32 s61, s64, s49
    buffer_load_dwordx4 v[96:99], v2, s[16:19], s61 offen
    s_and_b32 s61, s65, s49
    buffer_load_dwordx4 v[100:103], v2, s[16:19], s61 offen
L_p2:
    v_readlane_b32 s66, v196, 2
    v_readlane_b32 s67, v196, 3
    s_and_b32 s61, s66, s49
    buffer_load_dwordx4 v[104:107], v2, s[16:19], s61 offen
    s_and_b32 s61, s67, s49
    buffer_load_dwordx4 v[108:111], v2, s[16:19], s61 offen
L_p4:
    v_readlane_b32 s68, v196, 4
    v_readlane_b32 s69, v196, 5
    s_and_b32 s61, s68, s49
    buffer_load_dwordx4 v[112:115], v2, s[16:19], s61 offen
    s_and_b32 s61, s69, s49
    buffer_load_dwordx4 v[116:119], v2, s[16:19], s61 offen
    s_cmp_eq_u32 s72, 0
    s_cbranch_scc1 L_pd
L_p6:
    v_readlane_b32 s70, v196, 6
    v_readlane_b32 s71, v196, 7
    s_and_b32 s61, s70, s49
    buffer_load_dwordx4 v[120:123], v2, s[16:19], s61 offen
    s_and_b32 s61, s71, s49
    buffer_load_dwordx4 v[124:127], v2, s[16:19], s61 offen
    s_cmp_eq_u32 s72, 2
    s_cbranch_scc1 L_pd
L_p8:
    v_readlane_b32 s64, v196, 8
    v_readlane_b32 s65, v196, 9
    s_and_b32 s61, s64, s49
    buffer_load_dwordx4 v[96:99], v2, s[16:19], s61 offen
    s_and_b32 s61, s65, s49
    buffer_load_dwordx4 v[100:103], v2, s[16:19], s61 offen
    s_cmp_eq_u32 s72, 4
    s_cbranch_scc1 L_pd
L_p10:
    v_readlane_b32 s66, v196, 10
    v_readlane_b32 s67, v196, 11
    s_and_b32 s61, s66, s49
    buffer_load_dwordx4 v[104:107], v2, s[16:19], s61 offen
    s_and_b32 s61, s67, s49
    buffer_load_dwordx4 v[108:111], v2, s[16:19], s61 offen
L_pd:
    s_waitcnt vmcnt(6) lgkmcnt(0)
    s_barrier
    v_lshrrev_b32 v8, 21, v194
    v_lshl_add_u32 v11, v8, 3, s51
    v_lshl_add_u32 v8, v8, 5, v200
    ds_read_b64 v[192:193], v11
    ds_read_b128 v[164:167], v8
    v_lshlrev_b32 v12, 2, v1
    s_lshl_b32 s61, s3, 7
    v_and_b32 v205, 0x7380, v205
    v_xor_b32 v205, s61, v205
    v_alignbit_b32 v205, v205, v205, 12
    v_cmp_eq_u32 s[80:81], 0, v205
    v_cmp_eq_u32 s[82:83], 1, v205
    v_cmp_eq_u32 s[84:85], 2, v205
    v_cmp_eq_u32 s[96:97], 3, v205
    v_cmp_eq_u32 vcc, 4, v205
    s_ff1_i32_b64 s56, s[80:81]
    s_mul_i32 s56, s56, 1152
    v_add_u32 v208, s56, v12
    s_ff1_i32_b64 s57, s[82:83]
    s_mul_i32 s57, s57, 1152
    v_add_u32 v209, s57, v12
    s_ff1_i32_b64 s58, s[84:85]
    s_mul_i32 s58, s58, 1152
    v_add_u32 v210, s58, v12
    s_ff1_i32_b64 s59, s[96:97]
    s_mul_i32 s59, s59, 1152
    v_add_u32 v211, s59, v12
    s_ff1_i32_b64 s60, vcc
    s_mul_i32 s60, s60, 1152
    v_add_u32 v212, s60, v12
    s_waitcnt lgkmcnt(0)
.p2align 3
    v_mfma_f32_4x4x4_16b_bf16 v[144:147], v[192:193], v[188:189], 0 cbsz:4 abid:0
    v_mfma_f32_4x4x4_16b_bf16 v[148:151], v[192:193], v[188:189], 0 cbsz:4 abid:2
    v_mfma_f32_4x4x4_16b_bf16 v[152:155], v[192:193], v[188:189], 0 cbsz:4 abid:4
    v_mfma_f32_4x4x4_16b_bf16 v[156:159], v[192:193], v[188:189], 0 cbsz:4 abid:6
    v_lshlrev_b32 v196, 3, v197
    v_and_b32 v196, s55, v196
    v_add_u32 v198, 64, v198
    v_add_u32 v199, 64, v199
    v_smfmac_f32_32x32x32_bf16 v[64:79], v[164:167], v[172:179], v168
    ds_read_b32 v197, v198 offset:24
    ds_read_b32 v194, v199
    v_smfmac_f32_32x32x32_bf16 v[80:95], v[164:167], v[180:187], v168
    s_set_gpr_idx_on s54, gpr_idx(SRC0,SRC1)
    v_cvt_pk_bf16_f32 v9, v144, v144
    s_set_gpr_idx_off
    v_and_b32 v160, v190, v9
    v_and_b32 v161, v191, v9
    s_waitcnt lgkmcnt(0)
    v_lshrrev_b32 v8, 21, v194
    v_lshl_add_u32 v11, v8, 3, s51
    v_lshl_add_u32 v8, v8, 5, v200
    ds_read_b64 v[192:193], v11
    ds_read_b128 v[164:167], v8
    s_cmp_eq_u32 s53, 0
    s_cbranch_scc1 L_f0
    s_cmp_eq_u32 s54, 0
    s_cbranch_scc1 L_j0
    s_cmp_eq_u32 s54, 2
    s_cbranch_scc1 L_j2
    ds_read_b128 v[64:67], v169
    ds_read_b128 v[80:83], v169
    s_cmp_eq_u32 s54, 4
    s_cbranch_scc1 L_j4
    s_cmp_eq_u32 s54, 6
    s_cbranch_scc1 L_j6
    ds_read_b128 v[68:71], v169
    ds_read_b128 v[84:87], v169
    s_cmp_eq_u32 s54, 8
    s_cbranch_scc1 L_j8
    s_cmp_eq_u32 s54, 10
    s_cbranch_scc1 L_j10
    ds_read_b128 v[72:75], v169
    ds_read_b128 v[88:91], v169
    s_cmp_eq_u32 s54, 12
    s_cbranch_scc1 L_j12
    s_branch L_j14
.p2align 3
L_loop:
    s_waitcnt lgkmcnt(2)
.p2align 3
    v_mfma_f32_4x4x4_16b_bf16 v[144:147], v[192:193], v[188:189], 0 cbsz:4 abid:0
    v_mfma_f32_4x4x4_16b_bf16 v[148:151], v[192:193], v[188:189], 0 cbsz:4 abid:2
    v_mfma_f32_4x4x4_16b_bf16 v[152:155], v[192:193], v[188:189], 0 cbsz:4 abid:4
    v_mfma_f32_4x4x4_16b_bf16 v[156:159], v[192:193], v[188:189], 0 cbsz:4 abid:6
    v_lshlrev_b32 v196, 3, v197
    v_and_b32 v196, s55, v196
    v_add_u32 v198, 64, v198
    v_add_u32 v199, 64, v199
    s_waitcnt lgkmcnt(0)
.p2align 3
    v_smfmac_f32_32x32x32_bf16 v[64:79], v[164:167], v[172:179], v168
    ds_read_b32 v197, v198 offset:24
    ds_read_b32 v194, v199
    v_cvt_pk_bf16_f32 v9, v144, v144
    v_and_b32 v160, v190, v9
    v_and_b32 v161, v191, v9
    v_smfmac_f32_32x32x32_bf16 v[80:95], v[164:167], v[180:187], v168
L_j0:
    s_waitcnt vmcnt(5)
.p2align 3
    v_mfma_f32_16x16x16_bf16 v[128:131], v[160:161], v[96:97], 0
    v_readlane_b32 s70, v196, 0
    v_cvt_pk_bf16_f32 v10, v145, v145
    v_mfma_f32_16x16x16_bf16 v[132:135], v[160:161], v[98:99], 0
    v_and_b32 v162, v190, v10
    v_and_b32 v163, v191, v10
    s_and_b32 s61, s70, s49
    s_waitcnt vmcnt(4)
    buffer_load_dwordx4 v[120:123], v2, s[16:19], s61 offen
    v_mfma_f32_16x16x16_bf16 v[136:139], v[162:163], v[100:101], 0
    v_readlane_b32 s71, v196, 1
    v_cvt_pk_bf16_f32 v9, v146, v146
    v_mfma_f32_16x16x16_bf16 v[140:143], v[162:163], v[102:103], 0
    v_and_b32 v160, v190, v9
    v_and_b32 v161, v191, v9
    s_and_b32 s61, s71, s49
    s_set_gpr_idx_on s64, gpr_idx(SRC2,DST)
    buffer_load_dwordx4 v[124:127], v2, s[16:19], s61 offen
    v_pk_fma_f32 v[16:17], v[128:129], v[64:65], v[16:17] op_sel_hi:[1,0,1]
    v_pk_fma_f32 v[18:19], v[130:131], v[64:65], v[18:19] op_sel_hi:[1,0,1]
    v_pk_fma_f32 v[20:21], v[132:133], v[80:81], v[20:21] op_sel_hi:[1,0,1]
    v_pk_fma_f32 v[22:23], v[134:135], v[80:81], v[22:23] op_sel_hi:[1,0,1]
    s_set_gpr_idx_idx s65
.p2align 3
    v_pk_fma_f32 v[16:17], v[136:137], v[64:65], v[16:17] op_sel:[0,1,0] op_sel_hi:[1,1,1]
    v_pk_fma_f32 v[18:19], v[138:139], v[64:65], v[18:19] op_sel:[0,1,0] op_sel_hi:[1,1,1]
    v_pk_fma_f32 v[20:21], v[140:141], v[80:81], v[20:21] op_sel:[0,1,0] op_sel_hi:[1,1,1]
    v_pk_fma_f32 v[22:23], v[142:143], v[80:81], v[22:23] op_sel:[0,1,0] op_sel_hi:[1,1,1]
    s_set_gpr_idx_off
L_j2:
    s_waitcnt vmcnt(5)
.p2align 3
    v_mfma_f32_16x16x16_bf16 v[128:131], v[160:161], v[104:105], 0
    v_readlane_b32 s64, v196, 2
    v_cvt_pk_bf16_f32 v10, v147, v147
    v_mfma_f32_16x16x16_bf16 v[132:135], v[160:161], v[106:107], 0
    v_and_b32 v162, v190, v10
    v_and_b32 v163, v191, v10
    s_and_b32 s61, s64, s49
    s_waitcnt vmcnt(4)
    buffer_load_dwordx4 v[96:99], v2, s[16:19], s61 offen
    v_mfma_f32_16x16x16_bf16 v[136:139], v[162:163], v[108:109], 0
    v_readlane_b32 s65, v196, 3
    v_cvt_pk_bf16_f32 v9, v148, v148
    v_mfma_f32_16x16x16_bf16 v[140:143], v[162:163], v[110:111], 0
    v_and_b32 v160, v190, v9
    v_and_b32 v161, v191, v9
    s_waitcnt lgkmcnt(0)
    v_lshrrev_b32 v8, 21, v194
    v_lshl_add_u32 v11, v8, 3, s51
    v_lshl_add_u32 v8, v8, 5, v200
    ds_read_b64 v[192:193], v11
    ds_read_b128 v[164:167], v8
.p2align 3
    s_and_b32 s61, s65, s49
    s_set_gpr_idx_on s66, gpr_idx(SRC2,DST)
    buffer_load_dwordx4 v[100:103], v2, s[16:19], s61 offen
    v_pk_fma_f32 v[16:17], v[128:129], v[66:67], v[16:17] op_sel_hi:[1,0,1]
    v_pk_fma_f32 v[18:19], v[130:131], v[66:67], v[18:19] op_sel_hi:[1,0,1]
    v_pk_fma_f32 v[20:21], v[132:133], v[82:83], v[20:21] op_sel_hi:[1,0,1]
    v_pk_fma_f32 v[22:23], v[134:135], v[82:83], v[22:23] op_sel_hi:[1,0,1]
    s_set_gpr_idx_idx s67
.p2align 3
    v_pk_fma_f32 v[16:17], v[136:137], v[66:67], v[16:17] op_sel:[0,1,0] op_sel_hi:[1,1,1]
    v_pk_fma_f32 v[18:19], v[138:139], v[66:67], v[18:19] op_sel:[0,1,0] op_sel_hi:[1,1,1]
    v_pk_fma_f32 v[20:21], v[140:141], v[82:83], v[20:21] op_sel:[0,1,0] op_sel_hi:[1,1,1]
    v_pk_fma_f32 v[22:23], v[142:143], v[82:83], v[22:23] op_sel:[0,1,0] op_sel_hi:[1,1,1]
    ds_read_b128 v[64:67], v169
    ds_read_b128 v[80:83], v169
    s_set_gpr_idx_off
L_j4:
    s_waitcnt vmcnt(5)
.p2align 3
    v_mfma_f32_16x16x16_bf16 v[128:131], v[160:161], v[112:113], 0
    v_readlane_b32 s66, v196, 4
    v_cvt_pk_bf16_f32 v10, v149, v149
    v_mfma_f32_16x16x16_bf16 v[132:135], v[160:161], v[114:115], 0
    v_and_b32 v162, v190, v10
    v_and_b32 v163, v191, v10
    s_and_b32 s61, s66, s49
    s_waitcnt vmcnt(4)
    buffer_load_dwordx4 v[104:107], v2, s[16:19], s61 offen
    v_mfma_f32_16x16x16_bf16 v[136:139], v[162:163], v[116:117], 0
    v_readlane_b32 s67, v196, 5
    v_cvt_pk_bf16_f32 v9, v150, v150
    v_mfma_f32_16x16x16_bf16 v[140:143], v[162:163], v[118:119], 0
    v_and_b32 v160, v190, v9
    v_and_b32 v161, v191, v9
    s_and_b32 s61, s67, s49
    s_set_gpr_idx_on s68, gpr_idx(SRC2,DST)
    buffer_load_dwordx4 v[108:111], v2, s[16:19], s61 offen
    v_pk_fma_f32 v[16:17], v[128:129], v[68:69], v[16:17] op_sel_hi:[1,0,1]
    v_pk_fma_f32 v[18:19], v[130:131], v[68:69], v[18:19] op_sel_hi:[1,0,1]
    v_pk_fma_f32 v[20:21], v[132:133], v[84:85], v[20:21] op_sel_hi:[1,0,1]
    v_pk_fma_f32 v[22:23], v[134:135], v[84:85], v[22:23] op_sel_hi:[1,0,1]
    s_set_gpr_idx_idx s69
.p2align 3
    v_pk_fma_f32 v[16:17], v[136:137], v[68:69], v[16:17] op_sel:[0,1,0] op_sel_hi:[1,1,1]
    v_pk_fma_f32 v[18:19], v[138:139], v[68:69], v[18:19] op_sel:[0,1,0] op_sel_hi:[1,1,1]
    v_pk_fma_f32 v[20:21], v[140:141], v[84:85], v[20:21] op_sel:[0,1,0] op_sel_hi:[1,1,1]
    v_pk_fma_f32 v[22:23], v[142:143], v[84:85], v[22:23] op_sel:[0,1,0] op_sel_hi:[1,1,1]
    s_set_gpr_idx_off
L_j6:
    s_waitcnt vmcnt(5)
.p2align 3
    v_mfma_f32_16x16x16_bf16 v[128:131], v[160:161], v[120:121], 0
    v_readlane_b32 s68, v196, 6
    v_cvt_pk_bf16_f32 v10, v151, v151
    v_mfma_f32_16x16x16_bf16 v[132:135], v[160:161], v[122:123], 0
    v_and_b32 v162, v190, v10
    v_and_b32 v163, v191, v10
    s_and_b32 s61, s68, s49
    s_waitcnt vmcnt(4)
    buffer_load_dwordx4 v[112:115], v2, s[16:19], s61 offen
    v_mfma_f32_16x16x16_bf16 v[136:139], v[162:163], v[124:125], 0
    v_readlane_b32 s69, v196, 7
    v_cvt_pk_bf16_f32 v9, v152, v152
    v_mfma_f32_16x16x16_bf16 v[140:143], v[162:163], v[126:127], 0
    v_and_b32 v160, v190, v9
    v_and_b32 v161, v191, v9
    s_and_b32 s61, s69, s49
    s_set_gpr_idx_on s70, gpr_idx(SRC2,DST)
    buffer_load_dwordx4 v[116:119], v2, s[16:19], s61 offen
    v_pk_fma_f32 v[16:17], v[128:129], v[70:71], v[16:17] op_sel_hi:[1,0,1]
    v_pk_fma_f32 v[18:19], v[130:131], v[70:71], v[18:19] op_sel_hi:[1,0,1]
    v_pk_fma_f32 v[20:21], v[132:133], v[86:87], v[20:21] op_sel_hi:[1,0,1]
    v_pk_fma_f32 v[22:23], v[134:135], v[86:87], v[22:23] op_sel_hi:[1,0,1]
    s_set_gpr_idx_idx s71
.p2align 3
    v_pk_fma_f32 v[16:17], v[136:137], v[70:71], v[16:17] op_sel:[0,1,0] op_sel_hi:[1,1,1]
    v_pk_fma_f32 v[18:19], v[138:139], v[70:71], v[18:19] op_sel:[0,1,0] op_sel_hi:[1,1,1]
    v_pk_fma_f32 v[20:21], v[140:141], v[86:87], v[20:21] op_sel:[0,1,0] op_sel_hi:[1,1,1]
    v_pk_fma_f32 v[22:23], v[142:143], v[86:87], v[22:23] op_sel:[0,1,0] op_sel_hi:[1,1,1]
    ds_read_b128 v[68:71], v169
    ds_read_b128 v[84:87], v169
    s_set_gpr_idx_off
L_j8:
    s_waitcnt vmcnt(5)
.p2align 3
    v_mfma_f32_16x16x16_bf16 v[128:131], v[160:161], v[96:97], 0
    v_readlane_b32 s70, v196, 8
    v_cvt_pk_bf16_f32 v10, v153, v153
    v_mfma_f32_16x16x16_bf16 v[132:135], v[160:161], v[98:99], 0
    v_and_b32 v162, v190, v10
    v_and_b32 v163, v191, v10
    s_and_b32 s61, s70, s49
    s_waitcnt vmcnt(4)
    buffer_load_dwordx4 v[120:123], v2, s[16:19], s61 offen
    v_mfma_f32_16x16x16_bf16 v[136:139], v[162:163], v[100:101], 0
    v_readlane_b32 s71, v196, 9
    v_cvt_pk_bf16_f32 v9, v154, v154
    v_mfma_f32_16x16x16_bf16 v[140:143], v[162:163], v[102:103], 0
    v_and_b32 v160, v190, v9
    v_and_b32 v161, v191, v9
    s_and_b32 s61, s71, s49
    s_set_gpr_idx_on s64, gpr_idx(SRC2,DST)
    buffer_load_dwordx4 v[124:127], v2, s[16:19], s61 offen
    v_pk_fma_f32 v[16:17], v[128:129], v[72:73], v[16:17] op_sel_hi:[1,0,1]
    v_pk_fma_f32 v[18:19], v[130:131], v[72:73], v[18:19] op_sel_hi:[1,0,1]
    v_pk_fma_f32 v[20:21], v[132:133], v[88:89], v[20:21] op_sel_hi:[1,0,1]
    v_pk_fma_f32 v[22:23], v[134:135], v[88:89], v[22:23] op_sel_hi:[1,0,1]
    s_set_gpr_idx_idx s65
.p2align 3
    v_pk_fma_f32 v[16:17], v[136:137], v[72:73], v[16:17] op_sel:[0,1,0] op_sel_hi:[1,1,1]
    v_pk_fma_f32 v[18:19], v[138:139], v[72:73], v[18:19] op_sel:[0,1,0] op_sel_hi:[1,1,1]
    v_pk_fma_f32 v[20:21], v[140:141], v[88:89], v[20:21] op_sel:[0,1,0] op_sel_hi:[1,1,1]
    v_pk_fma_f32 v[22:23], v[142:143], v[88:89], v[22:23] op_sel:[0,1,0] op_sel_hi:[1,1,1]
    s_set_gpr_idx_off
L_j10:
    s_waitcnt vmcnt(5)
.p2align 3
    v_mfma_f32_16x16x16_bf16 v[128:131], v[160:161], v[104:105], 0
    v_readlane_b32 s64, v196, 10
    v_cvt_pk_bf16_f32 v10, v155, v155
    v_mfma_f32_16x16x16_bf16 v[132:135], v[160:161], v[106:107], 0
    v_and_b32 v162, v190, v10
    v_and_b32 v163, v191, v10
    s_and_b32 s61, s64, s49
    s_waitcnt vmcnt(4)
    buffer_load_dwordx4 v[96:99], v2, s[16:19], s61 offen
    v_mfma_f32_16x16x16_bf16 v[136:139], v[162:163], v[108:109], 0
    v_readlane_b32 s65, v196, 11
    v_cvt_pk_bf16_f32 v9, v156, v156
    v_mfma_f32_16x16x16_bf16 v[140:143], v[162:163], v[110:111], 0
    v_and_b32 v160, v190, v9
    v_and_b32 v161, v191, v9
    s_and_b32 s61, s65, s49
    s_set_gpr_idx_on s66, gpr_idx(SRC2,DST)
    buffer_load_dwordx4 v[100:103], v2, s[16:19], s61 offen
    v_pk_fma_f32 v[16:17], v[128:129], v[74:75], v[16:17] op_sel_hi:[1,0,1]
    v_pk_fma_f32 v[18:19], v[130:131], v[74:75], v[18:19] op_sel_hi:[1,0,1]
    v_pk_fma_f32 v[20:21], v[132:133], v[90:91], v[20:21] op_sel_hi:[1,0,1]
    v_pk_fma_f32 v[22:23], v[134:135], v[90:91], v[22:23] op_sel_hi:[1,0,1]
    s_set_gpr_idx_idx s67
.p2align 3
    v_pk_fma_f32 v[16:17], v[136:137], v[74:75], v[16:17] op_sel:[0,1,0] op_sel_hi:[1,1,1]
    v_pk_fma_f32 v[18:19], v[138:139], v[74:75], v[18:19] op_sel:[0,1,0] op_sel_hi:[1,1,1]
    v_pk_fma_f32 v[20:21], v[140:141], v[90:91], v[20:21] op_sel:[0,1,0] op_sel_hi:[1,1,1]
    v_pk_fma_f32 v[22:23], v[142:143], v[90:91], v[22:23] op_sel:[0,1,0] op_sel_hi:[1,1,1]
    ds_read_b128 v[72:75], v169
    ds_read_b128 v[88:91], v169
    s_set_gpr_idx_off
L_j12:
    s_waitcnt vmcnt(5)
.p2align 3
    v_mfma_f32_16x16x16_bf16 v[128:131], v[160:161], v[112:113], 0
    v_readlane_b32 s66, v196, 12
    v_cvt_pk_bf16_f32 v10, v157, v157
    v_mfma_f32_16x16x16_bf16 v[132:135], v[160:161], v[114:115], 0
    v_and_b32 v162, v190, v10
    v_and_b32 v163, v191, v10
    s_and_b32 s61, s66, s49
    s_waitcnt vmcnt(4)
    buffer_load_dwordx4 v[104:107], v2, s[16:19], s61 offen
    v_mfma_f32_16x16x16_bf16 v[136:139], v[162:163], v[116:117], 0
    v_readlane_b32 s67, v196, 13
    v_cvt_pk_bf16_f32 v9, v158, v158
    v_mfma_f32_16x16x16_bf16 v[140:143], v[162:163], v[118:119], 0
    v_and_b32 v160, v190, v9
    v_and_b32 v161, v191, v9
    s_and_b32 s61, s67, s49
    s_set_gpr_idx_on s68, gpr_idx(SRC2,DST)
    buffer_load_dwordx4 v[108:111], v2, s[16:19], s61 offen
    v_pk_fma_f32 v[16:17], v[128:129], v[76:77], v[16:17] op_sel_hi:[1,0,1]
    v_pk_fma_f32 v[18:19], v[130:131], v[76:77], v[18:19] op_sel_hi:[1,0,1]
    v_pk_fma_f32 v[20:21], v[132:133], v[92:93], v[20:21] op_sel_hi:[1,0,1]
    v_pk_fma_f32 v[22:23], v[134:135], v[92:93], v[22:23] op_sel_hi:[1,0,1]
    s_set_gpr_idx_idx s69
.p2align 3
    v_pk_fma_f32 v[16:17], v[136:137], v[76:77], v[16:17] op_sel:[0,1,0] op_sel_hi:[1,1,1]
    v_pk_fma_f32 v[18:19], v[138:139], v[76:77], v[18:19] op_sel:[0,1,0] op_sel_hi:[1,1,1]
    v_pk_fma_f32 v[20:21], v[140:141], v[92:93], v[20:21] op_sel:[0,1,0] op_sel_hi:[1,1,1]
    v_pk_fma_f32 v[22:23], v[142:143], v[92:93], v[22:23] op_sel:[0,1,0] op_sel_hi:[1,1,1]
    s_set_gpr_idx_off
L_j14:
    s_waitcnt vmcnt(5)
.p2align 3
    v_mfma_f32_16x16x16_bf16 v[128:131], v[160:161], v[120:121], 0
    v_readlane_b32 s68, v196, 14
    v_cvt_pk_bf16_f32 v10, v159, v159
    v_mfma_f32_16x16x16_bf16 v[132:135], v[160:161], v[122:123], 0
    v_and_b32 v162, v190, v10
    v_and_b32 v163, v191, v10
    s_and_b32 s61, s68, s49
    s_waitcnt vmcnt(4)
    buffer_load_dwordx4 v[112:115], v2, s[16:19], s61 offen
    v_mfma_f32_16x16x16_bf16 v[136:139], v[162:163], v[124:125], 0
    v_readlane_b32 s69, v196, 15
    v_mfma_f32_16x16x16_bf16 v[140:143], v[162:163], v[126:127], 0
    s_and_b32 s61, s69, s49
    s_set_gpr_idx_on s70, gpr_idx(SRC2,DST)
    buffer_load_dwordx4 v[116:119], v2, s[16:19], s61 offen
    v_pk_fma_f32 v[16:17], v[128:129], v[78:79], v[16:17] op_sel_hi:[1,0,1]
    v_pk_fma_f32 v[18:19], v[130:131], v[78:79], v[18:19] op_sel_hi:[1,0,1]
    v_pk_fma_f32 v[20:21], v[132:133], v[94:95], v[20:21] op_sel_hi:[1,0,1]
    v_pk_fma_f32 v[22:23], v[134:135], v[94:95], v[22:23] op_sel_hi:[1,0,1]
    s_set_gpr_idx_idx s71
    s_sub_u32 s53, s53, 1
.p2align 3
    v_pk_fma_f32 v[16:17], v[136:137], v[78:79], v[16:17] op_sel:[0,1,0] op_sel_hi:[1,1,1]
    v_pk_fma_f32 v[18:19], v[138:139], v[78:79], v[18:19] op_sel:[0,1,0] op_sel_hi:[1,1,1]
    v_pk_fma_f32 v[20:21], v[140:141], v[94:95], v[20:21] op_sel:[0,1,0] op_sel_hi:[1,1,1]
    v_pk_fma_f32 v[22:23], v[142:143], v[94:95], v[22:23] op_sel:[0,1,0] op_sel_hi:[1,1,1]
    ds_read_b128 v[76:79], v169
    ds_read_b128 v[92:95], v169
    s_set_gpr_idx_off
    s_cmp_lg_u32 s53, 0
    s_cbranch_scc1 L_loop
    s_waitcnt lgkmcnt(2)
.p2align 3
    v_mfma_f32_4x4x4_16b_bf16 v[144:147], v[192:193], v[188:189], 0 cbsz:4 abid:0
    v_mfma_f32_4x4x4_16b_bf16 v[148:151], v[192:193], v[188:189], 0 cbsz:4 abid:2
    v_mfma_f32_4x4x4_16b_bf16 v[152:155], v[192:193], v[188:189], 0 cbsz:4 abid:4
    v_mfma_f32_4x4x4_16b_bf16 v[156:159], v[192:193], v[188:189], 0 cbsz:4 abid:6
    v_lshlrev_b32 v196, 3, v197
    v_and_b32 v196, s55, v196
    s_waitcnt lgkmcnt(0)
.p2align 3
    v_smfmac_f32_32x32x32_bf16 v[64:79], v[164:167], v[172:179], v168
    v_cvt_pk_bf16_f32 v9, v144, v144
    v_and_b32 v160, v190, v9
    v_and_b32 v161, v191, v9
    v_smfmac_f32_32x32x32_bf16 v[80:95], v[164:167], v[180:187], v168
L_f0:
    s_waitcnt vmcnt(5)
.p2align 3
    v_mfma_f32_16x16x16_bf16 v[128:131], v[160:161], v[96:97], 0
    v_readlane_b32 s70, v196, 0
    v_cvt_pk_bf16_f32 v10, v145, v145
    v_mfma_f32_16x16x16_bf16 v[132:135], v[160:161], v[98:99], 0
    v_and_b32 v162, v190, v10
    v_and_b32 v163, v191, v10
    s_and_b32 s61, s70, s49
    s_waitcnt vmcnt(4)
    buffer_load_dwordx4 v[120:123], v2, s[16:19], s61 offen
    v_mfma_f32_16x16x16_bf16 v[136:139], v[162:163], v[100:101], 0
    v_readlane_b32 s71, v196, 1
    v_cvt_pk_bf16_f32 v9, v146, v146
    v_mfma_f32_16x16x16_bf16 v[140:143], v[162:163], v[102:103], 0
    v_and_b32 v160, v190, v9
    v_and_b32 v161, v191, v9
    s_and_b32 s61, s71, s49
    s_set_gpr_idx_on s64, gpr_idx(SRC2,DST)
    buffer_load_dwordx4 v[124:127], v2, s[16:19], s61 offen
    v_pk_fma_f32 v[16:17], v[128:129], v[64:65], v[16:17] op_sel_hi:[1,0,1]
    v_pk_fma_f32 v[18:19], v[130:131], v[64:65], v[18:19] op_sel_hi:[1,0,1]
    v_pk_fma_f32 v[20:21], v[132:133], v[80:81], v[20:21] op_sel_hi:[1,0,1]
    v_pk_fma_f32 v[22:23], v[134:135], v[80:81], v[22:23] op_sel_hi:[1,0,1]
    s_set_gpr_idx_idx s65
.p2align 3
    v_pk_fma_f32 v[16:17], v[136:137], v[64:65], v[16:17] op_sel:[0,1,0] op_sel_hi:[1,1,1]
    v_pk_fma_f32 v[18:19], v[138:139], v[64:65], v[18:19] op_sel:[0,1,0] op_sel_hi:[1,1,1]
    v_pk_fma_f32 v[20:21], v[140:141], v[80:81], v[20:21] op_sel:[0,1,0] op_sel_hi:[1,1,1]
    v_pk_fma_f32 v[22:23], v[142:143], v[80:81], v[22:23] op_sel:[0,1,0] op_sel_hi:[1,1,1]
    s_set_gpr_idx_off
    s_waitcnt vmcnt(5)
.p2align 3
    v_mfma_f32_16x16x16_bf16 v[128:131], v[160:161], v[104:105], 0
    v_readlane_b32 s64, v196, 2
    v_cvt_pk_bf16_f32 v10, v147, v147
    v_mfma_f32_16x16x16_bf16 v[132:135], v[160:161], v[106:107], 0
    v_and_b32 v162, v190, v10
    v_and_b32 v163, v191, v10
    s_and_b32 s61, s64, s49
    s_waitcnt vmcnt(4)
    buffer_load_dwordx4 v[96:99], v2, s[16:19], s61 offen
    v_mfma_f32_16x16x16_bf16 v[136:139], v[162:163], v[108:109], 0
    v_readlane_b32 s65, v196, 3
    v_cvt_pk_bf16_f32 v9, v148, v148
    v_mfma_f32_16x16x16_bf16 v[140:143], v[162:163], v[110:111], 0
    v_and_b32 v160, v190, v9
    v_and_b32 v161, v191, v9
    s_and_b32 s61, s65, s49
    s_set_gpr_idx_on s66, gpr_idx(SRC2,DST)
    buffer_load_dwordx4 v[100:103], v2, s[16:19], s61 offen
    v_pk_fma_f32 v[16:17], v[128:129], v[66:67], v[16:17] op_sel_hi:[1,0,1]
    v_pk_fma_f32 v[18:19], v[130:131], v[66:67], v[18:19] op_sel_hi:[1,0,1]
    v_pk_fma_f32 v[20:21], v[132:133], v[82:83], v[20:21] op_sel_hi:[1,0,1]
    v_pk_fma_f32 v[22:23], v[134:135], v[82:83], v[22:23] op_sel_hi:[1,0,1]
    s_set_gpr_idx_idx s67
.p2align 3
    v_pk_fma_f32 v[16:17], v[136:137], v[66:67], v[16:17] op_sel:[0,1,0] op_sel_hi:[1,1,1]
    v_pk_fma_f32 v[18:19], v[138:139], v[66:67], v[18:19] op_sel:[0,1,0] op_sel_hi:[1,1,1]
    v_pk_fma_f32 v[20:21], v[140:141], v[82:83], v[20:21] op_sel:[0,1,0] op_sel_hi:[1,1,1]
    v_pk_fma_f32 v[22:23], v[142:143], v[82:83], v[22:23] op_sel:[0,1,0] op_sel_hi:[1,1,1]
    s_set_gpr_idx_off
    s_waitcnt vmcnt(5)
.p2align 3
    v_mfma_f32_16x16x16_bf16 v[128:131], v[160:161], v[112:113], 0
    v_readlane_b32 s66, v196, 4
    v_cvt_pk_bf16_f32 v10, v149, v149
    v_mfma_f32_16x16x16_bf16 v[132:135], v[160:161], v[114:115], 0
    v_and_b32 v162, v190, v10
    v_and_b32 v163, v191, v10
    s_and_b32 s61, s66, s49
    s_waitcnt vmcnt(4)
    buffer_load_dwordx4 v[104:107], v2, s[16:19], s61 offen
    v_mfma_f32_16x16x16_bf16 v[136:139], v[162:163], v[116:117], 0
    v_readlane_b32 s67, v196, 5
    v_cvt_pk_bf16_f32 v9, v150, v150
    v_mfma_f32_16x16x16_bf16 v[140:143], v[162:163], v[118:119], 0
    v_and_b32 v160, v190, v9
    v_and_b32 v161, v191, v9
    s_and_b32 s61, s67, s49
    s_set_gpr_idx_on s68, gpr_idx(SRC2,DST)
    buffer_load_dwordx4 v[108:111], v2, s[16:19], s61 offen
    v_pk_fma_f32 v[16:17], v[128:129], v[68:69], v[16:17] op_sel_hi:[1,0,1]
    v_pk_fma_f32 v[18:19], v[130:131], v[68:69], v[18:19] op_sel_hi:[1,0,1]
    v_pk_fma_f32 v[20:21], v[132:133], v[84:85], v[20:21] op_sel_hi:[1,0,1]
    v_pk_fma_f32 v[22:23], v[134:135], v[84:85], v[22:23] op_sel_hi:[1,0,1]
    s_set_gpr_idx_idx s69
.p2align 3
    v_pk_fma_f32 v[16:17], v[136:137], v[68:69], v[16:17] op_sel:[0,1,0] op_sel_hi:[1,1,1]
    v_pk_fma_f32 v[18:19], v[138:139], v[68:69], v[18:19] op_sel:[0,1,0] op_sel_hi:[1,1,1]
    v_pk_fma_f32 v[20:21], v[140:141], v[84:85], v[20:21] op_sel:[0,1,0] op_sel_hi:[1,1,1]
    v_pk_fma_f32 v[22:23], v[142:143], v[84:85], v[22:23] op_sel:[0,1,0] op_sel_hi:[1,1,1]
    s_set_gpr_idx_off
    s_waitcnt vmcnt(5)
.p2align 3
    v_mfma_f32_16x16x16_bf16 v[128:131], v[160:161], v[120:121], 0
    v_readlane_b32 s68, v196, 6
    v_cvt_pk_bf16_f32 v10, v151, v151
    v_mfma_f32_16x16x16_bf16 v[132:135], v[160:161], v[122:123], 0
    v_and_b32 v162, v190, v10
    v_and_b32 v163, v191, v10
    s_and_b32 s61, s68, s49
    s_waitcnt vmcnt(4)
    buffer_load_dwordx4 v[112:115], v2, s[16:19], s61 offen
    v_mfma_f32_16x16x16_bf16 v[136:139], v[162:163], v[124:125], 0
    v_readlane_b32 s69, v196, 7
    v_cvt_pk_bf16_f32 v9, v152, v152
    v_mfma_f32_16x16x16_bf16 v[140:143], v[162:163], v[126:127], 0
    v_and_b32 v160, v190, v9
    v_and_b32 v161, v191, v9
    s_and_b32 s61, s69, s49
    s_set_gpr_idx_on s70, gpr_idx(SRC2,DST)
    buffer_load_dwordx4 v[116:119], v2, s[16:19], s61 offen
    v_pk_fma_f32 v[16:17], v[128:129], v[70:71], v[16:17] op_sel_hi:[1,0,1]
    v_pk_fma_f32 v[18:19], v[130:131], v[70:71], v[18:19] op_sel_hi:[1,0,1]
    v_pk_fma_f32 v[20:21], v[132:133], v[86:87], v[20:21] op_sel_hi:[1,0,1]
    v_pk_fma_f32 v[22:23], v[134:135], v[86:87], v[22:23] op_sel_hi:[1,0,1]
    s_set_gpr_idx_idx s71
.p2align 3
    v_pk_fma_f32 v[16:17], v[136:137], v[70:71], v[16:17] op_sel:[0,1,0] op_sel_hi:[1,1,1]
    v_pk_fma_f32 v[18:19], v[138:139], v[70:71], v[18:19] op_sel:[0,1,0] op_sel_hi:[1,1,1]
    v_pk_fma_f32 v[20:21], v[140:141], v[86:87], v[20:21] op_sel:[0,1,0] op_sel_hi:[1,1,1]
    v_pk_fma_f32 v[22:23], v[142:143], v[86:87], v[22:23] op_sel:[0,1,0] op_sel_hi:[1,1,1]
    s_set_gpr_idx_off
    s_waitcnt vmcnt(5)
.p2align 3
    v_mfma_f32_16x16x16_bf16 v[128:131], v[160:161], v[96:97], 0
    v_readlane_b32 s70, v196, 8
    v_cvt_pk_bf16_f32 v10, v153, v153
    v_mfma_f32_16x16x16_bf16 v[132:135], v[160:161], v[98:99], 0
    v_and_b32 v162, v190, v10
    v_and_b32 v163, v191, v10
    s_and_b32 s61, s70, s49
    s_waitcnt vmcnt(4)
    buffer_load_dwordx4 v[120:123], v2, s[16:19], s61 offen
    v_mfma_f32_16x16x16_bf16 v[136:139], v[162:163], v[100:101], 0
    v_readlane_b32 s71, v196, 9
    v_cvt_pk_bf16_f32 v9, v154, v154
    v_mfma_f32_16x16x16_bf16 v[140:143], v[162:163], v[102:103], 0
    v_and_b32 v160, v190, v9
    v_and_b32 v161, v191, v9
    s_and_b32 s61, s71, s49
    s_set_gpr_idx_on s64, gpr_idx(SRC2,DST)
    buffer_load_dwordx4 v[124:127], v2, s[16:19], s61 offen
    v_pk_fma_f32 v[16:17], v[128:129], v[72:73], v[16:17] op_sel_hi:[1,0,1]
    v_pk_fma_f32 v[18:19], v[130:131], v[72:73], v[18:19] op_sel_hi:[1,0,1]
    v_pk_fma_f32 v[20:21], v[132:133], v[88:89], v[20:21] op_sel_hi:[1,0,1]
    v_pk_fma_f32 v[22:23], v[134:135], v[88:89], v[22:23] op_sel_hi:[1,0,1]
    s_set_gpr_idx_idx s65
.p2align 3
    v_pk_fma_f32 v[16:17], v[136:137], v[72:73], v[16:17] op_sel:[0,1,0] op_sel_hi:[1,1,1]
    v_pk_fma_f32 v[18:19], v[138:139], v[72:73], v[18:19] op_sel:[0,1,0] op_sel_hi:[1,1,1]
    v_pk_fma_f32 v[20:21], v[140:141], v[88:89], v[20:21] op_sel:[0,1,0] op_sel_hi:[1,1,1]
    v_pk_fma_f32 v[22:23], v[142:143], v[88:89], v[22:23] op_sel:[0,1,0] op_sel_hi:[1,1,1]
    s_set_gpr_idx_off
    s_waitcnt vmcnt(5)
.p2align 3
    v_mfma_f32_16x16x16_bf16 v[128:131], v[160:161], v[104:105], 0
    v_cvt_pk_bf16_f32 v10, v155, v155
    v_mfma_f32_16x16x16_bf16 v[132:135], v[160:161], v[106:107], 0
    v_and_b32 v162, v190, v10
    v_and_b32 v163, v191, v10
    s_waitcnt vmcnt(4)
.p2align 3
    s_nop 0
    v_mfma_f32_16x16x16_bf16 v[136:139], v[162:163], v[108:109], 0
    v_cvt_pk_bf16_f32 v9, v156, v156
    v_mfma_f32_16x16x16_bf16 v[140:143], v[162:163], v[110:111], 0
    v_and_b32 v160, v190, v9
    v_and_b32 v161, v191, v9
    s_set_gpr_idx_on s66, gpr_idx(SRC2,DST)
.p2align 3
    v_pk_fma_f32 v[16:17], v[128:129], v[74:75], v[16:17] op_sel_hi:[1,0,1]
    v_pk_fma_f32 v[18:19], v[130:131], v[74:75], v[18:19] op_sel_hi:[1,0,1]
    v_pk_fma_f32 v[20:21], v[132:133], v[90:91], v[20:21] op_sel_hi:[1,0,1]
    v_pk_fma_f32 v[22:23], v[134:135], v[90:91], v[22:23] op_sel_hi:[1,0,1]
    s_set_gpr_idx_idx s67
.p2align 3
    v_pk_fma_f32 v[16:17], v[136:137], v[74:75], v[16:17] op_sel:[0,1,0] op_sel_hi:[1,1,1]
    v_pk_fma_f32 v[18:19], v[138:139], v[74:75], v[18:19] op_sel:[0,1,0] op_sel_hi:[1,1,1]
    v_pk_fma_f32 v[20:21], v[140:141], v[90:91], v[20:21] op_sel:[0,1,0] op_sel_hi:[1,1,1]
    v_pk_fma_f32 v[22:23], v[142:143], v[90:91], v[22:23] op_sel:[0,1,0] op_sel_hi:[1,1,1]
    s_set_gpr_idx_off
    s_waitcnt vmcnt(3)
.p2align 3
    v_mfma_f32_16x16x16_bf16 v[128:131], v[160:161], v[112:113], 0
    v_cvt_pk_bf16_f32 v10, v157, v157
    v_mfma_f32_16x16x16_bf16 v[132:135], v[160:161], v[114:115], 0
    v_and_b32 v162, v190, v10
    v_and_b32 v163, v191, v10
    s_waitcnt vmcnt(2)
.p2align 3
    s_nop 0
    v_mfma_f32_16x16x16_bf16 v[136:139], v[162:163], v[116:117], 0
    v_cvt_pk_bf16_f32 v9, v158, v158
    v_mfma_f32_16x16x16_bf16 v[140:143], v[162:163], v[118:119], 0
    v_and_b32 v160, v190, v9
    v_and_b32 v161, v191, v9
    s_set_gpr_idx_on s68, gpr_idx(SRC2,DST)
.p2align 3
    v_pk_fma_f32 v[16:17], v[128:129], v[76:77], v[16:17] op_sel_hi:[1,0,1]
    v_pk_fma_f32 v[18:19], v[130:131], v[76:77], v[18:19] op_sel_hi:[1,0,1]
    v_pk_fma_f32 v[20:21], v[132:133], v[92:93], v[20:21] op_sel_hi:[1,0,1]
    v_pk_fma_f32 v[22:23], v[134:135], v[92:93], v[22:23] op_sel_hi:[1,0,1]
    s_set_gpr_idx_idx s69
.p2align 3
    v_pk_fma_f32 v[16:17], v[136:137], v[76:77], v[16:17] op_sel:[0,1,0] op_sel_hi:[1,1,1]
    v_pk_fma_f32 v[18:19], v[138:139], v[76:77], v[18:19] op_sel:[0,1,0] op_sel_hi:[1,1,1]
    v_pk_fma_f32 v[20:21], v[140:141], v[92:93], v[20:21] op_sel:[0,1,0] op_sel_hi:[1,1,1]
    v_pk_fma_f32 v[22:23], v[142:143], v[92:93], v[22:23] op_sel:[0,1,0] op_sel_hi:[1,1,1]
    s_set_gpr_idx_off
    s_waitcnt vmcnt(1)
.p2align 3
    v_mfma_f32_16x16x16_bf16 v[128:131], v[160:161], v[120:121], 0
    v_cvt_pk_bf16_f32 v10, v159, v159
    v_mfma_f32_16x16x16_bf16 v[132:135], v[160:161], v[122:123], 0
    v_and_b32 v162, v190, v10
    v_and_b32 v163, v191, v10
    s_waitcnt vmcnt(0)
.p2align 3
    s_nop 0
    v_mfma_f32_16x16x16_bf16 v[136:139], v[162:163], v[124:125], 0
    v_mfma_f32_16x16x16_bf16 v[140:143], v[162:163], v[126:127], 0
    s_set_gpr_idx_on s70, gpr_idx(SRC2,DST)
.p2align 3
    v_pk_fma_f32 v[16:17], v[128:129], v[78:79], v[16:17] op_sel_hi:[1,0,1]
    v_pk_fma_f32 v[18:19], v[130:131], v[78:79], v[18:19] op_sel_hi:[1,0,1]
    v_pk_fma_f32 v[20:21], v[132:133], v[94:95], v[20:21] op_sel_hi:[1,0,1]
    v_pk_fma_f32 v[22:23], v[134:135], v[94:95], v[22:23] op_sel_hi:[1,0,1]
    s_set_gpr_idx_idx s71
.p2align 3
    s_nop 0
    v_pk_fma_f32 v[16:17], v[136:137], v[78:79], v[16:17] op_sel:[0,1,0] op_sel_hi:[1,1,1]
    v_pk_fma_f32 v[18:19], v[138:139], v[78:79], v[18:19] op_sel:[0,1,0] op_sel_hi:[1,1,1]
    v_pk_fma_f32 v[20:21], v[140:141], v[94:95], v[20:21] op_sel:[0,1,0] op_sel_hi:[1,1,1]
    v_pk_fma_f32 v[22:23], v[142:143], v[94:95], v[22:23] op_sel:[0,1,0] op_sel_hi:[1,1,1]
    s_set_gpr_idx_off
L_swept:
    s_add_u32 s48, s48, 224
    s_cmp_lt_u32 s48, s47
    s_cbranch_scc1 L_again
    s_setprio 0
    v_cvt_pk_bf16_f32 v64, v16, v20
    v_cvt_pk_bf16_f32 v65, v17, v21
    v_cvt_pk_bf16_f32 v66, v18, v22
    v_cvt_pk_bf16_f32 v67, v19, v23
    ds_write2_b32 v208, v64, v65 offset0:0 offset1:72
    ds_write2_b32 v208, v66, v67 offset0:144 offset1:216
    v_cvt_pk_bf16_f32 v68, v24, v28
    v_cvt_pk_bf16_f32 v69, v25, v29
    v_cvt_pk_bf16_f32 v70, v26, v30
    v_cvt_pk_bf16_f32 v71, v27, v31
    ds_write2_b32 v209, v68, v69 offset0:0 offset1:72
    ds_write2_b32 v209, v70, v71 offset0:144 offset1:216
    v_cvt_pk_bf16_f32 v72, v32, v36
    v_cvt_pk_bf16_f32 v73, v33, v37
    v_cvt_pk_bf16_f32 v74, v34, v38
    v_cvt_pk_bf16_f32 v75, v35, v39
    ds_write2_b32 v210, v72, v73 offset0:0 offset1:72
    ds_write2_b32 v210, v74, v75 offset0:144 offset1:216
    v_cvt_pk_bf16_f32 v76, v40, v44
    v_cvt_pk_bf16_f32 v77, v41, v45
    v_cvt_pk_bf16_f32 v78, v42, v46
    v_cvt_pk_bf16_f32 v79, v43, v47
    ds_write2_b32 v211, v76, v77 offset0:0 offset1:72
    ds_write2_b32 v211, v78, v79 offset0:144 offset1:216
    v_cvt_pk_bf16_f32 v80, v48, v52
    v_cvt_pk_bf16_f32 v81, v49, v53
    v_cvt_pk_bf16_f32 v82, v50, v54
    v_cvt_pk_bf16_f32 v83, v51, v55
    ds_write2_b32 v212, v80, v81 offset0:0 offset1:72
    ds_write2_b32 v212, v82, v83 offset0:144 offset1:216
    ds_read_b128 v[96:99], v215 offset:6144
    ds_read_b128 v[100:103], v215 offset:7168
    ds_read_b128 v[104:107], v215 offset:8192
    ds_read_b128 v[108:111], v215 offset:9216
    ds_read_b128 v[112:115], v215 offset:10240
    ds_read_b128 v[116:119], v215 offset:11264
    ds_read_b128 v[120:123], v215 offset:12288
    ds_read_b128 v[124:127], v215 offset:13312
    ds_read_b128 v[128:131], v215 offset:14336
    ds_read_b128 v[132:135], v215 offset:15360
    s_waitcnt lgkmcnt(10)
    s_barrier
    ds_read_b128 v[16:19], v213 offset:0
    ds_read_b128 v[20:23], v213 offset:64
    ds_read_b128 v[24:27], v213 offset:128
    ds_read_b128 v[28:31], v213 offset:192
    s_waitcnt lgkmcnt(3)
    v_mfma_f32_16x16x32_bf16 v[160:163], v[16:19], v[216:219], 0
    v_mfma_f32_16x16x32_bf16 v[164:167], v[16:19], v[220:223], 0
    v_mfma_f32_16x16x32_bf16 v[168:171], v[16:19], v[224:227], 0
    v_mfma_f32_16x16x32_bf16 v[172:175], v[16:19], v[228:231], 0
    ds_read_b128 v[32:35], v213 offset:4608
    ds_read_b128 v[36:39], v213 offset:4672
    ds_read_b128 v[40:43], v213 offset:4736
    ds_read_b128 v[44:47], v213 offset:4800
    s_waitcnt lgkmcnt(6)
    v_mfma_f32_16x16x32_bf16 v[160:163], v[20:23], v[232:235], v[160:163]
    v_mfma_f32_16x16x32_bf16 v[164:167], v[20:23], v[236:239], v[164:167]
    v_mfma_f32_16x16x32_bf16 v[168:171], v[20:23], v[96:99], v[168:171]
    v_mfma_f32_16x16x32_bf16 v[172:175], v[20:23], v[100:103], v[172:175]
    ds_read_b128 v[48:51], v213 offset:9216
    ds_read_b128 v[52:55], v213 offset:9280
    ds_read_b128 v[56:59], v213 offset:9344
    ds_read_b128 v[60:63], v213 offset:9408
    s_waitcnt lgkmcnt(9)
    v_mfma_f32_16x16x32_bf16 v[160:163], v[24:27], v[104:107], v[160:163]
    v_mfma_f32_16x16x32_bf16 v[164:167], v[24:27], v[108:111], v[164:167]
    v_mfma_f32_16x16x32_bf16 v[168:171], v[24:27], v[112:115], v[168:171]
    v_mfma_f32_16x16x32_bf16 v[172:175], v[24:27], v[116:119], v[172:175]
    s_waitcnt lgkmcnt(8)
    v_mfma_f32_16x16x32_bf16 v[160:163], v[28:31], v[120:123], v[160:163]
    v_mfma_f32_16x16x32_bf16 v[164:167], v[28:31], v[124:127], v[164:167]
    v_mfma_f32_16x16x32_bf16 v[168:171], v[28:31], v[128:131], v[168:171]
    v_mfma_f32_16x16x32_bf16 v[172:175], v[28:31], v[132:135], v[172:175]
    s_waitcnt lgkmcnt(4)
    v_mfma_f32_16x16x32_bf16 v[176:179], v[32:35], v[216:219], 0
    v_mfma_f32_16x16x32_bf16 v[180:183], v[32:35], v[220:223], 0
    v_mfma_f32_16x16x32_bf16 v[184:187], v[32:35], v[224:227], 0
    v_mfma_f32_16x16x32_bf16 v[188:191], v[32:35], v[228:231], 0
    v_mfma_f32_16x16x32_bf16 v[176:179], v[36:39], v[232:235], v[176:179]
    v_cvt_pk_bf16_f32 v64, v160, v164
    v_cvt_pk_bf16_f32 v80, v160, v164
    v_mfma_f32_16x16x32_bf16 v[180:183], v[36:39], v[236:239], v[180:183]
    v_cvt_pk_bf16_f32 v66, v162, v166
    v_cvt_pk_bf16_f32 v65, v168, v172
    v_mfma_f32_16x16x32_bf16 v[184:187], v[36:39], v[96:99], v[184:187]
    v_cvt_pk_bf16_f32 v81, v168, v172
    v_cvt_pk_bf16_f32 v67, v170, v174
    v_mfma_f32_16x16x32_bf16 v[188:191], v[36:39], v[100:103], v[188:191]
    v_mov_b32_dpp v64, v66 row_ror:8 row_mask:0xf bank_mask:0xc
    v_mov_b32_dpp v65, v67 row_ror:8 row_mask:0xf bank_mask:0xc
    v_mfma_f32_16x16x32_bf16 v[176:179], v[40:43], v[104:107], v[176:179]
    v_mov_b32_dpp v66, v80 row_ror:8 row_mask:0xf bank_mask:0x3
    v_mov_b32_dpp v67, v81 row_ror:8 row_mask:0xf bank_mask:0x3
    v_mfma_f32_16x16x32_bf16 v[180:183], v[40:43], v[108:111], v[180:183]
    buffer_store_dwordx4 v[64:67], v214, s[40:43], s87 offen offset:0 sc1
    v_cvt_pk_bf16_f32 v68, v161, v165
    v_mfma_f32_16x16x32_bf16 v[184:187], v[40:43], v[112:115], v[184:187]
    v_cvt_pk_bf16_f32 v82, v161, v165
    v_cvt_pk_bf16_f32 v70, v163, v167
    v_mfma_f32_16x16x32_bf16 v[188:191], v[40:43], v[116:119], v[188:191]
    v_cvt_pk_bf16_f32 v69, v169, v173
    v_cvt_pk_bf16_f32 v83, v169, v173
    v_mfma_f32_16x16x32_bf16 v[176:179], v[44:47], v[120:123], v[176:179]
    v_cvt_pk_bf16_f32 v71, v171, v175
    v_mov_b32_dpp v68, v70 row_ror:8 row_mask:0xf bank_mask:0xc
    v_mfma_f32_16x16x32_bf16 v[180:183], v[44:47], v[124:127], v[180:183]
    v_mov_b32_dpp v69, v71 row_ror:8 row_mask:0xf bank_mask:0xc
    v_mov_b32_dpp v70, v82 row_ror:8 row_mask:0xf bank_mask:0x3
    v_mfma_f32_16x16x32_bf16 v[184:187], v[44:47], v[128:131], v[184:187]
    v_mov_b32_dpp v71, v83 row_ror:8 row_mask:0xf bank_mask:0x3
    buffer_store_dwordx4 v[68:71], v214, s[40:43], s87 offen offset:256 sc1
    v_mfma_f32_16x16x32_bf16 v[188:191], v[44:47], v[132:135], v[188:191]
    s_add_u32 s87, s87, 4096
    s_cmp_ge_u32 s3, 4
    s_cbranch_scc1 L_two
    s_waitcnt lgkmcnt(0)
    v_mfma_f32_16x16x32_bf16 v[160:163], v[48:51], v[216:219], 0
    v_mfma_f32_16x16x32_bf16 v[164:167], v[48:51], v[220:223], 0
    v_mfma_f32_16x16x32_bf16 v[168:171], v[48:51], v[224:227], 0
    v_mfma_f32_16x16x32_bf16 v[172:175], v[48:51], v[228:231], 0
    v_mfma_f32_16x16x32_bf16 v[160:163], v[52:55], v[232:235], v[160:163]
    v_cvt_pk_bf16_f32 v72, v176, v180
    v_cvt_pk_bf16_f32 v80, v176, v180
    v_mfma_f32_16x16x32_bf16 v[164:167], v[52:55], v[236:239], v[164:167]
    v_cvt_pk_bf16_f32 v74, v178, v182
    v_cvt_pk_bf16_f32 v73, v184, v188
    v_mfma_f32_16x16x32_bf16 v[168:171], v[52:55], v[96:99], v[168:171]
    v_cvt_pk_bf16_f32 v81, v184, v188
    v_cvt_pk_bf16_f32 v75, v186, v190
    v_mfma_f32_16x16x32_bf16 v[172:175], v[52:55], v[100:103], v[172:175]
    v_mov_b32_dpp v72, v74 row_ror:8 row_mask:0xf bank_mask:0xc
    v_mov_b32_dpp v73, v75 row_ror:8 row_mask:0xf bank_mask:0xc
    v_mfma_f32_16x16x32_bf16 v[160:163], v[56:59], v[104:107], v[160:163]
    v_mov_b32_dpp v74, v80 row_ror:8 row_mask:0xf bank_mask:0x3
    v_mov_b32_dpp v75, v81 row_ror:8 row_mask:0xf bank_mask:0x3
    v_mfma_f32_16x16x32_bf16 v[164:167], v[56:59], v[108:111], v[164:167]
    buffer_store_dwordx4 v[72:75], v214, s[40:43], s87 offen offset:0 sc1
    v_cvt_pk_bf16_f32 v76, v177, v181
    v_mfma_f32_16x16x32_bf16 v[168:171], v[56:59], v[112:115], v[168:171]
    v_cvt_pk_bf16_f32 v82, v177, v181
    v_cvt_pk_bf16_f32 v78, v179, v183
    v_mfma_f32_16x16x32_bf16 v[172:175], v[56:59], v[116:119], v[172:175]
    v_cvt_pk_bf16_f32 v77, v185, v189
    v_cvt_pk_bf16_f32 v83, v185, v189
    v_mfma_f32_16x16x32_bf16 v[160:163], v[60:63], v[120:123], v[160:163]
    v_cvt_pk_bf16_f32 v79, v187, v191
    v_mov_b32_dpp v76, v78 row_ror:8 row_mask:0xf bank_mask:0xc
    v_mfma_f32_16x16x32_bf16 v[164:167], v[60:63], v[124:127], v[164:167]
    v_mov_b32_dpp v77, v79 row_ror:8 row_mask:0xf bank_mask:0xc
    v_mov_b32_dpp v78, v82 row_ror:8 row_mask:0xf bank_mask:0x3
    v_mfma_f32_16x16x32_bf16 v[168:171], v[60:63], v[128:131], v[168:171]
    v_mov_b32_dpp v79, v83 row_ror:8 row_mask:0xf bank_mask:0x3
    buffer_store_dwordx4 v[76:79], v214, s[40:43], s87 offen offset:256 sc1
    v_mfma_f32_16x16x32_bf16 v[172:175], v[60:63], v[132:135], v[172:175]
    s_add_u32 s87, s87, 4096
    s_nop 0
    v_cvt_pk_bf16_f32 v64, v160, v164
    v_cvt_pk_bf16_f32 v80, v160, v164
    v_cvt_pk_bf16_f32 v66, v162, v166
    s_nop 2
    v_cvt_pk_bf16_f32 v65, v168, v172
    v_cvt_pk_bf16_f32 v81, v168, v172
    v_cvt_pk_bf16_f32 v67, v170, v174
    v_mov_b32_dpp v64, v66 row_ror:8 row_mask:0xf bank_mask:0xc
    s_nop 0
    v_mov_b32_dpp v65, v67 row_ror:8 row_mask:0xf bank_mask:0xc
    v_mov_b32_dpp v66, v80 row_ror:8 row_mask:0xf bank_mask:0x3
    v_mov_b32_dpp v67, v81 row_ror:8 row_mask:0xf bank_mask:0x3
    buffer_store_dwordx4 v[64:67], v214, s[40:43], s87 offen offset:0 sc1
    v_cvt_pk_bf16_f32 v68, v161, v165
    v_cvt_pk_bf16_f32 v82, v161, v165
    v_cvt_pk_bf16_f32 v70, v163, v167
    v_cvt_pk_bf16_f32 v69, v169, v173
    v_cvt_pk_bf16_f32 v83, v169, v173
    v_cvt_pk_bf16_f32 v71, v171, v175
    v_mov_b32_dpp v68, v70 row_ror:8 row_mask:0xf bank_mask:0xc
    s_nop 0
    v_mov_b32_dpp v69, v71 row_ror:8 row_mask:0xf bank_mask:0xc
    v_mov_b32_dpp v70, v82 row_ror:8 row_mask:0xf bank_mask:0x3
    v_mov_b32_dpp v71, v83 row_ror:8 row_mask:0xf bank_mask:0x3
    buffer_store_dwordx4 v[68:71], v214, s[40:43], s87 offen offset:256 sc1
    s_add_u32 s87, s87, 4096
L_stored:
    s_or_b32 s4, s2, s3
    s_cbranch_scc1 L_notag
    v_mov_b32 v8, s62
    v_lshlrev_b32 v10, 2, v1
    s_mov_b32 s54, 524288
    buffer_store_dword v8, v10, s[20:23], s54 offen sc1
L_notag:
L_done:
    s_endpgm
L_again:
    s_waitcnt vmcnt(0) lgkmcnt(0)
    s_barrier
    v_lshlrev_b32 v11, 2, v0
    v_mov_b32 v12, 0x00700000
    v_mov_b32 v13, 0
    ds_write_b32 v11, v12 offset:0
    ds_write_b32 v11, v12 offset:2048
    ds_write_b32 v11, v12 offset:4096
    ds_write_b32 v11, v12 offset:6144
    ds_write_b32 v11, v13 offset:8192
    ds_write_b32 v11, v13 offset:10240
    ds_write_b32 v11, v13 offset:12288
    v_mov_b32 v64, 0
    v_mov_b32 v65, 0
    v_mov_b32 v66, 0
    v_mov_b32 v67, 0
    v_mov_b32 v68, 0
    v_mov_b32 v69, 0
    v_mov_b32 v70, 0
    v_mov_b32 v71, 0
    v_mov_b32 v72, 0
    v_mov_b32 v73, 0
    v_mov_b32 v74, 0
    v_mov_b32 v75, 0
    v_mov_b32 v76, 0
    v_mov_b32 v77, 0
    v_mov_b32 v78, 0
    v_mov_b32 v79, 0
    v_mov_b32 v80, 0
    v_mov_b32 v81, 0
    v_mov_b32 v82, 0
    v_mov_b32 v83, 0
    v_mov_b32 v84, 0
    v_mov_b32 v85, 0
    v_mov_b32 v86, 0
    v_mov_b32 v87, 0
    v_mov_b32 v88, 0
    v_mov_b32 v89, 0
    v_mov_b32 v90, 0
    v_mov_b32 v91, 0
    v_mov_b32 v92, 0
    v_mov_b32 v93, 0
    v_mov_b32 v94, 0
    v_mov_b32 v95, 0
    v_add_u32 v3, v3, v4
    v_subrev_u32 v3, 224, v3
    v_max_i32 v3, 0, v3
    v_subrev_u32 v4, 224, v4
    v_max_i32 v4, 0, v4
    v_sub_u32 v3, v3, v4
    v_add_u32 v5, 224, v5
    s_sub_i32 s95, s95, 224
    v_lshl_add_u32 v8, v4, 2, v241
    s_waitcnt lgkmcnt(0)
    s_barrier
L_clip:
    v_add_u32 v10, v4, v3
    v_min_i32 v10, 224, v10
    v_sub_u32 v10, v10, v4
    v_add_u32 v10, v10, v240
L_masks:
    v_cmp_lt_i32 s[64:65], 0, v10
    v_cmp_lt_i32 s[66:67], 2, v10
    v_cmp_lt_i32 s[68:69], 4, v10
    v_cmp_lt_i32 s[70:71], 6, v10
    v_cmp_lt_i32 s[72:73], 8, v10
    v_cmp_lt_i32 s[74:75], 10, v10
    v_cmp_lt_i32 s[76:77], 12, v10
    v_cmp_lt_i32 s[78:79], 14, v10
    s_nop 0
    s_branch L_mapw
L_map2:
    v_add_u32 v8, 56, v8
    v_subrev_u32 v10, 14, v10
    s_branch L_masks
L_r1:
    ds_read_b32 v139, v242 offset:768
    ds_read_b32 v146, v243 offset:768
    s_waitcnt lgkmcnt(0)
    v_mad_u32_u24 v139, v139, 12, v244
    buffer_load_dwordx3 v[160:162], v139, s[24:27], 0 offen offset:2304 sc1
    v_lshl_add_u32 v146, v146, 5, v2
    s_add_u32 m0, s52, 4096
    s_nop 0
    buffer_load_dwordx4 v146, s[28:31], s98 offen offset:2048 sc1 lds
    s_branch L_r1b
L_r2:
    v_lshrrev_b32 v135, 21, v162
    v_lshlrev_b32 v135, 2, v135
    v_lshrrev_b32 v11, 26, v162
    v_lshl_or_b32 v11, v11, 4, v245
    s_mov_b64 exec, s[96:97]
    ds_add_rtn_u32 v131, v135, v6 offset:8192
    ds_add_u32 v11, v6 offset:14336
    s_mov_b64 exec, -1
    s_mov_b32 exec_hi, 0
    ds_write_b64 v246, v[160:161] offset:1536
    s_mov_b32 exec_hi, -1
    v_and_or_b32 v162, v162, s55, v247
    v_add_u32 v162, 402653184, v162
    s_branch L_r2b
L_r3:
    ds_read_b32 v135, v135 offset:8192
    s_waitcnt lgkmcnt(0)
    v_bfe_u32 v15, v135, 12, 3
    v_or_b32 v162, v15, v162
    v_and_b32 v139, 0x3ff, v135
    v_lshrrev_b32 v135, 16, v135
    v_add_u32 v135, v135, v131
    ds_read_b32 v139, v139 offset:16384
    s_waitcnt lgkmcnt(0)
    v_lshl_add_u32 v135, v135, 2, v139
    s_mov_b64 exec, s[96:97]
    ds_write_b32 v135, v162
    s_mov_b64 exec, -1
    s_branch L_r3b
L_empty:
    s_waitcnt vmcnt(0) lgkmcnt(0)
    s_barrier
    v_lshlrev_b32 v12, 2, v1
    s_lshl_b32 s61, s3, 7
    v_and_b32 v205, 0x7380, v205
    v_xor_b32 v205, s61, v205
    v_alignbit_b32 v205, v205, v205, 12
    v_cmp_eq_u32 s[80:81], 0, v205
    v_cmp_eq_u32 s[82:83], 1, v205
    v_cmp_eq_u32 s[84:85], 2, v205
    v_cmp_eq_u32 s[96:97], 3, v205
    v_cmp_eq_u32 vcc, 4, v205
    s_ff1_i32_b64 s56, s[80:81]
    s_mul_i32 s56, s56, 1152
    v_add_u32 v208, s56, v12
    s_ff1_i32_b64 s57, s[82:83]
    s_mul_i32 s57, s57, 1152
    v_add_u32 v209, s57, v12
    s_ff1_i32_b64 s58, s[84:85]
    s_mul_i32 s58, s58, 1152
    v_add_u32 v210, s58, v12
    s_ff1_i32_b64 s59, s[96:97]
    s_mul_i32 s59, s59, 1152
    v_add_u32 v211, s59, v12
    s_ff1_i32_b64 s60, vcc
    s_mul_i32 s60, s60, 1152
    v_add_u32 v212, s60, v12
    s_branch L_swept
L_two:
    s_nop 7
    v_cvt_pk_bf16_f32 v72, v176, v180
    v_cvt_pk_bf16_f32 v80, v176, v180
    v_cvt_pk_bf16_f32 v74, v178, v182
    v_cvt_pk_bf16_f32 v73, v184, v188
    v_cvt_pk_bf16_f32 v81, v184, v188
    v_cvt_pk_bf16_f32 v75, v186, v190
    v_mov_b32_dpp v72, v74 row_ror:8 row_mask:0xf bank_mask:0xc
    s_nop 0
    v_mov_b32_dpp v73, v75 row_ror:8 row_mask:0xf bank_mask:0xc
    v_mov_b32_dpp v74, v80 row_ror:8 row_mask:0xf bank_mask:0x3
    v_mov_b32_dpp v75, v81 row_ror:8 row_mask:0xf bank_mask:0x3
    buffer_store_dwordx4 v[72:75], v214, s[40:43], s87 offen offset:0 sc1
    v_cvt_pk_bf16_f32 v76, v177, v181
    v_cvt_pk_bf16_f32 v82, v177, v181
    v_cvt_pk_bf16_f32 v78, v179, v183
    v_cvt_pk_bf16_f32 v77, v185, v189
    v_cvt_pk_bf16_f32 v83, v185, v189
    v_cvt_pk_bf16_f32 v79, v187, v191
    v_mov_b32_dpp v76, v78 row_ror:8 row_mask:0xf bank_mask:0xc
    s_nop 0
    v_mov_b32_dpp v77, v79 row_ror:8 row_mask:0xf bank_mask:0xc
    v_mov_b32_dpp v78, v82 row_ror:8 row_mask:0xf bank_mask:0x3
    v_mov_b32_dpp v79, v83 row_ror:8 row_mask:0xf bank_mask:0x3
    buffer_store_dwordx4 v[76:79], v214, s[40:43], s87 offen offset:256 sc1
    s_add_u32 s87, s87, 4096
    s_branch L_stored
L_poll:
    buffer_load_dwordx2 v[206:207], v10, s[20:23], s49 offen sc1
    s_sub_u32 s53, s53, 1
    s_cbranch_scc1 L_done
    s_waitcnt vmcnt(0)
    v_xor_b32 v11, s63, v206
    v_xor_b32 v12, s62, v207
    v_and_or_b32 v11, v11, s55, v12
    v_cmpx_ne_u32 vcc, 0, v11
    s_cbranch_execnz L_poll
    s_branch L_polled
L_rank2:
    ds_read_b32 v96, v248 offset:8192
    ds_read_b32 v97, v248 offset:8320
    ds_read_b32 v98, v248 offset:8448
    ds_read_b32 v99, v248 offset:8576
    ds_read_b32 v100, v248 offset:8704
    s_waitcnt lgkmcnt(0)
L_end:
    s_branch L_ranked
.section .rodata,"a"
.p2align 6
.amdhsa_kernel gather_scatter__tensor_product_equiv_mace__graph_kernel
  .amdhsa_next_free_vgpr 256
  .amdhsa_next_free_sgpr 102
  .amdhsa_accum_offset 256
  .amdhsa_group_segment_fixed_size 0
  .amdhsa_kernarg_size 88
  .amdhsa_user_sgpr_count 2
  .amdhsa_user_sgpr_kernarg_segment_ptr 1
  .amdhsa_system_sgpr_workgroup_id_x 1
  .amdhsa_float_denorm_mode_32 3
.end_amdhsa_kernel
```

```asm
; @launch grid=(256,1,1) block=(512,1,1) lds=158784
.amdgcn_target "amdgcn-amd-amdhsa--gfx950"
.text
.globl gather_scatter__tensor_product_equiv_mace__graph_kernel
.p2align 8
.type gather_scatter__tensor_product_equiv_mace__graph_kernel,@function
gather_scatter__tensor_product_equiv_mace__graph_kernel:
    s_cmp_ge_u32 s2, 256
    s_cbranch_scc1 L_done
    s_load_dwordx4 s[4:7], s[0:1], 8
    s_load_dwordx4 s[8:11], s[0:1], 24
    s_load_dwordx2 s[14:15], s[0:1], 80
    s_load_dwordx2 s[64:65], s[0:1], 0
    s_load_dwordx2 s[66:67], s[0:1], 40
    s_load_dwordx4 s[68:71], s[0:1], 48
    s_load_dwordx2 s[12:13], s[0:1], 64
    v_lshlrev_b32 v10, 3, v0
    s_getpc_b64 s[80:81]
L_pc:
    s_and_b32 s44, s2, 0xf8
    s_lshl_b32 s44, s44, 6
    v_and_b32 v11, 0x180, v10
    v_add_u32 v11, s44, v11
    v_min_u32 v11, L_end-L_pc, v11
    v_mov_b32 v113, s81
    v_add_co_u32 v112, vcc, s80, v11
    s_nop 1
    v_addc_co_u32 v113, vcc, 0, v113, vcc
    global_load_dword v205, v[112:113], off
    v_lshrrev_b32 v8, 6, v0
    v_and_b32 v1, 63, v0
    v_lshlrev_b32 v9, 2, v0
    v_mov_b32 v13, 0
    v_readfirstlane_b32 s3, v8
    ds_write_b32 v9, v13 offset:23552
    ds_write_b32 v9, v13 offset:28672
    s_mul_i32 s54, s2, 5000
    s_mul_i32 s55, s2, 10000
    s_mul_i32 s61, s2, 40000
    v_lshlrev_b32 v2, 4, v1
    v_lshlrev_b32 v15, 4, v0
    v_mov_b32 v6, 1
    s_lshl_b32 s52, s3, 10
    s_add_u32 s52, s52, 101376
    s_movk_i32 s53, 4096
    s_movk_i32 s50, 8192
    s_mov_b32 s34, 5000
    s_mov_b32 s35, 0x20000
    s_mov_b32 s38, 5000
    s_mov_b32 s39, 0x20000
    s_mov_b32 s98, 10000
    s_mov_b32 s99, 0x20000
    s_mov_b32 s30, 40000
    s_mov_b32 s31, 0x20000
    s_waitcnt lgkmcnt(0)
    s_add_u32 s32, s6, s54
    s_addc_u32 s33, s7, 0
    buffer_load_dword v64, v9, s[32:35], 0 offen offset:0 nt
    buffer_load_dword v65, v9, s[32:35], 0 offen offset:2048 nt
    buffer_load_dword v66, v9, s[32:35], s53 offen nt
    s_add_u32 s36, s4, s54
    s_addc_u32 s37, s5, 0
    s_barrier
    buffer_load_dword v68, v9, s[36:39], 0 offen offset:0 nt
    buffer_load_dword v69, v9, s[36:39], 0 offen offset:2048 nt
    buffer_load_dword v70, v9, s[36:39], s53 offen nt
    s_load_dword s62, s[14:15], 524288
    s_add_u32 s96, s8, s55
    s_addc_u32 s97, s9, 0
    s_add_u32 s28, s10, s61
    s_addc_u32 s29, s11, 0
    buffer_load_dwordx2 v[72:73], v10, s[96:99], 0 offen nt
    buffer_load_dwordx2 v[74:75], v10, s[96:99], s53 offen nt
    buffer_load_dwordx2 v[76:77], v10, s[96:99], s50 offen nt
    s_add_u32 m0, s52, 0
    s_mov_b32 s54, 0
    buffer_load_dwordx4 v15, s[28:31], s54 offen nt lds
    s_add_u32 m0, s52, 8192
    s_mov_b32 s54, 8192
    buffer_load_dwordx4 v15, s[28:31], s54 offen nt lds
    s_add_u32 m0, s52, 16384
    s_mov_b32 s54, 16384
    buffer_load_dwordx4 v15, s[28:31], s54 offen nt lds
    s_mov_b32 s72, 109951168
    s_movk_i32 s73, 625
    s_movk_i32 s74, 838
    s_movk_i32 s54, 226
    v_cmp_gt_u32 s[84:85], s54, v0
    s_mov_b32 s20, s14
    s_mov_b32 s21, s15
    s_mov_b32 s22, 524352
    s_mov_b32 s23, 0x20000
    v_lshlrev_b32 v11, 2, v0
    v_mov_b32 v12, 0x00700000
    v_mov_b32 v13, 0
    ds_write_b32 v11, v12 offset:0
    ds_write_b32 v11, v12 offset:2048
    ds_write_b32 v11, v12 offset:4096
    ds_write_b32 v11, v12 offset:6144
    ds_write_b32 v11, v13 offset:8192
    ds_write_b32 v11, v13 offset:10240
    ds_write_b32 v11, v13 offset:12288
    ds_write_b32 v11, v13 offset:14336
    s_waitcnt vmcnt(9)
    v_mul_hi_u32 v80, v64, s72
    v_mul_hi_u32 v81, v65, s72
    v_mul_hi_u32 v82, v66, s72
    v_lshlrev_b32 v84, 2, v80
    ds_add_rtn_u32 v88, v84, v6 offset:23552
    v_lshlrev_b32 v85, 2, v81
    ds_add_rtn_u32 v89, v85, v6 offset:23552
    v_lshlrev_b32 v86, 2, v82
    s_mov_b64 exec, s[84:85]
    ds_add_rtn_u32 v90, v86, v6 offset:23552
    s_mov_b64 exec, -1
    s_waitcnt lgkmcnt(0)
    s_barrier
    ds_read_b128 v[100:103], v2 offset:23552
    s_mul_i32 s62, s62, 0x9e3779b1
    s_add_u32 s62, s62, 0x7f4a7c15
    s_mul_i32 s63, s62, 0x85ebca6b
    s_and_b32 s63, s63, 0xffc00000
    s_add_u32 m0, s52, 24576
    s_mov_b32 s54, 24576
    buffer_load_dwordx4 v15, s[28:31], s54 offen nt lds
    s_add_u32 m0, s52, 32768
    s_mov_b32 s54, 32768
    buffer_load_dwordx4 v15, s[28:31], s54 offen nt lds
    v_mad_u32_u24 v92, v80, s73, 15
    v_lshrrev_b32 v92, 4, v92
    v_sub_u32 v92, v64, v92
    v_mad_u32_u24 v93, v81, s73, 15
    v_lshrrev_b32 v93, 4, v93
    v_sub_u32 v93, v65, v93
    v_mad_u32_u24 v94, v82, s73, 15
    v_lshrrev_b32 v94, 4, v94
    v_sub_u32 v94, v66, v94
    s_waitcnt lgkmcnt(0)
    v_add_u32 v11, v100, v101
    v_add3_u32 v11, v11, v102, v103
    v_mov_b32 v12, v11
    s_nop 1
    v_add_u32_dpp v12, v12, v12 row_shr:1 row_mask:0xf bank_mask:0xf
    s_nop 1
    v_add_u32_dpp v12, v12, v12 row_shr:2 row_mask:0xf bank_mask:0xf
    s_nop 1
    v_add_u32_dpp v12, v12, v12 row_shr:4 row_mask:0xf bank_mask:0xf
    s_nop 1
    v_add_u32_dpp v12, v12, v12 row_shr:8 row_mask:0xf bank_mask:0xf
    s_nop 1
    v_add_u32_dpp v12, v12, v12 row_bcast:15 row_mask:0xa bank_mask:0xf
    s_nop 1
    v_add_u32_dpp v12, v12, v12 row_bcast:31 row_mask:0xc bank_mask:0xf
    v_sub_u32 v104, v12, v11
    v_add_u32 v105, v104, v100
    v_add_u32 v106, v105, v101
    v_add_u32 v107, v106, v102
    ds_write_b128 v2, v[104:107] offset:24576
    ds_read_b32 v108, v84 offset:24576
    ds_read_b32 v109, v85 offset:24576
    ds_read_b32 v110, v86 offset:24576
    s_waitcnt vmcnt(8)
    v_mul_u32_u24 v96, s74, v68
    v_bfe_u32 v96, v96, 18, 5
    v_lshl_or_b32 v96, v92, 5, v96
    v_lshlrev_b32 v96, 21, v96
    v_lshl_or_b32 v96, v68, 7, v96
    v_mul_u32_u24 v97, s74, v69
    v_bfe_u32 v97, v97, 18, 5
    v_lshl_or_b32 v97, v93, 5, v97
    v_lshlrev_b32 v97, 21, v97
    v_lshl_or_b32 v97, v69, 7, v97
    v_mul_u32_u24 v98, s74, v70
    v_bfe_u32 v98, v98, 18, 5
    v_lshl_or_b32 v98, v94, 5, v98
    v_lshlrev_b32 v98, 21, v98
    v_lshl_or_b32 v98, v70, 7, v98
    v_lshlrev_b32 v92, 5, v0
    v_add_u32 v93, 16384, v92
    v_add_u32 v94, 32768, v92
    s_mov_b32 s55, 30720
    s_waitcnt vmcnt(5) lgkmcnt(0)
    v_add_u32 v108, v108, v88
    v_lshlrev_b32 v84, 2, v108
    v_mad_u32_u24 v108, v108, 12, s55
    ds_write_b32 v84, v92 offset:25600
    ds_write2_b32 v108, v72, v73 offset0:0 offset1:1
    ds_write_b32 v108, v96 offset:8
    v_add_u32 v109, v109, v89
    v_lshlrev_b32 v85, 2, v109
    v_mad_u32_u24 v109, v109, 12, s55
    ds_write_b32 v85, v93 offset:25600
    ds_write2_b32 v109, v74, v75 offset0:0 offset1:1
    ds_write_b32 v109, v97 offset:8
    v_add_u32 v110, v110, v90
    v_lshlrev_b32 v86, 2, v110
    v_mad_u32_u24 v110, v110, 12, s55
    s_mov_b64 exec, s[84:85]
    ds_write_b32 v86, v94 offset:25600
    ds_write2_b32 v110, v76, v77 offset0:0 offset1:1
    ds_write_b32 v110, v98 offset:8
    s_mov_b64 exec, -1
    s_lshl_b32 s54, s3, 7
    v_lshl_add_u32 v11, v1, 3, s54
    ds_read_b64 v[100:101], v11 offset:23552
    ds_read_b64 v[104:105], v11 offset:24576
    s_mul_i32 s54, s2, 15360
    s_add_u32 s54, s54, 1048576
    s_add_u32 s32, s14, s54
    s_addc_u32 s33, s15, 0
    s_mov_b32 s34, 15360
    s_mov_b32 s35, 0x20000
    s_mul_i32 s54, s2, 40960
    s_add_u32 s54, s54, 5242880
    s_add_u32 s36, s14, s54
    s_addc_u32 s37, s15, 0
    s_mov_b32 s38, 40000
    s_mov_b32 s39, 0x20000
    v_lshrrev_b32 v11, 1, v0
    v_lshlrev_b32 v11, 2, v11
    v_and_b32 v12, 1, v0
    v_lshlrev_b32 v12, 4, v12
    v_add_u32 v12, 101376, v12
    v_add_u32 v14, 30720, v15
    s_waitcnt lgkmcnt(0)
    s_barrier
    ds_read_b128 v[128:131], v14
    ds_read_b128 v[132:135], v14 offset:8192
    ds_read_b32 v156, v11 offset:25600
    ds_read_b32 v157, v11 offset:26624
    ds_read_b32 v158, v11 offset:27648
    ds_read_b32 v159, v11 offset:28672
    ds_read_b32 v160, v11 offset:29696
    s_cmp_lt_u32 s3, 4
    s_cselect_b32 s16, s68, s66
    s_cselect_b32 s17, s69, s67
    s_movk_i32 s54, 128
    s_cselect_b32 s18, s53, s54
    s_mov_b32 s19, 0x20000
    s_min_u32 s54, s3, 5
    s_lshl_b32 s54, s54, 10
    s_add_u32 m0, s54, 17408
    s_and_b32 s54, s54, 0xc00
    buffer_load_dwordx4 v2, s[16:19], s54 offen lds
    s_mov_b32 s40, s70
    s_mov_b32 s41, s71
    s_mov_b32 s42, 32768
    s_mov_b32 s43, 0x20000
    s_lshl_b32 s55, s3, 12
    s_add_u32 m0, s55, 46080
    s_nop 0
    buffer_load_dwordx4 v2, s[40:43], s55 offen offset:0 lds
    buffer_load_dwordx4 v2, s[40:43], s55 offen offset:1024 lds
    buffer_load_dwordx4 v2, s[40:43], s55 offen offset:2048 lds
    buffer_load_dwordx4 v2, s[40:43], s55 offen offset:3072 lds
    s_waitcnt lgkmcnt(0)
    v_add_u32 v156, v12, v156
    v_add_u32 v157, v12, v157
    v_add_u32 v158, v12, v158
    v_add_u32 v159, v12, v159
    v_add_u32 v160, v12, v160
    v_lshl_or_b32 v112, v100, 11, v104
    v_or_b32 v112, s63, v112
    v_mov_b32 v113, s62
    v_lshl_or_b32 v114, v101, 11, v105
    v_or_b32 v114, s63, v114
    v_mov_b32 v115, s62
    s_waitcnt vmcnt(0)
    s_barrier
    ds_read_b128 v[136:139], v156
    ds_read_b128 v[140:143], v157
    ds_read_b128 v[144:147], v158
    ds_read_b128 v[148:151], v159
    ds_read_b128 v[152:155], v160
    buffer_store_dwordx4 v[128:131], v15, s[32:35], 0 offen sc1
    buffer_store_dwordx4 v[132:135], v15, s[32:35], s50 offen sc1
    s_mov_b32 s54, 0
    s_waitcnt lgkmcnt(4)
    buffer_store_dwordx4 v[136:139], v15, s[36:39], s54 offen sc1
    s_mov_b32 s54, 8192
    s_waitcnt lgkmcnt(3)
    buffer_store_dwordx4 v[140:143], v15, s[36:39], s54 offen sc1
    s_mov_b32 s54, 16384
    s_waitcnt lgkmcnt(2)
    buffer_store_dwordx4 v[144:147], v15, s[36:39], s54 offen sc1
    s_mov_b32 s54, 24576
    s_waitcnt lgkmcnt(1)
    buffer_store_dwordx4 v[148:151], v15, s[36:39], s54 offen sc1
    s_mov_b32 s54, 32768
    s_waitcnt lgkmcnt(0)
    buffer_store_dwordx4 v[152:155], v15, s[36:39], s54 offen sc1
    s_and_b32 s44, s2, 7
    s_lshl_b32 s44, s44, 5
    s_lshr_b32 s54, s2, 3
    s_add_u32 s44, s44, s54
    s_mul_i32 s45, s44, 625
    s_add_u32 s46, s45, 640
    s_add_u32 s45, s45, 15
    s_lshr_b32 s45, s45, 4
    s_lshr_b32 s46, s46, 4
    s_sub_u32 s46, s46, s45
    v_bfe_i32 v168, v1, 2, 1
    v_and_b32 v168, 0xaaaa, v168
    v_add_u32 v168, 0x4444, v168
    v_mov_b32 v169, 158720
    v_and_b32 v11, 60, v9
    v_add_u32 v11, v11, v169
    ds_write_b32 v11, v13
    v_and_b32 v11, 4, v1
    v_lshlrev_b32 v11, 2, v11
    v_mov_b32 v12, 0xffff
    v_lshlrev_b32 v12, v11, v12
    v_bfe_i32 v11, v1, 3, 1
    v_and_b32 v191, v11, v12
    v_xor_b32 v190, v191, v12
    v_lshrrev_b32 v200, 5, v1
    v_lshlrev_b32 v200, 4, v200
    v_add_u32 v200, 101376, v200
    v_and_b32 v201, 15, v1
    v_lshlrev_b32 v201, 2, v201
    v_bfe_u32 v11, v1, 3, 2
    v_and_b32 v12, 3, v1
    v_lshl_add_u32 v11, v11, 2, v12
    v_lshlrev_b32 v202, 2, v11
    v_bfe_i32 v240, v0, 0, 1
    s_lshl_b32 s54, s3, 10
    v_and_b32 v241, 4, v240
    v_add_u32 v241, s54, v241
    v_lshl_add_u32 v242, v1, 2, s54
    v_lshrrev_b32 v243, 1, v1
    v_lshl_add_u32 v243, v243, 2, s54
    v_mul_u32_u24 v244, 12, v1
    v_and_b32 v245, 12, v242
    v_and_b32 v250, 124, v242
    s_mul_i32 s54, s3, 224
    v_add_u32 v247, s54, v1
    v_lshlrev_b32 v246, 3, v247
    v_add_u32 v246, 87040, v246
    v_lshlrev_b32 v247, 21, v247
    s_mul_i32 s54, s3, 640
    v_add_u32 v248, s54, v250
    v_sub_u32 v249, 63, v1
    s_getreg_b32 s86, hwreg(HW_REG_XCC_ID, 0, 3)
    s_lshl_b32 s54, s86, 4
    v_subrev_u32 v250, s54, v250
    v_and_b32 v250, 124, v250
    v_min_u32 v251, 39, v1
    v_lshlrev_b32 v251, 7, v251
    v_mov_b32 v253, 0x380
    v_lshrrev_b32 v252, 3, v1
    v_mul_u32_u24 v252, 64, v252
    v_add_u32 v252, 78848, v252
    s_lshr_b32 s87, s3, 1
    s_mul_i32 s87, s87, 3
    s_min_u32 s87, s87, 8
    s_mul_i32 s54, s87, 4608
    v_and_b32 v11, 15, v1
    v_lshrrev_b32 v12, 4, v1
    v_mul_u32_u24 v213, 288, v11
    v_lshl_add_u32 v213, v12, 4, v213
    v_add_u32 v213, s54, v213
    v_lshrrev_b32 v12, 3, v1
    v_lshlrev_b32 v12, 9, v12
    v_and_b32 v11, 7, v1
    v_lshl_add_u32 v214, v11, 4, v12
    s_lshl_b32 s87, s87, 12
    s_and_b32 s54, s3, 1
    s_lshl_b32 s54, s54, 7
    s_add_u32 s87, s87, s54
    s_lshl_b32 s54, s54, 7
    s_add_u32 s54, s54, 46080
    v_add_u32 v215, s54, v2
    s_cmp_eq_u32 s46, 40
    v_mov_b32 v203, 0
    s_mov_b32 s54, 685900808
    s_cselect_b32 s54, 568459824, s54
    s_mov_b32 exec_lo, 31
    s_mov_b32 exec_hi, 0
    v_mov_b32 v203, s54
    s_mov_b32 s54, 182814793
    s_cselect_b32 s54, 23232528, s54
    s_mov_b32 exec_lo, 992
    s_mov_b32 exec_hi, 0
    v_mov_b32 v203, s54
    s_mov_b32 s54, 984091248
    s_cselect_b32 s54, 719688297, s54
    s_mov_b32 exec_lo, 31744
    s_mov_b32 exec_hi, 0
    v_mov_b32 v203, s54
    s_mov_b32 s54, 424091761
    s_cselect_b32 s54, 984423522, s54
    s_mov_b32 exec_lo, 1015808
    s_mov_b32 exec_hi, 0
    v_mov_b32 v203, s54
    s_mov_b32 s54, 586001611
    s_cselect_b32 s54, 172635826, s54
    s_mov_b32 exec_lo, 32505856
    s_mov_b32 exec_hi, 0
    v_mov_b32 v203, s54
    s_mov_b32 s54, 64039106
    s_cselect_b32 s54, 454017211, s54
    s_mov_b32 exec_lo, 1040187392
    s_mov_b32 exec_hi, 0
    v_mov_b32 v203, s54
    s_mov_b32 s54, 330320603
    s_cselect_b32 s54, 743654643, s54
    s_mov_b32 exec_lo, 3221225472
    s_mov_b32 exec_hi, 7
    v_mov_b32 v203, s54
    s_mov_b32 s54, 217139484
    s_cselect_b32 s54, 607143691, s54
    s_mov_b32 exec_lo, 0
    s_mov_b32 exec_hi, 248
    v_mov_b32 v203, s54
    s_mov_b64 exec, -1
    v_mul_u32_u24 v11, 52, v1
    v_lshrrev_b32 v11, 8, v11
    v_mad_i32_i24 v11, v11, -5, v1
    v_mul_u32_u24 v11, 6, v11
    v_lshrrev_b32 v203, v11, v203
    v_and_b32 v11, 7, v203
    v_bfe_u32 v203, v203, 3, 3
    v_lshlrev_b32 v11, 12, v11
    v_lshl_or_b32 v203, v203, 7, v11
    s_add_u32 s24, s14, 1048576
    s_addc_u32 s25, s15, 0
    s_mov_b32 s26, 3932160
    s_mov_b32 s27, 0x20000
    v_mov_b32 v16, 0
    v_mov_b32 v17, 0
    v_mov_b32 v18, 0
    v_mov_b32 v19, 0
    v_mov_b32 v20, 0
    v_mov_b32 v21, 0
    v_mov_b32 v22, 0
    v_mov_b32 v23, 0
    v_mov_b32 v24, 0
    v_mov_b32 v25, 0
    v_mov_b32 v26, 0
    v_mov_b32 v27, 0
    v_mov_b32 v28, 0
    v_mov_b32 v29, 0
    v_mov_b32 v30, 0
    v_mov_b32 v31, 0
    v_mov_b32 v32, 0
    v_mov_b32 v33, 0
    v_mov_b32 v34, 0
    v_mov_b32 v35, 0
    v_mov_b32 v36, 0
    v_mov_b32 v37, 0
    v_mov_b32 v38, 0
    v_mov_b32 v39, 0
    v_mov_b32 v40, 0
    v_mov_b32 v41, 0
    v_mov_b32 v42, 0
    v_mov_b32 v43, 0
    v_mov_b32 v44, 0
    v_mov_b32 v45, 0
    v_mov_b32 v46, 0
    v_mov_b32 v47, 0
    v_mov_b32 v48, 0
    v_mov_b32 v49, 0
    v_mov_b32 v50, 0
    v_mov_b32 v51, 0
    v_mov_b32 v52, 0
    v_mov_b32 v53, 0
    v_mov_b32 v54, 0
    v_mov_b32 v55, 0
    v_mov_b32 v56, 0
    v_mov_b32 v57, 0
    v_mov_b32 v58, 0
    v_mov_b32 v59, 0
    v_mov_b32 v60, 0
    v_mov_b32 v61, 0
    v_mov_b32 v62, 0
    v_mov_b32 v63, 0
    s_lshl_b32 s54, s2, 3
    s_add_u32 s54, s54, s3
    s_lshl_b32 s54, s54, 8
    s_mov_b32 s16, s64
    s_mov_b32 s17, s65
    s_mov_b32 s18, 10240000
    s_mov_b32 s19, 0x20000
    s_add_u32 s28, s14, 5242880
    s_addc_u32 s29, s15, 0
    s_mov_b32 s30, 10485760
    s_mov_b32 s31, 0x20000
    s_and_b32 s51, s86, 7
    s_mul_i32 s51, s51, 1282048
    s_and_b32 s55, s2, 0xf8
    s_add_u32 s55, s55, s3
    s_mul_i32 s55, s55, 2304
    s_add_u32 s51, s51, s55
    v_min_u32 v14, 17, v1
    v_lshlrev_b32 v14, 7, v14
    s_waitcnt vmcnt(0)
    s_barrier
    s_mov_b64 exec, 0xffff
    buffer_store_dwordx4 v[112:115], v2, s[20:23], s54 offen sc1
    s_mov_b64 exec, -1
    buffer_load_dword v7, v14, s[16:19], s51 offen
    s_lshl_b32 s54, s45, 10
    s_add_u32 s40, s12, s54
    s_addc_u32 s41, s13, 0
    s_lshl_b32 s42, s46, 10
    s_mov_b32 s43, 0x20000
    v_lshrrev_b32 v8, 5, v1
    v_lshlrev_b32 v8, 10, v8
    v_and_b32 v9, 15, v1
    v_lshl_add_u32 v8, v9, 4, v8
    ds_read_b128 v[64:67], v8 offset:17408
    ds_read_b128 v[68:71], v8 offset:17664
    ds_read_b128 v[72:75], v8 offset:17920
    ds_read_b128 v[76:79], v8 offset:18176
    ds_read_b128 v[80:83], v8 offset:19456
    ds_read_b128 v[84:87], v8 offset:19712
    ds_read_b128 v[88:91], v8 offset:19968
    ds_read_b128 v[92:95], v8 offset:20224
    v_lshrrev_b32 v8, 4, v1
    v_lshlrev_b32 v8, 5, v8
    v_and_b32 v9, 3, v1
    v_lshl_add_u32 v8, v9, 1, v8
    ds_read_u16 v96, v8 offset:21504
    ds_read_u16 v97, v8 offset:21512
    ds_read_u16 v98, v8 offset:21520
    ds_read_u16 v99, v8 offset:21528
    v_bfe_i32 v10, v1, 4, 1
    v_and_b32 v10, 0x02020202, v10
    v_add_u32 v10, 0x05040100, v10
    s_waitcnt lgkmcnt(0)
    v_perm_b32 v172, v68, v64, v10
    v_perm_b32 v174, v76, v72, v10
    v_perm_b32 v176, v84, v80, v10
    v_perm_b32 v178, v92, v88, v10
    v_perm_b32 v173, v69, v65, v10
    v_perm_b32 v175, v77, v73, v10
    v_perm_b32 v177, v85, v81, v10
    v_perm_b32 v179, v93, v89, v10
    v_perm_b32 v180, v70, v66, v10
    v_perm_b32 v182, v78, v74, v10
    v_perm_b32 v184, v86, v82, v10
    v_perm_b32 v186, v94, v90, v10
    v_perm_b32 v181, v71, v67, v10
    v_perm_b32 v183, v79, v75, v10
    v_perm_b32 v185, v87, v83, v10
    v_perm_b32 v187, v95, v91, v10
    v_lshl_or_b32 v188, v97, 16, v96
    v_lshl_or_b32 v189, v99, 16, v98
    v_and_b32 v9, 7, v1
    v_lshrrev_b32 v8, 4, v1
    v_lshlrev_b32 v8, 13, v8
    v_lshl_add_u32 v8, v9, 4, v8
    v_and_b32 v9, 8, v1
    s_and_b32 s72, s3, 3
    s_lshl_b32 s72, s72, 8
    s_lshr_b32 s73, s3, 2
    s_lshl_b32 s73, s73, 7
    s_add_u32 s72, s72, s73
    s_add_u32 s72, s72, 46080
    v_add3_u32 v8, v8, v9, s72
    ds_read2st64_b64 v[128:131], v8 offset0:0 offset1:2
    ds_read2st64_b64 v[132:135], v8 offset0:4 offset1:6
    ds_read2st64_b64 v[136:139], v8 offset0:8 offset1:10
    ds_read2st64_b64 v[140:143], v8 offset0:12 offset1:14
    s_mov_b32 s72, 0x05040100
    s_mov_b32 s73, 0x07060302
    s_waitcnt lgkmcnt(3)
    v_perm_b32 v144, v130, v128, s72
    v_perm_b32 v148, v130, v128, s73
    v_perm_b32 v152, v131, v129, s72
    v_perm_b32 v156, v131, v129, s73
    s_waitcnt lgkmcnt(2)
    v_perm_b32 v145, v134, v132, s72
    v_perm_b32 v149, v134, v132, s73
    v_perm_b32 v153, v135, v133, s72
    v_perm_b32 v157, v135, v133, s73
    s_waitcnt lgkmcnt(1)
    v_perm_b32 v146, v138, v136, s72
    v_perm_b32 v150, v138, v136, s73
    v_perm_b32 v154, v139, v137, s72
    v_perm_b32 v158, v139, v137, s73
    s_waitcnt lgkmcnt(0)
    v_perm_b32 v147, v142, v140, s72
    v_perm_b32 v151, v142, v140, s73
    v_perm_b32 v155, v143, v141, s72
    v_perm_b32 v159, v143, v141, s73
    v_mov_b32 v64, 0
    v_mov_b32 v65, 0
    v_mov_b32 v66, 0
    v_mov_b32 v67, 0
    v_mov_b32 v68, 0
    v_mov_b32 v69, 0
    v_mov_b32 v70, 0
    v_mov_b32 v71, 0
    v_mov_b32 v72, 0
    v_mov_b32 v73, 0
    v_mov_b32 v74, 0
    v_mov_b32 v75, 0
    v_mov_b32 v76, 0
    v_mov_b32 v77, 0
    v_mov_b32 v78, 0
    v_mov_b32 v79, 0
    v_mov_b32 v80, 0
    v_mov_b32 v81, 0
    v_mov_b32 v82, 0
    v_mov_b32 v83, 0
    v_mov_b32 v84, 0
    v_mov_b32 v85, 0
    v_mov_b32 v86, 0
    v_mov_b32 v87, 0
    v_mov_b32 v88, 0
    v_mov_b32 v89, 0
    v_mov_b32 v90, 0
    v_mov_b32 v91, 0
    v_mov_b32 v92, 0
    v_mov_b32 v93, 0
    v_mov_b32 v94, 0
    v_mov_b32 v95, 0
    s_lshl_b32 s54, s3, 12
    v_add_u32 v8, s54, v2
    v_lshrrev_b32 v9, 1, v0
    v_lshlrev_b32 v10, 11, v9
    s_lshl_b32 s49, s44, 3
    v_mul_u32_u24 v5, 1280, v9
    s_mov_b32 s48, 0
    s_mov_b32 s53, 200000
    s_mov_b32 s55, 0xffc00000
    s_mul_i32 s52, s3, 7168
    s_add_u32 s52, s52, 101376
    s_movk_i32 s98, 4096
    s_waitcnt vmcnt(0)
    s_barrier
    buffer_load_dwordx2 v[206:207], v10, s[20:23], s49 offen sc1
    ds_write_b128 v8, v[144:147] offset:46080
    ds_write_b128 v8, v[148:151] offset:47104
    ds_write_b128 v8, v[152:155] offset:48128
    ds_write_b128 v8, v[156:159] offset:49152
    s_waitcnt vmcnt(0)
    v_xor_b32 v11, s63, v206
    v_xor_b32 v12, s62, v207
    v_and_or_b32 v11, v11, s55, v12
    v_cmpx_ne_u32 vcc, 0, v11
    s_cbranch_execnz L_poll
L_polled:
    s_mov_b64 exec, -1
    v_bfe_u32 v3, v206, 11, 11
    v_and_b32 v4, v3, v240
    v_add_u32 v10, v3, v240
    v_and_b32 v11, 0x7ff, v206
    v_add_u32_dpp v4, v4, v4 row_shr:1 row_mask:0xf bank_mask:0xf
    v_cmp_lt_i32 s[64:65], 0, v10
    v_cmp_lt_i32 s[66:67], 2, v10
    v_add_u32_dpp v4, v4, v4 row_shr:2 row_mask:0xf bank_mask:0xf
    v_cmp_lt_i32 s[68:69], 4, v10
    v_cmp_lt_i32 s[70:71], 6, v10
    v_add_u32_dpp v4, v4, v4 row_shr:4 row_mask:0xf bank_mask:0xf
    v_cmp_lt_i32 s[72:73], 8, v10
    v_cmp_lt_i32 s[74:75], 10, v10
    v_add_u32_dpp v4, v4, v4 row_shr:8 row_mask:0xf bank_mask:0xf
    v_cmp_lt_i32 s[76:77], 12, v10
    v_cmp_lt_i32 s[78:79], 14, v10
    v_add_u32_dpp v4, v4, v4 row_bcast:15 row_mask:0xa bank_mask:0xf
    v_add_u32 v5, v5, v11
    s_nop 0
    v_add_u32_dpp v4, v4, v4 row_bcast:31 row_mask:0xc bank_mask:0xf
    s_nop 0
    v_readlane_b32 s95, v4, 63
    v_mov_b32_dpp v4, v4 quad_perm:[0,0,2,2] row_mask:0xf bank_mask:0xf
    v_sub_u32 v5, v5, v4
    v_lshl_add_u32 v8, v4, 2, v241
    s_cmp_gt_u32 s95, 224
    s_cbranch_scc1 L_clip
L_mapw:
    s_mov_b64 exec, s[64:65]
    ds_write_b32 v8, v5 offset:0
    s_mov_b64 exec, s[66:67]
    ds_write_b32 v8, v5 offset:8
    s_mov_b64 exec, s[68:69]
    ds_write_b32 v8, v5 offset:16
    s_mov_b64 exec, s[70:71]
    ds_write_b32 v8, v5 offset:24
    s_mov_b64 exec, s[72:73]
    ds_write_b32 v8, v5 offset:32
    s_mov_b64 exec, s[74:75]
    ds_write_b32 v8, v5 offset:40
    s_mov_b64 exec, s[76:77]
    ds_write_b32 v8, v5 offset:48
    s_mov_b64 exec, -1
    s_cmp_lg_u64 s[78:79], 0
    s_cbranch_scc1 L_map2
    ds_read_b32 v136, v242 offset:0
    ds_read_b32 v137, v242 offset:256
    ds_read_b32 v138, v242 offset:512
    ds_read_b32 v140, v243 offset:0
    ds_read_b32 v141, v243 offset:128
    ds_read_b32 v142, v243 offset:256
    ds_read_b32 v143, v243 offset:384
    ds_read_b32 v144, v243 offset:512
    ds_read_b32 v145, v243 offset:640
    s_cmp_gt_i32 s95, 192
    s_cbranch_scc1 L_r1
L_r1b:
    s_waitcnt lgkmcnt(6)
    v_mad_u32_u24 v136, v136, 12, v244
    buffer_load_dwordx3 v[148:150], v136, s[24:27], 0 offen offset:0 sc1
    v_mad_u32_u24 v137, v137, 12, v244
    buffer_load_dwordx3 v[152:154], v137, s[24:27], 0 offen offset:768 sc1
    v_mad_u32_u24 v138, v138, 12, v244
    buffer_load_dwordx3 v[156:158], v138, s[24:27], 0 offen offset:1536 sc1
    v_mov_b32 v11, s95
    s_mov_b64 exec, 1
    ds_max_i32 v13, v11 offset:15360
    s_mov_b64 exec, -1
    s_waitcnt lgkmcnt(1)
    v_lshl_add_u32 v140, v140, 5, v2
    v_lshl_add_u32 v141, v141, 5, v2
    v_lshl_add_u32 v142, v142, 5, v2
    v_lshl_add_u32 v143, v143, 5, v2
    v_lshl_add_u32 v144, v144, 5, v2
    v_lshl_add_u32 v145, v145, 5, v2
    s_barrier
    s_add_u32 m0, s52, 0
    s_nop 0
    buffer_load_dwordx4 v140, s[28:31], 0 offen offset:0 sc1 lds
    buffer_load_dwordx4 v141, s[28:31], 0 offen offset:1024 sc1 lds
    s_min_i32 s54, s95, 224
    v_cmp_gt_i32 s[80:81], s54, v1
    s_sub_i32 s54, s54, 64
    v_cmp_gt_i32 s[82:83], s54, v1
    s_sub_i32 s54, s54, 64
    v_cmp_gt_i32 s[84:85], s54, v1
    s_sub_i32 s54, s54, 64
    v_cmp_gt_i32 s[96:97], s54, v1
    s_sub_i32 s54, s54, 64
    s_mov_b32 s55, 0x1fff80
    s_mul_i32 s61, s3, 5
    ds_read_b128 v[216:219], v215 offset:0
    ds_read_b128 v[220:223], v215 offset:1024
    ds_read_b128 v[224:227], v215 offset:2048
    ds_read_b128 v[228:231], v215 offset:3072
    ds_read_b128 v[232:235], v215 offset:4096
    ds_read_b128 v[236:239], v215 offset:5120
    s_waitcnt vmcnt(4)
    v_lshrrev_b32 v132, 21, v150
    v_lshlrev_b32 v132, 2, v132
    v_lshrrev_b32 v11, 26, v150
    v_lshl_or_b32 v11, v11, 4, v245
    s_mov_b64 exec, s[80:81]
    ds_add_rtn_u32 v128, v132, v6 offset:8192
    ds_add_u32 v11, v6 offset:14336
    s_mov_b64 exec, -1
    s_waitcnt vmcnt(3)
    v_lshrrev_b32 v133, 21, v154
    v_lshlrev_b32 v133, 2, v133
    v_lshrrev_b32 v11, 26, v154
    v_lshl_or_b32 v11, v11, 4, v245
    s_mov_b64 exec, s[82:83]
    ds_add_rtn_u32 v129, v133, v6 offset:8192
    ds_add_u32 v11, v6 offset:14336
    s_mov_b64 exec, -1
    s_waitcnt vmcnt(2)
    v_lshrrev_b32 v134, 21, v158
    v_lshlrev_b32 v134, 2, v134
    v_lshrrev_b32 v11, 26, v158
    v_lshl_or_b32 v11, v11, 4, v245
    s_mov_b64 exec, s[84:85]
    ds_add_rtn_u32 v130, v134, v6 offset:8192
    ds_add_u32 v11, v6 offset:14336
    s_mov_b64 exec, -1
    s_cmp_gt_i32 s95, 192
    s_cbranch_scc1 L_r2
L_r2b:
    buffer_load_dwordx4 v142, s[28:31], 0 offen offset:2048 sc1 lds
    s_add_u32 s65, s61, 1
    s_add_u32 s66, s61, 2
    s_add_u32 s67, s61, 3
    s_add_u32 s68, s61, 4
    s_waitcnt lgkmcnt(0)
    s_barrier
    s_cmp_lg_u32 s48, 0
    s_cbranch_scc1 L_rank2
    ds_read_b128 v[104:107], v2 offset:14336
    ds_read_b32 v96, v248 offset:8192
    ds_read_b32 v97, v248 offset:8320
    ds_read_b32 v98, v248 offset:8448
    ds_read_b32 v99, v248 offset:8576
    ds_read_b32 v100, v248 offset:8704
    ds_read_b32 v14, v13 offset:15360
    ds_write_b64 v246, v[148:149] offset:0
    v_and_or_b32 v150, v150, s55, v247
    ds_write_b64 v246, v[152:153] offset:512
    v_and_or_b32 v154, v154, s55, v247
    v_add_u32 v154, 134217728, v154
    ds_write_b64 v246, v[156:157] offset:1024
    v_and_or_b32 v158, v158, s55, v247
    v_add_u32 v158, 268435456, v158
    s_waitcnt lgkmcnt(9)
    v_add_u32 v9, v104, v105
    v_add3_u32 v9, v9, v106, v107
    v_lshl_or_b32 v9, v9, 6, v249
    s_nop 0
    v_readlane_b32 s64, v9, s61
    v_readlane_b32 s65, v9, s65
    v_readlane_b32 s66, v9, s66
    v_readlane_b32 s67, v9, s67
    v_readlane_b32 s68, v9, s68
    v_cmp_lt_u32 s[70:71], s64, v9
    v_cmp_lt_u32 s[72:73], s65, v9
    v_cmp_lt_u32 s[74:75], s66, v9
    v_cmp_lt_u32 s[76:77], s67, v9
    v_cmp_lt_u32 s[78:79], s68, v9
    s_bcnt1_i32_b64 s64, s[70:71]
    s_bcnt1_i32_b64 s65, s[72:73]
    s_bcnt1_i32_b64 s66, s[74:75]
    s_bcnt1_i32_b64 s67, s[76:77]
    s_bcnt1_i32_b64 s68, s[78:79]
    s_waitcnt lgkmcnt(3)
    v_readlane_b32 s90, v203, s64
    v_readlane_b32 s91, v203, s65
    v_readlane_b32 s92, v203, s66
    v_readlane_b32 s93, v203, s67
    v_readlane_b32 s94, v203, s68
    v_readfirstlane_b32 s47, v14
L_ranked:
    s_mov_b32 exec_hi, 0
    v_and_or_b32 v104, s90, v253, v250
    ds_add_rtn_u32 v96, v104, v96 offset:13312
    v_and_or_b32 v105, s91, v253, v250
    ds_add_rtn_u32 v97, v105, v97 offset:13312
    v_and_or_b32 v106, s92, v253, v250
    ds_add_rtn_u32 v98, v106, v98 offset:13312
    v_and_or_b32 v107, s93, v253, v250
    ds_add_rtn_u32 v99, v107, v99 offset:13312
    v_and_or_b32 v108, s94, v253, v250
    ds_add_rtn_u32 v100, v108, v100 offset:13312
    v_or_b32 v104, s90, v250
    v_or_b32 v105, s91, v250
    v_or_b32 v106, s92, v250
    v_or_b32 v107, s93, v250
    v_or_b32 v108, s94, v250
    s_lshl_b32 s54, s3, 3
    s_add_u32 s61, s54, 7
    s_waitcnt lgkmcnt(3)
    v_lshl_or_b32 v96, v96, 16, v104
    ds_write_b32 v248, v96 offset:8192
    v_lshl_or_b32 v97, v97, 16, v105
    ds_write_b32 v248, v97 offset:8320
    s_waitcnt lgkmcnt(2)
    v_lshl_or_b32 v98, v98, 16, v106
    ds_write_b32 v248, v98 offset:8448
    v_lshl_or_b32 v99, v99, 16, v107
    ds_write_b32 v248, v99 offset:8576
    v_lshl_or_b32 v100, v100, 16, v108
    ds_write_b32 v248, v100 offset:8704
    s_mov_b32 exec_hi, -1
    buffer_load_dwordx4 v143, s[28:31], 0 offen offset:3072 sc1 lds
    s_add_u32 m0, s52, 4096
    s_nop 0
    buffer_load_dwordx4 v144, s[28:31], s98 offen offset:0 sc1 lds
    s_waitcnt lgkmcnt(0)
    s_barrier
    ds_read_b128 v[96:99], v2 offset:13312
    ds_read_b32 v132, v132 offset:8192
    ds_read_b32 v133, v133 offset:8192
    ds_read_b32 v134, v134 offset:8192
    s_waitcnt lgkmcnt(3)
    v_add_u32 v9, v96, v97
    v_add3_u32 v9, v9, v98, v99
    v_mov_b32 v10, v9
    s_waitcnt lgkmcnt(0)
    v_bfe_u32 v15, v132, 12, 3
    v_add_u32_dpp v10, v10, v10 row_shr:1 row_mask:0xf bank_mask:0xf
    v_or_b32 v150, v15, v150
    v_and_b32 v136, 0x3ff, v132
    v_add_u32_dpp v10, v10, v10 row_shr:2 row_mask:0xf bank_mask:0xf
    v_lshrrev_b32 v132, 16, v132
    v_add_u32 v132, v132, v128
    v_add_u32_dpp v10, v10, v10 row_shr:4 row_mask:0xf bank_mask:0xf
    v_bfe_u32 v15, v133, 12, 3
    v_or_b32 v154, v15, v154
    v_add_u32_dpp v10, v10, v10 row_shr:8 row_mask:0xf bank_mask:0xf
    v_and_b32 v137, 0x3ff, v133
    v_lshrrev_b32 v133, 16, v133
    v_add_u32_dpp v10, v10, v10 row_bcast:15 row_mask:0xa bank_mask:0xf
    v_add_u32 v133, v133, v129
    v_bfe_u32 v15, v134, 12, 3
    v_add_u32_dpp v10, v10, v10 row_bcast:31 row_mask:0xc bank_mask:0xf
    v_or_b32 v158, v15, v158
    v_and_b32 v138, 0x3ff, v134
    v_sub_u32 v9, v10, v9
    v_lshl_add_u32 v104, v9, 2, v252
    v_lshl_add_u32 v105, v96, 2, v104
    v_lshl_add_u32 v106, v97, 2, v105
    v_lshl_add_u32 v107, v98, 2, v106
    ds_write_b128 v2, v[104:107] offset:16384
    ds_read_b32 v136, v136 offset:16384
    ds_read_b32 v137, v137 offset:16384
    ds_read_b32 v138, v138 offset:16384
    v_lshrrev_b32 v134, 16, v134
    v_add_u32 v134, v134, v130
    v_readlane_b32 s50, v10, s61
    v_readlane_b32 s53, v9, s54
    v_readlane_b32 s51, v104, s54
    v_mov_b32 v14, 2097029
    s_sub_u32 s50, s50, s53
    s_lshl2_add_u32 s55, s50, s51
    v_add_u32 v9, s55, v201
    ds_write_b32 v9, v14
    s_add_u32 s53, s50, 15
    s_lshr_b32 s53, s53, 4
    s_sub_u32 s54, 0, s50
    s_and_b32 s54, s54, 14
    s_sub_u32 s53, s53, 1
    s_cmp_gt_i32 s53, 0
    s_cselect_b32 s54, s54, 0
    s_lshl_b32 s61, s54, 2
    s_sub_u32 s51, s51, s61
    s_waitcnt lgkmcnt(1)
    v_lshl_add_u32 v132, v132, 2, v136
    v_lshl_add_u32 v133, v133, 2, v137
    v_lshl_add_u32 v134, v134, 2, v138
    s_mov_b64 exec, s[80:81]
    ds_write_b32 v132, v150
    s_mov_b64 exec, s[82:83]
    ds_write_b32 v133, v154
    s_mov_b64 exec, s[84:85]
    ds_write_b32 v134, v158
    s_mov_b64 exec, -1
    s_cmp_gt_i32 s95, 192
    s_cbranch_scc1 L_r3
L_r3b:
    buffer_load_dwordx4 v145, s[28:31], s98 offen offset:1024 sc1 lds
    v_add_u32 v198, s51, v201
    v_add_u32 v199, s51, v202
    s_and_b32 s61, s61, 32
    v_add_u32 v12, s61, v198
    s_and_b32 s72, s54, 6
    s_mov_b32 s55, 0x00fffc38
    s_mov_b32 s49, 0xffffff00
    s_mov_b32 s51, 87040
    s_cmp_lt_u32 s3, 4
    s_cbranch_scc1 L_np
    s_setprio 1
L_np:
    s_waitcnt lgkmcnt(0)
    s_barrier
    ds_read_b32 v196, v12
    ds_read_b32 v194, v199
    ds_read_b32 v197, v198 offset:24
    ds_read_b32 v205, v251 offset:8192
    s_cmp_eq_u32 s50, 0
    s_cbranch_scc1 L_empty
    s_waitcnt lgkmcnt(3)
    v_lshlrev_b32 v196, 3, v196
    v_and_b32 v196, s55, v196
    s_cmp_eq_u32 s72, 2
    s_cbranch_scc1 L_p2
    s_cmp_eq_u32 s72, 4
    s_cbranch_scc1 L_p4
    s_cmp_eq_u32 s72, 6
    s_cbranch_scc1 L_p6
L_p0:
    v_readlane_b32 s64, v196, 0
    v_readlane_b32 s65, v196, 1
    s_and_b32 s61, s64, s49
    buffer_load_dwordx4 v[96:99], v2, s[16:19], s61 offen
    s_and_b32 s61, s65, s49
    buffer_load_dwordx4 v[100:103], v2, s[16:19], s61 offen
L_p2:
    v_readlane_b32 s66, v196, 2
    v_readlane_b32 s67, v196, 3
    s_and_b32 s61, s66, s49
    buffer_load_dwordx4 v[104:107], v2, s[16:19], s61 offen
    s_and_b32 s61, s67, s49
    buffer_load_dwordx4 v[108:111], v2, s[16:19], s61 offen
L_p4:
    v_readlane_b32 s68, v196, 4
    v_readlane_b32 s69, v196, 5
    s_and_b32 s61, s68, s49
    buffer_load_dwordx4 v[112:115], v2, s[16:19], s61 offen
    s_and_b32 s61, s69, s49
    buffer_load_dwordx4 v[116:119], v2, s[16:19], s61 offen
    s_cmp_eq_u32 s72, 0
    s_cbranch_scc1 L_pd
L_p6:
    v_readlane_b32 s70, v196, 6
    v_readlane_b32 s71, v196, 7
    s_and_b32 s61, s70, s49
    buffer_load_dwordx4 v[120:123], v2, s[16:19], s61 offen
    s_and_b32 s61, s71, s49
    buffer_load_dwordx4 v[124:127], v2, s[16:19], s61 offen
    s_cmp_eq_u32 s72, 2
    s_cbranch_scc1 L_pd
L_p8:
    v_readlane_b32 s64, v196, 8
    v_readlane_b32 s65, v196, 9
    s_and_b32 s61, s64, s49
    buffer_load_dwordx4 v[96:99], v2, s[16:19], s61 offen
    s_and_b32 s61, s65, s49
    buffer_load_dwordx4 v[100:103], v2, s[16:19], s61 offen
    s_cmp_eq_u32 s72, 4
    s_cbranch_scc1 L_pd
L_p10:
    v_readlane_b32 s66, v196, 10
    v_readlane_b32 s67, v196, 11
    s_and_b32 s61, s66, s49
    buffer_load_dwordx4 v[104:107], v2, s[16:19], s61 offen
    s_and_b32 s61, s67, s49
    buffer_load_dwordx4 v[108:111], v2, s[16:19], s61 offen
L_pd:
    s_waitcnt vmcnt(6) lgkmcnt(0)
    s_barrier
    v_lshrrev_b32 v8, 21, v194
    v_lshl_add_u32 v11, v8, 3, s51
    v_lshl_add_u32 v8, v8, 5, v200
    ds_read_b64 v[192:193], v11
    ds_read_b128 v[164:167], v8
    v_lshlrev_b32 v12, 2, v1
    s_lshl_b32 s61, s3, 7
    v_and_b32 v205, 0x7380, v205
    v_xor_b32 v205, s61, v205
    v_alignbit_b32 v205, v205, v205, 12
    v_cmp_eq_u32 s[80:81], 0, v205
    v_cmp_eq_u32 s[82:83], 1, v205
    v_cmp_eq_u32 s[84:85], 2, v205
    v_cmp_eq_u32 s[96:97], 3, v205
    v_cmp_eq_u32 vcc, 4, v205
    s_ff1_i32_b64 s56, s[80:81]
    s_mul_i32 s56, s56, 1152
    v_add_u32 v208, s56, v12
    s_ff1_i32_b64 s57, s[82:83]
    s_mul_i32 s57, s57, 1152
    v_add_u32 v209, s57, v12
    s_ff1_i32_b64 s58, s[84:85]
    s_mul_i32 s58, s58, 1152
    v_add_u32 v210, s58, v12
    s_ff1_i32_b64 s59, s[96:97]
    s_mul_i32 s59, s59, 1152
    v_add_u32 v211, s59, v12
    s_ff1_i32_b64 s60, vcc
    s_mul_i32 s60, s60, 1152
    v_add_u32 v212, s60, v12
    s_waitcnt lgkmcnt(0)
.p2align 3
    v_mfma_f32_4x4x4_16b_bf16 v[144:147], v[192:193], v[188:189], 0 cbsz:4 abid:0
    v_mfma_f32_4x4x4_16b_bf16 v[148:151], v[192:193], v[188:189], 0 cbsz:4 abid:2
    v_mfma_f32_4x4x4_16b_bf16 v[152:155], v[192:193], v[188:189], 0 cbsz:4 abid:4
    v_mfma_f32_4x4x4_16b_bf16 v[156:159], v[192:193], v[188:189], 0 cbsz:4 abid:6
    v_lshlrev_b32 v196, 3, v197
    v_and_b32 v196, s55, v196
    v_add_u32 v198, 64, v198
    v_add_u32 v199, 64, v199
    v_smfmac_f32_32x32x32_bf16 v[64:79], v[164:167], v[172:179], v168
    ds_read_b32 v197, v198 offset:24
    ds_read_b32 v194, v199
    v_smfmac_f32_32x32x32_bf16 v[80:95], v[164:167], v[180:187], v168
    s_set_gpr_idx_on s54, gpr_idx(SRC0,SRC1)
    v_cvt_pk_bf16_f32 v9, v144, v144
    s_set_gpr_idx_off
    v_and_b32 v160, v190, v9
    v_and_b32 v161, v191, v9
    s_waitcnt lgkmcnt(0)
    v_lshrrev_b32 v8, 21, v194
    v_lshl_add_u32 v11, v8, 3, s51
    v_lshl_add_u32 v8, v8, 5, v200
    ds_read_b64 v[192:193], v11
    ds_read_b128 v[164:167], v8
    s_cmp_eq_u32 s53, 0
    s_cbranch_scc1 L_f0
    s_cmp_eq_u32 s54, 0
    s_cbranch_scc1 L_j0
    s_cmp_eq_u32 s54, 2
    s_cbranch_scc1 L_j2
    ds_read_b128 v[64:67], v169
    ds_read_b128 v[80:83], v169
    s_cmp_eq_u32 s54, 4
    s_cbranch_scc1 L_j4
    s_cmp_eq_u32 s54, 6
    s_cbranch_scc1 L_j6
    ds_read_b128 v[68:71], v169
    ds_read_b128 v[84:87], v169
    s_cmp_eq_u32 s54, 8
    s_cbranch_scc1 L_j8
    s_cmp_eq_u32 s54, 10
    s_cbranch_scc1 L_j10
    ds_read_b128 v[72:75], v169
    ds_read_b128 v[88:91], v169
    s_cmp_eq_u32 s54, 12
    s_cbranch_scc1 L_j12
    s_branch L_j14
.p2align 3
L_loop:
    s_waitcnt lgkmcnt(2)
.p2align 3
    v_mfma_f32_4x4x4_16b_bf16 v[144:147], v[192:193], v[188:189], 0 cbsz:4 abid:0
    v_mfma_f32_4x4x4_16b_bf16 v[148:151], v[192:193], v[188:189], 0 cbsz:4 abid:2
    v_mfma_f32_4x4x4_16b_bf16 v[152:155], v[192:193], v[188:189], 0 cbsz:4 abid:4
    v_mfma_f32_4x4x4_16b_bf16 v[156:159], v[192:193], v[188:189], 0 cbsz:4 abid:6
    v_lshlrev_b32 v196, 3, v197
    v_and_b32 v196, s55, v196
    v_add_u32 v198, 64, v198
    v_add_u32 v199, 64, v199
    s_waitcnt lgkmcnt(0)
.p2align 3
    v_smfmac_f32_32x32x32_bf16 v[64:79], v[164:167], v[172:179], v168
    ds_read_b32 v197, v198 offset:24
    ds_read_b32 v194, v199
    v_cvt_pk_bf16_f32 v9, v144, v144
    v_and_b32 v160, v190, v9
    v_and_b32 v161, v191, v9
    v_smfmac_f32_32x32x32_bf16 v[80:95], v[164:167], v[180:187], v168
L_j0:
    s_waitcnt vmcnt(5)
.p2align 3
    v_mfma_f32_16x16x16_bf16 v[128:131], v[160:161], v[96:97], 0
    v_readlane_b32 s70, v196, 0
    v_cvt_pk_bf16_f32 v10, v145, v145
    v_mfma_f32_16x16x16_bf16 v[132:135], v[160:161], v[98:99], 0
    v_and_b32 v162, v190, v10
    v_and_b32 v163, v191, v10
    s_and_b32 s61, s70, s49
    s_waitcnt vmcnt(4)
    buffer_load_dwordx4 v[120:123], v2, s[16:19], s61 offen
    v_mfma_f32_16x16x16_bf16 v[136:139], v[162:163], v[100:101], 0
    v_readlane_b32 s71, v196, 1
    v_cvt_pk_bf16_f32 v9, v146, v146
    v_mfma_f32_16x16x16_bf16 v[140:143], v[162:163], v[102:103], 0
    v_and_b32 v160, v190, v9
    v_and_b32 v161, v191, v9
    s_and_b32 s61, s71, s49
    s_set_gpr_idx_on s64, gpr_idx(SRC2,DST)
    buffer_load_dwordx4 v[124:127], v2, s[16:19], s61 offen
    v_pk_fma_f32 v[16:17], v[128:129], v[64:65], v[16:17] op_sel_hi:[1,0,1]
    v_pk_fma_f32 v[18:19], v[130:131], v[64:65], v[18:19] op_sel_hi:[1,0,1]
    v_pk_fma_f32 v[20:21], v[132:133], v[80:81], v[20:21] op_sel_hi:[1,0,1]
    v_pk_fma_f32 v[22:23], v[134:135], v[80:81], v[22:23] op_sel_hi:[1,0,1]
    s_set_gpr_idx_idx s65
.p2align 3
    v_pk_fma_f32 v[16:17], v[136:137], v[64:65], v[16:17] op_sel:[0,1,0] op_sel_hi:[1,1,1]
    v_pk_fma_f32 v[18:19], v[138:139], v[64:65], v[18:19] op_sel:[0,1,0] op_sel_hi:[1,1,1]
    v_pk_fma_f32 v[20:21], v[140:141], v[80:81], v[20:21] op_sel:[0,1,0] op_sel_hi:[1,1,1]
    v_pk_fma_f32 v[22:23], v[142:143], v[80:81], v[22:23] op_sel:[0,1,0] op_sel_hi:[1,1,1]
    s_set_gpr_idx_off
L_j2:
    s_waitcnt vmcnt(5)
.p2align 3
    v_mfma_f32_16x16x16_bf16 v[128:131], v[160:161], v[104:105], 0
    v_readlane_b32 s64, v196, 2
    v_cvt_pk_bf16_f32 v10, v147, v147
    v_mfma_f32_16x16x16_bf16 v[132:135], v[160:161], v[106:107], 0
    v_and_b32 v162, v190, v10
    v_and_b32 v163, v191, v10
    s_and_b32 s61, s64, s49
    s_waitcnt vmcnt(4)
    buffer_load_dwordx4 v[96:99], v2, s[16:19], s61 offen
    v_mfma_f32_16x16x16_bf16 v[136:139], v[162:163], v[108:109], 0
    v_readlane_b32 s65, v196, 3
    v_cvt_pk_bf16_f32 v9, v148, v148
    v_mfma_f32_16x16x16_bf16 v[140:143], v[162:163], v[110:111], 0
    v_and_b32 v160, v190, v9
    v_and_b32 v161, v191, v9
    s_waitcnt lgkmcnt(0)
    v_lshrrev_b32 v8, 21, v194
    v_lshl_add_u32 v11, v8, 3, s51
    v_lshl_add_u32 v8, v8, 5, v200
    ds_read_b64 v[192:193], v11
    ds_read_b128 v[164:167], v8
.p2align 3
    s_and_b32 s61, s65, s49
    s_set_gpr_idx_on s66, gpr_idx(SRC2,DST)
    buffer_load_dwordx4 v[100:103], v2, s[16:19], s61 offen
    v_pk_fma_f32 v[16:17], v[128:129], v[66:67], v[16:17] op_sel_hi:[1,0,1]
    v_pk_fma_f32 v[18:19], v[130:131], v[66:67], v[18:19] op_sel_hi:[1,0,1]
    v_pk_fma_f32 v[20:21], v[132:133], v[82:83], v[20:21] op_sel_hi:[1,0,1]
    v_pk_fma_f32 v[22:23], v[134:135], v[82:83], v[22:23] op_sel_hi:[1,0,1]
    s_set_gpr_idx_idx s67
.p2align 3
    v_pk_fma_f32 v[16:17], v[136:137], v[66:67], v[16:17] op_sel:[0,1,0] op_sel_hi:[1,1,1]
    v_pk_fma_f32 v[18:19], v[138:139], v[66:67], v[18:19] op_sel:[0,1,0] op_sel_hi:[1,1,1]
    v_pk_fma_f32 v[20:21], v[140:141], v[82:83], v[20:21] op_sel:[0,1,0] op_sel_hi:[1,1,1]
    v_pk_fma_f32 v[22:23], v[142:143], v[82:83], v[22:23] op_sel:[0,1,0] op_sel_hi:[1,1,1]
    ds_read_b128 v[64:67], v169
    ds_read_b128 v[80:83], v169
    s_set_gpr_idx_off
L_j4:
    s_waitcnt vmcnt(5)
.p2align 3
    v_mfma_f32_16x16x16_bf16 v[128:131], v[160:161], v[112:113], 0
    v_readlane_b32 s66, v196, 4
    v_cvt_pk_bf16_f32 v10, v149, v149
    v_mfma_f32_16x16x16_bf16 v[132:135], v[160:161], v[114:115], 0
    v_and_b32 v162, v190, v10
    v_and_b32 v163, v191, v10
    s_and_b32 s61, s66, s49
    s_waitcnt vmcnt(4)
    buffer_load_dwordx4 v[104:107], v2, s[16:19], s61 offen
    v_mfma_f32_16x16x16_bf16 v[136:139], v[162:163], v[116:117], 0
    v_readlane_b32 s67, v196, 5
    v_cvt_pk_bf16_f32 v9, v150, v150
    v_mfma_f32_16x16x16_bf16 v[140:143], v[162:163], v[118:119], 0
    v_and_b32 v160, v190, v9
    v_and_b32 v161, v191, v9
    s_and_b32 s61, s67, s49
    s_set_gpr_idx_on s68, gpr_idx(SRC2,DST)
    buffer_load_dwordx4 v[108:111], v2, s[16:19], s61 offen
    v_pk_fma_f32 v[16:17], v[128:129], v[68:69], v[16:17] op_sel_hi:[1,0,1]
    v_pk_fma_f32 v[18:19], v[130:131], v[68:69], v[18:19] op_sel_hi:[1,0,1]
    v_pk_fma_f32 v[20:21], v[132:133], v[84:85], v[20:21] op_sel_hi:[1,0,1]
    v_pk_fma_f32 v[22:23], v[134:135], v[84:85], v[22:23] op_sel_hi:[1,0,1]
    s_set_gpr_idx_idx s69
.p2align 3
    v_pk_fma_f32 v[16:17], v[136:137], v[68:69], v[16:17] op_sel:[0,1,0] op_sel_hi:[1,1,1]
    v_pk_fma_f32 v[18:19], v[138:139], v[68:69], v[18:19] op_sel:[0,1,0] op_sel_hi:[1,1,1]
    v_pk_fma_f32 v[20:21], v[140:141], v[84:85], v[20:21] op_sel:[0,1,0] op_sel_hi:[1,1,1]
    v_pk_fma_f32 v[22:23], v[142:143], v[84:85], v[22:23] op_sel:[0,1,0] op_sel_hi:[1,1,1]
    s_set_gpr_idx_off
L_j6:
    s_waitcnt vmcnt(5)
.p2align 3
    v_mfma_f32_16x16x16_bf16 v[128:131], v[160:161], v[120:121], 0
    v_readlane_b32 s68, v196, 6
    v_cvt_pk_bf16_f32 v10, v151, v151
    v_mfma_f32_16x16x16_bf16 v[132:135], v[160:161], v[122:123], 0
    v_and_b32 v162, v190, v10
    v_and_b32 v163, v191, v10
    s_and_b32 s61, s68, s49
    s_waitcnt vmcnt(4)
    buffer_load_dwordx4 v[112:115], v2, s[16:19], s61 offen
    v_mfma_f32_16x16x16_bf16 v[136:139], v[162:163], v[124:125], 0
    v_readlane_b32 s69, v196, 7
    v_cvt_pk_bf16_f32 v9, v152, v152
    v_mfma_f32_16x16x16_bf16 v[140:143], v[162:163], v[126:127], 0
    v_and_b32 v160, v190, v9
    v_and_b32 v161, v191, v9
    s_and_b32 s61, s69, s49
    s_set_gpr_idx_on s70, gpr_idx(SRC2,DST)
    buffer_load_dwordx4 v[116:119], v2, s[16:19], s61 offen
    v_pk_fma_f32 v[16:17], v[128:129], v[70:71], v[16:17] op_sel_hi:[1,0,1]
    v_pk_fma_f32 v[18:19], v[130:131], v[70:71], v[18:19] op_sel_hi:[1,0,1]
    v_pk_fma_f32 v[20:21], v[132:133], v[86:87], v[20:21] op_sel_hi:[1,0,1]
    v_pk_fma_f32 v[22:23], v[134:135], v[86:87], v[22:23] op_sel_hi:[1,0,1]
    s_set_gpr_idx_idx s71
.p2align 3
    v_pk_fma_f32 v[16:17], v[136:137], v[70:71], v[16:17] op_sel:[0,1,0] op_sel_hi:[1,1,1]
    v_pk_fma_f32 v[18:19], v[138:139], v[70:71], v[18:19] op_sel:[0,1,0] op_sel_hi:[1,1,1]
    v_pk_fma_f32 v[20:21], v[140:141], v[86:87], v[20:21] op_sel:[0,1,0] op_sel_hi:[1,1,1]
    v_pk_fma_f32 v[22:23], v[142:143], v[86:87], v[22:23] op_sel:[0,1,0] op_sel_hi:[1,1,1]
    ds_read_b128 v[68:71], v169
    ds_read_b128 v[84:87], v169
    s_set_gpr_idx_off
L_j8:
    s_waitcnt vmcnt(5)
.p2align 3
    v_mfma_f32_16x16x16_bf16 v[128:131], v[160:161], v[96:97], 0
    v_readlane_b32 s70, v196, 8
    v_cvt_pk_bf16_f32 v10, v153, v153
    v_mfma_f32_16x16x16_bf16 v[132:135], v[160:161], v[98:99], 0
    v_and_b32 v162, v190, v10
    v_and_b32 v163, v191, v10
    s_and_b32 s61, s70, s49
    s_waitcnt vmcnt(4)
    buffer_load_dwordx4 v[120:123], v2, s[16:19], s61 offen
    v_mfma_f32_16x16x16_bf16 v[136:139], v[162:163], v[100:101], 0
    v_readlane_b32 s71, v196, 9
    v_cvt_pk_bf16_f32 v9, v154, v154
    v_mfma_f32_16x16x16_bf16 v[140:143], v[162:163], v[102:103], 0
    v_and_b32 v160, v190, v9
    v_and_b32 v161, v191, v9
    s_and_b32 s61, s71, s49
    s_set_gpr_idx_on s64, gpr_idx(SRC2,DST)
    buffer_load_dwordx4 v[124:127], v2, s[16:19], s61 offen
    v_pk_fma_f32 v[16:17], v[128:129], v[72:73], v[16:17] op_sel_hi:[1,0,1]
    v_pk_fma_f32 v[18:19], v[130:131], v[72:73], v[18:19] op_sel_hi:[1,0,1]
    v_pk_fma_f32 v[20:21], v[132:133], v[88:89], v[20:21] op_sel_hi:[1,0,1]
    v_pk_fma_f32 v[22:23], v[134:135], v[88:89], v[22:23] op_sel_hi:[1,0,1]
    s_set_gpr_idx_idx s65
.p2align 3
    v_pk_fma_f32 v[16:17], v[136:137], v[72:73], v[16:17] op_sel:[0,1,0] op_sel_hi:[1,1,1]
    v_pk_fma_f32 v[18:19], v[138:139], v[72:73], v[18:19] op_sel:[0,1,0] op_sel_hi:[1,1,1]
    v_pk_fma_f32 v[20:21], v[140:141], v[88:89], v[20:21] op_sel:[0,1,0] op_sel_hi:[1,1,1]
    v_pk_fma_f32 v[22:23], v[142:143], v[88:89], v[22:23] op_sel:[0,1,0] op_sel_hi:[1,1,1]
    s_set_gpr_idx_off
L_j10:
    s_waitcnt vmcnt(5)
.p2align 3
    v_mfma_f32_16x16x16_bf16 v[128:131], v[160:161], v[104:105], 0
    v_readlane_b32 s64, v196, 10
    v_cvt_pk_bf16_f32 v10, v155, v155
    v_mfma_f32_16x16x16_bf16 v[132:135], v[160:161], v[106:107], 0
    v_and_b32 v162, v190, v10
    v_and_b32 v163, v191, v10
    s_and_b32 s61, s64, s49
    s_waitcnt vmcnt(4)
    buffer_load_dwordx4 v[96:99], v2, s[16:19], s61 offen
    v_mfma_f32_16x16x16_bf16 v[136:139], v[162:163], v[108:109], 0
    v_readlane_b32 s65, v196, 11
    v_cvt_pk_bf16_f32 v9, v156, v156
    v_mfma_f32_16x16x16_bf16 v[140:143], v[162:163], v[110:111], 0
    v_and_b32 v160, v190, v9
    v_and_b32 v161, v191, v9
    s_and_b32 s61, s65, s49
    s_set_gpr_idx_on s66, gpr_idx(SRC2,DST)
    buffer_load_dwordx4 v[100:103], v2, s[16:19], s61 offen
    v_pk_fma_f32 v[16:17], v[128:129], v[74:75], v[16:17] op_sel_hi:[1,0,1]
    v_pk_fma_f32 v[18:19], v[130:131], v[74:75], v[18:19] op_sel_hi:[1,0,1]
    v_pk_fma_f32 v[20:21], v[132:133], v[90:91], v[20:21] op_sel_hi:[1,0,1]
    v_pk_fma_f32 v[22:23], v[134:135], v[90:91], v[22:23] op_sel_hi:[1,0,1]
    s_set_gpr_idx_idx s67
.p2align 3
    v_pk_fma_f32 v[16:17], v[136:137], v[74:75], v[16:17] op_sel:[0,1,0] op_sel_hi:[1,1,1]
    v_pk_fma_f32 v[18:19], v[138:139], v[74:75], v[18:19] op_sel:[0,1,0] op_sel_hi:[1,1,1]
    v_pk_fma_f32 v[20:21], v[140:141], v[90:91], v[20:21] op_sel:[0,1,0] op_sel_hi:[1,1,1]
    v_pk_fma_f32 v[22:23], v[142:143], v[90:91], v[22:23] op_sel:[0,1,0] op_sel_hi:[1,1,1]
    ds_read_b128 v[72:75], v169
    ds_read_b128 v[88:91], v169
    s_set_gpr_idx_off
L_j12:
    s_waitcnt vmcnt(5)
.p2align 3
    v_mfma_f32_16x16x16_bf16 v[128:131], v[160:161], v[112:113], 0
    v_readlane_b32 s66, v196, 12
    v_cvt_pk_bf16_f32 v10, v157, v157
    v_mfma_f32_16x16x16_bf16 v[132:135], v[160:161], v[114:115], 0
    v_and_b32 v162, v190, v10
    v_and_b32 v163, v191, v10
    s_and_b32 s61, s66, s49
    s_waitcnt vmcnt(4)
    buffer_load_dwordx4 v[104:107], v2, s[16:19], s61 offen
    v_mfma_f32_16x16x16_bf16 v[136:139], v[162:163], v[116:117], 0
    v_readlane_b32 s67, v196, 13
    v_cvt_pk_bf16_f32 v9, v158, v158
    v_mfma_f32_16x16x16_bf16 v[140:143], v[162:163], v[118:119], 0
    v_and_b32 v160, v190, v9
    v_and_b32 v161, v191, v9
    s_and_b32 s61, s67, s49
    s_set_gpr_idx_on s68, gpr_idx(SRC2,DST)
    buffer_load_dwordx4 v[108:111], v2, s[16:19], s61 offen
    v_pk_fma_f32 v[16:17], v[128:129], v[76:77], v[16:17] op_sel_hi:[1,0,1]
    v_pk_fma_f32 v[18:19], v[130:131], v[76:77], v[18:19] op_sel_hi:[1,0,1]
    v_pk_fma_f32 v[20:21], v[132:133], v[92:93], v[20:21] op_sel_hi:[1,0,1]
    v_pk_fma_f32 v[22:23], v[134:135], v[92:93], v[22:23] op_sel_hi:[1,0,1]
    s_set_gpr_idx_idx s69
.p2align 3
    v_pk_fma_f32 v[16:17], v[136:137], v[76:77], v[16:17] op_sel:[0,1,0] op_sel_hi:[1,1,1]
    v_pk_fma_f32 v[18:19], v[138:139], v[76:77], v[18:19] op_sel:[0,1,0] op_sel_hi:[1,1,1]
    v_pk_fma_f32 v[20:21], v[140:141], v[92:93], v[20:21] op_sel:[0,1,0] op_sel_hi:[1,1,1]
    v_pk_fma_f32 v[22:23], v[142:143], v[92:93], v[22:23] op_sel:[0,1,0] op_sel_hi:[1,1,1]
    s_set_gpr_idx_off
L_j14:
    s_waitcnt vmcnt(5)
.p2align 3
    v_mfma_f32_16x16x16_bf16 v[128:131], v[160:161], v[120:121], 0
    v_readlane_b32 s68, v196, 14
    v_cvt_pk_bf16_f32 v10, v159, v159
    v_mfma_f32_16x16x16_bf16 v[132:135], v[160:161], v[122:123], 0
    v_and_b32 v162, v190, v10
    v_and_b32 v163, v191, v10
    s_and_b32 s61, s68, s49
    s_waitcnt vmcnt(4)
    buffer_load_dwordx4 v[112:115], v2, s[16:19], s61 offen
    v_mfma_f32_16x16x16_bf16 v[136:139], v[162:163], v[124:125], 0
    v_readlane_b32 s69, v196, 15
    v_mfma_f32_16x16x16_bf16 v[140:143], v[162:163], v[126:127], 0
    s_and_b32 s61, s69, s49
    s_set_gpr_idx_on s70, gpr_idx(SRC2,DST)
    buffer_load_dwordx4 v[116:119], v2, s[16:19], s61 offen
    v_pk_fma_f32 v[16:17], v[128:129], v[78:79], v[16:17] op_sel_hi:[1,0,1]
    v_pk_fma_f32 v[18:19], v[130:131], v[78:79], v[18:19] op_sel_hi:[1,0,1]
    v_pk_fma_f32 v[20:21], v[132:133], v[94:95], v[20:21] op_sel_hi:[1,0,1]
    v_pk_fma_f32 v[22:23], v[134:135], v[94:95], v[22:23] op_sel_hi:[1,0,1]
    s_set_gpr_idx_idx s71
    s_sub_u32 s53, s53, 1
.p2align 3
    v_pk_fma_f32 v[16:17], v[136:137], v[78:79], v[16:17] op_sel:[0,1,0] op_sel_hi:[1,1,1]
    v_pk_fma_f32 v[18:19], v[138:139], v[78:79], v[18:19] op_sel:[0,1,0] op_sel_hi:[1,1,1]
    v_pk_fma_f32 v[20:21], v[140:141], v[94:95], v[20:21] op_sel:[0,1,0] op_sel_hi:[1,1,1]
    v_pk_fma_f32 v[22:23], v[142:143], v[94:95], v[22:23] op_sel:[0,1,0] op_sel_hi:[1,1,1]
    ds_read_b128 v[76:79], v169
    ds_read_b128 v[92:95], v169
    s_set_gpr_idx_off
    s_cmp_lg_u32 s53, 0
    s_cbranch_scc1 L_loop
    s_waitcnt lgkmcnt(2)
.p2align 3
    v_mfma_f32_4x4x4_16b_bf16 v[144:147], v[192:193], v[188:189], 0 cbsz:4 abid:0
    v_mfma_f32_4x4x4_16b_bf16 v[148:151], v[192:193], v[188:189], 0 cbsz:4 abid:2
    v_mfma_f32_4x4x4_16b_bf16 v[152:155], v[192:193], v[188:189], 0 cbsz:4 abid:4
    v_mfma_f32_4x4x4_16b_bf16 v[156:159], v[192:193], v[188:189], 0 cbsz:4 abid:6
    v_lshlrev_b32 v196, 3, v197
    v_and_b32 v196, s55, v196
    s_waitcnt lgkmcnt(0)
.p2align 3
    v_smfmac_f32_32x32x32_bf16 v[64:79], v[164:167], v[172:179], v168
    v_cvt_pk_bf16_f32 v9, v144, v144
    v_and_b32 v160, v190, v9
    v_and_b32 v161, v191, v9
    v_smfmac_f32_32x32x32_bf16 v[80:95], v[164:167], v[180:187], v168
L_f0:
    s_waitcnt vmcnt(5)
.p2align 3
    v_mfma_f32_16x16x16_bf16 v[128:131], v[160:161], v[96:97], 0
    v_readlane_b32 s70, v196, 0
    v_cvt_pk_bf16_f32 v10, v145, v145
    v_mfma_f32_16x16x16_bf16 v[132:135], v[160:161], v[98:99], 0
    v_and_b32 v162, v190, v10
    v_and_b32 v163, v191, v10
    s_and_b32 s61, s70, s49
    s_waitcnt vmcnt(4)
    buffer_load_dwordx4 v[120:123], v2, s[16:19], s61 offen
    v_mfma_f32_16x16x16_bf16 v[136:139], v[162:163], v[100:101], 0
    v_readlane_b32 s71, v196, 1
    v_cvt_pk_bf16_f32 v9, v146, v146
    v_mfma_f32_16x16x16_bf16 v[140:143], v[162:163], v[102:103], 0
    v_and_b32 v160, v190, v9
    v_and_b32 v161, v191, v9
    s_and_b32 s61, s71, s49
    s_set_gpr_idx_on s64, gpr_idx(SRC2,DST)
    buffer_load_dwordx4 v[124:127], v2, s[16:19], s61 offen
    v_pk_fma_f32 v[16:17], v[128:129], v[64:65], v[16:17] op_sel_hi:[1,0,1]
    v_pk_fma_f32 v[18:19], v[130:131], v[64:65], v[18:19] op_sel_hi:[1,0,1]
    v_pk_fma_f32 v[20:21], v[132:133], v[80:81], v[20:21] op_sel_hi:[1,0,1]
    v_pk_fma_f32 v[22:23], v[134:135], v[80:81], v[22:23] op_sel_hi:[1,0,1]
    s_set_gpr_idx_idx s65
.p2align 3
    v_pk_fma_f32 v[16:17], v[136:137], v[64:65], v[16:17] op_sel:[0,1,0] op_sel_hi:[1,1,1]
    v_pk_fma_f32 v[18:19], v[138:139], v[64:65], v[18:19] op_sel:[0,1,0] op_sel_hi:[1,1,1]
    v_pk_fma_f32 v[20:21], v[140:141], v[80:81], v[20:21] op_sel:[0,1,0] op_sel_hi:[1,1,1]
    v_pk_fma_f32 v[22:23], v[142:143], v[80:81], v[22:23] op_sel:[0,1,0] op_sel_hi:[1,1,1]
    s_set_gpr_idx_off
    s_waitcnt vmcnt(5)
.p2align 3
    v_mfma_f32_16x16x16_bf16 v[128:131], v[160:161], v[104:105], 0
    v_readlane_b32 s64, v196, 2
    v_cvt_pk_bf16_f32 v10, v147, v147
    v_mfma_f32_16x16x16_bf16 v[132:135], v[160:161], v[106:107], 0
    v_and_b32 v162, v190, v10
    v_and_b32 v163, v191, v10
    s_and_b32 s61, s64, s49
    s_waitcnt vmcnt(4)
    buffer_load_dwordx4 v[96:99], v2, s[16:19], s61 offen
    v_mfma_f32_16x16x16_bf16 v[136:139], v[162:163], v[108:109], 0
    v_readlane_b32 s65, v196, 3
    v_cvt_pk_bf16_f32 v9, v148, v148
    v_mfma_f32_16x16x16_bf16 v[140:143], v[162:163], v[110:111], 0
    v_and_b32 v160, v190, v9
    v_and_b32 v161, v191, v9
    s_and_b32 s61, s65, s49
    s_set_gpr_idx_on s66, gpr_idx(SRC2,DST)
    buffer_load_dwordx4 v[100:103], v2, s[16:19], s61 offen
    v_pk_fma_f32 v[16:17], v[128:129], v[66:67], v[16:17] op_sel_hi:[1,0,1]
    v_pk_fma_f32 v[18:19], v[130:131], v[66:67], v[18:19] op_sel_hi:[1,0,1]
    v_pk_fma_f32 v[20:21], v[132:133], v[82:83], v[20:21] op_sel_hi:[1,0,1]
    v_pk_fma_f32 v[22:23], v[134:135], v[82:83], v[22:23] op_sel_hi:[1,0,1]
    s_set_gpr_idx_idx s67
.p2align 3
    v_pk_fma_f32 v[16:17], v[136:137], v[66:67], v[16:17] op_sel:[0,1,0] op_sel_hi:[1,1,1]
    v_pk_fma_f32 v[18:19], v[138:139], v[66:67], v[18:19] op_sel:[0,1,0] op_sel_hi:[1,1,1]
    v_pk_fma_f32 v[20:21], v[140:141], v[82:83], v[20:21] op_sel:[0,1,0] op_sel_hi:[1,1,1]
    v_pk_fma_f32 v[22:23], v[142:143], v[82:83], v[22:23] op_sel:[0,1,0] op_sel_hi:[1,1,1]
    s_set_gpr_idx_off
    s_waitcnt vmcnt(5)
.p2align 3
    v_mfma_f32_16x16x16_bf16 v[128:131], v[160:161], v[112:113], 0
    v_readlane_b32 s66, v196, 4
    v_cvt_pk_bf16_f32 v10, v149, v149
    v_mfma_f32_16x16x16_bf16 v[132:135], v[160:161], v[114:115], 0
    v_and_b32 v162, v190, v10
    v_and_b32 v163, v191, v10
    s_and_b32 s61, s66, s49
    s_waitcnt vmcnt(4)
    buffer_load_dwordx4 v[104:107], v2, s[16:19], s61 offen
    v_mfma_f32_16x16x16_bf16 v[136:139], v[162:163], v[116:117], 0
    v_readlane_b32 s67, v196, 5
    v_cvt_pk_bf16_f32 v9, v150, v150
    v_mfma_f32_16x16x16_bf16 v[140:143], v[162:163], v[118:119], 0
    v_and_b32 v160, v190, v9
    v_and_b32 v161, v191, v9
    s_and_b32 s61, s67, s49
    s_set_gpr_idx_on s68, gpr_idx(SRC2,DST)
    buffer_load_dwordx4 v[108:111], v2, s[16:19], s61 offen
    v_pk_fma_f32 v[16:17], v[128:129], v[68:69], v[16:17] op_sel_hi:[1,0,1]
    v_pk_fma_f32 v[18:19], v[130:131], v[68:69], v[18:19] op_sel_hi:[1,0,1]
    v_pk_fma_f32 v[20:21], v[132:133], v[84:85], v[20:21] op_sel_hi:[1,0,1]
    v_pk_fma_f32 v[22:23], v[134:135], v[84:85], v[22:23] op_sel_hi:[1,0,1]
    s_set_gpr_idx_idx s69
.p2align 3
    v_pk_fma_f32 v[16:17], v[136:137], v[68:69], v[16:17] op_sel:[0,1,0] op_sel_hi:[1,1,1]
    v_pk_fma_f32 v[18:19], v[138:139], v[68:69], v[18:19] op_sel:[0,1,0] op_sel_hi:[1,1,1]
    v_pk_fma_f32 v[20:21], v[140:141], v[84:85], v[20:21] op_sel:[0,1,0] op_sel_hi:[1,1,1]
    v_pk_fma_f32 v[22:23], v[142:143], v[84:85], v[22:23] op_sel:[0,1,0] op_sel_hi:[1,1,1]
    s_set_gpr_idx_off
    s_waitcnt vmcnt(5)
.p2align 3
    v_mfma_f32_16x16x16_bf16 v[128:131], v[160:161], v[120:121], 0
    v_readlane_b32 s68, v196, 6
    v_cvt_pk_bf16_f32 v10, v151, v151
    v_mfma_f32_16x16x16_bf16 v[132:135], v[160:161], v[122:123], 0
    v_and_b32 v162, v190, v10
    v_and_b32 v163, v191, v10
    s_and_b32 s61, s68, s49
    s_waitcnt vmcnt(4)
    buffer_load_dwordx4 v[112:115], v2, s[16:19], s61 offen
    v_mfma_f32_16x16x16_bf16 v[136:139], v[162:163], v[124:125], 0
    v_readlane_b32 s69, v196, 7
    v_cvt_pk_bf16_f32 v9, v152, v152
    v_mfma_f32_16x16x16_bf16 v[140:143], v[162:163], v[126:127], 0
    v_and_b32 v160, v190, v9
    v_and_b32 v161, v191, v9
    s_and_b32 s61, s69, s49
    s_set_gpr_idx_on s70, gpr_idx(SRC2,DST)
    buffer_load_dwordx4 v[116:119], v2, s[16:19], s61 offen
    v_pk_fma_f32 v[16:17], v[128:129], v[70:71], v[16:17] op_sel_hi:[1,0,1]
    v_pk_fma_f32 v[18:19], v[130:131], v[70:71], v[18:19] op_sel_hi:[1,0,1]
    v_pk_fma_f32 v[20:21], v[132:133], v[86:87], v[20:21] op_sel_hi:[1,0,1]
    v_pk_fma_f32 v[22:23], v[134:135], v[86:87], v[22:23] op_sel_hi:[1,0,1]
    s_set_gpr_idx_idx s71
.p2align 3
    v_pk_fma_f32 v[16:17], v[136:137], v[70:71], v[16:17] op_sel:[0,1,0] op_sel_hi:[1,1,1]
    v_pk_fma_f32 v[18:19], v[138:139], v[70:71], v[18:19] op_sel:[0,1,0] op_sel_hi:[1,1,1]
    v_pk_fma_f32 v[20:21], v[140:141], v[86:87], v[20:21] op_sel:[0,1,0] op_sel_hi:[1,1,1]
    v_pk_fma_f32 v[22:23], v[142:143], v[86:87], v[22:23] op_sel:[0,1,0] op_sel_hi:[1,1,1]
    s_set_gpr_idx_off
    s_waitcnt vmcnt(5)
.p2align 3
    v_mfma_f32_16x16x16_bf16 v[128:131], v[160:161], v[96:97], 0
    v_readlane_b32 s70, v196, 8
    v_cvt_pk_bf16_f32 v10, v153, v153
    v_mfma_f32_16x16x16_bf16 v[132:135], v[160:161], v[98:99], 0
    v_and_b32 v162, v190, v10
    v_and_b32 v163, v191, v10
    s_and_b32 s61, s70, s49
    s_waitcnt vmcnt(4)
    buffer_load_dwordx4 v[120:123], v2, s[16:19], s61 offen
    v_mfma_f32_16x16x16_bf16 v[136:139], v[162:163], v[100:101], 0
    v_readlane_b32 s71, v196, 9
    v_cvt_pk_bf16_f32 v9, v154, v154
    v_mfma_f32_16x16x16_bf16 v[140:143], v[162:163], v[102:103], 0
    v_and_b32 v160, v190, v9
    v_and_b32 v161, v191, v9
    s_and_b32 s61, s71, s49
    s_set_gpr_idx_on s64, gpr_idx(SRC2,DST)
    buffer_load_dwordx4 v[124:127], v2, s[16:19], s61 offen
    v_pk_fma_f32 v[16:17], v[128:129], v[72:73], v[16:17] op_sel_hi:[1,0,1]
    v_pk_fma_f32 v[18:19], v[130:131], v[72:73], v[18:19] op_sel_hi:[1,0,1]
    v_pk_fma_f32 v[20:21], v[132:133], v[88:89], v[20:21] op_sel_hi:[1,0,1]
    v_pk_fma_f32 v[22:23], v[134:135], v[88:89], v[22:23] op_sel_hi:[1,0,1]
    s_set_gpr_idx_idx s65
.p2align 3
    v_pk_fma_f32 v[16:17], v[136:137], v[72:73], v[16:17] op_sel:[0,1,0] op_sel_hi:[1,1,1]
    v_pk_fma_f32 v[18:19], v[138:139], v[72:73], v[18:19] op_sel:[0,1,0] op_sel_hi:[1,1,1]
    v_pk_fma_f32 v[20:21], v[140:141], v[88:89], v[20:21] op_sel:[0,1,0] op_sel_hi:[1,1,1]
    v_pk_fma_f32 v[22:23], v[142:143], v[88:89], v[22:23] op_sel:[0,1,0] op_sel_hi:[1,1,1]
    s_set_gpr_idx_off
    s_waitcnt vmcnt(5)
.p2align 3
    v_mfma_f32_16x16x16_bf16 v[128:131], v[160:161], v[104:105], 0
    v_cvt_pk_bf16_f32 v10, v155, v155
    v_mfma_f32_16x16x16_bf16 v[132:135], v[160:161], v[106:107], 0
    v_and_b32 v162, v190, v10
    v_and_b32 v163, v191, v10
    s_waitcnt vmcnt(4)
.p2align 3
    s_nop 0
    v_mfma_f32_16x16x16_bf16 v[136:139], v[162:163], v[108:109], 0
    v_cvt_pk_bf16_f32 v9, v156, v156
    v_mfma_f32_16x16x16_bf16 v[140:143], v[162:163], v[110:111], 0
    v_and_b32 v160, v190, v9
    v_and_b32 v161, v191, v9
    s_set_gpr_idx_on s66, gpr_idx(SRC2,DST)
.p2align 3
    v_pk_fma_f32 v[16:17], v[128:129], v[74:75], v[16:17] op_sel_hi:[1,0,1]
    v_pk_fma_f32 v[18:19], v[130:131], v[74:75], v[18:19] op_sel_hi:[1,0,1]
    v_pk_fma_f32 v[20:21], v[132:133], v[90:91], v[20:21] op_sel_hi:[1,0,1]
    v_pk_fma_f32 v[22:23], v[134:135], v[90:91], v[22:23] op_sel_hi:[1,0,1]
    s_set_gpr_idx_idx s67
.p2align 3
    v_pk_fma_f32 v[16:17], v[136:137], v[74:75], v[16:17] op_sel:[0,1,0] op_sel_hi:[1,1,1]
    v_pk_fma_f32 v[18:19], v[138:139], v[74:75], v[18:19] op_sel:[0,1,0] op_sel_hi:[1,1,1]
    v_pk_fma_f32 v[20:21], v[140:141], v[90:91], v[20:21] op_sel:[0,1,0] op_sel_hi:[1,1,1]
    v_pk_fma_f32 v[22:23], v[142:143], v[90:91], v[22:23] op_sel:[0,1,0] op_sel_hi:[1,1,1]
    s_set_gpr_idx_off
    s_waitcnt vmcnt(3)
.p2align 3
    v_mfma_f32_16x16x16_bf16 v[128:131], v[160:161], v[112:113], 0
    v_cvt_pk_bf16_f32 v10, v157, v157
    v_mfma_f32_16x16x16_bf16 v[132:135], v[160:161], v[114:115], 0
    v_and_b32 v162, v190, v10
    v_and_b32 v163, v191, v10
    s_waitcnt vmcnt(2)
.p2align 3
    s_nop 0
    v_mfma_f32_16x16x16_bf16 v[136:139], v[162:163], v[116:117], 0
    v_cvt_pk_bf16_f32 v9, v158, v158
    v_mfma_f32_16x16x16_bf16 v[140:143], v[162:163], v[118:119], 0
    v_and_b32 v160, v190, v9
    v_and_b32 v161, v191, v9
    s_set_gpr_idx_on s68, gpr_idx(SRC2,DST)
.p2align 3
    v_pk_fma_f32 v[16:17], v[128:129], v[76:77], v[16:17] op_sel_hi:[1,0,1]
    v_pk_fma_f32 v[18:19], v[130:131], v[76:77], v[18:19] op_sel_hi:[1,0,1]
    v_pk_fma_f32 v[20:21], v[132:133], v[92:93], v[20:21] op_sel_hi:[1,0,1]
    v_pk_fma_f32 v[22:23], v[134:135], v[92:93], v[22:23] op_sel_hi:[1,0,1]
    s_set_gpr_idx_idx s69
.p2align 3
    v_pk_fma_f32 v[16:17], v[136:137], v[76:77], v[16:17] op_sel:[0,1,0] op_sel_hi:[1,1,1]
    v_pk_fma_f32 v[18:19], v[138:139], v[76:77], v[18:19] op_sel:[0,1,0] op_sel_hi:[1,1,1]
    v_pk_fma_f32 v[20:21], v[140:141], v[92:93], v[20:21] op_sel:[0,1,0] op_sel_hi:[1,1,1]
    v_pk_fma_f32 v[22:23], v[142:143], v[92:93], v[22:23] op_sel:[0,1,0] op_sel_hi:[1,1,1]
    s_set_gpr_idx_off
    s_waitcnt vmcnt(1)
.p2align 3
    v_mfma_f32_16x16x16_bf16 v[128:131], v[160:161], v[120:121], 0
    v_cvt_pk_bf16_f32 v10, v159, v159
    v_mfma_f32_16x16x16_bf16 v[132:135], v[160:161], v[122:123], 0
    v_and_b32 v162, v190, v10
    v_and_b32 v163, v191, v10
    s_waitcnt vmcnt(0)
.p2align 3
    s_nop 0
    v_mfma_f32_16x16x16_bf16 v[136:139], v[162:163], v[124:125], 0
    v_mfma_f32_16x16x16_bf16 v[140:143], v[162:163], v[126:127], 0
    s_set_gpr_idx_on s70, gpr_idx(SRC2,DST)
.p2align 3
    v_pk_fma_f32 v[16:17], v[128:129], v[78:79], v[16:17] op_sel_hi:[1,0,1]
    v_pk_fma_f32 v[18:19], v[130:131], v[78:79], v[18:19] op_sel_hi:[1,0,1]
    v_pk_fma_f32 v[20:21], v[132:133], v[94:95], v[20:21] op_sel_hi:[1,0,1]
    v_pk_fma_f32 v[22:23], v[134:135], v[94:95], v[22:23] op_sel_hi:[1,0,1]
    s_set_gpr_idx_idx s71
.p2align 3
    s_nop 0
    v_pk_fma_f32 v[16:17], v[136:137], v[78:79], v[16:17] op_sel:[0,1,0] op_sel_hi:[1,1,1]
    v_pk_fma_f32 v[18:19], v[138:139], v[78:79], v[18:19] op_sel:[0,1,0] op_sel_hi:[1,1,1]
    v_pk_fma_f32 v[20:21], v[140:141], v[94:95], v[20:21] op_sel:[0,1,0] op_sel_hi:[1,1,1]
    v_pk_fma_f32 v[22:23], v[142:143], v[94:95], v[22:23] op_sel:[0,1,0] op_sel_hi:[1,1,1]
    s_set_gpr_idx_off
L_swept:
    s_add_u32 s48, s48, 224
    s_cmp_lt_u32 s48, s47
    s_cbranch_scc1 L_again
    s_setprio 0
    v_cvt_pk_bf16_f32 v64, v16, v20
    v_cvt_pk_bf16_f32 v65, v17, v21
    v_cvt_pk_bf16_f32 v66, v18, v22
    v_cvt_pk_bf16_f32 v67, v19, v23
    ds_write2_b32 v208, v64, v65 offset0:0 offset1:72
    ds_write2_b32 v208, v66, v67 offset0:144 offset1:216
    v_cvt_pk_bf16_f32 v68, v24, v28
    v_cvt_pk_bf16_f32 v69, v25, v29
    v_cvt_pk_bf16_f32 v70, v26, v30
    v_cvt_pk_bf16_f32 v71, v27, v31
    ds_write2_b32 v209, v68, v69 offset0:0 offset1:72
    ds_write2_b32 v209, v70, v71 offset0:144 offset1:216
    v_cvt_pk_bf16_f32 v72, v32, v36
    v_cvt_pk_bf16_f32 v73, v33, v37
    v_cvt_pk_bf16_f32 v74, v34, v38
    v_cvt_pk_bf16_f32 v75, v35, v39
    ds_write2_b32 v210, v72, v73 offset0:0 offset1:72
    ds_write2_b32 v210, v74, v75 offset0:144 offset1:216
    v_cvt_pk_bf16_f32 v76, v40, v44
    v_cvt_pk_bf16_f32 v77, v41, v45
    v_cvt_pk_bf16_f32 v78, v42, v46
    v_cvt_pk_bf16_f32 v79, v43, v47
    ds_write2_b32 v211, v76, v77 offset0:0 offset1:72
    ds_write2_b32 v211, v78, v79 offset0:144 offset1:216
    v_cvt_pk_bf16_f32 v80, v48, v52
    v_cvt_pk_bf16_f32 v81, v49, v53
    v_cvt_pk_bf16_f32 v82, v50, v54
    v_cvt_pk_bf16_f32 v83, v51, v55
    ds_write2_b32 v212, v80, v81 offset0:0 offset1:72
    ds_write2_b32 v212, v82, v83 offset0:144 offset1:216
    ds_read_b128 v[96:99], v215 offset:6144
    ds_read_b128 v[100:103], v215 offset:7168
    ds_read_b128 v[104:107], v215 offset:8192
    ds_read_b128 v[108:111], v215 offset:9216
    ds_read_b128 v[112:115], v215 offset:10240
    ds_read_b128 v[116:119], v215 offset:11264
    ds_read_b128 v[120:123], v215 offset:12288
    ds_read_b128 v[124:127], v215 offset:13312
    ds_read_b128 v[128:131], v215 offset:14336
    ds_read_b128 v[132:135], v215 offset:15360
    s_waitcnt lgkmcnt(10)
    s_barrier
    ds_read_b128 v[16:19], v213 offset:0
    ds_read_b128 v[20:23], v213 offset:64
    ds_read_b128 v[24:27], v213 offset:128
    ds_read_b128 v[28:31], v213 offset:192
    s_waitcnt lgkmcnt(3)
    v_mfma_f32_16x16x32_bf16 v[160:163], v[16:19], v[216:219], 0
    v_mfma_f32_16x16x32_bf16 v[164:167], v[16:19], v[220:223], 0
    v_mfma_f32_16x16x32_bf16 v[168:171], v[16:19], v[224:227], 0
    v_mfma_f32_16x16x32_bf16 v[172:175], v[16:19], v[228:231], 0
    ds_read_b128 v[32:35], v213 offset:4608
    ds_read_b128 v[36:39], v213 offset:4672
    ds_read_b128 v[40:43], v213 offset:4736
    ds_read_b128 v[44:47], v213 offset:4800
    s_waitcnt lgkmcnt(6)
    v_mfma_f32_16x16x32_bf16 v[160:163], v[20:23], v[232:235], v[160:163]
    v_mfma_f32_16x16x32_bf16 v[164:167], v[20:23], v[236:239], v[164:167]
    v_mfma_f32_16x16x32_bf16 v[168:171], v[20:23], v[96:99], v[168:171]
    v_mfma_f32_16x16x32_bf16 v[172:175], v[20:23], v[100:103], v[172:175]
    ds_read_b128 v[48:51], v213 offset:9216
    ds_read_b128 v[52:55], v213 offset:9280
    ds_read_b128 v[56:59], v213 offset:9344
    ds_read_b128 v[60:63], v213 offset:9408
    s_waitcnt lgkmcnt(9)
    v_mfma_f32_16x16x32_bf16 v[160:163], v[24:27], v[104:107], v[160:163]
    v_mfma_f32_16x16x32_bf16 v[164:167], v[24:27], v[108:111], v[164:167]
    v_mfma_f32_16x16x32_bf16 v[168:171], v[24:27], v[112:115], v[168:171]
    v_mfma_f32_16x16x32_bf16 v[172:175], v[24:27], v[116:119], v[172:175]
    s_waitcnt lgkmcnt(8)
    v_mfma_f32_16x16x32_bf16 v[160:163], v[28:31], v[120:123], v[160:163]
    v_mfma_f32_16x16x32_bf16 v[164:167], v[28:31], v[124:127], v[164:167]
    v_mfma_f32_16x16x32_bf16 v[168:171], v[28:31], v[128:131], v[168:171]
    v_mfma_f32_16x16x32_bf16 v[172:175], v[28:31], v[132:135], v[172:175]
    s_waitcnt lgkmcnt(4)
    v_mfma_f32_16x16x32_bf16 v[176:179], v[32:35], v[216:219], 0
    v_mfma_f32_16x16x32_bf16 v[180:183], v[32:35], v[220:223], 0
    v_mfma_f32_16x16x32_bf16 v[184:187], v[32:35], v[224:227], 0
    v_mfma_f32_16x16x32_bf16 v[188:191], v[32:35], v[228:231], 0
    v_mfma_f32_16x16x32_bf16 v[176:179], v[36:39], v[232:235], v[176:179]
    v_cvt_pk_bf16_f32 v64, v160, v164
    v_cvt_pk_bf16_f32 v80, v160, v164
    v_mfma_f32_16x16x32_bf16 v[180:183], v[36:39], v[236:239], v[180:183]
    v_cvt_pk_bf16_f32 v66, v162, v166
    v_cvt_pk_bf16_f32 v65, v168, v172
    v_mfma_f32_16x16x32_bf16 v[184:187], v[36:39], v[96:99], v[184:187]
    v_cvt_pk_bf16_f32 v81, v168, v172
    v_cvt_pk_bf16_f32 v67, v170, v174
    v_mfma_f32_16x16x32_bf16 v[188:191], v[36:39], v[100:103], v[188:191]
    v_mov_b32_dpp v64, v66 row_ror:8 row_mask:0xf bank_mask:0xc
    v_mov_b32_dpp v65, v67 row_ror:8 row_mask:0xf bank_mask:0xc
    v_mfma_f32_16x16x32_bf16 v[176:179], v[40:43], v[104:107], v[176:179]
    v_mov_b32_dpp v66, v80 row_ror:8 row_mask:0xf bank_mask:0x3
    v_mov_b32_dpp v67, v81 row_ror:8 row_mask:0xf bank_mask:0x3
    v_mfma_f32_16x16x32_bf16 v[180:183], v[40:43], v[108:111], v[180:183]
    buffer_store_dwordx4 v[64:67], v214, s[40:43], s87 offen offset:0 sc1
    v_cvt_pk_bf16_f32 v68, v161, v165
    v_mfma_f32_16x16x32_bf16 v[184:187], v[40:43], v[112:115], v[184:187]
    v_cvt_pk_bf16_f32 v82, v161, v165
    v_cvt_pk_bf16_f32 v70, v163, v167
    v_mfma_f32_16x16x32_bf16 v[188:191], v[40:43], v[116:119], v[188:191]
    v_cvt_pk_bf16_f32 v69, v169, v173
    v_cvt_pk_bf16_f32 v83, v169, v173
    v_mfma_f32_16x16x32_bf16 v[176:179], v[44:47], v[120:123], v[176:179]
    v_cvt_pk_bf16_f32 v71, v171, v175
    v_mov_b32_dpp v68, v70 row_ror:8 row_mask:0xf bank_mask:0xc
    v_mfma_f32_16x16x32_bf16 v[180:183], v[44:47], v[124:127], v[180:183]
    v_mov_b32_dpp v69, v71 row_ror:8 row_mask:0xf bank_mask:0xc
    v_mov_b32_dpp v70, v82 row_ror:8 row_mask:0xf bank_mask:0x3
    v_mfma_f32_16x16x32_bf16 v[184:187], v[44:47], v[128:131], v[184:187]
    v_mov_b32_dpp v71, v83 row_ror:8 row_mask:0xf bank_mask:0x3
    buffer_store_dwordx4 v[68:71], v214, s[40:43], s87 offen offset:256 sc1
    v_mfma_f32_16x16x32_bf16 v[188:191], v[44:47], v[132:135], v[188:191]
    s_add_u32 s87, s87, 4096
    s_cmp_ge_u32 s3, 4
    s_cbranch_scc1 L_two
    s_waitcnt lgkmcnt(0)
    v_mfma_f32_16x16x32_bf16 v[160:163], v[48:51], v[216:219], 0
    v_mfma_f32_16x16x32_bf16 v[164:167], v[48:51], v[220:223], 0
    v_mfma_f32_16x16x32_bf16 v[168:171], v[48:51], v[224:227], 0
    v_mfma_f32_16x16x32_bf16 v[172:175], v[48:51], v[228:231], 0
    v_mfma_f32_16x16x32_bf16 v[160:163], v[52:55], v[232:235], v[160:163]
    v_cvt_pk_bf16_f32 v72, v176, v180
    v_cvt_pk_bf16_f32 v80, v176, v180
    v_mfma_f32_16x16x32_bf16 v[164:167], v[52:55], v[236:239], v[164:167]
    v_cvt_pk_bf16_f32 v74, v178, v182
    v_cvt_pk_bf16_f32 v73, v184, v188
    v_mfma_f32_16x16x32_bf16 v[168:171], v[52:55], v[96:99], v[168:171]
    v_cvt_pk_bf16_f32 v81, v184, v188
    v_cvt_pk_bf16_f32 v75, v186, v190
    v_mfma_f32_16x16x32_bf16 v[172:175], v[52:55], v[100:103], v[172:175]
    v_mov_b32_dpp v72, v74 row_ror:8 row_mask:0xf bank_mask:0xc
    v_mov_b32_dpp v73, v75 row_ror:8 row_mask:0xf bank_mask:0xc
    v_mfma_f32_16x16x32_bf16 v[160:163], v[56:59], v[104:107], v[160:163]
    v_mov_b32_dpp v74, v80 row_ror:8 row_mask:0xf bank_mask:0x3
    v_mov_b32_dpp v75, v81 row_ror:8 row_mask:0xf bank_mask:0x3
    v_mfma_f32_16x16x32_bf16 v[164:167], v[56:59], v[108:111], v[164:167]
    buffer_store_dwordx4 v[72:75], v214, s[40:43], s87 offen offset:0 sc1
    v_cvt_pk_bf16_f32 v76, v177, v181
    v_mfma_f32_16x16x32_bf16 v[168:171], v[56:59], v[112:115], v[168:171]
    v_cvt_pk_bf16_f32 v82, v177, v181
    v_cvt_pk_bf16_f32 v78, v179, v183
    v_mfma_f32_16x16x32_bf16 v[172:175], v[56:59], v[116:119], v[172:175]
    v_cvt_pk_bf16_f32 v77, v185, v189
    v_cvt_pk_bf16_f32 v83, v185, v189
    v_mfma_f32_16x16x32_bf16 v[160:163], v[60:63], v[120:123], v[160:163]
    v_cvt_pk_bf16_f32 v79, v187, v191
    v_mov_b32_dpp v76, v78 row_ror:8 row_mask:0xf bank_mask:0xc
    v_mfma_f32_16x16x32_bf16 v[164:167], v[60:63], v[124:127], v[164:167]
    v_mov_b32_dpp v77, v79 row_ror:8 row_mask:0xf bank_mask:0xc
    v_mov_b32_dpp v78, v82 row_ror:8 row_mask:0xf bank_mask:0x3
    v_mfma_f32_16x16x32_bf16 v[168:171], v[60:63], v[128:131], v[168:171]
    v_mov_b32_dpp v79, v83 row_ror:8 row_mask:0xf bank_mask:0x3
    buffer_store_dwordx4 v[76:79], v214, s[40:43], s87 offen offset:256 sc1
    v_mfma_f32_16x16x32_bf16 v[172:175], v[60:63], v[132:135], v[172:175]
    s_add_u32 s87, s87, 4096
    s_nop 0
    v_cvt_pk_bf16_f32 v64, v160, v164
    v_cvt_pk_bf16_f32 v80, v160, v164
    v_cvt_pk_bf16_f32 v66, v162, v166
    s_nop 2
    v_cvt_pk_bf16_f32 v65, v168, v172
    v_cvt_pk_bf16_f32 v81, v168, v172
    v_cvt_pk_bf16_f32 v67, v170, v174
    v_mov_b32_dpp v64, v66 row_ror:8 row_mask:0xf bank_mask:0xc
    s_nop 0
    v_mov_b32_dpp v65, v67 row_ror:8 row_mask:0xf bank_mask:0xc
    v_mov_b32_dpp v66, v80 row_ror:8 row_mask:0xf bank_mask:0x3
    v_mov_b32_dpp v67, v81 row_ror:8 row_mask:0xf bank_mask:0x3
    buffer_store_dwordx4 v[64:67], v214, s[40:43], s87 offen offset:0 sc1
    v_cvt_pk_bf16_f32 v68, v161, v165
    v_cvt_pk_bf16_f32 v82, v161, v165
    v_cvt_pk_bf16_f32 v70, v163, v167
    v_cvt_pk_bf16_f32 v69, v169, v173
    v_cvt_pk_bf16_f32 v83, v169, v173
    v_cvt_pk_bf16_f32 v71, v171, v175
    v_mov_b32_dpp v68, v70 row_ror:8 row_mask:0xf bank_mask:0xc
    s_nop 0
    v_mov_b32_dpp v69, v71 row_ror:8 row_mask:0xf bank_mask:0xc
    v_mov_b32_dpp v70, v82 row_ror:8 row_mask:0xf bank_mask:0x3
    v_mov_b32_dpp v71, v83 row_ror:8 row_mask:0xf bank_mask:0x3
    buffer_store_dwordx4 v[68:71], v214, s[40:43], s87 offen offset:256 sc1
    s_add_u32 s87, s87, 4096
L_stored:
    s_or_b32 s4, s2, s3
    s_cbranch_scc1 L_notag
    v_mov_b32 v8, s62
    v_lshlrev_b32 v10, 2, v1
    s_mov_b32 s54, 524288
    buffer_store_dword v8, v10, s[20:23], s54 offen sc1
L_notag:
L_done:
    s_endpgm
L_again:
    s_waitcnt vmcnt(0) lgkmcnt(0)
    s_barrier
    v_lshlrev_b32 v11, 2, v0
    v_mov_b32 v12, 0x00700000
    v_mov_b32 v13, 0
    ds_write_b32 v11, v12 offset:0
    ds_write_b32 v11, v12 offset:2048
    ds_write_b32 v11, v12 offset:4096
    ds_write_b32 v11, v12 offset:6144
    ds_write_b32 v11, v13 offset:8192
    ds_write_b32 v11, v13 offset:10240
    ds_write_b32 v11, v13 offset:12288
    v_mov_b32 v64, 0
    v_mov_b32 v65, 0
    v_mov_b32 v66, 0
    v_mov_b32 v67, 0
    v_mov_b32 v68, 0
    v_mov_b32 v69, 0
    v_mov_b32 v70, 0
    v_mov_b32 v71, 0
    v_mov_b32 v72, 0
    v_mov_b32 v73, 0
    v_mov_b32 v74, 0
    v_mov_b32 v75, 0
    v_mov_b32 v76, 0
    v_mov_b32 v77, 0
    v_mov_b32 v78, 0
    v_mov_b32 v79, 0
    v_mov_b32 v80, 0
    v_mov_b32 v81, 0
    v_mov_b32 v82, 0
    v_mov_b32 v83, 0
    v_mov_b32 v84, 0
    v_mov_b32 v85, 0
    v_mov_b32 v86, 0
    v_mov_b32 v87, 0
    v_mov_b32 v88, 0
    v_mov_b32 v89, 0
    v_mov_b32 v90, 0
    v_mov_b32 v91, 0
    v_mov_b32 v92, 0
    v_mov_b32 v93, 0
    v_mov_b32 v94, 0
    v_mov_b32 v95, 0
    v_add_u32 v3, v3, v4
    v_subrev_u32 v3, 224, v3
    v_max_i32 v3, 0, v3
    v_subrev_u32 v4, 224, v4
    v_max_i32 v4, 0, v4
    v_sub_u32 v3, v3, v4
    v_add_u32 v5, 224, v5
    s_sub_i32 s95, s95, 224
    v_lshl_add_u32 v8, v4, 2, v241
    s_waitcnt lgkmcnt(0)
    s_barrier
L_clip:
    v_add_u32 v10, v4, v3
    v_min_i32 v10, 224, v10
    v_sub_u32 v10, v10, v4
    v_add_u32 v10, v10, v240
L_masks:
    v_cmp_lt_i32 s[64:65], 0, v10
    v_cmp_lt_i32 s[66:67], 2, v10
    v_cmp_lt_i32 s[68:69], 4, v10
    v_cmp_lt_i32 s[70:71], 6, v10
    v_cmp_lt_i32 s[72:73], 8, v10
    v_cmp_lt_i32 s[74:75], 10, v10
    v_cmp_lt_i32 s[76:77], 12, v10
    v_cmp_lt_i32 s[78:79], 14, v10
    s_nop 0
    s_branch L_mapw
L_map2:
    v_add_u32 v8, 56, v8
    v_subrev_u32 v10, 14, v10
    s_branch L_masks
L_r1:
    ds_read_b32 v139, v242 offset:768
    ds_read_b32 v146, v243 offset:768
    s_waitcnt lgkmcnt(0)
    v_mad_u32_u24 v139, v139, 12, v244
    buffer_load_dwordx3 v[160:162], v139, s[24:27], 0 offen offset:2304 sc1
    v_lshl_add_u32 v146, v146, 5, v2
    s_add_u32 m0, s52, 4096
    s_nop 0
    buffer_load_dwordx4 v146, s[28:31], s98 offen offset:2048 sc1 lds
    s_branch L_r1b
L_r2:
    v_lshrrev_b32 v135, 21, v162
    v_lshlrev_b32 v135, 2, v135
    v_lshrrev_b32 v11, 26, v162
    v_lshl_or_b32 v11, v11, 4, v245
    s_mov_b64 exec, s[96:97]
    ds_add_rtn_u32 v131, v135, v6 offset:8192
    ds_add_u32 v11, v6 offset:14336
    s_mov_b64 exec, -1
    s_mov_b32 exec_hi, 0
    ds_write_b64 v246, v[160:161] offset:1536
    s_mov_b32 exec_hi, -1
    v_and_or_b32 v162, v162, s55, v247
    v_add_u32 v162, 402653184, v162
    s_branch L_r2b
L_r3:
    ds_read_b32 v135, v135 offset:8192
    s_waitcnt lgkmcnt(0)
    v_bfe_u32 v15, v135, 12, 3
    v_or_b32 v162, v15, v162
    v_and_b32 v139, 0x3ff, v135
    v_lshrrev_b32 v135, 16, v135
    v_add_u32 v135, v135, v131
    ds_read_b32 v139, v139 offset:16384
    s_waitcnt lgkmcnt(0)
    v_lshl_add_u32 v135, v135, 2, v139
    s_mov_b64 exec, s[96:97]
    ds_write_b32 v135, v162
    s_mov_b64 exec, -1
    s_branch L_r3b
L_empty:
    s_waitcnt vmcnt(0) lgkmcnt(0)
    s_barrier
    v_lshlrev_b32 v12, 2, v1
    s_lshl_b32 s61, s3, 7
    v_and_b32 v205, 0x7380, v205
    v_xor_b32 v205, s61, v205
    v_alignbit_b32 v205, v205, v205, 12
    v_cmp_eq_u32 s[80:81], 0, v205
    v_cmp_eq_u32 s[82:83], 1, v205
    v_cmp_eq_u32 s[84:85], 2, v205
    v_cmp_eq_u32 s[96:97], 3, v205
    v_cmp_eq_u32 vcc, 4, v205
    s_ff1_i32_b64 s56, s[80:81]
    s_mul_i32 s56, s56, 1152
    v_add_u32 v208, s56, v12
    s_ff1_i32_b64 s57, s[82:83]
    s_mul_i32 s57, s57, 1152
    v_add_u32 v209, s57, v12
    s_ff1_i32_b64 s58, s[84:85]
    s_mul_i32 s58, s58, 1152
    v_add_u32 v210, s58, v12
    s_ff1_i32_b64 s59, s[96:97]
    s_mul_i32 s59, s59, 1152
    v_add_u32 v211, s59, v12
    s_ff1_i32_b64 s60, vcc
    s_mul_i32 s60, s60, 1152
    v_add_u32 v212, s60, v12
    s_branch L_swept
L_two:
    s_nop 7
    v_cvt_pk_bf16_f32 v72, v176, v180
    v_cvt_pk_bf16_f32 v80, v176, v180
    v_cvt_pk_bf16_f32 v74, v178, v182
    v_cvt_pk_bf16_f32 v73, v184, v188
    v_cvt_pk_bf16_f32 v81, v184, v188
    v_cvt_pk_bf16_f32 v75, v186, v190
    v_mov_b32_dpp v72, v74 row_ror:8 row_mask:0xf bank_mask:0xc
    s_nop 0
    v_mov_b32_dpp v73, v75 row_ror:8 row_mask:0xf bank_mask:0xc
    v_mov_b32_dpp v74, v80 row_ror:8 row_mask:0xf bank_mask:0x3
    v_mov_b32_dpp v75, v81 row_ror:8 row_mask:0xf bank_mask:0x3
    buffer_store_dwordx4 v[72:75], v214, s[40:43], s87 offen offset:0 sc1
    v_cvt_pk_bf16_f32 v76, v177, v181
    v_cvt_pk_bf16_f32 v82, v177, v181
    v_cvt_pk_bf16_f32 v78, v179, v183
    v_cvt_pk_bf16_f32 v77, v185, v189
    v_cvt_pk_bf16_f32 v83, v185, v189
    v_cvt_pk_bf16_f32 v79, v187, v191
    v_mov_b32_dpp v76, v78 row_ror:8 row_mask:0xf bank_mask:0xc
    s_nop 0
    v_mov_b32_dpp v77, v79 row_ror:8 row_mask:0xf bank_mask:0xc
    v_mov_b32_dpp v78, v82 row_ror:8 row_mask:0xf bank_mask:0x3
    v_mov_b32_dpp v79, v83 row_ror:8 row_mask:0xf bank_mask:0x3
    buffer_store_dwordx4 v[76:79], v214, s[40:43], s87 offen offset:256 sc1
    s_add_u32 s87, s87, 4096
    s_branch L_stored
L_poll:
    buffer_load_dwordx2 v[206:207], v10, s[20:23], s49 offen sc1
    s_sub_u32 s53, s53, 1
    s_cbranch_scc1 L_done
    s_waitcnt vmcnt(0)
    v_xor_b32 v11, s63, v206
    v_xor_b32 v12, s62, v207
    v_and_or_b32 v11, v11, s55, v12
    v_cmpx_ne_u32 vcc, 0, v11
    s_cbranch_execnz L_poll
    s_branch L_polled
L_rank2:
    ds_read_b32 v96, v248 offset:8192
    ds_read_b32 v97, v248 offset:8320
    ds_read_b32 v98, v248 offset:8448
    ds_read_b32 v99, v248 offset:8576
    ds_read_b32 v100, v248 offset:8704
    ds_write_b64 v246, v[148:149] offset:0
    v_and_or_b32 v150, v150, s55, v247
    ds_write_b64 v246, v[152:153] offset:512
    v_and_or_b32 v154, v154, s55, v247
    v_add_u32 v154, 134217728, v154
    ds_write_b64 v246, v[156:157] offset:1024
    v_and_or_b32 v158, v158, s55, v247
    v_add_u32 v158, 268435456, v158
    s_waitcnt lgkmcnt(0)
L_end:
    s_branch L_ranked
.section .rodata,"a"
.p2align 6
.amdhsa_kernel gather_scatter__tensor_product_equiv_mace__graph_kernel
  .amdhsa_next_free_vgpr 256
  .amdhsa_next_free_sgpr 102
  .amdhsa_accum_offset 256
  .amdhsa_group_segment_fixed_size 0
  .amdhsa_kernarg_size 88
  .amdhsa_user_sgpr_count 2
  .amdhsa_user_sgpr_kernarg_segment_ptr 1
  .amdhsa_system_sgpr_workgroup_id_x 1
  .amdhsa_float_denorm_mode_32 3
.end_amdhsa_kernel
```

```asm
; @launch grid=(256,1,1) block=(512,1,1) lds=158784
.amdgcn_target "amdgcn-amd-amdhsa--gfx950"
.text
.globl gather_scatter__tensor_product_equiv_mace__graph_kernel
.p2align 8
.type gather_scatter__tensor_product_equiv_mace__graph_kernel,@function
gather_scatter__tensor_product_equiv_mace__graph_kernel:
    s_cmp_ge_u32 s2, 256
    s_cbranch_scc1 L_done
    s_load_dwordx4 s[4:7], s[0:1], 8
    s_load_dwordx4 s[8:11], s[0:1], 24
    s_load_dwordx2 s[14:15], s[0:1], 80
    s_load_dwordx2 s[64:65], s[0:1], 0
    s_load_dwordx2 s[66:67], s[0:1], 40
    s_load_dwordx4 s[68:71], s[0:1], 48
    s_load_dwordx2 s[12:13], s[0:1], 64
    v_lshlrev_b32 v10, 3, v0
    s_getpc_b64 s[80:81]
L_pc:
    s_and_b32 s44, s2, 0xf8
    s_lshl_b32 s44, s44, 6
    v_and_b32 v11, 0x180, v10
    v_add_u32 v11, s44, v11
    v_min_u32 v11, L_end-L_pc, v11
    v_mov_b32 v113, s81
    v_add_co_u32 v112, vcc, s80, v11
    s_nop 1
    v_addc_co_u32 v113, vcc, 0, v113, vcc
    global_load_dword v205, v[112:113], off
    v_lshrrev_b32 v8, 6, v0
    v_and_b32 v1, 63, v0
    v_lshlrev_b32 v9, 2, v0
    v_mov_b32 v13, 0
    v_readfirstlane_b32 s3, v8
    ds_write_b32 v9, v13 offset:23552
    ds_write_b32 v9, v13 offset:28672
    s_mul_i32 s54, s2, 5000
    s_mul_i32 s55, s2, 10000
    s_mul_i32 s61, s2, 40000
    v_lshlrev_b32 v2, 4, v1
    v_lshlrev_b32 v15, 4, v0
    v_mov_b32 v6, 1
    s_lshl_b32 s52, s3, 10
    s_add_u32 s52, s52, 101376
    s_movk_i32 s53, 4096
    s_movk_i32 s50, 8192
    s_mov_b32 s34, 5000
    s_mov_b32 s35, 0x20000
    s_mov_b32 s38, 5000
    s_mov_b32 s39, 0x20000
    s_mov_b32 s98, 10000
    s_mov_b32 s99, 0x20000
    s_mov_b32 s30, 40000
    s_mov_b32 s31, 0x20000
    s_waitcnt lgkmcnt(0)
    s_add_u32 s32, s6, s54
    s_addc_u32 s33, s7, 0
    buffer_load_dword v64, v9, s[32:35], 0 offen offset:0 nt
    buffer_load_dword v65, v9, s[32:35], 0 offen offset:2048 nt
    buffer_load_dword v66, v9, s[32:35], s53 offen nt
    s_add_u32 s36, s4, s54
    s_addc_u32 s37, s5, 0
    s_barrier
    buffer_load_dword v68, v9, s[36:39], 0 offen offset:0 nt
    buffer_load_dword v69, v9, s[36:39], 0 offen offset:2048 nt
    buffer_load_dword v70, v9, s[36:39], s53 offen nt
    s_load_dword s62, s[14:15], 524288
    s_add_u32 s96, s8, s55
    s_addc_u32 s97, s9, 0
    s_add_u32 s28, s10, s61
    s_addc_u32 s29, s11, 0
    buffer_load_dwordx2 v[72:73], v10, s[96:99], 0 offen nt
    buffer_load_dwordx2 v[74:75], v10, s[96:99], s53 offen nt
    buffer_load_dwordx2 v[76:77], v10, s[96:99], s50 offen nt
    s_add_u32 m0, s52, 0
    s_mov_b32 s54, 0
    buffer_load_dwordx4 v15, s[28:31], s54 offen nt lds
    s_add_u32 m0, s52, 8192
    s_mov_b32 s54, 8192
    buffer_load_dwordx4 v15, s[28:31], s54 offen nt lds
    s_add_u32 m0, s52, 16384
    s_mov_b32 s54, 16384
    buffer_load_dwordx4 v15, s[28:31], s54 offen nt lds
    s_mov_b32 s72, 109951168
    s_movk_i32 s73, 625
    s_movk_i32 s74, 838
    s_movk_i32 s54, 226
    v_cmp_gt_u32 s[84:85], s54, v0
    s_mov_b32 s20, s14
    s_mov_b32 s21, s15
    s_mov_b32 s22, 524352
    s_mov_b32 s23, 0x20000
    v_lshlrev_b32 v11, 2, v0
    v_mov_b32 v12, 0x00700000
    v_mov_b32 v13, 0
    ds_write_b32 v11, v12 offset:0
    ds_write_b32 v11, v12 offset:2048
    ds_write_b32 v11, v12 offset:4096
    ds_write_b32 v11, v12 offset:6144
    ds_write_b32 v11, v13 offset:8192
    ds_write_b32 v11, v13 offset:10240
    ds_write_b32 v11, v13 offset:12288
    ds_write_b32 v11, v13 offset:14336
    s_waitcnt vmcnt(9)
    v_mul_hi_u32 v80, v64, s72
    v_mul_hi_u32 v81, v65, s72
    v_mul_hi_u32 v82, v66, s72
    v_lshlrev_b32 v84, 2, v80
    ds_add_rtn_u32 v88, v84, v6 offset:23552
    v_lshlrev_b32 v85, 2, v81
    ds_add_rtn_u32 v89, v85, v6 offset:23552
    v_lshlrev_b32 v86, 2, v82
    s_mov_b64 exec, s[84:85]
    ds_add_rtn_u32 v90, v86, v6 offset:23552
    s_mov_b64 exec, -1
    s_waitcnt lgkmcnt(0)
    s_barrier
    ds_read_b128 v[100:103], v2 offset:23552
    s_mul_i32 s62, s62, 0x9e3779b1
    s_add_u32 s62, s62, 0x7f4a7c15
    s_mul_i32 s63, s62, 0x85ebca6b
    s_and_b32 s63, s63, 0xffc00000
    s_add_u32 m0, s52, 24576
    s_mov_b32 s54, 24576
    buffer_load_dwordx4 v15, s[28:31], s54 offen nt lds
    s_add_u32 m0, s52, 32768
    s_mov_b32 s54, 32768
    buffer_load_dwordx4 v15, s[28:31], s54 offen nt lds
    v_mad_u32_u24 v92, v80, s73, 15
    v_lshrrev_b32 v92, 4, v92
    v_sub_u32 v92, v64, v92
    v_mad_u32_u24 v93, v81, s73, 15
    v_lshrrev_b32 v93, 4, v93
    v_sub_u32 v93, v65, v93
    v_mad_u32_u24 v94, v82, s73, 15
    v_lshrrev_b32 v94, 4, v94
    v_sub_u32 v94, v66, v94
    s_waitcnt lgkmcnt(0)
    v_add_u32 v11, v100, v101
    v_add3_u32 v11, v11, v102, v103
    v_mov_b32 v12, v11
    s_nop 1
    v_add_u32_dpp v12, v12, v12 row_shr:1 row_mask:0xf bank_mask:0xf
    s_nop 1
    v_add_u32_dpp v12, v12, v12 row_shr:2 row_mask:0xf bank_mask:0xf
    s_nop 1
    v_add_u32_dpp v12, v12, v12 row_shr:4 row_mask:0xf bank_mask:0xf
    s_nop 1
    v_add_u32_dpp v12, v12, v12 row_shr:8 row_mask:0xf bank_mask:0xf
    s_nop 1
    v_add_u32_dpp v12, v12, v12 row_bcast:15 row_mask:0xa bank_mask:0xf
    s_nop 1
    v_add_u32_dpp v12, v12, v12 row_bcast:31 row_mask:0xc bank_mask:0xf
    v_sub_u32 v104, v12, v11
    v_add_u32 v105, v104, v100
    v_add_u32 v106, v105, v101
    v_add_u32 v107, v106, v102
    ds_write_b128 v2, v[104:107] offset:24576
    ds_read_b32 v108, v84 offset:24576
    ds_read_b32 v109, v85 offset:24576
    ds_read_b32 v110, v86 offset:24576
    s_waitcnt vmcnt(8)
    v_mul_u32_u24 v96, s74, v68
    v_bfe_u32 v96, v96, 18, 5
    v_lshl_or_b32 v96, v92, 5, v96
    v_lshlrev_b32 v96, 21, v96
    v_lshl_or_b32 v96, v68, 7, v96
    v_mul_u32_u24 v97, s74, v69
    v_bfe_u32 v97, v97, 18, 5
    v_lshl_or_b32 v97, v93, 5, v97
    v_lshlrev_b32 v97, 21, v97
    v_lshl_or_b32 v97, v69, 7, v97
    v_mul_u32_u24 v98, s74, v70
    v_bfe_u32 v98, v98, 18, 5
    v_lshl_or_b32 v98, v94, 5, v98
    v_lshlrev_b32 v98, 21, v98
    v_lshl_or_b32 v98, v70, 7, v98
    v_lshlrev_b32 v92, 5, v0
    v_add_u32 v93, 16384, v92
    v_add_u32 v94, 32768, v92
    s_mov_b32 s55, 30720
    s_waitcnt vmcnt(5) lgkmcnt(0)
    v_add_u32 v108, v108, v88
    v_lshlrev_b32 v84, 2, v108
    v_mad_u32_u24 v108, v108, 12, s55
    ds_write_b32 v84, v92 offset:25600
    ds_write2_b32 v108, v72, v73 offset0:0 offset1:1
    ds_write_b32 v108, v96 offset:8
    v_add_u32 v109, v109, v89
    v_lshlrev_b32 v85, 2, v109
    v_mad_u32_u24 v109, v109, 12, s55
    ds_write_b32 v85, v93 offset:25600
    ds_write2_b32 v109, v74, v75 offset0:0 offset1:1
    ds_write_b32 v109, v97 offset:8
    v_add_u32 v110, v110, v90
    v_lshlrev_b32 v86, 2, v110
    v_mad_u32_u24 v110, v110, 12, s55
    s_mov_b64 exec, s[84:85]
    ds_write_b32 v86, v94 offset:25600
    ds_write2_b32 v110, v76, v77 offset0:0 offset1:1
    ds_write_b32 v110, v98 offset:8
    s_mov_b64 exec, -1
    s_lshl_b32 s54, s3, 7
    v_lshl_add_u32 v11, v1, 3, s54
    ds_read_b64 v[100:101], v11 offset:23552
    ds_read_b64 v[104:105], v11 offset:24576
    s_mul_i32 s54, s2, 15360
    s_add_u32 s54, s54, 1048576
    s_add_u32 s32, s14, s54
    s_addc_u32 s33, s15, 0
    s_mov_b32 s34, 15360
    s_mov_b32 s35, 0x20000
    s_mul_i32 s54, s2, 40960
    s_add_u32 s54, s54, 5242880
    s_add_u32 s36, s14, s54
    s_addc_u32 s37, s15, 0
    s_mov_b32 s38, 40000
    s_mov_b32 s39, 0x20000
    v_lshrrev_b32 v11, 1, v0
    v_lshlrev_b32 v11, 2, v11
    v_and_b32 v12, 1, v0
    v_lshlrev_b32 v12, 4, v12
    v_add_u32 v12, 101376, v12
    v_add_u32 v14, 30720, v15
    s_waitcnt lgkmcnt(0)
    s_barrier
    ds_read_b128 v[128:131], v14
    ds_read_b128 v[132:135], v14 offset:8192
    ds_read_b32 v156, v11 offset:25600
    ds_read_b32 v157, v11 offset:26624
    ds_read_b32 v158, v11 offset:27648
    ds_read_b32 v159, v11 offset:28672
    ds_read_b32 v160, v11 offset:29696
    s_cmp_lt_u32 s3, 4
    s_cselect_b32 s16, s68, s66
    s_cselect_b32 s17, s69, s67
    s_movk_i32 s54, 128
    s_cselect_b32 s18, s53, s54
    s_mov_b32 s19, 0x20000
    s_min_u32 s54, s3, 5
    s_lshl_b32 s54, s54, 10
    s_add_u32 m0, s54, 17408
    s_and_b32 s54, s54, 0xc00
    buffer_load_dwordx4 v2, s[16:19], s54 offen lds
    s_mov_b32 s40, s70
    s_mov_b32 s41, s71
    s_mov_b32 s42, 32768
    s_mov_b32 s43, 0x20000
    s_lshl_b32 s55, s3, 12
    s_add_u32 m0, s55, 46080
    s_nop 0
    buffer_load_dwordx4 v2, s[40:43], s55 offen offset:0 lds
    buffer_load_dwordx4 v2, s[40:43], s55 offen offset:1024 lds
    buffer_load_dwordx4 v2, s[40:43], s55 offen offset:2048 lds
    buffer_load_dwordx4 v2, s[40:43], s55 offen offset:3072 lds
    s_waitcnt lgkmcnt(0)
    v_add_u32 v156, v12, v156
    v_add_u32 v157, v12, v157
    v_add_u32 v158, v12, v158
    v_add_u32 v159, v12, v159
    v_add_u32 v160, v12, v160
    v_lshl_or_b32 v112, v100, 11, v104
    v_or_b32 v112, s63, v112
    v_mov_b32 v113, s62
    v_lshl_or_b32 v114, v101, 11, v105
    v_or_b32 v114, s63, v114
    v_mov_b32 v115, s62
    s_waitcnt vmcnt(0)
    s_barrier
    ds_read_b128 v[136:139], v156
    ds_read_b128 v[140:143], v157
    ds_read_b128 v[144:147], v158
    ds_read_b128 v[148:151], v159
    ds_read_b128 v[152:155], v160
    buffer_store_dwordx4 v[128:131], v15, s[32:35], 0 offen sc1
    buffer_store_dwordx4 v[132:135], v15, s[32:35], s50 offen sc1
    s_mov_b32 s54, 0
    s_waitcnt lgkmcnt(4)
    buffer_store_dwordx4 v[136:139], v15, s[36:39], s54 offen sc1
    s_mov_b32 s54, 8192
    s_waitcnt lgkmcnt(3)
    buffer_store_dwordx4 v[140:143], v15, s[36:39], s54 offen sc1
    s_mov_b32 s54, 16384
    s_waitcnt lgkmcnt(2)
    buffer_store_dwordx4 v[144:147], v15, s[36:39], s54 offen sc1
    s_mov_b32 s54, 24576
    s_waitcnt lgkmcnt(1)
    buffer_store_dwordx4 v[148:151], v15, s[36:39], s54 offen sc1
    s_mov_b32 s54, 32768
    s_waitcnt lgkmcnt(0)
    buffer_store_dwordx4 v[152:155], v15, s[36:39], s54 offen sc1
    s_and_b32 s44, s2, 7
    s_lshl_b32 s44, s44, 5
    s_lshr_b32 s54, s2, 3
    s_add_u32 s44, s44, s54
    s_mul_i32 s45, s44, 625
    s_add_u32 s46, s45, 640
    s_add_u32 s45, s45, 15
    s_lshr_b32 s45, s45, 4
    s_lshr_b32 s46, s46, 4
    s_sub_u32 s46, s46, s45
    v_bfe_i32 v168, v1, 2, 1
    v_and_b32 v168, 0xaaaa, v168
    v_add_u32 v168, 0x4444, v168
    v_mov_b32 v169, 158720
    v_and_b32 v11, 60, v9
    v_add_u32 v11, v11, v169
    ds_write_b32 v11, v13
    v_and_b32 v11, 4, v1
    v_lshlrev_b32 v11, 2, v11
    v_mov_b32 v12, 0xffff
    v_lshlrev_b32 v12, v11, v12
    v_bfe_i32 v11, v1, 3, 1
    v_and_b32 v191, v11, v12
    v_xor_b32 v190, v191, v12
    v_lshrrev_b32 v200, 5, v1
    v_lshlrev_b32 v200, 4, v200
    v_add_u32 v200, 101376, v200
    v_and_b32 v201, 15, v1
    v_lshlrev_b32 v201, 2, v201
    v_bfe_u32 v11, v1, 3, 2
    v_and_b32 v12, 3, v1
    v_lshl_add_u32 v11, v11, 2, v12
    v_lshlrev_b32 v202, 2, v11
    v_bfe_i32 v240, v0, 0, 1
    s_lshl_b32 s54, s3, 10
    v_and_b32 v241, 4, v240
    v_add_u32 v241, s54, v241
    v_lshl_add_u32 v242, v1, 2, s54
    v_lshrrev_b32 v243, 1, v1
    v_lshl_add_u32 v243, v243, 2, s54
    v_mul_u32_u24 v244, 12, v1
    v_and_b32 v245, 12, v242
    v_and_b32 v250, 124, v242
    s_mul_i32 s54, s3, 224
    v_add_u32 v247, s54, v1
    v_lshlrev_b32 v246, 3, v247
    v_add_u32 v246, 87040, v246
    v_lshlrev_b32 v247, 21, v247
    s_mul_i32 s54, s3, 640
    v_add_u32 v248, s54, v250
    v_sub_u32 v249, 63, v1
    s_getreg_b32 s86, hwreg(HW_REG_XCC_ID, 0, 3)
    s_lshl_b32 s54, s86, 4
    v_subrev_u32 v250, s54, v250
    v_and_b32 v250, 124, v250
    v_min_u32 v251, 39, v1
    v_lshlrev_b32 v251, 7, v251
    v_mov_b32 v253, 0x380
    v_lshrrev_b32 v252, 3, v1
    v_mul_u32_u24 v252, 64, v252
    v_add_u32 v252, 78848, v252
    s_lshr_b32 s87, s3, 1
    s_mul_i32 s87, s87, 3
    s_min_u32 s87, s87, 8
    s_mul_i32 s54, s87, 4608
    v_and_b32 v11, 15, v1
    v_lshrrev_b32 v12, 4, v1
    v_mul_u32_u24 v213, 288, v11
    v_lshl_add_u32 v213, v12, 4, v213
    v_add_u32 v213, s54, v213
    v_lshrrev_b32 v12, 3, v1
    v_lshlrev_b32 v12, 9, v12
    v_and_b32 v11, 7, v1
    v_lshl_add_u32 v214, v11, 4, v12
    s_lshl_b32 s87, s87, 12
    s_and_b32 s54, s3, 1
    s_lshl_b32 s54, s54, 7
    s_add_u32 s87, s87, s54
    s_lshl_b32 s54, s54, 7
    s_add_u32 s54, s54, 46080
    v_add_u32 v215, s54, v2
    s_cmp_eq_u32 s46, 40
    v_mov_b32 v203, 0
    s_mov_b32 s54, 685900808
    s_cselect_b32 s54, 568459824, s54
    s_mov_b32 exec_lo, 31
    s_mov_b32 exec_hi, 0
    v_mov_b32 v203, s54
    s_mov_b32 s54, 182814793
    s_cselect_b32 s54, 23232528, s54
    s_mov_b32 exec_lo, 992
    s_mov_b32 exec_hi, 0
    v_mov_b32 v203, s54
    s_mov_b32 s54, 984091248
    s_cselect_b32 s54, 719688297, s54
    s_mov_b32 exec_lo, 31744
    s_mov_b32 exec_hi, 0
    v_mov_b32 v203, s54
    s_mov_b32 s54, 424091761
    s_cselect_b32 s54, 984423522, s54
    s_mov_b32 exec_lo, 1015808
    s_mov_b32 exec_hi, 0
    v_mov_b32 v203, s54
    s_mov_b32 s54, 586001611
    s_cselect_b32 s54, 172635826, s54
    s_mov_b32 exec_lo, 32505856
    s_mov_b32 exec_hi, 0
    v_mov_b32 v203, s54
    s_mov_b32 s54, 64039106
    s_cselect_b32 s54, 454017211, s54
    s_mov_b32 exec_lo, 1040187392
    s_mov_b32 exec_hi, 0
    v_mov_b32 v203, s54
    s_mov_b32 s54, 330320603
    s_cselect_b32 s54, 743654643, s54
    s_mov_b32 exec_lo, 3221225472
    s_mov_b32 exec_hi, 7
    v_mov_b32 v203, s54
    s_mov_b32 s54, 217139484
    s_cselect_b32 s54, 607143691, s54
    s_mov_b32 exec_lo, 0
    s_mov_b32 exec_hi, 248
    v_mov_b32 v203, s54
    s_mov_b64 exec, -1
    v_mul_u32_u24 v11, 52, v1
    v_lshrrev_b32 v11, 8, v11
    v_mad_i32_i24 v11, v11, -5, v1
    v_mul_u32_u24 v11, 6, v11
    v_lshrrev_b32 v203, v11, v203
    v_and_b32 v11, 7, v203
    v_bfe_u32 v203, v203, 3, 3
    v_lshlrev_b32 v11, 12, v11
    v_lshl_or_b32 v203, v203, 7, v11
    s_add_u32 s24, s14, 1048576
    s_addc_u32 s25, s15, 0
    s_mov_b32 s26, 3932160
    s_mov_b32 s27, 0x20000
    v_mov_b32 v16, 0
    v_mov_b32 v17, 0
    v_mov_b32 v18, 0
    v_mov_b32 v19, 0
    v_mov_b32 v20, 0
    v_mov_b32 v21, 0
    v_mov_b32 v22, 0
    v_mov_b32 v23, 0
    v_mov_b32 v24, 0
    v_mov_b32 v25, 0
    v_mov_b32 v26, 0
    v_mov_b32 v27, 0
    v_mov_b32 v28, 0
    v_mov_b32 v29, 0
    v_mov_b32 v30, 0
    v_mov_b32 v31, 0
    v_mov_b32 v32, 0
    v_mov_b32 v33, 0
    v_mov_b32 v34, 0
    v_mov_b32 v35, 0
    v_mov_b32 v36, 0
    v_mov_b32 v37, 0
    v_mov_b32 v38, 0
    v_mov_b32 v39, 0
    v_mov_b32 v40, 0
    v_mov_b32 v41, 0
    v_mov_b32 v42, 0
    v_mov_b32 v43, 0
    v_mov_b32 v44, 0
    v_mov_b32 v45, 0
    v_mov_b32 v46, 0
    v_mov_b32 v47, 0
    v_mov_b32 v48, 0
    v_mov_b32 v49, 0
    v_mov_b32 v50, 0
    v_mov_b32 v51, 0
    v_mov_b32 v52, 0
    v_mov_b32 v53, 0
    v_mov_b32 v54, 0
    v_mov_b32 v55, 0
    v_mov_b32 v56, 0
    v_mov_b32 v57, 0
    v_mov_b32 v58, 0
    v_mov_b32 v59, 0
    v_mov_b32 v60, 0
    v_mov_b32 v61, 0
    v_mov_b32 v62, 0
    v_mov_b32 v63, 0
    s_lshl_b32 s54, s2, 3
    s_add_u32 s54, s54, s3
    s_lshl_b32 s54, s54, 8
    s_mov_b32 s16, s64
    s_mov_b32 s17, s65
    s_mov_b32 s18, 10240000
    s_mov_b32 s19, 0x20000
    s_add_u32 s28, s14, 5242880
    s_addc_u32 s29, s15, 0
    s_mov_b32 s30, 10485760
    s_mov_b32 s31, 0x20000
    s_and_b32 s51, s86, 7
    s_mul_i32 s51, s51, 1282048
    s_and_b32 s55, s2, 0xf8
    s_add_u32 s55, s55, s3
    s_mul_i32 s55, s55, 2304
    s_add_u32 s51, s51, s55
    v_min_u32 v14, 17, v1
    v_lshlrev_b32 v14, 7, v14
    s_waitcnt vmcnt(0)
    s_barrier
    s_mov_b64 exec, 0xffff
    buffer_store_dwordx4 v[112:115], v2, s[20:23], s54 offen sc1
    s_mov_b64 exec, -1
    buffer_load_dword v7, v14, s[16:19], s51 offen
    s_lshl_b32 s54, s45, 10
    s_add_u32 s40, s12, s54
    s_addc_u32 s41, s13, 0
    s_lshl_b32 s42, s46, 10
    s_mov_b32 s43, 0x20000
    v_lshrrev_b32 v8, 5, v1
    v_lshlrev_b32 v8, 10, v8
    v_and_b32 v9, 15, v1
    v_lshl_add_u32 v8, v9, 4, v8
    ds_read_b128 v[64:67], v8 offset:17408
    ds_read_b128 v[68:71], v8 offset:17664
    ds_read_b128 v[72:75], v8 offset:17920
    ds_read_b128 v[76:79], v8 offset:18176
    ds_read_b128 v[80:83], v8 offset:19456
    ds_read_b128 v[84:87], v8 offset:19712
    ds_read_b128 v[88:91], v8 offset:19968
    ds_read_b128 v[92:95], v8 offset:20224
    v_lshrrev_b32 v8, 4, v1
    v_lshlrev_b32 v8, 5, v8
    v_and_b32 v9, 3, v1
    v_lshl_add_u32 v8, v9, 1, v8
    ds_read_u16 v96, v8 offset:21504
    ds_read_u16 v97, v8 offset:21512
    ds_read_u16 v98, v8 offset:21520
    ds_read_u16 v99, v8 offset:21528
    v_bfe_i32 v10, v1, 4, 1
    v_and_b32 v10, 0x02020202, v10
    v_add_u32 v10, 0x05040100, v10
    s_waitcnt lgkmcnt(0)
    v_perm_b32 v172, v68, v64, v10
    v_perm_b32 v174, v76, v72, v10
    v_perm_b32 v176, v84, v80, v10
    v_perm_b32 v178, v92, v88, v10
    v_perm_b32 v173, v69, v65, v10
    v_perm_b32 v175, v77, v73, v10
    v_perm_b32 v177, v85, v81, v10
    v_perm_b32 v179, v93, v89, v10
    v_perm_b32 v180, v70, v66, v10
    v_perm_b32 v182, v78, v74, v10
    v_perm_b32 v184, v86, v82, v10
    v_perm_b32 v186, v94, v90, v10
    v_perm_b32 v181, v71, v67, v10
    v_perm_b32 v183, v79, v75, v10
    v_perm_b32 v185, v87, v83, v10
    v_perm_b32 v187, v95, v91, v10
    v_lshl_or_b32 v188, v97, 16, v96
    v_lshl_or_b32 v189, v99, 16, v98
    v_and_b32 v9, 7, v1
    v_lshrrev_b32 v8, 4, v1
    v_lshlrev_b32 v8, 13, v8
    v_lshl_add_u32 v8, v9, 4, v8
    v_and_b32 v9, 8, v1
    s_and_b32 s72, s3, 3
    s_lshl_b32 s72, s72, 8
    s_lshr_b32 s73, s3, 2
    s_lshl_b32 s73, s73, 7
    s_add_u32 s72, s72, s73
    s_add_u32 s72, s72, 46080
    v_add3_u32 v8, v8, v9, s72
    ds_read2st64_b64 v[128:131], v8 offset0:0 offset1:2
    ds_read2st64_b64 v[132:135], v8 offset0:4 offset1:6
    ds_read2st64_b64 v[136:139], v8 offset0:8 offset1:10
    ds_read2st64_b64 v[140:143], v8 offset0:12 offset1:14
    s_mov_b32 s72, 0x05040100
    s_mov_b32 s73, 0x07060302
    s_waitcnt lgkmcnt(3)
    v_perm_b32 v144, v130, v128, s72
    v_perm_b32 v148, v130, v128, s73
    v_perm_b32 v152, v131, v129, s72
    v_perm_b32 v156, v131, v129, s73
    s_waitcnt lgkmcnt(2)
    v_perm_b32 v145, v134, v132, s72
    v_perm_b32 v149, v134, v132, s73
    v_perm_b32 v153, v135, v133, s72
    v_perm_b32 v157, v135, v133, s73
    s_waitcnt lgkmcnt(1)
    v_perm_b32 v146, v138, v136, s72
    v_perm_b32 v150, v138, v136, s73
    v_perm_b32 v154, v139, v137, s72
    v_perm_b32 v158, v139, v137, s73
    s_waitcnt lgkmcnt(0)
    v_perm_b32 v147, v142, v140, s72
    v_perm_b32 v151, v142, v140, s73
    v_perm_b32 v155, v143, v141, s72
    v_perm_b32 v159, v143, v141, s73
    v_mov_b32 v64, 0
    v_mov_b32 v65, 0
    v_mov_b32 v66, 0
    v_mov_b32 v67, 0
    v_mov_b32 v68, 0
    v_mov_b32 v69, 0
    v_mov_b32 v70, 0
    v_mov_b32 v71, 0
    v_mov_b32 v72, 0
    v_mov_b32 v73, 0
    v_mov_b32 v74, 0
    v_mov_b32 v75, 0
    v_mov_b32 v76, 0
    v_mov_b32 v77, 0
    v_mov_b32 v78, 0
    v_mov_b32 v79, 0
    v_mov_b32 v80, 0
    v_mov_b32 v81, 0
    v_mov_b32 v82, 0
    v_mov_b32 v83, 0
    v_mov_b32 v84, 0
    v_mov_b32 v85, 0
    v_mov_b32 v86, 0
    v_mov_b32 v87, 0
    v_mov_b32 v88, 0
    v_mov_b32 v89, 0
    v_mov_b32 v90, 0
    v_mov_b32 v91, 0
    v_mov_b32 v92, 0
    v_mov_b32 v93, 0
    v_mov_b32 v94, 0
    v_mov_b32 v95, 0
    s_lshl_b32 s54, s3, 12
    v_add_u32 v8, s54, v2
    v_lshrrev_b32 v9, 1, v0
    v_lshlrev_b32 v10, 11, v9
    s_lshl_b32 s49, s44, 3
    v_mul_u32_u24 v5, 1280, v9
    s_mov_b32 s48, 0
    s_mov_b32 s53, 200000
    s_mov_b32 s55, 0xffc00000
    s_mul_i32 s52, s3, 7168
    s_add_u32 s52, s52, 101376
    s_movk_i32 s98, 4096
    s_waitcnt vmcnt(0)
    s_barrier
    buffer_load_dwordx2 v[206:207], v10, s[20:23], s49 offen sc1
    ds_write_b128 v8, v[144:147] offset:46080
    ds_write_b128 v8, v[148:151] offset:47104
    ds_write_b128 v8, v[152:155] offset:48128
    ds_write_b128 v8, v[156:159] offset:49152
    s_waitcnt vmcnt(0)
    v_xor_b32 v11, s63, v206
    v_xor_b32 v12, s62, v207
    v_and_or_b32 v11, v11, s55, v12
    v_cmpx_ne_u32 vcc, 0, v11
    s_cbranch_execnz L_poll
L_polled:
    s_mov_b64 exec, -1
    v_bfe_u32 v3, v206, 11, 11
    v_and_b32 v4, v3, v240
    v_add_u32 v10, v3, v240
    v_and_b32 v11, 0x7ff, v206
    v_add_u32_dpp v4, v4, v4 row_shr:1 row_mask:0xf bank_mask:0xf
    v_cmp_lt_i32 s[64:65], 0, v10
    v_cmp_lt_i32 s[66:67], 2, v10
    v_add_u32_dpp v4, v4, v4 row_shr:2 row_mask:0xf bank_mask:0xf
    v_cmp_lt_i32 s[68:69], 4, v10
    v_cmp_lt_i32 s[70:71], 6, v10
    v_add_u32_dpp v4, v4, v4 row_shr:4 row_mask:0xf bank_mask:0xf
    v_cmp_lt_i32 s[72:73], 8, v10
    v_cmp_lt_i32 s[74:75], 10, v10
    v_add_u32_dpp v4, v4, v4 row_shr:8 row_mask:0xf bank_mask:0xf
    v_cmp_lt_i32 s[76:77], 12, v10
    v_cmp_lt_i32 s[78:79], 14, v10
    v_add_u32_dpp v4, v4, v4 row_bcast:15 row_mask:0xa bank_mask:0xf
    v_add_u32 v5, v5, v11
    s_nop 0
    v_add_u32_dpp v4, v4, v4 row_bcast:31 row_mask:0xc bank_mask:0xf
    s_nop 0
    v_readlane_b32 s95, v4, 63
    v_mov_b32_dpp v4, v4 quad_perm:[0,0,2,2] row_mask:0xf bank_mask:0xf
    v_sub_u32 v5, v5, v4
    v_lshl_add_u32 v8, v4, 2, v241
    s_cmp_gt_u32 s95, 224
    s_cbranch_scc1 L_clip
L_mapw:
    s_mov_b64 exec, s[64:65]
    ds_write_b32 v8, v5 offset:0
    s_mov_b64 exec, s[66:67]
    ds_write_b32 v8, v5 offset:8
    s_mov_b64 exec, s[68:69]
    ds_write_b32 v8, v5 offset:16
    s_mov_b64 exec, s[70:71]
    ds_write_b32 v8, v5 offset:24
    s_mov_b64 exec, s[72:73]
    ds_write_b32 v8, v5 offset:32
    s_mov_b64 exec, s[74:75]
    ds_write_b32 v8, v5 offset:40
    s_mov_b64 exec, s[76:77]
    ds_write_b32 v8, v5 offset:48
    s_mov_b64 exec, -1
    s_cmp_lg_u64 s[78:79], 0
    s_cbranch_scc1 L_map2
    ds_read_b32 v136, v242 offset:0
    ds_read_b32 v137, v242 offset:256
    ds_read_b32 v138, v242 offset:512
    ds_read_b32 v140, v243 offset:0
    ds_read_b32 v141, v243 offset:128
    ds_read_b32 v142, v243 offset:256
    ds_read_b32 v143, v243 offset:384
    ds_read_b32 v144, v243 offset:512
    ds_read_b32 v145, v243 offset:640
    s_cmp_gt_i32 s95, 192
    s_cbranch_scc1 L_r1
L_r1b:
    s_waitcnt lgkmcnt(6)
    v_mad_u32_u24 v136, v136, 12, v244
    buffer_load_dwordx3 v[148:150], v136, s[24:27], 0 offen offset:0 sc1
    v_mad_u32_u24 v137, v137, 12, v244
    buffer_load_dwordx3 v[152:154], v137, s[24:27], 0 offen offset:768 sc1
    v_mad_u32_u24 v138, v138, 12, v244
    buffer_load_dwordx3 v[156:158], v138, s[24:27], 0 offen offset:1536 sc1
    v_mov_b32 v11, s95
    s_mov_b64 exec, 1
    ds_max_i32 v13, v11 offset:15360
    s_mov_b64 exec, -1
    s_waitcnt lgkmcnt(1)
    v_lshl_add_u32 v140, v140, 5, v2
    v_lshl_add_u32 v141, v141, 5, v2
    v_lshl_add_u32 v142, v142, 5, v2
    v_lshl_add_u32 v143, v143, 5, v2
    v_lshl_add_u32 v144, v144, 5, v2
    v_lshl_add_u32 v145, v145, 5, v2
    s_barrier
    s_add_u32 m0, s52, 0
    s_nop 0
    buffer_load_dwordx4 v140, s[28:31], 0 offen offset:0 sc1 lds
    buffer_load_dwordx4 v141, s[28:31], 0 offen offset:1024 sc1 lds
    s_min_i32 s54, s95, 224
    v_cmp_gt_i32 s[80:81], s54, v1
    s_sub_i32 s54, s54, 64
    v_cmp_gt_i32 s[82:83], s54, v1
    s_sub_i32 s54, s54, 64
    v_cmp_gt_i32 s[84:85], s54, v1
    s_sub_i32 s54, s54, 64
    v_cmp_gt_i32 s[96:97], s54, v1
    s_sub_i32 s54, s54, 64
    s_mov_b32 s55, 0x1fff80
    s_mul_i32 s61, s3, 5
    ds_read_b128 v[216:219], v215 offset:0
    ds_read_b128 v[220:223], v215 offset:1024
    ds_read_b128 v[224:227], v215 offset:2048
    ds_read_b128 v[228:231], v215 offset:3072
    ds_read_b128 v[232:235], v215 offset:4096
    ds_read_b128 v[236:239], v215 offset:5120
    s_waitcnt vmcnt(4)
    v_lshrrev_b32 v132, 21, v150
    v_lshlrev_b32 v132, 2, v132
    v_lshrrev_b32 v11, 26, v150
    v_lshl_or_b32 v11, v11, 4, v245
    s_mov_b64 exec, s[80:81]
    ds_add_rtn_u32 v128, v132, v6 offset:8192
    ds_add_u32 v11, v6 offset:14336
    s_mov_b64 exec, -1
    s_waitcnt vmcnt(3)
    v_lshrrev_b32 v133, 21, v154
    v_lshlrev_b32 v133, 2, v133
    v_lshrrev_b32 v11, 26, v154
    v_lshl_or_b32 v11, v11, 4, v245
    s_mov_b64 exec, s[82:83]
    ds_add_rtn_u32 v129, v133, v6 offset:8192
    ds_add_u32 v11, v6 offset:14336
    s_mov_b64 exec, -1
    s_waitcnt vmcnt(2)
    v_lshrrev_b32 v134, 21, v158
    v_lshlrev_b32 v134, 2, v134
    v_lshrrev_b32 v11, 26, v158
    v_lshl_or_b32 v11, v11, 4, v245
    s_mov_b64 exec, s[84:85]
    ds_add_rtn_u32 v130, v134, v6 offset:8192
    ds_add_u32 v11, v6 offset:14336
    s_mov_b64 exec, -1
    s_cmp_gt_i32 s95, 192
    s_cbranch_scc1 L_r2
L_r2b:
    buffer_load_dwordx4 v142, s[28:31], 0 offen offset:2048 sc1 lds
    s_add_u32 s65, s61, 1
    s_add_u32 s66, s61, 2
    s_add_u32 s67, s61, 3
    s_add_u32 s68, s61, 4
    s_waitcnt lgkmcnt(0)
    s_barrier
    s_cmp_lg_u32 s48, 0
    s_cbranch_scc1 L_rank2
    ds_read_b128 v[104:107], v2 offset:14336
    ds_read_b32 v96, v248 offset:8192
    ds_read_b32 v97, v248 offset:8320
    ds_read_b32 v98, v248 offset:8448
    ds_read_b32 v99, v248 offset:8576
    ds_read_b32 v100, v248 offset:8704
    ds_read_b32 v14, v13 offset:15360
    ds_write_b64 v246, v[148:149] offset:0
    v_and_or_b32 v150, v150, s55, v247
    ds_write_b64 v246, v[152:153] offset:512
    v_and_or_b32 v154, v154, s55, v247
    v_add_u32 v154, 134217728, v154
    ds_write_b64 v246, v[156:157] offset:1024
    v_and_or_b32 v158, v158, s55, v247
    v_add_u32 v158, 268435456, v158
    s_waitcnt lgkmcnt(9)
    v_add_u32 v9, v104, v105
    v_add3_u32 v9, v9, v106, v107
    v_lshl_or_b32 v9, v9, 6, v249
    s_nop 0
    v_readlane_b32 s64, v9, s61
    v_readlane_b32 s65, v9, s65
    v_readlane_b32 s66, v9, s66
    v_readlane_b32 s67, v9, s67
    v_readlane_b32 s68, v9, s68
    v_cmp_lt_u32 s[70:71], s64, v9
    v_cmp_lt_u32 s[72:73], s65, v9
    v_cmp_lt_u32 s[74:75], s66, v9
    v_cmp_lt_u32 s[76:77], s67, v9
    v_cmp_lt_u32 s[78:79], s68, v9
    s_bcnt1_i32_b64 s64, s[70:71]
    s_bcnt1_i32_b64 s65, s[72:73]
    s_bcnt1_i32_b64 s66, s[74:75]
    s_bcnt1_i32_b64 s67, s[76:77]
    s_bcnt1_i32_b64 s68, s[78:79]
    s_waitcnt lgkmcnt(3)
    v_readlane_b32 s90, v203, s64
    v_readlane_b32 s91, v203, s65
    v_readlane_b32 s92, v203, s66
    v_readlane_b32 s93, v203, s67
    v_readlane_b32 s94, v203, s68
    v_readfirstlane_b32 s47, v14
L_ranked:
    s_mov_b32 exec_hi, 0
    v_and_or_b32 v104, s90, v253, v250
    ds_add_rtn_u32 v96, v104, v96 offset:13312
    v_and_or_b32 v105, s91, v253, v250
    ds_add_rtn_u32 v97, v105, v97 offset:13312
    v_and_or_b32 v106, s92, v253, v250
    ds_add_rtn_u32 v98, v106, v98 offset:13312
    v_and_or_b32 v107, s93, v253, v250
    ds_add_rtn_u32 v99, v107, v99 offset:13312
    v_and_or_b32 v108, s94, v253, v250
    ds_add_rtn_u32 v100, v108, v100 offset:13312
    v_or_b32 v104, s90, v250
    v_or_b32 v105, s91, v250
    v_or_b32 v106, s92, v250
    v_or_b32 v107, s93, v250
    v_or_b32 v108, s94, v250
    s_lshl_b32 s54, s3, 3
    s_add_u32 s61, s54, 7
    s_waitcnt lgkmcnt(3)
    v_lshl_or_b32 v96, v96, 16, v104
    ds_write_b32 v248, v96 offset:8192
    v_lshl_or_b32 v97, v97, 16, v105
    ds_write_b32 v248, v97 offset:8320
    s_waitcnt lgkmcnt(2)
    v_lshl_or_b32 v98, v98, 16, v106
    ds_write_b32 v248, v98 offset:8448
    v_lshl_or_b32 v99, v99, 16, v107
    ds_write_b32 v248, v99 offset:8576
    v_lshl_or_b32 v100, v100, 16, v108
    ds_write_b32 v248, v100 offset:8704
    s_mov_b32 exec_hi, -1
    buffer_load_dwordx4 v143, s[28:31], 0 offen offset:3072 sc1 lds
    s_add_u32 m0, s52, 4096
    s_nop 0
    buffer_load_dwordx4 v144, s[28:31], s98 offen offset:0 sc1 lds
    s_waitcnt lgkmcnt(0)
    s_barrier
    ds_read_b128 v[96:99], v2 offset:13312
    ds_read_b32 v132, v132 offset:8192
    ds_read_b32 v133, v133 offset:8192
    ds_read_b32 v134, v134 offset:8192
    s_waitcnt lgkmcnt(3)
    v_add_u32 v9, v96, v97
    v_add3_u32 v9, v9, v98, v99
    v_mov_b32 v10, v9
    s_waitcnt lgkmcnt(0)
    v_bfe_u32 v15, v132, 12, 3
    v_add_u32_dpp v10, v10, v10 row_shr:1 row_mask:0xf bank_mask:0xf
    v_or_b32 v150, v15, v150
    v_and_b32 v136, 0x3ff, v132
    v_add_u32_dpp v10, v10, v10 row_shr:2 row_mask:0xf bank_mask:0xf
    v_lshrrev_b32 v132, 16, v132
    v_add_u32 v132, v132, v128
    v_add_u32_dpp v10, v10, v10 row_shr:4 row_mask:0xf bank_mask:0xf
    v_bfe_u32 v15, v133, 12, 3
    v_or_b32 v154, v15, v154
    v_add_u32_dpp v10, v10, v10 row_shr:8 row_mask:0xf bank_mask:0xf
    v_and_b32 v137, 0x3ff, v133
    v_lshrrev_b32 v133, 16, v133
    v_add_u32_dpp v10, v10, v10 row_bcast:15 row_mask:0xa bank_mask:0xf
    v_add_u32 v133, v133, v129
    v_bfe_u32 v15, v134, 12, 3
    v_add_u32_dpp v10, v10, v10 row_bcast:31 row_mask:0xc bank_mask:0xf
    v_or_b32 v158, v15, v158
    v_and_b32 v138, 0x3ff, v134
    v_sub_u32 v9, v10, v9
    v_lshl_add_u32 v104, v9, 2, v252
    v_lshl_add_u32 v105, v96, 2, v104
    v_lshl_add_u32 v106, v97, 2, v105
    v_lshl_add_u32 v107, v98, 2, v106
    ds_write_b128 v2, v[104:107] offset:16384
    ds_read_b32 v136, v136 offset:16384
    ds_read_b32 v137, v137 offset:16384
    ds_read_b32 v138, v138 offset:16384
    v_lshrrev_b32 v134, 16, v134
    v_add_u32 v134, v134, v130
    v_readlane_b32 s50, v10, s61
    v_readlane_b32 s53, v9, s54
    v_readlane_b32 s51, v104, s54
    v_mov_b32 v14, 2097029
    s_sub_u32 s50, s50, s53
    s_lshl2_add_u32 s55, s50, s51
    v_add_u32 v9, s55, v201
    ds_write_b32 v9, v14
    s_add_u32 s53, s50, 15
    s_lshr_b32 s53, s53, 4
    s_sub_u32 s54, 0, s50
    s_and_b32 s54, s54, 14
    s_sub_u32 s53, s53, 1
    s_cmp_gt_i32 s53, 0
    s_cselect_b32 s54, s54, 0
    s_lshl_b32 s61, s54, 2
    s_sub_u32 s51, s51, s61
    s_waitcnt lgkmcnt(1)
    v_lshl_add_u32 v132, v132, 2, v136
    v_lshl_add_u32 v133, v133, 2, v137
    v_lshl_add_u32 v134, v134, 2, v138
    s_mov_b64 exec, s[80:81]
    ds_write_b32 v132, v150
    s_mov_b64 exec, s[82:83]
    ds_write_b32 v133, v154
    s_mov_b64 exec, s[84:85]
    ds_write_b32 v134, v158
    s_mov_b64 exec, -1
    s_cmp_gt_i32 s95, 192
    s_cbranch_scc1 L_r3
L_r3b:
    buffer_load_dwordx4 v145, s[28:31], s98 offen offset:1024 sc1 lds
    v_add_u32 v198, s51, v201
    v_add_u32 v199, s51, v202
    s_and_b32 s61, s61, 32
    v_add_u32 v12, s61, v198
    s_and_b32 s72, s54, 6
    s_mov_b32 s55, 0x00fffc38
    s_mov_b32 s49, 0xffffff00
    s_mov_b32 s51, 87040
    s_cmp_lt_u32 s3, 4
    s_cbranch_scc1 L_np
    s_setprio 1
L_np:
    s_waitcnt lgkmcnt(0)
    s_barrier
    ds_read_b32 v196, v12
    ds_read_b32 v194, v199
    ds_read_b32 v197, v198 offset:24
    ds_read_b32 v205, v251 offset:8192
    s_cmp_eq_u32 s50, 0
    s_cbranch_scc1 L_empty
    s_waitcnt lgkmcnt(3)
    v_lshlrev_b32 v196, 3, v196
    v_and_b32 v196, s55, v196
    s_cmp_eq_u32 s72, 2
    s_cbranch_scc1 L_p2
    s_cmp_eq_u32 s72, 4
    s_cbranch_scc1 L_p4
    s_cmp_eq_u32 s72, 6
    s_cbranch_scc1 L_p6
L_p0:
    v_readlane_b32 s64, v196, 0
    v_readlane_b32 s65, v196, 1
    s_and_b32 s61, s64, s49
    buffer_load_dwordx4 v[96:99], v2, s[16:19], s61 offen
    s_and_b32 s61, s65, s49
    buffer_load_dwordx4 v[100:103], v2, s[16:19], s61 offen
    s_waitcnt vmcnt(2) lgkmcnt(0)
    s_barrier
    v_lshrrev_b32 v8, 21, v194
    v_lshl_add_u32 v11, v8, 3, s51
    v_lshl_add_u32 v8, v8, 5, v200
    ds_read_b64 v[192:193], v11
    ds_read_b128 v[164:167], v8
    v_readlane_b32 s66, v196, 2
    v_readlane_b32 s67, v196, 3
    s_and_b32 s61, s66, s49
    buffer_load_dwordx4 v[104:107], v2, s[16:19], s61 offen
    s_and_b32 s61, s67, s49
    buffer_load_dwordx4 v[108:111], v2, s[16:19], s61 offen
    v_readlane_b32 s68, v196, 4
    v_readlane_b32 s69, v196, 5
    s_and_b32 s61, s68, s49
    buffer_load_dwordx4 v[112:115], v2, s[16:19], s61 offen
    s_and_b32 s61, s69, s49
    buffer_load_dwordx4 v[116:119], v2, s[16:19], s61 offen
    s_branch L_pd
L_p2:
    v_readlane_b32 s66, v196, 2
    v_readlane_b32 s67, v196, 3
    s_and_b32 s61, s66, s49
    buffer_load_dwordx4 v[104:107], v2, s[16:19], s61 offen
    s_and_b32 s61, s67, s49
    buffer_load_dwordx4 v[108:111], v2, s[16:19], s61 offen
    s_waitcnt vmcnt(2) lgkmcnt(0)
    s_barrier
    v_lshrrev_b32 v8, 21, v194
    v_lshl_add_u32 v11, v8, 3, s51
    v_lshl_add_u32 v8, v8, 5, v200
    ds_read_b64 v[192:193], v11
    ds_read_b128 v[164:167], v8
    v_readlane_b32 s68, v196, 4
    v_readlane_b32 s69, v196, 5
    s_and_b32 s61, s68, s49
    buffer_load_dwordx4 v[112:115], v2, s[16:19], s61 offen
    s_and_b32 s61, s69, s49
    buffer_load_dwordx4 v[116:119], v2, s[16:19], s61 offen
    v_readlane_b32 s70, v196, 6
    v_readlane_b32 s71, v196, 7
    s_and_b32 s61, s70, s49
    buffer_load_dwordx4 v[120:123], v2, s[16:19], s61 offen
    s_and_b32 s61, s71, s49
    buffer_load_dwordx4 v[124:127], v2, s[16:19], s61 offen
    s_branch L_pd
L_p4:
    v_readlane_b32 s68, v196, 4
    v_readlane_b32 s69, v196, 5
    s_and_b32 s61, s68, s49
    buffer_load_dwordx4 v[112:115], v2, s[16:19], s61 offen
    s_and_b32 s61, s69, s49
    buffer_load_dwordx4 v[116:119], v2, s[16:19], s61 offen
    s_waitcnt vmcnt(2) lgkmcnt(0)
    s_barrier
    v_lshrrev_b32 v8, 21, v194
    v_lshl_add_u32 v11, v8, 3, s51
    v_lshl_add_u32 v8, v8, 5, v200
    ds_read_b64 v[192:193], v11
    ds_read_b128 v[164:167], v8
    v_readlane_b32 s70, v196, 6
    v_readlane_b32 s71, v196, 7
    s_and_b32 s61, s70, s49
    buffer_load_dwordx4 v[120:123], v2, s[16:19], s61 offen
    s_and_b32 s61, s71, s49
    buffer_load_dwordx4 v[124:127], v2, s[16:19], s61 offen
    v_readlane_b32 s64, v196, 8
    v_readlane_b32 s65, v196, 9
    s_and_b32 s61, s64, s49
    buffer_load_dwordx4 v[96:99], v2, s[16:19], s61 offen
    s_and_b32 s61, s65, s49
    buffer_load_dwordx4 v[100:103], v2, s[16:19], s61 offen
    s_branch L_pd
L_p6:
    v_readlane_b32 s70, v196, 6
    v_readlane_b32 s71, v196, 7
    s_and_b32 s61, s70, s49
    buffer_load_dwordx4 v[120:123], v2, s[16:19], s61 offen
    s_and_b32 s61, s71, s49
    buffer_load_dwordx4 v[124:127], v2, s[16:19], s61 offen
    s_waitcnt vmcnt(2) lgkmcnt(0)
    s_barrier
    v_lshrrev_b32 v8, 21, v194
    v_lshl_add_u32 v11, v8, 3, s51
    v_lshl_add_u32 v8, v8, 5, v200
    ds_read_b64 v[192:193], v11
    ds_read_b128 v[164:167], v8
    v_readlane_b32 s64, v196, 8
    v_readlane_b32 s65, v196, 9
    s_and_b32 s61, s64, s49
    buffer_load_dwordx4 v[96:99], v2, s[16:19], s61 offen
    s_and_b32 s61, s65, s49
    buffer_load_dwordx4 v[100:103], v2, s[16:19], s61 offen
    v_readlane_b32 s66, v196, 10
    v_readlane_b32 s67, v196, 11
    s_and_b32 s61, s66, s49
    buffer_load_dwordx4 v[104:107], v2, s[16:19], s61 offen
    s_and_b32 s61, s67, s49
    buffer_load_dwordx4 v[108:111], v2, s[16:19], s61 offen
L_pd:
    s_waitcnt lgkmcnt(0)
.p2align 3
    v_mfma_f32_4x4x4_16b_bf16 v[144:147], v[192:193], v[188:189], 0 cbsz:4 abid:0
    v_mfma_f32_4x4x4_16b_bf16 v[148:151], v[192:193], v[188:189], 0 cbsz:4 abid:2
    v_mfma_f32_4x4x4_16b_bf16 v[152:155], v[192:193], v[188:189], 0 cbsz:4 abid:4
    v_mfma_f32_4x4x4_16b_bf16 v[156:159], v[192:193], v[188:189], 0 cbsz:4 abid:6
    v_lshlrev_b32 v196, 3, v197
    v_and_b32 v196, s55, v196
    v_add_u32 v198, 64, v198
    v_add_u32 v199, 64, v199
    v_smfmac_f32_32x32x32_bf16 v[64:79], v[164:167], v[172:179], v168
    ds_read_b32 v197, v198 offset:24
    ds_read_b32 v194, v199
    v_smfmac_f32_32x32x32_bf16 v[80:95], v[164:167], v[180:187], v168
    s_set_gpr_idx_on s54, gpr_idx(SRC0,SRC1)
    v_cvt_pk_bf16_f32 v9, v144, v144
    s_set_gpr_idx_off
    v_and_b32 v160, v190, v9
    v_and_b32 v161, v191, v9
    s_waitcnt lgkmcnt(0)
    v_lshrrev_b32 v8, 21, v194
    v_lshl_add_u32 v11, v8, 3, s51
    v_lshl_add_u32 v8, v8, 5, v200
    ds_read_b64 v[192:193], v11
    ds_read_b128 v[164:167], v8
    s_cmp_eq_u32 s53, 0
    s_cbranch_scc1 L_f0
    s_cmp_eq_u32 s54, 0
    s_cbranch_scc1 L_j0
    s_cmp_eq_u32 s54, 2
    s_cbranch_scc1 L_j2
    ds_read_b128 v[64:67], v169
    ds_read_b128 v[80:83], v169
    s_cmp_eq_u32 s54, 4
    s_cbranch_scc1 L_j4
    s_cmp_eq_u32 s54, 6
    s_cbranch_scc1 L_j6
    ds_read_b128 v[68:71], v169
    ds_read_b128 v[84:87], v169
    s_cmp_eq_u32 s54, 8
    s_cbranch_scc1 L_j8
    s_cmp_eq_u32 s54, 10
    s_cbranch_scc1 L_j10
    ds_read_b128 v[72:75], v169
    ds_read_b128 v[88:91], v169
    s_cmp_eq_u32 s54, 12
    s_cbranch_scc1 L_j12
    s_branch L_j14
.p2align 3
L_loop:
    s_waitcnt lgkmcnt(2)
.p2align 3
    v_mfma_f32_4x4x4_16b_bf16 v[144:147], v[192:193], v[188:189], 0 cbsz:4 abid:0
    v_mfma_f32_4x4x4_16b_bf16 v[148:151], v[192:193], v[188:189], 0 cbsz:4 abid:2
    v_mfma_f32_4x4x4_16b_bf16 v[152:155], v[192:193], v[188:189], 0 cbsz:4 abid:4
    v_mfma_f32_4x4x4_16b_bf16 v[156:159], v[192:193], v[188:189], 0 cbsz:4 abid:6
    v_lshlrev_b32 v196, 3, v197
    v_and_b32 v196, s55, v196
    v_add_u32 v198, 64, v198
    v_add_u32 v199, 64, v199
    s_waitcnt lgkmcnt(0)
.p2align 3
    v_smfmac_f32_32x32x32_bf16 v[64:79], v[164:167], v[172:179], v168
    ds_read_b32 v197, v198 offset:24
    ds_read_b32 v194, v199
    v_cvt_pk_bf16_f32 v9, v144, v144
    v_and_b32 v160, v190, v9
    v_and_b32 v161, v191, v9
    v_smfmac_f32_32x32x32_bf16 v[80:95], v[164:167], v[180:187], v168
L_j0:
    s_waitcnt vmcnt(5)
.p2align 3
    v_mfma_f32_16x16x16_bf16 v[128:131], v[160:161], v[96:97], 0
    v_readlane_b32 s70, v196, 0
    v_cvt_pk_bf16_f32 v10, v145, v145
    v_mfma_f32_16x16x16_bf16 v[132:135], v[160:161], v[98:99], 0
    v_and_b32 v162, v190, v10
    v_and_b32 v163, v191, v10
    s_and_b32 s61, s70, s49
    s_waitcnt vmcnt(4)
    buffer_load_dwordx4 v[120:123], v2, s[16:19], s61 offen
    v_mfma_f32_16x16x16_bf16 v[136:139], v[162:163], v[100:101], 0
    v_readlane_b32 s71, v196, 1
    v_cvt_pk_bf16_f32 v9, v146, v146
    v_mfma_f32_16x16x16_bf16 v[140:143], v[162:163], v[102:103], 0
    v_and_b32 v160, v190, v9
    v_and_b32 v161, v191, v9
    s_and_b32 s61, s71, s49
    s_set_gpr_idx_on s64, gpr_idx(SRC2,DST)
    buffer_load_dwordx4 v[124:127], v2, s[16:19], s61 offen
    v_pk_fma_f32 v[16:17], v[128:129], v[64:65], v[16:17] op_sel_hi:[1,0,1]
    v_pk_fma_f32 v[18:19], v[130:131], v[64:65], v[18:19] op_sel_hi:[1,0,1]
    v_pk_fma_f32 v[20:21], v[132:133], v[80:81], v[20:21] op_sel_hi:[1,0,1]
    v_pk_fma_f32 v[22:23], v[134:135], v[80:81], v[22:23] op_sel_hi:[1,0,1]
    s_set_gpr_idx_idx s65
.p2align 3
    v_pk_fma_f32 v[16:17], v[136:137], v[64:65], v[16:17] op_sel:[0,1,0] op_sel_hi:[1,1,1]
    v_pk_fma_f32 v[18:19], v[138:139], v[64:65], v[18:19] op_sel:[0,1,0] op_sel_hi:[1,1,1]
    v_pk_fma_f32 v[20:21], v[140:141], v[80:81], v[20:21] op_sel:[0,1,0] op_sel_hi:[1,1,1]
    v_pk_fma_f32 v[22:23], v[142:143], v[80:81], v[22:23] op_sel:[0,1,0] op_sel_hi:[1,1,1]
    s_set_gpr_idx_off
L_j2:
    s_waitcnt vmcnt(5)
.p2align 3
    v_mfma_f32_16x16x16_bf16 v[128:131], v[160:161], v[104:105], 0
    v_readlane_b32 s64, v196, 2
    v_cvt_pk_bf16_f32 v10, v147, v147
    v_mfma_f32_16x16x16_bf16 v[132:135], v[160:161], v[106:107], 0
    v_and_b32 v162, v190, v10
    v_and_b32 v163, v191, v10
    s_and_b32 s61, s64, s49
    s_waitcnt vmcnt(4)
    buffer_load_dwordx4 v[96:99], v2, s[16:19], s61 offen
    v_mfma_f32_16x16x16_bf16 v[136:139], v[162:163], v[108:109], 0
    v_readlane_b32 s65, v196, 3
    v_cvt_pk_bf16_f32 v9, v148, v148
    v_mfma_f32_16x16x16_bf16 v[140:143], v[162:163], v[110:111], 0
    v_and_b32 v160, v190, v9
    v_and_b32 v161, v191, v9
    s_waitcnt lgkmcnt(0)
    v_lshrrev_b32 v8, 21, v194
    v_lshl_add_u32 v11, v8, 3, s51
    v_lshl_add_u32 v8, v8, 5, v200
    ds_read_b64 v[192:193], v11
    ds_read_b128 v[164:167], v8
.p2align 3
    s_and_b32 s61, s65, s49
    s_set_gpr_idx_on s66, gpr_idx(SRC2,DST)
    buffer_load_dwordx4 v[100:103], v2, s[16:19], s61 offen
    v_pk_fma_f32 v[16:17], v[128:129], v[66:67], v[16:17] op_sel_hi:[1,0,1]
    v_pk_fma_f32 v[18:19], v[130:131], v[66:67], v[18:19] op_sel_hi:[1,0,1]
    v_pk_fma_f32 v[20:21], v[132:133], v[82:83], v[20:21] op_sel_hi:[1,0,1]
    v_pk_fma_f32 v[22:23], v[134:135], v[82:83], v[22:23] op_sel_hi:[1,0,1]
    s_set_gpr_idx_idx s67
.p2align 3
    v_pk_fma_f32 v[16:17], v[136:137], v[66:67], v[16:17] op_sel:[0,1,0] op_sel_hi:[1,1,1]
    v_pk_fma_f32 v[18:19], v[138:139], v[66:67], v[18:19] op_sel:[0,1,0] op_sel_hi:[1,1,1]
    v_pk_fma_f32 v[20:21], v[140:141], v[82:83], v[20:21] op_sel:[0,1,0] op_sel_hi:[1,1,1]
    v_pk_fma_f32 v[22:23], v[142:143], v[82:83], v[22:23] op_sel:[0,1,0] op_sel_hi:[1,1,1]
    ds_read_b128 v[64:67], v169
    ds_read_b128 v[80:83], v169
    s_set_gpr_idx_off
L_j4:
    s_waitcnt vmcnt(5)
.p2align 3
    v_mfma_f32_16x16x16_bf16 v[128:131], v[160:161], v[112:113], 0
    v_readlane_b32 s66, v196, 4
    v_cvt_pk_bf16_f32 v10, v149, v149
    v_mfma_f32_16x16x16_bf16 v[132:135], v[160:161], v[114:115], 0
    v_and_b32 v162, v190, v10
    v_and_b32 v163, v191, v10
    s_and_b32 s61, s66, s49
    s_waitcnt vmcnt(4)
    buffer_load_dwordx4 v[104:107], v2, s[16:19], s61 offen
    v_mfma_f32_16x16x16_bf16 v[136:139], v[162:163], v[116:117], 0
    v_readlane_b32 s67, v196, 5
    v_cvt_pk_bf16_f32 v9, v150, v150
    v_mfma_f32_16x16x16_bf16 v[140:143], v[162:163], v[118:119], 0
    v_and_b32 v160, v190, v9
    v_and_b32 v161, v191, v9
    s_and_b32 s61, s67, s49
    s_set_gpr_idx_on s68, gpr_idx(SRC2,DST)
    buffer_load_dwordx4 v[108:111], v2, s[16:19], s61 offen
    v_pk_fma_f32 v[16:17], v[128:129], v[68:69], v[16:17] op_sel_hi:[1,0,1]
    v_pk_fma_f32 v[18:19], v[130:131], v[68:69], v[18:19] op_sel_hi:[1,0,1]
    v_pk_fma_f32 v[20:21], v[132:133], v[84:85], v[20:21] op_sel_hi:[1,0,1]
    v_pk_fma_f32 v[22:23], v[134:135], v[84:85], v[22:23] op_sel_hi:[1,0,1]
    s_set_gpr_idx_idx s69
.p2align 3
    v_pk_fma_f32 v[16:17], v[136:137], v[68:69], v[16:17] op_sel:[0,1,0] op_sel_hi:[1,1,1]
    v_pk_fma_f32 v[18:19], v[138:139], v[68:69], v[18:19] op_sel:[0,1,0] op_sel_hi:[1,1,1]
    v_pk_fma_f32 v[20:21], v[140:141], v[84:85], v[20:21] op_sel:[0,1,0] op_sel_hi:[1,1,1]
    v_pk_fma_f32 v[22:23], v[142:143], v[84:85], v[22:23] op_sel:[0,1,0] op_sel_hi:[1,1,1]
    s_set_gpr_idx_off
L_j6:
    s_waitcnt vmcnt(5)
.p2align 3
    v_mfma_f32_16x16x16_bf16 v[128:131], v[160:161], v[120:121], 0
    v_readlane_b32 s68, v196, 6
    v_cvt_pk_bf16_f32 v10, v151, v151
    v_mfma_f32_16x16x16_bf16 v[132:135], v[160:161], v[122:123], 0
    v_and_b32 v162, v190, v10
    v_and_b32 v163, v191, v10
    s_and_b32 s61, s68, s49
    s_waitcnt vmcnt(4)
    buffer_load_dwordx4 v[112:115], v2, s[16:19], s61 offen
    v_mfma_f32_16x16x16_bf16 v[136:139], v[162:163], v[124:125], 0
    v_readlane_b32 s69, v196, 7
    v_cvt_pk_bf16_f32 v9, v152, v152
    v_mfma_f32_16x16x16_bf16 v[140:143], v[162:163], v[126:127], 0
    v_and_b32 v160, v190, v9
    v_and_b32 v161, v191, v9
    s_and_b32 s61, s69, s49
    s_set_gpr_idx_on s70, gpr_idx(SRC2,DST)
    buffer_load_dwordx4 v[116:119], v2, s[16:19], s61 offen
    v_pk_fma_f32 v[16:17], v[128:129], v[70:71], v[16:17] op_sel_hi:[1,0,1]
    v_pk_fma_f32 v[18:19], v[130:131], v[70:71], v[18:19] op_sel_hi:[1,0,1]
    v_pk_fma_f32 v[20:21], v[132:133], v[86:87], v[20:21] op_sel_hi:[1,0,1]
    v_pk_fma_f32 v[22:23], v[134:135], v[86:87], v[22:23] op_sel_hi:[1,0,1]
    s_set_gpr_idx_idx s71
.p2align 3
    v_pk_fma_f32 v[16:17], v[136:137], v[70:71], v[16:17] op_sel:[0,1,0] op_sel_hi:[1,1,1]
    v_pk_fma_f32 v[18:19], v[138:139], v[70:71], v[18:19] op_sel:[0,1,0] op_sel_hi:[1,1,1]
    v_pk_fma_f32 v[20:21], v[140:141], v[86:87], v[20:21] op_sel:[0,1,0] op_sel_hi:[1,1,1]
    v_pk_fma_f32 v[22:23], v[142:143], v[86:87], v[22:23] op_sel:[0,1,0] op_sel_hi:[1,1,1]
    ds_read_b128 v[68:71], v169
    ds_read_b128 v[84:87], v169
    s_set_gpr_idx_off
L_j8:
    s_waitcnt vmcnt(5)
.p2align 3
    v_mfma_f32_16x16x16_bf16 v[128:131], v[160:161], v[96:97], 0
    v_readlane_b32 s70, v196, 8
    v_cvt_pk_bf16_f32 v10, v153, v153
    v_mfma_f32_16x16x16_bf16 v[132:135], v[160:161], v[98:99], 0
    v_and_b32 v162, v190, v10
    v_and_b32 v163, v191, v10
    s_and_b32 s61, s70, s49
    s_waitcnt vmcnt(4)
    buffer_load_dwordx4 v[120:123], v2, s[16:19], s61 offen
    v_mfma_f32_16x16x16_bf16 v[136:139], v[162:163], v[100:101], 0
    v_readlane_b32 s71, v196, 9
    v_cvt_pk_bf16_f32 v9, v154, v154
    v_mfma_f32_16x16x16_bf16 v[140:143], v[162:163], v[102:103], 0
    v_and_b32 v160, v190, v9
    v_and_b32 v161, v191, v9
    s_and_b32 s61, s71, s49
    s_set_gpr_idx_on s64, gpr_idx(SRC2,DST)
    buffer_load_dwordx4 v[124:127], v2, s[16:19], s61 offen
    v_pk_fma_f32 v[16:17], v[128:129], v[72:73], v[16:17] op_sel_hi:[1,0,1]
    v_pk_fma_f32 v[18:19], v[130:131], v[72:73], v[18:19] op_sel_hi:[1,0,1]
    v_pk_fma_f32 v[20:21], v[132:133], v[88:89], v[20:21] op_sel_hi:[1,0,1]
    v_pk_fma_f32 v[22:23], v[134:135], v[88:89], v[22:23] op_sel_hi:[1,0,1]
    s_set_gpr_idx_idx s65
.p2align 3
    v_pk_fma_f32 v[16:17], v[136:137], v[72:73], v[16:17] op_sel:[0,1,0] op_sel_hi:[1,1,1]
    v_pk_fma_f32 v[18:19], v[138:139], v[72:73], v[18:19] op_sel:[0,1,0] op_sel_hi:[1,1,1]
    v_pk_fma_f32 v[20:21], v[140:141], v[88:89], v[20:21] op_sel:[0,1,0] op_sel_hi:[1,1,1]
    v_pk_fma_f32 v[22:23], v[142:143], v[88:89], v[22:23] op_sel:[0,1,0] op_sel_hi:[1,1,1]
    s_set_gpr_idx_off
L_j10:
    s_waitcnt vmcnt(5)
.p2align 3
    v_mfma_f32_16x16x16_bf16 v[128:131], v[160:161], v[104:105], 0
    v_readlane_b32 s64, v196, 10
    v_cvt_pk_bf16_f32 v10, v155, v155
    v_mfma_f32_16x16x16_bf16 v[132:135], v[160:161], v[106:107], 0
    v_and_b32 v162, v190, v10
    v_and_b32 v163, v191, v10
    s_and_b32 s61, s64, s49
    s_waitcnt vmcnt(4)
    buffer_load_dwordx4 v[96:99], v2, s[16:19], s61 offen
    v_mfma_f32_16x16x16_bf16 v[136:139], v[162:163], v[108:109], 0
    v_readlane_b32 s65, v196, 11
    v_cvt_pk_bf16_f32 v9, v156, v156
    v_mfma_f32_16x16x16_bf16 v[140:143], v[162:163], v[110:111], 0
    v_and_b32 v160, v190, v9
    v_and_b32 v161, v191, v9
    s_and_b32 s61, s65, s49
    s_set_gpr_idx_on s66, gpr_idx(SRC2,DST)
    buffer_load_dwordx4 v[100:103], v2, s[16:19], s61 offen
    v_pk_fma_f32 v[16:17], v[128:129], v[74:75], v[16:17] op_sel_hi:[1,0,1]
    v_pk_fma_f32 v[18:19], v[130:131], v[74:75], v[18:19] op_sel_hi:[1,0,1]
    v_pk_fma_f32 v[20:21], v[132:133], v[90:91], v[20:21] op_sel_hi:[1,0,1]
    v_pk_fma_f32 v[22:23], v[134:135], v[90:91], v[22:23] op_sel_hi:[1,0,1]
    s_set_gpr_idx_idx s67
.p2align 3
    v_pk_fma_f32 v[16:17], v[136:137], v[74:75], v[16:17] op_sel:[0,1,0] op_sel_hi:[1,1,1]
    v_pk_fma_f32 v[18:19], v[138:139], v[74:75], v[18:19] op_sel:[0,1,0] op_sel_hi:[1,1,1]
    v_pk_fma_f32 v[20:21], v[140:141], v[90:91], v[20:21] op_sel:[0,1,0] op_sel_hi:[1,1,1]
    v_pk_fma_f32 v[22:23], v[142:143], v[90:91], v[22:23] op_sel:[0,1,0] op_sel_hi:[1,1,1]
    ds_read_b128 v[72:75], v169
    ds_read_b128 v[88:91], v169
    s_set_gpr_idx_off
L_j12:
    s_waitcnt vmcnt(5)
.p2align 3
    v_mfma_f32_16x16x16_bf16 v[128:131], v[160:161], v[112:113], 0
    v_readlane_b32 s66, v196, 12
    v_cvt_pk_bf16_f32 v10, v157, v157
    v_mfma_f32_16x16x16_bf16 v[132:135], v[160:161], v[114:115], 0
    v_and_b32 v162, v190, v10
    v_and_b32 v163, v191, v10
    s_and_b32 s61, s66, s49
    s_waitcnt vmcnt(4)
    buffer_load_dwordx4 v[104:107], v2, s[16:19], s61 offen
    v_mfma_f32_16x16x16_bf16 v[136:139], v[162:163], v[116:117], 0
    v_readlane_b32 s67, v196, 13
    v_cvt_pk_bf16_f32 v9, v158, v158
    v_mfma_f32_16x16x16_bf16 v[140:143], v[162:163], v[118:119], 0
    v_and_b32 v160, v190, v9
    v_and_b32 v161, v191, v9
    s_and_b32 s61, s67, s49
    s_set_gpr_idx_on s68, gpr_idx(SRC2,DST)
    buffer_load_dwordx4 v[108:111], v2, s[16:19], s61 offen
    v_pk_fma_f32 v[16:17], v[128:129], v[76:77], v[16:17] op_sel_hi:[1,0,1]
    v_pk_fma_f32 v[18:19], v[130:131], v[76:77], v[18:19] op_sel_hi:[1,0,1]
    v_pk_fma_f32 v[20:21], v[132:133], v[92:93], v[20:21] op_sel_hi:[1,0,1]
    v_pk_fma_f32 v[22:23], v[134:135], v[92:93], v[22:23] op_sel_hi:[1,0,1]
    s_set_gpr_idx_idx s69
.p2align 3
    v_pk_fma_f32 v[16:17], v[136:137], v[76:77], v[16:17] op_sel:[0,1,0] op_sel_hi:[1,1,1]
    v_pk_fma_f32 v[18:19], v[138:139], v[76:77], v[18:19] op_sel:[0,1,0] op_sel_hi:[1,1,1]
    v_pk_fma_f32 v[20:21], v[140:141], v[92:93], v[20:21] op_sel:[0,1,0] op_sel_hi:[1,1,1]
    v_pk_fma_f32 v[22:23], v[142:143], v[92:93], v[22:23] op_sel:[0,1,0] op_sel_hi:[1,1,1]
    s_set_gpr_idx_off
L_j14:
    s_waitcnt vmcnt(5)
.p2align 3
    v_mfma_f32_16x16x16_bf16 v[128:131], v[160:161], v[120:121], 0
    v_readlane_b32 s68, v196, 14
    v_cvt_pk_bf16_f32 v10, v159, v159
    v_mfma_f32_16x16x16_bf16 v[132:135], v[160:161], v[122:123], 0
    v_and_b32 v162, v190, v10
    v_and_b32 v163, v191, v10
    s_and_b32 s61, s68, s49
    s_waitcnt vmcnt(4)
    buffer_load_dwordx4 v[112:115], v2, s[16:19], s61 offen
    v_mfma_f32_16x16x16_bf16 v[136:139], v[162:163], v[124:125], 0
    v_readlane_b32 s69, v196, 15
    v_mfma_f32_16x16x16_bf16 v[140:143], v[162:163], v[126:127], 0
    s_and_b32 s61, s69, s49
    s_set_gpr_idx_on s70, gpr_idx(SRC2,DST)
    buffer_load_dwordx4 v[116:119], v2, s[16:19], s61 offen
    v_pk_fma_f32 v[16:17], v[128:129], v[78:79], v[16:17] op_sel_hi:[1,0,1]
    v_pk_fma_f32 v[18:19], v[130:131], v[78:79], v[18:19] op_sel_hi:[1,0,1]
    v_pk_fma_f32 v[20:21], v[132:133], v[94:95], v[20:21] op_sel_hi:[1,0,1]
    v_pk_fma_f32 v[22:23], v[134:135], v[94:95], v[22:23] op_sel_hi:[1,0,1]
    s_set_gpr_idx_idx s71
    s_sub_u32 s53, s53, 1
.p2align 3
    v_pk_fma_f32 v[16:17], v[136:137], v[78:79], v[16:17] op_sel:[0,1,0] op_sel_hi:[1,1,1]
    v_pk_fma_f32 v[18:19], v[138:139], v[78:79], v[18:19] op_sel:[0,1,0] op_sel_hi:[1,1,1]
    v_pk_fma_f32 v[20:21], v[140:141], v[94:95], v[20:21] op_sel:[0,1,0] op_sel_hi:[1,1,1]
    v_pk_fma_f32 v[22:23], v[142:143], v[94:95], v[22:23] op_sel:[0,1,0] op_sel_hi:[1,1,1]
    ds_read_b128 v[76:79], v169
    ds_read_b128 v[92:95], v169
    s_set_gpr_idx_off
    s_cmp_lg_u32 s53, 0
    s_cbranch_scc1 L_loop
    s_waitcnt lgkmcnt(2)
.p2align 3
    v_mfma_f32_4x4x4_16b_bf16 v[144:147], v[192:193], v[188:189], 0 cbsz:4 abid:0
    v_mfma_f32_4x4x4_16b_bf16 v[148:151], v[192:193], v[188:189], 0 cbsz:4 abid:2
    v_mfma_f32_4x4x4_16b_bf16 v[152:155], v[192:193], v[188:189], 0 cbsz:4 abid:4
    v_mfma_f32_4x4x4_16b_bf16 v[156:159], v[192:193], v[188:189], 0 cbsz:4 abid:6
    v_lshlrev_b32 v196, 3, v197
    v_and_b32 v196, s55, v196
    s_waitcnt lgkmcnt(0)
.p2align 3
    v_smfmac_f32_32x32x32_bf16 v[64:79], v[164:167], v[172:179], v168
    v_cvt_pk_bf16_f32 v9, v144, v144
    v_and_b32 v160, v190, v9
    v_and_b32 v161, v191, v9
    v_smfmac_f32_32x32x32_bf16 v[80:95], v[164:167], v[180:187], v168
L_f0:
    s_waitcnt vmcnt(5)
.p2align 3
    v_mfma_f32_16x16x16_bf16 v[128:131], v[160:161], v[96:97], 0
    v_readlane_b32 s70, v196, 0
    v_cvt_pk_bf16_f32 v10, v145, v145
    v_mfma_f32_16x16x16_bf16 v[132:135], v[160:161], v[98:99], 0
    v_and_b32 v162, v190, v10
    v_and_b32 v163, v191, v10
    s_and_b32 s61, s70, s49
    s_waitcnt vmcnt(4)
    buffer_load_dwordx4 v[120:123], v2, s[16:19], s61 offen
    v_mfma_f32_16x16x16_bf16 v[136:139], v[162:163], v[100:101], 0
    v_readlane_b32 s71, v196, 1
    v_cvt_pk_bf16_f32 v9, v146, v146
    v_mfma_f32_16x16x16_bf16 v[140:143], v[162:163], v[102:103], 0
    v_and_b32 v160, v190, v9
    v_and_b32 v161, v191, v9
    s_and_b32 s61, s71, s49
    s_set_gpr_idx_on s64, gpr_idx(SRC2,DST)
    buffer_load_dwordx4 v[124:127], v2, s[16:19], s61 offen
    v_pk_fma_f32 v[16:17], v[128:129], v[64:65], v[16:17] op_sel_hi:[1,0,1]
    v_pk_fma_f32 v[18:19], v[130:131], v[64:65], v[18:19] op_sel_hi:[1,0,1]
    v_pk_fma_f32 v[20:21], v[132:133], v[80:81], v[20:21] op_sel_hi:[1,0,1]
    v_pk_fma_f32 v[22:23], v[134:135], v[80:81], v[22:23] op_sel_hi:[1,0,1]
    s_set_gpr_idx_idx s65
.p2align 3
    v_pk_fma_f32 v[16:17], v[136:137], v[64:65], v[16:17] op_sel:[0,1,0] op_sel_hi:[1,1,1]
    v_pk_fma_f32 v[18:19], v[138:139], v[64:65], v[18:19] op_sel:[0,1,0] op_sel_hi:[1,1,1]
    v_pk_fma_f32 v[20:21], v[140:141], v[80:81], v[20:21] op_sel:[0,1,0] op_sel_hi:[1,1,1]
    v_pk_fma_f32 v[22:23], v[142:143], v[80:81], v[22:23] op_sel:[0,1,0] op_sel_hi:[1,1,1]
    s_set_gpr_idx_off
    s_waitcnt vmcnt(5)
.p2align 3
    v_mfma_f32_16x16x16_bf16 v[128:131], v[160:161], v[104:105], 0
    v_readlane_b32 s64, v196, 2
    v_cvt_pk_bf16_f32 v10, v147, v147
    v_mfma_f32_16x16x16_bf16 v[132:135], v[160:161], v[106:107], 0
    v_and_b32 v162, v190, v10
    v_and_b32 v163, v191, v10
    s_and_b32 s61, s64, s49
    s_waitcnt vmcnt(4)
    buffer_load_dwordx4 v[96:99], v2, s[16:19], s61 offen
    v_mfma_f32_16x16x16_bf16 v[136:139], v[162:163], v[108:109], 0
    v_readlane_b32 s65, v196, 3
    v_cvt_pk_bf16_f32 v9, v148, v148
    v_mfma_f32_16x16x16_bf16 v[140:143], v[162:163], v[110:111], 0
    v_and_b32 v160, v190, v9
    v_and_b32 v161, v191, v9
    v_lshlrev_b32 v12, 2, v1
    s_lshl_b32 s61, s3, 7
    v_and_b32 v205, 0x7380, v205
    v_xor_b32 v205, s61, v205
    v_alignbit_b32 v205, v205, v205, 12
    v_cmp_eq_u32 s[80:81], 0, v205
    v_cmp_eq_u32 s[82:83], 1, v205
    v_cmp_eq_u32 s[84:85], 2, v205
    v_cmp_eq_u32 s[96:97], 3, v205
    v_cmp_eq_u32 vcc, 4, v205
    s_ff1_i32_b64 s56, s[80:81]
    s_mul_i32 s56, s56, 1152
    v_add_u32 v208, s56, v12
    s_ff1_i32_b64 s57, s[82:83]
    s_mul_i32 s57, s57, 1152
    v_add_u32 v209, s57, v12
    s_ff1_i32_b64 s58, s[84:85]
    s_mul_i32 s58, s58, 1152
    v_add_u32 v210, s58, v12
    s_ff1_i32_b64 s59, s[96:97]
    s_mul_i32 s59, s59, 1152
    v_add_u32 v211, s59, v12
    s_ff1_i32_b64 s60, vcc
    s_mul_i32 s60, s60, 1152
    v_add_u32 v212, s60, v12
.p2align 3
    s_and_b32 s61, s65, s49
    s_set_gpr_idx_on s66, gpr_idx(SRC2,DST)
    buffer_load_dwordx4 v[100:103], v2, s[16:19], s61 offen
    v_pk_fma_f32 v[16:17], v[128:129], v[66:67], v[16:17] op_sel_hi:[1,0,1]
    v_pk_fma_f32 v[18:19], v[130:131], v[66:67], v[18:19] op_sel_hi:[1,0,1]
    v_pk_fma_f32 v[20:21], v[132:133], v[82:83], v[20:21] op_sel_hi:[1,0,1]
    v_pk_fma_f32 v[22:23], v[134:135], v[82:83], v[22:23] op_sel_hi:[1,0,1]
    s_set_gpr_idx_idx s67
.p2align 3
    v_pk_fma_f32 v[16:17], v[136:137], v[66:67], v[16:17] op_sel:[0,1,0] op_sel_hi:[1,1,1]
    v_pk_fma_f32 v[18:19], v[138:139], v[66:67], v[18:19] op_sel:[0,1,0] op_sel_hi:[1,1,1]
    v_pk_fma_f32 v[20:21], v[140:141], v[82:83], v[20:21] op_sel:[0,1,0] op_sel_hi:[1,1,1]
    v_pk_fma_f32 v[22:23], v[142:143], v[82:83], v[22:23] op_sel:[0,1,0] op_sel_hi:[1,1,1]
    s_set_gpr_idx_off
    s_waitcnt vmcnt(5)
.p2align 3
    v_mfma_f32_16x16x16_bf16 v[128:131], v[160:161], v[112:113], 0
    v_readlane_b32 s66, v196, 4
    v_cvt_pk_bf16_f32 v10, v149, v149
    v_mfma_f32_16x16x16_bf16 v[132:135], v[160:161], v[114:115], 0
    v_and_b32 v162, v190, v10
    v_and_b32 v163, v191, v10
    s_and_b32 s61, s66, s49
    s_waitcnt vmcnt(4)
    buffer_load_dwordx4 v[104:107], v2, s[16:19], s61 offen
    v_mfma_f32_16x16x16_bf16 v[136:139], v[162:163], v[116:117], 0
    v_readlane_b32 s67, v196, 5
    v_cvt_pk_bf16_f32 v9, v150, v150
    v_mfma_f32_16x16x16_bf16 v[140:143], v[162:163], v[118:119], 0
    v_and_b32 v160, v190, v9
    v_and_b32 v161, v191, v9
    s_and_b32 s61, s67, s49
    s_set_gpr_idx_on s68, gpr_idx(SRC2,DST)
    buffer_load_dwordx4 v[108:111], v2, s[16:19], s61 offen
    v_pk_fma_f32 v[16:17], v[128:129], v[68:69], v[16:17] op_sel_hi:[1,0,1]
    v_pk_fma_f32 v[18:19], v[130:131], v[68:69], v[18:19] op_sel_hi:[1,0,1]
    v_pk_fma_f32 v[20:21], v[132:133], v[84:85], v[20:21] op_sel_hi:[1,0,1]
    v_pk_fma_f32 v[22:23], v[134:135], v[84:85], v[22:23] op_sel_hi:[1,0,1]
    s_set_gpr_idx_idx s69
.p2align 3
    v_pk_fma_f32 v[16:17], v[136:137], v[68:69], v[16:17] op_sel:[0,1,0] op_sel_hi:[1,1,1]
    v_pk_fma_f32 v[18:19], v[138:139], v[68:69], v[18:19] op_sel:[0,1,0] op_sel_hi:[1,1,1]
    v_pk_fma_f32 v[20:21], v[140:141], v[84:85], v[20:21] op_sel:[0,1,0] op_sel_hi:[1,1,1]
    v_pk_fma_f32 v[22:23], v[142:143], v[84:85], v[22:23] op_sel:[0,1,0] op_sel_hi:[1,1,1]
    s_set_gpr_idx_off
    s_waitcnt vmcnt(5)
.p2align 3
    v_mfma_f32_16x16x16_bf16 v[128:131], v[160:161], v[120:121], 0
    v_readlane_b32 s68, v196, 6
    v_cvt_pk_bf16_f32 v10, v151, v151
    v_mfma_f32_16x16x16_bf16 v[132:135], v[160:161], v[122:123], 0
    v_and_b32 v162, v190, v10
    v_and_b32 v163, v191, v10
    s_and_b32 s61, s68, s49
    s_waitcnt vmcnt(4)
    buffer_load_dwordx4 v[112:115], v2, s[16:19], s61 offen
    v_mfma_f32_16x16x16_bf16 v[136:139], v[162:163], v[124:125], 0
    v_readlane_b32 s69, v196, 7
    v_cvt_pk_bf16_f32 v9, v152, v152
    v_mfma_f32_16x16x16_bf16 v[140:143], v[162:163], v[126:127], 0
    v_and_b32 v160, v190, v9
    v_and_b32 v161, v191, v9
    s_and_b32 s61, s69, s49
    s_set_gpr_idx_on s70, gpr_idx(SRC2,DST)
    buffer_load_dwordx4 v[116:119], v2, s[16:19], s61 offen
    v_pk_fma_f32 v[16:17], v[128:129], v[70:71], v[16:17] op_sel_hi:[1,0,1]
    v_pk_fma_f32 v[18:19], v[130:131], v[70:71], v[18:19] op_sel_hi:[1,0,1]
    v_pk_fma_f32 v[20:21], v[132:133], v[86:87], v[20:21] op_sel_hi:[1,0,1]
    v_pk_fma_f32 v[22:23], v[134:135], v[86:87], v[22:23] op_sel_hi:[1,0,1]
    s_set_gpr_idx_idx s71
.p2align 3
    v_pk_fma_f32 v[16:17], v[136:137], v[70:71], v[16:17] op_sel:[0,1,0] op_sel_hi:[1,1,1]
    v_pk_fma_f32 v[18:19], v[138:139], v[70:71], v[18:19] op_sel:[0,1,0] op_sel_hi:[1,1,1]
    v_pk_fma_f32 v[20:21], v[140:141], v[86:87], v[20:21] op_sel:[0,1,0] op_sel_hi:[1,1,1]
    v_pk_fma_f32 v[22:23], v[142:143], v[86:87], v[22:23] op_sel:[0,1,0] op_sel_hi:[1,1,1]
    ds_read_b128 v[144:147], v215 offset:14336
    ds_read_b128 v[148:151], v215 offset:15360
    s_set_gpr_idx_off
    s_waitcnt vmcnt(5)
.p2align 3
    v_mfma_f32_16x16x16_bf16 v[128:131], v[160:161], v[96:97], 0
    v_readlane_b32 s70, v196, 8
    v_cvt_pk_bf16_f32 v10, v153, v153
    v_mfma_f32_16x16x16_bf16 v[132:135], v[160:161], v[98:99], 0
    v_and_b32 v162, v190, v10
    v_and_b32 v163, v191, v10
    s_and_b32 s61, s70, s49
    s_waitcnt vmcnt(4)
    buffer_load_dwordx4 v[120:123], v2, s[16:19], s61 offen
    v_mfma_f32_16x16x16_bf16 v[136:139], v[162:163], v[100:101], 0
    v_readlane_b32 s71, v196, 9
    v_cvt_pk_bf16_f32 v9, v154, v154
    v_mfma_f32_16x16x16_bf16 v[140:143], v[162:163], v[102:103], 0
    v_and_b32 v160, v190, v9
    v_and_b32 v161, v191, v9
    s_and_b32 s61, s71, s49
    s_set_gpr_idx_on s64, gpr_idx(SRC2,DST)
    buffer_load_dwordx4 v[124:127], v2, s[16:19], s61 offen
    v_pk_fma_f32 v[16:17], v[128:129], v[72:73], v[16:17] op_sel_hi:[1,0,1]
    v_pk_fma_f32 v[18:19], v[130:131], v[72:73], v[18:19] op_sel_hi:[1,0,1]
    v_pk_fma_f32 v[20:21], v[132:133], v[88:89], v[20:21] op_sel_hi:[1,0,1]
    v_pk_fma_f32 v[22:23], v[134:135], v[88:89], v[22:23] op_sel_hi:[1,0,1]
    s_set_gpr_idx_idx s65
.p2align 3
    v_pk_fma_f32 v[16:17], v[136:137], v[72:73], v[16:17] op_sel:[0,1,0] op_sel_hi:[1,1,1]
    v_pk_fma_f32 v[18:19], v[138:139], v[72:73], v[18:19] op_sel:[0,1,0] op_sel_hi:[1,1,1]
    v_pk_fma_f32 v[20:21], v[140:141], v[88:89], v[20:21] op_sel:[0,1,0] op_sel_hi:[1,1,1]
    v_pk_fma_f32 v[22:23], v[142:143], v[88:89], v[22:23] op_sel:[0,1,0] op_sel_hi:[1,1,1]
    ds_read_b128 v[96:99], v215 offset:6144
    ds_read_b128 v[100:103], v215 offset:7168
    s_set_gpr_idx_off
    s_waitcnt vmcnt(5)
.p2align 3
    v_mfma_f32_16x16x16_bf16 v[128:131], v[160:161], v[104:105], 0
    v_cvt_pk_bf16_f32 v10, v155, v155
    v_mfma_f32_16x16x16_bf16 v[132:135], v[160:161], v[106:107], 0
    v_and_b32 v162, v190, v10
    v_and_b32 v163, v191, v10
    s_waitcnt vmcnt(4)
.p2align 3
    s_nop 0
    v_mfma_f32_16x16x16_bf16 v[136:139], v[162:163], v[108:109], 0
    v_cvt_pk_bf16_f32 v9, v156, v156
    v_mfma_f32_16x16x16_bf16 v[140:143], v[162:163], v[110:111], 0
    v_and_b32 v160, v190, v9
    v_and_b32 v161, v191, v9
    s_set_gpr_idx_on s66, gpr_idx(SRC2,DST)
.p2align 3
    v_pk_fma_f32 v[16:17], v[128:129], v[74:75], v[16:17] op_sel_hi:[1,0,1]
    v_pk_fma_f32 v[18:19], v[130:131], v[74:75], v[18:19] op_sel_hi:[1,0,1]
    v_pk_fma_f32 v[20:21], v[132:133], v[90:91], v[20:21] op_sel_hi:[1,0,1]
    v_pk_fma_f32 v[22:23], v[134:135], v[90:91], v[22:23] op_sel_hi:[1,0,1]
    s_set_gpr_idx_idx s67
.p2align 3
    v_pk_fma_f32 v[16:17], v[136:137], v[74:75], v[16:17] op_sel:[0,1,0] op_sel_hi:[1,1,1]
    v_pk_fma_f32 v[18:19], v[138:139], v[74:75], v[18:19] op_sel:[0,1,0] op_sel_hi:[1,1,1]
    v_pk_fma_f32 v[20:21], v[140:141], v[90:91], v[20:21] op_sel:[0,1,0] op_sel_hi:[1,1,1]
    v_pk_fma_f32 v[22:23], v[142:143], v[90:91], v[22:23] op_sel:[0,1,0] op_sel_hi:[1,1,1]
    ds_read_b128 v[104:107], v215 offset:8192
    ds_read_b128 v[108:111], v215 offset:9216
    s_set_gpr_idx_off
    s_waitcnt vmcnt(3)
.p2align 3
    v_mfma_f32_16x16x16_bf16 v[128:131], v[160:161], v[112:113], 0
    v_cvt_pk_bf16_f32 v10, v157, v157
    v_mfma_f32_16x16x16_bf16 v[132:135], v[160:161], v[114:115], 0
    v_and_b32 v162, v190, v10
    v_and_b32 v163, v191, v10
    s_waitcnt vmcnt(2)
.p2align 3
    s_nop 0
    v_mfma_f32_16x16x16_bf16 v[136:139], v[162:163], v[116:117], 0
    v_cvt_pk_bf16_f32 v9, v158, v158
    v_mfma_f32_16x16x16_bf16 v[140:143], v[162:163], v[118:119], 0
    v_and_b32 v160, v190, v9
    v_and_b32 v161, v191, v9
    s_set_gpr_idx_on s68, gpr_idx(SRC2,DST)
.p2align 3
    v_pk_fma_f32 v[16:17], v[128:129], v[76:77], v[16:17] op_sel_hi:[1,0,1]
    v_pk_fma_f32 v[18:19], v[130:131], v[76:77], v[18:19] op_sel_hi:[1,0,1]
    v_pk_fma_f32 v[20:21], v[132:133], v[92:93], v[20:21] op_sel_hi:[1,0,1]
    v_pk_fma_f32 v[22:23], v[134:135], v[92:93], v[22:23] op_sel_hi:[1,0,1]
    s_set_gpr_idx_idx s69
.p2align 3
    v_pk_fma_f32 v[16:17], v[136:137], v[76:77], v[16:17] op_sel:[0,1,0] op_sel_hi:[1,1,1]
    v_pk_fma_f32 v[18:19], v[138:139], v[76:77], v[18:19] op_sel:[0,1,0] op_sel_hi:[1,1,1]
    v_pk_fma_f32 v[20:21], v[140:141], v[92:93], v[20:21] op_sel:[0,1,0] op_sel_hi:[1,1,1]
    v_pk_fma_f32 v[22:23], v[142:143], v[92:93], v[22:23] op_sel:[0,1,0] op_sel_hi:[1,1,1]
    ds_read_b128 v[112:115], v215 offset:10240
    ds_read_b128 v[116:119], v215 offset:11264
    s_set_gpr_idx_off
    s_waitcnt vmcnt(1)
.p2align 3
    v_mfma_f32_16x16x16_bf16 v[128:131], v[160:161], v[120:121], 0
    v_cvt_pk_bf16_f32 v10, v159, v159
    v_mfma_f32_16x16x16_bf16 v[132:135], v[160:161], v[122:123], 0
    v_and_b32 v162, v190, v10
    v_and_b32 v163, v191, v10
    s_waitcnt vmcnt(0)
.p2align 3
    s_nop 0
    v_mfma_f32_16x16x16_bf16 v[136:139], v[162:163], v[124:125], 0
    v_mfma_f32_16x16x16_bf16 v[140:143], v[162:163], v[126:127], 0
    s_set_gpr_idx_on s70, gpr_idx(SRC2,DST)
.p2align 3
    v_pk_fma_f32 v[16:17], v[128:129], v[78:79], v[16:17] op_sel_hi:[1,0,1]
    v_pk_fma_f32 v[18:19], v[130:131], v[78:79], v[18:19] op_sel_hi:[1,0,1]
    v_pk_fma_f32 v[20:21], v[132:133], v[94:95], v[20:21] op_sel_hi:[1,0,1]
    v_pk_fma_f32 v[22:23], v[134:135], v[94:95], v[22:23] op_sel_hi:[1,0,1]
    s_set_gpr_idx_idx s71
.p2align 3
    s_nop 0
    v_pk_fma_f32 v[16:17], v[136:137], v[78:79], v[16:17] op_sel:[0,1,0] op_sel_hi:[1,1,1]
    v_pk_fma_f32 v[18:19], v[138:139], v[78:79], v[18:19] op_sel:[0,1,0] op_sel_hi:[1,1,1]
    v_pk_fma_f32 v[20:21], v[140:141], v[94:95], v[20:21] op_sel:[0,1,0] op_sel_hi:[1,1,1]
    v_pk_fma_f32 v[22:23], v[142:143], v[94:95], v[22:23] op_sel:[0,1,0] op_sel_hi:[1,1,1]
    ds_read_b128 v[120:123], v215 offset:12288
    ds_read_b128 v[124:127], v215 offset:13312
    s_set_gpr_idx_off
L_swept:
    s_add_u32 s48, s48, 224
    s_cmp_lt_u32 s48, s47
    s_cbranch_scc1 L_again
    s_setprio 0
    v_cvt_pk_bf16_f32 v64, v16, v20
    v_cvt_pk_bf16_f32 v65, v17, v21
    v_cvt_pk_bf16_f32 v66, v18, v22
    v_cvt_pk_bf16_f32 v67, v19, v23
    ds_write2_b32 v208, v64, v65 offset0:0 offset1:72
    ds_write2_b32 v208, v66, v67 offset0:144 offset1:216
    v_cvt_pk_bf16_f32 v68, v24, v28
    v_cvt_pk_bf16_f32 v69, v25, v29
    v_cvt_pk_bf16_f32 v70, v26, v30
    v_cvt_pk_bf16_f32 v71, v27, v31
    ds_write2_b32 v209, v68, v69 offset0:0 offset1:72
    ds_write2_b32 v209, v70, v71 offset0:144 offset1:216
    v_cvt_pk_bf16_f32 v72, v32, v36
    v_cvt_pk_bf16_f32 v73, v33, v37
    v_cvt_pk_bf16_f32 v74, v34, v38
    v_cvt_pk_bf16_f32 v75, v35, v39
    ds_write2_b32 v210, v72, v73 offset0:0 offset1:72
    ds_write2_b32 v210, v74, v75 offset0:144 offset1:216
    v_cvt_pk_bf16_f32 v76, v40, v44
    v_cvt_pk_bf16_f32 v77, v41, v45
    v_cvt_pk_bf16_f32 v78, v42, v46
    v_cvt_pk_bf16_f32 v79, v43, v47
    ds_write2_b32 v211, v76, v77 offset0:0 offset1:72
    ds_write2_b32 v211, v78, v79 offset0:144 offset1:216
    v_cvt_pk_bf16_f32 v80, v48, v52
    v_cvt_pk_bf16_f32 v81, v49, v53
    v_cvt_pk_bf16_f32 v82, v50, v54
    v_cvt_pk_bf16_f32 v83, v51, v55
    ds_write2_b32 v212, v80, v81 offset0:0 offset1:72
    ds_write2_b32 v212, v82, v83 offset0:144 offset1:216
    s_waitcnt lgkmcnt(0)
    s_barrier
    ds_read_b128 v[16:19], v213 offset:0
    ds_read_b128 v[20:23], v213 offset:64
    ds_read_b128 v[24:27], v213 offset:128
    ds_read_b128 v[28:31], v213 offset:192
    s_waitcnt lgkmcnt(3)
    v_mfma_f32_16x16x32_bf16 v[160:163], v[16:19], v[216:219], 0
    v_mfma_f32_16x16x32_bf16 v[164:167], v[16:19], v[220:223], 0
    v_mfma_f32_16x16x32_bf16 v[168:171], v[16:19], v[224:227], 0
    v_mfma_f32_16x16x32_bf16 v[172:175], v[16:19], v[228:231], 0
    ds_read_b128 v[32:35], v213 offset:4608
    ds_read_b128 v[36:39], v213 offset:4672
    ds_read_b128 v[40:43], v213 offset:4736
    ds_read_b128 v[44:47], v213 offset:4800
    s_waitcnt lgkmcnt(6)
    v_mfma_f32_16x16x32_bf16 v[160:163], v[20:23], v[232:235], v[160:163]
    v_mfma_f32_16x16x32_bf16 v[164:167], v[20:23], v[236:239], v[164:167]
    v_mfma_f32_16x16x32_bf16 v[168:171], v[20:23], v[96:99], v[168:171]
    v_mfma_f32_16x16x32_bf16 v[172:175], v[20:23], v[100:103], v[172:175]
    ds_read_b128 v[48:51], v213 offset:9216
    ds_read_b128 v[52:55], v213 offset:9280
    ds_read_b128 v[56:59], v213 offset:9344
    ds_read_b128 v[60:63], v213 offset:9408
    s_waitcnt lgkmcnt(9)
    v_mfma_f32_16x16x32_bf16 v[160:163], v[24:27], v[104:107], v[160:163]
    v_mfma_f32_16x16x32_bf16 v[164:167], v[24:27], v[108:111], v[164:167]
    v_mfma_f32_16x16x32_bf16 v[168:171], v[24:27], v[112:115], v[168:171]
    v_mfma_f32_16x16x32_bf16 v[172:175], v[24:27], v[116:119], v[172:175]
    s_waitcnt lgkmcnt(8)
    v_mfma_f32_16x16x32_bf16 v[160:163], v[28:31], v[120:123], v[160:163]
    v_mfma_f32_16x16x32_bf16 v[164:167], v[28:31], v[124:127], v[164:167]
    v_mfma_f32_16x16x32_bf16 v[168:171], v[28:31], v[144:147], v[168:171]
    v_mfma_f32_16x16x32_bf16 v[172:175], v[28:31], v[148:151], v[172:175]
    s_waitcnt lgkmcnt(4)
    v_mfma_f32_16x16x32_bf16 v[176:179], v[32:35], v[216:219], 0
    v_mfma_f32_16x16x32_bf16 v[180:183], v[32:35], v[220:223], 0
    v_mfma_f32_16x16x32_bf16 v[184:187], v[32:35], v[224:227], 0
    v_mfma_f32_16x16x32_bf16 v[188:191], v[32:35], v[228:231], 0
    v_mfma_f32_16x16x32_bf16 v[176:179], v[36:39], v[232:235], v[176:179]
    v_cvt_pk_bf16_f32 v64, v160, v164
    v_cvt_pk_bf16_f32 v80, v160, v164
    v_mfma_f32_16x16x32_bf16 v[180:183], v[36:39], v[236:239], v[180:183]
    v_cvt_pk_bf16_f32 v66, v162, v166
    v_cvt_pk_bf16_f32 v65, v168, v172
    v_mfma_f32_16x16x32_bf16 v[184:187], v[36:39], v[96:99], v[184:187]
    v_cvt_pk_bf16_f32 v81, v168, v172
    v_cvt_pk_bf16_f32 v67, v170, v174
    v_mfma_f32_16x16x32_bf16 v[188:191], v[36:39], v[100:103], v[188:191]
    v_mov_b32_dpp v64, v66 row_ror:8 row_mask:0xf bank_mask:0xc
    v_mov_b32_dpp v65, v67 row_ror:8 row_mask:0xf bank_mask:0xc
    v_mfma_f32_16x16x32_bf16 v[176:179], v[40:43], v[104:107], v[176:179]
    v_mov_b32_dpp v66, v80 row_ror:8 row_mask:0xf bank_mask:0x3
    v_mov_b32_dpp v67, v81 row_ror:8 row_mask:0xf bank_mask:0x3
    v_mfma_f32_16x16x32_bf16 v[180:183], v[40:43], v[108:111], v[180:183]
    buffer_store_dwordx4 v[64:67], v214, s[40:43], s87 offen offset:0 sc1
    v_cvt_pk_bf16_f32 v68, v161, v165
    v_mfma_f32_16x16x32_bf16 v[184:187], v[40:43], v[112:115], v[184:187]
    v_cvt_pk_bf16_f32 v82, v161, v165
    v_cvt_pk_bf16_f32 v70, v163, v167
    v_mfma_f32_16x16x32_bf16 v[188:191], v[40:43], v[116:119], v[188:191]
    v_cvt_pk_bf16_f32 v69, v169, v173
    v_cvt_pk_bf16_f32 v83, v169, v173
    v_mfma_f32_16x16x32_bf16 v[176:179], v[44:47], v[120:123], v[176:179]
    v_cvt_pk_bf16_f32 v71, v171, v175
    v_mov_b32_dpp v68, v70 row_ror:8 row_mask:0xf bank_mask:0xc
    v_mfma_f32_16x16x32_bf16 v[180:183], v[44:47], v[124:127], v[180:183]
    v_mov_b32_dpp v69, v71 row_ror:8 row_mask:0xf bank_mask:0xc
    v_mov_b32_dpp v70, v82 row_ror:8 row_mask:0xf bank_mask:0x3
    v_mfma_f32_16x16x32_bf16 v[184:187], v[44:47], v[144:147], v[184:187]
    v_mov_b32_dpp v71, v83 row_ror:8 row_mask:0xf bank_mask:0x3
    buffer_store_dwordx4 v[68:71], v214, s[40:43], s87 offen offset:256 sc1
    v_mfma_f32_16x16x32_bf16 v[188:191], v[44:47], v[148:151], v[188:191]
    s_add_u32 s87, s87, 4096
    s_cmp_ge_u32 s3, 4
    s_cbranch_scc1 L_two
    s_waitcnt lgkmcnt(0)
    v_mfma_f32_16x16x32_bf16 v[160:163], v[48:51], v[216:219], 0
    v_mfma_f32_16x16x32_bf16 v[164:167], v[48:51], v[220:223], 0
    v_mfma_f32_16x16x32_bf16 v[168:171], v[48:51], v[224:227], 0
    v_mfma_f32_16x16x32_bf16 v[172:175], v[48:51], v[228:231], 0
    v_mfma_f32_16x16x32_bf16 v[160:163], v[52:55], v[232:235], v[160:163]
    v_cvt_pk_bf16_f32 v72, v176, v180
    v_cvt_pk_bf16_f32 v80, v176, v180
    v_mfma_f32_16x16x32_bf16 v[164:167], v[52:55], v[236:239], v[164:167]
    v_cvt_pk_bf16_f32 v74, v178, v182
    v_cvt_pk_bf16_f32 v73, v184, v188
    v_mfma_f32_16x16x32_bf16 v[168:171], v[52:55], v[96:99], v[168:171]
    v_cvt_pk_bf16_f32 v81, v184, v188
    v_cvt_pk_bf16_f32 v75, v186, v190
    v_mfma_f32_16x16x32_bf16 v[172:175], v[52:55], v[100:103], v[172:175]
    v_mov_b32_dpp v72, v74 row_ror:8 row_mask:0xf bank_mask:0xc
    v_mov_b32_dpp v73, v75 row_ror:8 row_mask:0xf bank_mask:0xc
    v_mfma_f32_16x16x32_bf16 v[160:163], v[56:59], v[104:107], v[160:163]
    v_mov_b32_dpp v74, v80 row_ror:8 row_mask:0xf bank_mask:0x3
    v_mov_b32_dpp v75, v81 row_ror:8 row_mask:0xf bank_mask:0x3
    v_mfma_f32_16x16x32_bf16 v[164:167], v[56:59], v[108:111], v[164:167]
    buffer_store_dwordx4 v[72:75], v214, s[40:43], s87 offen offset:0 sc1
    v_cvt_pk_bf16_f32 v76, v177, v181
    v_mfma_f32_16x16x32_bf16 v[168:171], v[56:59], v[112:115], v[168:171]
    v_cvt_pk_bf16_f32 v82, v177, v181
    v_cvt_pk_bf16_f32 v78, v179, v183
    v_mfma_f32_16x16x32_bf16 v[172:175], v[56:59], v[116:119], v[172:175]
    v_cvt_pk_bf16_f32 v77, v185, v189
    v_cvt_pk_bf16_f32 v83, v185, v189
    v_mfma_f32_16x16x32_bf16 v[160:163], v[60:63], v[120:123], v[160:163]
    v_cvt_pk_bf16_f32 v79, v187, v191
    v_mov_b32_dpp v76, v78 row_ror:8 row_mask:0xf bank_mask:0xc
    v_mfma_f32_16x16x32_bf16 v[164:167], v[60:63], v[124:127], v[164:167]
    v_mov_b32_dpp v77, v79 row_ror:8 row_mask:0xf bank_mask:0xc
    v_mov_b32_dpp v78, v82 row_ror:8 row_mask:0xf bank_mask:0x3
    v_mfma_f32_16x16x32_bf16 v[168:171], v[60:63], v[144:147], v[168:171]
    v_mov_b32_dpp v79, v83 row_ror:8 row_mask:0xf bank_mask:0x3
    buffer_store_dwordx4 v[76:79], v214, s[40:43], s87 offen offset:256 sc1
    v_mfma_f32_16x16x32_bf16 v[172:175], v[60:63], v[148:151], v[172:175]
    s_add_u32 s87, s87, 4096
    s_nop 0
    v_cvt_pk_bf16_f32 v64, v160, v164
    v_cvt_pk_bf16_f32 v80, v160, v164
    v_cvt_pk_bf16_f32 v66, v162, v166
    s_nop 2
    v_cvt_pk_bf16_f32 v65, v168, v172
    v_cvt_pk_bf16_f32 v81, v168, v172
    v_cvt_pk_bf16_f32 v67, v170, v174
    v_mov_b32_dpp v64, v66 row_ror:8 row_mask:0xf bank_mask:0xc
    s_nop 0
    v_mov_b32_dpp v65, v67 row_ror:8 row_mask:0xf bank_mask:0xc
    v_mov_b32_dpp v66, v80 row_ror:8 row_mask:0xf bank_mask:0x3
    v_mov_b32_dpp v67, v81 row_ror:8 row_mask:0xf bank_mask:0x3
    buffer_store_dwordx4 v[64:67], v214, s[40:43], s87 offen offset:0 sc1
    v_cvt_pk_bf16_f32 v68, v161, v165
    v_cvt_pk_bf16_f32 v82, v161, v165
    v_cvt_pk_bf16_f32 v70, v163, v167
    v_cvt_pk_bf16_f32 v69, v169, v173
    v_cvt_pk_bf16_f32 v83, v169, v173
    v_cvt_pk_bf16_f32 v71, v171, v175
    v_mov_b32_dpp v68, v70 row_ror:8 row_mask:0xf bank_mask:0xc
    s_nop 0
    v_mov_b32_dpp v69, v71 row_ror:8 row_mask:0xf bank_mask:0xc
    v_mov_b32_dpp v70, v82 row_ror:8 row_mask:0xf bank_mask:0x3
    v_mov_b32_dpp v71, v83 row_ror:8 row_mask:0xf bank_mask:0x3
    buffer_store_dwordx4 v[68:71], v214, s[40:43], s87 offen offset:256 sc1
    s_add_u32 s87, s87, 4096
L_stored:
    s_or_b32 s4, s2, s3
    s_cbranch_scc1 L_notag
    v_mov_b32 v8, s62
    v_lshlrev_b32 v10, 2, v1
    s_mov_b32 s54, 524288
    buffer_store_dword v8, v10, s[20:23], s54 offen sc1
L_notag:
L_done:
    s_endpgm
L_again:
    s_waitcnt vmcnt(0) lgkmcnt(0)
    s_barrier
    v_lshlrev_b32 v11, 2, v0
    v_mov_b32 v12, 0x00700000
    v_mov_b32 v13, 0
    ds_write_b32 v11, v12 offset:0
    ds_write_b32 v11, v12 offset:2048
    ds_write_b32 v11, v12 offset:4096
    ds_write_b32 v11, v12 offset:6144
    ds_write_b32 v11, v13 offset:8192
    ds_write_b32 v11, v13 offset:10240
    ds_write_b32 v11, v13 offset:12288
    v_mov_b32 v64, 0
    v_mov_b32 v65, 0
    v_mov_b32 v66, 0
    v_mov_b32 v67, 0
    v_mov_b32 v68, 0
    v_mov_b32 v69, 0
    v_mov_b32 v70, 0
    v_mov_b32 v71, 0
    v_mov_b32 v72, 0
    v_mov_b32 v73, 0
    v_mov_b32 v74, 0
    v_mov_b32 v75, 0
    v_mov_b32 v76, 0
    v_mov_b32 v77, 0
    v_mov_b32 v78, 0
    v_mov_b32 v79, 0
    v_mov_b32 v80, 0
    v_mov_b32 v81, 0
    v_mov_b32 v82, 0
    v_mov_b32 v83, 0
    v_mov_b32 v84, 0
    v_mov_b32 v85, 0
    v_mov_b32 v86, 0
    v_mov_b32 v87, 0
    v_mov_b32 v88, 0
    v_mov_b32 v89, 0
    v_mov_b32 v90, 0
    v_mov_b32 v91, 0
    v_mov_b32 v92, 0
    v_mov_b32 v93, 0
    v_mov_b32 v94, 0
    v_mov_b32 v95, 0
    v_add_u32 v3, v3, v4
    v_subrev_u32 v3, 224, v3
    v_max_i32 v3, 0, v3
    v_subrev_u32 v4, 224, v4
    v_max_i32 v4, 0, v4
    v_sub_u32 v3, v3, v4
    v_add_u32 v5, 224, v5
    s_sub_i32 s95, s95, 224
    v_lshl_add_u32 v8, v4, 2, v241
    s_waitcnt lgkmcnt(0)
    s_barrier
L_clip:
    v_add_u32 v10, v4, v3
    v_min_i32 v10, 224, v10
    v_sub_u32 v10, v10, v4
    v_add_u32 v10, v10, v240
L_masks:
    v_cmp_lt_i32 s[64:65], 0, v10
    v_cmp_lt_i32 s[66:67], 2, v10
    v_cmp_lt_i32 s[68:69], 4, v10
    v_cmp_lt_i32 s[70:71], 6, v10
    v_cmp_lt_i32 s[72:73], 8, v10
    v_cmp_lt_i32 s[74:75], 10, v10
    v_cmp_lt_i32 s[76:77], 12, v10
    v_cmp_lt_i32 s[78:79], 14, v10
    s_nop 0
    s_branch L_mapw
L_map2:
    v_add_u32 v8, 56, v8
    v_subrev_u32 v10, 14, v10
    s_branch L_masks
L_r1:
    ds_read_b32 v139, v242 offset:768
    ds_read_b32 v146, v243 offset:768
    s_waitcnt lgkmcnt(0)
    v_mad_u32_u24 v139, v139, 12, v244
    buffer_load_dwordx3 v[160:162], v139, s[24:27], 0 offen offset:2304 sc1
    v_lshl_add_u32 v146, v146, 5, v2
    s_add_u32 m0, s52, 4096
    s_nop 0
    buffer_load_dwordx4 v146, s[28:31], s98 offen offset:2048 sc1 lds
    s_branch L_r1b
L_r2:
    v_lshrrev_b32 v135, 21, v162
    v_lshlrev_b32 v135, 2, v135
    v_lshrrev_b32 v11, 26, v162
    v_lshl_or_b32 v11, v11, 4, v245
    s_mov_b64 exec, s[96:97]
    ds_add_rtn_u32 v131, v135, v6 offset:8192
    ds_add_u32 v11, v6 offset:14336
    s_mov_b64 exec, -1
    s_mov_b32 exec_hi, 0
    ds_write_b64 v246, v[160:161] offset:1536
    s_mov_b32 exec_hi, -1
    v_and_or_b32 v162, v162, s55, v247
    v_add_u32 v162, 402653184, v162
    s_branch L_r2b
L_r3:
    ds_read_b32 v135, v135 offset:8192
    s_waitcnt lgkmcnt(0)
    v_bfe_u32 v15, v135, 12, 3
    v_or_b32 v162, v15, v162
    v_and_b32 v139, 0x3ff, v135
    v_lshrrev_b32 v135, 16, v135
    v_add_u32 v135, v135, v131
    ds_read_b32 v139, v139 offset:16384
    s_waitcnt lgkmcnt(0)
    v_lshl_add_u32 v135, v135, 2, v139
    s_mov_b64 exec, s[96:97]
    ds_write_b32 v135, v162
    s_mov_b64 exec, -1
    s_branch L_r3b
L_empty:
    s_waitcnt vmcnt(0) lgkmcnt(0)
    s_barrier
    v_lshlrev_b32 v12, 2, v1
    s_lshl_b32 s61, s3, 7
    v_and_b32 v205, 0x7380, v205
    v_xor_b32 v205, s61, v205
    v_alignbit_b32 v205, v205, v205, 12
    v_cmp_eq_u32 s[80:81], 0, v205
    v_cmp_eq_u32 s[82:83], 1, v205
    v_cmp_eq_u32 s[84:85], 2, v205
    v_cmp_eq_u32 s[96:97], 3, v205
    v_cmp_eq_u32 vcc, 4, v205
    s_ff1_i32_b64 s56, s[80:81]
    s_mul_i32 s56, s56, 1152
    v_add_u32 v208, s56, v12
    s_ff1_i32_b64 s57, s[82:83]
    s_mul_i32 s57, s57, 1152
    v_add_u32 v209, s57, v12
    s_ff1_i32_b64 s58, s[84:85]
    s_mul_i32 s58, s58, 1152
    v_add_u32 v210, s58, v12
    s_ff1_i32_b64 s59, s[96:97]
    s_mul_i32 s59, s59, 1152
    v_add_u32 v211, s59, v12
    s_ff1_i32_b64 s60, vcc
    s_mul_i32 s60, s60, 1152
    v_add_u32 v212, s60, v12
    ds_read_b128 v[96:99], v215 offset:6144
    ds_read_b128 v[100:103], v215 offset:7168
    ds_read_b128 v[104:107], v215 offset:8192
    ds_read_b128 v[108:111], v215 offset:9216
    ds_read_b128 v[112:115], v215 offset:10240
    ds_read_b128 v[116:119], v215 offset:11264
    ds_read_b128 v[120:123], v215 offset:12288
    ds_read_b128 v[124:127], v215 offset:13312
    ds_read_b128 v[144:147], v215 offset:14336
    ds_read_b128 v[148:151], v215 offset:15360
    s_branch L_swept
L_two:
    s_nop 7
    v_cvt_pk_bf16_f32 v72, v176, v180
    v_cvt_pk_bf16_f32 v80, v176, v180
    v_cvt_pk_bf16_f32 v74, v178, v182
    v_cvt_pk_bf16_f32 v73, v184, v188
    v_cvt_pk_bf16_f32 v81, v184, v188
    v_cvt_pk_bf16_f32 v75, v186, v190
    v_mov_b32_dpp v72, v74 row_ror:8 row_mask:0xf bank_mask:0xc
    s_nop 0
    v_mov_b32_dpp v73, v75 row_ror:8 row_mask:0xf bank_mask:0xc
    v_mov_b32_dpp v74, v80 row_ror:8 row_mask:0xf bank_mask:0x3
    v_mov_b32_dpp v75, v81 row_ror:8 row_mask:0xf bank_mask:0x3
    buffer_store_dwordx4 v[72:75], v214, s[40:43], s87 offen offset:0 sc1
    v_cvt_pk_bf16_f32 v76, v177, v181
    v_cvt_pk_bf16_f32 v82, v177, v181
    v_cvt_pk_bf16_f32 v78, v179, v183
    v_cvt_pk_bf16_f32 v77, v185, v189
    v_cvt_pk_bf16_f32 v83, v185, v189
    v_cvt_pk_bf16_f32 v79, v187, v191
    v_mov_b32_dpp v76, v78 row_ror:8 row_mask:0xf bank_mask:0xc
    s_nop 0
    v_mov_b32_dpp v77, v79 row_ror:8 row_mask:0xf bank_mask:0xc
    v_mov_b32_dpp v78, v82 row_ror:8 row_mask:0xf bank_mask:0x3
    v_mov_b32_dpp v79, v83 row_ror:8 row_mask:0xf bank_mask:0x3
    buffer_store_dwordx4 v[76:79], v214, s[40:43], s87 offen offset:256 sc1
    s_add_u32 s87, s87, 4096
    s_branch L_stored
L_poll:
    buffer_load_dwordx2 v[206:207], v10, s[20:23], s49 offen sc1
    s_sub_u32 s53, s53, 1
    s_cbranch_scc1 L_done
    s_waitcnt vmcnt(0)
    v_xor_b32 v11, s63, v206
    v_xor_b32 v12, s62, v207
    v_and_or_b32 v11, v11, s55, v12
    v_cmpx_ne_u32 vcc, 0, v11
    s_cbranch_execnz L_poll
    s_branch L_polled
L_rank2:
    ds_read_b32 v96, v248 offset:8192
    ds_read_b32 v97, v248 offset:8320
    ds_read_b32 v98, v248 offset:8448
    ds_read_b32 v99, v248 offset:8576
    ds_read_b32 v100, v248 offset:8704
    ds_write_b64 v246, v[148:149] offset:0
    v_and_or_b32 v150, v150, s55, v247
    ds_write_b64 v246, v[152:153] offset:512
    v_and_or_b32 v154, v154, s55, v247
    v_add_u32 v154, 134217728, v154
    ds_write_b64 v246, v[156:157] offset:1024
    v_and_or_b32 v158, v158, s55, v247
    v_add_u32 v158, 268435456, v158
    s_waitcnt lgkmcnt(0)
L_end:
    s_branch L_ranked
.section .rodata,"a"
.p2align 6
.amdhsa_kernel gather_scatter__tensor_product_equiv_mace__graph_kernel
  .amdhsa_next_free_vgpr 256
  .amdhsa_next_free_sgpr 102
  .amdhsa_accum_offset 256
  .amdhsa_group_segment_fixed_size 0
  .amdhsa_kernarg_size 88
  .amdhsa_user_sgpr_count 2
  .amdhsa_user_sgpr_kernarg_segment_ptr 1
  .amdhsa_system_sgpr_workgroup_id_x 1
  .amdhsa_float_denorm_mode_32 3
.end_amdhsa_kernel
```

```asm
; @launch grid=(256,1,1) block=(512,1,1) lds=158784
.amdgcn_target "amdgcn-amd-amdhsa--gfx950"
.text
.globl gather_scatter__tensor_product_equiv_mace__graph_kernel
.p2align 8
.type gather_scatter__tensor_product_equiv_mace__graph_kernel,@function
gather_scatter__tensor_product_equiv_mace__graph_kernel:
    s_cmp_ge_u32 s2, 256
    s_cbranch_scc1 L_done
    s_load_dwordx4 s[4:7], s[0:1], 8
    s_load_dwordx4 s[8:11], s[0:1], 24
    s_load_dwordx2 s[14:15], s[0:1], 80
    s_load_dwordx2 s[64:65], s[0:1], 0
    s_load_dwordx2 s[66:67], s[0:1], 40
    s_load_dwordx4 s[68:71], s[0:1], 48
    s_load_dwordx2 s[12:13], s[0:1], 64
    v_lshlrev_b32 v10, 3, v0
    s_getpc_b64 s[80:81]
L_pc:
    s_and_b32 s44, s2, 0xf8
    s_lshl_b32 s44, s44, 6
    v_and_b32 v11, 0x180, v10
    v_add_u32 v11, s44, v11
    v_min_u32 v11, L_end-L_pc, v11
    v_mov_b32 v113, s81
    v_add_co_u32 v112, vcc, s80, v11
    s_nop 1
    v_addc_co_u32 v113, vcc, 0, v113, vcc
    global_load_dword v205, v[112:113], off
    v_lshrrev_b32 v8, 6, v0
    v_and_b32 v1, 63, v0
    v_lshlrev_b32 v9, 2, v0
    v_mov_b32 v13, 0
    v_readfirstlane_b32 s3, v8
    ds_write_b32 v9, v13 offset:23552
    ds_write_b32 v9, v13 offset:28672
    s_mul_i32 s54, s2, 5000
    s_mul_i32 s55, s2, 10000
    s_mul_i32 s61, s2, 40000
    v_lshlrev_b32 v2, 4, v1
    v_lshlrev_b32 v15, 4, v0
    v_mov_b32 v6, 1
    s_lshl_b32 s52, s3, 10
    s_add_u32 s52, s52, 101376
    s_movk_i32 s53, 4096
    s_movk_i32 s50, 8192
    s_mov_b32 s34, 5000
    s_mov_b32 s35, 0x20000
    s_mov_b32 s38, 5000
    s_mov_b32 s39, 0x20000
    s_mov_b32 s98, 10000
    s_mov_b32 s99, 0x20000
    s_mov_b32 s30, 40000
    s_mov_b32 s31, 0x20000
    s_waitcnt lgkmcnt(0)
    s_add_u32 s32, s6, s54
    s_addc_u32 s33, s7, 0
    buffer_load_dword v64, v9, s[32:35], 0 offen offset:0 nt
    buffer_load_dword v65, v9, s[32:35], 0 offen offset:2048 nt
    buffer_load_dword v66, v9, s[32:35], s53 offen nt
    s_add_u32 s36, s4, s54
    s_addc_u32 s37, s5, 0
    s_barrier
    buffer_load_dword v68, v9, s[36:39], 0 offen offset:0 nt
    buffer_load_dword v69, v9, s[36:39], 0 offen offset:2048 nt
    buffer_load_dword v70, v9, s[36:39], s53 offen nt
    s_load_dword s62, s[14:15], 524288
    s_add_u32 s96, s8, s55
    s_addc_u32 s97, s9, 0
    s_add_u32 s28, s10, s61
    s_addc_u32 s29, s11, 0
    buffer_load_dwordx2 v[72:73], v10, s[96:99], 0 offen nt
    buffer_load_dwordx2 v[74:75], v10, s[96:99], s53 offen nt
    buffer_load_dwordx2 v[76:77], v10, s[96:99], s50 offen nt
    s_add_u32 m0, s52, 0
    s_mov_b32 s54, 0
    buffer_load_dwordx4 v15, s[28:31], s54 offen nt lds
    s_add_u32 m0, s52, 8192
    s_mov_b32 s54, 8192
    buffer_load_dwordx4 v15, s[28:31], s54 offen nt lds
    s_add_u32 m0, s52, 16384
    s_mov_b32 s54, 16384
    buffer_load_dwordx4 v15, s[28:31], s54 offen nt lds
    s_mov_b32 s72, 109951168
    s_movk_i32 s73, 625
    s_movk_i32 s74, 838
    s_movk_i32 s54, 226
    v_cmp_gt_u32 s[84:85], s54, v0
    s_mov_b32 s20, s14
    s_mov_b32 s21, s15
    s_mov_b32 s22, 524352
    s_mov_b32 s23, 0x20000
    v_lshlrev_b32 v11, 2, v0
    v_mov_b32 v12, 0x00700000
    v_mov_b32 v13, 0
    ds_write_b32 v11, v12 offset:0
    ds_write_b32 v11, v12 offset:2048
    ds_write_b32 v11, v12 offset:4096
    ds_write_b32 v11, v12 offset:6144
    ds_write_b32 v11, v13 offset:8192
    ds_write_b32 v11, v13 offset:10240
    ds_write_b32 v11, v13 offset:12288
    ds_write_b32 v11, v13 offset:14336
    s_waitcnt vmcnt(9)
    v_mul_hi_u32 v80, v64, s72
    v_mul_hi_u32 v81, v65, s72
    v_mul_hi_u32 v82, v66, s72
    v_lshlrev_b32 v84, 2, v80
    ds_add_rtn_u32 v88, v84, v6 offset:23552
    v_lshlrev_b32 v85, 2, v81
    ds_add_rtn_u32 v89, v85, v6 offset:23552
    v_lshlrev_b32 v86, 2, v82
    s_mov_b64 exec, s[84:85]
    ds_add_rtn_u32 v90, v86, v6 offset:23552
    s_mov_b64 exec, -1
    s_waitcnt lgkmcnt(0)
    s_barrier
    ds_read_b128 v[100:103], v2 offset:23552
    s_mul_i32 s62, s62, 0x9e3779b1
    s_add_u32 s62, s62, 0x7f4a7c15
    s_mul_i32 s63, s62, 0x85ebca6b
    s_and_b32 s63, s63, 0xffc00000
    s_add_u32 m0, s52, 24576
    s_mov_b32 s54, 24576
    buffer_load_dwordx4 v15, s[28:31], s54 offen nt lds
    s_add_u32 m0, s52, 32768
    s_mov_b32 s54, 32768
    buffer_load_dwordx4 v15, s[28:31], s54 offen nt lds
    v_mad_u32_u24 v92, v80, s73, 15
    v_lshrrev_b32 v92, 4, v92
    v_sub_u32 v92, v64, v92
    v_mad_u32_u24 v93, v81, s73, 15
    v_lshrrev_b32 v93, 4, v93
    v_sub_u32 v93, v65, v93
    v_mad_u32_u24 v94, v82, s73, 15
    v_lshrrev_b32 v94, 4, v94
    v_sub_u32 v94, v66, v94
    s_waitcnt lgkmcnt(0)
    v_add_u32 v11, v100, v101
    v_add3_u32 v11, v11, v102, v103
    v_mov_b32 v12, v11
    s_nop 1
    v_add_u32_dpp v12, v12, v12 row_shr:1 row_mask:0xf bank_mask:0xf
    s_nop 1
    v_add_u32_dpp v12, v12, v12 row_shr:2 row_mask:0xf bank_mask:0xf
    s_nop 1
    v_add_u32_dpp v12, v12, v12 row_shr:4 row_mask:0xf bank_mask:0xf
    s_nop 1
    v_add_u32_dpp v12, v12, v12 row_shr:8 row_mask:0xf bank_mask:0xf
    s_nop 1
    v_add_u32_dpp v12, v12, v12 row_bcast:15 row_mask:0xa bank_mask:0xf
    s_nop 1
    v_add_u32_dpp v12, v12, v12 row_bcast:31 row_mask:0xc bank_mask:0xf
    v_sub_u32 v104, v12, v11
    v_add_u32 v105, v104, v100
    v_add_u32 v106, v105, v101
    v_add_u32 v107, v106, v102
    ds_write_b128 v2, v[104:107] offset:24576
    ds_read_b32 v108, v84 offset:24576
    ds_read_b32 v109, v85 offset:24576
    ds_read_b32 v110, v86 offset:24576
    s_waitcnt vmcnt(8)
    v_mul_u32_u24 v96, s74, v68
    v_bfe_u32 v96, v96, 18, 5
    v_lshl_or_b32 v96, v92, 5, v96
    v_lshlrev_b32 v96, 21, v96
    v_lshl_or_b32 v96, v68, 7, v96
    v_mul_u32_u24 v97, s74, v69
    v_bfe_u32 v97, v97, 18, 5
    v_lshl_or_b32 v97, v93, 5, v97
    v_lshlrev_b32 v97, 21, v97
    v_lshl_or_b32 v97, v69, 7, v97
    v_mul_u32_u24 v98, s74, v70
    v_bfe_u32 v98, v98, 18, 5
    v_lshl_or_b32 v98, v94, 5, v98
    v_lshlrev_b32 v98, 21, v98
    v_lshl_or_b32 v98, v70, 7, v98
    v_lshlrev_b32 v92, 5, v0
    v_add_u32 v93, 16384, v92
    v_add_u32 v94, 32768, v92
    s_mov_b32 s55, 30720
    s_waitcnt vmcnt(5) lgkmcnt(0)
    v_add_u32 v108, v108, v88
    v_lshlrev_b32 v84, 2, v108
    v_mad_u32_u24 v108, v108, 12, s55
    ds_write_b32 v84, v92 offset:25600
    ds_write2_b32 v108, v72, v73 offset0:0 offset1:1
    ds_write_b32 v108, v96 offset:8
    v_add_u32 v109, v109, v89
    v_lshlrev_b32 v85, 2, v109
    v_mad_u32_u24 v109, v109, 12, s55
    ds_write_b32 v85, v93 offset:25600
    ds_write2_b32 v109, v74, v75 offset0:0 offset1:1
    ds_write_b32 v109, v97 offset:8
    v_add_u32 v110, v110, v90
    v_lshlrev_b32 v86, 2, v110
    v_mad_u32_u24 v110, v110, 12, s55
    s_mov_b64 exec, s[84:85]
    ds_write_b32 v86, v94 offset:25600
    ds_write2_b32 v110, v76, v77 offset0:0 offset1:1
    ds_write_b32 v110, v98 offset:8
    s_mov_b64 exec, -1
    s_lshl_b32 s54, s3, 7
    v_lshl_add_u32 v11, v1, 3, s54
    ds_read_b64 v[100:101], v11 offset:23552
    ds_read_b64 v[104:105], v11 offset:24576
    s_mul_i32 s54, s2, 15360
    s_add_u32 s54, s54, 1048576
    s_add_u32 s32, s14, s54
    s_addc_u32 s33, s15, 0
    s_mov_b32 s34, 15360
    s_mov_b32 s35, 0x20000
    s_mul_i32 s54, s2, 40960
    s_add_u32 s54, s54, 5242880
    s_add_u32 s36, s14, s54
    s_addc_u32 s37, s15, 0
    s_mov_b32 s38, 40000
    s_mov_b32 s39, 0x20000
    v_lshrrev_b32 v11, 1, v0
    v_lshlrev_b32 v11, 2, v11
    v_and_b32 v12, 1, v0
    v_lshlrev_b32 v12, 4, v12
    v_add_u32 v12, 101376, v12
    v_add_u32 v14, 30720, v15
    s_waitcnt lgkmcnt(0)
    s_barrier
    ds_read_b128 v[128:131], v14
    ds_read_b128 v[132:135], v14 offset:8192
    ds_read_b32 v156, v11 offset:25600
    ds_read_b32 v157, v11 offset:26624
    ds_read_b32 v158, v11 offset:27648
    ds_read_b32 v159, v11 offset:28672
    ds_read_b32 v160, v11 offset:29696
    s_cmp_lt_u32 s3, 4
    s_cselect_b32 s16, s68, s66
    s_cselect_b32 s17, s69, s67
    s_movk_i32 s54, 128
    s_cselect_b32 s18, s53, s54
    s_mov_b32 s19, 0x20000
    s_min_u32 s54, s3, 5
    s_lshl_b32 s54, s54, 10
    s_add_u32 m0, s54, 17408
    s_and_b32 s54, s54, 0xc00
    buffer_load_dwordx4 v2, s[16:19], s54 offen lds
    s_mov_b32 s40, s70
    s_mov_b32 s41, s71
    s_mov_b32 s42, 32768
    s_mov_b32 s43, 0x20000
    s_lshl_b32 s55, s3, 12
    s_add_u32 m0, s55, 46080
    s_nop 0
    buffer_load_dwordx4 v2, s[40:43], s55 offen offset:0 lds
    buffer_load_dwordx4 v2, s[40:43], s55 offen offset:1024 lds
    buffer_load_dwordx4 v2, s[40:43], s55 offen offset:2048 lds
    buffer_load_dwordx4 v2, s[40:43], s55 offen offset:3072 lds
    s_waitcnt lgkmcnt(0)
    v_add_u32 v156, v12, v156
    v_add_u32 v157, v12, v157
    v_add_u32 v158, v12, v158
    v_add_u32 v159, v12, v159
    v_add_u32 v160, v12, v160
    v_lshl_or_b32 v112, v100, 11, v104
    v_or_b32 v112, s63, v112
    v_mov_b32 v113, s62
    v_lshl_or_b32 v114, v101, 11, v105
    v_or_b32 v114, s63, v114
    v_mov_b32 v115, s62
    s_waitcnt vmcnt(0)
    s_barrier
    ds_read_b128 v[136:139], v156
    ds_read_b128 v[140:143], v157
    ds_read_b128 v[144:147], v158
    ds_read_b128 v[148:151], v159
    ds_read_b128 v[152:155], v160
    buffer_store_dwordx4 v[128:131], v15, s[32:35], 0 offen sc1
    buffer_store_dwordx4 v[132:135], v15, s[32:35], s50 offen sc1
    s_mov_b32 s54, 0
    s_waitcnt lgkmcnt(4)
    buffer_store_dwordx4 v[136:139], v15, s[36:39], s54 offen sc1
    s_mov_b32 s54, 8192
    s_waitcnt lgkmcnt(3)
    buffer_store_dwordx4 v[140:143], v15, s[36:39], s54 offen sc1
    s_mov_b32 s54, 16384
    s_waitcnt lgkmcnt(2)
    buffer_store_dwordx4 v[144:147], v15, s[36:39], s54 offen sc1
    s_mov_b32 s54, 24576
    s_waitcnt lgkmcnt(1)
    buffer_store_dwordx4 v[148:151], v15, s[36:39], s54 offen sc1
    s_mov_b32 s54, 32768
    s_waitcnt lgkmcnt(0)
    buffer_store_dwordx4 v[152:155], v15, s[36:39], s54 offen sc1
    s_and_b32 s44, s2, 7
    s_lshl_b32 s44, s44, 5
    s_lshr_b32 s54, s2, 3
    s_add_u32 s44, s44, s54
    s_mul_i32 s45, s44, 625
    s_add_u32 s46, s45, 640
    s_add_u32 s45, s45, 15
    s_lshr_b32 s45, s45, 4
    s_lshr_b32 s46, s46, 4
    s_sub_u32 s46, s46, s45
    v_bfe_i32 v168, v1, 2, 1
    v_and_b32 v168, 0xaaaa, v168
    v_add_u32 v168, 0x4444, v168
    v_mov_b32 v169, 158720
    v_and_b32 v11, 60, v9
    v_add_u32 v11, v11, v169
    ds_write_b32 v11, v13
    v_and_b32 v11, 4, v1
    v_lshlrev_b32 v11, 2, v11
    v_mov_b32 v12, 0xffff
    v_lshlrev_b32 v12, v11, v12
    v_bfe_i32 v11, v1, 3, 1
    v_and_b32 v191, v11, v12
    v_xor_b32 v190, v191, v12
    v_mov_b32 v11, 0x0c0c0c0c
    v_mov_b32 v12, 0x03020302
    v_bfi_b32 v254, v190, v12, v11
    v_bfi_b32 v255, v191, v12, v11
    v_mov_b32 v12, 0x01000100
    v_bfi_b32 v190, v190, v12, v11
    v_bfi_b32 v191, v191, v12, v11
    v_lshrrev_b32 v200, 5, v1
    v_lshlrev_b32 v200, 4, v200
    v_add_u32 v200, 101376, v200
    v_and_b32 v201, 15, v1
    v_lshlrev_b32 v201, 2, v201
    v_bfe_u32 v11, v1, 3, 2
    v_and_b32 v12, 3, v1
    v_lshl_add_u32 v11, v11, 2, v12
    v_lshlrev_b32 v202, 2, v11
    v_bfe_i32 v240, v0, 0, 1
    s_lshl_b32 s54, s3, 10
    v_and_b32 v241, 4, v240
    v_add_u32 v241, s54, v241
    v_lshl_add_u32 v242, v1, 2, s54
    v_lshrrev_b32 v243, 1, v1
    v_lshl_add_u32 v243, v243, 2, s54
    v_mul_u32_u24 v244, 12, v1
    v_and_b32 v245, 12, v242
    v_and_b32 v250, 124, v242
    s_mul_i32 s54, s3, 224
    v_add_u32 v247, s54, v1
    v_lshlrev_b32 v246, 3, v247
    v_add_u32 v246, 87040, v246
    v_lshlrev_b32 v247, 21, v247
    s_mul_i32 s54, s3, 640
    v_add_u32 v248, s54, v250
    v_sub_u32 v249, 63, v1
    s_getreg_b32 s86, hwreg(HW_REG_XCC_ID, 0, 3)
    s_lshl_b32 s54, s86, 4
    v_subrev_u32 v250, s54, v250
    v_and_b32 v250, 124, v250
    v_min_u32 v251, 39, v1
    v_lshlrev_b32 v251, 7, v251
    v_mov_b32 v253, 0x380
    v_lshrrev_b32 v252, 3, v1
    v_mul_u32_u24 v252, 64, v252
    v_add_u32 v252, 78848, v252
    s_lshr_b32 s87, s3, 1
    s_mul_i32 s87, s87, 3
    s_min_u32 s87, s87, 8
    s_mul_i32 s54, s87, 4608
    v_and_b32 v11, 15, v1
    v_lshrrev_b32 v12, 4, v1
    v_mul_u32_u24 v213, 288, v11
    v_lshl_add_u32 v213, v12, 4, v213
    v_add_u32 v213, s54, v213
    v_lshrrev_b32 v12, 3, v1
    v_lshlrev_b32 v12, 9, v12
    v_and_b32 v11, 7, v1
    v_lshl_add_u32 v214, v11, 4, v12
    s_lshl_b32 s87, s87, 12
    s_and_b32 s54, s3, 1
    s_lshl_b32 s54, s54, 7
    s_add_u32 s87, s87, s54
    s_lshl_b32 s54, s54, 7
    s_add_u32 s54, s54, 46080
    v_add_u32 v215, s54, v2
    s_cmp_eq_u32 s46, 40
    v_mov_b32 v203, 0
    s_mov_b32 s54, 685900808
    s_cselect_b32 s54, 568459824, s54
    s_mov_b32 exec_lo, 31
    s_mov_b32 exec_hi, 0
    v_mov_b32 v203, s54
    s_mov_b32 s54, 182814793
    s_cselect_b32 s54, 23232528, s54
    s_mov_b32 exec_lo, 992
    s_mov_b32 exec_hi, 0
    v_mov_b32 v203, s54
    s_mov_b32 s54, 984091248
    s_cselect_b32 s54, 719688297, s54
    s_mov_b32 exec_lo, 31744
    s_mov_b32 exec_hi, 0
    v_mov_b32 v203, s54
    s_mov_b32 s54, 424091761
    s_cselect_b32 s54, 984423522, s54
    s_mov_b32 exec_lo, 1015808
    s_mov_b32 exec_hi, 0
    v_mov_b32 v203, s54
    s_mov_b32 s54, 586001611
    s_cselect_b32 s54, 172635826, s54
    s_mov_b32 exec_lo, 32505856
    s_mov_b32 exec_hi, 0
    v_mov_b32 v203, s54
    s_mov_b32 s54, 64039106
    s_cselect_b32 s54, 454017211, s54
    s_mov_b32 exec_lo, 1040187392
    s_mov_b32 exec_hi, 0
    v_mov_b32 v203, s54
    s_mov_b32 s54, 330320603
    s_cselect_b32 s54, 743654643, s54
    s_mov_b32 exec_lo, 3221225472
    s_mov_b32 exec_hi, 7
    v_mov_b32 v203, s54
    s_mov_b32 s54, 217139484
    s_cselect_b32 s54, 607143691, s54
    s_mov_b32 exec_lo, 0
    s_mov_b32 exec_hi, 248
    v_mov_b32 v203, s54
    s_mov_b64 exec, -1
    v_mul_u32_u24 v11, 52, v1
    v_lshrrev_b32 v11, 8, v11
    v_mad_i32_i24 v11, v11, -5, v1
    v_mul_u32_u24 v11, 6, v11
    v_lshrrev_b32 v203, v11, v203
    v_and_b32 v11, 7, v203
    v_bfe_u32 v203, v203, 3, 3
    v_lshlrev_b32 v11, 12, v11
    v_lshl_or_b32 v203, v203, 7, v11
    s_add_u32 s24, s14, 1048576
    s_addc_u32 s25, s15, 0
    s_mov_b32 s26, 3932160
    s_mov_b32 s27, 0x20000
    v_mov_b32 v16, 0
    v_mov_b32 v17, 0
    v_mov_b32 v18, 0
    v_mov_b32 v19, 0
    v_mov_b32 v20, 0
    v_mov_b32 v21, 0
    v_mov_b32 v22, 0
    v_mov_b32 v23, 0
    v_mov_b32 v24, 0
    v_mov_b32 v25, 0
    v_mov_b32 v26, 0
    v_mov_b32 v27, 0
    v_mov_b32 v28, 0
    v_mov_b32 v29, 0
    v_mov_b32 v30, 0
    v_mov_b32 v31, 0
    v_mov_b32 v32, 0
    v_mov_b32 v33, 0
    v_mov_b32 v34, 0
    v_mov_b32 v35, 0
    v_mov_b32 v36, 0
    v_mov_b32 v37, 0
    v_mov_b32 v38, 0
    v_mov_b32 v39, 0
    v_mov_b32 v40, 0
    v_mov_b32 v41, 0
    v_mov_b32 v42, 0
    v_mov_b32 v43, 0
    v_mov_b32 v44, 0
    v_mov_b32 v45, 0
    v_mov_b32 v46, 0
    v_mov_b32 v47, 0
    v_mov_b32 v48, 0
    v_mov_b32 v49, 0
    v_mov_b32 v50, 0
    v_mov_b32 v51, 0
    v_mov_b32 v52, 0
    v_mov_b32 v53, 0
    v_mov_b32 v54, 0
    v_mov_b32 v55, 0
    v_mov_b32 v56, 0
    v_mov_b32 v57, 0
    v_mov_b32 v58, 0
    v_mov_b32 v59, 0
    v_mov_b32 v60, 0
    v_mov_b32 v61, 0
    v_mov_b32 v62, 0
    v_mov_b32 v63, 0
    s_lshl_b32 s54, s2, 3
    s_add_u32 s54, s54, s3
    s_lshl_b32 s54, s54, 8
    s_mov_b32 s16, s64
    s_mov_b32 s17, s65
    s_mov_b32 s18, 10240000
    s_mov_b32 s19, 0x20000
    s_add_u32 s28, s14, 5242880
    s_addc_u32 s29, s15, 0
    s_mov_b32 s30, 10485760
    s_mov_b32 s31, 0x20000
    s_and_b32 s51, s86, 7
    s_mul_i32 s51, s51, 1282048
    s_and_b32 s55, s2, 0xf8
    s_add_u32 s55, s55, s3
    s_mul_i32 s55, s55, 2304
    s_add_u32 s51, s51, s55
    v_min_u32 v14, 17, v1
    v_lshlrev_b32 v14, 7, v14
    s_waitcnt vmcnt(0)
    s_barrier
    s_mov_b64 exec, 0xffff
    buffer_store_dwordx4 v[112:115], v2, s[20:23], s54 offen sc1
    s_mov_b64 exec, -1
    buffer_load_dword v7, v14, s[16:19], s51 offen
    s_lshl_b32 s54, s45, 10
    s_add_u32 s40, s12, s54
    s_addc_u32 s41, s13, 0
    s_lshl_b32 s42, s46, 10
    s_mov_b32 s43, 0x20000
    v_lshrrev_b32 v8, 5, v1
    v_lshlrev_b32 v8, 10, v8
    v_and_b32 v9, 15, v1
    v_lshl_add_u32 v8, v9, 4, v8
    ds_read_b128 v[64:67], v8 offset:17408
    ds_read_b128 v[68:71], v8 offset:17664
    ds_read_b128 v[72:75], v8 offset:17920
    ds_read_b128 v[76:79], v8 offset:18176
    ds_read_b128 v[80:83], v8 offset:19456
    ds_read_b128 v[84:87], v8 offset:19712
    ds_read_b128 v[88:91], v8 offset:19968
    ds_read_b128 v[92:95], v8 offset:20224
    v_lshrrev_b32 v8, 4, v1
    v_lshlrev_b32 v8, 5, v8
    v_and_b32 v9, 3, v1
    v_lshl_add_u32 v8, v9, 1, v8
    ds_read_u16 v96, v8 offset:21504
    ds_read_u16 v97, v8 offset:21512
    ds_read_u16 v98, v8 offset:21520
    ds_read_u16 v99, v8 offset:21528
    v_bfe_i32 v10, v1, 4, 1
    v_and_b32 v10, 0x02020202, v10
    v_add_u32 v10, 0x05040100, v10
    s_waitcnt lgkmcnt(0)
    v_perm_b32 v172, v68, v64, v10
    v_perm_b32 v174, v76, v72, v10
    v_perm_b32 v176, v84, v80, v10
    v_perm_b32 v178, v92, v88, v10
    v_perm_b32 v173, v69, v65, v10
    v_perm_b32 v175, v77, v73, v10
    v_perm_b32 v177, v85, v81, v10
    v_perm_b32 v179, v93, v89, v10
    v_perm_b32 v180, v70, v66, v10
    v_perm_b32 v182, v78, v74, v10
    v_perm_b32 v184, v86, v82, v10
    v_perm_b32 v186, v94, v90, v10
    v_perm_b32 v181, v71, v67, v10
    v_perm_b32 v183, v79, v75, v10
    v_perm_b32 v185, v87, v83, v10
    v_perm_b32 v187, v95, v91, v10
    v_lshl_or_b32 v188, v97, 16, v96
    v_lshl_or_b32 v189, v99, 16, v98
    v_and_b32 v9, 7, v1
    v_lshrrev_b32 v8, 4, v1
    v_lshlrev_b32 v8, 13, v8
    v_lshl_add_u32 v8, v9, 4, v8
    v_and_b32 v9, 8, v1
    s_and_b32 s72, s3, 3
    s_lshl_b32 s72, s72, 8
    s_lshr_b32 s73, s3, 2
    s_lshl_b32 s73, s73, 7
    s_add_u32 s72, s72, s73
    s_add_u32 s72, s72, 46080
    v_add3_u32 v8, v8, v9, s72
    ds_read2st64_b64 v[128:131], v8 offset0:0 offset1:2
    ds_read2st64_b64 v[132:135], v8 offset0:4 offset1:6
    ds_read2st64_b64 v[136:139], v8 offset0:8 offset1:10
    ds_read2st64_b64 v[140:143], v8 offset0:12 offset1:14
    s_mov_b32 s72, 0x05040100
    s_mov_b32 s73, 0x07060302
    s_waitcnt lgkmcnt(3)
    v_perm_b32 v144, v130, v128, s72
    v_perm_b32 v148, v130, v128, s73
    v_perm_b32 v152, v131, v129, s72
    v_perm_b32 v156, v131, v129, s73
    s_waitcnt lgkmcnt(2)
    v_perm_b32 v145, v134, v132, s72
    v_perm_b32 v149, v134, v132, s73
    v_perm_b32 v153, v135, v133, s72
    v_perm_b32 v157, v135, v133, s73
    s_waitcnt lgkmcnt(1)
    v_perm_b32 v146, v138, v136, s72
    v_perm_b32 v150, v138, v136, s73
    v_perm_b32 v154, v139, v137, s72
    v_perm_b32 v158, v139, v137, s73
    s_waitcnt lgkmcnt(0)
    v_perm_b32 v147, v142, v140, s72
    v_perm_b32 v151, v142, v140, s73
    v_perm_b32 v155, v143, v141, s72
    v_perm_b32 v159, v143, v141, s73
    v_mov_b32 v64, 0
    v_mov_b32 v65, 0
    v_mov_b32 v66, 0
    v_mov_b32 v67, 0
    v_mov_b32 v68, 0
    v_mov_b32 v69, 0
    v_mov_b32 v70, 0
    v_mov_b32 v71, 0
    v_mov_b32 v72, 0
    v_mov_b32 v73, 0
    v_mov_b32 v74, 0
    v_mov_b32 v75, 0
    v_mov_b32 v76, 0
    v_mov_b32 v77, 0
    v_mov_b32 v78, 0
    v_mov_b32 v79, 0
    v_mov_b32 v80, 0
    v_mov_b32 v81, 0
    v_mov_b32 v82, 0
    v_mov_b32 v83, 0
    v_mov_b32 v84, 0
    v_mov_b32 v85, 0
    v_mov_b32 v86, 0
    v_mov_b32 v87, 0
    v_mov_b32 v88, 0
    v_mov_b32 v89, 0
    v_mov_b32 v90, 0
    v_mov_b32 v91, 0
    v_mov_b32 v92, 0
    v_mov_b32 v93, 0
    v_mov_b32 v94, 0
    v_mov_b32 v95, 0
    s_lshl_b32 s54, s3, 12
    v_add_u32 v8, s54, v2
    v_lshrrev_b32 v9, 1, v0
    v_lshlrev_b32 v10, 11, v9
    s_lshl_b32 s49, s44, 3
    v_mul_u32_u24 v5, 1280, v9
    s_mov_b32 s48, 0
    s_mov_b32 s53, 200000
    s_mov_b32 s55, 0xffc00000
    s_mul_i32 s52, s3, 7168
    s_add_u32 s52, s52, 101376
    s_movk_i32 s98, 4096
    s_waitcnt vmcnt(0)
    s_barrier
    buffer_load_dwordx2 v[206:207], v10, s[20:23], s49 offen sc1
    ds_write_b128 v8, v[144:147] offset:46080
    ds_write_b128 v8, v[148:151] offset:47104
    ds_write_b128 v8, v[152:155] offset:48128
    ds_write_b128 v8, v[156:159] offset:49152
    s_waitcnt vmcnt(0)
    v_xor_b32 v11, s63, v206
    v_xor_b32 v12, s62, v207
    v_and_or_b32 v11, v11, s55, v12
    v_cmpx_ne_u32 vcc, 0, v11
    s_cbranch_execnz L_poll
L_polled:
    s_mov_b64 exec, -1
    v_bfe_u32 v3, v206, 11, 11
    v_and_b32 v4, v3, v240
    v_add_u32 v10, v3, v240
    v_and_b32 v11, 0x7ff, v206
    v_add_u32_dpp v4, v4, v4 row_shr:1 row_mask:0xf bank_mask:0xf
    v_cmp_lt_i32 s[64:65], 0, v10
    v_cmp_lt_i32 s[66:67], 2, v10
    v_add_u32_dpp v4, v4, v4 row_shr:2 row_mask:0xf bank_mask:0xf
    v_cmp_lt_i32 s[68:69], 4, v10
    v_cmp_lt_i32 s[70:71], 6, v10
    v_add_u32_dpp v4, v4, v4 row_shr:4 row_mask:0xf bank_mask:0xf
    v_cmp_lt_i32 s[72:73], 8, v10
    v_cmp_lt_i32 s[74:75], 10, v10
    v_add_u32_dpp v4, v4, v4 row_shr:8 row_mask:0xf bank_mask:0xf
    v_cmp_lt_i32 s[76:77], 12, v10
    v_cmp_lt_i32 s[78:79], 14, v10
    v_add_u32_dpp v4, v4, v4 row_bcast:15 row_mask:0xa bank_mask:0xf
    v_add_u32 v5, v5, v11
    s_nop 0
    v_add_u32_dpp v4, v4, v4 row_bcast:31 row_mask:0xc bank_mask:0xf
    s_nop 0
    v_readlane_b32 s95, v4, 63
    v_mov_b32_dpp v4, v4 quad_perm:[0,0,2,2] row_mask:0xf bank_mask:0xf
    v_sub_u32 v5, v5, v4
    v_lshl_add_u32 v8, v4, 2, v241
    s_cmp_gt_u32 s95, 224
    s_cbranch_scc1 L_clip
L_mapw:
    s_mov_b64 exec, s[64:65]
    ds_write_b32 v8, v5 offset:0
    s_mov_b64 exec, s[66:67]
    ds_write_b32 v8, v5 offset:8
    s_mov_b64 exec, s[68:69]
    ds_write_b32 v8, v5 offset:16
    s_mov_b64 exec, s[70:71]
    ds_write_b32 v8, v5 offset:24
    s_mov_b64 exec, s[72:73]
    ds_write_b32 v8, v5 offset:32
    s_mov_b64 exec, s[74:75]
    ds_write_b32 v8, v5 offset:40
    s_mov_b64 exec, s[76:77]
    ds_write_b32 v8, v5 offset:48
    s_mov_b64 exec, -1
    s_cmp_lg_u64 s[78:79], 0
    s_cbranch_scc1 L_map2
    ds_read_b32 v136, v242 offset:0
    ds_read_b32 v137, v242 offset:256
    ds_read_b32 v138, v242 offset:512
    ds_read_b32 v140, v243 offset:0
    ds_read_b32 v141, v243 offset:128
    ds_read_b32 v142, v243 offset:256
    ds_read_b32 v143, v243 offset:384
    ds_read_b32 v144, v243 offset:512
    ds_read_b32 v145, v243 offset:640
    s_cmp_gt_i32 s95, 192
    s_cbranch_scc1 L_r1
L_r1b:
    s_waitcnt lgkmcnt(6)
    v_mad_u32_u24 v136, v136, 12, v244
    buffer_load_dwordx3 v[148:150], v136, s[24:27], 0 offen offset:0 sc1
    v_mad_u32_u24 v137, v137, 12, v244
    buffer_load_dwordx3 v[152:154], v137, s[24:27], 0 offen offset:768 sc1
    v_mad_u32_u24 v138, v138, 12, v244
    buffer_load_dwordx3 v[156:158], v138, s[24:27], 0 offen offset:1536 sc1
    v_mov_b32 v11, s95
    s_mov_b64 exec, 1
    ds_max_i32 v13, v11 offset:15360
    s_mov_b64 exec, -1
    s_waitcnt lgkmcnt(1)
    v_lshl_add_u32 v140, v140, 5, v2
    v_lshl_add_u32 v141, v141, 5, v2
    v_lshl_add_u32 v142, v142, 5, v2
    v_lshl_add_u32 v143, v143, 5, v2
    v_lshl_add_u32 v144, v144, 5, v2
    v_lshl_add_u32 v145, v145, 5, v2
    s_barrier
    s_add_u32 m0, s52, 0
    s_nop 0
    buffer_load_dwordx4 v140, s[28:31], 0 offen offset:0 sc1 lds
    buffer_load_dwordx4 v141, s[28:31], 0 offen offset:1024 sc1 lds
    s_min_i32 s54, s95, 224
    v_cmp_gt_i32 s[80:81], s54, v1
    s_sub_i32 s54, s54, 64
    v_cmp_gt_i32 s[82:83], s54, v1
    s_sub_i32 s54, s54, 64
    v_cmp_gt_i32 s[84:85], s54, v1
    s_sub_i32 s54, s54, 64
    v_cmp_gt_i32 s[96:97], s54, v1
    s_sub_i32 s54, s54, 64
    s_mov_b32 s55, 0x1fff80
    s_mul_i32 s61, s3, 5
    ds_read_b128 v[216:219], v215 offset:0
    ds_read_b128 v[220:223], v215 offset:1024
    ds_read_b128 v[224:227], v215 offset:2048
    ds_read_b128 v[228:231], v215 offset:3072
    ds_read_b128 v[232:235], v215 offset:4096
    ds_read_b128 v[236:239], v215 offset:5120
    s_waitcnt vmcnt(4)
    v_lshrrev_b32 v132, 21, v150
    v_lshlrev_b32 v132, 2, v132
    v_lshrrev_b32 v11, 26, v150
    v_lshl_or_b32 v11, v11, 4, v245
    s_mov_b64 exec, s[80:81]
    ds_add_rtn_u32 v128, v132, v6 offset:8192
    ds_add_u32 v11, v6 offset:14336
    s_mov_b64 exec, -1
    s_waitcnt vmcnt(3)
    v_lshrrev_b32 v133, 21, v154
    v_lshlrev_b32 v133, 2, v133
    v_lshrrev_b32 v11, 26, v154
    v_lshl_or_b32 v11, v11, 4, v245
    s_mov_b64 exec, s[82:83]
    ds_add_rtn_u32 v129, v133, v6 offset:8192
    ds_add_u32 v11, v6 offset:14336
    s_mov_b64 exec, -1
    s_waitcnt vmcnt(2)
    v_lshrrev_b32 v134, 21, v158
    v_lshlrev_b32 v134, 2, v134
    v_lshrrev_b32 v11, 26, v158
    v_lshl_or_b32 v11, v11, 4, v245
    s_mov_b64 exec, s[84:85]
    ds_add_rtn_u32 v130, v134, v6 offset:8192
    ds_add_u32 v11, v6 offset:14336
    s_mov_b64 exec, -1
    s_cmp_gt_i32 s95, 192
    s_cbranch_scc1 L_r2
L_r2b:
    buffer_load_dwordx4 v142, s[28:31], 0 offen offset:2048 sc1 lds
    s_add_u32 s65, s61, 1
    s_add_u32 s66, s61, 2
    s_add_u32 s67, s61, 3
    s_add_u32 s68, s61, 4
    s_waitcnt lgkmcnt(0)
    s_barrier
    s_cmp_lg_u32 s48, 0
    s_cbranch_scc1 L_rank2
    ds_read_b128 v[104:107], v2 offset:14336
    ds_read_b32 v96, v248 offset:8192
    ds_read_b32 v97, v248 offset:8320
    ds_read_b32 v98, v248 offset:8448
    ds_read_b32 v99, v248 offset:8576
    ds_read_b32 v100, v248 offset:8704
    ds_read_b32 v14, v13 offset:15360
    ds_write_b64 v246, v[148:149] offset:0
    v_and_or_b32 v150, v150, s55, v247
    ds_write_b64 v246, v[152:153] offset:512
    v_and_or_b32 v154, v154, s55, v247
    v_add_u32 v154, 134217728, v154
    ds_write_b64 v246, v[156:157] offset:1024
    v_and_or_b32 v158, v158, s55, v247
    v_add_u32 v158, 268435456, v158
    s_waitcnt lgkmcnt(9)
    v_add_u32 v9, v104, v105
    v_add3_u32 v9, v9, v106, v107
    v_lshl_or_b32 v9, v9, 6, v249
    s_nop 0
    v_readlane_b32 s64, v9, s61
    v_readlane_b32 s65, v9, s65
    v_readlane_b32 s66, v9, s66
    v_readlane_b32 s67, v9, s67
    v_readlane_b32 s68, v9, s68
    v_cmp_lt_u32 s[70:71], s64, v9
    v_cmp_lt_u32 s[72:73], s65, v9
    v_cmp_lt_u32 s[74:75], s66, v9
    v_cmp_lt_u32 s[76:77], s67, v9
    v_cmp_lt_u32 s[78:79], s68, v9
    s_bcnt1_i32_b64 s64, s[70:71]
    s_bcnt1_i32_b64 s65, s[72:73]
    s_bcnt1_i32_b64 s66, s[74:75]
    s_bcnt1_i32_b64 s67, s[76:77]
    s_bcnt1_i32_b64 s68, s[78:79]
    s_waitcnt lgkmcnt(3)
    v_readlane_b32 s90, v203, s64
    v_readlane_b32 s91, v203, s65
    v_readlane_b32 s92, v203, s66
    v_readlane_b32 s93, v203, s67
    v_readlane_b32 s94, v203, s68
    v_readfirstlane_b32 s47, v14
L_ranked:
    s_mov_b32 exec_hi, 0
    v_and_or_b32 v104, s90, v253, v250
    ds_add_rtn_u32 v96, v104, v96 offset:13312
    v_and_or_b32 v105, s91, v253, v250
    ds_add_rtn_u32 v97, v105, v97 offset:13312
    v_and_or_b32 v106, s92, v253, v250
    ds_add_rtn_u32 v98, v106, v98 offset:13312
    v_and_or_b32 v107, s93, v253, v250
    ds_add_rtn_u32 v99, v107, v99 offset:13312
    v_and_or_b32 v108, s94, v253, v250
    ds_add_rtn_u32 v100, v108, v100 offset:13312
    v_or_b32 v104, s90, v250
    v_or_b32 v105, s91, v250
    v_or_b32 v106, s92, v250
    v_or_b32 v107, s93, v250
    v_or_b32 v108, s94, v250
    s_lshl_b32 s54, s3, 3
    s_add_u32 s61, s54, 7
    s_waitcnt lgkmcnt(3)
    v_lshl_or_b32 v96, v96, 16, v104
    ds_write_b32 v248, v96 offset:8192
    v_lshl_or_b32 v97, v97, 16, v105
    ds_write_b32 v248, v97 offset:8320
    s_waitcnt lgkmcnt(2)
    v_lshl_or_b32 v98, v98, 16, v106
    ds_write_b32 v248, v98 offset:8448
    v_lshl_or_b32 v99, v99, 16, v107
    ds_write_b32 v248, v99 offset:8576
    v_lshl_or_b32 v100, v100, 16, v108
    ds_write_b32 v248, v100 offset:8704
    s_mov_b32 exec_hi, -1
    buffer_load_dwordx4 v143, s[28:31], 0 offen offset:3072 sc1 lds
    s_add_u32 m0, s52, 4096
    s_nop 0
    buffer_load_dwordx4 v144, s[28:31], s98 offen offset:0 sc1 lds
    s_waitcnt lgkmcnt(0)
    s_barrier
    ds_read_b128 v[96:99], v2 offset:13312
    ds_read_b32 v132, v132 offset:8192
    ds_read_b32 v133, v133 offset:8192
    ds_read_b32 v134, v134 offset:8192
    s_waitcnt lgkmcnt(3)
    v_add_u32 v9, v96, v97
    v_add3_u32 v9, v9, v98, v99
    v_mov_b32 v10, v9
    s_waitcnt lgkmcnt(0)
    v_bfe_u32 v15, v132, 12, 3
    v_add_u32_dpp v10, v10, v10 row_shr:1 row_mask:0xf bank_mask:0xf
    v_or_b32 v150, v15, v150
    v_and_b32 v136, 0x3ff, v132
    v_add_u32_dpp v10, v10, v10 row_shr:2 row_mask:0xf bank_mask:0xf
    v_lshrrev_b32 v132, 16, v132
    v_add_u32 v132, v132, v128
    v_add_u32_dpp v10, v10, v10 row_shr:4 row_mask:0xf bank_mask:0xf
    v_bfe_u32 v15, v133, 12, 3
    v_or_b32 v154, v15, v154
    v_add_u32_dpp v10, v10, v10 row_shr:8 row_mask:0xf bank_mask:0xf
    v_and_b32 v137, 0x3ff, v133
    v_lshrrev_b32 v133, 16, v133
    v_add_u32_dpp v10, v10, v10 row_bcast:15 row_mask:0xa bank_mask:0xf
    v_add_u32 v133, v133, v129
    v_bfe_u32 v15, v134, 12, 3
    v_add_u32_dpp v10, v10, v10 row_bcast:31 row_mask:0xc bank_mask:0xf
    v_or_b32 v158, v15, v158
    v_and_b32 v138, 0x3ff, v134
    v_sub_u32 v9, v10, v9
    v_lshl_add_u32 v104, v9, 2, v252
    v_lshl_add_u32 v105, v96, 2, v104
    v_lshl_add_u32 v106, v97, 2, v105
    v_lshl_add_u32 v107, v98, 2, v106
    ds_write_b128 v2, v[104:107] offset:16384
    ds_read_b32 v136, v136 offset:16384
    ds_read_b32 v137, v137 offset:16384
    ds_read_b32 v138, v138 offset:16384
    v_lshrrev_b32 v134, 16, v134
    v_add_u32 v134, v134, v130
    v_readlane_b32 s50, v10, s61
    v_readlane_b32 s53, v9, s54
    v_readlane_b32 s51, v104, s54
    v_mov_b32 v14, 2097029
    s_sub_u32 s50, s50, s53
    s_lshl2_add_u32 s55, s50, s51
    v_add_u32 v9, s55, v201
    ds_write_b32 v9, v14
    s_add_u32 s53, s50, 15
    s_lshr_b32 s53, s53, 4
    s_sub_u32 s54, 0, s50
    s_and_b32 s54, s54, 14
    s_sub_u32 s53, s53, 1
    s_cmp_gt_i32 s53, 0
    s_cselect_b32 s54, s54, 0
    s_lshl_b32 s61, s54, 2
    s_sub_u32 s51, s51, s61
    s_waitcnt lgkmcnt(1)
    v_lshl_add_u32 v132, v132, 2, v136
    v_lshl_add_u32 v133, v133, 2, v137
    v_lshl_add_u32 v134, v134, 2, v138
    s_mov_b64 exec, s[80:81]
    ds_write_b32 v132, v150
    s_mov_b64 exec, s[82:83]
    ds_write_b32 v133, v154
    s_mov_b64 exec, s[84:85]
    ds_write_b32 v134, v158
    s_mov_b64 exec, -1
    s_cmp_gt_i32 s95, 192
    s_cbranch_scc1 L_r3
L_r3b:
    buffer_load_dwordx4 v145, s[28:31], s98 offen offset:1024 sc1 lds
    v_add_u32 v198, s51, v201
    v_add_u32 v199, s51, v202
    s_and_b32 s61, s61, 32
    v_add_u32 v12, s61, v198
    s_and_b32 s72, s54, 6
    s_mov_b32 s55, 0x00fffc38
    s_mov_b32 s49, 0xffffff00
    s_mov_b32 s51, 87040
    s_cmp_lt_u32 s3, 4
    s_cbranch_scc1 L_np
    s_setprio 1
L_np:
    s_waitcnt lgkmcnt(0)
    s_barrier
    ds_read_b32 v196, v12
    ds_read_b32 v194, v199
    ds_read_b32 v197, v198 offset:24
    ds_read_b32 v205, v251 offset:8192
    s_cmp_eq_u32 s50, 0
    s_cbranch_scc1 L_empty
    s_waitcnt lgkmcnt(3)
    v_lshlrev_b32 v196, 3, v196
    v_and_b32 v196, s55, v196
    s_cmp_eq_u32 s72, 2
    s_cbranch_scc1 L_p2
    s_cmp_eq_u32 s72, 4
    s_cbranch_scc1 L_p4
    s_cmp_eq_u32 s72, 6
    s_cbranch_scc1 L_p6
L_p0:
    v_readlane_b32 s64, v196, 0
    v_readlane_b32 s65, v196, 1
    s_and_b32 s61, s64, s49
    buffer_load_dwordx4 v[96:99], v2, s[16:19], s61 offen
    s_and_b32 s61, s65, s49
    buffer_load_dwordx4 v[100:103], v2, s[16:19], s61 offen
    s_waitcnt vmcnt(2) lgkmcnt(0)
    s_barrier
    v_lshrrev_b32 v8, 21, v194
    v_lshl_add_u32 v11, v8, 3, s51
    v_lshl_add_u32 v8, v8, 5, v200
    ds_read_b64 v[192:193], v11
    ds_read_b128 v[164:167], v8
    v_readlane_b32 s66, v196, 2
    v_readlane_b32 s67, v196, 3
    s_and_b32 s61, s66, s49
    buffer_load_dwordx4 v[104:107], v2, s[16:19], s61 offen
    s_and_b32 s61, s67, s49
    buffer_load_dwordx4 v[108:111], v2, s[16:19], s61 offen
    v_readlane_b32 s68, v196, 4
    v_readlane_b32 s69, v196, 5
    s_and_b32 s61, s68, s49
    buffer_load_dwordx4 v[112:115], v2, s[16:19], s61 offen
    s_and_b32 s61, s69, s49
    buffer_load_dwordx4 v[116:119], v2, s[16:19], s61 offen
    s_branch L_pd
L_p2:
    v_readlane_b32 s66, v196, 2
    v_readlane_b32 s67, v196, 3
    s_and_b32 s61, s66, s49
    buffer_load_dwordx4 v[104:107], v2, s[16:19], s61 offen
    s_and_b32 s61, s67, s49
    buffer_load_dwordx4 v[108:111], v2, s[16:19], s61 offen
    s_waitcnt vmcnt(2) lgkmcnt(0)
    s_barrier
    v_lshrrev_b32 v8, 21, v194
    v_lshl_add_u32 v11, v8, 3, s51
    v_lshl_add_u32 v8, v8, 5, v200
    ds_read_b64 v[192:193], v11
    ds_read_b128 v[164:167], v8
    v_readlane_b32 s68, v196, 4
    v_readlane_b32 s69, v196, 5
    s_and_b32 s61, s68, s49
    buffer_load_dwordx4 v[112:115], v2, s[16:19], s61 offen
    s_and_b32 s61, s69, s49
    buffer_load_dwordx4 v[116:119], v2, s[16:19], s61 offen
    v_readlane_b32 s70, v196, 6
    v_readlane_b32 s71, v196, 7
    s_and_b32 s61, s70, s49
    buffer_load_dwordx4 v[120:123], v2, s[16:19], s61 offen
    s_and_b32 s61, s71, s49
    buffer_load_dwordx4 v[124:127], v2, s[16:19], s61 offen
    s_branch L_pd
L_p4:
    v_readlane_b32 s68, v196, 4
    v_readlane_b32 s69, v196, 5
    s_and_b32 s61, s68, s49
    buffer_load_dwordx4 v[112:115], v2, s[16:19], s61 offen
    s_and_b32 s61, s69, s49
    buffer_load_dwordx4 v[116:119], v2, s[16:19], s61 offen
    s_waitcnt vmcnt(2) lgkmcnt(0)
    s_barrier
    v_lshrrev_b32 v8, 21, v194
    v_lshl_add_u32 v11, v8, 3, s51
    v_lshl_add_u32 v8, v8, 5, v200
    ds_read_b64 v[192:193], v11
    ds_read_b128 v[164:167], v8
    v_readlane_b32 s70, v196, 6
    v_readlane_b32 s71, v196, 7
    s_and_b32 s61, s70, s49
    buffer_load_dwordx4 v[120:123], v2, s[16:19], s61 offen
    s_and_b32 s61, s71, s49
    buffer_load_dwordx4 v[124:127], v2, s[16:19], s61 offen
    v_readlane_b32 s64, v196, 8
    v_readlane_b32 s65, v196, 9
    s_and_b32 s61, s64, s49
    buffer_load_dwordx4 v[96:99], v2, s[16:19], s61 offen
    s_and_b32 s61, s65, s49
    buffer_load_dwordx4 v[100:103], v2, s[16:19], s61 offen
    s_branch L_pd
L_p6:
    v_readlane_b32 s70, v196, 6
    v_readlane_b32 s71, v196, 7
    s_and_b32 s61, s70, s49
    buffer_load_dwordx4 v[120:123], v2, s[16:19], s61 offen
    s_and_b32 s61, s71, s49
    buffer_load_dwordx4 v[124:127], v2, s[16:19], s61 offen
    s_waitcnt vmcnt(2) lgkmcnt(0)
    s_barrier
    v_lshrrev_b32 v8, 21, v194
    v_lshl_add_u32 v11, v8, 3, s51
    v_lshl_add_u32 v8, v8, 5, v200
    ds_read_b64 v[192:193], v11
    ds_read_b128 v[164:167], v8
    v_readlane_b32 s64, v196, 8
    v_readlane_b32 s65, v196, 9
    s_and_b32 s61, s64, s49
    buffer_load_dwordx4 v[96:99], v2, s[16:19], s61 offen
    s_and_b32 s61, s65, s49
    buffer_load_dwordx4 v[100:103], v2, s[16:19], s61 offen
    v_readlane_b32 s66, v196, 10
    v_readlane_b32 s67, v196, 11
    s_and_b32 s61, s66, s49
    buffer_load_dwordx4 v[104:107], v2, s[16:19], s61 offen
    s_and_b32 s61, s67, s49
    buffer_load_dwordx4 v[108:111], v2, s[16:19], s61 offen
L_pd:
    s_waitcnt lgkmcnt(0)
    v_mfma_f32_4x4x4_16b_bf16 v[144:147], v[192:193], v[188:189], 0 cbsz:4 abid:0
    v_mfma_f32_4x4x4_16b_bf16 v[148:151], v[192:193], v[188:189], 0 cbsz:4 abid:2
    v_mfma_f32_4x4x4_16b_bf16 v[152:155], v[192:193], v[188:189], 0 cbsz:4 abid:4
    v_mfma_f32_4x4x4_16b_bf16 v[156:159], v[192:193], v[188:189], 0 cbsz:4 abid:6
    v_lshlrev_b32 v196, 3, v197
    v_and_b32 v196, s55, v196
    v_add_u32 v198, 64, v198
    v_add_u32 v199, 64, v199
    v_smfmac_f32_32x32x32_bf16 v[64:79], v[164:167], v[172:179], v168
    ds_read_b32 v197, v198 offset:24
    ds_read_b32 v194, v199
    v_smfmac_f32_32x32x32_bf16 v[80:95], v[164:167], v[180:187], v168
    s_set_gpr_idx_on s54, gpr_idx(SRC0,SRC1)
    v_cvt_pk_bf16_f32 v9, v144, v145
    s_set_gpr_idx_off
    v_perm_b32 v160, v9, v9, v190
    v_perm_b32 v161, v9, v9, v191
    s_waitcnt lgkmcnt(0)
    v_lshrrev_b32 v8, 21, v194
    v_lshl_add_u32 v11, v8, 3, s51
    v_lshl_add_u32 v8, v8, 5, v200
    ds_read_b64 v[192:193], v11
    ds_read_b128 v[164:167], v8
    s_cmp_eq_u32 s53, 0
    s_cbranch_scc1 L_f0
    s_cmp_eq_u32 s54, 0
    s_cbranch_scc1 L_j0
    s_cmp_eq_u32 s54, 2
    s_cbranch_scc1 L_j2
    ds_read_b128 v[64:67], v169
    ds_read_b128 v[80:83], v169
    s_cmp_eq_u32 s54, 4
    s_cbranch_scc1 L_j4
    s_cmp_eq_u32 s54, 6
    s_cbranch_scc1 L_j6
    ds_read_b128 v[68:71], v169
    ds_read_b128 v[84:87], v169
    s_cmp_eq_u32 s54, 8
    s_cbranch_scc1 L_j8
    s_cmp_eq_u32 s54, 10
    s_cbranch_scc1 L_j10
    ds_read_b128 v[72:75], v169
    ds_read_b128 v[88:91], v169
    s_cmp_eq_u32 s54, 12
    s_cbranch_scc1 L_j12
    s_branch L_j14
.p2align 3
L_loop:
    s_waitcnt lgkmcnt(2)
    v_mfma_f32_4x4x4_16b_bf16 v[144:147], v[192:193], v[188:189], 0 cbsz:4 abid:0
    v_mfma_f32_4x4x4_16b_bf16 v[148:151], v[192:193], v[188:189], 0 cbsz:4 abid:2
    v_mfma_f32_4x4x4_16b_bf16 v[152:155], v[192:193], v[188:189], 0 cbsz:4 abid:4
    v_mfma_f32_4x4x4_16b_bf16 v[156:159], v[192:193], v[188:189], 0 cbsz:4 abid:6
    v_lshlrev_b32 v196, 3, v197
    v_and_b32 v196, s55, v196
    v_add_u32 v198, 64, v198
    v_add_u32 v199, 64, v199
    s_waitcnt lgkmcnt(0)
    v_smfmac_f32_32x32x32_bf16 v[64:79], v[164:167], v[172:179], v168
    ds_read_b32 v197, v198 offset:24
    ds_read_b32 v194, v199
    v_cvt_pk_bf16_f32 v9, v144, v145
    v_perm_b32 v160, v9, v9, v190
    v_perm_b32 v161, v9, v9, v191
    v_smfmac_f32_32x32x32_bf16 v[80:95], v[164:167], v[180:187], v168
L_j0:
    s_waitcnt vmcnt(5)
    v_mfma_f32_16x16x16_bf16 v[128:131], v[160:161], v[96:97], 0
    v_readlane_b32 s70, v196, 0
    v_perm_b32 v162, v9, v9, v254
    v_mfma_f32_16x16x16_bf16 v[132:135], v[160:161], v[98:99], 0
    v_perm_b32 v163, v9, v9, v255
    s_and_b32 s61, s70, s49
    s_waitcnt vmcnt(4)
    buffer_load_dwordx4 v[120:123], v2, s[16:19], s61 offen
    v_mfma_f32_16x16x16_bf16 v[136:139], v[162:163], v[100:101], 0
    v_readlane_b32 s71, v196, 1
    v_cvt_pk_bf16_f32 v9, v146, v147
    v_mfma_f32_16x16x16_bf16 v[140:143], v[162:163], v[102:103], 0
    v_perm_b32 v160, v9, v9, v190
    v_perm_b32 v161, v9, v9, v191
    s_and_b32 s61, s71, s49
    s_set_gpr_idx_on s64, gpr_idx(SRC2,DST)
    buffer_load_dwordx4 v[124:127], v2, s[16:19], s61 offen
    v_pk_fma_f32 v[16:17], v[128:129], v[64:65], v[16:17] op_sel_hi:[1,0,1]
    v_pk_fma_f32 v[18:19], v[130:131], v[64:65], v[18:19] op_sel_hi:[1,0,1]
    v_pk_fma_f32 v[20:21], v[132:133], v[80:81], v[20:21] op_sel_hi:[1,0,1]
    v_pk_fma_f32 v[22:23], v[134:135], v[80:81], v[22:23] op_sel_hi:[1,0,1]
    s_set_gpr_idx_idx s65
    v_pk_fma_f32 v[16:17], v[136:137], v[64:65], v[16:17] op_sel:[0,1,0] op_sel_hi:[1,1,1]
    v_pk_fma_f32 v[18:19], v[138:139], v[64:65], v[18:19] op_sel:[0,1,0] op_sel_hi:[1,1,1]
    v_pk_fma_f32 v[20:21], v[140:141], v[80:81], v[20:21] op_sel:[0,1,0] op_sel_hi:[1,1,1]
    v_pk_fma_f32 v[22:23], v[142:143], v[80:81], v[22:23] op_sel:[0,1,0] op_sel_hi:[1,1,1]
    s_set_gpr_idx_off
L_j2:
    s_waitcnt vmcnt(5)
    v_mfma_f32_16x16x16_bf16 v[128:131], v[160:161], v[104:105], 0
    v_readlane_b32 s64, v196, 2
    v_perm_b32 v162, v9, v9, v254
    v_mfma_f32_16x16x16_bf16 v[132:135], v[160:161], v[106:107], 0
    v_perm_b32 v163, v9, v9, v255
    s_and_b32 s61, s64, s49
    s_waitcnt vmcnt(4)
    buffer_load_dwordx4 v[96:99], v2, s[16:19], s61 offen
    v_mfma_f32_16x16x16_bf16 v[136:139], v[162:163], v[108:109], 0
    v_readlane_b32 s65, v196, 3
    v_cvt_pk_bf16_f32 v9, v148, v149
    v_mfma_f32_16x16x16_bf16 v[140:143], v[162:163], v[110:111], 0
    v_perm_b32 v160, v9, v9, v190
    v_perm_b32 v161, v9, v9, v191
    s_waitcnt lgkmcnt(0)
    v_lshrrev_b32 v8, 21, v194
    v_lshl_add_u32 v11, v8, 3, s51
    v_lshl_add_u32 v8, v8, 5, v200
    ds_read_b64 v[192:193], v11
    ds_read_b128 v[164:167], v8
    s_and_b32 s61, s65, s49
    s_set_gpr_idx_on s66, gpr_idx(SRC2,DST)
    buffer_load_dwordx4 v[100:103], v2, s[16:19], s61 offen
    v_pk_fma_f32 v[16:17], v[128:129], v[66:67], v[16:17] op_sel_hi:[1,0,1]
    v_pk_fma_f32 v[18:19], v[130:131], v[66:67], v[18:19] op_sel_hi:[1,0,1]
    v_pk_fma_f32 v[20:21], v[132:133], v[82:83], v[20:21] op_sel_hi:[1,0,1]
    v_pk_fma_f32 v[22:23], v[134:135], v[82:83], v[22:23] op_sel_hi:[1,0,1]
    s_set_gpr_idx_idx s67
    v_pk_fma_f32 v[16:17], v[136:137], v[66:67], v[16:17] op_sel:[0,1,0] op_sel_hi:[1,1,1]
    v_pk_fma_f32 v[18:19], v[138:139], v[66:67], v[18:19] op_sel:[0,1,0] op_sel_hi:[1,1,1]
    v_pk_fma_f32 v[20:21], v[140:141], v[82:83], v[20:21] op_sel:[0,1,0] op_sel_hi:[1,1,1]
    v_pk_fma_f32 v[22:23], v[142:143], v[82:83], v[22:23] op_sel:[0,1,0] op_sel_hi:[1,1,1]
    ds_read_b128 v[64:67], v169
    ds_read_b128 v[80:83], v169
    s_set_gpr_idx_off
L_j4:
    s_waitcnt vmcnt(5)
    v_mfma_f32_16x16x16_bf16 v[128:131], v[160:161], v[112:113], 0
    v_readlane_b32 s66, v196, 4
    v_perm_b32 v162, v9, v9, v254
    v_mfma_f32_16x16x16_bf16 v[132:135], v[160:161], v[114:115], 0
    v_perm_b32 v163, v9, v9, v255
    s_and_b32 s61, s66, s49
    s_waitcnt vmcnt(4)
    buffer_load_dwordx4 v[104:107], v2, s[16:19], s61 offen
    v_mfma_f32_16x16x16_bf16 v[136:139], v[162:163], v[116:117], 0
    v_readlane_b32 s67, v196, 5
    v_cvt_pk_bf16_f32 v9, v150, v151
    v_mfma_f32_16x16x16_bf16 v[140:143], v[162:163], v[118:119], 0
    v_perm_b32 v160, v9, v9, v190
    v_perm_b32 v161, v9, v9, v191
    s_and_b32 s61, s67, s49
    s_set_gpr_idx_on s68, gpr_idx(SRC2,DST)
    buffer_load_dwordx4 v[108:111], v2, s[16:19], s61 offen
    v_pk_fma_f32 v[16:17], v[128:129], v[68:69], v[16:17] op_sel_hi:[1,0,1]
    v_pk_fma_f32 v[18:19], v[130:131], v[68:69], v[18:19] op_sel_hi:[1,0,1]
    v_pk_fma_f32 v[20:21], v[132:133], v[84:85], v[20:21] op_sel_hi:[1,0,1]
    v_pk_fma_f32 v[22:23], v[134:135], v[84:85], v[22:23] op_sel_hi:[1,0,1]
    s_set_gpr_idx_idx s69
    v_pk_fma_f32 v[16:17], v[136:137], v[68:69], v[16:17] op_sel:[0,1,0] op_sel_hi:[1,1,1]
    v_pk_fma_f32 v[18:19], v[138:139], v[68:69], v[18:19] op_sel:[0,1,0] op_sel_hi:[1,1,1]
    v_pk_fma_f32 v[20:21], v[140:141], v[84:85], v[20:21] op_sel:[0,1,0] op_sel_hi:[1,1,1]
    v_pk_fma_f32 v[22:23], v[142:143], v[84:85], v[22:23] op_sel:[0,1,0] op_sel_hi:[1,1,1]
    s_set_gpr_idx_off
L_j6:
    s_waitcnt vmcnt(5)
    v_mfma_f32_16x16x16_bf16 v[128:131], v[160:161], v[120:121], 0
    v_readlane_b32 s68, v196, 6
    v_perm_b32 v162, v9, v9, v254
    v_mfma_f32_16x16x16_bf16 v[132:135], v[160:161], v[122:123], 0
    v_perm_b32 v163, v9, v9, v255
    s_and_b32 s61, s68, s49
    s_waitcnt vmcnt(4)
    buffer_load_dwordx4 v[112:115], v2, s[16:19], s61 offen
    v_mfma_f32_16x16x16_bf16 v[136:139], v[162:163], v[124:125], 0
    v_readlane_b32 s69, v196, 7
    v_cvt_pk_bf16_f32 v9, v152, v153
    v_mfma_f32_16x16x16_bf16 v[140:143], v[162:163], v[126:127], 0
    v_perm_b32 v160, v9, v9, v190
    v_perm_b32 v161, v9, v9, v191
    s_and_b32 s61, s69, s49
    s_set_gpr_idx_on s70, gpr_idx(SRC2,DST)
    buffer_load_dwordx4 v[116:119], v2, s[16:19], s61 offen
    v_pk_fma_f32 v[16:17], v[128:129], v[70:71], v[16:17] op_sel_hi:[1,0,1]
    v_pk_fma_f32 v[18:19], v[130:131], v[70:71], v[18:19] op_sel_hi:[1,0,1]
    v_pk_fma_f32 v[20:21], v[132:133], v[86:87], v[20:21] op_sel_hi:[1,0,1]
    v_pk_fma_f32 v[22:23], v[134:135], v[86:87], v[22:23] op_sel_hi:[1,0,1]
    s_set_gpr_idx_idx s71
    v_pk_fma_f32 v[16:17], v[136:137], v[70:71], v[16:17] op_sel:[0,1,0] op_sel_hi:[1,1,1]
    v_pk_fma_f32 v[18:19], v[138:139], v[70:71], v[18:19] op_sel:[0,1,0] op_sel_hi:[1,1,1]
    v_pk_fma_f32 v[20:21], v[140:141], v[86:87], v[20:21] op_sel:[0,1,0] op_sel_hi:[1,1,1]
    v_pk_fma_f32 v[22:23], v[142:143], v[86:87], v[22:23] op_sel:[0,1,0] op_sel_hi:[1,1,1]
    ds_read_b128 v[68:71], v169
    ds_read_b128 v[84:87], v169
    s_set_gpr_idx_off
L_j8:
    s_waitcnt vmcnt(5)
    v_mfma_f32_16x16x16_bf16 v[128:131], v[160:161], v[96:97], 0
    v_readlane_b32 s70, v196, 8
    v_perm_b32 v162, v9, v9, v254
    v_mfma_f32_16x16x16_bf16 v[132:135], v[160:161], v[98:99], 0
    v_perm_b32 v163, v9, v9, v255
    s_and_b32 s61, s70, s49
    s_waitcnt vmcnt(4)
    buffer_load_dwordx4 v[120:123], v2, s[16:19], s61 offen
    v_mfma_f32_16x16x16_bf16 v[136:139], v[162:163], v[100:101], 0
    v_readlane_b32 s71, v196, 9
    v_cvt_pk_bf16_f32 v9, v154, v155
    v_mfma_f32_16x16x16_bf16 v[140:143], v[162:163], v[102:103], 0
    v_perm_b32 v160, v9, v9, v190
    v_perm_b32 v161, v9, v9, v191
    s_and_b32 s61, s71, s49
    s_set_gpr_idx_on s64, gpr_idx(SRC2,DST)
    buffer_load_dwordx4 v[124:127], v2, s[16:19], s61 offen
    v_pk_fma_f32 v[16:17], v[128:129], v[72:73], v[16:17] op_sel_hi:[1,0,1]
    v_pk_fma_f32 v[18:19], v[130:131], v[72:73], v[18:19] op_sel_hi:[1,0,1]
    v_pk_fma_f32 v[20:21], v[132:133], v[88:89], v[20:21] op_sel_hi:[1,0,1]
    v_pk_fma_f32 v[22:23], v[134:135], v[88:89], v[22:23] op_sel_hi:[1,0,1]
    s_set_gpr_idx_idx s65
    v_pk_fma_f32 v[16:17], v[136:137], v[72:73], v[16:17] op_sel:[0,1,0] op_sel_hi:[1,1,1]
    v_pk_fma_f32 v[18:19], v[138:139], v[72:73], v[18:19] op_sel:[0,1,0] op_sel_hi:[1,1,1]
    v_pk_fma_f32 v[20:21], v[140:141], v[88:89], v[20:21] op_sel:[0,1,0] op_sel_hi:[1,1,1]
    v_pk_fma_f32 v[22:23], v[142:143], v[88:89], v[22:23] op_sel:[0,1,0] op_sel_hi:[1,1,1]
    s_set_gpr_idx_off
L_j10:
    s_waitcnt vmcnt(5)
    v_mfma_f32_16x16x16_bf16 v[128:131], v[160:161], v[104:105], 0
    v_readlane_b32 s64, v196, 10
    v_perm_b32 v162, v9, v9, v254
    v_mfma_f32_16x16x16_bf16 v[132:135], v[160:161], v[106:107], 0
    v_perm_b32 v163, v9, v9, v255
    s_and_b32 s61, s64, s49
    s_waitcnt vmcnt(4)
    buffer_load_dwordx4 v[96:99], v2, s[16:19], s61 offen
    v_mfma_f32_16x16x16_bf16 v[136:139], v[162:163], v[108:109], 0
    v_readlane_b32 s65, v196, 11
    v_cvt_pk_bf16_f32 v9, v156, v157
    v_mfma_f32_16x16x16_bf16 v[140:143], v[162:163], v[110:111], 0
    v_perm_b32 v160, v9, v9, v190
    v_perm_b32 v161, v9, v9, v191
    s_and_b32 s61, s65, s49
    s_set_gpr_idx_on s66, gpr_idx(SRC2,DST)
    buffer_load_dwordx4 v[100:103], v2, s[16:19], s61 offen
    v_pk_fma_f32 v[16:17], v[128:129], v[74:75], v[16:17] op_sel_hi:[1,0,1]
    v_pk_fma_f32 v[18:19], v[130:131], v[74:75], v[18:19] op_sel_hi:[1,0,1]
    v_pk_fma_f32 v[20:21], v[132:133], v[90:91], v[20:21] op_sel_hi:[1,0,1]
    v_pk_fma_f32 v[22:23], v[134:135], v[90:91], v[22:23] op_sel_hi:[1,0,1]
    s_set_gpr_idx_idx s67
    v_pk_fma_f32 v[16:17], v[136:137], v[74:75], v[16:17] op_sel:[0,1,0] op_sel_hi:[1,1,1]
    v_pk_fma_f32 v[18:19], v[138:139], v[74:75], v[18:19] op_sel:[0,1,0] op_sel_hi:[1,1,1]
    v_pk_fma_f32 v[20:21], v[140:141], v[90:91], v[20:21] op_sel:[0,1,0] op_sel_hi:[1,1,1]
    v_pk_fma_f32 v[22:23], v[142:143], v[90:91], v[22:23] op_sel:[0,1,0] op_sel_hi:[1,1,1]
    ds_read_b128 v[72:75], v169
    ds_read_b128 v[88:91], v169
    s_set_gpr_idx_off
L_j12:
    s_waitcnt vmcnt(5)
    v_mfma_f32_16x16x16_bf16 v[128:131], v[160:161], v[112:113], 0
    v_readlane_b32 s66, v196, 12
    v_perm_b32 v162, v9, v9, v254
    v_mfma_f32_16x16x16_bf16 v[132:135], v[160:161], v[114:115], 0
    v_perm_b32 v163, v9, v9, v255
    s_and_b32 s61, s66, s49
    s_waitcnt vmcnt(4)
    buffer_load_dwordx4 v[104:107], v2, s[16:19], s61 offen
    v_mfma_f32_16x16x16_bf16 v[136:139], v[162:163], v[116:117], 0
    v_readlane_b32 s67, v196, 13
    v_cvt_pk_bf16_f32 v9, v158, v159
    v_mfma_f32_16x16x16_bf16 v[140:143], v[162:163], v[118:119], 0
    v_perm_b32 v160, v9, v9, v190
    v_perm_b32 v161, v9, v9, v191
    s_and_b32 s61, s67, s49
    s_set_gpr_idx_on s68, gpr_idx(SRC2,DST)
    buffer_load_dwordx4 v[108:111], v2, s[16:19], s61 offen
    v_pk_fma_f32 v[16:17], v[128:129], v[76:77], v[16:17] op_sel_hi:[1,0,1]
    v_pk_fma_f32 v[18:19], v[130:131], v[76:77], v[18:19] op_sel_hi:[1,0,1]
    v_pk_fma_f32 v[20:21], v[132:133], v[92:93], v[20:21] op_sel_hi:[1,0,1]
    v_pk_fma_f32 v[22:23], v[134:135], v[92:93], v[22:23] op_sel_hi:[1,0,1]
    s_set_gpr_idx_idx s69
    v_pk_fma_f32 v[16:17], v[136:137], v[76:77], v[16:17] op_sel:[0,1,0] op_sel_hi:[1,1,1]
    v_pk_fma_f32 v[18:19], v[138:139], v[76:77], v[18:19] op_sel:[0,1,0] op_sel_hi:[1,1,1]
    v_pk_fma_f32 v[20:21], v[140:141], v[92:93], v[20:21] op_sel:[0,1,0] op_sel_hi:[1,1,1]
    v_pk_fma_f32 v[22:23], v[142:143], v[92:93], v[22:23] op_sel:[0,1,0] op_sel_hi:[1,1,1]
    s_set_gpr_idx_off
L_j14:
    s_waitcnt vmcnt(5)
    v_mfma_f32_16x16x16_bf16 v[128:131], v[160:161], v[120:121], 0
    v_readlane_b32 s68, v196, 14
    v_perm_b32 v162, v9, v9, v254
    v_mfma_f32_16x16x16_bf16 v[132:135], v[160:161], v[122:123], 0
    v_perm_b32 v163, v9, v9, v255
    s_and_b32 s61, s68, s49
    s_waitcnt vmcnt(4)
    buffer_load_dwordx4 v[112:115], v2, s[16:19], s61 offen
    v_mfma_f32_16x16x16_bf16 v[136:139], v[162:163], v[124:125], 0
    v_readlane_b32 s69, v196, 15
    v_mfma_f32_16x16x16_bf16 v[140:143], v[162:163], v[126:127], 0
    s_and_b32 s61, s69, s49
    s_set_gpr_idx_on s70, gpr_idx(SRC2,DST)
    buffer_load_dwordx4 v[116:119], v2, s[16:19], s61 offen
    v_pk_fma_f32 v[16:17], v[128:129], v[78:79], v[16:17] op_sel_hi:[1,0,1]
    v_pk_fma_f32 v[18:19], v[130:131], v[78:79], v[18:19] op_sel_hi:[1,0,1]
    v_pk_fma_f32 v[20:21], v[132:133], v[94:95], v[20:21] op_sel_hi:[1,0,1]
    v_pk_fma_f32 v[22:23], v[134:135], v[94:95], v[22:23] op_sel_hi:[1,0,1]
    s_set_gpr_idx_idx s71
    s_sub_u32 s53, s53, 1
    v_pk_fma_f32 v[16:17], v[136:137], v[78:79], v[16:17] op_sel:[0,1,0] op_sel_hi:[1,1,1]
    v_pk_fma_f32 v[18:19], v[138:139], v[78:79], v[18:19] op_sel:[0,1,0] op_sel_hi:[1,1,1]
    v_pk_fma_f32 v[20:21], v[140:141], v[94:95], v[20:21] op_sel:[0,1,0] op_sel_hi:[1,1,1]
    v_pk_fma_f32 v[22:23], v[142:143], v[94:95], v[22:23] op_sel:[0,1,0] op_sel_hi:[1,1,1]
    ds_read_b128 v[76:79], v169
    ds_read_b128 v[92:95], v169
    s_set_gpr_idx_off
    s_cmp_lg_u32 s53, 0
    s_cbranch_scc1 L_loop
    s_waitcnt lgkmcnt(2)
    v_mfma_f32_4x4x4_16b_bf16 v[144:147], v[192:193], v[188:189], 0 cbsz:4 abid:0
    v_mfma_f32_4x4x4_16b_bf16 v[148:151], v[192:193], v[188:189], 0 cbsz:4 abid:2
    v_mfma_f32_4x4x4_16b_bf16 v[152:155], v[192:193], v[188:189], 0 cbsz:4 abid:4
    v_mfma_f32_4x4x4_16b_bf16 v[156:159], v[192:193], v[188:189], 0 cbsz:4 abid:6
    v_lshlrev_b32 v196, 3, v197
    v_and_b32 v196, s55, v196
    s_waitcnt lgkmcnt(0)
    v_smfmac_f32_32x32x32_bf16 v[64:79], v[164:167], v[172:179], v168
    v_cvt_pk_bf16_f32 v9, v144, v145
    v_perm_b32 v160, v9, v9, v190
    v_perm_b32 v161, v9, v9, v191
    v_smfmac_f32_32x32x32_bf16 v[80:95], v[164:167], v[180:187], v168
L_f0:
    s_waitcnt vmcnt(5)
    v_mfma_f32_16x16x16_bf16 v[128:131], v[160:161], v[96:97], 0
    v_readlane_b32 s70, v196, 0
    v_perm_b32 v162, v9, v9, v254
    v_mfma_f32_16x16x16_bf16 v[132:135], v[160:161], v[98:99], 0
    v_perm_b32 v163, v9, v9, v255
    s_and_b32 s61, s70, s49
    s_waitcnt vmcnt(4)
    buffer_load_dwordx4 v[120:123], v2, s[16:19], s61 offen
    v_mfma_f32_16x16x16_bf16 v[136:139], v[162:163], v[100:101], 0
    v_readlane_b32 s71, v196, 1
    v_cvt_pk_bf16_f32 v9, v146, v147
    v_mfma_f32_16x16x16_bf16 v[140:143], v[162:163], v[102:103], 0
    v_perm_b32 v160, v9, v9, v190
    v_perm_b32 v161, v9, v9, v191
    s_and_b32 s61, s71, s49
    s_set_gpr_idx_on s64, gpr_idx(SRC2,DST)
    buffer_load_dwordx4 v[124:127], v2, s[16:19], s61 offen
    v_pk_fma_f32 v[16:17], v[128:129], v[64:65], v[16:17] op_sel_hi:[1,0,1]
    v_pk_fma_f32 v[18:19], v[130:131], v[64:65], v[18:19] op_sel_hi:[1,0,1]
    v_pk_fma_f32 v[20:21], v[132:133], v[80:81], v[20:21] op_sel_hi:[1,0,1]
    v_pk_fma_f32 v[22:23], v[134:135], v[80:81], v[22:23] op_sel_hi:[1,0,1]
    s_set_gpr_idx_idx s65
    v_pk_fma_f32 v[16:17], v[136:137], v[64:65], v[16:17] op_sel:[0,1,0] op_sel_hi:[1,1,1]
    v_pk_fma_f32 v[18:19], v[138:139], v[64:65], v[18:19] op_sel:[0,1,0] op_sel_hi:[1,1,1]
    v_pk_fma_f32 v[20:21], v[140:141], v[80:81], v[20:21] op_sel:[0,1,0] op_sel_hi:[1,1,1]
    v_pk_fma_f32 v[22:23], v[142:143], v[80:81], v[22:23] op_sel:[0,1,0] op_sel_hi:[1,1,1]
    s_set_gpr_idx_off
    s_waitcnt vmcnt(5)
    v_mfma_f32_16x16x16_bf16 v[128:131], v[160:161], v[104:105], 0
    v_readlane_b32 s64, v196, 2
    v_perm_b32 v162, v9, v9, v254
    v_mfma_f32_16x16x16_bf16 v[132:135], v[160:161], v[106:107], 0
    v_perm_b32 v163, v9, v9, v255
    s_and_b32 s61, s64, s49
    s_waitcnt vmcnt(4)
    buffer_load_dwordx4 v[96:99], v2, s[16:19], s61 offen
    v_mfma_f32_16x16x16_bf16 v[136:139], v[162:163], v[108:109], 0
    v_readlane_b32 s65, v196, 3
    v_cvt_pk_bf16_f32 v9, v148, v149
    v_mfma_f32_16x16x16_bf16 v[140:143], v[162:163], v[110:111], 0
    v_perm_b32 v160, v9, v9, v190
    v_perm_b32 v161, v9, v9, v191
    v_lshlrev_b32 v12, 2, v1
    s_lshl_b32 s61, s3, 7
    v_and_b32 v205, 0x7380, v205
    v_xor_b32 v205, s61, v205
    v_alignbit_b32 v205, v205, v205, 12
    v_cmp_eq_u32 s[80:81], 0, v205
    v_cmp_eq_u32 s[82:83], 1, v205
    v_cmp_eq_u32 s[84:85], 2, v205
    v_cmp_eq_u32 s[96:97], 3, v205
    v_cmp_eq_u32 vcc, 4, v205
    s_ff1_i32_b64 s56, s[80:81]
    s_mul_i32 s56, s56, 1152
    v_add_u32 v208, s56, v12
    s_ff1_i32_b64 s57, s[82:83]
    s_mul_i32 s57, s57, 1152
    v_add_u32 v209, s57, v12
    s_ff1_i32_b64 s58, s[84:85]
    s_mul_i32 s58, s58, 1152
    v_add_u32 v210, s58, v12
    s_ff1_i32_b64 s59, s[96:97]
    s_mul_i32 s59, s59, 1152
    v_add_u32 v211, s59, v12
    s_ff1_i32_b64 s60, vcc
    s_mul_i32 s60, s60, 1152
    v_add_u32 v212, s60, v12
    s_and_b32 s61, s65, s49
    s_set_gpr_idx_on s66, gpr_idx(SRC2,DST)
    buffer_load_dwordx4 v[100:103], v2, s[16:19], s61 offen
    v_pk_fma_f32 v[16:17], v[128:129], v[66:67], v[16:17] op_sel_hi:[1,0,1]
    v_pk_fma_f32 v[18:19], v[130:131], v[66:67], v[18:19] op_sel_hi:[1,0,1]
    v_pk_fma_f32 v[20:21], v[132:133], v[82:83], v[20:21] op_sel_hi:[1,0,1]
    v_pk_fma_f32 v[22:23], v[134:135], v[82:83], v[22:23] op_sel_hi:[1,0,1]
    s_set_gpr_idx_idx s67
    v_pk_fma_f32 v[16:17], v[136:137], v[66:67], v[16:17] op_sel:[0,1,0] op_sel_hi:[1,1,1]
    v_pk_fma_f32 v[18:19], v[138:139], v[66:67], v[18:19] op_sel:[0,1,0] op_sel_hi:[1,1,1]
    v_pk_fma_f32 v[20:21], v[140:141], v[82:83], v[20:21] op_sel:[0,1,0] op_sel_hi:[1,1,1]
    v_pk_fma_f32 v[22:23], v[142:143], v[82:83], v[22:23] op_sel:[0,1,0] op_sel_hi:[1,1,1]
    s_set_gpr_idx_off
    s_waitcnt vmcnt(5)
    v_mfma_f32_16x16x16_bf16 v[128:131], v[160:161], v[112:113], 0
    v_readlane_b32 s66, v196, 4
    v_perm_b32 v162, v9, v9, v254
    v_mfma_f32_16x16x16_bf16 v[132:135], v[160:161], v[114:115], 0
    v_perm_b32 v163, v9, v9, v255
    s_and_b32 s61, s66, s49
    s_waitcnt vmcnt(4)
    buffer_load_dwordx4 v[104:107], v2, s[16:19], s61 offen
    v_mfma_f32_16x16x16_bf16 v[136:139], v[162:163], v[116:117], 0
    v_readlane_b32 s67, v196, 5
    v_cvt_pk_bf16_f32 v9, v150, v151
    v_mfma_f32_16x16x16_bf16 v[140:143], v[162:163], v[118:119], 0
    v_perm_b32 v160, v9, v9, v190
    v_perm_b32 v161, v9, v9, v191
    s_and_b32 s61, s67, s49
    s_set_gpr_idx_on s68, gpr_idx(SRC2,DST)
    buffer_load_dwordx4 v[108:111], v2, s[16:19], s61 offen
    v_pk_fma_f32 v[16:17], v[128:129], v[68:69], v[16:17] op_sel_hi:[1,0,1]
    v_pk_fma_f32 v[18:19], v[130:131], v[68:69], v[18:19] op_sel_hi:[1,0,1]
    v_pk_fma_f32 v[20:21], v[132:133], v[84:85], v[20:21] op_sel_hi:[1,0,1]
    v_pk_fma_f32 v[22:23], v[134:135], v[84:85], v[22:23] op_sel_hi:[1,0,1]
    s_set_gpr_idx_idx s69
    v_pk_fma_f32 v[16:17], v[136:137], v[68:69], v[16:17] op_sel:[0,1,0] op_sel_hi:[1,1,1]
    v_pk_fma_f32 v[18:19], v[138:139], v[68:69], v[18:19] op_sel:[0,1,0] op_sel_hi:[1,1,1]
    v_pk_fma_f32 v[20:21], v[140:141], v[84:85], v[20:21] op_sel:[0,1,0] op_sel_hi:[1,1,1]
    v_pk_fma_f32 v[22:23], v[142:143], v[84:85], v[22:23] op_sel:[0,1,0] op_sel_hi:[1,1,1]
    s_set_gpr_idx_off
    s_waitcnt vmcnt(5)
    v_mfma_f32_16x16x16_bf16 v[128:131], v[160:161], v[120:121], 0
    v_readlane_b32 s68, v196, 6
    v_perm_b32 v162, v9, v9, v254
    v_mfma_f32_16x16x16_bf16 v[132:135], v[160:161], v[122:123], 0
    v_perm_b32 v163, v9, v9, v255
    s_and_b32 s61, s68, s49
    s_waitcnt vmcnt(4)
    buffer_load_dwordx4 v[112:115], v2, s[16:19], s61 offen
    v_mfma_f32_16x16x16_bf16 v[136:139], v[162:163], v[124:125], 0
    v_readlane_b32 s69, v196, 7
    v_cvt_pk_bf16_f32 v9, v152, v153
    v_mfma_f32_16x16x16_bf16 v[140:143], v[162:163], v[126:127], 0
    v_perm_b32 v160, v9, v9, v190
    v_perm_b32 v161, v9, v9, v191
    s_and_b32 s61, s69, s49
    s_set_gpr_idx_on s70, gpr_idx(SRC2,DST)
    buffer_load_dwordx4 v[116:119], v2, s[16:19], s61 offen
    v_pk_fma_f32 v[16:17], v[128:129], v[70:71], v[16:17] op_sel_hi:[1,0,1]
    v_pk_fma_f32 v[18:19], v[130:131], v[70:71], v[18:19] op_sel_hi:[1,0,1]
    v_pk_fma_f32 v[20:21], v[132:133], v[86:87], v[20:21] op_sel_hi:[1,0,1]
    v_pk_fma_f32 v[22:23], v[134:135], v[86:87], v[22:23] op_sel_hi:[1,0,1]
    s_set_gpr_idx_idx s71
    v_pk_fma_f32 v[16:17], v[136:137], v[70:71], v[16:17] op_sel:[0,1,0] op_sel_hi:[1,1,1]
    v_pk_fma_f32 v[18:19], v[138:139], v[70:71], v[18:19] op_sel:[0,1,0] op_sel_hi:[1,1,1]
    v_pk_fma_f32 v[20:21], v[140:141], v[86:87], v[20:21] op_sel:[0,1,0] op_sel_hi:[1,1,1]
    v_pk_fma_f32 v[22:23], v[142:143], v[86:87], v[22:23] op_sel:[0,1,0] op_sel_hi:[1,1,1]
    ds_read_b128 v[144:147], v215 offset:14336
    ds_read_b128 v[148:151], v215 offset:15360
    s_set_gpr_idx_off
    s_waitcnt vmcnt(5)
    v_mfma_f32_16x16x16_bf16 v[128:131], v[160:161], v[96:97], 0
    v_readlane_b32 s70, v196, 8
    v_perm_b32 v162, v9, v9, v254
    v_mfma_f32_16x16x16_bf16 v[132:135], v[160:161], v[98:99], 0
    v_perm_b32 v163, v9, v9, v255
    s_and_b32 s61, s70, s49
    s_waitcnt vmcnt(4)
    buffer_load_dwordx4 v[120:123], v2, s[16:19], s61 offen
    v_mfma_f32_16x16x16_bf16 v[136:139], v[162:163], v[100:101], 0
    v_readlane_b32 s71, v196, 9
    v_cvt_pk_bf16_f32 v9, v154, v155
    v_mfma_f32_16x16x16_bf16 v[140:143], v[162:163], v[102:103], 0
    v_perm_b32 v160, v9, v9, v190
    v_perm_b32 v161, v9, v9, v191
    s_and_b32 s61, s71, s49
    s_set_gpr_idx_on s64, gpr_idx(SRC2,DST)
    buffer_load_dwordx4 v[124:127], v2, s[16:19], s61 offen
    v_pk_fma_f32 v[16:17], v[128:129], v[72:73], v[16:17] op_sel_hi:[1,0,1]
    v_pk_fma_f32 v[18:19], v[130:131], v[72:73], v[18:19] op_sel_hi:[1,0,1]
    v_pk_fma_f32 v[20:21], v[132:133], v[88:89], v[20:21] op_sel_hi:[1,0,1]
    v_pk_fma_f32 v[22:23], v[134:135], v[88:89], v[22:23] op_sel_hi:[1,0,1]
    s_set_gpr_idx_idx s65
    v_pk_fma_f32 v[16:17], v[136:137], v[72:73], v[16:17] op_sel:[0,1,0] op_sel_hi:[1,1,1]
    v_pk_fma_f32 v[18:19], v[138:139], v[72:73], v[18:19] op_sel:[0,1,0] op_sel_hi:[1,1,1]
    v_pk_fma_f32 v[20:21], v[140:141], v[88:89], v[20:21] op_sel:[0,1,0] op_sel_hi:[1,1,1]
    v_pk_fma_f32 v[22:23], v[142:143], v[88:89], v[22:23] op_sel:[0,1,0] op_sel_hi:[1,1,1]
    ds_read_b128 v[96:99], v215 offset:6144
    ds_read_b128 v[100:103], v215 offset:7168
    s_set_gpr_idx_off
    s_waitcnt vmcnt(5)
    v_mfma_f32_16x16x16_bf16 v[128:131], v[160:161], v[104:105], 0
    v_perm_b32 v162, v9, v9, v254
    v_mfma_f32_16x16x16_bf16 v[132:135], v[160:161], v[106:107], 0
    v_perm_b32 v163, v9, v9, v255
    s_waitcnt vmcnt(4)
    s_nop 0
    v_mfma_f32_16x16x16_bf16 v[136:139], v[162:163], v[108:109], 0
    v_cvt_pk_bf16_f32 v9, v156, v157
    v_mfma_f32_16x16x16_bf16 v[140:143], v[162:163], v[110:111], 0
    v_perm_b32 v160, v9, v9, v190
    v_perm_b32 v161, v9, v9, v191
    s_set_gpr_idx_on s66, gpr_idx(SRC2,DST)
    v_pk_fma_f32 v[16:17], v[128:129], v[74:75], v[16:17] op_sel_hi:[1,0,1]
    v_pk_fma_f32 v[18:19], v[130:131], v[74:75], v[18:19] op_sel_hi:[1,0,1]
    v_pk_fma_f32 v[20:21], v[132:133], v[90:91], v[20:21] op_sel_hi:[1,0,1]
    v_pk_fma_f32 v[22:23], v[134:135], v[90:91], v[22:23] op_sel_hi:[1,0,1]
    s_set_gpr_idx_idx s67
    v_pk_fma_f32 v[16:17], v[136:137], v[74:75], v[16:17] op_sel:[0,1,0] op_sel_hi:[1,1,1]
    v_pk_fma_f32 v[18:19], v[138:139], v[74:75], v[18:19] op_sel:[0,1,0] op_sel_hi:[1,1,1]
    v_pk_fma_f32 v[20:21], v[140:141], v[90:91], v[20:21] op_sel:[0,1,0] op_sel_hi:[1,1,1]
    v_pk_fma_f32 v[22:23], v[142:143], v[90:91], v[22:23] op_sel:[0,1,0] op_sel_hi:[1,1,1]
    ds_read_b128 v[104:107], v215 offset:8192
    ds_read_b128 v[108:111], v215 offset:9216
    s_set_gpr_idx_off
    s_waitcnt vmcnt(3)
    v_mfma_f32_16x16x16_bf16 v[128:131], v[160:161], v[112:113], 0
    v_perm_b32 v162, v9, v9, v254
    v_mfma_f32_16x16x16_bf16 v[132:135], v[160:161], v[114:115], 0
    v_perm_b32 v163, v9, v9, v255
    s_waitcnt vmcnt(2)
    s_nop 0
    v_mfma_f32_16x16x16_bf16 v[136:139], v[162:163], v[116:117], 0
    v_cvt_pk_bf16_f32 v9, v158, v159
    v_mfma_f32_16x16x16_bf16 v[140:143], v[162:163], v[118:119], 0
    v_perm_b32 v160, v9, v9, v190
    v_perm_b32 v161, v9, v9, v191
    s_set_gpr_idx_on s68, gpr_idx(SRC2,DST)
    v_pk_fma_f32 v[16:17], v[128:129], v[76:77], v[16:17] op_sel_hi:[1,0,1]
    v_pk_fma_f32 v[18:19], v[130:131], v[76:77], v[18:19] op_sel_hi:[1,0,1]
    v_pk_fma_f32 v[20:21], v[132:133], v[92:93], v[20:21] op_sel_hi:[1,0,1]
    v_pk_fma_f32 v[22:23], v[134:135], v[92:93], v[22:23] op_sel_hi:[1,0,1]
    s_set_gpr_idx_idx s69
    v_pk_fma_f32 v[16:17], v[136:137], v[76:77], v[16:17] op_sel:[0,1,0] op_sel_hi:[1,1,1]
    v_pk_fma_f32 v[18:19], v[138:139], v[76:77], v[18:19] op_sel:[0,1,0] op_sel_hi:[1,1,1]
    v_pk_fma_f32 v[20:21], v[140:141], v[92:93], v[20:21] op_sel:[0,1,0] op_sel_hi:[1,1,1]
    v_pk_fma_f32 v[22:23], v[142:143], v[92:93], v[22:23] op_sel:[0,1,0] op_sel_hi:[1,1,1]
    ds_read_b128 v[112:115], v215 offset:10240
    ds_read_b128 v[116:119], v215 offset:11264
    s_set_gpr_idx_off
    s_waitcnt vmcnt(1)
    v_mfma_f32_16x16x16_bf16 v[128:131], v[160:161], v[120:121], 0
    v_perm_b32 v162, v9, v9, v254
    v_mfma_f32_16x16x16_bf16 v[132:135], v[160:161], v[122:123], 0
    v_perm_b32 v163, v9, v9, v255
    s_waitcnt vmcnt(0)
    s_nop 0
    v_mfma_f32_16x16x16_bf16 v[136:139], v[162:163], v[124:125], 0
    v_mfma_f32_16x16x16_bf16 v[140:143], v[162:163], v[126:127], 0
    s_set_gpr_idx_on s70, gpr_idx(SRC2,DST)
    v_pk_fma_f32 v[16:17], v[128:129], v[78:79], v[16:17] op_sel_hi:[1,0,1]
    v_pk_fma_f32 v[18:19], v[130:131], v[78:79], v[18:19] op_sel_hi:[1,0,1]
    v_pk_fma_f32 v[20:21], v[132:133], v[94:95], v[20:21] op_sel_hi:[1,0,1]
    v_pk_fma_f32 v[22:23], v[134:135], v[94:95], v[22:23] op_sel_hi:[1,0,1]
    s_set_gpr_idx_idx s71
    s_nop 0
    v_pk_fma_f32 v[16:17], v[136:137], v[78:79], v[16:17] op_sel:[0,1,0] op_sel_hi:[1,1,1]
    v_pk_fma_f32 v[18:19], v[138:139], v[78:79], v[18:19] op_sel:[0,1,0] op_sel_hi:[1,1,1]
    v_pk_fma_f32 v[20:21], v[140:141], v[94:95], v[20:21] op_sel:[0,1,0] op_sel_hi:[1,1,1]
    v_pk_fma_f32 v[22:23], v[142:143], v[94:95], v[22:23] op_sel:[0,1,0] op_sel_hi:[1,1,1]
    ds_read_b128 v[120:123], v215 offset:12288
    ds_read_b128 v[124:127], v215 offset:13312
    s_set_gpr_idx_off
L_swept:
    s_add_u32 s48, s48, 224
    s_cmp_lt_u32 s48, s47
    s_cbranch_scc1 L_again
    s_setprio 0
    v_cvt_pk_bf16_f32 v64, v16, v20
    v_cvt_pk_bf16_f32 v65, v17, v21
    v_cvt_pk_bf16_f32 v66, v18, v22
    v_cvt_pk_bf16_f32 v67, v19, v23
    ds_write2_b32 v208, v64, v65 offset0:0 offset1:72
    ds_write2_b32 v208, v66, v67 offset0:144 offset1:216
    v_cvt_pk_bf16_f32 v68, v24, v28
    v_cvt_pk_bf16_f32 v69, v25, v29
    v_cvt_pk_bf16_f32 v70, v26, v30
    v_cvt_pk_bf16_f32 v71, v27, v31
    ds_write2_b32 v209, v68, v69 offset0:0 offset1:72
    ds_write2_b32 v209, v70, v71 offset0:144 offset1:216
    v_cvt_pk_bf16_f32 v72, v32, v36
    v_cvt_pk_bf16_f32 v73, v33, v37
    v_cvt_pk_bf16_f32 v74, v34, v38
    v_cvt_pk_bf16_f32 v75, v35, v39
    ds_write2_b32 v210, v72, v73 offset0:0 offset1:72
    ds_write2_b32 v210, v74, v75 offset0:144 offset1:216
    v_cvt_pk_bf16_f32 v76, v40, v44
    v_cvt_pk_bf16_f32 v77, v41, v45
    v_cvt_pk_bf16_f32 v78, v42, v46
    v_cvt_pk_bf16_f32 v79, v43, v47
    ds_write2_b32 v211, v76, v77 offset0:0 offset1:72
    ds_write2_b32 v211, v78, v79 offset0:144 offset1:216
    v_cvt_pk_bf16_f32 v80, v48, v52
    v_cvt_pk_bf16_f32 v81, v49, v53
    v_cvt_pk_bf16_f32 v82, v50, v54
    v_cvt_pk_bf16_f32 v83, v51, v55
    ds_write2_b32 v212, v80, v81 offset0:0 offset1:72
    ds_write2_b32 v212, v82, v83 offset0:144 offset1:216
    s_waitcnt lgkmcnt(0)
    s_barrier
    ds_read_b128 v[16:19], v213 offset:0
    ds_read_b128 v[20:23], v213 offset:64
    ds_read_b128 v[24:27], v213 offset:128
    ds_read_b128 v[28:31], v213 offset:192
    s_waitcnt lgkmcnt(3)
    v_mfma_f32_16x16x32_bf16 v[160:163], v[16:19], v[216:219], 0
    v_mfma_f32_16x16x32_bf16 v[164:167], v[16:19], v[220:223], 0
    v_mfma_f32_16x16x32_bf16 v[168:171], v[16:19], v[224:227], 0
    v_mfma_f32_16x16x32_bf16 v[172:175], v[16:19], v[228:231], 0
    ds_read_b128 v[32:35], v213 offset:4608
    ds_read_b128 v[36:39], v213 offset:4672
    ds_read_b128 v[40:43], v213 offset:4736
    ds_read_b128 v[44:47], v213 offset:4800
    s_waitcnt lgkmcnt(6)
    v_mfma_f32_16x16x32_bf16 v[160:163], v[20:23], v[232:235], v[160:163]
    v_mfma_f32_16x16x32_bf16 v[164:167], v[20:23], v[236:239], v[164:167]
    v_mfma_f32_16x16x32_bf16 v[168:171], v[20:23], v[96:99], v[168:171]
    v_mfma_f32_16x16x32_bf16 v[172:175], v[20:23], v[100:103], v[172:175]
    ds_read_b128 v[48:51], v213 offset:9216
    ds_read_b128 v[52:55], v213 offset:9280
    ds_read_b128 v[56:59], v213 offset:9344
    ds_read_b128 v[60:63], v213 offset:9408
    s_waitcnt lgkmcnt(9)
    v_mfma_f32_16x16x32_bf16 v[160:163], v[24:27], v[104:107], v[160:163]
    v_mfma_f32_16x16x32_bf16 v[164:167], v[24:27], v[108:111], v[164:167]
    v_mfma_f32_16x16x32_bf16 v[168:171], v[24:27], v[112:115], v[168:171]
    v_mfma_f32_16x16x32_bf16 v[172:175], v[24:27], v[116:119], v[172:175]
    s_waitcnt lgkmcnt(8)
    v_mfma_f32_16x16x32_bf16 v[160:163], v[28:31], v[120:123], v[160:163]
    v_mfma_f32_16x16x32_bf16 v[164:167], v[28:31], v[124:127], v[164:167]
    v_mfma_f32_16x16x32_bf16 v[168:171], v[28:31], v[144:147], v[168:171]
    v_mfma_f32_16x16x32_bf16 v[172:175], v[28:31], v[148:151], v[172:175]
    s_waitcnt lgkmcnt(4)
    v_mfma_f32_16x16x32_bf16 v[176:179], v[32:35], v[216:219], 0
    v_mfma_f32_16x16x32_bf16 v[180:183], v[32:35], v[220:223], 0
    v_mfma_f32_16x16x32_bf16 v[184:187], v[32:35], v[224:227], 0
    v_mfma_f32_16x16x32_bf16 v[188:191], v[32:35], v[228:231], 0
    v_mfma_f32_16x16x32_bf16 v[176:179], v[36:39], v[232:235], v[176:179]
    v_cvt_pk_bf16_f32 v64, v160, v164
    v_cvt_pk_bf16_f32 v80, v160, v164
    v_mfma_f32_16x16x32_bf16 v[180:183], v[36:39], v[236:239], v[180:183]
    v_cvt_pk_bf16_f32 v66, v162, v166
    v_cvt_pk_bf16_f32 v65, v168, v172
    v_mfma_f32_16x16x32_bf16 v[184:187], v[36:39], v[96:99], v[184:187]
    v_cvt_pk_bf16_f32 v81, v168, v172
    v_cvt_pk_bf16_f32 v67, v170, v174
    v_mfma_f32_16x16x32_bf16 v[188:191], v[36:39], v[100:103], v[188:191]
    v_mov_b32_dpp v64, v66 row_ror:8 row_mask:0xf bank_mask:0xc
    v_mov_b32_dpp v65, v67 row_ror:8 row_mask:0xf bank_mask:0xc
    v_mfma_f32_16x16x32_bf16 v[176:179], v[40:43], v[104:107], v[176:179]
    v_mov_b32_dpp v66, v80 row_ror:8 row_mask:0xf bank_mask:0x3
    v_mov_b32_dpp v67, v81 row_ror:8 row_mask:0xf bank_mask:0x3
    v_mfma_f32_16x16x32_bf16 v[180:183], v[40:43], v[108:111], v[180:183]
    buffer_store_dwordx4 v[64:67], v214, s[40:43], s87 offen offset:0 sc1
    v_cvt_pk_bf16_f32 v68, v161, v165
    v_mfma_f32_16x16x32_bf16 v[184:187], v[40:43], v[112:115], v[184:187]
    v_cvt_pk_bf16_f32 v82, v161, v165
    v_cvt_pk_bf16_f32 v70, v163, v167
    v_mfma_f32_16x16x32_bf16 v[188:191], v[40:43], v[116:119], v[188:191]
    v_cvt_pk_bf16_f32 v69, v169, v173
    v_cvt_pk_bf16_f32 v83, v169, v173
    v_mfma_f32_16x16x32_bf16 v[176:179], v[44:47], v[120:123], v[176:179]
    v_cvt_pk_bf16_f32 v71, v171, v175
    v_mov_b32_dpp v68, v70 row_ror:8 row_mask:0xf bank_mask:0xc
    v_mfma_f32_16x16x32_bf16 v[180:183], v[44:47], v[124:127], v[180:183]
    v_mov_b32_dpp v69, v71 row_ror:8 row_mask:0xf bank_mask:0xc
    v_mov_b32_dpp v70, v82 row_ror:8 row_mask:0xf bank_mask:0x3
    v_mfma_f32_16x16x32_bf16 v[184:187], v[44:47], v[144:147], v[184:187]
    v_mov_b32_dpp v71, v83 row_ror:8 row_mask:0xf bank_mask:0x3
    buffer_store_dwordx4 v[68:71], v214, s[40:43], s87 offen offset:256 sc1
    v_mfma_f32_16x16x32_bf16 v[188:191], v[44:47], v[148:151], v[188:191]
    s_add_u32 s87, s87, 4096
    s_cmp_ge_u32 s3, 4
    s_cbranch_scc1 L_two
    s_waitcnt lgkmcnt(0)
    v_mfma_f32_16x16x32_bf16 v[160:163], v[48:51], v[216:219], 0
    v_mfma_f32_16x16x32_bf16 v[164:167], v[48:51], v[220:223], 0
    v_mfma_f32_16x16x32_bf16 v[168:171], v[48:51], v[224:227], 0
    v_mfma_f32_16x16x32_bf16 v[172:175], v[48:51], v[228:231], 0
    v_mfma_f32_16x16x32_bf16 v[160:163], v[52:55], v[232:235], v[160:163]
    v_cvt_pk_bf16_f32 v72, v176, v180
    v_cvt_pk_bf16_f32 v80, v176, v180
    v_mfma_f32_16x16x32_bf16 v[164:167], v[52:55], v[236:239], v[164:167]
    v_cvt_pk_bf16_f32 v74, v178, v182
    v_cvt_pk_bf16_f32 v73, v184, v188
    v_mfma_f32_16x16x32_bf16 v[168:171], v[52:55], v[96:99], v[168:171]
    v_cvt_pk_bf16_f32 v81, v184, v188
    v_cvt_pk_bf16_f32 v75, v186, v190
    v_mfma_f32_16x16x32_bf16 v[172:175], v[52:55], v[100:103], v[172:175]
    v_mov_b32_dpp v72, v74 row_ror:8 row_mask:0xf bank_mask:0xc
    v_mov_b32_dpp v73, v75 row_ror:8 row_mask:0xf bank_mask:0xc
    v_mfma_f32_16x16x32_bf16 v[160:163], v[56:59], v[104:107], v[160:163]
    v_mov_b32_dpp v74, v80 row_ror:8 row_mask:0xf bank_mask:0x3
    v_mov_b32_dpp v75, v81 row_ror:8 row_mask:0xf bank_mask:0x3
    v_mfma_f32_16x16x32_bf16 v[164:167], v[56:59], v[108:111], v[164:167]
    buffer_store_dwordx4 v[72:75], v214, s[40:43], s87 offen offset:0 sc1
    v_cvt_pk_bf16_f32 v76, v177, v181
    v_mfma_f32_16x16x32_bf16 v[168:171], v[56:59], v[112:115], v[168:171]
    v_cvt_pk_bf16_f32 v82, v177, v181
    v_cvt_pk_bf16_f32 v78, v179, v183
    v_mfma_f32_16x16x32_bf16 v[172:175], v[56:59], v[116:119], v[172:175]
    v_cvt_pk_bf16_f32 v77, v185, v189
    v_cvt_pk_bf16_f32 v83, v185, v189
    v_mfma_f32_16x16x32_bf16 v[160:163], v[60:63], v[120:123], v[160:163]
    v_cvt_pk_bf16_f32 v79, v187, v191
    v_mov_b32_dpp v76, v78 row_ror:8 row_mask:0xf bank_mask:0xc
    v_mfma_f32_16x16x32_bf16 v[164:167], v[60:63], v[124:127], v[164:167]
    v_mov_b32_dpp v77, v79 row_ror:8 row_mask:0xf bank_mask:0xc
    v_mov_b32_dpp v78, v82 row_ror:8 row_mask:0xf bank_mask:0x3
    v_mfma_f32_16x16x32_bf16 v[168:171], v[60:63], v[144:147], v[168:171]
    v_mov_b32_dpp v79, v83 row_ror:8 row_mask:0xf bank_mask:0x3
    buffer_store_dwordx4 v[76:79], v214, s[40:43], s87 offen offset:256 sc1
    v_mfma_f32_16x16x32_bf16 v[172:175], v[60:63], v[148:151], v[172:175]
    s_add_u32 s87, s87, 4096
    s_nop 0
    v_cvt_pk_bf16_f32 v64, v160, v164
    v_cvt_pk_bf16_f32 v80, v160, v164
    v_cvt_pk_bf16_f32 v66, v162, v166
    s_nop 2
    v_cvt_pk_bf16_f32 v65, v168, v172
    v_cvt_pk_bf16_f32 v81, v168, v172
    v_cvt_pk_bf16_f32 v67, v170, v174
    v_mov_b32_dpp v64, v66 row_ror:8 row_mask:0xf bank_mask:0xc
    s_nop 0
    v_mov_b32_dpp v65, v67 row_ror:8 row_mask:0xf bank_mask:0xc
    v_mov_b32_dpp v66, v80 row_ror:8 row_mask:0xf bank_mask:0x3
    v_mov_b32_dpp v67, v81 row_ror:8 row_mask:0xf bank_mask:0x3
    buffer_store_dwordx4 v[64:67], v214, s[40:43], s87 offen offset:0 sc1
    v_cvt_pk_bf16_f32 v68, v161, v165
    v_cvt_pk_bf16_f32 v82, v161, v165
    v_cvt_pk_bf16_f32 v70, v163, v167
    v_cvt_pk_bf16_f32 v69, v169, v173
    v_cvt_pk_bf16_f32 v83, v169, v173
    v_cvt_pk_bf16_f32 v71, v171, v175
    v_mov_b32_dpp v68, v70 row_ror:8 row_mask:0xf bank_mask:0xc
    s_nop 0
    v_mov_b32_dpp v69, v71 row_ror:8 row_mask:0xf bank_mask:0xc
    v_mov_b32_dpp v70, v82 row_ror:8 row_mask:0xf bank_mask:0x3
    v_mov_b32_dpp v71, v83 row_ror:8 row_mask:0xf bank_mask:0x3
    buffer_store_dwordx4 v[68:71], v214, s[40:43], s87 offen offset:256 sc1
    s_add_u32 s87, s87, 4096
L_stored:
    s_or_b32 s4, s2, s3
    s_cbranch_scc1 L_notag
    v_mov_b32 v8, s62
    v_lshlrev_b32 v10, 2, v1
    s_mov_b32 s54, 524288
    buffer_store_dword v8, v10, s[20:23], s54 offen sc1
L_notag:
L_done:
    s_endpgm
L_again:
    s_waitcnt vmcnt(0) lgkmcnt(0)
    s_barrier
    v_lshlrev_b32 v11, 2, v0
    v_mov_b32 v12, 0x00700000
    v_mov_b32 v13, 0
    ds_write_b32 v11, v12 offset:0
    ds_write_b32 v11, v12 offset:2048
    ds_write_b32 v11, v12 offset:4096
    ds_write_b32 v11, v12 offset:6144
    ds_write_b32 v11, v13 offset:8192
    ds_write_b32 v11, v13 offset:10240
    ds_write_b32 v11, v13 offset:12288
    v_mov_b32 v64, 0
    v_mov_b32 v65, 0
    v_mov_b32 v66, 0
    v_mov_b32 v67, 0
    v_mov_b32 v68, 0
    v_mov_b32 v69, 0
    v_mov_b32 v70, 0
    v_mov_b32 v71, 0
    v_mov_b32 v72, 0
    v_mov_b32 v73, 0
    v_mov_b32 v74, 0
    v_mov_b32 v75, 0
    v_mov_b32 v76, 0
    v_mov_b32 v77, 0
    v_mov_b32 v78, 0
    v_mov_b32 v79, 0
    v_mov_b32 v80, 0
    v_mov_b32 v81, 0
    v_mov_b32 v82, 0
    v_mov_b32 v83, 0
    v_mov_b32 v84, 0
    v_mov_b32 v85, 0
    v_mov_b32 v86, 0
    v_mov_b32 v87, 0
    v_mov_b32 v88, 0
    v_mov_b32 v89, 0
    v_mov_b32 v90, 0
    v_mov_b32 v91, 0
    v_mov_b32 v92, 0
    v_mov_b32 v93, 0
    v_mov_b32 v94, 0
    v_mov_b32 v95, 0
    v_add_u32 v3, v3, v4
    v_subrev_u32 v3, 224, v3
    v_max_i32 v3, 0, v3
    v_subrev_u32 v4, 224, v4
    v_max_i32 v4, 0, v4
    v_sub_u32 v3, v3, v4
    v_add_u32 v5, 224, v5
    s_sub_i32 s95, s95, 224
    v_lshl_add_u32 v8, v4, 2, v241
    s_waitcnt lgkmcnt(0)
    s_barrier
L_clip:
    v_add_u32 v10, v4, v3
    v_min_i32 v10, 224, v10
    v_sub_u32 v10, v10, v4
    v_add_u32 v10, v10, v240
L_masks:
    v_cmp_lt_i32 s[64:65], 0, v10
    v_cmp_lt_i32 s[66:67], 2, v10
    v_cmp_lt_i32 s[68:69], 4, v10
    v_cmp_lt_i32 s[70:71], 6, v10
    v_cmp_lt_i32 s[72:73], 8, v10
    v_cmp_lt_i32 s[74:75], 10, v10
    v_cmp_lt_i32 s[76:77], 12, v10
    v_cmp_lt_i32 s[78:79], 14, v10
    s_nop 0
    s_branch L_mapw
L_map2:
    v_add_u32 v8, 56, v8
    v_subrev_u32 v10, 14, v10
    s_branch L_masks
L_r1:
    ds_read_b32 v139, v242 offset:768
    ds_read_b32 v146, v243 offset:768
    s_waitcnt lgkmcnt(0)
    v_mad_u32_u24 v139, v139, 12, v244
    buffer_load_dwordx3 v[160:162], v139, s[24:27], 0 offen offset:2304 sc1
    v_lshl_add_u32 v146, v146, 5, v2
    s_add_u32 m0, s52, 4096
    s_nop 0
    buffer_load_dwordx4 v146, s[28:31], s98 offen offset:2048 sc1 lds
    s_branch L_r1b
L_r2:
    v_lshrrev_b32 v135, 21, v162
    v_lshlrev_b32 v135, 2, v135
    v_lshrrev_b32 v11, 26, v162
    v_lshl_or_b32 v11, v11, 4, v245
    s_mov_b64 exec, s[96:97]
    ds_add_rtn_u32 v131, v135, v6 offset:8192
    ds_add_u32 v11, v6 offset:14336
    s_mov_b64 exec, -1
    s_mov_b32 exec_hi, 0
    ds_write_b64 v246, v[160:161] offset:1536
    s_mov_b32 exec_hi, -1
    v_and_or_b32 v162, v162, s55, v247
    v_add_u32 v162, 402653184, v162
    s_branch L_r2b
L_r3:
    ds_read_b32 v135, v135 offset:8192
    s_waitcnt lgkmcnt(0)
    v_bfe_u32 v15, v135, 12, 3
    v_or_b32 v162, v15, v162
    v_and_b32 v139, 0x3ff, v135
    v_lshrrev_b32 v135, 16, v135
    v_add_u32 v135, v135, v131
    ds_read_b32 v139, v139 offset:16384
    s_waitcnt lgkmcnt(0)
    v_lshl_add_u32 v135, v135, 2, v139
    s_mov_b64 exec, s[96:97]
    ds_write_b32 v135, v162
    s_mov_b64 exec, -1
    s_branch L_r3b
L_empty:
    s_waitcnt vmcnt(0) lgkmcnt(0)
    s_barrier
    v_lshlrev_b32 v12, 2, v1
    s_lshl_b32 s61, s3, 7
    v_and_b32 v205, 0x7380, v205
    v_xor_b32 v205, s61, v205
    v_alignbit_b32 v205, v205, v205, 12
    v_cmp_eq_u32 s[80:81], 0, v205
    v_cmp_eq_u32 s[82:83], 1, v205
    v_cmp_eq_u32 s[84:85], 2, v205
    v_cmp_eq_u32 s[96:97], 3, v205
    v_cmp_eq_u32 vcc, 4, v205
    s_ff1_i32_b64 s56, s[80:81]
    s_mul_i32 s56, s56, 1152
    v_add_u32 v208, s56, v12
    s_ff1_i32_b64 s57, s[82:83]
    s_mul_i32 s57, s57, 1152
    v_add_u32 v209, s57, v12
    s_ff1_i32_b64 s58, s[84:85]
    s_mul_i32 s58, s58, 1152
    v_add_u32 v210, s58, v12
    s_ff1_i32_b64 s59, s[96:97]
    s_mul_i32 s59, s59, 1152
    v_add_u32 v211, s59, v12
    s_ff1_i32_b64 s60, vcc
    s_mul_i32 s60, s60, 1152
    v_add_u32 v212, s60, v12
    ds_read_b128 v[96:99], v215 offset:6144
    ds_read_b128 v[100:103], v215 offset:7168
    ds_read_b128 v[104:107], v215 offset:8192
    ds_read_b128 v[108:111], v215 offset:9216
    ds_read_b128 v[112:115], v215 offset:10240
    ds_read_b128 v[116:119], v215 offset:11264
    ds_read_b128 v[120:123], v215 offset:12288
    ds_read_b128 v[124:127], v215 offset:13312
    ds_read_b128 v[144:147], v215 offset:14336
    ds_read_b128 v[148:151], v215 offset:15360
    s_branch L_swept
L_two:
    s_nop 7
    v_cvt_pk_bf16_f32 v72, v176, v180
    v_cvt_pk_bf16_f32 v80, v176, v180
    v_cvt_pk_bf16_f32 v74, v178, v182
    v_cvt_pk_bf16_f32 v73, v184, v188
    v_cvt_pk_bf16_f32 v81, v184, v188
    v_cvt_pk_bf16_f32 v75, v186, v190
    v_mov_b32_dpp v72, v74 row_ror:8 row_mask:0xf bank_mask:0xc
    s_nop 0
    v_mov_b32_dpp v73, v75 row_ror:8 row_mask:0xf bank_mask:0xc
    v_mov_b32_dpp v74, v80 row_ror:8 row_mask:0xf bank_mask:0x3
    v_mov_b32_dpp v75, v81 row_ror:8 row_mask:0xf bank_mask:0x3
    buffer_store_dwordx4 v[72:75], v214, s[40:43], s87 offen offset:0 sc1
    v_cvt_pk_bf16_f32 v76, v177, v181
    v_cvt_pk_bf16_f32 v82, v177, v181
    v_cvt_pk_bf16_f32 v78, v179, v183
    v_cvt_pk_bf16_f32 v77, v185, v189
    v_cvt_pk_bf16_f32 v83, v185, v189
    v_cvt_pk_bf16_f32 v79, v187, v191
    v_mov_b32_dpp v76, v78 row_ror:8 row_mask:0xf bank_mask:0xc
    s_nop 0
    v_mov_b32_dpp v77, v79 row_ror:8 row_mask:0xf bank_mask:0xc
    v_mov_b32_dpp v78, v82 row_ror:8 row_mask:0xf bank_mask:0x3
    v_mov_b32_dpp v79, v83 row_ror:8 row_mask:0xf bank_mask:0x3
    buffer_store_dwordx4 v[76:79], v214, s[40:43], s87 offen offset:256 sc1
    s_add_u32 s87, s87, 4096
    s_branch L_stored
L_poll:
    buffer_load_dwordx2 v[206:207], v10, s[20:23], s49 offen sc1
    s_sub_u32 s53, s53, 1
    s_cbranch_scc1 L_done
    s_waitcnt vmcnt(0)
    v_xor_b32 v11, s63, v206
    v_xor_b32 v12, s62, v207
    v_and_or_b32 v11, v11, s55, v12
    v_cmpx_ne_u32 vcc, 0, v11
    s_cbranch_execnz L_poll
    s_branch L_polled
L_rank2:
    ds_read_b32 v96, v248 offset:8192
    ds_read_b32 v97, v248 offset:8320
    ds_read_b32 v98, v248 offset:8448
    ds_read_b32 v99, v248 offset:8576
    ds_read_b32 v100, v248 offset:8704
    ds_write_b64 v246, v[148:149] offset:0
    v_and_or_b32 v150, v150, s55, v247
    ds_write_b64 v246, v[152:153] offset:512
    v_and_or_b32 v154, v154, s55, v247
    v_add_u32 v154, 134217728, v154
    ds_write_b64 v246, v[156:157] offset:1024
    v_and_or_b32 v158, v158, s55, v247
    v_add_u32 v158, 268435456, v158
    s_waitcnt lgkmcnt(0)
L_end:
    s_branch L_ranked
.section .rodata,"a"
.p2align 6
.amdhsa_kernel gather_scatter__tensor_product_equiv_mace__graph_kernel
  .amdhsa_next_free_vgpr 256
  .amdhsa_next_free_sgpr 102
  .amdhsa_accum_offset 256
  .amdhsa_group_segment_fixed_size 0
  .amdhsa_kernarg_size 88
  .amdhsa_user_sgpr_count 2
  .amdhsa_user_sgpr_kernarg_segment_ptr 1
  .amdhsa_system_sgpr_workgroup_id_x 1
  .amdhsa_float_denorm_mode_32 3
.end_amdhsa_kernel
```

```asm
; @launch grid=(256,1,1) block=(512,1,1) lds=158784
.amdgcn_target "amdgcn-amd-amdhsa--gfx950"
.text
.globl gather_scatter__tensor_product_equiv_mace__graph_kernel
.p2align 8
.type gather_scatter__tensor_product_equiv_mace__graph_kernel,@function
gather_scatter__tensor_product_equiv_mace__graph_kernel:
    s_cmp_ge_u32 s2, 256
    s_cbranch_scc1 L_done
    s_load_dwordx4 s[4:7], s[0:1], 8
    s_load_dwordx4 s[8:11], s[0:1], 24
    s_load_dwordx2 s[14:15], s[0:1], 80
    s_load_dwordx2 s[64:65], s[0:1], 0
    s_load_dwordx2 s[66:67], s[0:1], 40
    s_load_dwordx4 s[68:71], s[0:1], 48
    s_load_dwordx2 s[12:13], s[0:1], 64
    v_lshlrev_b32 v10, 3, v0
    s_getpc_b64 s[80:81]
L_pc:
    s_and_b32 s44, s2, 0xf8
    s_lshl_b32 s44, s44, 6
    v_and_b32 v11, 0x180, v10
    v_add_u32 v11, s44, v11
    v_min_u32 v11, L_end-L_pc, v11
    v_mov_b32 v113, s81
    v_add_co_u32 v112, vcc, s80, v11
    s_nop 1
    v_addc_co_u32 v113, vcc, 0, v113, vcc
    global_load_dword v205, v[112:113], off
    v_lshrrev_b32 v8, 6, v0
    v_and_b32 v1, 63, v0
    v_lshlrev_b32 v9, 2, v0
    v_mov_b32 v13, 0
    v_readfirstlane_b32 s3, v8
    ds_write_b32 v9, v13 offset:23552
    ds_write_b32 v9, v13 offset:28672
    s_mul_i32 s54, s2, 5000
    s_mul_i32 s55, s2, 10000
    s_mul_i32 s61, s2, 40000
    v_lshlrev_b32 v2, 4, v1
    v_lshlrev_b32 v15, 4, v0
    v_mov_b32 v6, 1
    s_lshl_b32 s52, s3, 10
    s_add_u32 s52, s52, 101376
    s_movk_i32 s53, 4096
    s_movk_i32 s50, 8192
    s_mov_b32 s34, 5000
    s_mov_b32 s35, 0x20000
    s_mov_b32 s38, 5000
    s_mov_b32 s39, 0x20000
    s_mov_b32 s98, 10000
    s_mov_b32 s99, 0x20000
    s_mov_b32 s30, 40000
    s_mov_b32 s31, 0x20000
    s_waitcnt lgkmcnt(0)
    s_add_u32 s32, s6, s54
    s_addc_u32 s33, s7, 0
    buffer_load_dword v64, v9, s[32:35], 0 offen offset:0 nt
    buffer_load_dword v65, v9, s[32:35], 0 offen offset:2048 nt
    buffer_load_dword v66, v9, s[32:35], s53 offen nt
    s_add_u32 s36, s4, s54
    s_addc_u32 s37, s5, 0
    s_barrier
    buffer_load_dword v68, v9, s[36:39], 0 offen offset:0 nt
    buffer_load_dword v69, v9, s[36:39], 0 offen offset:2048 nt
    buffer_load_dword v70, v9, s[36:39], s53 offen nt
    s_load_dword s62, s[14:15], 524288
    s_add_u32 s96, s8, s55
    s_addc_u32 s97, s9, 0
    s_add_u32 s28, s10, s61
    s_addc_u32 s29, s11, 0
    buffer_load_dwordx2 v[72:73], v10, s[96:99], 0 offen nt
    buffer_load_dwordx2 v[74:75], v10, s[96:99], s53 offen nt
    buffer_load_dwordx2 v[76:77], v10, s[96:99], s50 offen nt
    s_add_u32 m0, s52, 0
    s_mov_b32 s54, 0
    buffer_load_dwordx4 v15, s[28:31], s54 offen nt lds
    s_add_u32 m0, s52, 8192
    s_mov_b32 s54, 8192
    buffer_load_dwordx4 v15, s[28:31], s54 offen nt lds
    s_add_u32 m0, s52, 16384
    s_mov_b32 s54, 16384
    buffer_load_dwordx4 v15, s[28:31], s54 offen nt lds
    s_mov_b32 s72, 109951168
    s_movk_i32 s73, 625
    s_movk_i32 s74, 838
    s_movk_i32 s54, 226
    v_cmp_gt_u32 s[84:85], s54, v0
    s_mov_b32 s20, s14
    s_mov_b32 s21, s15
    s_mov_b32 s22, 524352
    s_mov_b32 s23, 0x20000
    v_lshlrev_b32 v11, 2, v0
    v_mov_b32 v12, 0x00700000
    v_mov_b32 v13, 0
    ds_write_b32 v11, v12 offset:0
    ds_write_b32 v11, v12 offset:2048
    ds_write_b32 v11, v12 offset:4096
    ds_write_b32 v11, v12 offset:6144
    ds_write_b32 v11, v13 offset:8192
    ds_write_b32 v11, v13 offset:10240
    ds_write_b32 v11, v13 offset:12288
    ds_write_b32 v11, v13 offset:14336
    s_waitcnt vmcnt(9)
    v_mul_hi_u32 v80, v64, s72
    v_mul_hi_u32 v81, v65, s72
    v_mul_hi_u32 v82, v66, s72
    v_lshlrev_b32 v84, 2, v80
    ds_add_rtn_u32 v88, v84, v6 offset:23552
    v_lshlrev_b32 v85, 2, v81
    ds_add_rtn_u32 v89, v85, v6 offset:23552
    v_lshlrev_b32 v86, 2, v82
    s_mov_b64 exec, s[84:85]
    ds_add_rtn_u32 v90, v86, v6 offset:23552
    s_mov_b64 exec, -1
    s_waitcnt lgkmcnt(0)
    s_barrier
    ds_read_b128 v[100:103], v2 offset:23552
    s_mul_i32 s62, s62, 0x9e3779b1
    s_add_u32 s62, s62, 0x7f4a7c15
    s_mul_i32 s63, s62, 0x85ebca6b
    s_and_b32 s63, s63, 0xffc00000
    s_add_u32 m0, s52, 24576
    s_mov_b32 s54, 24576
    buffer_load_dwordx4 v15, s[28:31], s54 offen nt lds
    s_add_u32 m0, s52, 32768
    s_mov_b32 s54, 32768
    buffer_load_dwordx4 v15, s[28:31], s54 offen nt lds
    v_mad_u32_u24 v92, v80, s73, 15
    v_lshrrev_b32 v92, 4, v92
    v_sub_u32 v92, v64, v92
    v_mad_u32_u24 v93, v81, s73, 15
    v_lshrrev_b32 v93, 4, v93
    v_sub_u32 v93, v65, v93
    v_mad_u32_u24 v94, v82, s73, 15
    v_lshrrev_b32 v94, 4, v94
    v_sub_u32 v94, v66, v94
    s_waitcnt lgkmcnt(0)
    v_add_u32 v11, v100, v101
    v_add3_u32 v11, v11, v102, v103
    v_mov_b32 v12, v11
    s_nop 1
    v_add_u32_dpp v12, v12, v12 row_shr:1 row_mask:0xf bank_mask:0xf
    s_nop 1
    v_add_u32_dpp v12, v12, v12 row_shr:2 row_mask:0xf bank_mask:0xf
    s_nop 1
    v_add_u32_dpp v12, v12, v12 row_shr:4 row_mask:0xf bank_mask:0xf
    s_nop 1
    v_add_u32_dpp v12, v12, v12 row_shr:8 row_mask:0xf bank_mask:0xf
    s_nop 1
    v_add_u32_dpp v12, v12, v12 row_bcast:15 row_mask:0xa bank_mask:0xf
    s_nop 1
    v_add_u32_dpp v12, v12, v12 row_bcast:31 row_mask:0xc bank_mask:0xf
    v_sub_u32 v104, v12, v11
    v_add_u32 v105, v104, v100
    v_add_u32 v106, v105, v101
    v_add_u32 v107, v106, v102
    ds_write_b128 v2, v[104:107] offset:24576
    ds_read_b32 v108, v84 offset:24576
    ds_read_b32 v109, v85 offset:24576
    ds_read_b32 v110, v86 offset:24576
    s_waitcnt vmcnt(8)
    v_mul_u32_u24 v96, s74, v68
    v_bfe_u32 v96, v96, 18, 5
    v_lshl_or_b32 v96, v92, 5, v96
    v_lshlrev_b32 v96, 21, v96
    v_lshl_or_b32 v96, v68, 7, v96
    v_mul_u32_u24 v97, s74, v69
    v_bfe_u32 v97, v97, 18, 5
    v_lshl_or_b32 v97, v93, 5, v97
    v_lshlrev_b32 v97, 21, v97
    v_lshl_or_b32 v97, v69, 7, v97
    v_mul_u32_u24 v98, s74, v70
    v_bfe_u32 v98, v98, 18, 5
    v_lshl_or_b32 v98, v94, 5, v98
    v_lshlrev_b32 v98, 21, v98
    v_lshl_or_b32 v98, v70, 7, v98
    v_lshlrev_b32 v92, 5, v0
    v_add_u32 v93, 16384, v92
    v_add_u32 v94, 32768, v92
    s_mov_b32 s55, 30720
    s_waitcnt vmcnt(5) lgkmcnt(0)
    v_add_u32 v108, v108, v88
    v_lshlrev_b32 v84, 2, v108
    v_mad_u32_u24 v108, v108, 12, s55
    ds_write_b32 v84, v92 offset:25600
    ds_write2_b32 v108, v72, v73 offset0:0 offset1:1
    ds_write_b32 v108, v96 offset:8
    v_add_u32 v109, v109, v89
    v_lshlrev_b32 v85, 2, v109
    v_mad_u32_u24 v109, v109, 12, s55
    ds_write_b32 v85, v93 offset:25600
    ds_write2_b32 v109, v74, v75 offset0:0 offset1:1
    ds_write_b32 v109, v97 offset:8
    v_add_u32 v110, v110, v90
    v_lshlrev_b32 v86, 2, v110
    v_mad_u32_u24 v110, v110, 12, s55
    s_mov_b64 exec, s[84:85]
    ds_write_b32 v86, v94 offset:25600
    ds_write2_b32 v110, v76, v77 offset0:0 offset1:1
    ds_write_b32 v110, v98 offset:8
    s_mov_b64 exec, -1
    s_lshl_b32 s54, s3, 7
    v_lshl_add_u32 v11, v1, 3, s54
    ds_read_b64 v[100:101], v11 offset:23552
    ds_read_b64 v[104:105], v11 offset:24576
    s_mul_i32 s54, s2, 15360
    s_add_u32 s54, s54, 1048576
    s_add_u32 s32, s14, s54
    s_addc_u32 s33, s15, 0
    s_mov_b32 s34, 15360
    s_mov_b32 s35, 0x20000
    s_mul_i32 s54, s2, 40960
    s_add_u32 s54, s54, 5242880
    s_add_u32 s36, s14, s54
    s_addc_u32 s37, s15, 0
    s_mov_b32 s38, 40000
    s_mov_b32 s39, 0x20000
    v_lshrrev_b32 v11, 1, v0
    v_lshlrev_b32 v11, 2, v11
    v_and_b32 v12, 1, v0
    v_lshlrev_b32 v12, 4, v12
    v_add_u32 v12, 101376, v12
    v_add_u32 v14, 30720, v15
    s_waitcnt lgkmcnt(0)
    s_barrier
    ds_read_b128 v[128:131], v14
    ds_read_b128 v[132:135], v14 offset:8192
    ds_read_b32 v156, v11 offset:25600
    ds_read_b32 v157, v11 offset:26624
    ds_read_b32 v158, v11 offset:27648
    ds_read_b32 v159, v11 offset:28672
    ds_read_b32 v160, v11 offset:29696
    s_cmp_lt_u32 s3, 4
    s_cselect_b32 s16, s68, s66
    s_cselect_b32 s17, s69, s67
    s_movk_i32 s54, 128
    s_cselect_b32 s18, s53, s54
    s_mov_b32 s19, 0x20000
    s_min_u32 s54, s3, 5
    s_lshl_b32 s54, s54, 10
    s_add_u32 m0, s54, 17408
    s_and_b32 s54, s54, 0xc00
    buffer_load_dwordx4 v2, s[16:19], s54 offen lds
    s_mov_b32 s40, s70
    s_mov_b32 s41, s71
    s_mov_b32 s42, 32768
    s_mov_b32 s43, 0x20000
    s_lshl_b32 s55, s3, 12
    s_add_u32 m0, s55, 46080
    s_nop 0
    buffer_load_dwordx4 v2, s[40:43], s55 offen offset:0 lds
    buffer_load_dwordx4 v2, s[40:43], s55 offen offset:1024 lds
    buffer_load_dwordx4 v2, s[40:43], s55 offen offset:2048 lds
    buffer_load_dwordx4 v2, s[40:43], s55 offen offset:3072 lds
    s_waitcnt lgkmcnt(0)
    v_add_u32 v156, v12, v156
    v_add_u32 v157, v12, v157
    v_add_u32 v158, v12, v158
    v_add_u32 v159, v12, v159
    v_add_u32 v160, v12, v160
    v_lshl_or_b32 v112, v100, 11, v104
    v_or_b32 v112, s63, v112
    v_mov_b32 v113, s62
    v_lshl_or_b32 v114, v101, 11, v105
    v_or_b32 v114, s63, v114
    v_mov_b32 v115, s62
    s_waitcnt vmcnt(0)
    s_barrier
    ds_read_b128 v[136:139], v156
    ds_read_b128 v[140:143], v157
    ds_read_b128 v[144:147], v158
    ds_read_b128 v[148:151], v159
    ds_read_b128 v[152:155], v160
    buffer_store_dwordx4 v[128:131], v15, s[32:35], 0 offen sc1
    buffer_store_dwordx4 v[132:135], v15, s[32:35], s50 offen sc1
    s_mov_b32 s54, 0
    s_waitcnt lgkmcnt(4)
    buffer_store_dwordx4 v[136:139], v15, s[36:39], s54 offen sc1
    s_mov_b32 s54, 8192
    s_waitcnt lgkmcnt(3)
    buffer_store_dwordx4 v[140:143], v15, s[36:39], s54 offen sc1
    s_mov_b32 s54, 16384
    s_waitcnt lgkmcnt(2)
    buffer_store_dwordx4 v[144:147], v15, s[36:39], s54 offen sc1
    s_mov_b32 s54, 24576
    s_waitcnt lgkmcnt(1)
    buffer_store_dwordx4 v[148:151], v15, s[36:39], s54 offen sc1
    s_mov_b32 s54, 32768
    s_waitcnt lgkmcnt(0)
    buffer_store_dwordx4 v[152:155], v15, s[36:39], s54 offen sc1
    s_and_b32 s44, s2, 7
    s_lshl_b32 s44, s44, 5
    s_lshr_b32 s54, s2, 3
    s_add_u32 s44, s44, s54
    s_mul_i32 s45, s44, 625
    s_add_u32 s46, s45, 640
    s_add_u32 s45, s45, 15
    s_lshr_b32 s45, s45, 4
    s_lshr_b32 s46, s46, 4
    s_sub_u32 s46, s46, s45
    v_bfe_i32 v168, v1, 2, 1
    v_and_b32 v168, 0xaaaa, v168
    v_add_u32 v168, 0x4444, v168
    v_mov_b32 v169, 158720
    v_and_b32 v11, 60, v9
    v_add_u32 v11, v11, v169
    ds_write_b32 v11, v13
    v_and_b32 v11, 4, v1
    v_lshlrev_b32 v11, 2, v11
    v_mov_b32 v12, 0xffff
    v_lshlrev_b32 v12, v11, v12
    v_bfe_i32 v11, v1, 3, 1
    v_and_b32 v191, v11, v12
    v_xor_b32 v190, v191, v12
    v_mov_b32 v11, 0x0c0c0c0c
    v_mov_b32 v12, 0x03020302
    v_bfi_b32 v254, v190, v12, v11
    v_bfi_b32 v255, v191, v12, v11
    v_mov_b32 v12, 0x01000100
    v_bfi_b32 v190, v190, v12, v11
    v_bfi_b32 v191, v191, v12, v11
    v_lshrrev_b32 v200, 5, v1
    v_lshlrev_b32 v200, 4, v200
    v_add_u32 v200, 101376, v200
    v_and_b32 v201, 15, v1
    v_lshlrev_b32 v201, 2, v201
    v_bfe_u32 v11, v1, 3, 2
    v_and_b32 v12, 3, v1
    v_lshl_add_u32 v11, v11, 2, v12
    v_lshlrev_b32 v202, 2, v11
    v_bfe_i32 v240, v0, 0, 1
    s_lshl_b32 s54, s3, 10
    v_and_b32 v241, 4, v240
    v_add_u32 v241, s54, v241
    v_lshl_add_u32 v242, v1, 2, s54
    v_lshrrev_b32 v243, 1, v1
    v_lshl_add_u32 v243, v243, 2, s54
    v_mul_u32_u24 v244, 12, v1
    v_and_b32 v245, 12, v242
    v_and_b32 v250, 124, v242
    s_mul_i32 s54, s3, 224
    v_add_u32 v247, s54, v1
    v_lshlrev_b32 v246, 3, v247
    v_add_u32 v246, 87040, v246
    v_lshlrev_b32 v247, 21, v247
    s_mul_i32 s54, s3, 640
    v_add_u32 v248, s54, v250
    v_sub_u32 v249, 63, v1
    s_getreg_b32 s86, hwreg(HW_REG_XCC_ID, 0, 3)
    s_lshl_b32 s54, s86, 4
    v_subrev_u32 v250, s54, v250
    v_and_b32 v250, 124, v250
    v_min_u32 v251, 39, v1
    v_lshlrev_b32 v251, 7, v251
    v_mov_b32 v253, 0x380
    v_lshrrev_b32 v252, 3, v1
    v_mul_u32_u24 v252, 64, v252
    v_add_u32 v252, 78848, v252
    s_lshr_b32 s87, s3, 1
    s_mul_i32 s87, s87, 3
    s_min_u32 s87, s87, 8
    s_mul_i32 s54, s87, 4608
    v_and_b32 v11, 15, v1
    v_lshrrev_b32 v12, 4, v1
    v_mul_u32_u24 v213, 288, v11
    v_lshl_add_u32 v213, v12, 4, v213
    v_add_u32 v213, s54, v213
    v_lshrrev_b32 v12, 3, v1
    v_lshlrev_b32 v12, 9, v12
    v_and_b32 v11, 7, v1
    v_lshl_add_u32 v214, v11, 4, v12
    s_lshl_b32 s87, s87, 12
    s_and_b32 s54, s3, 1
    s_lshl_b32 s54, s54, 7
    s_add_u32 s87, s87, s54
    s_lshl_b32 s54, s54, 7
    s_add_u32 s54, s54, 46080
    v_add_u32 v215, s54, v2
    s_cmp_eq_u32 s46, 40
    v_mov_b32 v203, 0
    s_mov_b32 s54, 685900808
    s_cselect_b32 s54, 568459824, s54
    s_mov_b32 exec_lo, 31
    s_mov_b32 exec_hi, 0
    v_mov_b32 v203, s54
    s_mov_b32 s54, 182814793
    s_cselect_b32 s54, 23232528, s54
    s_mov_b32 exec_lo, 992
    s_mov_b32 exec_hi, 0
    v_mov_b32 v203, s54
    s_mov_b32 s54, 984091248
    s_cselect_b32 s54, 719688297, s54
    s_mov_b32 exec_lo, 31744
    s_mov_b32 exec_hi, 0
    v_mov_b32 v203, s54
    s_mov_b32 s54, 424091761
    s_cselect_b32 s54, 984423522, s54
    s_mov_b32 exec_lo, 1015808
    s_mov_b32 exec_hi, 0
    v_mov_b32 v203, s54
    s_mov_b32 s54, 586001611
    s_cselect_b32 s54, 172635826, s54
    s_mov_b32 exec_lo, 32505856
    s_mov_b32 exec_hi, 0
    v_mov_b32 v203, s54
    s_mov_b32 s54, 64039106
    s_cselect_b32 s54, 454017211, s54
    s_mov_b32 exec_lo, 1040187392
    s_mov_b32 exec_hi, 0
    v_mov_b32 v203, s54
    s_mov_b32 s54, 330320603
    s_cselect_b32 s54, 743654643, s54
    s_mov_b32 exec_lo, 3221225472
    s_mov_b32 exec_hi, 7
    v_mov_b32 v203, s54
    s_mov_b32 s54, 217139484
    s_cselect_b32 s54, 607143691, s54
    s_mov_b32 exec_lo, 0
    s_mov_b32 exec_hi, 248
    v_mov_b32 v203, s54
    s_mov_b64 exec, -1
    v_mul_u32_u24 v11, 52, v1
    v_lshrrev_b32 v11, 8, v11
    v_mad_i32_i24 v11, v11, -5, v1
    v_mul_u32_u24 v11, 6, v11
    v_lshrrev_b32 v203, v11, v203
    v_and_b32 v11, 7, v203
    v_bfe_u32 v203, v203, 3, 3
    v_lshlrev_b32 v11, 12, v11
    v_lshl_or_b32 v203, v203, 7, v11
    s_add_u32 s24, s14, 1048576
    s_addc_u32 s25, s15, 0
    s_mov_b32 s26, 3932160
    s_mov_b32 s27, 0x20000
    v_mov_b32 v16, 0
    v_mov_b32 v17, 0
    v_mov_b32 v18, 0
    v_mov_b32 v19, 0
    v_mov_b32 v20, 0
    v_mov_b32 v21, 0
    v_mov_b32 v22, 0
    v_mov_b32 v23, 0
    v_mov_b32 v24, 0
    v_mov_b32 v25, 0
    v_mov_b32 v26, 0
    v_mov_b32 v27, 0
    v_mov_b32 v28, 0
    v_mov_b32 v29, 0
    v_mov_b32 v30, 0
    v_mov_b32 v31, 0
    v_mov_b32 v32, 0
    v_mov_b32 v33, 0
    v_mov_b32 v34, 0
    v_mov_b32 v35, 0
    v_mov_b32 v36, 0
    v_mov_b32 v37, 0
    v_mov_b32 v38, 0
    v_mov_b32 v39, 0
    v_mov_b32 v40, 0
    v_mov_b32 v41, 0
    v_mov_b32 v42, 0
    v_mov_b32 v43, 0
    v_mov_b32 v44, 0
    v_mov_b32 v45, 0
    v_mov_b32 v46, 0
    v_mov_b32 v47, 0
    v_mov_b32 v48, 0
    v_mov_b32 v49, 0
    v_mov_b32 v50, 0
    v_mov_b32 v51, 0
    v_mov_b32 v52, 0
    v_mov_b32 v53, 0
    v_mov_b32 v54, 0
    v_mov_b32 v55, 0
    v_mov_b32 v56, 0
    v_mov_b32 v57, 0
    v_mov_b32 v58, 0
    v_mov_b32 v59, 0
    v_mov_b32 v60, 0
    v_mov_b32 v61, 0
    v_mov_b32 v62, 0
    v_mov_b32 v63, 0
    s_lshl_b32 s54, s2, 3
    s_add_u32 s54, s54, s3
    s_lshl_b32 s54, s54, 8
    s_mov_b32 s16, s64
    s_mov_b32 s17, s65
    s_mov_b32 s18, 10240000
    s_mov_b32 s19, 0x20000
    s_add_u32 s28, s14, 5242880
    s_addc_u32 s29, s15, 0
    s_mov_b32 s30, 10485760
    s_mov_b32 s31, 0x20000
    s_and_b32 s51, s86, 7
    s_mul_i32 s51, s51, 1282048
    s_and_b32 s55, s2, 0xf8
    s_add_u32 s55, s55, s3
    s_mul_i32 s55, s55, 2304
    s_add_u32 s51, s51, s55
    v_min_u32 v14, 17, v1
    v_lshlrev_b32 v14, 7, v14
    s_waitcnt vmcnt(0)
    s_barrier
    s_mov_b64 exec, 0xffff
    buffer_store_dwordx4 v[112:115], v2, s[20:23], s54 offen sc1
    s_mov_b64 exec, -1
    buffer_load_dword v7, v14, s[16:19], s51 offen
    s_lshl_b32 s54, s45, 10
    s_add_u32 s40, s12, s54
    s_addc_u32 s41, s13, 0
    s_lshl_b32 s42, s46, 10
    s_mov_b32 s43, 0x20000
    v_lshrrev_b32 v8, 5, v1
    v_lshlrev_b32 v8, 10, v8
    v_and_b32 v9, 15, v1
    v_lshl_add_u32 v8, v9, 4, v8
    ds_read_b128 v[64:67], v8 offset:17408
    ds_read_b128 v[68:71], v8 offset:17664
    ds_read_b128 v[72:75], v8 offset:17920
    ds_read_b128 v[76:79], v8 offset:18176
    ds_read_b128 v[80:83], v8 offset:19456
    ds_read_b128 v[84:87], v8 offset:19712
    ds_read_b128 v[88:91], v8 offset:19968
    ds_read_b128 v[92:95], v8 offset:20224
    v_lshrrev_b32 v8, 4, v1
    v_lshlrev_b32 v8, 5, v8
    v_and_b32 v9, 3, v1
    v_lshl_add_u32 v8, v9, 1, v8
    ds_read_u16 v96, v8 offset:21504
    ds_read_u16 v97, v8 offset:21512
    ds_read_u16 v98, v8 offset:21520
    ds_read_u16 v99, v8 offset:21528
    v_bfe_i32 v10, v1, 4, 1
    v_and_b32 v10, 0x02020202, v10
    v_add_u32 v10, 0x05040100, v10
    s_waitcnt lgkmcnt(0)
    v_perm_b32 v172, v68, v64, v10
    v_perm_b32 v174, v76, v72, v10
    v_perm_b32 v176, v84, v80, v10
    v_perm_b32 v178, v92, v88, v10
    v_perm_b32 v173, v69, v65, v10
    v_perm_b32 v175, v77, v73, v10
    v_perm_b32 v177, v85, v81, v10
    v_perm_b32 v179, v93, v89, v10
    v_perm_b32 v180, v70, v66, v10
    v_perm_b32 v182, v78, v74, v10
    v_perm_b32 v184, v86, v82, v10
    v_perm_b32 v186, v94, v90, v10
    v_perm_b32 v181, v71, v67, v10
    v_perm_b32 v183, v79, v75, v10
    v_perm_b32 v185, v87, v83, v10
    v_perm_b32 v187, v95, v91, v10
    v_lshl_or_b32 v188, v97, 16, v96
    v_lshl_or_b32 v189, v99, 16, v98
    v_and_b32 v9, 7, v1
    v_lshrrev_b32 v8, 4, v1
    v_lshlrev_b32 v8, 13, v8
    v_lshl_add_u32 v8, v9, 4, v8
    v_and_b32 v9, 8, v1
    s_and_b32 s72, s3, 3
    s_lshl_b32 s72, s72, 8
    s_lshr_b32 s73, s3, 2
    s_lshl_b32 s73, s73, 7
    s_add_u32 s72, s72, s73
    s_add_u32 s72, s72, 46080
    v_add3_u32 v8, v8, v9, s72
    ds_read2st64_b64 v[128:131], v8 offset0:0 offset1:2
    ds_read2st64_b64 v[132:135], v8 offset0:4 offset1:6
    ds_read2st64_b64 v[136:139], v8 offset0:8 offset1:10
    ds_read2st64_b64 v[140:143], v8 offset0:12 offset1:14
    s_mov_b32 s72, 0x05040100
    s_mov_b32 s73, 0x07060302
    s_waitcnt lgkmcnt(3)
    v_perm_b32 v144, v130, v128, s72
    v_perm_b32 v148, v130, v128, s73
    v_perm_b32 v152, v131, v129, s72
    v_perm_b32 v156, v131, v129, s73
    s_waitcnt lgkmcnt(2)
    v_perm_b32 v145, v134, v132, s72
    v_perm_b32 v149, v134, v132, s73
    v_perm_b32 v153, v135, v133, s72
    v_perm_b32 v157, v135, v133, s73
    s_waitcnt lgkmcnt(1)
    v_perm_b32 v146, v138, v136, s72
    v_perm_b32 v150, v138, v136, s73
    v_perm_b32 v154, v139, v137, s72
    v_perm_b32 v158, v139, v137, s73
    s_waitcnt lgkmcnt(0)
    v_perm_b32 v147, v142, v140, s72
    v_perm_b32 v151, v142, v140, s73
    v_perm_b32 v155, v143, v141, s72
    v_perm_b32 v159, v143, v141, s73
    v_mov_b32 v64, 0
    v_mov_b32 v65, 0
    v_mov_b32 v66, 0
    v_mov_b32 v67, 0
    v_mov_b32 v68, 0
    v_mov_b32 v69, 0
    v_mov_b32 v70, 0
    v_mov_b32 v71, 0
    v_mov_b32 v72, 0
    v_mov_b32 v73, 0
    v_mov_b32 v74, 0
    v_mov_b32 v75, 0
    v_mov_b32 v76, 0
    v_mov_b32 v77, 0
    v_mov_b32 v78, 0
    v_mov_b32 v79, 0
    v_mov_b32 v80, 0
    v_mov_b32 v81, 0
    v_mov_b32 v82, 0
    v_mov_b32 v83, 0
    v_mov_b32 v84, 0
    v_mov_b32 v85, 0
    v_mov_b32 v86, 0
    v_mov_b32 v87, 0
    v_mov_b32 v88, 0
    v_mov_b32 v89, 0
    v_mov_b32 v90, 0
    v_mov_b32 v91, 0
    v_mov_b32 v92, 0
    v_mov_b32 v93, 0
    v_mov_b32 v94, 0
    v_mov_b32 v95, 0
    s_lshl_b32 s54, s3, 12
    v_add_u32 v8, s54, v2
    v_lshrrev_b32 v9, 1, v0
    v_lshlrev_b32 v10, 11, v9
    s_lshl_b32 s49, s44, 3
    v_mul_u32_u24 v5, 1280, v9
    s_mov_b32 s48, 0
    s_mov_b32 s53, 200000
    s_mov_b32 s55, 0xffc00000
    s_mul_i32 s52, s3, 7168
    s_add_u32 s52, s52, 101376
    s_movk_i32 s98, 4096
    s_waitcnt vmcnt(0)
    s_barrier
    buffer_load_dwordx2 v[206:207], v10, s[20:23], s49 offen sc1
    ds_write_b128 v8, v[144:147] offset:46080
    ds_write_b128 v8, v[148:151] offset:47104
    ds_write_b128 v8, v[152:155] offset:48128
    ds_write_b128 v8, v[156:159] offset:49152
    s_waitcnt vmcnt(0)
    v_xor_b32 v11, s63, v206
    v_xor_b32 v12, s62, v207
    v_and_or_b32 v11, v11, s55, v12
    v_cmpx_ne_u32 vcc, 0, v11
    s_cbranch_execnz L_poll
L_polled:
    s_mov_b64 exec, -1
    v_bfe_u32 v3, v206, 11, 11
    v_and_b32 v4, v3, v240
    v_add_u32 v10, v3, v240
    v_and_b32 v11, 0x7ff, v206
    v_add_u32_dpp v4, v4, v4 row_shr:1 row_mask:0xf bank_mask:0xf
    v_cmp_lt_i32 s[64:65], 0, v10
    v_cmp_lt_i32 s[66:67], 2, v10
    v_add_u32_dpp v4, v4, v4 row_shr:2 row_mask:0xf bank_mask:0xf
    v_cmp_lt_i32 s[68:69], 4, v10
    v_cmp_lt_i32 s[70:71], 6, v10
    v_add_u32_dpp v4, v4, v4 row_shr:4 row_mask:0xf bank_mask:0xf
    v_cmp_lt_i32 s[72:73], 8, v10
    v_cmp_lt_i32 s[74:75], 10, v10
    v_add_u32_dpp v4, v4, v4 row_shr:8 row_mask:0xf bank_mask:0xf
    v_cmp_lt_i32 s[76:77], 12, v10
    v_cmp_lt_i32 s[78:79], 14, v10
    v_add_u32_dpp v4, v4, v4 row_bcast:15 row_mask:0xa bank_mask:0xf
    v_add_u32 v5, v5, v11
    s_nop 0
    v_add_u32_dpp v4, v4, v4 row_bcast:31 row_mask:0xc bank_mask:0xf
    s_nop 0
    v_readlane_b32 s95, v4, 63
    v_mov_b32_dpp v4, v4 quad_perm:[0,0,2,2] row_mask:0xf bank_mask:0xf
    v_sub_u32 v5, v5, v4
    v_lshl_add_u32 v8, v4, 2, v241
    s_cmp_gt_u32 s95, 224
    s_cbranch_scc1 L_clip
L_mapw:
    s_mov_b64 exec, s[64:65]
    ds_write_b32 v8, v5 offset:0
    s_mov_b64 exec, s[66:67]
    ds_write_b32 v8, v5 offset:8
    s_mov_b64 exec, s[68:69]
    ds_write_b32 v8, v5 offset:16
    s_mov_b64 exec, s[70:71]
    ds_write_b32 v8, v5 offset:24
    s_mov_b64 exec, s[72:73]
    ds_write_b32 v8, v5 offset:32
    s_mov_b64 exec, s[74:75]
    ds_write_b32 v8, v5 offset:40
    s_mov_b64 exec, s[76:77]
    ds_write_b32 v8, v5 offset:48
    s_mov_b64 exec, -1
    s_cmp_lg_u64 s[78:79], 0
    s_cbranch_scc1 L_map2
    ds_read_b32 v136, v242 offset:0
    ds_read_b32 v137, v242 offset:256
    ds_read_b32 v138, v242 offset:512
    ds_read_b32 v140, v243 offset:0
    ds_read_b32 v141, v243 offset:128
    ds_read_b32 v142, v243 offset:256
    ds_read_b32 v143, v243 offset:384
    ds_read_b32 v144, v243 offset:512
    ds_read_b32 v145, v243 offset:640
    s_cmp_gt_i32 s95, 192
    s_cbranch_scc1 L_r1
L_r1b:
    s_waitcnt lgkmcnt(6)
    v_mad_u32_u24 v136, v136, 12, v244
    buffer_load_dwordx3 v[148:150], v136, s[24:27], 0 offen offset:0 sc1
    v_mad_u32_u24 v137, v137, 12, v244
    buffer_load_dwordx3 v[152:154], v137, s[24:27], 0 offen offset:768 sc1
    v_mad_u32_u24 v138, v138, 12, v244
    buffer_load_dwordx3 v[156:158], v138, s[24:27], 0 offen offset:1536 sc1
    v_mov_b32 v11, s95
    s_mov_b64 exec, 1
    ds_max_i32 v13, v11 offset:15360
    s_mov_b64 exec, -1
    s_waitcnt lgkmcnt(1)
    v_lshl_add_u32 v140, v140, 5, v2
    v_lshl_add_u32 v141, v141, 5, v2
    v_lshl_add_u32 v142, v142, 5, v2
    v_lshl_add_u32 v143, v143, 5, v2
    v_lshl_add_u32 v144, v144, 5, v2
    v_lshl_add_u32 v145, v145, 5, v2
    s_barrier
    s_add_u32 m0, s52, 0
    s_nop 0
    buffer_load_dwordx4 v140, s[28:31], 0 offen offset:0 sc1 lds
    buffer_load_dwordx4 v141, s[28:31], 0 offen offset:1024 sc1 lds
    s_min_i32 s54, s95, 224
    v_cmp_gt_i32 s[80:81], s54, v1
    s_sub_i32 s54, s54, 64
    v_cmp_gt_i32 s[82:83], s54, v1
    s_sub_i32 s54, s54, 64
    v_cmp_gt_i32 s[84:85], s54, v1
    s_sub_i32 s54, s54, 64
    v_cmp_gt_i32 s[96:97], s54, v1
    s_sub_i32 s54, s54, 64
    s_mov_b32 s55, 0x1fff80
    s_mul_i32 s61, s3, 5
    ds_read_b128 v[216:219], v215 offset:0
    ds_read_b128 v[220:223], v215 offset:1024
    ds_read_b128 v[224:227], v215 offset:2048
    ds_read_b128 v[228:231], v215 offset:3072
    ds_read_b128 v[232:235], v215 offset:4096
    ds_read_b128 v[236:239], v215 offset:5120
    s_waitcnt vmcnt(4)
    v_lshrrev_b32 v132, 21, v150
    v_lshlrev_b32 v132, 2, v132
    v_lshrrev_b32 v11, 26, v150
    v_lshl_or_b32 v11, v11, 4, v245
    s_mov_b64 exec, s[80:81]
    ds_add_rtn_u32 v128, v132, v6 offset:8192
    ds_add_u32 v11, v6 offset:14336
    s_mov_b64 exec, -1
    s_waitcnt vmcnt(3)
    v_lshrrev_b32 v133, 21, v154
    v_lshlrev_b32 v133, 2, v133
    v_lshrrev_b32 v11, 26, v154
    v_lshl_or_b32 v11, v11, 4, v245
    s_mov_b64 exec, s[82:83]
    ds_add_rtn_u32 v129, v133, v6 offset:8192
    ds_add_u32 v11, v6 offset:14336
    s_mov_b64 exec, -1
    s_waitcnt vmcnt(2)
    v_lshrrev_b32 v134, 21, v158
    v_lshlrev_b32 v134, 2, v134
    v_lshrrev_b32 v11, 26, v158
    v_lshl_or_b32 v11, v11, 4, v245
    s_mov_b64 exec, s[84:85]
    ds_add_rtn_u32 v130, v134, v6 offset:8192
    ds_add_u32 v11, v6 offset:14336
    s_mov_b64 exec, -1
    s_cmp_gt_i32 s95, 192
    s_cbranch_scc1 L_r2
L_r2b:
    s_or_b32 s54, s2, s3
    s_cbranch_scc0 L_tag
L_tagged:
    buffer_load_dwordx4 v142, s[28:31], 0 offen offset:2048 sc1 lds
    s_add_u32 s65, s61, 1
    s_add_u32 s66, s61, 2
    s_add_u32 s67, s61, 3
    s_add_u32 s68, s61, 4
    s_waitcnt lgkmcnt(0)
    s_barrier
    s_cmp_lg_u32 s48, 0
    s_cbranch_scc1 L_rank2
    ds_read_b128 v[104:107], v2 offset:14336
    ds_read_b32 v96, v248 offset:8192
    ds_read_b32 v97, v248 offset:8320
    ds_read_b32 v98, v248 offset:8448
    ds_read_b32 v99, v248 offset:8576
    ds_read_b32 v100, v248 offset:8704
    ds_read_b32 v14, v13 offset:15360
    ds_write_b64 v246, v[148:149] offset:0
    v_and_or_b32 v150, v150, s55, v247
    ds_write_b64 v246, v[152:153] offset:512
    v_and_or_b32 v154, v154, s55, v247
    v_add_u32 v154, 134217728, v154
    ds_write_b64 v246, v[156:157] offset:1024
    v_and_or_b32 v158, v158, s55, v247
    v_add_u32 v158, 268435456, v158
    s_waitcnt lgkmcnt(9)
    v_add_u32 v9, v104, v105
    v_add3_u32 v9, v9, v106, v107
    v_lshl_or_b32 v9, v9, 6, v249
    s_nop 0
    v_readlane_b32 s64, v9, s61
    v_readlane_b32 s65, v9, s65
    v_readlane_b32 s66, v9, s66
    v_readlane_b32 s67, v9, s67
    v_readlane_b32 s68, v9, s68
    v_cmp_lt_u32 s[70:71], s64, v9
    v_cmp_lt_u32 s[72:73], s65, v9
    v_cmp_lt_u32 s[74:75], s66, v9
    v_cmp_lt_u32 s[76:77], s67, v9
    v_cmp_lt_u32 s[78:79], s68, v9
    s_bcnt1_i32_b64 s64, s[70:71]
    s_bcnt1_i32_b64 s65, s[72:73]
    s_bcnt1_i32_b64 s66, s[74:75]
    s_bcnt1_i32_b64 s67, s[76:77]
    s_bcnt1_i32_b64 s68, s[78:79]
    s_waitcnt lgkmcnt(3)
    v_readlane_b32 s90, v203, s64
    v_readlane_b32 s91, v203, s65
    v_readlane_b32 s92, v203, s66
    v_readlane_b32 s93, v203, s67
    v_readlane_b32 s94, v203, s68
    v_readfirstlane_b32 s47, v14
L_ranked:
    s_mov_b32 exec_hi, 0
    v_and_or_b32 v104, s90, v253, v250
    ds_add_rtn_u32 v96, v104, v96 offset:13312
    v_and_or_b32 v105, s91, v253, v250
    ds_add_rtn_u32 v97, v105, v97 offset:13312
    v_and_or_b32 v106, s92, v253, v250
    ds_add_rtn_u32 v98, v106, v98 offset:13312
    v_and_or_b32 v107, s93, v253, v250
    ds_add_rtn_u32 v99, v107, v99 offset:13312
    v_and_or_b32 v108, s94, v253, v250
    ds_add_rtn_u32 v100, v108, v100 offset:13312
    v_or_b32 v104, s90, v250
    v_or_b32 v105, s91, v250
    v_or_b32 v106, s92, v250
    v_or_b32 v107, s93, v250
    v_or_b32 v108, s94, v250
    s_lshl_b32 s54, s3, 3
    s_add_u32 s61, s54, 7
    s_waitcnt lgkmcnt(3)
    v_lshl_or_b32 v96, v96, 16, v104
    ds_write_b32 v248, v96 offset:8192
    v_lshl_or_b32 v97, v97, 16, v105
    ds_write_b32 v248, v97 offset:8320
    s_waitcnt lgkmcnt(2)
    v_lshl_or_b32 v98, v98, 16, v106
    ds_write_b32 v248, v98 offset:8448
    v_lshl_or_b32 v99, v99, 16, v107
    ds_write_b32 v248, v99 offset:8576
    v_lshl_or_b32 v100, v100, 16, v108
    ds_write_b32 v248, v100 offset:8704
    s_mov_b32 exec_hi, -1
    buffer_load_dwordx4 v143, s[28:31], 0 offen offset:3072 sc1 lds
    s_add_u32 m0, s52, 4096
    s_nop 0
    buffer_load_dwordx4 v144, s[28:31], s98 offen offset:0 sc1 lds
    s_waitcnt lgkmcnt(0)
    s_barrier
    ds_read_b128 v[96:99], v2 offset:13312
    ds_read_b32 v132, v132 offset:8192
    ds_read_b32 v133, v133 offset:8192
    ds_read_b32 v134, v134 offset:8192
    s_waitcnt lgkmcnt(3)
    v_add_u32 v9, v96, v97
    v_add3_u32 v9, v9, v98, v99
    v_mov_b32 v10, v9
    s_waitcnt lgkmcnt(0)
    v_bfe_u32 v15, v132, 12, 3
    v_add_u32_dpp v10, v10, v10 row_shr:1 row_mask:0xf bank_mask:0xf
    v_or_b32 v150, v15, v150
    v_and_b32 v136, 0x3ff, v132
    v_add_u32_dpp v10, v10, v10 row_shr:2 row_mask:0xf bank_mask:0xf
    v_lshrrev_b32 v132, 16, v132
    v_add_u32 v132, v132, v128
    v_add_u32_dpp v10, v10, v10 row_shr:4 row_mask:0xf bank_mask:0xf
    v_bfe_u32 v15, v133, 12, 3
    v_or_b32 v154, v15, v154
    v_add_u32_dpp v10, v10, v10 row_shr:8 row_mask:0xf bank_mask:0xf
    v_and_b32 v137, 0x3ff, v133
    v_lshrrev_b32 v133, 16, v133
    v_add_u32_dpp v10, v10, v10 row_bcast:15 row_mask:0xa bank_mask:0xf
    v_add_u32 v133, v133, v129
    v_bfe_u32 v15, v134, 12, 3
    v_add_u32_dpp v10, v10, v10 row_bcast:31 row_mask:0xc bank_mask:0xf
    v_or_b32 v158, v15, v158
    v_and_b32 v138, 0x3ff, v134
    v_sub_u32 v9, v10, v9
    v_lshl_add_u32 v104, v9, 2, v252
    v_lshl_add_u32 v105, v96, 2, v104
    v_lshl_add_u32 v106, v97, 2, v105
    v_lshl_add_u32 v107, v98, 2, v106
    ds_write_b128 v2, v[104:107] offset:16384
    ds_read_b32 v136, v136 offset:16384
    ds_read_b32 v137, v137 offset:16384
    ds_read_b32 v138, v138 offset:16384
    v_lshrrev_b32 v134, 16, v134
    v_add_u32 v134, v134, v130
    v_readlane_b32 s50, v10, s61
    v_readlane_b32 s53, v9, s54
    v_readlane_b32 s51, v104, s54
    v_mov_b32 v14, 2097029
    s_sub_u32 s50, s50, s53
    s_lshl2_add_u32 s55, s50, s51
    v_add_u32 v9, s55, v201
    ds_write_b32 v9, v14
    s_add_u32 s53, s50, 15
    s_lshr_b32 s53, s53, 4
    s_sub_u32 s54, 0, s50
    s_and_b32 s54, s54, 14
    s_sub_u32 s53, s53, 1
    s_cmp_gt_i32 s53, 0
    s_cselect_b32 s54, s54, 0
    s_lshl_b32 s61, s54, 2
    s_sub_u32 s51, s51, s61
    s_waitcnt lgkmcnt(1)
    v_lshl_add_u32 v132, v132, 2, v136
    v_lshl_add_u32 v133, v133, 2, v137
    v_lshl_add_u32 v134, v134, 2, v138
    s_mov_b64 exec, s[80:81]
    ds_write_b32 v132, v150
    s_mov_b64 exec, s[82:83]
    ds_write_b32 v133, v154
    s_mov_b64 exec, s[84:85]
    ds_write_b32 v134, v158
    s_mov_b64 exec, -1
    s_cmp_gt_i32 s95, 192
    s_cbranch_scc1 L_r3
L_r3b:
    buffer_load_dwordx4 v145, s[28:31], s98 offen offset:1024 sc1 lds
    v_add_u32 v198, s51, v201
    v_add_u32 v199, s51, v202
    s_and_b32 s61, s61, 32
    v_add_u32 v12, s61, v198
    s_and_b32 s72, s54, 6
    s_mov_b32 s55, 0x00fffc38
    s_mov_b32 s49, 0xffffff00
    s_mov_b32 s51, 87040
    s_cmp_lt_u32 s3, 4
    s_cbranch_scc1 L_np
    s_setprio 1
L_np:
    s_waitcnt lgkmcnt(0)
    s_barrier
    ds_read_b32 v196, v12
    ds_read_b32 v194, v199
    ds_read_b32 v197, v198 offset:24
    ds_read_b32 v205, v251 offset:8192
    s_cmp_eq_u32 s50, 0
    s_cbranch_scc1 L_empty
    s_waitcnt lgkmcnt(3)
    v_lshlrev_b32 v196, 3, v196
    v_and_b32 v196, s55, v196
    s_cmp_eq_u32 s72, 2
    s_cbranch_scc1 L_p2
    s_cmp_eq_u32 s72, 4
    s_cbranch_scc1 L_p4
    s_cmp_eq_u32 s72, 6
    s_cbranch_scc1 L_p6
L_p0:
    v_readlane_b32 s64, v196, 0
    v_readlane_b32 s65, v196, 1
    s_and_b32 s61, s64, s49
    buffer_load_dwordx4 v[96:99], v2, s[16:19], s61 offen
    s_and_b32 s61, s65, s49
    buffer_load_dwordx4 v[100:103], v2, s[16:19], s61 offen
    s_waitcnt vmcnt(2) lgkmcnt(0)
    s_barrier
    v_lshrrev_b32 v8, 21, v194
    v_lshl_add_u32 v11, v8, 3, s51
    v_lshl_add_u32 v8, v8, 5, v200
    ds_read_b64 v[192:193], v11
    ds_read_b128 v[164:167], v8
    v_readlane_b32 s66, v196, 2
    v_readlane_b32 s67, v196, 3
    s_and_b32 s61, s66, s49
    buffer_load_dwordx4 v[104:107], v2, s[16:19], s61 offen
    s_and_b32 s61, s67, s49
    buffer_load_dwordx4 v[108:111], v2, s[16:19], s61 offen
    v_readlane_b32 s68, v196, 4
    v_readlane_b32 s69, v196, 5
    s_and_b32 s61, s68, s49
    buffer_load_dwordx4 v[112:115], v2, s[16:19], s61 offen
    s_and_b32 s61, s69, s49
    buffer_load_dwordx4 v[116:119], v2, s[16:19], s61 offen
    s_branch L_pd
L_p2:
    v_readlane_b32 s66, v196, 2
    v_readlane_b32 s67, v196, 3
    s_and_b32 s61, s66, s49
    buffer_load_dwordx4 v[104:107], v2, s[16:19], s61 offen
    s_and_b32 s61, s67, s49
    buffer_load_dwordx4 v[108:111], v2, s[16:19], s61 offen
    s_waitcnt vmcnt(2) lgkmcnt(0)
    s_barrier
    v_lshrrev_b32 v8, 21, v194
    v_lshl_add_u32 v11, v8, 3, s51
    v_lshl_add_u32 v8, v8, 5, v200
    ds_read_b64 v[192:193], v11
    ds_read_b128 v[164:167], v8
    v_readlane_b32 s68, v196, 4
    v_readlane_b32 s69, v196, 5
    s_and_b32 s61, s68, s49
    buffer_load_dwordx4 v[112:115], v2, s[16:19], s61 offen
    s_and_b32 s61, s69, s49
    buffer_load_dwordx4 v[116:119], v2, s[16:19], s61 offen
    v_readlane_b32 s70, v196, 6
    v_readlane_b32 s71, v196, 7
    s_and_b32 s61, s70, s49
    buffer_load_dwordx4 v[120:123], v2, s[16:19], s61 offen
    s_and_b32 s61, s71, s49
    buffer_load_dwordx4 v[124:127], v2, s[16:19], s61 offen
    s_branch L_pd
L_p4:
    v_readlane_b32 s68, v196, 4
    v_readlane_b32 s69, v196, 5
    s_and_b32 s61, s68, s49
    buffer_load_dwordx4 v[112:115], v2, s[16:19], s61 offen
    s_and_b32 s61, s69, s49
    buffer_load_dwordx4 v[116:119], v2, s[16:19], s61 offen
    s_waitcnt vmcnt(2) lgkmcnt(0)
    s_barrier
    v_lshrrev_b32 v8, 21, v194
    v_lshl_add_u32 v11, v8, 3, s51
    v_lshl_add_u32 v8, v8, 5, v200
    ds_read_b64 v[192:193], v11
    ds_read_b128 v[164:167], v8
    v_readlane_b32 s70, v196, 6
    v_readlane_b32 s71, v196, 7
    s_and_b32 s61, s70, s49
    buffer_load_dwordx4 v[120:123], v2, s[16:19], s61 offen
    s_and_b32 s61, s71, s49
    buffer_load_dwordx4 v[124:127], v2, s[16:19], s61 offen
    v_readlane_b32 s64, v196, 8
    v_readlane_b32 s65, v196, 9
    s_and_b32 s61, s64, s49
    buffer_load_dwordx4 v[96:99], v2, s[16:19], s61 offen
    s_and_b32 s61, s65, s49
    buffer_load_dwordx4 v[100:103], v2, s[16:19], s61 offen
    s_branch L_pd
L_p6:
    v_readlane_b32 s70, v196, 6
    v_readlane_b32 s71, v196, 7
    s_and_b32 s61, s70, s49
    buffer_load_dwordx4 v[120:123], v2, s[16:19], s61 offen
    s_and_b32 s61, s71, s49
    buffer_load_dwordx4 v[124:127], v2, s[16:19], s61 offen
    s_waitcnt vmcnt(2) lgkmcnt(0)
    s_barrier
    v_lshrrev_b32 v8, 21, v194
    v_lshl_add_u32 v11, v8, 3, s51
    v_lshl_add_u32 v8, v8, 5, v200
    ds_read_b64 v[192:193], v11
    ds_read_b128 v[164:167], v8
    v_readlane_b32 s64, v196, 8
    v_readlane_b32 s65, v196, 9
    s_and_b32 s61, s64, s49
    buffer_load_dwordx4 v[96:99], v2, s[16:19], s61 offen
    s_and_b32 s61, s65, s49
    buffer_load_dwordx4 v[100:103], v2, s[16:19], s61 offen
    v_readlane_b32 s66, v196, 10
    v_readlane_b32 s67, v196, 11
    s_and_b32 s61, s66, s49
    buffer_load_dwordx4 v[104:107], v2, s[16:19], s61 offen
    s_and_b32 s61, s67, s49
    buffer_load_dwordx4 v[108:111], v2, s[16:19], s61 offen
L_pd:
    s_waitcnt lgkmcnt(0)
    v_mfma_f32_4x4x4_16b_bf16 v[144:147], v[192:193], v[188:189], 0 cbsz:4 abid:0
    v_mfma_f32_4x4x4_16b_bf16 v[148:151], v[192:193], v[188:189], 0 cbsz:4 abid:2
    v_mfma_f32_4x4x4_16b_bf16 v[152:155], v[192:193], v[188:189], 0 cbsz:4 abid:4
    v_mfma_f32_4x4x4_16b_bf16 v[156:159], v[192:193], v[188:189], 0 cbsz:4 abid:6
    v_lshlrev_b32 v196, 3, v197
    v_and_b32 v196, s55, v196
    v_add_u32 v198, 64, v198
    v_add_u32 v199, 64, v199
    v_smfmac_f32_32x32x32_bf16 v[64:79], v[164:167], v[172:179], v168
    ds_read_b32 v197, v198 offset:24
    ds_read_b32 v194, v199
    v_smfmac_f32_32x32x32_bf16 v[80:95], v[164:167], v[180:187], v168
    s_set_gpr_idx_on s54, gpr_idx(SRC0,SRC1)
    v_cvt_pk_bf16_f32 v9, v144, v145
    s_set_gpr_idx_off
    v_perm_b32 v160, v9, v9, v190
    v_perm_b32 v161, v9, v9, v191
    s_waitcnt lgkmcnt(0)
    v_lshrrev_b32 v8, 21, v194
    v_lshl_add_u32 v11, v8, 3, s51
    v_lshl_add_u32 v8, v8, 5, v200
    ds_read_b64 v[192:193], v11
    ds_read_b128 v[164:167], v8
    s_cmp_eq_u32 s53, 0
    s_cbranch_scc1 L_f0
    s_cmp_eq_u32 s54, 0
    s_cbranch_scc1 L_j0
    s_cmp_eq_u32 s54, 2
    s_cbranch_scc1 L_j2
    ds_read_b128 v[64:67], v169
    ds_read_b128 v[80:83], v169
    s_cmp_eq_u32 s54, 4
    s_cbranch_scc1 L_j4
    s_cmp_eq_u32 s54, 6
    s_cbranch_scc1 L_j6
    ds_read_b128 v[68:71], v169
    ds_read_b128 v[84:87], v169
    s_cmp_eq_u32 s54, 8
    s_cbranch_scc1 L_j8
    s_cmp_eq_u32 s54, 10
    s_cbranch_scc1 L_j10
    ds_read_b128 v[72:75], v169
    ds_read_b128 v[88:91], v169
    s_cmp_eq_u32 s54, 12
    s_cbranch_scc1 L_j12
    s_branch L_j14
.p2align 3
L_loop:
    s_waitcnt lgkmcnt(2)
    v_mfma_f32_4x4x4_16b_bf16 v[144:147], v[192:193], v[188:189], 0 cbsz:4 abid:0
    v_mfma_f32_4x4x4_16b_bf16 v[148:151], v[192:193], v[188:189], 0 cbsz:4 abid:2
    v_mfma_f32_4x4x4_16b_bf16 v[152:155], v[192:193], v[188:189], 0 cbsz:4 abid:4
    v_mfma_f32_4x4x4_16b_bf16 v[156:159], v[192:193], v[188:189], 0 cbsz:4 abid:6
    v_lshlrev_b32 v196, 3, v197
    v_and_b32 v196, s55, v196
    v_add_u32 v198, 64, v198
    v_add_u32 v199, 64, v199
    s_waitcnt lgkmcnt(0)
    v_smfmac_f32_32x32x32_bf16 v[64:79], v[164:167], v[172:179], v168
    ds_read_b32 v197, v198 offset:24
    ds_read_b32 v194, v199
    v_cvt_pk_bf16_f32 v9, v144, v145
    v_perm_b32 v160, v9, v9, v190
    v_perm_b32 v161, v9, v9, v191
    v_smfmac_f32_32x32x32_bf16 v[80:95], v[164:167], v[180:187], v168
L_j0:
    s_waitcnt vmcnt(5)
    v_mfma_f32_16x16x16_bf16 v[128:131], v[160:161], v[96:97], 0
    v_readlane_b32 s70, v196, 0
    v_perm_b32 v162, v9, v9, v254
    v_mfma_f32_16x16x16_bf16 v[132:135], v[160:161], v[98:99], 0
    v_perm_b32 v163, v9, v9, v255
    s_and_b32 s61, s70, s49
    s_waitcnt vmcnt(4)
    buffer_load_dwordx4 v[120:123], v2, s[16:19], s61 offen
    v_mfma_f32_16x16x16_bf16 v[136:139], v[162:163], v[100:101], 0
    v_readlane_b32 s71, v196, 1
    v_cvt_pk_bf16_f32 v9, v146, v147
    v_mfma_f32_16x16x16_bf16 v[140:143], v[162:163], v[102:103], 0
    v_perm_b32 v160, v9, v9, v190
    v_perm_b32 v161, v9, v9, v191
    s_and_b32 s61, s71, s49
    s_set_gpr_idx_on s64, gpr_idx(SRC2,DST)
    buffer_load_dwordx4 v[124:127], v2, s[16:19], s61 offen
    v_pk_fma_f32 v[16:17], v[128:129], v[64:65], v[16:17] op_sel_hi:[1,0,1]
    v_pk_fma_f32 v[18:19], v[130:131], v[64:65], v[18:19] op_sel_hi:[1,0,1]
    v_pk_fma_f32 v[20:21], v[132:133], v[80:81], v[20:21] op_sel_hi:[1,0,1]
    v_pk_fma_f32 v[22:23], v[134:135], v[80:81], v[22:23] op_sel_hi:[1,0,1]
    s_set_gpr_idx_idx s65
    v_pk_fma_f32 v[16:17], v[136:137], v[64:65], v[16:17] op_sel:[0,1,0] op_sel_hi:[1,1,1]
    v_pk_fma_f32 v[18:19], v[138:139], v[64:65], v[18:19] op_sel:[0,1,0] op_sel_hi:[1,1,1]
    v_pk_fma_f32 v[20:21], v[140:141], v[80:81], v[20:21] op_sel:[0,1,0] op_sel_hi:[1,1,1]
    v_pk_fma_f32 v[22:23], v[142:143], v[80:81], v[22:23] op_sel:[0,1,0] op_sel_hi:[1,1,1]
    s_set_gpr_idx_off
L_j2:
    s_waitcnt vmcnt(5)
    v_mfma_f32_16x16x16_bf16 v[128:131], v[160:161], v[104:105], 0
    v_readlane_b32 s64, v196, 2
    v_perm_b32 v162, v9, v9, v254
    v_mfma_f32_16x16x16_bf16 v[132:135], v[160:161], v[106:107], 0
    v_perm_b32 v163, v9, v9, v255
    s_and_b32 s61, s64, s49
    s_waitcnt vmcnt(4)
    buffer_load_dwordx4 v[96:99], v2, s[16:19], s61 offen
    v_mfma_f32_16x16x16_bf16 v[136:139], v[162:163], v[108:109], 0
    v_readlane_b32 s65, v196, 3
    v_cvt_pk_bf16_f32 v9, v148, v149
    v_mfma_f32_16x16x16_bf16 v[140:143], v[162:163], v[110:111], 0
    v_perm_b32 v160, v9, v9, v190
    v_perm_b32 v161, v9, v9, v191
    s_waitcnt lgkmcnt(0)
    v_lshrrev_b32 v8, 21, v194
    v_lshl_add_u32 v11, v8, 3, s51
    v_lshl_add_u32 v8, v8, 5, v200
    ds_read_b64 v[192:193], v11
    ds_read_b128 v[164:167], v8
    s_and_b32 s61, s65, s49
    s_set_gpr_idx_on s66, gpr_idx(SRC2,DST)
    buffer_load_dwordx4 v[100:103], v2, s[16:19], s61 offen
    v_pk_fma_f32 v[16:17], v[128:129], v[66:67], v[16:17] op_sel_hi:[1,0,1]
    v_pk_fma_f32 v[18:19], v[130:131], v[66:67], v[18:19] op_sel_hi:[1,0,1]
    v_pk_fma_f32 v[20:21], v[132:133], v[82:83], v[20:21] op_sel_hi:[1,0,1]
    v_pk_fma_f32 v[22:23], v[134:135], v[82:83], v[22:23] op_sel_hi:[1,0,1]
    s_set_gpr_idx_idx s67
    v_pk_fma_f32 v[16:17], v[136:137], v[66:67], v[16:17] op_sel:[0,1,0] op_sel_hi:[1,1,1]
    v_pk_fma_f32 v[18:19], v[138:139], v[66:67], v[18:19] op_sel:[0,1,0] op_sel_hi:[1,1,1]
    v_pk_fma_f32 v[20:21], v[140:141], v[82:83], v[20:21] op_sel:[0,1,0] op_sel_hi:[1,1,1]
    v_pk_fma_f32 v[22:23], v[142:143], v[82:83], v[22:23] op_sel:[0,1,0] op_sel_hi:[1,1,1]
    ds_read_b128 v[64:67], v169
    ds_read_b128 v[80:83], v169
    s_set_gpr_idx_off
L_j4:
    s_waitcnt vmcnt(5)
    v_mfma_f32_16x16x16_bf16 v[128:131], v[160:161], v[112:113], 0
    v_readlane_b32 s66, v196, 4
    v_perm_b32 v162, v9, v9, v254
    v_mfma_f32_16x16x16_bf16 v[132:135], v[160:161], v[114:115], 0
    v_perm_b32 v163, v9, v9, v255
    s_and_b32 s61, s66, s49
    s_waitcnt vmcnt(4)
    buffer_load_dwordx4 v[104:107], v2, s[16:19], s61 offen
    v_mfma_f32_16x16x16_bf16 v[136:139], v[162:163], v[116:117], 0
    v_readlane_b32 s67, v196, 5
    v_cvt_pk_bf16_f32 v9, v150, v151
    v_mfma_f32_16x16x16_bf16 v[140:143], v[162:163], v[118:119], 0
    v_perm_b32 v160, v9, v9, v190
    v_perm_b32 v161, v9, v9, v191
    s_and_b32 s61, s67, s49
    s_set_gpr_idx_on s68, gpr_idx(SRC2,DST)
    buffer_load_dwordx4 v[108:111], v2, s[16:19], s61 offen
    v_pk_fma_f32 v[16:17], v[128:129], v[68:69], v[16:17] op_sel_hi:[1,0,1]
    v_pk_fma_f32 v[18:19], v[130:131], v[68:69], v[18:19] op_sel_hi:[1,0,1]
    v_pk_fma_f32 v[20:21], v[132:133], v[84:85], v[20:21] op_sel_hi:[1,0,1]
    v_pk_fma_f32 v[22:23], v[134:135], v[84:85], v[22:23] op_sel_hi:[1,0,1]
    s_set_gpr_idx_idx s69
    v_pk_fma_f32 v[16:17], v[136:137], v[68:69], v[16:17] op_sel:[0,1,0] op_sel_hi:[1,1,1]
    v_pk_fma_f32 v[18:19], v[138:139], v[68:69], v[18:19] op_sel:[0,1,0] op_sel_hi:[1,1,1]
    v_pk_fma_f32 v[20:21], v[140:141], v[84:85], v[20:21] op_sel:[0,1,0] op_sel_hi:[1,1,1]
    v_pk_fma_f32 v[22:23], v[142:143], v[84:85], v[22:23] op_sel:[0,1,0] op_sel_hi:[1,1,1]
    s_set_gpr_idx_off
L_j6:
    s_waitcnt vmcnt(5)
    v_mfma_f32_16x16x16_bf16 v[128:131], v[160:161], v[120:121], 0
    v_readlane_b32 s68, v196, 6
    v_perm_b32 v162, v9, v9, v254
    v_mfma_f32_16x16x16_bf16 v[132:135], v[160:161], v[122:123], 0
    v_perm_b32 v163, v9, v9, v255
    s_and_b32 s61, s68, s49
    s_waitcnt vmcnt(4)
    buffer_load_dwordx4 v[112:115], v2, s[16:19], s61 offen
    v_mfma_f32_16x16x16_bf16 v[136:139], v[162:163], v[124:125], 0
    v_readlane_b32 s69, v196, 7
    v_cvt_pk_bf16_f32 v9, v152, v153
    v_mfma_f32_16x16x16_bf16 v[140:143], v[162:163], v[126:127], 0
    v_perm_b32 v160, v9, v9, v190
    v_perm_b32 v161, v9, v9, v191
    s_and_b32 s61, s69, s49
    s_set_gpr_idx_on s70, gpr_idx(SRC2,DST)
    buffer_load_dwordx4 v[116:119], v2, s[16:19], s61 offen
    v_pk_fma_f32 v[16:17], v[128:129], v[70:71], v[16:17] op_sel_hi:[1,0,1]
    v_pk_fma_f32 v[18:19], v[130:131], v[70:71], v[18:19] op_sel_hi:[1,0,1]
    v_pk_fma_f32 v[20:21], v[132:133], v[86:87], v[20:21] op_sel_hi:[1,0,1]
    v_pk_fma_f32 v[22:23], v[134:135], v[86:87], v[22:23] op_sel_hi:[1,0,1]
    s_set_gpr_idx_idx s71
    v_pk_fma_f32 v[16:17], v[136:137], v[70:71], v[16:17] op_sel:[0,1,0] op_sel_hi:[1,1,1]
    v_pk_fma_f32 v[18:19], v[138:139], v[70:71], v[18:19] op_sel:[0,1,0] op_sel_hi:[1,1,1]
    v_pk_fma_f32 v[20:21], v[140:141], v[86:87], v[20:21] op_sel:[0,1,0] op_sel_hi:[1,1,1]
    v_pk_fma_f32 v[22:23], v[142:143], v[86:87], v[22:23] op_sel:[0,1,0] op_sel_hi:[1,1,1]
    ds_read_b128 v[68:71], v169
    ds_read_b128 v[84:87], v169
    s_set_gpr_idx_off
L_j8:
    s_waitcnt vmcnt(5)
    v_mfma_f32_16x16x16_bf16 v[128:131], v[160:161], v[96:97], 0
    v_readlane_b32 s70, v196, 8
    v_perm_b32 v162, v9, v9, v254
    v_mfma_f32_16x16x16_bf16 v[132:135], v[160:161], v[98:99], 0
    v_perm_b32 v163, v9, v9, v255
    s_and_b32 s61, s70, s49
    s_waitcnt vmcnt(4)
    buffer_load_dwordx4 v[120:123], v2, s[16:19], s61 offen
    v_mfma_f32_16x16x16_bf16 v[136:139], v[162:163], v[100:101], 0
    v_readlane_b32 s71, v196, 9
    v_cvt_pk_bf16_f32 v9, v154, v155
    v_mfma_f32_16x16x16_bf16 v[140:143], v[162:163], v[102:103], 0
    v_perm_b32 v160, v9, v9, v190
    v_perm_b32 v161, v9, v9, v191
    s_and_b32 s61, s71, s49
    s_set_gpr_idx_on s64, gpr_idx(SRC2,DST)
    buffer_load_dwordx4 v[124:127], v2, s[16:19], s61 offen
    v_pk_fma_f32 v[16:17], v[128:129], v[72:73], v[16:17] op_sel_hi:[1,0,1]
    v_pk_fma_f32 v[18:19], v[130:131], v[72:73], v[18:19] op_sel_hi:[1,0,1]
    v_pk_fma_f32 v[20:21], v[132:133], v[88:89], v[20:21] op_sel_hi:[1,0,1]
    v_pk_fma_f32 v[22:23], v[134:135], v[88:89], v[22:23] op_sel_hi:[1,0,1]
    s_set_gpr_idx_idx s65
    v_pk_fma_f32 v[16:17], v[136:137], v[72:73], v[16:17] op_sel:[0,1,0] op_sel_hi:[1,1,1]
    v_pk_fma_f32 v[18:19], v[138:139], v[72:73], v[18:19] op_sel:[0,1,0] op_sel_hi:[1,1,1]
    v_pk_fma_f32 v[20:21], v[140:141], v[88:89], v[20:21] op_sel:[0,1,0] op_sel_hi:[1,1,1]
    v_pk_fma_f32 v[22:23], v[142:143], v[88:89], v[22:23] op_sel:[0,1,0] op_sel_hi:[1,1,1]
    s_set_gpr_idx_off
L_j10:
    s_waitcnt vmcnt(5)
    v_mfma_f32_16x16x16_bf16 v[128:131], v[160:161], v[104:105], 0
    v_readlane_b32 s64, v196, 10
    v_perm_b32 v162, v9, v9, v254
    v_mfma_f32_16x16x16_bf16 v[132:135], v[160:161], v[106:107], 0
    v_perm_b32 v163, v9, v9, v255
    s_and_b32 s61, s64, s49
    s_waitcnt vmcnt(4)
    buffer_load_dwordx4 v[96:99], v2, s[16:19], s61 offen
    v_mfma_f32_16x16x16_bf16 v[136:139], v[162:163], v[108:109], 0
    v_readlane_b32 s65, v196, 11
    v_cvt_pk_bf16_f32 v9, v156, v157
    v_mfma_f32_16x16x16_bf16 v[140:143], v[162:163], v[110:111], 0
    v_perm_b32 v160, v9, v9, v190
    v_perm_b32 v161, v9, v9, v191
    s_and_b32 s61, s65, s49
    s_set_gpr_idx_on s66, gpr_idx(SRC2,DST)
    buffer_load_dwordx4 v[100:103], v2, s[16:19], s61 offen
    v_pk_fma_f32 v[16:17], v[128:129], v[74:75], v[16:17] op_sel_hi:[1,0,1]
    v_pk_fma_f32 v[18:19], v[130:131], v[74:75], v[18:19] op_sel_hi:[1,0,1]
    v_pk_fma_f32 v[20:21], v[132:133], v[90:91], v[20:21] op_sel_hi:[1,0,1]
    v_pk_fma_f32 v[22:23], v[134:135], v[90:91], v[22:23] op_sel_hi:[1,0,1]
    s_set_gpr_idx_idx s67
    v_pk_fma_f32 v[16:17], v[136:137], v[74:75], v[16:17] op_sel:[0,1,0] op_sel_hi:[1,1,1]
    v_pk_fma_f32 v[18:19], v[138:139], v[74:75], v[18:19] op_sel:[0,1,0] op_sel_hi:[1,1,1]
    v_pk_fma_f32 v[20:21], v[140:141], v[90:91], v[20:21] op_sel:[0,1,0] op_sel_hi:[1,1,1]
    v_pk_fma_f32 v[22:23], v[142:143], v[90:91], v[22:23] op_sel:[0,1,0] op_sel_hi:[1,1,1]
    ds_read_b128 v[72:75], v169
    ds_read_b128 v[88:91], v169
    s_set_gpr_idx_off
L_j12:
    s_waitcnt vmcnt(5)
    v_mfma_f32_16x16x16_bf16 v[128:131], v[160:161], v[112:113], 0
    v_readlane_b32 s66, v196, 12
    v_perm_b32 v162, v9, v9, v254
    v_mfma_f32_16x16x16_bf16 v[132:135], v[160:161], v[114:115], 0
    v_perm_b32 v163, v9, v9, v255
    s_and_b32 s61, s66, s49
    s_waitcnt vmcnt(4)
    buffer_load_dwordx4 v[104:107], v2, s[16:19], s61 offen
    v_mfma_f32_16x16x16_bf16 v[136:139], v[162:163], v[116:117], 0
    v_readlane_b32 s67, v196, 13
    v_cvt_pk_bf16_f32 v9, v158, v159
    v_mfma_f32_16x16x16_bf16 v[140:143], v[162:163], v[118:119], 0
    v_perm_b32 v160, v9, v9, v190
    v_perm_b32 v161, v9, v9, v191
    s_and_b32 s61, s67, s49
    s_set_gpr_idx_on s68, gpr_idx(SRC2,DST)
    buffer_load_dwordx4 v[108:111], v2, s[16:19], s61 offen
    v_pk_fma_f32 v[16:17], v[128:129], v[76:77], v[16:17] op_sel_hi:[1,0,1]
    v_pk_fma_f32 v[18:19], v[130:131], v[76:77], v[18:19] op_sel_hi:[1,0,1]
    v_pk_fma_f32 v[20:21], v[132:133], v[92:93], v[20:21] op_sel_hi:[1,0,1]
    v_pk_fma_f32 v[22:23], v[134:135], v[92:93], v[22:23] op_sel_hi:[1,0,1]
    s_set_gpr_idx_idx s69
    v_pk_fma_f32 v[16:17], v[136:137], v[76:77], v[16:17] op_sel:[0,1,0] op_sel_hi:[1,1,1]
    v_pk_fma_f32 v[18:19], v[138:139], v[76:77], v[18:19] op_sel:[0,1,0] op_sel_hi:[1,1,1]
    v_pk_fma_f32 v[20:21], v[140:141], v[92:93], v[20:21] op_sel:[0,1,0] op_sel_hi:[1,1,1]
    v_pk_fma_f32 v[22:23], v[142:143], v[92:93], v[22:23] op_sel:[0,1,0] op_sel_hi:[1,1,1]
    s_set_gpr_idx_off
L_j14:
    s_waitcnt vmcnt(5)
    v_mfma_f32_16x16x16_bf16 v[128:131], v[160:161], v[120:121], 0
    v_readlane_b32 s68, v196, 14
    v_perm_b32 v162, v9, v9, v254
    v_mfma_f32_16x16x16_bf16 v[132:135], v[160:161], v[122:123], 0
    v_perm_b32 v163, v9, v9, v255
    s_and_b32 s61, s68, s49
    s_waitcnt vmcnt(4)
    buffer_load_dwordx4 v[112:115], v2, s[16:19], s61 offen
    v_mfma_f32_16x16x16_bf16 v[136:139], v[162:163], v[124:125], 0
    v_readlane_b32 s69, v196, 15
    v_mfma_f32_16x16x16_bf16 v[140:143], v[162:163], v[126:127], 0
    s_and_b32 s61, s69, s49
    s_set_gpr_idx_on s70, gpr_idx(SRC2,DST)
    buffer_load_dwordx4 v[116:119], v2, s[16:19], s61 offen
    v_pk_fma_f32 v[16:17], v[128:129], v[78:79], v[16:17] op_sel_hi:[1,0,1]
    v_pk_fma_f32 v[18:19], v[130:131], v[78:79], v[18:19] op_sel_hi:[1,0,1]
    v_pk_fma_f32 v[20:21], v[132:133], v[94:95], v[20:21] op_sel_hi:[1,0,1]
    v_pk_fma_f32 v[22:23], v[134:135], v[94:95], v[22:23] op_sel_hi:[1,0,1]
    s_set_gpr_idx_idx s71
    s_sub_u32 s53, s53, 1
    v_pk_fma_f32 v[16:17], v[136:137], v[78:79], v[16:17] op_sel:[0,1,0] op_sel_hi:[1,1,1]
    v_pk_fma_f32 v[18:19], v[138:139], v[78:79], v[18:19] op_sel:[0,1,0] op_sel_hi:[1,1,1]
    v_pk_fma_f32 v[20:21], v[140:141], v[94:95], v[20:21] op_sel:[0,1,0] op_sel_hi:[1,1,1]
    v_pk_fma_f32 v[22:23], v[142:143], v[94:95], v[22:23] op_sel:[0,1,0] op_sel_hi:[1,1,1]
    ds_read_b128 v[76:79], v169
    ds_read_b128 v[92:95], v169
    s_set_gpr_idx_off
    s_cmp_lg_u32 s53, 0
    s_cbranch_scc1 L_loop
    s_waitcnt lgkmcnt(2)
    v_mfma_f32_4x4x4_16b_bf16 v[144:147], v[192:193], v[188:189], 0 cbsz:4 abid:0
    v_mfma_f32_4x4x4_16b_bf16 v[148:151], v[192:193], v[188:189], 0 cbsz:4 abid:2
    v_mfma_f32_4x4x4_16b_bf16 v[152:155], v[192:193], v[188:189], 0 cbsz:4 abid:4
    v_mfma_f32_4x4x4_16b_bf16 v[156:159], v[192:193], v[188:189], 0 cbsz:4 abid:6
    v_lshlrev_b32 v196, 3, v197
    v_and_b32 v196, s55, v196
    s_waitcnt lgkmcnt(0)
    v_smfmac_f32_32x32x32_bf16 v[64:79], v[164:167], v[172:179], v168
    v_cvt_pk_bf16_f32 v9, v144, v145
    v_perm_b32 v160, v9, v9, v190
    v_perm_b32 v161, v9, v9, v191
    v_smfmac_f32_32x32x32_bf16 v[80:95], v[164:167], v[180:187], v168
L_f0:
    s_waitcnt vmcnt(5)
    v_mfma_f32_16x16x16_bf16 v[128:131], v[160:161], v[96:97], 0
    v_readlane_b32 s70, v196, 0
    v_perm_b32 v162, v9, v9, v254
    v_mfma_f32_16x16x16_bf16 v[132:135], v[160:161], v[98:99], 0
    v_perm_b32 v163, v9, v9, v255
    s_and_b32 s61, s70, s49
    s_waitcnt vmcnt(4)
    buffer_load_dwordx4 v[120:123], v2, s[16:19], s61 offen
    v_mfma_f32_16x16x16_bf16 v[136:139], v[162:163], v[100:101], 0
    v_readlane_b32 s71, v196, 1
    v_cvt_pk_bf16_f32 v9, v146, v147
    v_mfma_f32_16x16x16_bf16 v[140:143], v[162:163], v[102:103], 0
    v_perm_b32 v160, v9, v9, v190
    v_perm_b32 v161, v9, v9, v191
    s_and_b32 s61, s71, s49
    s_set_gpr_idx_on s64, gpr_idx(SRC2,DST)
    buffer_load_dwordx4 v[124:127], v2, s[16:19], s61 offen
    v_pk_fma_f32 v[16:17], v[128:129], v[64:65], v[16:17] op_sel_hi:[1,0,1]
    v_pk_fma_f32 v[18:19], v[130:131], v[64:65], v[18:19] op_sel_hi:[1,0,1]
    v_pk_fma_f32 v[20:21], v[132:133], v[80:81], v[20:21] op_sel_hi:[1,0,1]
    v_pk_fma_f32 v[22:23], v[134:135], v[80:81], v[22:23] op_sel_hi:[1,0,1]
    s_set_gpr_idx_idx s65
    v_pk_fma_f32 v[16:17], v[136:137], v[64:65], v[16:17] op_sel:[0,1,0] op_sel_hi:[1,1,1]
    v_pk_fma_f32 v[18:19], v[138:139], v[64:65], v[18:19] op_sel:[0,1,0] op_sel_hi:[1,1,1]
    v_pk_fma_f32 v[20:21], v[140:141], v[80:81], v[20:21] op_sel:[0,1,0] op_sel_hi:[1,1,1]
    v_pk_fma_f32 v[22:23], v[142:143], v[80:81], v[22:23] op_sel:[0,1,0] op_sel_hi:[1,1,1]
    s_set_gpr_idx_off
    s_waitcnt vmcnt(5)
    v_mfma_f32_16x16x16_bf16 v[128:131], v[160:161], v[104:105], 0
    v_readlane_b32 s64, v196, 2
    v_perm_b32 v162, v9, v9, v254
    v_mfma_f32_16x16x16_bf16 v[132:135], v[160:161], v[106:107], 0
    v_perm_b32 v163, v9, v9, v255
    s_and_b32 s61, s64, s49
    s_waitcnt vmcnt(4)
    buffer_load_dwordx4 v[96:99], v2, s[16:19], s61 offen
    v_mfma_f32_16x16x16_bf16 v[136:139], v[162:163], v[108:109], 0
    v_readlane_b32 s65, v196, 3
    v_cvt_pk_bf16_f32 v9, v148, v149
    v_mfma_f32_16x16x16_bf16 v[140:143], v[162:163], v[110:111], 0
    v_perm_b32 v160, v9, v9, v190
    v_perm_b32 v161, v9, v9, v191
    v_lshlrev_b32 v12, 2, v1
    s_lshl_b32 s61, s3, 7
    v_and_b32 v205, 0x7380, v205
    v_xor_b32 v205, s61, v205
    v_alignbit_b32 v205, v205, v205, 12
    v_cmp_eq_u32 s[80:81], 0, v205
    v_cmp_eq_u32 s[82:83], 1, v205
    v_cmp_eq_u32 s[84:85], 2, v205
    v_cmp_eq_u32 s[96:97], 3, v205
    v_cmp_eq_u32 vcc, 4, v205
    s_ff1_i32_b64 s56, s[80:81]
    s_mul_i32 s56, s56, 1152
    v_add_u32 v208, s56, v12
    s_ff1_i32_b64 s57, s[82:83]
    s_mul_i32 s57, s57, 1152
    v_add_u32 v209, s57, v12
    s_ff1_i32_b64 s58, s[84:85]
    s_mul_i32 s58, s58, 1152
    v_add_u32 v210, s58, v12
    s_ff1_i32_b64 s59, s[96:97]
    s_mul_i32 s59, s59, 1152
    v_add_u32 v211, s59, v12
    s_ff1_i32_b64 s60, vcc
    s_mul_i32 s60, s60, 1152
    v_add_u32 v212, s60, v12
    s_and_b32 s61, s65, s49
    s_set_gpr_idx_on s66, gpr_idx(SRC2,DST)
    buffer_load_dwordx4 v[100:103], v2, s[16:19], s61 offen
    v_pk_fma_f32 v[16:17], v[128:129], v[66:67], v[16:17] op_sel_hi:[1,0,1]
    v_pk_fma_f32 v[18:19], v[130:131], v[66:67], v[18:19] op_sel_hi:[1,0,1]
    v_pk_fma_f32 v[20:21], v[132:133], v[82:83], v[20:21] op_sel_hi:[1,0,1]
    v_pk_fma_f32 v[22:23], v[134:135], v[82:83], v[22:23] op_sel_hi:[1,0,1]
    s_set_gpr_idx_idx s67
    v_pk_fma_f32 v[16:17], v[136:137], v[66:67], v[16:17] op_sel:[0,1,0] op_sel_hi:[1,1,1]
    v_pk_fma_f32 v[18:19], v[138:139], v[66:67], v[18:19] op_sel:[0,1,0] op_sel_hi:[1,1,1]
    v_pk_fma_f32 v[20:21], v[140:141], v[82:83], v[20:21] op_sel:[0,1,0] op_sel_hi:[1,1,1]
    v_pk_fma_f32 v[22:23], v[142:143], v[82:83], v[22:23] op_sel:[0,1,0] op_sel_hi:[1,1,1]
    s_set_gpr_idx_off
    s_waitcnt vmcnt(5)
    v_mfma_f32_16x16x16_bf16 v[128:131], v[160:161], v[112:113], 0
    v_readlane_b32 s66, v196, 4
    v_perm_b32 v162, v9, v9, v254
    v_mfma_f32_16x16x16_bf16 v[132:135], v[160:161], v[114:115], 0
    v_perm_b32 v163, v9, v9, v255
    s_and_b32 s61, s66, s49
    s_waitcnt vmcnt(4)
    buffer_load_dwordx4 v[104:107], v2, s[16:19], s61 offen
    v_mfma_f32_16x16x16_bf16 v[136:139], v[162:163], v[116:117], 0
    v_readlane_b32 s67, v196, 5
    v_cvt_pk_bf16_f32 v9, v150, v151
    v_mfma_f32_16x16x16_bf16 v[140:143], v[162:163], v[118:119], 0
    v_perm_b32 v160, v9, v9, v190
    v_perm_b32 v161, v9, v9, v191
    s_and_b32 s61, s67, s49
    s_set_gpr_idx_on s68, gpr_idx(SRC2,DST)
    buffer_load_dwordx4 v[108:111], v2, s[16:19], s61 offen
    v_pk_fma_f32 v[16:17], v[128:129], v[68:69], v[16:17] op_sel_hi:[1,0,1]
    v_pk_fma_f32 v[18:19], v[130:131], v[68:69], v[18:19] op_sel_hi:[1,0,1]
    v_pk_fma_f32 v[20:21], v[132:133], v[84:85], v[20:21] op_sel_hi:[1,0,1]
    v_pk_fma_f32 v[22:23], v[134:135], v[84:85], v[22:23] op_sel_hi:[1,0,1]
    s_set_gpr_idx_idx s69
    v_pk_fma_f32 v[16:17], v[136:137], v[68:69], v[16:17] op_sel:[0,1,0] op_sel_hi:[1,1,1]
    v_pk_fma_f32 v[18:19], v[138:139], v[68:69], v[18:19] op_sel:[0,1,0] op_sel_hi:[1,1,1]
    v_pk_fma_f32 v[20:21], v[140:141], v[84:85], v[20:21] op_sel:[0,1,0] op_sel_hi:[1,1,1]
    v_pk_fma_f32 v[22:23], v[142:143], v[84:85], v[22:23] op_sel:[0,1,0] op_sel_hi:[1,1,1]
    s_set_gpr_idx_off
    s_waitcnt vmcnt(5)
    v_mfma_f32_16x16x16_bf16 v[128:131], v[160:161], v[120:121], 0
    v_readlane_b32 s68, v196, 6
    v_perm_b32 v162, v9, v9, v254
    v_mfma_f32_16x16x16_bf16 v[132:135], v[160:161], v[122:123], 0
    v_perm_b32 v163, v9, v9, v255
    s_and_b32 s61, s68, s49
    s_waitcnt vmcnt(4)
    buffer_load_dwordx4 v[112:115], v2, s[16:19], s61 offen
    v_mfma_f32_16x16x16_bf16 v[136:139], v[162:163], v[124:125], 0
    v_readlane_b32 s69, v196, 7
    v_cvt_pk_bf16_f32 v9, v152, v153
    v_mfma_f32_16x16x16_bf16 v[140:143], v[162:163], v[126:127], 0
    v_perm_b32 v160, v9, v9, v190
    v_perm_b32 v161, v9, v9, v191
    s_and_b32 s61, s69, s49
    s_set_gpr_idx_on s70, gpr_idx(SRC2,DST)
    buffer_load_dwordx4 v[116:119], v2, s[16:19], s61 offen
    v_pk_fma_f32 v[16:17], v[128:129], v[70:71], v[16:17] op_sel_hi:[1,0,1]
    v_pk_fma_f32 v[18:19], v[130:131], v[70:71], v[18:19] op_sel_hi:[1,0,1]
    v_pk_fma_f32 v[20:21], v[132:133], v[86:87], v[20:21] op_sel_hi:[1,0,1]
    v_pk_fma_f32 v[22:23], v[134:135], v[86:87], v[22:23] op_sel_hi:[1,0,1]
    s_set_gpr_idx_idx s71
    v_pk_fma_f32 v[16:17], v[136:137], v[70:71], v[16:17] op_sel:[0,1,0] op_sel_hi:[1,1,1]
    v_pk_fma_f32 v[18:19], v[138:139], v[70:71], v[18:19] op_sel:[0,1,0] op_sel_hi:[1,1,1]
    v_pk_fma_f32 v[20:21], v[140:141], v[86:87], v[20:21] op_sel:[0,1,0] op_sel_hi:[1,1,1]
    v_pk_fma_f32 v[22:23], v[142:143], v[86:87], v[22:23] op_sel:[0,1,0] op_sel_hi:[1,1,1]
    ds_read_b128 v[144:147], v215 offset:14336
    ds_read_b128 v[148:151], v215 offset:15360
    s_set_gpr_idx_off
    s_waitcnt vmcnt(5)
    v_mfma_f32_16x16x16_bf16 v[128:131], v[160:161], v[96:97], 0
    v_readlane_b32 s70, v196, 8
    v_perm_b32 v162, v9, v9, v254
    v_mfma_f32_16x16x16_bf16 v[132:135], v[160:161], v[98:99], 0
    v_perm_b32 v163, v9, v9, v255
    s_and_b32 s61, s70, s49
    s_waitcnt vmcnt(4)
    buffer_load_dwordx4 v[120:123], v2, s[16:19], s61 offen
    v_mfma_f32_16x16x16_bf16 v[136:139], v[162:163], v[100:101], 0
    v_readlane_b32 s71, v196, 9
    v_cvt_pk_bf16_f32 v9, v154, v155
    v_mfma_f32_16x16x16_bf16 v[140:143], v[162:163], v[102:103], 0
    v_perm_b32 v160, v9, v9, v190
    v_perm_b32 v161, v9, v9, v191
    s_and_b32 s61, s71, s49
    s_set_gpr_idx_on s64, gpr_idx(SRC2,DST)
    buffer_load_dwordx4 v[124:127], v2, s[16:19], s61 offen
    v_pk_fma_f32 v[16:17], v[128:129], v[72:73], v[16:17] op_sel_hi:[1,0,1]
    v_pk_fma_f32 v[18:19], v[130:131], v[72:73], v[18:19] op_sel_hi:[1,0,1]
    v_pk_fma_f32 v[20:21], v[132:133], v[88:89], v[20:21] op_sel_hi:[1,0,1]
    v_pk_fma_f32 v[22:23], v[134:135], v[88:89], v[22:23] op_sel_hi:[1,0,1]
    s_set_gpr_idx_idx s65
    v_pk_fma_f32 v[16:17], v[136:137], v[72:73], v[16:17] op_sel:[0,1,0] op_sel_hi:[1,1,1]
    v_pk_fma_f32 v[18:19], v[138:139], v[72:73], v[18:19] op_sel:[0,1,0] op_sel_hi:[1,1,1]
    v_pk_fma_f32 v[20:21], v[140:141], v[88:89], v[20:21] op_sel:[0,1,0] op_sel_hi:[1,1,1]
    v_pk_fma_f32 v[22:23], v[142:143], v[88:89], v[22:23] op_sel:[0,1,0] op_sel_hi:[1,1,1]
    ds_read_b128 v[96:99], v215 offset:6144
    ds_read_b128 v[100:103], v215 offset:7168
    s_set_gpr_idx_off
    s_waitcnt vmcnt(5)
    v_mfma_f32_16x16x16_bf16 v[128:131], v[160:161], v[104:105], 0
    v_perm_b32 v162, v9, v9, v254
    v_mfma_f32_16x16x16_bf16 v[132:135], v[160:161], v[106:107], 0
    v_perm_b32 v163, v9, v9, v255
    s_waitcnt vmcnt(4)
    s_nop 0
    v_mfma_f32_16x16x16_bf16 v[136:139], v[162:163], v[108:109], 0
    v_cvt_pk_bf16_f32 v9, v156, v157
    v_mfma_f32_16x16x16_bf16 v[140:143], v[162:163], v[110:111], 0
    v_perm_b32 v160, v9, v9, v190
    v_perm_b32 v161, v9, v9, v191
    s_set_gpr_idx_on s66, gpr_idx(SRC2,DST)
    v_pk_fma_f32 v[16:17], v[128:129], v[74:75], v[16:17] op_sel_hi:[1,0,1]
    v_pk_fma_f32 v[18:19], v[130:131], v[74:75], v[18:19] op_sel_hi:[1,0,1]
    v_pk_fma_f32 v[20:21], v[132:133], v[90:91], v[20:21] op_sel_hi:[1,0,1]
    v_pk_fma_f32 v[22:23], v[134:135], v[90:91], v[22:23] op_sel_hi:[1,0,1]
    s_set_gpr_idx_idx s67
    v_pk_fma_f32 v[16:17], v[136:137], v[74:75], v[16:17] op_sel:[0,1,0] op_sel_hi:[1,1,1]
    v_pk_fma_f32 v[18:19], v[138:139], v[74:75], v[18:19] op_sel:[0,1,0] op_sel_hi:[1,1,1]
    v_pk_fma_f32 v[20:21], v[140:141], v[90:91], v[20:21] op_sel:[0,1,0] op_sel_hi:[1,1,1]
    v_pk_fma_f32 v[22:23], v[142:143], v[90:91], v[22:23] op_sel:[0,1,0] op_sel_hi:[1,1,1]
    ds_read_b128 v[104:107], v215 offset:8192
    ds_read_b128 v[108:111], v215 offset:9216
    s_set_gpr_idx_off
    s_waitcnt vmcnt(3)
    v_mfma_f32_16x16x16_bf16 v[128:131], v[160:161], v[112:113], 0
    v_perm_b32 v162, v9, v9, v254
    v_mfma_f32_16x16x16_bf16 v[132:135], v[160:161], v[114:115], 0
    v_perm_b32 v163, v9, v9, v255
    s_waitcnt vmcnt(2)
    s_nop 0
    v_mfma_f32_16x16x16_bf16 v[136:139], v[162:163], v[116:117], 0
    v_cvt_pk_bf16_f32 v9, v158, v159
    v_mfma_f32_16x16x16_bf16 v[140:143], v[162:163], v[118:119], 0
    v_perm_b32 v160, v9, v9, v190
    v_perm_b32 v161, v9, v9, v191
    s_set_gpr_idx_on s68, gpr_idx(SRC2,DST)
    v_pk_fma_f32 v[16:17], v[128:129], v[76:77], v[16:17] op_sel_hi:[1,0,1]
    v_pk_fma_f32 v[18:19], v[130:131], v[76:77], v[18:19] op_sel_hi:[1,0,1]
    v_pk_fma_f32 v[20:21], v[132:133], v[92:93], v[20:21] op_sel_hi:[1,0,1]
    v_pk_fma_f32 v[22:23], v[134:135], v[92:93], v[22:23] op_sel_hi:[1,0,1]
    s_set_gpr_idx_idx s69
    v_pk_fma_f32 v[16:17], v[136:137], v[76:77], v[16:17] op_sel:[0,1,0] op_sel_hi:[1,1,1]
    v_pk_fma_f32 v[18:19], v[138:139], v[76:77], v[18:19] op_sel:[0,1,0] op_sel_hi:[1,1,1]
    v_pk_fma_f32 v[20:21], v[140:141], v[92:93], v[20:21] op_sel:[0,1,0] op_sel_hi:[1,1,1]
    v_pk_fma_f32 v[22:23], v[142:143], v[92:93], v[22:23] op_sel:[0,1,0] op_sel_hi:[1,1,1]
    ds_read_b128 v[112:115], v215 offset:10240
    ds_read_b128 v[116:119], v215 offset:11264
    s_set_gpr_idx_off
    s_waitcnt vmcnt(1)
    v_mfma_f32_16x16x16_bf16 v[128:131], v[160:161], v[120:121], 0
    v_perm_b32 v162, v9, v9, v254
    v_mfma_f32_16x16x16_bf16 v[132:135], v[160:161], v[122:123], 0
    v_perm_b32 v163, v9, v9, v255
    s_waitcnt vmcnt(0)
    s_nop 0
    v_mfma_f32_16x16x16_bf16 v[136:139], v[162:163], v[124:125], 0
    v_mfma_f32_16x16x16_bf16 v[140:143], v[162:163], v[126:127], 0
    s_set_gpr_idx_on s70, gpr_idx(SRC2,DST)
    v_pk_fma_f32 v[16:17], v[128:129], v[78:79], v[16:17] op_sel_hi:[1,0,1]
    v_pk_fma_f32 v[18:19], v[130:131], v[78:79], v[18:19] op_sel_hi:[1,0,1]
    v_pk_fma_f32 v[20:21], v[132:133], v[94:95], v[20:21] op_sel_hi:[1,0,1]
    v_pk_fma_f32 v[22:23], v[134:135], v[94:95], v[22:23] op_sel_hi:[1,0,1]
    s_set_gpr_idx_idx s71
    s_nop 0
    v_pk_fma_f32 v[16:17], v[136:137], v[78:79], v[16:17] op_sel:[0,1,0] op_sel_hi:[1,1,1]
    v_pk_fma_f32 v[18:19], v[138:139], v[78:79], v[18:19] op_sel:[0,1,0] op_sel_hi:[1,1,1]
    v_pk_fma_f32 v[20:21], v[140:141], v[94:95], v[20:21] op_sel:[0,1,0] op_sel_hi:[1,1,1]
    v_pk_fma_f32 v[22:23], v[142:143], v[94:95], v[22:23] op_sel:[0,1,0] op_sel_hi:[1,1,1]
    ds_read_b128 v[120:123], v215 offset:12288
    ds_read_b128 v[124:127], v215 offset:13312
    s_set_gpr_idx_off
L_swept:
    s_add_u32 s48, s48, 224
    s_cmp_lt_u32 s48, s47
    s_cbranch_scc1 L_again
    s_setprio 0
    v_cvt_pk_bf16_f32 v64, v16, v20
    v_cvt_pk_bf16_f32 v65, v17, v21
    v_cvt_pk_bf16_f32 v66, v18, v22
    v_cvt_pk_bf16_f32 v67, v19, v23
    ds_write2_b32 v208, v64, v65 offset0:0 offset1:72
    ds_write2_b32 v208, v66, v67 offset0:144 offset1:216
    v_cvt_pk_bf16_f32 v68, v24, v28
    v_cvt_pk_bf16_f32 v69, v25, v29
    v_cvt_pk_bf16_f32 v70, v26, v30
    v_cvt_pk_bf16_f32 v71, v27, v31
    ds_write2_b32 v209, v68, v69 offset0:0 offset1:72
    ds_write2_b32 v209, v70, v71 offset0:144 offset1:216
    v_cvt_pk_bf16_f32 v72, v32, v36
    v_cvt_pk_bf16_f32 v73, v33, v37
    v_cvt_pk_bf16_f32 v74, v34, v38
    v_cvt_pk_bf16_f32 v75, v35, v39
    ds_write2_b32 v210, v72, v73 offset0:0 offset1:72
    ds_write2_b32 v210, v74, v75 offset0:144 offset1:216
    v_cvt_pk_bf16_f32 v76, v40, v44
    v_cvt_pk_bf16_f32 v77, v41, v45
    v_cvt_pk_bf16_f32 v78, v42, v46
    v_cvt_pk_bf16_f32 v79, v43, v47
    ds_write2_b32 v211, v76, v77 offset0:0 offset1:72
    ds_write2_b32 v211, v78, v79 offset0:144 offset1:216
    v_cvt_pk_bf16_f32 v80, v48, v52
    v_cvt_pk_bf16_f32 v81, v49, v53
    v_cvt_pk_bf16_f32 v82, v50, v54
    v_cvt_pk_bf16_f32 v83, v51, v55
    ds_write2_b32 v212, v80, v81 offset0:0 offset1:72
    ds_write2_b32 v212, v82, v83 offset0:144 offset1:216
    s_waitcnt lgkmcnt(0)
    s_barrier
    ds_read_b128 v[16:19], v213 offset:0
    ds_read_b128 v[20:23], v213 offset:64
    ds_read_b128 v[24:27], v213 offset:128
    ds_read_b128 v[28:31], v213 offset:192
    s_waitcnt lgkmcnt(3)
    v_mfma_f32_16x16x32_bf16 v[160:163], v[16:19], v[216:219], 0
    v_mfma_f32_16x16x32_bf16 v[164:167], v[16:19], v[220:223], 0
    v_mfma_f32_16x16x32_bf16 v[168:171], v[16:19], v[224:227], 0
    v_mfma_f32_16x16x32_bf16 v[172:175], v[16:19], v[228:231], 0
    ds_read_b128 v[32:35], v213 offset:4608
    ds_read_b128 v[36:39], v213 offset:4672
    ds_read_b128 v[40:43], v213 offset:4736
    ds_read_b128 v[44:47], v213 offset:4800
    s_waitcnt lgkmcnt(6)
    v_mfma_f32_16x16x32_bf16 v[160:163], v[20:23], v[232:235], v[160:163]
    v_mfma_f32_16x16x32_bf16 v[164:167], v[20:23], v[236:239], v[164:167]
    v_mfma_f32_16x16x32_bf16 v[168:171], v[20:23], v[96:99], v[168:171]
    v_mfma_f32_16x16x32_bf16 v[172:175], v[20:23], v[100:103], v[172:175]
    ds_read_b128 v[48:51], v213 offset:9216
    ds_read_b128 v[52:55], v213 offset:9280
    ds_read_b128 v[56:59], v213 offset:9344
    ds_read_b128 v[60:63], v213 offset:9408
    s_waitcnt lgkmcnt(9)
    v_mfma_f32_16x16x32_bf16 v[160:163], v[24:27], v[104:107], v[160:163]
    v_mfma_f32_16x16x32_bf16 v[164:167], v[24:27], v[108:111], v[164:167]
    v_mfma_f32_16x16x32_bf16 v[168:171], v[24:27], v[112:115], v[168:171]
    v_mfma_f32_16x16x32_bf16 v[172:175], v[24:27], v[116:119], v[172:175]
    s_waitcnt lgkmcnt(8)
    v_mfma_f32_16x16x32_bf16 v[160:163], v[28:31], v[120:123], v[160:163]
    v_mfma_f32_16x16x32_bf16 v[164:167], v[28:31], v[124:127], v[164:167]
    v_mfma_f32_16x16x32_bf16 v[168:171], v[28:31], v[144:147], v[168:171]
    v_mfma_f32_16x16x32_bf16 v[172:175], v[28:31], v[148:151], v[172:175]
    s_waitcnt lgkmcnt(4)
    v_mfma_f32_16x16x32_bf16 v[176:179], v[32:35], v[216:219], 0
    v_mfma_f32_16x16x32_bf16 v[180:183], v[32:35], v[220:223], 0
    v_mfma_f32_16x16x32_bf16 v[184:187], v[32:35], v[224:227], 0
    v_mfma_f32_16x16x32_bf16 v[188:191], v[32:35], v[228:231], 0
    v_mfma_f32_16x16x32_bf16 v[176:179], v[36:39], v[232:235], v[176:179]
    v_cvt_pk_bf16_f32 v64, v160, v164
    v_cvt_pk_bf16_f32 v80, v160, v164
    v_mfma_f32_16x16x32_bf16 v[180:183], v[36:39], v[236:239], v[180:183]
    v_cvt_pk_bf16_f32 v66, v162, v166
    v_cvt_pk_bf16_f32 v65, v168, v172
    v_mfma_f32_16x16x32_bf16 v[184:187], v[36:39], v[96:99], v[184:187]
    v_cvt_pk_bf16_f32 v81, v168, v172
    v_cvt_pk_bf16_f32 v67, v170, v174
    v_mfma_f32_16x16x32_bf16 v[188:191], v[36:39], v[100:103], v[188:191]
    v_mov_b32_dpp v64, v66 row_ror:8 row_mask:0xf bank_mask:0xc
    v_mov_b32_dpp v65, v67 row_ror:8 row_mask:0xf bank_mask:0xc
    v_mfma_f32_16x16x32_bf16 v[176:179], v[40:43], v[104:107], v[176:179]
    v_mov_b32_dpp v66, v80 row_ror:8 row_mask:0xf bank_mask:0x3
    v_mov_b32_dpp v67, v81 row_ror:8 row_mask:0xf bank_mask:0x3
    v_mfma_f32_16x16x32_bf16 v[180:183], v[40:43], v[108:111], v[180:183]
    buffer_store_dwordx4 v[64:67], v214, s[40:43], s87 offen offset:0 sc1
    v_cvt_pk_bf16_f32 v68, v161, v165
    v_mfma_f32_16x16x32_bf16 v[184:187], v[40:43], v[112:115], v[184:187]
    v_cvt_pk_bf16_f32 v82, v161, v165
    v_cvt_pk_bf16_f32 v70, v163, v167
    v_mfma_f32_16x16x32_bf16 v[188:191], v[40:43], v[116:119], v[188:191]
    v_cvt_pk_bf16_f32 v69, v169, v173
    v_cvt_pk_bf16_f32 v83, v169, v173
    v_mfma_f32_16x16x32_bf16 v[176:179], v[44:47], v[120:123], v[176:179]
    v_cvt_pk_bf16_f32 v71, v171, v175
    v_mov_b32_dpp v68, v70 row_ror:8 row_mask:0xf bank_mask:0xc
    v_mfma_f32_16x16x32_bf16 v[180:183], v[44:47], v[124:127], v[180:183]
    v_mov_b32_dpp v69, v71 row_ror:8 row_mask:0xf bank_mask:0xc
    v_mov_b32_dpp v70, v82 row_ror:8 row_mask:0xf bank_mask:0x3
    v_mfma_f32_16x16x32_bf16 v[184:187], v[44:47], v[144:147], v[184:187]
    v_mov_b32_dpp v71, v83 row_ror:8 row_mask:0xf bank_mask:0x3
    buffer_store_dwordx4 v[68:71], v214, s[40:43], s87 offen offset:256 sc1
    v_mfma_f32_16x16x32_bf16 v[188:191], v[44:47], v[148:151], v[188:191]
    s_add_u32 s87, s87, 4096
    s_cmp_ge_u32 s3, 4
    s_cbranch_scc1 L_two
    s_waitcnt lgkmcnt(0)
    v_mfma_f32_16x16x32_bf16 v[160:163], v[48:51], v[216:219], 0
    v_mfma_f32_16x16x32_bf16 v[164:167], v[48:51], v[220:223], 0
    v_mfma_f32_16x16x32_bf16 v[168:171], v[48:51], v[224:227], 0
    v_mfma_f32_16x16x32_bf16 v[172:175], v[48:51], v[228:231], 0
    v_mfma_f32_16x16x32_bf16 v[160:163], v[52:55], v[232:235], v[160:163]
    v_cvt_pk_bf16_f32 v72, v176, v180
    v_cvt_pk_bf16_f32 v80, v176, v180
    v_mfma_f32_16x16x32_bf16 v[164:167], v[52:55], v[236:239], v[164:167]
    v_cvt_pk_bf16_f32 v74, v178, v182
    v_cvt_pk_bf16_f32 v73, v184, v188
    v_mfma_f32_16x16x32_bf16 v[168:171], v[52:55], v[96:99], v[168:171]
    v_cvt_pk_bf16_f32 v81, v184, v188
    v_cvt_pk_bf16_f32 v75, v186, v190
    v_mfma_f32_16x16x32_bf16 v[172:175], v[52:55], v[100:103], v[172:175]
    v_mov_b32_dpp v72, v74 row_ror:8 row_mask:0xf bank_mask:0xc
    v_mov_b32_dpp v73, v75 row_ror:8 row_mask:0xf bank_mask:0xc
    v_mfma_f32_16x16x32_bf16 v[160:163], v[56:59], v[104:107], v[160:163]
    v_mov_b32_dpp v74, v80 row_ror:8 row_mask:0xf bank_mask:0x3
    v_mov_b32_dpp v75, v81 row_ror:8 row_mask:0xf bank_mask:0x3
    v_mfma_f32_16x16x32_bf16 v[164:167], v[56:59], v[108:111], v[164:167]
    buffer_store_dwordx4 v[72:75], v214, s[40:43], s87 offen offset:0 sc1
    v_cvt_pk_bf16_f32 v76, v177, v181
    v_mfma_f32_16x16x32_bf16 v[168:171], v[56:59], v[112:115], v[168:171]
    v_cvt_pk_bf16_f32 v82, v177, v181
    v_cvt_pk_bf16_f32 v78, v179, v183
    v_mfma_f32_16x16x32_bf16 v[172:175], v[56:59], v[116:119], v[172:175]
    v_cvt_pk_bf16_f32 v77, v185, v189
    v_cvt_pk_bf16_f32 v83, v185, v189
    v_mfma_f32_16x16x32_bf16 v[160:163], v[60:63], v[120:123], v[160:163]
    v_cvt_pk_bf16_f32 v79, v187, v191
    v_mov_b32_dpp v76, v78 row_ror:8 row_mask:0xf bank_mask:0xc
    v_mfma_f32_16x16x32_bf16 v[164:167], v[60:63], v[124:127], v[164:167]
    v_mov_b32_dpp v77, v79 row_ror:8 row_mask:0xf bank_mask:0xc
    v_mov_b32_dpp v78, v82 row_ror:8 row_mask:0xf bank_mask:0x3
    v_mfma_f32_16x16x32_bf16 v[168:171], v[60:63], v[144:147], v[168:171]
    v_mov_b32_dpp v79, v83 row_ror:8 row_mask:0xf bank_mask:0x3
    buffer_store_dwordx4 v[76:79], v214, s[40:43], s87 offen offset:256 sc1
    v_mfma_f32_16x16x32_bf16 v[172:175], v[60:63], v[148:151], v[172:175]
    s_add_u32 s87, s87, 4096
    s_nop 0
    v_cvt_pk_bf16_f32 v64, v160, v164
    v_cvt_pk_bf16_f32 v80, v160, v164
    v_cvt_pk_bf16_f32 v66, v162, v166
    s_nop 2
    v_cvt_pk_bf16_f32 v65, v168, v172
    v_cvt_pk_bf16_f32 v81, v168, v172
    v_cvt_pk_bf16_f32 v67, v170, v174
    v_mov_b32_dpp v64, v66 row_ror:8 row_mask:0xf bank_mask:0xc
    s_nop 0
    v_mov_b32_dpp v65, v67 row_ror:8 row_mask:0xf bank_mask:0xc
    v_mov_b32_dpp v66, v80 row_ror:8 row_mask:0xf bank_mask:0x3
    v_mov_b32_dpp v67, v81 row_ror:8 row_mask:0xf bank_mask:0x3
    buffer_store_dwordx4 v[64:67], v214, s[40:43], s87 offen offset:0 sc1
    v_cvt_pk_bf16_f32 v68, v161, v165
    v_cvt_pk_bf16_f32 v82, v161, v165
    v_cvt_pk_bf16_f32 v70, v163, v167
    v_cvt_pk_bf16_f32 v69, v169, v173
    v_cvt_pk_bf16_f32 v83, v169, v173
    v_cvt_pk_bf16_f32 v71, v171, v175
    v_mov_b32_dpp v68, v70 row_ror:8 row_mask:0xf bank_mask:0xc
    s_nop 0
    v_mov_b32_dpp v69, v71 row_ror:8 row_mask:0xf bank_mask:0xc
    v_mov_b32_dpp v70, v82 row_ror:8 row_mask:0xf bank_mask:0x3
    v_mov_b32_dpp v71, v83 row_ror:8 row_mask:0xf bank_mask:0x3
    buffer_store_dwordx4 v[68:71], v214, s[40:43], s87 offen offset:256 sc1
    s_add_u32 s87, s87, 4096
L_stored:
L_done:
    s_endpgm
L_again:
    s_waitcnt vmcnt(0) lgkmcnt(0)
    s_barrier
    v_lshlrev_b32 v11, 2, v0
    v_mov_b32 v12, 0x00700000
    v_mov_b32 v13, 0
    ds_write_b32 v11, v12 offset:0
    ds_write_b32 v11, v12 offset:2048
    ds_write_b32 v11, v12 offset:4096
    ds_write_b32 v11, v12 offset:6144
    ds_write_b32 v11, v13 offset:8192
    ds_write_b32 v11, v13 offset:10240
    ds_write_b32 v11, v13 offset:12288
    v_mov_b32 v64, 0
    v_mov_b32 v65, 0
    v_mov_b32 v66, 0
    v_mov_b32 v67, 0
    v_mov_b32 v68, 0
    v_mov_b32 v69, 0
    v_mov_b32 v70, 0
    v_mov_b32 v71, 0
    v_mov_b32 v72, 0
    v_mov_b32 v73, 0
    v_mov_b32 v74, 0
    v_mov_b32 v75, 0
    v_mov_b32 v76, 0
    v_mov_b32 v77, 0
    v_mov_b32 v78, 0
    v_mov_b32 v79, 0
    v_mov_b32 v80, 0
    v_mov_b32 v81, 0
    v_mov_b32 v82, 0
    v_mov_b32 v83, 0
    v_mov_b32 v84, 0
    v_mov_b32 v85, 0
    v_mov_b32 v86, 0
    v_mov_b32 v87, 0
    v_mov_b32 v88, 0
    v_mov_b32 v89, 0
    v_mov_b32 v90, 0
    v_mov_b32 v91, 0
    v_mov_b32 v92, 0
    v_mov_b32 v93, 0
    v_mov_b32 v94, 0
    v_mov_b32 v95, 0
    v_add_u32 v3, v3, v4
    v_subrev_u32 v3, 224, v3
    v_max_i32 v3, 0, v3
    v_subrev_u32 v4, 224, v4
    v_max_i32 v4, 0, v4
    v_sub_u32 v3, v3, v4
    v_add_u32 v5, 224, v5
    s_sub_i32 s95, s95, 224
    v_lshl_add_u32 v8, v4, 2, v241
    s_waitcnt lgkmcnt(0)
    s_barrier
L_clip:
    v_add_u32 v10, v4, v3
    v_min_i32 v10, 224, v10
    v_sub_u32 v10, v10, v4
    v_add_u32 v10, v10, v240
L_masks:
    v_cmp_lt_i32 s[64:65], 0, v10
    v_cmp_lt_i32 s[66:67], 2, v10
    v_cmp_lt_i32 s[68:69], 4, v10
    v_cmp_lt_i32 s[70:71], 6, v10
    v_cmp_lt_i32 s[72:73], 8, v10
    v_cmp_lt_i32 s[74:75], 10, v10
    v_cmp_lt_i32 s[76:77], 12, v10
    v_cmp_lt_i32 s[78:79], 14, v10
    s_nop 0
    s_branch L_mapw
L_map2:
    v_add_u32 v8, 56, v8
    v_subrev_u32 v10, 14, v10
    s_branch L_masks
L_r1:
    ds_read_b32 v139, v242 offset:768
    ds_read_b32 v146, v243 offset:768
    s_waitcnt lgkmcnt(0)
    v_mad_u32_u24 v139, v139, 12, v244
    buffer_load_dwordx3 v[160:162], v139, s[24:27], 0 offen offset:2304 sc1
    v_lshl_add_u32 v146, v146, 5, v2
    s_add_u32 m0, s52, 4096
    s_nop 0
    buffer_load_dwordx4 v146, s[28:31], s98 offen offset:2048 sc1 lds
    s_branch L_r1b
L_r2:
    v_lshrrev_b32 v135, 21, v162
    v_lshlrev_b32 v135, 2, v135
    v_lshrrev_b32 v11, 26, v162
    v_lshl_or_b32 v11, v11, 4, v245
    s_mov_b64 exec, s[96:97]
    ds_add_rtn_u32 v131, v135, v6 offset:8192
    ds_add_u32 v11, v6 offset:14336
    s_mov_b64 exec, -1
    s_mov_b32 exec_hi, 0
    ds_write_b64 v246, v[160:161] offset:1536
    s_mov_b32 exec_hi, -1
    v_and_or_b32 v162, v162, s55, v247
    v_add_u32 v162, 402653184, v162
    s_branch L_r2b
L_r3:
    ds_read_b32 v135, v135 offset:8192
    s_waitcnt lgkmcnt(0)
    v_bfe_u32 v15, v135, 12, 3
    v_or_b32 v162, v15, v162
    v_and_b32 v139, 0x3ff, v135
    v_lshrrev_b32 v135, 16, v135
    v_add_u32 v135, v135, v131
    ds_read_b32 v139, v139 offset:16384
    s_waitcnt lgkmcnt(0)
    v_lshl_add_u32 v135, v135, 2, v139
    s_mov_b64 exec, s[96:97]
    ds_write_b32 v135, v162
    s_mov_b64 exec, -1
    s_branch L_r3b
L_tag:
    v_mov_b32 v11, s62
    s_mov_b32 s54, 524288
    buffer_store_dword v11, v242, s[20:23], s54 offen sc1
    s_branch L_tagged
L_empty:
    s_waitcnt vmcnt(0) lgkmcnt(0)
    s_barrier
    v_lshlrev_b32 v12, 2, v1
    s_lshl_b32 s61, s3, 7
    v_and_b32 v205, 0x7380, v205
    v_xor_b32 v205, s61, v205
    v_alignbit_b32 v205, v205, v205, 12
    v_cmp_eq_u32 s[80:81], 0, v205
    v_cmp_eq_u32 s[82:83], 1, v205
    v_cmp_eq_u32 s[84:85], 2, v205
    v_cmp_eq_u32 s[96:97], 3, v205
    v_cmp_eq_u32 vcc, 4, v205
    s_ff1_i32_b64 s56, s[80:81]
    s_mul_i32 s56, s56, 1152
    v_add_u32 v208, s56, v12
    s_ff1_i32_b64 s57, s[82:83]
    s_mul_i32 s57, s57, 1152
    v_add_u32 v209, s57, v12
    s_ff1_i32_b64 s58, s[84:85]
    s_mul_i32 s58, s58, 1152
    v_add_u32 v210, s58, v12
    s_ff1_i32_b64 s59, s[96:97]
    s_mul_i32 s59, s59, 1152
    v_add_u32 v211, s59, v12
    s_ff1_i32_b64 s60, vcc
    s_mul_i32 s60, s60, 1152
    v_add_u32 v212, s60, v12
    ds_read_b128 v[96:99], v215 offset:6144
    ds_read_b128 v[100:103], v215 offset:7168
    ds_read_b128 v[104:107], v215 offset:8192
    ds_read_b128 v[108:111], v215 offset:9216
    ds_read_b128 v[112:115], v215 offset:10240
    ds_read_b128 v[116:119], v215 offset:11264
    ds_read_b128 v[120:123], v215 offset:12288
    ds_read_b128 v[124:127], v215 offset:13312
    ds_read_b128 v[144:147], v215 offset:14336
    ds_read_b128 v[148:151], v215 offset:15360
    s_branch L_swept
L_two:
    s_nop 7
    v_cvt_pk_bf16_f32 v72, v176, v180
    v_cvt_pk_bf16_f32 v80, v176, v180
    v_cvt_pk_bf16_f32 v74, v178, v182
    v_cvt_pk_bf16_f32 v73, v184, v188
    v_cvt_pk_bf16_f32 v81, v184, v188
    v_cvt_pk_bf16_f32 v75, v186, v190
    v_mov_b32_dpp v72, v74 row_ror:8 row_mask:0xf bank_mask:0xc
    s_nop 0
    v_mov_b32_dpp v73, v75 row_ror:8 row_mask:0xf bank_mask:0xc
    v_mov_b32_dpp v74, v80 row_ror:8 row_mask:0xf bank_mask:0x3
    v_mov_b32_dpp v75, v81 row_ror:8 row_mask:0xf bank_mask:0x3
    buffer_store_dwordx4 v[72:75], v214, s[40:43], s87 offen offset:0 sc1
    v_cvt_pk_bf16_f32 v76, v177, v181
    v_cvt_pk_bf16_f32 v82, v177, v181
    v_cvt_pk_bf16_f32 v78, v179, v183
    v_cvt_pk_bf16_f32 v77, v185, v189
    v_cvt_pk_bf16_f32 v83, v185, v189
    v_cvt_pk_bf16_f32 v79, v187, v191
    v_mov_b32_dpp v76, v78 row_ror:8 row_mask:0xf bank_mask:0xc
    s_nop 0
    v_mov_b32_dpp v77, v79 row_ror:8 row_mask:0xf bank_mask:0xc
    v_mov_b32_dpp v78, v82 row_ror:8 row_mask:0xf bank_mask:0x3
    v_mov_b32_dpp v79, v83 row_ror:8 row_mask:0xf bank_mask:0x3
    buffer_store_dwordx4 v[76:79], v214, s[40:43], s87 offen offset:256 sc1
    s_add_u32 s87, s87, 4096
    s_branch L_stored
L_poll:
    buffer_load_dwordx2 v[206:207], v10, s[20:23], s49 offen sc1
    s_sub_u32 s53, s53, 1
    s_cbranch_scc1 L_done
    s_waitcnt vmcnt(0)
    v_xor_b32 v11, s63, v206
    v_xor_b32 v12, s62, v207
    v_and_or_b32 v11, v11, s55, v12
    v_cmpx_ne_u32 vcc, 0, v11
    s_cbranch_execnz L_poll
    s_branch L_polled
L_rank2:
    ds_read_b32 v96, v248 offset:8192
    ds_read_b32 v97, v248 offset:8320
    ds_read_b32 v98, v248 offset:8448
    ds_read_b32 v99, v248 offset:8576
    ds_read_b32 v100, v248 offset:8704
    ds_write_b64 v246, v[148:149] offset:0
    v_and_or_b32 v150, v150, s55, v247
    ds_write_b64 v246, v[152:153] offset:512
    v_and_or_b32 v154, v154, s55, v247
    v_add_u32 v154, 134217728, v154
    ds_write_b64 v246, v[156:157] offset:1024
    v_and_or_b32 v158, v158, s55, v247
    v_add_u32 v158, 268435456, v158
    s_waitcnt lgkmcnt(0)
L_end:
    s_branch L_ranked
.section .rodata,"a"
.p2align 6
.amdhsa_kernel gather_scatter__tensor_product_equiv_mace__graph_kernel
  .amdhsa_next_free_vgpr 256
  .amdhsa_next_free_sgpr 102
  .amdhsa_accum_offset 256
  .amdhsa_group_segment_fixed_size 0
  .amdhsa_kernarg_size 88
  .amdhsa_user_sgpr_count 2
  .amdhsa_user_sgpr_kernarg_segment_ptr 1
  .amdhsa_system_sgpr_workgroup_id_x 1
  .amdhsa_float_denorm_mode_32 3
.end_amdhsa_kernel
```
